```python
import torch

def _softmax(x, axis=-1):
    return torch.softmax(x, dim=axis)

def _gelu(x):
    return torch.nn.functional.gelu(x, approximate='tanh')

def _silu(x):
    return torch.nn.functional.silu(x)

def _sigmoid(x):
    return torch.sigmoid(x)

def _layernorm(x, axis=-1, eps=1e-05):
    m = x.mean(dim=axis, keepdim=True)
    v = x.var(dim=axis, keepdim=True, unbiased=False)
    return (x - m) / torch.sqrt(v + eps)

def _scatter_add(tgt, idx, src, axis=0):
    return tgt.clone().index_add_(axis, idx, src)

def _segment_sum(src, seg, n):
    out = torch.zeros((n,) + src.shape[1:], dtype=src.dtype)
    return out.index_add_(0, seg, src)

def _pad(x, pw):
    flat = tuple((v for pair in reversed(pw) for v in pair))
    return torch.nn.functional.pad(x, flat)
kernel_name = 'adaLN_cond__sliding_block_cached__dense_activation_gelu__decode'

def setup_inputs():

    _w = lambda a: (lambda t: t.to(torch.bfloat16) if t.is_floating_point() else t)(torch.as_tensor(a))

    def _A_setup():
        B, Sq, D = (4, 1, 640)
        Hq, Hkv, Sk, Dh = (32, 32, 8192, 128)
        assert Hq % Hkv == 0, (Hq, Hkv)
        return {'x': _w((lambda *s: torch.randn(*s, dtype=torch.bfloat16) * 0.1)(B, Sq, D)), 'k_cache': _w((lambda *s: torch.randn(*s, dtype=torch.bfloat16) * 0.8)(B, Hkv, Sk, Dh)), 'v_cache': _w((lambda *s: torch.randn(*s, dtype=torch.bfloat16) * 3.2)(B, Hkv, Sk, Dh)), 'wq': _w((lambda *s: torch.randn(*s, dtype=torch.bfloat16) * 0.8)(D, Hq * Dh) * D ** (-0.5)), 'wo': _w((lambda *s: torch.randn(*s, dtype=torch.bfloat16) * 3.2)(Hq * Dh, D) * (Hq * Dh) ** (-0.5))}
    _A_in = _A_setup()

    def _B_setup():
        B, S, D, F = (4, 1, 640, 1728)
        return {'x': _w((lambda *s: torch.randn(*s, dtype=torch.bfloat16) * 0.1)(B, S, D)), 'w1': _w((lambda *s: torch.randn(*s, dtype=torch.bfloat16) * 3.2)(D, F) * D ** (-0.5)), 'b1': _w((lambda *s: torch.randn(*s, dtype=torch.bfloat16) * 3.2)(F) * 0.01), 'w2': _w((lambda *s: torch.randn(*s, dtype=torch.bfloat16) * 3.2)(F, D) * F ** (-0.5)), 'b2': _w((lambda *s: torch.randn(*s, dtype=torch.bfloat16) * 3.2)(D) * 0.01)}
    _B_in = _B_setup()
    return {'A_x': _A_in['x'], 'A_k_cache': _A_in['k_cache'], 'A_v_cache': _A_in['v_cache'], 'A_wq': _A_in['wq'], 'A_wo': _A_in['wo'], 'B_x': _B_in['x'], 'B_w1': _B_in['w1'], 'B_b1': _B_in['b1'], 'B_w2': _B_in['w2'], 'B_b2': _B_in['b2'], 'c': _w((lambda *s: torch.randn(*s, dtype=torch.bfloat16) * 0.1)(4, 640) * 8.0), 'w_mod': _w((lambda *s: torch.randn(*s, dtype=torch.bfloat16) * 0.1)(640, 6 * 640) * 640 ** (-0.5) * 8.0)}

def reference(A_x, A_k_cache, A_v_cache, A_wq, A_wo, B_x, B_w1, B_b1, B_w2, B_b2, c, w_mod):

    def _A_ref(x, k_cache, v_cache, wq, wo):
        B, Sq, D = x.shape
        Hq, Dh = (32, 128)
        Hkv, Sk = (k_cache.shape[1], k_cache.shape[2])
        W = min(4096, max(256, Sk // 4))
        rep = Hq // Hkv
        q = (lambda x, *d: x.permute(*d))((x @ wq).reshape(B, Sq, Hq, Dh), 0, 2, 1, 3)
        k = (lambda x, n, axis: torch.repeat_interleave(x, n, dim=axis))(k_cache[:, :, Sk - W:, :], rep, axis=1)
        v = (lambda x, n, axis: torch.repeat_interleave(x, n, dim=axis))(v_cache[:, :, Sk - W:, :], rep, axis=1)
        scores = torch.einsum('bhqd,bhkd->bhqk', q, k) * Dh ** (-0.5)
        p = _softmax(scores, axis=-1)
        o = torch.einsum('bhqk,bhkd->bhqd', p, v)
        return (lambda x, *d: x.permute(*d))(o, 0, 2, 1, 3).reshape(B, Sq, Hq * Dh) @ wo

    def _B_ref(x, w1, b1, w2, b2):
        h = torch.einsum('bsd,df->bsf', x, w1) + b1
        h = _gelu(h)
        return torch.einsum('bsf,fd->bsd', h, w2) + b2
    x = A_x
    mod = (_silu(c) @ w_mod).reshape(c.shape[0], 6, 1, -1)
    sa, ca, ga, sb, cb, gb = (mod[:, 0].clone(), mod[:, 1].clone(), mod[:, 2].clone(), mod[:, 3].clone(), mod[:, 4].clone(), mod[:, 5].clone())
    h = _layernorm(x, axis=-1) * (1 + ca) + sa
    x = x + ga * _A_ref(h, A_k_cache, A_v_cache, A_wq, A_wo)
    h = _layernorm(x, axis=-1) * (1 + cb) + sb
    x = x + gb * _B_ref(h, B_w1, B_b1, B_w2, B_b2)
    return x
```

```asm
; @launch grid=(256,1,1) block=(768,1,1) lds=161344
.amdgcn_target "amdgcn-amd-amdhsa--gfx950"
.text
.globl adaLN_cond__sliding_block_cached__dense_activation_gelu__decode_kernel
.p2align 8
.type adaLN_cond__sliding_block_cached__dense_activation_gelu__decode_kernel,@function
adaLN_cond__sliding_block_cached__dense_activation_gelu__decode_kernel:
    s_cmp_ge_u32 s2, 256
    s_cbranch_scc1 L_end
    s_load_dwordx16 s[4:19], s[0:1], 0
    s_load_dwordx8 s[20:27], s[0:1], 64
    s_load_dwordx4 s[28:31], s[0:1], 96
    s_load_dwordx2 s[32:33], s[0:1], 112
    v_lshrrev_b32 v1, 6, v0
    v_and_b32 v0, 63, v0
    v_readfirstlane_b32 s3, v1
    s_and_b32 s34, s2, 7
    s_lshr_b32 s35, s2, 3
    s_lshr_b32 s36, s35, 3
    s_lshl2_add_u32 s36, s34, s36
    s_bfe_u32 s37, s35, 0x20001
    s_and_b32 s38, s35, 1
    s_cmp_lt_u32 s35, 27
    s_cselect_b32 s39, 1, 0
    s_cmp_eq_u32 s34, 0
    s_cselect_b32 s39, s39, 0
    s_mov_b32 s60, 400000
    s_mov_b32 s61, 0
    s_waitcnt lgkmcnt(0)
    s_mov_b32 s40, s32
    s_mov_b32 s41, s33
    s_mov_b32 s42, 262144
    s_mov_b32 s43, 0x20000
    s_mov_b32 s44, s30
    s_mov_b32 s45, s31
    s_mov_b32 s46, 256
    s_mov_b32 s47, 0x20000
    s_cmp_lt_u32 s3, 4
    s_cbranch_scc1 L_helpers
    s_sub_u32 s3, s3, 4
    s_lshl_b32 s62, s37, 5
    s_add_u32 s62, s62, s36
    s_lshl_b32 s63, s62, 21
    s_lshl_b32 s96, s38, 18
    s_add_u32 s63, s63, s96
    s_add_u32 s63, s63, 1572864
    s_add_u32 s48, s6, s63
    s_addc_u32 s49, s7, 0
    s_mov_b32 s50, 262144
    s_mov_b32 s51, 0x20000
    v_lshlrev_b32 v1, 4, v0
    s_lshl_b32 s96, s3, 12
    v_add_u32 v1, s96, v1
    s_mov_b32 s97, 0
    buffer_load_dwordx4 v[40:43], v1, s[48:51], s97 offen offset:0 nt
    buffer_load_dwordx4 v[44:47], v1, s[48:51], s97 offen offset:1024 nt
    buffer_load_dwordx4 v[48:51], v1, s[48:51], s97 offen offset:2048 nt
    buffer_load_dwordx4 v[52:55], v1, s[48:51], s97 offen offset:3072 nt
    s_add_u32 s97, s97, 32768
    s_add_u32 s52, s8, s63
    s_addc_u32 s53, s9, 0
    s_mov_b32 s54, 262144
    s_mov_b32 s55, 0x20000
    v_mov_b32 v36, 0
    v_and_b32 v2, 15, v0
    v_lshrrev_b32 v3, 1, v2
    v_and_b32 v37, 1, v2
    v_lshlrev_b32 v37, 4, v37
    v_mov_b32 v38, 0xffff
    v_lshlrev_b32 v37, v37, v38
    v_cmp_eq_u32 vcc, 0, v3
    s_nop 1
    v_cndmask_b32 v20, 0, v37, vcc
    v_mov_b32 v32, 0
    v_cmp_eq_u32 vcc, 1, v3
    s_nop 1
    v_cndmask_b32 v21, 0, v37, vcc
    v_mov_b32 v33, 0
    v_cmp_eq_u32 vcc, 2, v3
    s_nop 1
    v_cndmask_b32 v22, 0, v37, vcc
    v_mov_b32 v34, 0
    v_cmp_eq_u32 vcc, 3, v3
    s_nop 1
    v_cndmask_b32 v23, 0, v37, vcc
    v_mov_b32 v35, 0
    v_lshlrev_b32 v2, 4, v2
    s_lshl_b32 s98, s62, 8
    s_lshl_b32 s99, s62, 7
    s_add_u32 s99, s99, 32768
    s_waitcnt vmcnt(3)
    buffer_load_dwordx4 v[56:59], v1, s[48:51], s97 offen offset:0 nt
    s_waitcnt vmcnt(3)
    buffer_load_dwordx4 v[60:63], v1, s[48:51], s97 offen offset:1024 nt
    s_waitcnt vmcnt(3)
    buffer_load_dwordx4 v[64:67], v1, s[48:51], s97 offen offset:2048 nt
    s_waitcnt vmcnt(3)
    buffer_load_dwordx4 v[68:71], v1, s[48:51], s97 offen offset:3072 nt
    s_add_u32 s97, s97, 32768
    s_waitcnt vmcnt(3)
    buffer_load_dwordx4 v[72:75], v1, s[48:51], s97 offen offset:0 nt
    s_waitcnt vmcnt(3)
    buffer_load_dwordx4 v[76:79], v1, s[48:51], s97 offen offset:1024 nt
    s_waitcnt vmcnt(3)
    buffer_load_dwordx4 v[80:83], v1, s[48:51], s97 offen offset:2048 nt
    s_waitcnt vmcnt(3)
    buffer_load_dwordx4 v[84:87], v1, s[48:51], s97 offen offset:3072 nt
    s_add_u32 s97, s97, 32768
    s_waitcnt vmcnt(3)
    buffer_load_dwordx4 v[88:91], v1, s[48:51], s97 offen offset:0 nt
    s_waitcnt vmcnt(3)
    buffer_load_dwordx4 v[92:95], v1, s[48:51], s97 offen offset:1024 nt
    s_waitcnt vmcnt(3)
    buffer_load_dwordx4 v[96:99], v1, s[48:51], s97 offen offset:2048 nt
    s_waitcnt vmcnt(3)
    buffer_load_dwordx4 v[100:103], v1, s[48:51], s97 offen offset:3072 nt
    s_add_u32 s97, s97, 32768
    s_waitcnt vmcnt(3)
    buffer_load_dwordx4 v[104:107], v1, s[48:51], s97 offen offset:0 nt
    s_waitcnt vmcnt(3)
    buffer_load_dwordx4 v[108:111], v1, s[48:51], s97 offen offset:1024 nt
    s_waitcnt vmcnt(3)
    buffer_load_dwordx4 v[112:115], v1, s[48:51], s97 offen offset:2048 nt
    s_waitcnt vmcnt(3)
    buffer_load_dwordx4 v[116:119], v1, s[48:51], s97 offen offset:3072 nt
    s_add_u32 s97, s97, 32768
    s_waitcnt vmcnt(3)
    buffer_load_dwordx4 v[120:123], v1, s[48:51], s97 offen offset:0 nt
    s_waitcnt vmcnt(3)
    buffer_load_dwordx4 v[124:127], v1, s[48:51], s97 offen offset:1024 nt
    s_waitcnt vmcnt(3)
    buffer_load_dwordx4 v[128:131], v1, s[48:51], s97 offen offset:2048 nt
    buffer_load_dword v37, v36, s[44:47], 0 offen offset:128 sc1
    s_waitcnt vmcnt(3)
    buffer_load_dwordx4 v[132:135], v1, s[48:51], s97 offen offset:3072 nt
    s_add_u32 s97, s97, 32768
    s_waitcnt vmcnt(3)
    buffer_load_dwordx4 v[136:139], v1, s[48:51], s97 offen offset:0 nt
    s_waitcnt vmcnt(3)
    buffer_load_dwordx4 v[140:143], v1, s[48:51], s97 offen offset:1024 nt
    s_waitcnt vmcnt(3)
    buffer_load_dwordx4 v[144:147], v1, s[48:51], s97 offen offset:2048 nt
    s_waitcnt vmcnt(3)
    buffer_load_dwordx4 v[148:151], v1, s[48:51], s97 offen offset:3072 nt
    s_add_u32 s97, s97, 32768
    v_readfirstlane_b32 s96, v37
    buffer_load_dwordx4 v[4:7], v2, s[40:43], s98 offen sc1
    s_waitcnt vmcnt(3)
    buffer_load_dwordx4 v[152:155], v1, s[48:51], s97 offen offset:0 nt
    s_waitcnt vmcnt(3)
    buffer_load_dwordx4 v[156:159], v1, s[48:51], s97 offen offset:1024 nt
    s_waitcnt vmcnt(3)
    buffer_load_dwordx4 v[160:163], v1, s[48:51], s97 offen offset:2048 nt
    s_waitcnt vmcnt(3)
    buffer_load_dwordx4 v[164:167], v1, s[48:51], s97 offen offset:3072 nt
    s_mov_b32 s97, 0
    v_max3_u32 v38, v4, v5, v6
    v_max_u32 v38, v38, v7
    v_cmp_eq_u32 vcc, -1, v38
    s_cmp_eq_u32 s96, 0
    s_cbranch_scc1 L_qslow
    s_cbranch_vccnz L_qslow2
L_qok:
    v_dot2_f32_bf16 v8, v40, v4, 0
    v_dot2_f32_bf16 v9, v44, v4, 0
    v_dot2_f32_bf16 v10, v48, v4, 0
    v_dot2_f32_bf16 v11, v52, v4, 0
    v_dot2_f32_bf16 v24, v56, v4, 0
    v_dot2_f32_bf16 v25, v60, v4, 0
    v_dot2_f32_bf16 v26, v64, v4, 0
    v_dot2_f32_bf16 v27, v68, v4, 0
    v_dot2_f32_bf16 v8, v41, v5, v8
    v_dot2_f32_bf16 v9, v45, v5, v9
    v_dot2_f32_bf16 v10, v49, v5, v10
    v_dot2_f32_bf16 v11, v53, v5, v11
    v_dot2_f32_bf16 v24, v57, v5, v24
    v_dot2_f32_bf16 v25, v61, v5, v25
    v_dot2_f32_bf16 v26, v65, v5, v26
    v_dot2_f32_bf16 v27, v69, v5, v27
    v_dot2_f32_bf16 v8, v42, v6, v8
    v_dot2_f32_bf16 v9, v46, v6, v9
    v_dot2_f32_bf16 v10, v50, v6, v10
    v_dot2_f32_bf16 v11, v54, v6, v11
    v_dot2_f32_bf16 v24, v58, v6, v24
    v_dot2_f32_bf16 v25, v62, v6, v25
    v_dot2_f32_bf16 v26, v66, v6, v26
    v_dot2_f32_bf16 v27, v70, v6, v27
    v_dot2_f32_bf16 v8, v43, v7, v8
    v_dot2_f32_bf16 v9, v47, v7, v9
    v_dot2_f32_bf16 v10, v51, v7, v10
    v_dot2_f32_bf16 v11, v55, v7, v11
    v_dot2_f32_bf16 v24, v59, v7, v24
    v_dot2_f32_bf16 v25, v63, v7, v25
    v_dot2_f32_bf16 v26, v67, v7, v26
    v_dot2_f32_bf16 v27, v71, v7, v27
    v_add_f32_dpp v8, v8, v8 row_ror:8 row_mask:0xf bank_mask:0x3
    v_add_f32_dpp v10, v10, v10 row_ror:8 row_mask:0xf bank_mask:0x3
    v_add_f32_dpp v24, v24, v24 row_ror:8 row_mask:0xf bank_mask:0x3
    v_add_f32_dpp v26, v26, v26 row_ror:8 row_mask:0xf bank_mask:0x3
    v_add_f32_dpp v8, v9, v9 row_ror:8 row_mask:0xf bank_mask:0xc
    v_add_f32_dpp v10, v11, v11 row_ror:8 row_mask:0xf bank_mask:0xc
    v_add_f32_dpp v24, v25, v25 row_ror:8 row_mask:0xf bank_mask:0xc
    v_add_f32_dpp v26, v27, v27 row_ror:8 row_mask:0xf bank_mask:0xc
    v_add_f32_dpp v12, v8, v8 row_half_mirror row_mask:0xf bank_mask:0x5
    v_add_f32_dpp v13, v24, v24 row_half_mirror row_mask:0xf bank_mask:0x5
    v_add_f32_dpp v12, v10, v10 row_half_mirror row_mask:0xf bank_mask:0xa
    v_add_f32_dpp v13, v26, v26 row_half_mirror row_mask:0xf bank_mask:0xa
    s_nop 0
    v_add_f32_dpp v12, v12, v12 quad_perm:[1,0,3,2] row_mask:0xf bank_mask:0xf
    v_add_f32_dpp v13, v13, v13 quad_perm:[1,0,3,2] row_mask:0xf bank_mask:0xf
    s_nop 0
    v_add_f32_dpp v12, v12, v12 quad_perm:[2,3,0,1] row_mask:0xf bank_mask:0xf
    v_add_f32_dpp v13, v13, v13 quad_perm:[2,3,0,1] row_mask:0xf bank_mask:0xf
    s_waitcnt vmcnt(3)
    buffer_load_dwordx4 v[40:43], v1, s[52:55], s97 offen offset:0 nt
    v_dot2_f32_bf16 v8, v72, v4, 0
    v_dot2_f32_bf16 v9, v76, v4, 0
    v_dot2_f32_bf16 v10, v80, v4, 0
    v_dot2_f32_bf16 v11, v84, v4, 0
    v_dot2_f32_bf16 v24, v88, v4, 0
    v_dot2_f32_bf16 v25, v92, v4, 0
    v_dot2_f32_bf16 v26, v96, v4, 0
    v_dot2_f32_bf16 v27, v100, v4, 0
    v_dot2_f32_bf16 v28, v104, v4, 0
    v_dot2_f32_bf16 v29, v108, v4, 0
    v_dot2_f32_bf16 v30, v112, v4, 0
    v_dot2_f32_bf16 v31, v116, v4, 0
    v_dot2_f32_bf16 v8, v73, v5, v8
    v_dot2_f32_bf16 v9, v77, v5, v9
    v_dot2_f32_bf16 v10, v81, v5, v10
    v_dot2_f32_bf16 v11, v85, v5, v11
    v_dot2_f32_bf16 v24, v89, v5, v24
    v_dot2_f32_bf16 v25, v93, v5, v25
    v_dot2_f32_bf16 v26, v97, v5, v26
    v_dot2_f32_bf16 v27, v101, v5, v27
    v_dot2_f32_bf16 v28, v105, v5, v28
    v_dot2_f32_bf16 v29, v109, v5, v29
    v_dot2_f32_bf16 v30, v113, v5, v30
    v_dot2_f32_bf16 v31, v117, v5, v31
    v_dot2_f32_bf16 v8, v74, v6, v8
    v_dot2_f32_bf16 v9, v78, v6, v9
    v_dot2_f32_bf16 v10, v82, v6, v10
    v_dot2_f32_bf16 v11, v86, v6, v11
    v_dot2_f32_bf16 v24, v90, v6, v24
    v_dot2_f32_bf16 v25, v94, v6, v25
    v_dot2_f32_bf16 v26, v98, v6, v26
    v_dot2_f32_bf16 v27, v102, v6, v27
    v_dot2_f32_bf16 v28, v106, v6, v28
    v_dot2_f32_bf16 v29, v110, v6, v29
    v_dot2_f32_bf16 v30, v114, v6, v30
    v_dot2_f32_bf16 v31, v118, v6, v31
    v_dot2_f32_bf16 v8, v75, v7, v8
    v_dot2_f32_bf16 v9, v79, v7, v9
    v_dot2_f32_bf16 v10, v83, v7, v10
    v_dot2_f32_bf16 v11, v87, v7, v11
    v_dot2_f32_bf16 v24, v91, v7, v24
    v_dot2_f32_bf16 v25, v95, v7, v25
    v_dot2_f32_bf16 v26, v99, v7, v26
    v_dot2_f32_bf16 v27, v103, v7, v27
    v_dot2_f32_bf16 v28, v107, v7, v28
    v_dot2_f32_bf16 v29, v111, v7, v29
    v_dot2_f32_bf16 v30, v115, v7, v30
    v_dot2_f32_bf16 v31, v119, v7, v31
    v_add_f32_dpp v8, v8, v8 row_ror:8 row_mask:0xf bank_mask:0x3
    v_add_f32_dpp v10, v10, v10 row_ror:8 row_mask:0xf bank_mask:0x3
    v_add_f32_dpp v24, v24, v24 row_ror:8 row_mask:0xf bank_mask:0x3
    v_add_f32_dpp v26, v26, v26 row_ror:8 row_mask:0xf bank_mask:0x3
    v_add_f32_dpp v28, v28, v28 row_ror:8 row_mask:0xf bank_mask:0x3
    v_add_f32_dpp v30, v30, v30 row_ror:8 row_mask:0xf bank_mask:0x3
    v_add_f32_dpp v8, v9, v9 row_ror:8 row_mask:0xf bank_mask:0xc
    v_add_f32_dpp v10, v11, v11 row_ror:8 row_mask:0xf bank_mask:0xc
    v_add_f32_dpp v24, v25, v25 row_ror:8 row_mask:0xf bank_mask:0xc
    v_add_f32_dpp v26, v27, v27 row_ror:8 row_mask:0xf bank_mask:0xc
    v_add_f32_dpp v28, v29, v29 row_ror:8 row_mask:0xf bank_mask:0xc
    v_add_f32_dpp v30, v31, v31 row_ror:8 row_mask:0xf bank_mask:0xc
    v_add_f32_dpp v14, v8, v8 row_half_mirror row_mask:0xf bank_mask:0x5
    v_add_f32_dpp v15, v24, v24 row_half_mirror row_mask:0xf bank_mask:0x5
    v_add_f32_dpp v16, v28, v28 row_half_mirror row_mask:0xf bank_mask:0x5
    v_add_f32_dpp v14, v10, v10 row_half_mirror row_mask:0xf bank_mask:0xa
    v_add_f32_dpp v15, v26, v26 row_half_mirror row_mask:0xf bank_mask:0xa
    v_add_f32_dpp v16, v30, v30 row_half_mirror row_mask:0xf bank_mask:0xa
    v_add_f32_dpp v14, v14, v14 quad_perm:[1,0,3,2] row_mask:0xf bank_mask:0xf
    v_add_f32_dpp v15, v15, v15 quad_perm:[1,0,3,2] row_mask:0xf bank_mask:0xf
    v_add_f32_dpp v16, v16, v16 quad_perm:[1,0,3,2] row_mask:0xf bank_mask:0xf
    v_add_f32_dpp v14, v14, v14 quad_perm:[2,3,0,1] row_mask:0xf bank_mask:0xf
    v_add_f32_dpp v15, v15, v15 quad_perm:[2,3,0,1] row_mask:0xf bank_mask:0xf
    v_add_f32_dpp v16, v16, v16 quad_perm:[2,3,0,1] row_mask:0xf bank_mask:0xf
    s_waitcnt vmcnt(3)
    buffer_load_dwordx4 v[44:47], v1, s[52:55], s97 offen offset:1024 nt
    v_dot2_f32_bf16 v8, v120, v4, 0
    v_dot2_f32_bf16 v9, v124, v4, 0
    v_dot2_f32_bf16 v10, v128, v4, 0
    v_dot2_f32_bf16 v11, v132, v4, 0
    v_dot2_f32_bf16 v24, v136, v4, 0
    v_dot2_f32_bf16 v25, v140, v4, 0
    v_dot2_f32_bf16 v26, v144, v4, 0
    v_dot2_f32_bf16 v27, v148, v4, 0
    v_dot2_f32_bf16 v8, v121, v5, v8
    v_dot2_f32_bf16 v9, v125, v5, v9
    v_dot2_f32_bf16 v10, v129, v5, v10
    v_dot2_f32_bf16 v11, v133, v5, v11
    v_dot2_f32_bf16 v24, v137, v5, v24
    v_dot2_f32_bf16 v25, v141, v5, v25
    v_dot2_f32_bf16 v26, v145, v5, v26
    v_dot2_f32_bf16 v27, v149, v5, v27
    v_dot2_f32_bf16 v8, v122, v6, v8
    v_dot2_f32_bf16 v9, v126, v6, v9
    v_dot2_f32_bf16 v10, v130, v6, v10
    v_dot2_f32_bf16 v11, v134, v6, v11
    v_dot2_f32_bf16 v24, v138, v6, v24
    v_dot2_f32_bf16 v25, v142, v6, v25
    v_dot2_f32_bf16 v26, v146, v6, v26
    v_dot2_f32_bf16 v27, v150, v6, v27
    v_dot2_f32_bf16 v8, v123, v7, v8
    v_dot2_f32_bf16 v9, v127, v7, v9
    v_dot2_f32_bf16 v10, v131, v7, v10
    v_dot2_f32_bf16 v11, v135, v7, v11
    v_dot2_f32_bf16 v24, v139, v7, v24
    v_dot2_f32_bf16 v25, v143, v7, v25
    v_dot2_f32_bf16 v26, v147, v7, v26
    v_dot2_f32_bf16 v27, v151, v7, v27
    v_add_f32_dpp v8, v8, v8 row_ror:8 row_mask:0xf bank_mask:0x3
    v_add_f32_dpp v10, v10, v10 row_ror:8 row_mask:0xf bank_mask:0x3
    v_add_f32_dpp v24, v24, v24 row_ror:8 row_mask:0xf bank_mask:0x3
    v_add_f32_dpp v26, v26, v26 row_ror:8 row_mask:0xf bank_mask:0x3
    v_add_f32_dpp v8, v9, v9 row_ror:8 row_mask:0xf bank_mask:0xc
    v_add_f32_dpp v10, v11, v11 row_ror:8 row_mask:0xf bank_mask:0xc
    v_add_f32_dpp v24, v25, v25 row_ror:8 row_mask:0xf bank_mask:0xc
    v_add_f32_dpp v26, v27, v27 row_ror:8 row_mask:0xf bank_mask:0xc
    v_add_f32_dpp v17, v8, v8 row_half_mirror row_mask:0xf bank_mask:0x5
    v_add_f32_dpp v18, v24, v24 row_half_mirror row_mask:0xf bank_mask:0x5
    v_add_f32_dpp v17, v10, v10 row_half_mirror row_mask:0xf bank_mask:0xa
    v_add_f32_dpp v18, v26, v26 row_half_mirror row_mask:0xf bank_mask:0xa
    s_nop 0
    v_add_f32_dpp v17, v17, v17 quad_perm:[1,0,3,2] row_mask:0xf bank_mask:0xf
    v_add_f32_dpp v18, v18, v18 quad_perm:[1,0,3,2] row_mask:0xf bank_mask:0xf
    s_nop 0
    v_add_f32_dpp v17, v17, v17 quad_perm:[2,3,0,1] row_mask:0xf bank_mask:0xf
    v_add_f32_dpp v18, v18, v18 quad_perm:[2,3,0,1] row_mask:0xf bank_mask:0xf
    s_waitcnt vmcnt(3)
    buffer_load_dwordx4 v[48:51], v1, s[52:55], s97 offen offset:2048 nt
    s_waitcnt vmcnt(3)
    buffer_load_dwordx4 v[52:55], v1, s[52:55], s97 offen offset:3072 nt
    s_add_u32 s97, s97, 32768
    v_dot2_f32_bf16 v8, v152, v4, 0
    v_dot2_f32_bf16 v9, v156, v4, 0
    v_dot2_f32_bf16 v10, v160, v4, 0
    v_dot2_f32_bf16 v11, v164, v4, 0
    v_dot2_f32_bf16 v8, v153, v5, v8
    v_dot2_f32_bf16 v9, v157, v5, v9
    v_dot2_f32_bf16 v10, v161, v5, v10
    v_dot2_f32_bf16 v11, v165, v5, v11
    v_dot2_f32_bf16 v8, v154, v6, v8
    v_dot2_f32_bf16 v9, v158, v6, v9
    v_dot2_f32_bf16 v10, v162, v6, v10
    v_dot2_f32_bf16 v11, v166, v6, v11
    v_dot2_f32_bf16 v8, v155, v7, v8
    v_dot2_f32_bf16 v9, v159, v7, v9
    v_dot2_f32_bf16 v10, v163, v7, v10
    v_dot2_f32_bf16 v11, v167, v7, v11
    v_add_f32_dpp v8, v8, v8 row_ror:8 row_mask:0xf bank_mask:0x3
    s_nop 0
    v_add_f32_dpp v10, v10, v10 row_ror:8 row_mask:0xf bank_mask:0x3
    v_add_f32_dpp v8, v9, v9 row_ror:8 row_mask:0xf bank_mask:0xc
    v_add_f32_dpp v10, v11, v11 row_ror:8 row_mask:0xf bank_mask:0xc
    s_nop 0
    v_add_f32_dpp v19, v8, v8 row_half_mirror row_mask:0xf bank_mask:0x5
    v_add_f32_dpp v19, v10, v10 row_half_mirror row_mask:0xf bank_mask:0xa
    s_nop 1
    v_add_f32_dpp v19, v19, v19 quad_perm:[1,0,3,2] row_mask:0xf bank_mask:0xf
    s_nop 1
    v_add_f32_dpp v19, v19, v19 quad_perm:[2,3,0,1] row_mask:0xf bank_mask:0xf
    v_max3_f32 v3, v12, v13, v14
    v_max3_f32 v8, v15, v16, v17
    v_max3_f32 v3, v3, v18, v19
    v_max_f32 v3, v3, v8
    s_nop 1
    v_max_f32_dpp v3, v3, v3 row_ror:4 row_mask:0xf bank_mask:0xf
    s_nop 1
    v_max_f32_dpp v3, v3, v3 row_ror:8 row_mask:0xf bank_mask:0xf
    v_mov_b32 v8, v3
    s_nop 1
    v_permlane16_swap_b32 v3, v8
    v_max_f32 v3, v3, v8
    v_mov_b32 v8, v3
    s_nop 1
    v_permlane32_swap_b32 v3, v8
    v_max_f32 v3, v3, v8
    s_mov_b32 s96, 0x3e0293ee
    v_mul_f32 v8, s96, v3
    v_fma_f32 v12, v12, s96, -v8
    v_fma_f32 v13, v13, s96, -v8
    v_fma_f32 v14, v14, s96, -v8
    v_fma_f32 v15, v15, s96, -v8
    v_fma_f32 v16, v16, s96, -v8
    v_fma_f32 v17, v17, s96, -v8
    v_fma_f32 v18, v18, s96, -v8
    v_fma_f32 v19, v19, s96, -v8
    v_exp_f32 v12, v12
    v_exp_f32 v13, v13
    v_exp_f32 v14, v14
    v_exp_f32 v15, v15
    v_exp_f32 v16, v16
    v_exp_f32 v17, v17
    v_exp_f32 v18, v18
    v_exp_f32 v19, v19
    v_add_f32 v9, v12, v13
    v_add_f32 v10, v14, v15
    v_add_f32 v11, v16, v17
    v_add_f32 v3, v18, v19
    v_add_f32 v9, v9, v10
    v_add_f32 v3, v3, v11
    v_add_f32 v9, v9, v3
    v_cvt_pk_bf16_f32 v12, v12, v12
    v_cvt_pk_bf16_f32 v13, v13, v13
    v_cvt_pk_bf16_f32 v14, v14, v14
    v_cvt_pk_bf16_f32 v15, v15, v15
    v_cvt_pk_bf16_f32 v16, v16, v16
    v_cvt_pk_bf16_f32 v17, v17, v17
    v_cvt_pk_bf16_f32 v18, v18, v18
    v_cvt_pk_bf16_f32 v19, v19, v19
    v_add_f32_dpp v9, v9, v9 row_ror:4 row_mask:0xf bank_mask:0xf
    s_nop 1
    v_add_f32_dpp v9, v9, v9 row_ror:8 row_mask:0xf bank_mask:0xf
    v_mov_b32 v10, v9
    s_nop 1
    v_permlane16_swap_b32 v9, v10
    v_add_f32 v9, v9, v10
    v_mov_b32 v10, v9
    s_nop 1
    v_permlane32_swap_b32 v9, v10
    v_add_f32 v9, v9, v10
    s_lshl_b32 s96, s38, 3
    s_add_u32 s96, s96, s3
    s_lshl3_add_u32 s96, s96, s99
    s_mov_b64 exec, 1
    buffer_store_dwordx2 v[8:9], v36, s[40:43], s96 offen sc1
    s_mov_b64 exec, -1
    v_mov_b32 v3, v8
    v_lshrrev_b32 v2, 1, v2
    v_and_b32_dpp v24, v12, v20 row_newbcast:0 row_mask:0xf bank_mask:0xf
    v_and_b32_dpp v25, v12, v21 row_newbcast:0 row_mask:0xf bank_mask:0xf
    v_and_b32_dpp v26, v12, v22 row_newbcast:0 row_mask:0xf bank_mask:0xf
    v_and_b32_dpp v27, v12, v23 row_newbcast:0 row_mask:0xf bank_mask:0xf
    s_waitcnt vmcnt(4)
    s_nop 0
    v_mfma_f32_16x16x32_bf16 v[32:35], v[24:27], v[40:43], v[32:35]
    v_and_b32_dpp v28, v12, v20 row_newbcast:8 row_mask:0xf bank_mask:0xf
    v_and_b32_dpp v29, v12, v21 row_newbcast:8 row_mask:0xf bank_mask:0xf
    v_and_b32_dpp v30, v12, v22 row_newbcast:8 row_mask:0xf bank_mask:0xf
    v_and_b32_dpp v31, v12, v23 row_newbcast:8 row_mask:0xf bank_mask:0xf
    s_waitcnt vmcnt(3)
    buffer_load_dwordx4 v[56:59], v1, s[52:55], s97 offen offset:0 nt
    v_mfma_f32_16x16x32_bf16 v[32:35], v[28:31], v[44:47], v[32:35]
    v_and_b32_dpp v24, v12, v20 row_newbcast:4 row_mask:0xf bank_mask:0xf
    v_and_b32_dpp v25, v12, v21 row_newbcast:4 row_mask:0xf bank_mask:0xf
    v_and_b32_dpp v26, v12, v22 row_newbcast:4 row_mask:0xf bank_mask:0xf
    v_and_b32_dpp v27, v12, v23 row_newbcast:4 row_mask:0xf bank_mask:0xf
    s_waitcnt vmcnt(3)
    buffer_load_dwordx4 v[60:63], v1, s[52:55], s97 offen offset:1024 nt
    v_mfma_f32_16x16x32_bf16 v[32:35], v[24:27], v[48:51], v[32:35]
    v_and_b32_dpp v28, v12, v20 row_newbcast:12 row_mask:0xf bank_mask:0xf
    v_and_b32_dpp v29, v12, v21 row_newbcast:12 row_mask:0xf bank_mask:0xf
    v_and_b32_dpp v30, v12, v22 row_newbcast:12 row_mask:0xf bank_mask:0xf
    v_and_b32_dpp v31, v12, v23 row_newbcast:12 row_mask:0xf bank_mask:0xf
    s_waitcnt vmcnt(3)
    buffer_load_dwordx4 v[64:67], v1, s[52:55], s97 offen offset:2048 nt
    v_mfma_f32_16x16x32_bf16 v[32:35], v[28:31], v[52:55], v[32:35]
    v_and_b32_dpp v24, v13, v20 row_newbcast:0 row_mask:0xf bank_mask:0xf
    v_and_b32_dpp v25, v13, v21 row_newbcast:0 row_mask:0xf bank_mask:0xf
    v_and_b32_dpp v26, v13, v22 row_newbcast:0 row_mask:0xf bank_mask:0xf
    v_and_b32_dpp v27, v13, v23 row_newbcast:0 row_mask:0xf bank_mask:0xf
    s_waitcnt vmcnt(2)
    buffer_load_dwordx4 v[68:71], v1, s[52:55], s97 offen offset:3072 nt
    s_add_u32 s97, s97, 32768
    buffer_load_dwordx4 v[72:75], v1, s[52:55], s97 offen offset:0 nt
    v_mfma_f32_16x16x32_bf16 v[32:35], v[24:27], v[56:59], v[32:35]
    v_and_b32_dpp v28, v13, v20 row_newbcast:8 row_mask:0xf bank_mask:0xf
    v_and_b32_dpp v29, v13, v21 row_newbcast:8 row_mask:0xf bank_mask:0xf
    v_and_b32_dpp v30, v13, v22 row_newbcast:8 row_mask:0xf bank_mask:0xf
    v_and_b32_dpp v31, v13, v23 row_newbcast:8 row_mask:0xf bank_mask:0xf
    s_waitcnt vmcnt(3)
    buffer_load_dwordx4 v[76:79], v1, s[52:55], s97 offen offset:1024 nt
    v_mfma_f32_16x16x32_bf16 v[32:35], v[28:31], v[60:63], v[32:35]
    v_and_b32_dpp v24, v13, v20 row_newbcast:4 row_mask:0xf bank_mask:0xf
    v_and_b32_dpp v25, v13, v21 row_newbcast:4 row_mask:0xf bank_mask:0xf
    v_and_b32_dpp v26, v13, v22 row_newbcast:4 row_mask:0xf bank_mask:0xf
    v_and_b32_dpp v27, v13, v23 row_newbcast:4 row_mask:0xf bank_mask:0xf
    s_waitcnt vmcnt(3)
    buffer_load_dwordx4 v[80:83], v1, s[52:55], s97 offen offset:2048 nt
    v_mfma_f32_16x16x32_bf16 v[32:35], v[24:27], v[64:67], v[32:35]
    v_and_b32_dpp v28, v13, v20 row_newbcast:12 row_mask:0xf bank_mask:0xf
    v_and_b32_dpp v29, v13, v21 row_newbcast:12 row_mask:0xf bank_mask:0xf
    v_and_b32_dpp v30, v13, v22 row_newbcast:12 row_mask:0xf bank_mask:0xf
    v_and_b32_dpp v31, v13, v23 row_newbcast:12 row_mask:0xf bank_mask:0xf
    s_waitcnt vmcnt(3)
    buffer_load_dwordx4 v[84:87], v1, s[52:55], s97 offen offset:3072 nt
    s_add_u32 s97, s97, 32768
    v_mfma_f32_16x16x32_bf16 v[32:35], v[28:31], v[68:71], v[32:35]
    v_and_b32_dpp v24, v14, v20 row_newbcast:0 row_mask:0xf bank_mask:0xf
    v_and_b32_dpp v25, v14, v21 row_newbcast:0 row_mask:0xf bank_mask:0xf
    v_and_b32_dpp v26, v14, v22 row_newbcast:0 row_mask:0xf bank_mask:0xf
    v_and_b32_dpp v27, v14, v23 row_newbcast:0 row_mask:0xf bank_mask:0xf
    s_waitcnt vmcnt(3)
    buffer_load_dwordx4 v[88:91], v1, s[52:55], s97 offen offset:0 nt
    v_mfma_f32_16x16x32_bf16 v[32:35], v[24:27], v[72:75], v[32:35]
    v_and_b32_dpp v28, v14, v20 row_newbcast:8 row_mask:0xf bank_mask:0xf
    v_and_b32_dpp v29, v14, v21 row_newbcast:8 row_mask:0xf bank_mask:0xf
    v_and_b32_dpp v30, v14, v22 row_newbcast:8 row_mask:0xf bank_mask:0xf
    v_and_b32_dpp v31, v14, v23 row_newbcast:8 row_mask:0xf bank_mask:0xf
    s_waitcnt vmcnt(3)
    buffer_load_dwordx4 v[92:95], v1, s[52:55], s97 offen offset:1024 nt
    v_mfma_f32_16x16x32_bf16 v[32:35], v[28:31], v[76:79], v[32:35]
    v_and_b32_dpp v24, v14, v20 row_newbcast:4 row_mask:0xf bank_mask:0xf
    v_and_b32_dpp v25, v14, v21 row_newbcast:4 row_mask:0xf bank_mask:0xf
    v_and_b32_dpp v26, v14, v22 row_newbcast:4 row_mask:0xf bank_mask:0xf
    v_and_b32_dpp v27, v14, v23 row_newbcast:4 row_mask:0xf bank_mask:0xf
    s_waitcnt vmcnt(3)
    buffer_load_dwordx4 v[96:99], v1, s[52:55], s97 offen offset:2048 nt
    v_mfma_f32_16x16x32_bf16 v[32:35], v[24:27], v[80:83], v[32:35]
    v_and_b32_dpp v28, v14, v20 row_newbcast:12 row_mask:0xf bank_mask:0xf
    v_and_b32_dpp v29, v14, v21 row_newbcast:12 row_mask:0xf bank_mask:0xf
    v_and_b32_dpp v30, v14, v22 row_newbcast:12 row_mask:0xf bank_mask:0xf
    v_and_b32_dpp v31, v14, v23 row_newbcast:12 row_mask:0xf bank_mask:0xf
    s_waitcnt vmcnt(3)
    buffer_load_dwordx4 v[100:103], v1, s[52:55], s97 offen offset:3072 nt
    s_add_u32 s97, s97, 32768
    v_mfma_f32_16x16x32_bf16 v[32:35], v[28:31], v[84:87], v[32:35]
    v_and_b32_dpp v24, v15, v20 row_newbcast:0 row_mask:0xf bank_mask:0xf
    v_and_b32_dpp v25, v15, v21 row_newbcast:0 row_mask:0xf bank_mask:0xf
    v_and_b32_dpp v26, v15, v22 row_newbcast:0 row_mask:0xf bank_mask:0xf
    v_and_b32_dpp v27, v15, v23 row_newbcast:0 row_mask:0xf bank_mask:0xf
    s_waitcnt vmcnt(3)
    buffer_load_dwordx4 v[104:107], v1, s[52:55], s97 offen offset:0 nt
    v_mfma_f32_16x16x32_bf16 v[32:35], v[24:27], v[88:91], v[32:35]
    v_and_b32_dpp v28, v15, v20 row_newbcast:8 row_mask:0xf bank_mask:0xf
    v_and_b32_dpp v29, v15, v21 row_newbcast:8 row_mask:0xf bank_mask:0xf
    v_and_b32_dpp v30, v15, v22 row_newbcast:8 row_mask:0xf bank_mask:0xf
    v_and_b32_dpp v31, v15, v23 row_newbcast:8 row_mask:0xf bank_mask:0xf
    s_waitcnt vmcnt(3)
    buffer_load_dwordx4 v[108:111], v1, s[52:55], s97 offen offset:1024 nt
    v_mfma_f32_16x16x32_bf16 v[32:35], v[28:31], v[92:95], v[32:35]
    v_and_b32_dpp v24, v15, v20 row_newbcast:4 row_mask:0xf bank_mask:0xf
    v_and_b32_dpp v25, v15, v21 row_newbcast:4 row_mask:0xf bank_mask:0xf
    v_and_b32_dpp v26, v15, v22 row_newbcast:4 row_mask:0xf bank_mask:0xf
    v_and_b32_dpp v27, v15, v23 row_newbcast:4 row_mask:0xf bank_mask:0xf
    s_waitcnt vmcnt(3)
    buffer_load_dwordx4 v[112:115], v1, s[52:55], s97 offen offset:2048 nt
    v_mfma_f32_16x16x32_bf16 v[32:35], v[24:27], v[96:99], v[32:35]
    v_and_b32_dpp v28, v15, v20 row_newbcast:12 row_mask:0xf bank_mask:0xf
    v_and_b32_dpp v29, v15, v21 row_newbcast:12 row_mask:0xf bank_mask:0xf
    v_and_b32_dpp v30, v15, v22 row_newbcast:12 row_mask:0xf bank_mask:0xf
    v_and_b32_dpp v31, v15, v23 row_newbcast:12 row_mask:0xf bank_mask:0xf
    s_waitcnt vmcnt(3)
    buffer_load_dwordx4 v[116:119], v1, s[52:55], s97 offen offset:3072 nt
    s_add_u32 s97, s97, 32768
    v_mfma_f32_16x16x32_bf16 v[32:35], v[28:31], v[100:103], v[32:35]
    v_and_b32_dpp v24, v16, v20 row_newbcast:0 row_mask:0xf bank_mask:0xf
    v_and_b32_dpp v25, v16, v21 row_newbcast:0 row_mask:0xf bank_mask:0xf
    v_and_b32_dpp v26, v16, v22 row_newbcast:0 row_mask:0xf bank_mask:0xf
    v_and_b32_dpp v27, v16, v23 row_newbcast:0 row_mask:0xf bank_mask:0xf
    s_waitcnt vmcnt(3)
    buffer_load_dwordx4 v[120:123], v1, s[52:55], s97 offen offset:0 nt
    v_mfma_f32_16x16x32_bf16 v[32:35], v[24:27], v[104:107], v[32:35]
    v_and_b32_dpp v28, v16, v20 row_newbcast:8 row_mask:0xf bank_mask:0xf
    v_and_b32_dpp v29, v16, v21 row_newbcast:8 row_mask:0xf bank_mask:0xf
    v_and_b32_dpp v30, v16, v22 row_newbcast:8 row_mask:0xf bank_mask:0xf
    v_and_b32_dpp v31, v16, v23 row_newbcast:8 row_mask:0xf bank_mask:0xf
    s_waitcnt vmcnt(3)
    buffer_load_dwordx4 v[124:127], v1, s[52:55], s97 offen offset:1024 nt
    buffer_load_dwordx2 v[8:9], v2, s[40:43], s99 offen sc1
    s_lshl_b32 s98, s34, 5
    s_add_u32 s98, s98, s35
    s_lshl_b32 s98, s98, 8
    s_add_u32 s98, s98, 86016
    s_lshl_b32 s96, s34, 2
    v_lshlrev_b32 v39, 2, v0
    buffer_load_dword v10, v39, s[40:43], s98 offen sc1
    buffer_load_dword v11, v36, s[44:47], s96 offen offset:64 sc1
    v_mfma_f32_16x16x32_bf16 v[32:35], v[28:31], v[108:111], v[32:35]
    v_and_b32_dpp v24, v16, v20 row_newbcast:4 row_mask:0xf bank_mask:0xf
    v_and_b32_dpp v25, v16, v21 row_newbcast:4 row_mask:0xf bank_mask:0xf
    v_and_b32_dpp v26, v16, v22 row_newbcast:4 row_mask:0xf bank_mask:0xf
    v_and_b32_dpp v27, v16, v23 row_newbcast:4 row_mask:0xf bank_mask:0xf
    s_waitcnt vmcnt(6)
    s_nop 0
    v_mfma_f32_16x16x32_bf16 v[32:35], v[24:27], v[112:115], v[32:35]
    v_and_b32_dpp v28, v16, v20 row_newbcast:12 row_mask:0xf bank_mask:0xf
    v_and_b32_dpp v29, v16, v21 row_newbcast:12 row_mask:0xf bank_mask:0xf
    v_and_b32_dpp v30, v16, v22 row_newbcast:12 row_mask:0xf bank_mask:0xf
    v_and_b32_dpp v31, v16, v23 row_newbcast:12 row_mask:0xf bank_mask:0xf
    s_waitcnt vmcnt(5)
    s_nop 0
    v_mfma_f32_16x16x32_bf16 v[32:35], v[28:31], v[116:119], v[32:35]
    v_and_b32_dpp v24, v17, v20 row_newbcast:0 row_mask:0xf bank_mask:0xf
    v_and_b32_dpp v25, v17, v21 row_newbcast:0 row_mask:0xf bank_mask:0xf
    v_and_b32_dpp v26, v17, v22 row_newbcast:0 row_mask:0xf bank_mask:0xf
    v_and_b32_dpp v27, v17, v23 row_newbcast:0 row_mask:0xf bank_mask:0xf
    s_waitcnt vmcnt(4)
    s_nop 0
    v_mfma_f32_16x16x32_bf16 v[32:35], v[24:27], v[120:123], v[32:35]
    v_and_b32_dpp v28, v17, v20 row_newbcast:8 row_mask:0xf bank_mask:0xf
    v_and_b32_dpp v29, v17, v21 row_newbcast:8 row_mask:0xf bank_mask:0xf
    v_and_b32_dpp v30, v17, v22 row_newbcast:8 row_mask:0xf bank_mask:0xf
    v_and_b32_dpp v31, v17, v23 row_newbcast:8 row_mask:0xf bank_mask:0xf
    s_waitcnt vmcnt(3)
    buffer_load_dwordx4 v[128:131], v1, s[52:55], s97 offen offset:2048 nt
    v_mfma_f32_16x16x32_bf16 v[32:35], v[28:31], v[124:127], v[32:35]
    v_and_b32_dpp v24, v17, v20 row_newbcast:4 row_mask:0xf bank_mask:0xf
    v_and_b32_dpp v25, v17, v21 row_newbcast:4 row_mask:0xf bank_mask:0xf
    v_and_b32_dpp v26, v17, v22 row_newbcast:4 row_mask:0xf bank_mask:0xf
    v_and_b32_dpp v27, v17, v23 row_newbcast:4 row_mask:0xf bank_mask:0xf
    s_waitcnt vmcnt(0)
    buffer_load_dwordx4 v[132:135], v1, s[52:55], s97 offen offset:3072 nt
    s_add_u32 s97, s97, 32768
    buffer_load_dwordx4 v[136:139], v1, s[52:55], s97 offen offset:0 nt
    buffer_load_dwordx4 v[140:143], v1, s[52:55], s97 offen offset:1024 nt
    buffer_load_dwordx4 v[144:147], v1, s[52:55], s97 offen offset:2048 nt
    v_mfma_f32_16x16x32_bf16 v[32:35], v[24:27], v[128:131], v[32:35]
    v_and_b32_dpp v28, v17, v20 row_newbcast:12 row_mask:0xf bank_mask:0xf
    v_and_b32_dpp v29, v17, v21 row_newbcast:12 row_mask:0xf bank_mask:0xf
    v_and_b32_dpp v30, v17, v22 row_newbcast:12 row_mask:0xf bank_mask:0xf
    v_and_b32_dpp v31, v17, v23 row_newbcast:12 row_mask:0xf bank_mask:0xf
    s_waitcnt vmcnt(3)
    buffer_load_dwordx4 v[148:151], v1, s[52:55], s97 offen offset:3072 nt
    s_add_u32 s97, s97, 32768
    v_mfma_f32_16x16x32_bf16 v[32:35], v[28:31], v[132:135], v[32:35]
    v_and_b32_dpp v24, v18, v20 row_newbcast:0 row_mask:0xf bank_mask:0xf
    v_and_b32_dpp v25, v18, v21 row_newbcast:0 row_mask:0xf bank_mask:0xf
    v_and_b32_dpp v26, v18, v22 row_newbcast:0 row_mask:0xf bank_mask:0xf
    v_and_b32_dpp v27, v18, v23 row_newbcast:0 row_mask:0xf bank_mask:0xf
    s_waitcnt vmcnt(3)
    buffer_load_dwordx4 v[152:155], v1, s[52:55], s97 offen offset:0 nt
    v_mfma_f32_16x16x32_bf16 v[32:35], v[24:27], v[136:139], v[32:35]
    v_max_u32 v38, v8, v9
    v_cmp_eq_u32 vcc, -1, v38
    s_cbranch_vccnz L_mlslow
L_mlok:
    v_mov_b32 v37, v8
    s_nop 1
    v_max_f32_dpp v37, v37, v37 quad_perm:[1,0,3,2] row_mask:0xf bank_mask:0xf
    s_nop 1
    v_max_f32_dpp v37, v37, v37 quad_perm:[2,3,0,1] row_mask:0xf bank_mask:0xf
    s_nop 1
    v_max_f32_dpp v37, v37, v37 row_ror:4 row_mask:0xf bank_mask:0xf
    s_nop 1
    v_max_f32_dpp v37, v37, v37 row_ror:8 row_mask:0xf bank_mask:0xf
    v_sub_f32 v8, v8, v37
    v_sub_f32 v3, v3, v37
    v_exp_f32 v8, v8
    v_exp_f32 v3, v3
    v_mul_f32 v8, v8, v9
    s_nop 1
    v_add_f32_dpp v8, v8, v8 quad_perm:[1,0,3,2] row_mask:0xf bank_mask:0xf
    s_nop 1
    v_add_f32_dpp v8, v8, v8 quad_perm:[2,3,0,1] row_mask:0xf bank_mask:0xf
    s_nop 1
    v_add_f32_dpp v8, v8, v8 row_ror:4 row_mask:0xf bank_mask:0xf
    s_nop 1
    v_add_f32_dpp v8, v8, v8 row_ror:8 row_mask:0xf bank_mask:0xf
    v_rcp_f32 v8, v8
    s_nop 0
    v_mul_f32 v3, v3, v8
    s_getreg_b32 s62, hwreg(HW_REG_XCC_ID, 0, 4)
    s_mul_i32 s63, s62, s62
    s_lshl_b32 s62, s62, 13
    s_lshl_b32 s63, s63, 22
    s_add_u32 s62, s62, s63
    s_add_u32 s62, s62, 32
    v_readfirstlane_b32 s63, v11
    s_nop 0
    s_cmp_eq_u32 s62, s63
    s_cselect_b32 s61, 1, 0
    v_and_b32 v8, 15, v0
    v_lshrrev_b32 v9, 4, v0
    v_lshlrev_b32 v8, 5, v8
    v_lshl_add_u32 v8, v9, 4, v8
    s_lshl_b32 s96, s3, 9
    s_add_u32 s96, s96, 154944
    v_add_u32 v8, s96, v8
    v_lshlrev_b32 v9, 3, v0
    v_add_u32 v9, 154944, v9
    v_and_b32_dpp v28, v18, v20 row_newbcast:8 row_mask:0xf bank_mask:0xf
    v_and_b32_dpp v29, v18, v21 row_newbcast:8 row_mask:0xf bank_mask:0xf
    v_and_b32_dpp v30, v18, v22 row_newbcast:8 row_mask:0xf bank_mask:0xf
    v_and_b32_dpp v31, v18, v23 row_newbcast:8 row_mask:0xf bank_mask:0xf
    s_waitcnt vmcnt(3)
    buffer_load_dwordx4 v[156:159], v1, s[52:55], s97 offen offset:1024 nt
    v_mfma_f32_16x16x32_bf16 v[32:35], v[28:31], v[140:143], v[32:35]
    v_and_b32_dpp v24, v18, v20 row_newbcast:4 row_mask:0xf bank_mask:0xf
    v_and_b32_dpp v25, v18, v21 row_newbcast:4 row_mask:0xf bank_mask:0xf
    v_and_b32_dpp v26, v18, v22 row_newbcast:4 row_mask:0xf bank_mask:0xf
    v_and_b32_dpp v27, v18, v23 row_newbcast:4 row_mask:0xf bank_mask:0xf
    s_waitcnt vmcnt(3)
    buffer_load_dwordx4 v[160:163], v1, s[52:55], s97 offen offset:2048 nt
    v_mfma_f32_16x16x32_bf16 v[32:35], v[24:27], v[144:147], v[32:35]
    v_and_b32_dpp v28, v18, v20 row_newbcast:12 row_mask:0xf bank_mask:0xf
    v_and_b32_dpp v29, v18, v21 row_newbcast:12 row_mask:0xf bank_mask:0xf
    v_and_b32_dpp v30, v18, v22 row_newbcast:12 row_mask:0xf bank_mask:0xf
    v_and_b32_dpp v31, v18, v23 row_newbcast:12 row_mask:0xf bank_mask:0xf
    s_waitcnt vmcnt(3)
    buffer_load_dwordx4 v[164:167], v1, s[52:55], s97 offen offset:3072 nt
    s_mov_b32 s97, 0
    v_mfma_f32_16x16x32_bf16 v[32:35], v[28:31], v[148:151], v[32:35]
    v_and_b32_dpp v24, v19, v20 row_newbcast:0 row_mask:0xf bank_mask:0xf
    v_and_b32_dpp v25, v19, v21 row_newbcast:0 row_mask:0xf bank_mask:0xf
    v_and_b32_dpp v26, v19, v22 row_newbcast:0 row_mask:0xf bank_mask:0xf
    v_and_b32_dpp v27, v19, v23 row_newbcast:0 row_mask:0xf bank_mask:0xf
    s_waitcnt vmcnt(3)
    s_nop 0
    v_mfma_f32_16x16x32_bf16 v[32:35], v[24:27], v[152:155], v[32:35]
    v_and_b32_dpp v28, v19, v20 row_newbcast:8 row_mask:0xf bank_mask:0xf
    v_and_b32_dpp v29, v19, v21 row_newbcast:8 row_mask:0xf bank_mask:0xf
    v_and_b32_dpp v30, v19, v22 row_newbcast:8 row_mask:0xf bank_mask:0xf
    v_and_b32_dpp v31, v19, v23 row_newbcast:8 row_mask:0xf bank_mask:0xf
    s_waitcnt vmcnt(2)
    s_nop 0
    v_mfma_f32_16x16x32_bf16 v[32:35], v[28:31], v[156:159], v[32:35]
    v_and_b32_dpp v24, v19, v20 row_newbcast:4 row_mask:0xf bank_mask:0xf
    v_and_b32_dpp v25, v19, v21 row_newbcast:4 row_mask:0xf bank_mask:0xf
    v_and_b32_dpp v26, v19, v22 row_newbcast:4 row_mask:0xf bank_mask:0xf
    v_and_b32_dpp v27, v19, v23 row_newbcast:4 row_mask:0xf bank_mask:0xf
    s_waitcnt vmcnt(1)
    s_nop 0
    v_mfma_f32_16x16x32_bf16 v[32:35], v[24:27], v[160:163], v[32:35]
    v_and_b32_dpp v28, v19, v20 row_newbcast:12 row_mask:0xf bank_mask:0xf
    v_and_b32_dpp v29, v19, v21 row_newbcast:12 row_mask:0xf bank_mask:0xf
    v_and_b32_dpp v30, v19, v22 row_newbcast:12 row_mask:0xf bank_mask:0xf
    v_and_b32_dpp v31, v19, v23 row_newbcast:12 row_mask:0xf bank_mask:0xf
    s_waitcnt vmcnt(0)
    s_nop 0
    v_mfma_f32_16x16x32_bf16 v[32:35], v[28:31], v[164:167], v[32:35]
    s_nop 7
    v_mul_f32 v32, v32, v3
    v_mul_f32 v33, v33, v3
    v_mul_f32 v34, v34, v3
    v_mul_f32 v35, v35, v3
    s_mov_b32 exec_hi, 0
    ds_write_b128 v8, v[32:35]
    s_mov_b32 exec_hi, -1
    s_waitcnt lgkmcnt(0)
    s_barrier
    s_cmp_lg_u32 s3, 0
    s_cbranch_scc1 L_s_post
    ds_read_b64 v[40:41], v9 offset:0
    ds_read_b64 v[42:43], v9 offset:512
    ds_read_b64 v[44:45], v9 offset:1024
    ds_read_b64 v[46:47], v9 offset:1536
    ds_read_b64 v[48:49], v9 offset:2048
    ds_read_b64 v[50:51], v9 offset:2560
    ds_read_b64 v[52:53], v9 offset:3072
    ds_read_b64 v[54:55], v9 offset:3584
    s_waitcnt lgkmcnt(6)
    v_pk_add_f32 v[40:41], v[40:41], v[42:43]
    s_waitcnt lgkmcnt(4)
    v_pk_add_f32 v[44:45], v[44:45], v[46:47]
    s_waitcnt lgkmcnt(2)
    v_pk_add_f32 v[48:49], v[48:49], v[50:51]
    v_pk_add_f32 v[40:41], v[40:41], v[44:45]
    s_waitcnt lgkmcnt(0)
    v_pk_add_f32 v[52:53], v[52:53], v[54:55]
    v_pk_add_f32 v[40:41], v[40:41], v[48:49]
    v_pk_add_f32 v[40:41], v[40:41], v[52:53]
    v_cvt_pk_bf16_f32 v40, v40, v41
    s_cmp_eq_u32 s61, 1
    s_cbranch_scc1 L_st_1f
    buffer_store_dword v40, v39, s[40:43], s98 offen sc1
    s_branch L_st_1e
L_st_1f:
    buffer_store_dword v40, v39, s[40:43], s98 offen
L_st_1e:
L_s_post:
    s_cmp_eq_u32 s39, 1
    s_cbranch_scc1 L_s_role
    s_endpgm
L_qslow:
L_wy_2:
    buffer_load_dword v37, v36, s[44:47], 0 offen offset:128 sc1
    s_waitcnt vmcnt(0)
    v_cmp_eq_u32 vcc, 0, v37
    s_cbranch_vccz L_wy_2e
    s_sleep 4
    s_sub_u32 s60, s60, 1
    s_cbranch_scc0 L_wy_2
    s_mov_b32 s60, 0
L_wy_2e:
L_qslow2:
L_poll_3:
    buffer_load_dwordx4 v[4:7], v2, s[40:43], s98 offen sc1
    s_waitcnt vmcnt(0)
    v_max3_u32 v38, v4, v5, v6
    v_max_u32 v38, v38, v7
    v_cmp_eq_u32 vcc, -1, v38
    s_cbranch_vccz L_poll_3e
    s_sleep 2
    s_sub_u32 s60, s60, 1
    s_cbranch_scc0 L_poll_3
    s_mov_b32 s60, 0
L_poll_3e:
    s_branch L_qok
L_mlslow:
L_poll_4:
    buffer_load_dwordx2 v[8:9], v2, s[40:43], s99 offen sc1
    s_waitcnt vmcnt(0)
    v_max_u32 v38, v8, v9
    v_cmp_eq_u32 vcc, -1, v38
    s_cbranch_vccz L_poll_4e
    s_sleep 8
    s_sub_u32 s60, s60, 1
    s_cbranch_scc0 L_poll_4
    s_mov_b32 s60, 0
L_poll_4e:
    s_branch L_mlok
L_s_role:
    s_cmp_gt_u32 s3, 3
    s_cbranch_scc1 L_t2
    v_bfe_u32 v1, v0, 2, 2
    v_and_b32 v2, 3, v0
    v_lshrrev_b32 v3, 4, v0
    v_lshl_add_u32 v4, v3, 2, v2
    v_mul_u32_u24 v72, 3456, v1
    v_lshl_add_u32 v72, v4, 4, v72
    s_mul_i32 s62, s3, 768
    s_add_u32 s62, s62, 69632
    s_lshr_b32 s63, s3, 1
    s_lshl_b32 s96, s63, 8
    s_add_u32 s96, s96, 72704
    v_add_u32 v73, s96, v72
    v_add_u32 v72, s62, v72
    v_lshrrev_b32 v5, 1, v3
    v_mul_u32_u24 v5, s63, v5
    v_lshlrev_b32 v5, 7, v5
    v_sub_u32 v73, v73, v5
    buffer_load_dwordx4 v[8:11], v72, s[40:43], 0 offen offset:0 sc1
    buffer_load_dwordx4 v[12:15], v72, s[40:43], 0 offen offset:256 sc1
    buffer_load_dwordx4 v[16:19], v72, s[40:43], 0 offen offset:512 sc1
    buffer_load_dwordx4 v[20:23], v73, s[40:43], 0 offen sc1
    v_bfe_u32 v5, v0, 2, 2
    v_lshl_add_u32 v5, v4, 3, v5
    v_mul_u32_u24 v5, 48, v5
    s_mul_i32 s62, s3, 24576
    s_add_u32 s62, s62, -4096
    s_cmp_eq_u32 s3, 0
    s_cselect_b32 s62, 94208, s62
    v_add_u32 v5, s62, v5
    s_and_b32 s63, s3, 1
    s_mul_i32 s63, s63, 24
    v_add_u32 v6, s63, v5
    ds_read_b64_tr_b16 v[84:85], v5 offset:0
    ds_read_b64_tr_b16 v[86:87], v5 offset:192
    ds_read_b64_tr_b16 v[88:89], v5 offset:8
    ds_read_b64_tr_b16 v[90:91], v5 offset:200
    ds_read_b64_tr_b16 v[92:93], v5 offset:16
    ds_read_b64_tr_b16 v[94:95], v5 offset:208
    ds_read_b64_tr_b16 v[96:97], v5 offset:24
    ds_read_b64_tr_b16 v[98:99], v5 offset:216
    ds_read_b64_tr_b16 v[100:101], v5 offset:32
    ds_read_b64_tr_b16 v[102:103], v5 offset:224
    ds_read_b64_tr_b16 v[104:105], v5 offset:40
    ds_read_b64_tr_b16 v[106:107], v5 offset:232
    ds_read_b64_tr_b16 v[108:109], v5 offset:6144
    ds_read_b64_tr_b16 v[110:111], v5 offset:6336
    ds_read_b64_tr_b16 v[112:113], v5 offset:6152
    ds_read_b64_tr_b16 v[114:115], v5 offset:6344
    ds_read_b64_tr_b16 v[116:117], v5 offset:6160
    ds_read_b64_tr_b16 v[118:119], v5 offset:6352
    ds_read_b64_tr_b16 v[120:121], v5 offset:6168
    ds_read_b64_tr_b16 v[122:123], v5 offset:6360
    ds_read_b64_tr_b16 v[124:125], v5 offset:6176
    ds_read_b64_tr_b16 v[126:127], v5 offset:6368
    ds_read_b64_tr_b16 v[128:129], v5 offset:6184
    ds_read_b64_tr_b16 v[130:131], v5 offset:6376
    ds_read_b64_tr_b16 v[132:133], v5 offset:12288
    ds_read_b64_tr_b16 v[134:135], v5 offset:12480
    ds_read_b64_tr_b16 v[136:137], v5 offset:12296
    ds_read_b64_tr_b16 v[138:139], v5 offset:12488
    ds_read_b64_tr_b16 v[140:141], v5 offset:12304
    ds_read_b64_tr_b16 v[142:143], v5 offset:12496
    ds_read_b64_tr_b16 v[144:145], v5 offset:12312
    ds_read_b64_tr_b16 v[146:147], v5 offset:12504
    ds_read_b64_tr_b16 v[148:149], v5 offset:12320
    ds_read_b64_tr_b16 v[150:151], v5 offset:12512
    ds_read_b64_tr_b16 v[152:153], v5 offset:12328
    ds_read_b64_tr_b16 v[154:155], v5 offset:12520
    ds_read_b64_tr_b16 v[156:157], v6 offset:18432
    ds_read_b64_tr_b16 v[158:159], v6 offset:18624
    ds_read_b64_tr_b16 v[160:161], v6 offset:18440
    ds_read_b64_tr_b16 v[162:163], v6 offset:18632
    ds_read_b64_tr_b16 v[164:165], v6 offset:18448
    ds_read_b64_tr_b16 v[166:167], v6 offset:18640
    s_mov_b32 s48, s22
    s_mov_b32 s49, s23
    s_mov_b32 s50, 1280
    s_mov_b32 s51, 0x20000
    s_mov_b32 s52, s28
    s_mov_b32 s53, s29
    s_mov_b32 s54, 5120
    s_mov_b32 s55, 0x20000
    v_and_b32 v7, 15, v0
    v_lshlrev_b32 v74, 2, v7
    s_mul_i32 s62, s35, 48
    v_add_u32 v74, s62, v74
    v_mul_u32_u24 v75, 1280, v3
    v_add_u32 v75, v75, v74
    v_cmp_gt_u32 vcc, 12, v7
    s_nop 0
    s_mov_b64 s[56:57], vcc
    v_cmp_gt_u32 vcc, 1280, v74
    s_nop 0
    s_and_b64 s[56:57], s[56:57], vcc
    s_mov_b64 exec, s[56:57]
    buffer_load_dword v76, v74, s[48:51], 0 offen
    s_mov_b32 s62, 64512
L_poll_5:
    buffer_load_dword v77, v75, s[40:43], s62 offen sc1
    s_waitcnt vmcnt(0)
    v_cmp_eq_u32 vcc, -1, v77
    s_cbranch_vccz L_poll_5e
    s_sleep 2
    s_sub_u32 s60, s60, 1
    s_cbranch_scc0 L_poll_5
    s_mov_b32 s60, 0
L_poll_5e:
    s_mov_b64 exec, -1
    v_lshlrev_b32 v78, 1, v75
    v_add_u32 v78, 144704, v78
    v_lshlrev_b32 v79, 7, v3
    v_lshl_add_u32 v80, v7, 2, v79
    s_lshl_b32 s62, s3, 9
    s_add_u32 s62, s62, 159296
    v_add_u32 v80, s62, v80
    v_lshl_add_u32 v79, v7, 3, v79
    v_add_u32 v79, 159296, v79
    s_waitcnt lgkmcnt(0)
    s_cmp_lt_u32 s3, 3
    s_cbranch_scc1 L_t2_skip
L_t2:
    s_sub_u32 s62, s3, 3
    s_lshl_b32 s62, s62, 4
    v_and_b32 v1, 15, v0
    v_add_u32 v1, s62, v1
    v_lshrrev_b32 v3, 4, v0
    v_mul_u32_u24 v2, 0x5556, v1
    v_lshrrev_b32 v2, 16, v2
    v_mul_u32_u24 v4, 3, v2
    v_sub_u32 v4, v1, v4
    v_lshlrev_b32 v5, 8, v2
    v_lshl_add_u32 v5, v4, 4, v5
    v_mad_u32_u24 v5, v3, 48, v5
    v_cmp_eq_u32 vcc, 2, v4
    v_lshlrev_b32 v4, 2, v4
    s_nop 0
    v_cndmask_b32 v4, v4, 16, vcc
    v_mad_u32_u24 v4, v2, 24, v4
    v_cndmask_b32 v6, 8, 4, vcc
    v_add_u32 v6, v4, v6
    v_mul_u32_u24 v1, 1280, v3
    v_lshl_add_u32 v2, v6, 1, v1
    v_lshl_add_u32 v1, v4, 1, v1
    s_mov_b32 s48, s4
    s_mov_b32 s49, s5
    s_mov_b32 s50, 5120
    s_mov_b32 s51, 0x20000
    buffer_load_dwordx2 v[8:9], v1, s[48:51], 0 offen
    buffer_load_dwordx2 v[10:11], v2, s[48:51], 0 offen
    s_mov_b32 s62, 49152
    s_mov_b32 s63, 59392
L_poll_6:
    buffer_load_dwordx2 v[12:13], v1, s[40:43], s62 offen sc1
    buffer_load_dwordx2 v[14:15], v2, s[40:43], s62 offen sc1
    buffer_load_dwordx2 v[16:17], v1, s[40:43], s63 offen sc1
    buffer_load_dwordx2 v[18:19], v2, s[40:43], s63 offen sc1
    s_waitcnt vmcnt(0)
    v_max3_u32 v38, v12, v13, v14
    v_max3_u32 v38, v38, v15, v16
    v_max3_u32 v38, v38, v17, v18
    v_max_u32 v38, v38, v19
    v_cmp_eq_u32 vcc, -1, v38
    s_cbranch_vccz L_poll_6e
    s_sleep 2
    s_sub_u32 s60, s60, 1
    s_cbranch_scc0 L_poll_6
    s_mov_b32 s60, 0
L_poll_6e:
    v_lshlrev_b32 v40, 16, v8
    v_and_b32 v41, 0xffff0000, v8
    v_lshlrev_b32 v42, 16, v9
    v_and_b32 v43, 0xffff0000, v9
    v_lshlrev_b32 v44, 16, v10
    v_and_b32 v45, 0xffff0000, v10
    v_lshlrev_b32 v46, 16, v11
    v_and_b32 v47, 0xffff0000, v11
    v_lshlrev_b32 v48, 16, v12
    v_and_b32 v49, 0xffff0000, v12
    v_lshlrev_b32 v50, 16, v13
    v_and_b32 v51, 0xffff0000, v13
    v_lshlrev_b32 v52, 16, v14
    v_and_b32 v53, 0xffff0000, v14
    v_lshlrev_b32 v54, 16, v15
    v_and_b32 v55, 0xffff0000, v15
    v_lshlrev_b32 v56, 16, v16
    v_and_b32 v57, 0xffff0000, v16
    v_lshlrev_b32 v58, 16, v17
    v_and_b32 v59, 0xffff0000, v17
    v_lshlrev_b32 v60, 16, v18
    v_and_b32 v61, 0xffff0000, v18
    v_lshlrev_b32 v62, 16, v19
    v_and_b32 v63, 0xffff0000, v19
    v_mul_u32_u24 v7, 1296, v3
    v_add_u32 v7, 129152, v7
    v_lshl_add_u32 v4, v4, 1, v7
    v_lshl_add_u32 v6, v6, 1, v7
    v_lshlrev_b32 v1, 1, v1
    v_lshlrev_b32 v2, 1, v2
    v_add_u32 v1, 144704, v1
    v_add_u32 v2, 144704, v2
    v_lshlrev_b32 v7, 6, v3
    s_sub_u32 s62, s3, 3
    s_lshl_b32 s62, s62, 3
    s_add_u32 s62, s62, 159040
    v_add_u32 v7, s62, v7
    s_mov_b32 s58, 0x3f80
    s_mov_b32 s59, 0x3f800000
    v_mov_b32 v64, 0
    v_mov_b32 v65, 0
    v_mov_b32 v66, 0
    v_mov_b32 v67, 0
    v_mov_b32 v68, 0
    v_mov_b32 v69, 0
    v_mov_b32 v70, 0
    v_mov_b32 v71, 0
L_poll_7:
    s_mov_b32 s62, 151552
    buffer_load_dwordx4 v[8:11], v5, s[40:43], s62 offen sc1
    s_mov_b32 s62, 158464
    buffer_load_dwordx4 v[12:15], v5, s[40:43], s62 offen sc1
    s_mov_b32 s62, 165376
    buffer_load_dwordx4 v[16:19], v5, s[40:43], s62 offen sc1
    s_mov_b32 s62, 172288
    buffer_load_dwordx4 v[20:23], v5, s[40:43], s62 offen sc1
    s_mov_b32 s62, 179200
    buffer_load_dwordx4 v[24:27], v5, s[40:43], s62 offen sc1
    s_mov_b32 s62, 186112
    buffer_load_dwordx4 v[28:31], v5, s[40:43], s62 offen sc1
    s_mov_b32 s62, 193024
    buffer_load_dwordx4 v[32:35], v5, s[40:43], s62 offen sc1
    s_mov_b32 s62, 199936
    buffer_load_dwordx4 v[36:39], v5, s[40:43], s62 offen sc1
    s_waitcnt vmcnt(0)
    v_max3_u32 v3, v8, v9, v10
    v_max3_u32 v3, v3, v11, v12
    v_max3_u32 v3, v3, v13, v14
    v_max3_u32 v3, v3, v15, v16
    v_max3_u32 v3, v3, v17, v18
    v_max3_u32 v3, v3, v19, v20
    v_max3_u32 v3, v3, v21, v22
    v_max3_u32 v3, v3, v23, v24
    v_max3_u32 v3, v3, v25, v26
    v_max3_u32 v3, v3, v27, v28
    v_max3_u32 v3, v3, v29, v30
    v_max3_u32 v3, v3, v31, v32
    v_max3_u32 v3, v3, v33, v34
    v_max3_u32 v3, v3, v35, v36
    v_max3_u32 v3, v3, v37, v38
    v_max_u32 v3, v3, v39
    v_cmp_eq_u32 vcc, -1, v3
    s_cbranch_vccz L_poll_7e
    s_sub_u32 s60, s60, 1
    s_cbranch_scc0 L_poll_7
    s_mov_b32 s60, 0
L_poll_7e:
    v_dot2c_f32_bf16 v64, s58, v8
    v_dot2c_f32_bf16 v68, s59, v8
    v_dot2c_f32_bf16 v65, s58, v9
    v_dot2c_f32_bf16 v69, s59, v9
    v_dot2c_f32_bf16 v66, s58, v10
    v_dot2c_f32_bf16 v70, s59, v10
    v_dot2c_f32_bf16 v67, s58, v11
    v_dot2c_f32_bf16 v71, s59, v11
    v_dot2c_f32_bf16 v64, s58, v12
    v_dot2c_f32_bf16 v68, s59, v12
    v_dot2c_f32_bf16 v65, s58, v13
    v_dot2c_f32_bf16 v69, s59, v13
    v_dot2c_f32_bf16 v66, s58, v14
    v_dot2c_f32_bf16 v70, s59, v14
    v_dot2c_f32_bf16 v67, s58, v15
    v_dot2c_f32_bf16 v71, s59, v15
    v_dot2c_f32_bf16 v64, s58, v16
    v_dot2c_f32_bf16 v68, s59, v16
    v_dot2c_f32_bf16 v65, s58, v17
    v_dot2c_f32_bf16 v69, s59, v17
    v_dot2c_f32_bf16 v66, s58, v18
    v_dot2c_f32_bf16 v70, s59, v18
    v_dot2c_f32_bf16 v67, s58, v19
    v_dot2c_f32_bf16 v71, s59, v19
    v_dot2c_f32_bf16 v64, s58, v20
    v_dot2c_f32_bf16 v68, s59, v20
    v_dot2c_f32_bf16 v65, s58, v21
    v_dot2c_f32_bf16 v69, s59, v21
    v_dot2c_f32_bf16 v66, s58, v22
    v_dot2c_f32_bf16 v70, s59, v22
    v_dot2c_f32_bf16 v67, s58, v23
    v_dot2c_f32_bf16 v71, s59, v23
    v_dot2c_f32_bf16 v64, s58, v24
    v_dot2c_f32_bf16 v68, s59, v24
    v_dot2c_f32_bf16 v65, s58, v25
    v_dot2c_f32_bf16 v69, s59, v25
    v_dot2c_f32_bf16 v66, s58, v26
    v_dot2c_f32_bf16 v70, s59, v26
    v_dot2c_f32_bf16 v67, s58, v27
    v_dot2c_f32_bf16 v71, s59, v27
    v_dot2c_f32_bf16 v64, s58, v28
    v_dot2c_f32_bf16 v68, s59, v28
    v_dot2c_f32_bf16 v65, s58, v29
    v_dot2c_f32_bf16 v69, s59, v29
    v_dot2c_f32_bf16 v66, s58, v30
    v_dot2c_f32_bf16 v70, s59, v30
    v_dot2c_f32_bf16 v67, s58, v31
    v_dot2c_f32_bf16 v71, s59, v31
    v_dot2c_f32_bf16 v64, s58, v32
    v_dot2c_f32_bf16 v68, s59, v32
    v_dot2c_f32_bf16 v65, s58, v33
    v_dot2c_f32_bf16 v69, s59, v33
    v_dot2c_f32_bf16 v66, s58, v34
    v_dot2c_f32_bf16 v70, s59, v34
    v_dot2c_f32_bf16 v67, s58, v35
    v_dot2c_f32_bf16 v71, s59, v35
    v_dot2c_f32_bf16 v64, s58, v36
    v_dot2c_f32_bf16 v68, s59, v36
    v_dot2c_f32_bf16 v65, s58, v37
    v_dot2c_f32_bf16 v69, s59, v37
    v_dot2c_f32_bf16 v66, s58, v38
    v_dot2c_f32_bf16 v70, s59, v38
    v_dot2c_f32_bf16 v67, s58, v39
    v_dot2c_f32_bf16 v71, s59, v39
    v_fma_f32 v64, v64, v48, v40
    v_fma_f32 v65, v65, v49, v41
    v_fma_f32 v66, v66, v50, v42
    v_fma_f32 v67, v67, v51, v43
    v_fma_f32 v68, v68, v52, v44
    v_fma_f32 v69, v69, v53, v45
    v_fma_f32 v70, v70, v54, v46
    v_fma_f32 v71, v71, v55, v47
    v_mul_f32 v56, v64, v56
    v_mul_f32 v57, v65, v57
    v_mul_f32 v58, v66, v58
    v_mul_f32 v59, v67, v59
    v_mul_f32 v60, v68, v60
    v_mul_f32 v61, v69, v61
    v_mul_f32 v62, v70, v62
    v_mul_f32 v63, v71, v63
    v_cvt_pk_bf16_f32 v8, v56, v57
    v_cvt_pk_bf16_f32 v9, v58, v59
    v_cvt_pk_bf16_f32 v10, v60, v61
    v_cvt_pk_bf16_f32 v11, v62, v63
    ds_write_b64 v4, v[8:9]
    ds_write_b64 v6, v[10:11]
    s_waitcnt lgkmcnt(0)
    s_barrier
    ds_write_b128 v1, v[64:67]
    ds_write_b128 v2, v[68:71]
    v_pk_add_f32 v[8:9], v[64:65], v[66:67]
    v_pk_add_f32 v[10:11], v[68:69], v[70:71]
    v_pk_mul_f32 v[12:13], v[64:65], v[64:65]
    v_pk_add_f32 v[8:9], v[8:9], v[10:11]
    v_pk_fma_f32 v[12:13], v[66:67], v[66:67], v[12:13]
    v_pk_fma_f32 v[12:13], v[68:69], v[68:69], v[12:13]
    v_pk_fma_f32 v[12:13], v[70:71], v[70:71], v[12:13]
    v_add_f32 v8, v8, v9
    v_add_f32 v9, v12, v13
    s_nop 0
    v_add_f32_dpp v8, v8, v8 quad_perm:[1,0,3,2] row_mask:0xf bank_mask:0xf
    v_add_f32_dpp v9, v9, v9 quad_perm:[1,0,3,2] row_mask:0xf bank_mask:0xf
    s_nop 0
    v_add_f32_dpp v8, v8, v8 quad_perm:[2,3,0,1] row_mask:0xf bank_mask:0xf
    v_add_f32_dpp v9, v9, v9 quad_perm:[2,3,0,1] row_mask:0xf bank_mask:0xf
    s_nop 0
    v_add_f32_dpp v8, v8, v8 row_ror:4 row_mask:0xf bank_mask:0xf
    v_add_f32_dpp v9, v9, v9 row_ror:4 row_mask:0xf bank_mask:0xf
    s_nop 0
    v_add_f32_dpp v8, v8, v8 row_ror:8 row_mask:0xf bank_mask:0xf
    v_add_f32_dpp v9, v9, v9 row_ror:8 row_mask:0xf bank_mask:0xf
    ds_write_b64 v7, v[8:9]
    s_waitcnt lgkmcnt(0)
    s_barrier
    s_cmp_eq_u32 s3, 3
    s_cbranch_scc1 L_ffn2
    s_endpgm
L_t2_skip:
    s_barrier
    s_barrier
L_ffn2:
    ds_read_b64 v[82:83], v78
L_poll_8:
    buffer_load_dwordx4 v[8:11], v72, s[40:43], 0 offen offset:0 sc1
    buffer_load_dwordx4 v[12:15], v72, s[40:43], 0 offen offset:256 sc1
    buffer_load_dwordx4 v[16:19], v72, s[40:43], 0 offen offset:512 sc1
    buffer_load_dwordx4 v[20:23], v73, s[40:43], 0 offen sc1
    s_waitcnt vmcnt(0)
    v_max3_u32 v3, v8, v9, v10
    v_max3_u32 v3, v3, v11, v12
    v_max3_u32 v3, v3, v13, v14
    v_max3_u32 v3, v3, v15, v16
    v_max3_u32 v3, v3, v17, v18
    v_max3_u32 v3, v3, v19, v20
    v_max3_u32 v3, v3, v21, v22
    v_max_u32 v3, v3, v23
    v_cmp_eq_u32 vcc, -1, v3
    s_cbranch_vccz L_poll_8e
    s_sub_u32 s60, s60, 1
    s_cbranch_scc0 L_poll_8
    s_mov_b32 s60, 0
L_poll_8e:
    v_mfma_f32_16x16x32_bf16 v[24:27], v[8:11], v[84:87], 0
    v_mfma_f32_16x16x32_bf16 v[28:31], v[8:11], v[88:91], 0
    v_mfma_f32_16x16x32_bf16 v[32:35], v[8:11], v[92:95], 0
    v_mfma_f32_16x16x32_bf16 v[36:39], v[8:11], v[96:99], 0
    v_mfma_f32_16x16x32_bf16 v[40:43], v[8:11], v[100:103], 0
    v_mfma_f32_16x16x32_bf16 v[44:47], v[8:11], v[104:107], 0
    v_mfma_f32_16x16x32_bf16 v[24:27], v[12:15], v[108:111], v[24:27]
    v_mfma_f32_16x16x32_bf16 v[28:31], v[12:15], v[112:115], v[28:31]
    v_mfma_f32_16x16x32_bf16 v[32:35], v[12:15], v[116:119], v[32:35]
    v_mfma_f32_16x16x32_bf16 v[36:39], v[12:15], v[120:123], v[36:39]
    v_mfma_f32_16x16x32_bf16 v[40:43], v[12:15], v[124:127], v[40:43]
    v_mfma_f32_16x16x32_bf16 v[44:47], v[12:15], v[128:131], v[44:47]
    v_mfma_f32_16x16x32_bf16 v[24:27], v[16:19], v[132:135], v[24:27]
    v_mfma_f32_16x16x32_bf16 v[28:31], v[16:19], v[136:139], v[28:31]
    v_mfma_f32_16x16x32_bf16 v[32:35], v[16:19], v[140:143], v[32:35]
    v_mfma_f32_16x16x32_bf16 v[36:39], v[16:19], v[144:147], v[36:39]
    v_mfma_f32_16x16x32_bf16 v[40:43], v[16:19], v[148:151], v[40:43]
    v_mfma_f32_16x16x32_bf16 v[44:47], v[16:19], v[152:155], v[44:47]
    s_bitcmp1_b32 s3, 0
    s_cbranch_scc1 L_f2odd
    v_mfma_f32_16x16x32_bf16 v[24:27], v[20:23], v[156:159], v[24:27]
    v_mfma_f32_16x16x32_bf16 v[28:31], v[20:23], v[160:163], v[28:31]
    v_mfma_f32_16x16x32_bf16 v[32:35], v[20:23], v[164:167], v[32:35]
    s_branch L_f2red
L_f2odd:
    v_mfma_f32_16x16x32_bf16 v[36:39], v[20:23], v[156:159], v[36:39]
    v_mfma_f32_16x16x32_bf16 v[40:43], v[20:23], v[160:163], v[40:43]
    v_mfma_f32_16x16x32_bf16 v[44:47], v[20:23], v[164:167], v[44:47]
L_f2red:
    s_nop 4
    v_add_f32_dpp v8, v25, v24 row_ror:12 row_mask:0xf bank_mask:0x1
    s_nop 1
    v_add_f32_dpp v8, v26, v8 row_ror:8 row_mask:0xf bank_mask:0x1
    s_nop 1
    v_add_f32_dpp v8, v27, v8 row_ror:4 row_mask:0xf bank_mask:0x1
    v_add_f32_dpp v8, v28, v29 row_ror:4 row_mask:0xf bank_mask:0x2
    s_nop 1
    v_add_f32_dpp v8, v30, v8 row_ror:12 row_mask:0xf bank_mask:0x2
    s_nop 1
    v_add_f32_dpp v8, v31, v8 row_ror:8 row_mask:0xf bank_mask:0x2
    v_add_f32_dpp v8, v32, v34 row_ror:8 row_mask:0xf bank_mask:0x4
    s_nop 1
    v_add_f32_dpp v8, v33, v8 row_ror:4 row_mask:0xf bank_mask:0x4
    s_nop 1
    v_add_f32_dpp v8, v35, v8 row_ror:12 row_mask:0xf bank_mask:0x4
    v_add_f32_dpp v8, v36, v39 row_ror:12 row_mask:0xf bank_mask:0x8
    s_nop 1
    v_add_f32_dpp v8, v37, v8 row_ror:8 row_mask:0xf bank_mask:0x8
    s_nop 1
    v_add_f32_dpp v8, v38, v8 row_ror:4 row_mask:0xf bank_mask:0x8
    v_add_f32_dpp v9, v41, v40 row_ror:12 row_mask:0xf bank_mask:0x1
    s_nop 1
    v_add_f32_dpp v9, v42, v9 row_ror:8 row_mask:0xf bank_mask:0x1
    s_nop 1
    v_add_f32_dpp v9, v43, v9 row_ror:4 row_mask:0xf bank_mask:0x1
    v_add_f32_dpp v9, v44, v45 row_ror:4 row_mask:0xf bank_mask:0x2
    s_nop 1
    v_add_f32_dpp v9, v46, v9 row_ror:12 row_mask:0xf bank_mask:0x2
    s_nop 1
    v_add_f32_dpp v9, v47, v9 row_ror:8 row_mask:0xf bank_mask:0x2
    ds_write_b32 v80, v8
    ds_write_b32 v80, v9 offset:64
    s_waitcnt lgkmcnt(0)
    s_barrier
    s_cmp_lg_u32 s3, 0
    s_cbranch_scc1 L_end
    ds_read_b64 v[8:9], v79
    ds_read_b64 v[10:11], v79 offset:512
    ds_read_b64 v[12:13], v79 offset:1024
    ds_read_b64 v[14:15], v79 offset:1536
    v_lshlrev_b32 v16, 16, v76
    v_and_b32 v17, 0xffff0000, v76
    v_lshlrev_b32 v18, 16, v77
    v_and_b32 v19, 0xffff0000, v77
    s_waitcnt lgkmcnt(2)
    v_pk_add_f32 v[8:9], v[8:9], v[10:11]
    s_waitcnt lgkmcnt(0)
    v_pk_add_f32 v[12:13], v[12:13], v[14:15]
    v_pk_add_f32 v[8:9], v[8:9], v[16:17]
    v_pk_add_f32 v[8:9], v[8:9], v[12:13]
    v_pk_fma_f32 v[8:9], v[8:9], v[18:19], v[82:83]
    v_cvt_pk_bf16_f32 v8, v8, v9
    s_mov_b64 exec, s[56:57]
    buffer_store_dword v8, v75, s[52:55], 0 offen
    s_endpgm
L_helpers:
    s_cmp_eq_u32 s3, 2
    s_cbranch_scc1 L_h2
    s_cmp_eq_u32 s3, 1
    s_cbranch_scc1 L_h1
    s_cmp_eq_u32 s3, 3
    s_cbranch_scc1 L_h3
    s_cmp_ge_u32 s35, 27
    s_cbranch_scc1 L_end
    v_mov_b32 v36, 0
    s_mul_i32 s96, s35, 48
    s_mul_i32 s97, s34, 655360
    v_add_u32 v8, 0, v0
    v_mul_u32_u24 v4, 0x5556, v8
    v_lshrrev_b32 v4, 16, v4
    v_mul_u32_u24 v9, 3, v4
    v_sub_u32 v8, v8, v9
    v_mul_u32_u24 v4, 1280, v4
    v_lshl_add_u32 v4, v8, 4, v4
    v_add_u32 v4, s96, v4
    v_add_u32 v4, s97, v4
    v_add_u32 v8, 64, v0
    v_mul_u32_u24 v5, 0x5556, v8
    v_lshrrev_b32 v5, 16, v5
    v_mul_u32_u24 v9, 3, v5
    v_sub_u32 v8, v8, v9
    v_mul_u32_u24 v5, 1280, v5
    v_lshl_add_u32 v5, v8, 4, v5
    v_add_u32 v5, s96, v5
    v_add_u32 v5, s97, v5
    v_add_u32 v8, 128, v0
    v_mul_u32_u24 v6, 0x5556, v8
    v_lshrrev_b32 v6, 16, v6
    v_mul_u32_u24 v9, 3, v6
    v_sub_u32 v8, v8, v9
    v_mul_u32_u24 v6, 1280, v6
    v_lshl_add_u32 v6, v8, 4, v6
    v_add_u32 v6, s96, v6
    v_add_u32 v6, s97, v6
    s_mov_b32 s48, s12
    s_mov_b32 s49, s13
    s_mov_b32 s50, 5242880
    s_mov_b32 s51, 0x20000
L_wy_9:
    buffer_load_dword v37, v36, s[44:47], 0 offen offset:128 sc1
    s_waitcnt vmcnt(0)
    v_cmp_eq_u32 vcc, 0, v37
    s_cbranch_vccz L_wy_9e
    s_sleep 4
    s_sub_u32 s60, s60, 1
    s_cbranch_scc0 L_wy_9
    s_mov_b32 s60, 0
L_wy_9e:
    s_mov_b32 m0, 94208
    s_mov_b32 s62, 8
L_dmb_10:
    buffer_load_dwordx4 v4, s[48:51], 0 offen nt lds
    s_add_u32 m0, m0, 1024
    v_add_u32 v4, 81920, v4
    s_waitcnt vmcnt(3)
    buffer_load_dwordx4 v5, s[48:51], 0 offen nt lds
    s_add_u32 m0, m0, 1024
    v_add_u32 v5, 81920, v5
    s_waitcnt vmcnt(3)
    buffer_load_dwordx4 v6, s[48:51], 0 offen nt lds
    s_add_u32 m0, m0, 1024
    v_add_u32 v6, 81920, v6
    s_waitcnt vmcnt(3)
    s_sub_u32 s62, s62, 1
    s_cmp_lg_u32 s62, 0
    s_cbranch_scc1 L_dmb_10
    v_lshrrev_b32 v1, 4, v0
    v_bfe_u32 v2, v0, 1, 1
    v_lshl_add_u32 v2, v1, 1, v2
    v_bfe_u32 v3, v0, 2, 2
    v_lshl_add_u32 v2, v2, 3, v3
    v_mul_u32_u24 v2, 48, v2
    v_and_b32 v3, 1, v0
    v_lshl_add_u32 v2, v3, 3, v2
    v_add_u32 v2, 94208, v2
    s_waitcnt vmcnt(0)
    ds_read_b64_tr_b16 v[64:65], v2 offset:0
    ds_read_b64_tr_b16 v[66:67], v2 offset:192
    ds_read_b64_tr_b16 v[68:69], v2 offset:16
    ds_read_b64_tr_b16 v[70:71], v2 offset:208
    ds_read_b64_tr_b16 v[72:73], v2 offset:32
    ds_read_b64_tr_b16 v[74:75], v2 offset:224
    ds_read_b64_tr_b16 v[76:77], v2 offset:3072
    ds_read_b64_tr_b16 v[78:79], v2 offset:3264
    ds_read_b64_tr_b16 v[80:81], v2 offset:3088
    ds_read_b64_tr_b16 v[82:83], v2 offset:3280
    ds_read_b64_tr_b16 v[84:85], v2 offset:3104
    ds_read_b64_tr_b16 v[86:87], v2 offset:3296
    ds_read_b64_tr_b16 v[88:89], v2 offset:6144
    ds_read_b64_tr_b16 v[90:91], v2 offset:6336
    ds_read_b64_tr_b16 v[92:93], v2 offset:6160
    ds_read_b64_tr_b16 v[94:95], v2 offset:6352
    ds_read_b64_tr_b16 v[96:97], v2 offset:6176
    ds_read_b64_tr_b16 v[98:99], v2 offset:6368
    ds_read_b64_tr_b16 v[100:101], v2 offset:9216
    ds_read_b64_tr_b16 v[102:103], v2 offset:9408
    ds_read_b64_tr_b16 v[104:105], v2 offset:9232
    ds_read_b64_tr_b16 v[106:107], v2 offset:9424
    ds_read_b64_tr_b16 v[108:109], v2 offset:9248
    ds_read_b64_tr_b16 v[110:111], v2 offset:9440
    ds_read_b64_tr_b16 v[112:113], v2 offset:12288
    ds_read_b64_tr_b16 v[114:115], v2 offset:12480
    ds_read_b64_tr_b16 v[116:117], v2 offset:12304
    ds_read_b64_tr_b16 v[118:119], v2 offset:12496
    ds_read_b64_tr_b16 v[120:121], v2 offset:12320
    ds_read_b64_tr_b16 v[122:123], v2 offset:12512
    ds_read_b64_tr_b16 v[124:125], v2 offset:15360
    ds_read_b64_tr_b16 v[126:127], v2 offset:15552
    ds_read_b64_tr_b16 v[128:129], v2 offset:15376
    ds_read_b64_tr_b16 v[130:131], v2 offset:15568
    ds_read_b64_tr_b16 v[132:133], v2 offset:15392
    ds_read_b64_tr_b16 v[134:135], v2 offset:15584
    ds_read_b64_tr_b16 v[136:137], v2 offset:18432
    ds_read_b64_tr_b16 v[138:139], v2 offset:18624
    ds_read_b64_tr_b16 v[140:141], v2 offset:18448
    ds_read_b64_tr_b16 v[142:143], v2 offset:18640
    ds_read_b64_tr_b16 v[144:145], v2 offset:18464
    ds_read_b64_tr_b16 v[146:147], v2 offset:18656
    ds_read_b64_tr_b16 v[148:149], v2 offset:21504
    ds_read_b64_tr_b16 v[150:151], v2 offset:21696
    ds_read_b64_tr_b16 v[152:153], v2 offset:21520
    ds_read_b64_tr_b16 v[154:155], v2 offset:21712
    ds_read_b64_tr_b16 v[156:157], v2 offset:21536
    ds_read_b64_tr_b16 v[158:159], v2 offset:21728
    v_bfe_u32 v2, v0, 1, 3
    v_lshlrev_b32 v2, 8, v2
    v_lshl_add_u32 v2, v1, 5, v2
    v_lshl_add_u32 v60, v3, 4, v2
    v_and_b32 v3, 15, v0
    v_lshlrev_b32 v61, 2, v3
    v_mad_u32_u24 v61, v1, 48, v61
    v_cmp_gt_u32 vcc, 12, v3
    s_nop 0
    s_mov_b64 s[56:57], vcc
    s_lshl_b32 s98, s34, 13
    s_add_u32 s98, s98, 86016
    s_add_u32 s99, s98, 4096
    s_mul_i32 s58, s34, 27
    s_add_u32 s58, s58, s35
    s_lshl_b32 s58, s58, 8
    s_add_u32 s58, s58, 151552
    s_waitcnt lgkmcnt(0)
    s_cmp_eq_u32 s39, 1
    s_cbranch_scc1 L_role_load
L_t1:
    s_barrier
L_poll_11:
    buffer_load_dwordx4 v[8:11], v60, s[40:43], s98 offen offset:0 sc1
    buffer_load_dwordx4 v[12:15], v60, s[40:43], s98 offen offset:128 sc1
    buffer_load_dwordx4 v[16:19], v60, s[40:43], s98 offen offset:2048 sc1
    buffer_load_dwordx4 v[20:23], v60, s[40:43], s98 offen offset:2176 sc1
    buffer_load_dwordx4 v[24:27], v60, s[40:43], s99 offen offset:0 sc1
    buffer_load_dwordx4 v[28:31], v60, s[40:43], s99 offen offset:128 sc1
    buffer_load_dwordx4 v[32:35], v60, s[40:43], s99 offen offset:2048 sc1
    buffer_load_dwordx4 v[36:39], v60, s[40:43], s99 offen offset:2176 sc1
    s_waitcnt vmcnt(0)
    v_max3_u32 v3, v8, v9, v10
    v_max3_u32 v3, v3, v11, v12
    v_max3_u32 v3, v3, v13, v14
    v_max3_u32 v3, v3, v15, v16
    v_max3_u32 v3, v3, v17, v18
    v_max3_u32 v3, v3, v19, v20
    v_max3_u32 v3, v3, v21, v22
    v_max3_u32 v3, v3, v23, v24
    v_max3_u32 v3, v3, v25, v26
    v_max3_u32 v3, v3, v27, v28
    v_max3_u32 v3, v3, v29, v30
    v_max3_u32 v3, v3, v31, v32
    v_max3_u32 v3, v3, v33, v34
    v_max3_u32 v3, v3, v35, v36
    v_max3_u32 v3, v3, v37, v38
    v_max_u32 v3, v3, v39
    v_cmp_eq_u32 vcc, -1, v3
    s_cbranch_vccz L_poll_11e
    s_sub_u32 s60, s60, 1
    s_cbranch_scc0 L_poll_11
    s_mov_b32 s60, 0
L_poll_11e:
    v_mfma_f32_16x16x32_bf16 v[40:43], v[8:11], v[64:67], 0
    v_mfma_f32_16x16x32_bf16 v[44:47], v[8:11], v[68:71], 0
    v_mfma_f32_16x16x32_bf16 v[48:51], v[8:11], v[72:75], 0
    v_mfma_f32_16x16x32_bf16 v[40:43], v[12:15], v[76:79], v[40:43]
    v_mfma_f32_16x16x32_bf16 v[44:47], v[12:15], v[80:83], v[44:47]
    v_mfma_f32_16x16x32_bf16 v[48:51], v[12:15], v[84:87], v[48:51]
    v_mfma_f32_16x16x32_bf16 v[40:43], v[16:19], v[88:91], v[40:43]
    v_mfma_f32_16x16x32_bf16 v[44:47], v[16:19], v[92:95], v[44:47]
    v_mfma_f32_16x16x32_bf16 v[48:51], v[16:19], v[96:99], v[48:51]
    v_mfma_f32_16x16x32_bf16 v[40:43], v[20:23], v[100:103], v[40:43]
    v_mfma_f32_16x16x32_bf16 v[44:47], v[20:23], v[104:107], v[44:47]
    v_mfma_f32_16x16x32_bf16 v[48:51], v[20:23], v[108:111], v[48:51]
    v_mfma_f32_16x16x32_bf16 v[40:43], v[24:27], v[112:115], v[40:43]
    v_mfma_f32_16x16x32_bf16 v[44:47], v[24:27], v[116:119], v[44:47]
    v_mfma_f32_16x16x32_bf16 v[48:51], v[24:27], v[120:123], v[48:51]
    v_mfma_f32_16x16x32_bf16 v[40:43], v[28:31], v[124:127], v[40:43]
    v_mfma_f32_16x16x32_bf16 v[44:47], v[28:31], v[128:131], v[44:47]
    v_mfma_f32_16x16x32_bf16 v[48:51], v[28:31], v[132:135], v[48:51]
    v_mfma_f32_16x16x32_bf16 v[40:43], v[32:35], v[136:139], v[40:43]
    v_mfma_f32_16x16x32_bf16 v[44:47], v[32:35], v[140:143], v[44:47]
    v_mfma_f32_16x16x32_bf16 v[48:51], v[32:35], v[144:147], v[48:51]
    v_mfma_f32_16x16x32_bf16 v[40:43], v[36:39], v[148:151], v[40:43]
    v_mfma_f32_16x16x32_bf16 v[44:47], v[36:39], v[152:155], v[44:47]
    v_mfma_f32_16x16x32_bf16 v[48:51], v[36:39], v[156:159], v[48:51]
    s_nop 5
    v_add_f32 v40, v40, v42
    v_add_f32 v41, v41, v43
    v_add_f32 v44, v44, v46
    v_add_f32 v45, v45, v47
    v_add_f32 v48, v48, v50
    v_add_f32 v49, v49, v51
    v_add_f32_dpp v8, v41, v40 row_ror:8 row_mask:0xf bank_mask:0x3
    s_nop 0
    v_add_f32_dpp v8, v48, v49 row_ror:8 row_mask:0xf bank_mask:0xc
    v_add_f32_dpp v9, v45, v44 row_ror:8 row_mask:0xf bank_mask:0x3
    s_nop 0
    v_mov_b32_dpp v9, v8 row_shl:4 row_mask:0xf bank_mask:0x4
    v_cvt_pk_bf16_f32 v8, v8, v9
    s_mov_b64 exec, s[56:57]
    buffer_store_dword v8, v61, s[40:43], s58 offen sc1
    s_mov_b64 exec, -1
    s_cmp_eq_u32 s39, 1
    s_cbranch_scc1 L_role_frag
    s_endpgm
L_h2:
    s_sub_u32 s62, s34, 0
    s_and_b32 s62, s62, 7
    s_and_b32 s63, s35, 15
    s_sub_u32 s96, s62, 1
    s_lshl4_add_u32 s96, s96, s63
    s_lshr_b32 s97, s35, 4
    s_cmp_lt_u32 s62, 6
    s_cbranch_scc1 L_m1
    s_lshl_b32 s96, s62, 5
    s_add_u32 s96, s96, s35
    s_sub_u32 s96, s96, 112
    s_mov_b32 s97, 1
L_m1:
    s_cmp_lg_u32 s62, 0
    s_cbranch_scc1 L_m2
    s_add_u32 s96, s63, 144
    s_cmp_eq_u32 s97, 0
    s_cbranch_scc1 L_m_done
L_m2:
    v_mov_b32 v36, 0
    v_lshrrev_b32 v1, 1, v0
    v_mul_u32_u24 v1, 7680, v1
    v_and_b32 v2, 1, v0
    s_lshl_b32 s98, s96, 4
    s_mov_b32 s99, 1280
    s_cmp_eq_u32 s97, 0
    s_cbranch_scc1 L_m3
    s_lshl_b32 s98, s96, 5
    s_add_u32 s98, s98, 2560
    s_mov_b32 s99, 16
L_m3:
    v_mad_u32_u24 v1, v2, s99, v1
    v_add_u32 v1, s98, v1
    s_mov_b32 s48, s26
    s_mov_b32 s49, s27
    s_mov_b32 s50, 4915200
    s_mov_b32 s51, 0x20000
    s_mov_b32 s52, s24
    s_mov_b32 s53, s25
    s_mov_b32 s54, 5120
    s_mov_b32 s55, 0x20000
    s_mov_b32 s56, s4
    s_mov_b32 s57, s5
    s_mov_b32 s58, 5120
    s_mov_b32 s59, 0x20000
    v_lshrrev_b32 v4, 4, v0
    v_and_b32 v5, 15, v0
    v_lshlrev_b32 v5, 4, v5
    v_mul_u32_u24 v2, 1280, v4
    v_add3_u32 v2, v2, v5, 0
    v_mul_u32_u24 v3, 1296, v4
    v_add_u32 v3, v3, v5
    v_add_u32 v3, 118784, v3
    s_cmp_eq_u32 s97, 0
    s_cbranch_scc1 L_m_clear
L_wy_12:
    buffer_load_dword v37, v36, s[44:47], 0 offen offset:128 sc1
    s_waitcnt vmcnt(0)
    v_cmp_eq_u32 vcc, 0, v37
    s_cbranch_vccz L_wy_12e
    s_sleep 4
    s_sub_u32 s60, s60, 1
    s_cbranch_scc0 L_wy_12
    s_mov_b32 s60, 0
L_wy_12e:
    s_branch L_m_load
L_m_clear:
    v_mov_b32 v4, -1
    v_mov_b32 v5, -1
    v_mov_b32 v6, -1
    v_mov_b32 v7, -1
    v_lshlrev_b32 v8, 4, v0
    s_mul_i32 s62, s96, 3072
    buffer_store_dwordx4 v[4:7], v8, s[40:43], s62 offen sc1
    buffer_store_dwordx4 v[4:7], v8, s[40:43], s62 offen offset:1024 sc1
    buffer_store_dwordx4 v[4:7], v8, s[40:43], s62 offen offset:2048 sc1
    v_mul_u32_u24 v9, 1280, v0
    s_add_u32 s62, s98, 245760
    s_mov_b64 exec, 15
    buffer_store_dwordx4 v[4:7], v9, s[40:43], s62 offen sc1
    s_mov_b64 exec, -1
L_m_load:
    buffer_load_dwordx4 v[8:11], v2, s[52:55], 0 offen offset:0
    buffer_load_dwordx4 v[12:15], v2, s[52:55], 0 offen offset:256
    buffer_load_dwordx4 v[16:19], v2, s[52:55], 0 offen offset:512
    buffer_load_dwordx4 v[20:23], v2, s[52:55], 0 offen offset:768
    buffer_load_dwordx4 v[24:27], v2, s[52:55], 0 offen offset:1024
    s_mov_b32 m0, 45056
    s_mov_b32 s62, 0
L_dma_13:
    buffer_load_dwordx4 v1, s[48:51], s62 offen nt lds
    s_add_u32 m0, m0, 1024
    s_add_u32 s62, s62, 245760
    s_cmp_lt_u32 s62, 4915200
    s_cbranch_scc1 L_dma_13
    v_and_b32 v30, 3, v0
    v_mul_u32_u24 v30, 1280, v30
    v_lshrrev_b32 v31, 2, v0
    v_lshl_add_u32 v31, v31, 4, v30
    v_bfe_u32 v32, v0, 4, 1
    v_lshl_add_u32 v30, v32, 3, v30
    buffer_load_dwordx4 v[80:83], v31, s[56:59], 0 offen offset:0
    buffer_load_dwordx4 v[84:87], v31, s[56:59], 0 offen offset:256
    buffer_load_dwordx4 v[88:91], v31, s[56:59], 0 offen offset:512
    buffer_load_dwordx4 v[92:95], v31, s[56:59], 0 offen offset:768
    buffer_load_dwordx4 v[96:99], v31, s[56:59], 0 offen offset:1024
    buffer_load_dwordx2 v[100:101], v30, s[56:59], s98 offen
    s_waitcnt vmcnt(26)
    s_cmp_lg_u32 s97, 0
    s_cbranch_scc1 L_m_noarr
    v_mov_b32 v38, 1
    s_mov_b64 exec, 1
    buffer_atomic_add v38, v36, s[44:47], 0 offen sc0 sc1
    s_mov_b64 exec, -1
L_m_noarr:
    s_mov_b32 s62, 0xbfb8aa3b
    v_lshlrev_b32 v40, 16, v8
    v_and_b32 v41, 0xffff0000, v8
    v_lshlrev_b32 v42, 16, v9
    v_and_b32 v43, 0xffff0000, v9
    v_lshlrev_b32 v44, 16, v10
    v_and_b32 v45, 0xffff0000, v10
    v_lshlrev_b32 v46, 16, v11
    v_and_b32 v47, 0xffff0000, v11
    v_mul_f32 v48, s62, v40
    v_mul_f32 v49, s62, v41
    v_mul_f32 v50, s62, v42
    v_mul_f32 v51, s62, v43
    v_mul_f32 v52, s62, v44
    v_mul_f32 v53, s62, v45
    v_mul_f32 v54, s62, v46
    v_mul_f32 v55, s62, v47
    v_exp_f32 v48, v48
    v_exp_f32 v49, v49
    v_exp_f32 v50, v50
    v_exp_f32 v51, v51
    v_exp_f32 v52, v52
    v_exp_f32 v53, v53
    v_exp_f32 v54, v54
    v_exp_f32 v55, v55
    v_add_f32 v48, 1.0, v48
    v_add_f32 v49, 1.0, v49
    v_add_f32 v50, 1.0, v50
    v_add_f32 v51, 1.0, v51
    v_add_f32 v52, 1.0, v52
    v_add_f32 v53, 1.0, v53
    v_add_f32 v54, 1.0, v54
    v_add_f32 v55, 1.0, v55
    v_rcp_f32 v48, v48
    v_rcp_f32 v49, v49
    v_rcp_f32 v50, v50
    v_rcp_f32 v51, v51
    v_rcp_f32 v52, v52
    v_rcp_f32 v53, v53
    v_rcp_f32 v54, v54
    v_rcp_f32 v55, v55
    v_mul_f32 v40, v40, v48
    v_mul_f32 v41, v41, v49
    v_mul_f32 v42, v42, v50
    v_mul_f32 v43, v43, v51
    v_mul_f32 v44, v44, v52
    v_mul_f32 v45, v45, v53
    v_mul_f32 v46, v46, v54
    v_mul_f32 v47, v47, v55
    v_cvt_pk_bf16_f32 v8, v40, v41
    v_cvt_pk_bf16_f32 v9, v42, v43
    v_cvt_pk_bf16_f32 v10, v44, v45
    v_cvt_pk_bf16_f32 v11, v46, v47
    ds_write_b128 v3, v[8:11] offset:0
    v_lshlrev_b32 v40, 16, v12
    v_and_b32 v41, 0xffff0000, v12
    v_lshlrev_b32 v42, 16, v13
    v_and_b32 v43, 0xffff0000, v13
    v_lshlrev_b32 v44, 16, v14
    v_and_b32 v45, 0xffff0000, v14
    v_lshlrev_b32 v46, 16, v15
    v_and_b32 v47, 0xffff0000, v15
    v_mul_f32 v48, s62, v40
    v_mul_f32 v49, s62, v41
    v_mul_f32 v50, s62, v42
    v_mul_f32 v51, s62, v43
    v_mul_f32 v52, s62, v44
    v_mul_f32 v53, s62, v45
    v_mul_f32 v54, s62, v46
    v_mul_f32 v55, s62, v47
    v_exp_f32 v48, v48
    v_exp_f32 v49, v49
    v_exp_f32 v50, v50
    v_exp_f32 v51, v51
    v_exp_f32 v52, v52
    v_exp_f32 v53, v53
    v_exp_f32 v54, v54
    v_exp_f32 v55, v55
    v_add_f32 v48, 1.0, v48
    v_add_f32 v49, 1.0, v49
    v_add_f32 v50, 1.0, v50
    v_add_f32 v51, 1.0, v51
    v_add_f32 v52, 1.0, v52
    v_add_f32 v53, 1.0, v53
    v_add_f32 v54, 1.0, v54
    v_add_f32 v55, 1.0, v55
    v_rcp_f32 v48, v48
    v_rcp_f32 v49, v49
    v_rcp_f32 v50, v50
    v_rcp_f32 v51, v51
    v_rcp_f32 v52, v52
    v_rcp_f32 v53, v53
    v_rcp_f32 v54, v54
    v_rcp_f32 v55, v55
    v_mul_f32 v40, v40, v48
    v_mul_f32 v41, v41, v49
    v_mul_f32 v42, v42, v50
    v_mul_f32 v43, v43, v51
    v_mul_f32 v44, v44, v52
    v_mul_f32 v45, v45, v53
    v_mul_f32 v46, v46, v54
    v_mul_f32 v47, v47, v55
    v_cvt_pk_bf16_f32 v12, v40, v41
    v_cvt_pk_bf16_f32 v13, v42, v43
    v_cvt_pk_bf16_f32 v14, v44, v45
    v_cvt_pk_bf16_f32 v15, v46, v47
    ds_write_b128 v3, v[12:15] offset:256
    v_lshlrev_b32 v40, 16, v16
    v_and_b32 v41, 0xffff0000, v16
    v_lshlrev_b32 v42, 16, v17
    v_and_b32 v43, 0xffff0000, v17
    v_lshlrev_b32 v44, 16, v18
    v_and_b32 v45, 0xffff0000, v18
    v_lshlrev_b32 v46, 16, v19
    v_and_b32 v47, 0xffff0000, v19
    v_mul_f32 v48, s62, v40
    v_mul_f32 v49, s62, v41
    v_mul_f32 v50, s62, v42
    v_mul_f32 v51, s62, v43
    v_mul_f32 v52, s62, v44
    v_mul_f32 v53, s62, v45
    v_mul_f32 v54, s62, v46
    v_mul_f32 v55, s62, v47
    v_exp_f32 v48, v48
    v_exp_f32 v49, v49
    v_exp_f32 v50, v50
    v_exp_f32 v51, v51
    v_exp_f32 v52, v52
    v_exp_f32 v53, v53
    v_exp_f32 v54, v54
    v_exp_f32 v55, v55
    v_add_f32 v48, 1.0, v48
    v_add_f32 v49, 1.0, v49
    v_add_f32 v50, 1.0, v50
    v_add_f32 v51, 1.0, v51
    v_add_f32 v52, 1.0, v52
    v_add_f32 v53, 1.0, v53
    v_add_f32 v54, 1.0, v54
    v_add_f32 v55, 1.0, v55
    v_rcp_f32 v48, v48
    v_rcp_f32 v49, v49
    v_rcp_f32 v50, v50
    v_rcp_f32 v51, v51
    v_rcp_f32 v52, v52
    v_rcp_f32 v53, v53
    v_rcp_f32 v54, v54
    v_rcp_f32 v55, v55
    v_mul_f32 v40, v40, v48
    v_mul_f32 v41, v41, v49
    v_mul_f32 v42, v42, v50
    v_mul_f32 v43, v43, v51
    v_mul_f32 v44, v44, v52
    v_mul_f32 v45, v45, v53
    v_mul_f32 v46, v46, v54
    v_mul_f32 v47, v47, v55
    v_cvt_pk_bf16_f32 v16, v40, v41
    v_cvt_pk_bf16_f32 v17, v42, v43
    v_cvt_pk_bf16_f32 v18, v44, v45
    v_cvt_pk_bf16_f32 v19, v46, v47
    ds_write_b128 v3, v[16:19] offset:512
    v_lshlrev_b32 v40, 16, v20
    v_and_b32 v41, 0xffff0000, v20
    v_lshlrev_b32 v42, 16, v21
    v_and_b32 v43, 0xffff0000, v21
    v_lshlrev_b32 v44, 16, v22
    v_and_b32 v45, 0xffff0000, v22
    v_lshlrev_b32 v46, 16, v23
    v_and_b32 v47, 0xffff0000, v23
    v_mul_f32 v48, s62, v40
    v_mul_f32 v49, s62, v41
    v_mul_f32 v50, s62, v42
    v_mul_f32 v51, s62, v43
    v_mul_f32 v52, s62, v44
    v_mul_f32 v53, s62, v45
    v_mul_f32 v54, s62, v46
    v_mul_f32 v55, s62, v47
    v_exp_f32 v48, v48
    v_exp_f32 v49, v49
    v_exp_f32 v50, v50
    v_exp_f32 v51, v51
    v_exp_f32 v52, v52
    v_exp_f32 v53, v53
    v_exp_f32 v54, v54
    v_exp_f32 v55, v55
    v_add_f32 v48, 1.0, v48
    v_add_f32 v49, 1.0, v49
    v_add_f32 v50, 1.0, v50
    v_add_f32 v51, 1.0, v51
    v_add_f32 v52, 1.0, v52
    v_add_f32 v53, 1.0, v53
    v_add_f32 v54, 1.0, v54
    v_add_f32 v55, 1.0, v55
    v_rcp_f32 v48, v48
    v_rcp_f32 v49, v49
    v_rcp_f32 v50, v50
    v_rcp_f32 v51, v51
    v_rcp_f32 v52, v52
    v_rcp_f32 v53, v53
    v_rcp_f32 v54, v54
    v_rcp_f32 v55, v55
    v_mul_f32 v40, v40, v48
    v_mul_f32 v41, v41, v49
    v_mul_f32 v42, v42, v50
    v_mul_f32 v43, v43, v51
    v_mul_f32 v44, v44, v52
    v_mul_f32 v45, v45, v53
    v_mul_f32 v46, v46, v54
    v_mul_f32 v47, v47, v55
    v_cvt_pk_bf16_f32 v20, v40, v41
    v_cvt_pk_bf16_f32 v21, v42, v43
    v_cvt_pk_bf16_f32 v22, v44, v45
    v_cvt_pk_bf16_f32 v23, v46, v47
    ds_write_b128 v3, v[20:23] offset:768
    v_lshlrev_b32 v40, 16, v24
    v_and_b32 v41, 0xffff0000, v24
    v_lshlrev_b32 v42, 16, v25
    v_and_b32 v43, 0xffff0000, v25
    v_lshlrev_b32 v44, 16, v26
    v_and_b32 v45, 0xffff0000, v26
    v_lshlrev_b32 v46, 16, v27
    v_and_b32 v47, 0xffff0000, v27
    v_mul_f32 v48, s62, v40
    v_mul_f32 v49, s62, v41
    v_mul_f32 v50, s62, v42
    v_mul_f32 v51, s62, v43
    v_mul_f32 v52, s62, v44
    v_mul_f32 v53, s62, v45
    v_mul_f32 v54, s62, v46
    v_mul_f32 v55, s62, v47
    v_exp_f32 v48, v48
    v_exp_f32 v49, v49
    v_exp_f32 v50, v50
    v_exp_f32 v51, v51
    v_exp_f32 v52, v52
    v_exp_f32 v53, v53
    v_exp_f32 v54, v54
    v_exp_f32 v55, v55
    v_add_f32 v48, 1.0, v48
    v_add_f32 v49, 1.0, v49
    v_add_f32 v50, 1.0, v50
    v_add_f32 v51, 1.0, v51
    v_add_f32 v52, 1.0, v52
    v_add_f32 v53, 1.0, v53
    v_add_f32 v54, 1.0, v54
    v_add_f32 v55, 1.0, v55
    v_rcp_f32 v48, v48
    v_rcp_f32 v49, v49
    v_rcp_f32 v50, v50
    v_rcp_f32 v51, v51
    v_rcp_f32 v52, v52
    v_rcp_f32 v53, v53
    v_rcp_f32 v54, v54
    v_rcp_f32 v55, v55
    v_mul_f32 v40, v40, v48
    v_mul_f32 v41, v41, v49
    v_mul_f32 v42, v42, v50
    v_mul_f32 v43, v43, v51
    v_mul_f32 v44, v44, v52
    v_mul_f32 v45, v45, v53
    v_mul_f32 v46, v46, v54
    v_mul_f32 v47, v47, v55
    v_cvt_pk_bf16_f32 v24, v40, v41
    v_cvt_pk_bf16_f32 v25, v42, v43
    v_cvt_pk_bf16_f32 v26, v44, v45
    v_cvt_pk_bf16_f32 v27, v46, v47
    ds_write_b128 v3, v[24:27] offset:1024
    v_lshrrev_b32 v4, 4, v0
    v_lshlrev_b32 v4, 8, v4
    v_and_b32 v6, 15, v0
    v_lshl_add_u32 v4, v6, 3, v4
    v_add_u32 v4, 45056, v4
    v_and_b32 v5, 3, v0
    v_mul_u32_u24 v5, 1296, v5
    v_lshrrev_b32 v6, 4, v0
    v_lshl_add_u32 v5, v6, 4, v5
    v_add_u32 v5, 118784, v5
    s_waitcnt vmcnt(0) lgkmcnt(0)
    s_cmp_lg_u32 s97, 0
    s_cbranch_scc1 L_m_noy
    v_readfirstlane_b32 s62, v38
    s_nop 0
    s_cmp_lg_u32 s62, 79
    s_cbranch_scc1 L_m_noy
    v_mov_b32 v38, 1
    s_mov_b64 exec, 1
    buffer_store_dword v38, v36, s[44:47], 0 offen offset:128 sc1
    s_mov_b64 exec, -1
L_m_noy:
    v_mov_b32 v8, 0
    v_mov_b32 v9, 0
    v_mov_b32 v10, 0
    v_mov_b32 v11, 0
    s_mov_b32 s62, 4
L_gv_14:
    ds_read_b64_tr_b16 v[40:41], v4 offset:0
    ds_read_b64_tr_b16 v[42:43], v4 offset:128
    ds_read_b128 v[44:47], v5 offset:0
    ds_read_b64_tr_b16 v[48:49], v4 offset:1024
    ds_read_b64_tr_b16 v[50:51], v4 offset:1152
    ds_read_b128 v[52:55], v5 offset:64
    ds_read_b64_tr_b16 v[56:57], v4 offset:2048
    ds_read_b64_tr_b16 v[58:59], v4 offset:2176
    ds_read_b128 v[60:63], v5 offset:128
    ds_read_b64_tr_b16 v[64:65], v4 offset:3072
    ds_read_b64_tr_b16 v[66:67], v4 offset:3200
    ds_read_b128 v[68:71], v5 offset:192
    ds_read_b64_tr_b16 v[72:73], v4 offset:4096
    ds_read_b64_tr_b16 v[74:75], v4 offset:4224
    ds_read_b128 v[76:79], v5 offset:256
    v_add_u32 v4, 5120, v4
    v_add_u32 v5, 320, v5
    s_waitcnt lgkmcnt(12)
    v_mfma_f32_16x16x32_bf16 v[8:11], v[40:43], v[44:47], v[8:11]
    s_waitcnt lgkmcnt(9)
    v_mfma_f32_16x16x32_bf16 v[8:11], v[48:51], v[52:55], v[8:11]
    s_waitcnt lgkmcnt(6)
    v_mfma_f32_16x16x32_bf16 v[8:11], v[56:59], v[60:63], v[8:11]
    s_waitcnt lgkmcnt(3)
    v_mfma_f32_16x16x32_bf16 v[8:11], v[64:67], v[68:71], v[8:11]
    s_waitcnt lgkmcnt(0)
    v_mfma_f32_16x16x32_bf16 v[8:11], v[72:75], v[76:79], v[8:11]
    s_sub_u32 s62, s62, 1
    s_cmp_lg_u32 s62, 0
    s_cbranch_scc1 L_gv_14
    v_and_b32 v1, 15, v0
    v_cmp_gt_u32 s[56:57], 4, v1
    s_cmp_lg_u32 s97, 0
    s_cbranch_scc1 L_m_other
    v_mov_b32 v12, 0
    v_mov_b32 v13, 0
    s_mov_b32 s62, 0x3f803f80
    v_dot2c_f32_bf16 v12, s62, v80
    v_dot2c_f32_bf16 v13, v80, v80
    v_dot2c_f32_bf16 v12, s62, v81
    v_dot2c_f32_bf16 v13, v81, v81
    v_dot2c_f32_bf16 v12, s62, v82
    v_dot2c_f32_bf16 v13, v82, v82
    v_dot2c_f32_bf16 v12, s62, v83
    v_dot2c_f32_bf16 v13, v83, v83
    v_dot2c_f32_bf16 v12, s62, v84
    v_dot2c_f32_bf16 v13, v84, v84
    v_dot2c_f32_bf16 v12, s62, v85
    v_dot2c_f32_bf16 v13, v85, v85
    v_dot2c_f32_bf16 v12, s62, v86
    v_dot2c_f32_bf16 v13, v86, v86
    v_dot2c_f32_bf16 v12, s62, v87
    v_dot2c_f32_bf16 v13, v87, v87
    v_dot2c_f32_bf16 v12, s62, v88
    v_dot2c_f32_bf16 v13, v88, v88
    v_dot2c_f32_bf16 v12, s62, v89
    v_dot2c_f32_bf16 v13, v89, v89
    v_dot2c_f32_bf16 v12, s62, v90
    v_dot2c_f32_bf16 v13, v90, v90
    v_dot2c_f32_bf16 v12, s62, v91
    v_dot2c_f32_bf16 v13, v91, v91
    v_dot2c_f32_bf16 v12, s62, v92
    v_dot2c_f32_bf16 v13, v92, v92
    v_dot2c_f32_bf16 v12, s62, v93
    v_dot2c_f32_bf16 v13, v93, v93
    v_dot2c_f32_bf16 v12, s62, v94
    v_dot2c_f32_bf16 v13, v94, v94
    v_dot2c_f32_bf16 v12, s62, v95
    v_dot2c_f32_bf16 v13, v95, v95
    v_dot2c_f32_bf16 v12, s62, v96
    v_dot2c_f32_bf16 v13, v96, v96
    v_dot2c_f32_bf16 v12, s62, v97
    v_dot2c_f32_bf16 v13, v97, v97
    v_dot2c_f32_bf16 v12, s62, v98
    v_dot2c_f32_bf16 v13, v98, v98
    v_dot2c_f32_bf16 v12, s62, v99
    v_dot2c_f32_bf16 v13, v99, v99
    s_nop 1
    v_add_f32_dpp v12, v12, v12 row_ror:4 row_mask:0xf bank_mask:0xf
    v_add_f32_dpp v13, v13, v13 row_ror:4 row_mask:0xf bank_mask:0xf
    s_nop 0
    v_add_f32_dpp v12, v12, v12 row_ror:8 row_mask:0xf bank_mask:0xf
    v_add_f32_dpp v13, v13, v13 row_ror:8 row_mask:0xf bank_mask:0xf
    v_mov_b32 v14, v12
    v_mov_b32 v15, v13
    s_nop 0
    v_permlane16_swap_b32 v12, v14
    v_permlane16_swap_b32 v13, v15
    v_add_f32 v12, v12, v14
    v_add_f32 v13, v13, v15
    v_mov_b32 v14, v12
    v_mov_b32 v15, v13
    s_nop 0
    v_permlane32_swap_b32 v12, v14
    v_permlane32_swap_b32 v13, v15
    v_add_f32 v12, v12, v14
    v_add_f32 v13, v13, v15
    s_mov_b32 s62, 0x3acccccd
    v_mul_f32 v12, s62, v12
    v_mul_f32 v13, s62, v13
    v_fma_f32 v13, -v12, v12, v13
    v_max_f32 v13, 0, v13
    v_add_f32 v13, 0x3727c5ac, v13
    v_rsq_f32 v13, v13
    v_lshlrev_b32 v16, 16, v100
    v_and_b32 v17, 0xffff0000, v100
    v_lshlrev_b32 v18, 16, v101
    v_and_b32 v19, 0xffff0000, v101
    v_sub_f32 v16, v16, v12
    v_mov_b32 v20, v8
    v_sub_f32 v17, v17, v12
    v_mov_b32 v21, v9
    v_sub_f32 v18, v18, v12
    v_mov_b32 v22, v10
    v_sub_f32 v19, v19, v12
    v_mov_b32 v23, v11
    v_mul_f32 v16, v16, v13
    v_permlane32_swap_b32 v8, v20
    v_mul_f32 v17, v17, v13
    v_permlane32_swap_b32 v9, v21
    v_mul_f32 v18, v18, v13
    v_permlane32_swap_b32 v10, v22
    v_mul_f32 v19, v19, v13
    v_permlane32_swap_b32 v11, v23
    v_add_f32 v20, 1.0, v20
    v_add_f32 v21, 1.0, v21
    v_add_f32 v22, 1.0, v22
    v_add_f32 v23, 1.0, v23
    v_fma_f32 v8, v16, v20, v8
    v_fma_f32 v9, v17, v21, v9
    v_fma_f32 v10, v18, v22, v10
    v_fma_f32 v11, v19, v23, v11
    v_cvt_pk_bf16_f32 v8, v8, v9
    v_cvt_pk_bf16_f32 v9, v10, v11
    s_add_u32 s62, s98, 245760
    s_mov_b32 exec_lo, s56
    s_mov_b32 exec_hi, 0
    buffer_store_dwordx2 v[8:9], v30, s[40:43], s62 offen sc1
    s_mov_b64 exec, -1
    s_endpgm
L_m_other:
    s_mul_i32 s62, s96, 0x667
    s_lshr_b32 s62, s62, 16
    s_mul_i32 s63, s62, 3840
    s_lshl_b32 s98, s96, 5
    s_add_u32 s98, s98, s63
    s_add_u32 s98, s98, 49152
    s_cmp_eq_u32 s62, 2
    s_cselect_b32 s62, 1.0, 0
    v_mul_u32_u24 v1, 1280, v1
    v_lshrrev_b32 v2, 4, v0
    v_lshl_add_u32 v1, v2, 3, v1
    v_add_f32 v8, s62, v8
    v_add_f32 v9, s62, v9
    v_add_f32 v10, s62, v10
    v_add_f32 v11, s62, v11
    v_cvt_pk_bf16_f32 v8, v8, v9
    v_cvt_pk_bf16_f32 v9, v10, v11
    s_mov_b64 exec, s[56:57]
    buffer_store_dwordx2 v[8:9], v1, s[40:43], s98 offen sc1
    s_mov_b64 exec, -1
L_m_done:
    s_cmp_eq_u32 s39, 1
    s_cbranch_scc1 L_role_load
    s_endpgm
L_h1:
    s_and_b32 s96, s35, 7
    s_lshl_b32 s96, s96, 5
    s_lshl_b32 s97, s36, 8
    s_add_u32 s96, s96, s97
    v_lshrrev_b32 v1, 1, v0
    v_lshlrev_b32 v1, 13, v1
    v_and_b32 v2, 1, v0
    v_lshl_add_u32 v1, v2, 4, v1
    v_add_u32 v1, s96, v1
    s_mov_b32 s48, s10
    s_mov_b32 s49, s11
    s_mov_b32 s50, 5242880
    s_mov_b32 s51, 0x20000
    s_mov_b32 m0, 20480
    s_mov_b32 s62, 0
L_dma_15:
    buffer_load_dwordx4 v1, s[48:51], s62 offen nt lds
    s_add_u32 m0, m0, 1024
    s_add_u32 s62, s62, 262144
    s_cmp_lt_u32 s62, 5242880
    s_cbranch_scc1 L_dma_15
    v_mov_b32 v36, 0
    s_mov_b32 s97, 245760
    v_lshrrev_b32 v4, 4, v0
    v_and_b32 v5, 15, v0
    v_lshlrev_b32 v5, 4, v5
    v_mul_u32_u24 v2, 1280, v4
    v_add3_u32 v2, v2, v5, s97
    v_mul_u32_u24 v3, 1296, v4
    v_add_u32 v3, v3, v5
    v_add_u32 v3, 123968, v3
    v_lshrrev_b32 v4, 4, v0
    v_lshlrev_b32 v4, 8, v4
    v_and_b32 v6, 15, v0
    v_lshl_add_u32 v4, v6, 3, v4
    v_add_u32 v4, 20480, v4
    v_and_b32 v5, 3, v0
    v_mul_u32_u24 v5, 1296, v5
    v_lshrrev_b32 v6, 4, v0
    v_lshl_add_u32 v5, v6, 4, v5
    v_add_u32 v5, 123968, v5
L_wy_16:
    buffer_load_dword v37, v36, s[44:47], 0 offen offset:128 sc1
    s_waitcnt vmcnt(0)
    v_cmp_eq_u32 vcc, 0, v37
    s_cbranch_vccz L_wy_16e
    s_sleep 4
    s_sub_u32 s60, s60, 1
    s_cbranch_scc0 L_wy_16
    s_mov_b32 s60, 0
L_wy_16e:
    s_getreg_b32 s62, hwreg(HW_REG_XCC_ID, 0, 4)
    s_mul_i32 s63, s62, s62
    s_lshl_b32 s62, s62, 8
    s_lshl_b32 s63, s63, 17
    s_add_u32 s62, s62, s63
    s_add_u32 s62, s62, 1
    v_mov_b32 v38, s62
    s_lshl_b32 s63, s34, 2
L_poll_17:
    buffer_load_dwordx4 v[8:11], v2, s[40:43], 0 offen offset:0 sc1
    buffer_load_dwordx4 v[12:15], v2, s[40:43], 0 offen offset:256 sc1
    buffer_load_dwordx4 v[16:19], v2, s[40:43], 0 offen offset:512 sc1
    buffer_load_dwordx4 v[20:23], v2, s[40:43], 0 offen offset:768 sc1
    buffer_load_dwordx4 v[24:27], v2, s[40:43], 0 offen offset:1024 sc1
    s_waitcnt vmcnt(0)
    v_max3_u32 v37, v8, v9, v10
    v_max3_u32 v37, v37, v11, v12
    v_max3_u32 v37, v37, v13, v14
    v_max3_u32 v37, v37, v15, v16
    v_max3_u32 v37, v37, v17, v18
    v_max3_u32 v37, v37, v19, v20
    v_max3_u32 v37, v37, v21, v22
    v_max3_u32 v37, v37, v23, v24
    v_max3_u32 v37, v37, v25, v26
    v_max_u32 v37, v37, v27
    v_cmp_eq_u32 vcc, -1, v37
    s_cbranch_vccz L_poll_17e
    s_sleep 1
    s_sub_u32 s60, s60, 1
    s_cbranch_scc0 L_poll_17
    s_mov_b32 s60, 0
L_poll_17e:
    ds_write_b128 v3, v[8:11] offset:0
    ds_write_b128 v3, v[12:15] offset:256
    ds_write_b128 v3, v[16:19] offset:512
    ds_write_b128 v3, v[20:23] offset:768
    ds_write_b128 v3, v[24:27] offset:1024
    s_mov_b64 exec, 1
    buffer_atomic_add v38, v36, s[44:47], s63 offen offset:64 sc1
    s_mov_b64 exec, -1
    s_waitcnt lgkmcnt(0)
    v_mov_b32 v28, 0
    v_mov_b32 v29, 0
    v_mov_b32 v30, 0
    v_mov_b32 v31, 0
    s_mov_b32 s62, 4
L_gv_18:
    ds_read_b64_tr_b16 v[40:41], v4 offset:0
    ds_read_b64_tr_b16 v[42:43], v4 offset:128
    ds_read_b128 v[44:47], v5 offset:0
    ds_read_b64_tr_b16 v[48:49], v4 offset:1024
    ds_read_b64_tr_b16 v[50:51], v4 offset:1152
    ds_read_b128 v[52:55], v5 offset:64
    ds_read_b64_tr_b16 v[56:57], v4 offset:2048
    ds_read_b64_tr_b16 v[58:59], v4 offset:2176
    ds_read_b128 v[60:63], v5 offset:128
    ds_read_b64_tr_b16 v[64:65], v4 offset:3072
    ds_read_b64_tr_b16 v[66:67], v4 offset:3200
    ds_read_b128 v[68:71], v5 offset:192
    ds_read_b64_tr_b16 v[72:73], v4 offset:4096
    ds_read_b64_tr_b16 v[74:75], v4 offset:4224
    ds_read_b128 v[76:79], v5 offset:256
    v_add_u32 v4, 5120, v4
    v_add_u32 v5, 320, v5
    s_waitcnt lgkmcnt(12)
    v_mfma_f32_16x16x32_bf16 v[28:31], v[40:43], v[44:47], v[28:31]
    s_waitcnt lgkmcnt(9)
    v_mfma_f32_16x16x32_bf16 v[28:31], v[48:51], v[52:55], v[28:31]
    s_waitcnt lgkmcnt(6)
    v_mfma_f32_16x16x32_bf16 v[28:31], v[56:59], v[60:63], v[28:31]
    s_waitcnt lgkmcnt(3)
    v_mfma_f32_16x16x32_bf16 v[28:31], v[64:67], v[68:71], v[28:31]
    s_waitcnt lgkmcnt(0)
    v_mfma_f32_16x16x32_bf16 v[28:31], v[72:75], v[76:79], v[28:31]
    s_sub_u32 s62, s62, 1
    s_cmp_lg_u32 s62, 0
    s_cbranch_scc1 L_gv_18
    v_and_b32 v1, 15, v0
    v_cmp_gt_u32 vcc, 4, v1
    v_lshlrev_b32 v1, 13, v1
    v_lshrrev_b32 v2, 4, v0
    v_lshl_add_u32 v1, v2, 3, v1
    v_cvt_pk_bf16_f32 v28, v28, v29
    v_cvt_pk_bf16_f32 v29, v30, v31
    s_mov_b64 exec, vcc
    buffer_store_dwordx2 v[28:29], v1, s[40:43], s96 offen sc1
    s_mov_b64 exec, -1
    s_cmp_eq_u32 s39, 1
    s_cbranch_scc1 L_role_load
    s_endpgm
L_h3:
    s_cmp_eq_u32 s39, 1
    s_cbranch_scc0 L_end
L_role_load:
    s_mul_i32 s96, s3, 24576
    s_add_u32 s96, s96, -4096
    s_cmp_eq_u32 s3, 0
    s_cselect_b32 s97, 94208, s96
    s_cselect_b32 s96, 0, s96
    s_lshl_b32 s63, s35, 7
    s_lshl_b32 s62, s3, 5
    s_add_u32 s63, s63, s62
    s_add_u32 s59, s63, 69632
    v_lshrrev_b32 v1, 1, v0
    v_mul_u32_u24 v1, 3456, v1
    v_and_b32 v2, 1, v0
    v_lshl_add_u32 v1, v2, 4, v1
    v_add_u32 v1, s63, v1
    v_lshrrev_b32 v2, 4, v0
    v_lshlrev_b32 v2, 3, v2
    s_mov_b32 s48, s16
    s_mov_b32 s49, s17
    s_mov_b32 s50, 2211840
    s_mov_b32 s51, 0x20000
    s_mov_b32 s52, s18
    s_mov_b32 s53, s19
    s_mov_b32 s54, 3456
    s_mov_b32 s55, 0x20000
    buffer_load_dwordx2 v[162:163], v2, s[52:55], s63 offen
    s_mov_b32 m0, s96
    s_mov_b32 s62, 0
L_dma_19:
    buffer_load_dwordx4 v1, s[48:51], s62 offen nt lds
    s_add_u32 m0, m0, 1024
    s_add_u32 s62, s62, 110592
    s_waitcnt vmcnt(2)
    s_cmp_lt_u32 s62, 2211840
    s_cbranch_scc1 L_dma_19
    v_lshrrev_b32 v160, 4, v0
    v_lshlrev_b32 v160, 8, v160
    v_and_b32 v3, 15, v0
    v_lshl_add_u32 v160, v3, 3, v160
    v_add_u32 v160, s96, v160
    s_mul_i32 s63, s35, 48
    s_mul_i32 s100, s3, 491520
    v_add_u32 v8, 0, v0
    v_mul_u32_u24 v4, 0x5556, v8
    v_lshrrev_b32 v4, 16, v4
    v_mul_u32_u24 v9, 3, v4
    v_sub_u32 v8, v8, v9
    v_mul_u32_u24 v4, 1280, v4
    v_lshl_add_u32 v4, v8, 4, v4
    v_add_u32 v4, s63, v4
    v_add_u32 v4, s100, v4
    v_add_u32 v8, 64, v0
    v_mul_u32_u24 v5, 0x5556, v8
    v_lshrrev_b32 v5, 16, v5
    v_mul_u32_u24 v9, 3, v5
    v_sub_u32 v8, v8, v9
    v_mul_u32_u24 v5, 1280, v5
    v_lshl_add_u32 v5, v8, 4, v5
    v_add_u32 v5, s63, v5
    v_add_u32 v5, s100, v5
    v_add_u32 v8, 128, v0
    v_mul_u32_u24 v6, 0x5556, v8
    v_lshrrev_b32 v6, 16, v6
    v_mul_u32_u24 v9, 3, v6
    v_sub_u32 v8, v8, v9
    v_mul_u32_u24 v6, 1280, v6
    v_lshl_add_u32 v6, v8, 4, v6
    v_add_u32 v6, s63, v6
    v_add_u32 v6, s100, v6
    s_mov_b32 s48, s20
    s_mov_b32 s49, s21
    s_mov_b32 s50, 2211840
    s_mov_b32 s51, 0x20000
    s_cmp_eq_u32 s3, 0
    s_cbranch_scc1 L_role_w2
    s_waitcnt vmcnt(0)
L_role_frag:
    ds_read_b64_tr_b16 v[80:81], v160 offset:0
    ds_read_b64_tr_b16 v[82:83], v160 offset:128
    ds_read_b64_tr_b16 v[84:85], v160 offset:1024
    ds_read_b64_tr_b16 v[86:87], v160 offset:1152
    ds_read_b64_tr_b16 v[88:89], v160 offset:2048
    ds_read_b64_tr_b16 v[90:91], v160 offset:2176
    ds_read_b64_tr_b16 v[92:93], v160 offset:3072
    ds_read_b64_tr_b16 v[94:95], v160 offset:3200
    ds_read_b64_tr_b16 v[96:97], v160 offset:4096
    ds_read_b64_tr_b16 v[98:99], v160 offset:4224
    ds_read_b64_tr_b16 v[100:101], v160 offset:5120
    ds_read_b64_tr_b16 v[102:103], v160 offset:5248
    ds_read_b64_tr_b16 v[104:105], v160 offset:6144
    ds_read_b64_tr_b16 v[106:107], v160 offset:6272
    ds_read_b64_tr_b16 v[108:109], v160 offset:7168
    ds_read_b64_tr_b16 v[110:111], v160 offset:7296
    ds_read_b64_tr_b16 v[112:113], v160 offset:8192
    ds_read_b64_tr_b16 v[114:115], v160 offset:8320
    ds_read_b64_tr_b16 v[116:117], v160 offset:9216
    ds_read_b64_tr_b16 v[118:119], v160 offset:9344
    ds_read_b64_tr_b16 v[120:121], v160 offset:10240
    ds_read_b64_tr_b16 v[122:123], v160 offset:10368
    ds_read_b64_tr_b16 v[124:125], v160 offset:11264
    ds_read_b64_tr_b16 v[126:127], v160 offset:11392
    ds_read_b64_tr_b16 v[128:129], v160 offset:12288
    ds_read_b64_tr_b16 v[130:131], v160 offset:12416
    ds_read_b64_tr_b16 v[132:133], v160 offset:13312
    ds_read_b64_tr_b16 v[134:135], v160 offset:13440
    ds_read_b64_tr_b16 v[136:137], v160 offset:14336
    ds_read_b64_tr_b16 v[138:139], v160 offset:14464
    ds_read_b64_tr_b16 v[140:141], v160 offset:15360
    ds_read_b64_tr_b16 v[142:143], v160 offset:15488
    ds_read_b64_tr_b16 v[144:145], v160 offset:16384
    ds_read_b64_tr_b16 v[146:147], v160 offset:16512
    ds_read_b64_tr_b16 v[148:149], v160 offset:17408
    ds_read_b64_tr_b16 v[150:151], v160 offset:17536
    ds_read_b64_tr_b16 v[152:153], v160 offset:18432
    ds_read_b64_tr_b16 v[154:155], v160 offset:18560
    ds_read_b64_tr_b16 v[156:157], v160 offset:19456
    ds_read_b64_tr_b16 v[158:159], v160 offset:19584
    s_waitcnt lgkmcnt(0)
    s_cmp_eq_u32 s3, 0
    s_cbranch_scc1 L_ffn1
L_role_w2:
    s_mov_b32 m0, s97
    s_mov_b32 s62, 6
L_dmb_20:
    buffer_load_dwordx4 v4, s[48:51], 0 offen nt lds
    s_add_u32 m0, m0, 1024
    v_add_u32 v4, 81920, v4
    s_waitcnt vmcnt(2)
    buffer_load_dwordx4 v5, s[48:51], 0 offen nt lds
    s_add_u32 m0, m0, 1024
    v_add_u32 v5, 81920, v5
    s_waitcnt vmcnt(2)
    buffer_load_dwordx4 v6, s[48:51], 0 offen nt lds
    s_add_u32 m0, m0, 1024
    v_add_u32 v6, 81920, v6
    s_waitcnt vmcnt(2)
    s_sub_u32 s62, s62, 1
    s_cmp_lg_u32 s62, 0
    s_cbranch_scc1 L_dmb_20
    s_lshr_b32 s62, s3, 1
    s_lshl_b32 s62, s62, 7
    s_add_u32 s62, s62, 1152
    s_mul_i32 s63, s3, 384
    s_sub_u32 s62, s62, s63
    s_mul_i32 s62, s62, 1280
    v_add_u32 v4, s62, v4
    v_add_u32 v5, s62, v5
    v_add_u32 v6, s62, v6
    s_mov_b32 s62, 2
L_dmb_21:
    buffer_load_dwordx4 v4, s[48:51], 0 offen nt lds
    s_add_u32 m0, m0, 1024
    v_add_u32 v4, 81920, v4
    s_waitcnt vmcnt(2)
    buffer_load_dwordx4 v5, s[48:51], 0 offen nt lds
    s_add_u32 m0, m0, 1024
    v_add_u32 v5, 81920, v5
    s_waitcnt vmcnt(2)
    buffer_load_dwordx4 v6, s[48:51], 0 offen nt lds
    s_add_u32 m0, m0, 1024
    v_add_u32 v6, 81920, v6
    s_waitcnt vmcnt(2)
    s_sub_u32 s62, s62, 1
    s_cmp_lg_u32 s62, 0
    s_cbranch_scc1 L_dmb_21
    v_mov_b32 v36, 0
    s_cmp_lg_u32 s3, 3
    s_cbranch_scc1 L_role_nomo
L_wy_22:
    buffer_load_dword v37, v36, s[44:47], 0 offen offset:128 sc1
    s_waitcnt vmcnt(0)
    v_cmp_eq_u32 vcc, 0, v37
    s_cbranch_vccz L_wy_22e
    s_sleep 4
    s_sub_u32 s60, s60, 1
    s_cbranch_scc0 L_wy_22
    s_mov_b32 s60, 0
L_wy_22e:
    s_mov_b32 s62, 54272
    v_lshrrev_b32 v4, 4, v0
    v_and_b32 v5, 15, v0
    v_lshlrev_b32 v5, 4, v5
    v_mul_u32_u24 v2, 1280, v4
    v_add3_u32 v2, v2, v5, s62
    v_mul_u32_u24 v3, 1296, v4
    v_add_u32 v3, v3, v5
    v_add_u32 v3, 134336, v3
    s_mov_b32 s62, 5120
L_poll_23:
    buffer_load_dwordx4 v[8:11], v2, s[40:43], 0 offen offset:0 sc1
    buffer_load_dwordx4 v[12:15], v2, s[40:43], 0 offen offset:256 sc1
    buffer_load_dwordx4 v[16:19], v2, s[40:43], 0 offen offset:512 sc1
    buffer_load_dwordx4 v[20:23], v2, s[40:43], 0 offen offset:768 sc1
    buffer_load_dwordx4 v[24:27], v2, s[40:43], 0 offen offset:1024 sc1
    buffer_load_dwordx4 v[28:31], v2, s[40:43], s62 offen offset:0 sc1
    buffer_load_dwordx4 v[32:35], v2, s[40:43], s62 offen offset:256 sc1
    buffer_load_dwordx4 v[36:39], v2, s[40:43], s62 offen offset:512 sc1
    buffer_load_dwordx4 v[40:43], v2, s[40:43], s62 offen offset:768 sc1
    buffer_load_dwordx4 v[44:47], v2, s[40:43], s62 offen offset:1024 sc1
    s_waitcnt vmcnt(0)
    v_max3_u32 v50, v8, v9, v10
    v_max3_u32 v50, v50, v11, v12
    v_max3_u32 v50, v50, v13, v14
    v_max3_u32 v50, v50, v15, v16
    v_max3_u32 v50, v50, v17, v18
    v_max3_u32 v50, v50, v19, v20
    v_max3_u32 v50, v50, v21, v22
    v_max3_u32 v50, v50, v23, v24
    v_max3_u32 v50, v50, v25, v26
    v_max3_u32 v50, v50, v27, v28
    v_max3_u32 v50, v50, v29, v30
    v_max3_u32 v50, v50, v31, v32
    v_max3_u32 v50, v50, v33, v34
    v_max3_u32 v50, v50, v35, v36
    v_max3_u32 v50, v50, v37, v38
    v_max3_u32 v50, v50, v39, v40
    v_max3_u32 v50, v50, v41, v42
    v_max3_u32 v50, v50, v43, v44
    v_max3_u32 v50, v50, v45, v46
    v_max_u32 v50, v50, v47
    v_cmp_eq_u32 vcc, -1, v50
    s_cbranch_vccz L_poll_23e
    s_sleep 8
    s_sub_u32 s60, s60, 1
    s_cbranch_scc0 L_poll_23
    s_mov_b32 s60, 0
L_poll_23e:
    ds_write_b128 v3, v[28:31] offset:0
    ds_write_b128 v3, v[32:35] offset:256
    ds_write_b128 v3, v[36:39] offset:512
    ds_write_b128 v3, v[40:43] offset:768
    ds_write_b128 v3, v[44:47] offset:1024
    ds_write_b128 v3, v[8:11] offset:5184
    ds_write_b128 v3, v[12:15] offset:5440
    ds_write_b128 v3, v[16:19] offset:5696
    ds_write_b128 v3, v[20:23] offset:5952
    ds_write_b128 v3, v[24:27] offset:6208
    v_mov_b32 v36, 0
L_role_nomo:
    s_lshl_b32 s62, s34, 2
    buffer_load_dword v37, v36, s[44:47], s62 offen offset:64 sc1
    v_and_b32 v1, 15, v0
    v_min_u32 v161, 11, v1
    v_mul_u32_u24 v161, 1296, v161
    v_lshrrev_b32 v2, 4, v0
    v_lshl_add_u32 v161, v2, 4, v161
    v_add_u32 v161, 129152, v161
    v_mul_u32_u24 v164, 3456, v1
    v_lshl_add_u32 v164, v2, 3, v164
    v_and_b32 v165, 3, v0
    v_lshlrev_b32 v165, 6, v165
    v_add_u32 v165, 159040, v165
    s_waitcnt vmcnt(0) lgkmcnt(0)
    s_getreg_b32 s62, hwreg(HW_REG_XCC_ID, 0, 4)
    s_mul_i32 s63, s62, s62
    s_lshl_b32 s62, s62, 13
    s_lshl_b32 s63, s63, 22
    s_add_u32 s62, s62, s63
    s_add_u32 s62, s62, 32
    v_readfirstlane_b32 s63, v37
    s_nop 0
    s_cmp_eq_u32 s62, s63
    s_cselect_b32 s61, 1, 0
    s_cmp_eq_u32 s3, 0
    s_cbranch_scc1 L_t1
    s_barrier
L_ffn1:
    v_lshlrev_b32 v60, 16, v162
    v_and_b32 v61, 0xffff0000, v162
    v_lshlrev_b32 v62, 16, v163
    v_and_b32 v63, 0xffff0000, v163
    s_barrier
    ds_read_b128 v[8:11], v161 offset:0
    ds_read_b128 v[12:15], v161 offset:64
    ds_read_b128 v[16:19], v161 offset:128
    ds_read_b128 v[20:23], v161 offset:192
    ds_read_b128 v[24:27], v161 offset:256
    ds_read_b128 v[28:31], v161 offset:320
    ds_read_b128 v[32:35], v161 offset:384
    ds_read_b128 v[36:39], v161 offset:448
    ds_read_b128 v[40:43], v161 offset:512
    ds_read_b128 v[44:47], v161 offset:576
    s_waitcnt lgkmcnt(9)
    v_mfma_f32_16x16x32_bf16 v[4:7], v[80:83], v[8:11], 0
    ds_read_b128 v[8:11], v161 offset:640
    s_waitcnt lgkmcnt(9)
    v_mfma_f32_16x16x32_bf16 v[4:7], v[84:87], v[12:15], v[4:7]
    ds_read_b128 v[12:15], v161 offset:704
    s_waitcnt lgkmcnt(9)
    v_mfma_f32_16x16x32_bf16 v[4:7], v[88:91], v[16:19], v[4:7]
    ds_read_b128 v[16:19], v161 offset:768
    s_waitcnt lgkmcnt(9)
    v_mfma_f32_16x16x32_bf16 v[4:7], v[92:95], v[20:23], v[4:7]
    ds_read_b128 v[20:23], v161 offset:832
    s_waitcnt lgkmcnt(9)
    v_mfma_f32_16x16x32_bf16 v[4:7], v[96:99], v[24:27], v[4:7]
    ds_read_b128 v[24:27], v161 offset:896
    s_waitcnt lgkmcnt(9)
    v_mfma_f32_16x16x32_bf16 v[4:7], v[100:103], v[28:31], v[4:7]
    ds_read_b128 v[28:31], v161 offset:960
    s_waitcnt lgkmcnt(9)
    v_mfma_f32_16x16x32_bf16 v[4:7], v[104:107], v[32:35], v[4:7]
    ds_read_b128 v[32:35], v161 offset:1024
    s_waitcnt lgkmcnt(9)
    v_mfma_f32_16x16x32_bf16 v[4:7], v[108:111], v[36:39], v[4:7]
    ds_read_b128 v[36:39], v161 offset:1088
    s_waitcnt lgkmcnt(9)
    v_mfma_f32_16x16x32_bf16 v[4:7], v[112:115], v[40:43], v[4:7]
    ds_read_b128 v[40:43], v161 offset:1152
    s_waitcnt lgkmcnt(9)
    v_mfma_f32_16x16x32_bf16 v[4:7], v[116:119], v[44:47], v[4:7]
    ds_read_b128 v[44:47], v161 offset:1216
    s_barrier
    ds_read_b128 v[48:51], v165
    ds_read_b128 v[52:55], v165 offset:16
    ds_read_b64 v[56:57], v165 offset:32
    s_waitcnt lgkmcnt(12)
    v_mfma_f32_16x16x32_bf16 v[4:7], v[120:123], v[8:11], v[4:7]
    s_waitcnt lgkmcnt(11)
    v_mfma_f32_16x16x32_bf16 v[4:7], v[124:127], v[12:15], v[4:7]
    s_waitcnt lgkmcnt(10)
    v_mfma_f32_16x16x32_bf16 v[4:7], v[128:131], v[16:19], v[4:7]
    s_waitcnt lgkmcnt(9)
    v_mfma_f32_16x16x32_bf16 v[4:7], v[132:135], v[20:23], v[4:7]
    s_waitcnt lgkmcnt(8)
    v_mfma_f32_16x16x32_bf16 v[4:7], v[136:139], v[24:27], v[4:7]
    s_waitcnt lgkmcnt(7)
    v_mfma_f32_16x16x32_bf16 v[4:7], v[140:143], v[28:31], v[4:7]
    s_waitcnt lgkmcnt(6)
    v_mfma_f32_16x16x32_bf16 v[4:7], v[144:147], v[32:35], v[4:7]
    s_waitcnt lgkmcnt(5)
    v_mfma_f32_16x16x32_bf16 v[4:7], v[148:151], v[36:39], v[4:7]
    s_waitcnt lgkmcnt(4)
    v_mfma_f32_16x16x32_bf16 v[4:7], v[152:155], v[40:43], v[4:7]
    s_waitcnt lgkmcnt(3)
    v_mfma_f32_16x16x32_bf16 v[4:7], v[156:159], v[44:47], v[4:7]
    s_waitcnt lgkmcnt(0)
    v_pk_add_f32 v[48:49], v[48:49], v[50:51]
    v_pk_add_f32 v[52:53], v[52:53], v[54:55]
    v_pk_add_f32 v[48:49], v[48:49], v[56:57]
    v_pk_add_f32 v[48:49], v[48:49], v[52:53]
    s_mov_b32 s62, 0xbacccccd
    v_mul_f32 v48, s62, v48
    v_mul_f32 v49, s62, v49
    v_fma_f32 v49, -v48, v48, -v49
    v_max_f32 v49, 0, v49
    v_add_f32 v49, 0x3727c5ac, v49
    v_rsq_f32 v49, v49
    v_add_f32_dpp v60, v4, v60 row_shl:8 row_mask:0xf bank_mask:0x1
    v_add_f32_dpp v61, v5, v61 row_shl:8 row_mask:0xf bank_mask:0x1
    v_add_f32_dpp v62, v6, v62 row_shl:8 row_mask:0xf bank_mask:0x1
    v_add_f32_dpp v63, v7, v63 row_shl:8 row_mask:0xf bank_mask:0x1
    v_fmac_f32_dpp v4, v4, v48 row_shl:4 row_mask:0xf bank_mask:0x1
    v_fmac_f32_dpp v5, v5, v48 row_shl:4 row_mask:0xf bank_mask:0x1
    v_fmac_f32_dpp v6, v6, v48 row_shl:4 row_mask:0xf bank_mask:0x1
    v_fmac_f32_dpp v7, v7, v48 row_shl:4 row_mask:0xf bank_mask:0x1
    v_fma_f32 v4, v4, v49, v60
    v_fma_f32 v5, v5, v49, v61
    v_fma_f32 v6, v6, v49, v62
    v_fma_f32 v7, v7, v49, v63
    s_mov_b32 s62, 0xbdd2d3e8
    v_mov_b32 v50, 0xc0135761
    v_mul_f32 v8, v4, v4
    v_mul_f32 v9, v5, v5
    v_mul_f32 v10, v6, v6
    v_mul_f32 v11, v7, v7
    v_fma_f32 v8, v8, s62, v50
    v_fma_f32 v9, v9, s62, v50
    v_fma_f32 v10, v10, s62, v50
    v_fma_f32 v11, v11, s62, v50
    v_mul_f32 v8, v8, v4
    v_mul_f32 v9, v9, v5
    v_mul_f32 v10, v10, v6
    v_mul_f32 v11, v11, v7
    v_exp_f32 v8, v8
    v_exp_f32 v9, v9
    v_exp_f32 v10, v10
    v_exp_f32 v11, v11
    v_add_f32 v8, 1.0, v8
    v_add_f32 v9, 1.0, v9
    v_add_f32 v10, 1.0, v10
    v_add_f32 v11, 1.0, v11
    v_rcp_f32 v8, v8
    v_rcp_f32 v9, v9
    v_rcp_f32 v10, v10
    v_rcp_f32 v11, v11
    v_mul_f32 v4, v4, v8
    v_mul_f32 v5, v5, v9
    v_mul_f32 v6, v6, v10
    v_mul_f32 v7, v7, v11
    v_cvt_pk_bf16_f32 v4, v4, v5
    v_cvt_pk_bf16_f32 v5, v6, v7
    s_mov_b32 exec_lo, 0x000f000f
    s_mov_b32 exec_hi, 0x000f000f
    s_cmp_eq_u32 s61, 1
    s_cbranch_scc1 L_st_24f
    buffer_store_dwordx2 v[4:5], v164, s[40:43], s59 offen sc1
    s_branch L_st_24e
L_st_24f:
    buffer_store_dwordx2 v[4:5], v164, s[40:43], s59 offen
L_st_24e:
L_end:
    s_endpgm
.section .rodata,"a"
.p2align 6
.amdhsa_kernel adaLN_cond__sliding_block_cached__dense_activation_gelu__decode_kernel
  .amdhsa_next_free_vgpr 168
  .amdhsa_next_free_sgpr 102
  .amdhsa_accum_offset 168
  .amdhsa_group_segment_fixed_size 0
  .amdhsa_kernarg_size 120
  .amdhsa_user_sgpr_count 2
  .amdhsa_user_sgpr_kernarg_segment_ptr 1
  .amdhsa_system_sgpr_workgroup_id_x 1
.end_amdhsa_kernel
```

```asm
; @launch grid=(256,1,1) block=(768,1,1) lds=162176
.amdgcn_target "amdgcn-amd-amdhsa--gfx950"
.text
.globl adaLN_cond__sliding_block_cached__dense_activation_gelu__decode_kernel
.p2align 8
.type adaLN_cond__sliding_block_cached__dense_activation_gelu__decode_kernel,@function
adaLN_cond__sliding_block_cached__dense_activation_gelu__decode_kernel:
    s_cmp_ge_u32 s2, 256
    s_cbranch_scc1 L_end
    s_load_dwordx16 s[4:19], s[0:1], 0
    s_load_dwordx8 s[20:27], s[0:1], 64
    s_load_dwordx4 s[28:31], s[0:1], 96
    s_load_dwordx2 s[32:33], s[0:1], 112
    v_lshrrev_b32 v1, 6, v0
    v_lshlrev_b32 v2, 4, v0
    v_readfirstlane_b32 s3, v1
    v_and_b32 v0, 63, v0
    s_and_b32 s34, s2, 7
    s_lshr_b32 s35, s2, 3
    s_cmp_lg_u32 s35, 21
    s_cbranch_scc1 L_nopf
    s_getpc_b64 s[48:49]
    s_and_b32 s48, s48, 0xffffff00
    s_mov_b32 s50, L_codeend-adaLN_cond__sliding_block_cached__dense_activation_gelu__decode_kernel
    s_mov_b32 s51, 0x20000
    s_mov_b32 s52, 12288
    buffer_load_dwordx4 v[152:155], v2, s[48:51], 0 offen
    buffer_load_dwordx4 v[156:159], v2, s[48:51], s52 offen
L_nopf:
    s_lshr_b32 s36, s35, 3
    s_lshl2_add_u32 s36, s34, s36
    s_bfe_u32 s37, s35, 0x20001
    s_and_b32 s38, s35, 1
    s_cmp_lt_u32 s35, 27
    s_cselect_b32 s39, 1, 0
    s_cmp_eq_u32 s34, 2
    s_cselect_b32 s39, s39, 0
    s_sub_u32 s62, s34, 3
    s_and_b32 s62, s62, 7
    s_mul_i32 s56, s35, 7
    s_add_u32 s56, s56, s62
    s_cmp_eq_u32 s62, 7
    s_cselect_b32 s56, 255, s56
    s_mov_b32 s60, 400000
    s_mov_b32 s61, 0
    v_mov_b32 v36, 0
    s_waitcnt lgkmcnt(0)
    s_mov_b32 s40, s32
    s_mov_b32 s41, s33
    s_mov_b32 s42, 589824
    s_mov_b32 s43, 0x20000
    s_mov_b32 s44, s30
    s_mov_b32 s45, s31
    s_mov_b32 s46, 256
    s_mov_b32 s47, 0x20000
    s_cmp_lt_u32 s3, 4
    s_cbranch_scc1 L_helpers
    s_sub_u32 s3, s3, 4
    s_cmp_ge_u32 s35, 22
    s_cselect_b32 s59, 1, 0
    s_mov_b32 s13, 0
    s_add_u32 s62, s3, s59
    s_cmp_ge_u32 s62, 7
    s_cselect_b32 s62, s39, 0
    s_cmp_eq_u32 s62, 1
    s_cbranch_scc1 L_proxy
    s_cmp_eq_u32 s59, 1
    s_cselect_b32 s12, 0, 81920
    s_lshl_b32 s62, s3, 13
    s_add_u32 s12, s12, s62
    s_and_b32 s62, s39, s59
    s_cselect_b32 s12, -1, s12
L_stream:
    s_lshl_b32 s62, s37, 5
    s_add_u32 s62, s62, s36
    s_lshl_b32 s63, s62, 21
    s_lshl_b32 s96, s38, 18
    s_add_u32 s63, s63, s96
    s_add_u32 s63, s63, 1572864
    s_add_u32 s48, s6, s63
    s_addc_u32 s49, s7, 0
    s_mov_b32 s50, 262144
    s_mov_b32 s51, 0x20000
    v_lshlrev_b32 v1, 4, v0
    s_lshl_b32 s96, s3, 12
    v_add_u32 v1, s96, v1
    s_mov_b32 s97, 0
    s_cmp_lt_u32 s56, 84
    s_cbranch_scc0 L_nob0
    s_barrier
L_nob0:
    buffer_load_dwordx4 v[40:43], v1, s[48:51], s97 offen offset:0 nt
    buffer_load_dwordx4 v[44:47], v1, s[48:51], s97 offen offset:1024 nt
    s_bitcmp1_b32 s3, 0
    s_mov_b32 s57, 0xffffffff
    s_mov_b32 s58, 0x3ff
    s_mov_b32 s14, 0xffffffff
    s_mov_b32 s15, 0x0
L_pm_1:
    s_cmp_lt_u32 s56, 84
    s_cbranch_scc0 L_pm_2
    s_bitcmp1_b32 s3, 0
    s_mov_b32 s57, 0x3ff
    s_mov_b32 s58, 0x0
    s_mov_b32 s14, 0xfffc0000
    s_mov_b32 s15, 0x0
L_pm_2:
    s_cmp_lt_u32 s56, 20
    s_cbranch_scc0 L_pm_3
    s_bitcmp1_b32 s3, 0
    s_mov_b32 s57, 0xf
    s_mov_b32 s58, 0xf
    s_mov_b32 s14, 0xfffff000
    s_mov_b32 s15, 0x0
L_pm_3:
    s_cmp_eq_u32 s39, 1
    s_cbranch_scc0 L_pm_4
    s_bitcmp1_b32 s3, 0
    s_mov_b32 s57, 0xffffffff
    s_mov_b32 s58, 0x0
    s_mov_b32 s14, 0xffffffff
    s_mov_b32 s15, 0x0
L_pm_4:
    s_cmp_lg_u32 s13, 0
    s_cbranch_scc0 L_pm_5
    s_bitcmp1_b32 s3, 0
    s_mov_b32 s57, 0x0
    s_mov_b32 s58, 0x0
    s_mov_b32 s14, 0x0
    s_mov_b32 s15, 0x0
L_pm_5:
    s_and_b32 s96, s39, s59
    s_cbranch_scc0 L_pm_6
    s_bitcmp1_b32 s3, 0
    s_mov_b32 s57, 0xffffffff
    s_mov_b32 s58, 0xff00ff
    s_cselect_b32 s58, 0xff00ff00, s58
    s_mov_b32 s14, 0x0
    s_mov_b32 s15, 0x0
L_pm_6:
    s_cmp_lt_u32 s56, 84
    s_cbranch_scc1 L_nob1
    s_barrier
L_nob1:
    s_add_u32 s52, s8, s63
    s_addc_u32 s53, s9, 0
    s_mov_b32 s54, 262144
    s_mov_b32 s55, 0x20000
    v_and_b32 v2, 15, v0
    v_lshrrev_b32 v3, 1, v2
    v_and_b32 v37, 1, v2
    v_lshlrev_b32 v37, 4, v37
    v_mov_b32 v38, 0xffff
    v_lshlrev_b32 v37, v37, v38
    v_cmp_eq_u32 vcc, 0, v3
    v_mov_b32 v32, 0
    s_nop 0
    v_cndmask_b32 v20, 0, v37, vcc
    v_cmp_eq_u32 vcc, 1, v3
    v_mov_b32 v33, 0
    s_nop 0
    v_cndmask_b32 v21, 0, v37, vcc
    v_cmp_eq_u32 vcc, 2, v3
    v_mov_b32 v34, 0
    s_nop 0
    v_cndmask_b32 v22, 0, v37, vcc
    v_cmp_eq_u32 vcc, 3, v3
    v_mov_b32 v35, 0
    s_nop 0
    v_cndmask_b32 v23, 0, v37, vcc
    v_lshlrev_b32 v2, 4, v2
    s_lshl_b32 s98, s62, 8
    s_lshl_b32 s99, s62, 7
    s_add_u32 s99, s99, 65536
    s_bitcmp0_b32 s57, 2
    s_cbranch_scc1 L_sf_7
    s_bitcmp0_b32 s58, 2
    s_cbranch_scc1 L_sf_7
    s_waitcnt vmcnt(1)
L_sf_7:
    buffer_load_dwordx4 v[48:51], v1, s[48:51], s97 offen offset:2048 nt
    s_bitcmp0_b32 s57, 3
    s_cbranch_scc1 L_sf_8
    s_waitcnt vmcnt(2)
    s_bitcmp0_b32 s58, 3
    s_cbranch_scc1 L_sf_8
    s_waitcnt vmcnt(1)
L_sf_8:
    buffer_load_dwordx4 v[52:55], v1, s[48:51], s97 offen offset:3072 nt
    s_add_u32 s97, s97, 32768
    s_waitcnt vmcnt(3)
    s_bitcmp0_b32 s57, 4
    s_cbranch_scc1 L_sf_9
    s_waitcnt vmcnt(2)
    s_bitcmp0_b32 s58, 4
    s_cbranch_scc1 L_sf_9
    s_waitcnt vmcnt(1)
L_sf_9:
    buffer_load_dwordx4 v[56:59], v1, s[48:51], s97 offen offset:0 nt
    s_waitcnt vmcnt(3)
    s_bitcmp0_b32 s57, 5
    s_cbranch_scc1 L_sf_10
    s_waitcnt vmcnt(2)
    s_bitcmp0_b32 s58, 5
    s_cbranch_scc1 L_sf_10
    s_waitcnt vmcnt(1)
L_sf_10:
    buffer_load_dwordx4 v[60:63], v1, s[48:51], s97 offen offset:1024 nt
    s_waitcnt vmcnt(3)
    s_bitcmp0_b32 s57, 6
    s_cbranch_scc1 L_sf_11
    s_waitcnt vmcnt(2)
    s_bitcmp0_b32 s58, 6
    s_cbranch_scc1 L_sf_11
    s_waitcnt vmcnt(1)
L_sf_11:
    buffer_load_dwordx4 v[64:67], v1, s[48:51], s97 offen offset:2048 nt
    s_waitcnt vmcnt(3)
    s_bitcmp0_b32 s57, 7
    s_cbranch_scc1 L_sf_12
    s_waitcnt vmcnt(2)
    s_bitcmp0_b32 s58, 7
    s_cbranch_scc1 L_sf_12
    s_waitcnt vmcnt(1)
L_sf_12:
    buffer_load_dwordx4 v[68:71], v1, s[48:51], s97 offen offset:3072 nt
    s_add_u32 s97, s97, 32768
    s_waitcnt vmcnt(3)
    s_bitcmp0_b32 s57, 8
    s_cbranch_scc1 L_sf_13
    s_waitcnt vmcnt(2)
    s_bitcmp0_b32 s58, 8
    s_cbranch_scc1 L_sf_13
    s_waitcnt vmcnt(1)
L_sf_13:
    buffer_load_dwordx4 v[72:75], v1, s[48:51], s97 offen offset:0 nt
    s_waitcnt vmcnt(3)
    s_bitcmp0_b32 s57, 9
    s_cbranch_scc1 L_sf_14
    s_waitcnt vmcnt(2)
    s_bitcmp0_b32 s58, 9
    s_cbranch_scc1 L_sf_14
    s_waitcnt vmcnt(1)
L_sf_14:
    buffer_load_dwordx4 v[76:79], v1, s[48:51], s97 offen offset:1024 nt
    s_waitcnt vmcnt(3)
    s_bitcmp0_b32 s57, 10
    s_cbranch_scc1 L_sf_15
    s_waitcnt vmcnt(2)
    s_bitcmp0_b32 s58, 10
    s_cbranch_scc1 L_sf_15
    s_waitcnt vmcnt(1)
L_sf_15:
    buffer_load_dwordx4 v[80:83], v1, s[48:51], s97 offen offset:2048 nt
    s_waitcnt vmcnt(3)
    s_bitcmp0_b32 s57, 11
    s_cbranch_scc1 L_sf_16
    s_waitcnt vmcnt(2)
    s_bitcmp0_b32 s58, 11
    s_cbranch_scc1 L_sf_16
    s_waitcnt vmcnt(1)
L_sf_16:
    buffer_load_dwordx4 v[84:87], v1, s[48:51], s97 offen offset:3072 nt
    s_add_u32 s97, s97, 32768
    s_waitcnt vmcnt(3)
    s_bitcmp0_b32 s57, 12
    s_cbranch_scc1 L_sf_17
    s_waitcnt vmcnt(2)
    s_bitcmp0_b32 s58, 12
    s_cbranch_scc1 L_sf_17
    s_waitcnt vmcnt(1)
L_sf_17:
    buffer_load_dwordx4 v[88:91], v1, s[48:51], s97 offen offset:0 nt
    s_waitcnt vmcnt(3)
    s_bitcmp0_b32 s57, 13
    s_cbranch_scc1 L_sf_18
    s_waitcnt vmcnt(2)
    s_bitcmp0_b32 s58, 13
    s_cbranch_scc1 L_sf_18
    s_waitcnt vmcnt(1)
L_sf_18:
    buffer_load_dwordx4 v[92:95], v1, s[48:51], s97 offen offset:1024 nt
    s_waitcnt vmcnt(3)
    s_bitcmp0_b32 s57, 14
    s_cbranch_scc1 L_sf_19
    s_waitcnt vmcnt(2)
    s_bitcmp0_b32 s58, 14
    s_cbranch_scc1 L_sf_19
    s_waitcnt vmcnt(1)
L_sf_19:
    buffer_load_dwordx4 v[96:99], v1, s[48:51], s97 offen offset:2048 nt
    s_waitcnt vmcnt(3)
    s_bitcmp0_b32 s57, 15
    s_cbranch_scc1 L_sf_20
    s_waitcnt vmcnt(2)
    s_bitcmp0_b32 s58, 15
    s_cbranch_scc1 L_sf_20
    s_waitcnt vmcnt(1)
L_sf_20:
    buffer_load_dwordx4 v[100:103], v1, s[48:51], s97 offen offset:3072 nt
    s_add_u32 s97, s97, 32768
    s_waitcnt vmcnt(3)
    s_bitcmp0_b32 s57, 16
    s_cbranch_scc1 L_sf_21
    s_waitcnt vmcnt(2)
    s_bitcmp0_b32 s58, 16
    s_cbranch_scc1 L_sf_21
    s_waitcnt vmcnt(1)
L_sf_21:
    buffer_load_dwordx4 v[104:107], v1, s[48:51], s97 offen offset:0 nt
    s_waitcnt vmcnt(3)
    s_bitcmp0_b32 s57, 17
    s_cbranch_scc1 L_sf_22
    s_waitcnt vmcnt(2)
    s_bitcmp0_b32 s58, 17
    s_cbranch_scc1 L_sf_22
    s_waitcnt vmcnt(1)
L_sf_22:
    buffer_load_dwordx4 v[108:111], v1, s[48:51], s97 offen offset:1024 nt
    s_waitcnt vmcnt(3)
    s_bitcmp0_b32 s57, 18
    s_cbranch_scc1 L_sf_23
    s_waitcnt vmcnt(2)
    s_bitcmp0_b32 s58, 18
    s_cbranch_scc1 L_sf_23
    s_waitcnt vmcnt(1)
L_sf_23:
    buffer_load_dwordx4 v[112:115], v1, s[48:51], s97 offen offset:2048 nt
    s_waitcnt vmcnt(3)
    s_bitcmp0_b32 s57, 19
    s_cbranch_scc1 L_sf_24
    s_waitcnt vmcnt(2)
    s_bitcmp0_b32 s58, 19
    s_cbranch_scc1 L_sf_24
    s_waitcnt vmcnt(1)
L_sf_24:
    buffer_load_dwordx4 v[116:119], v1, s[48:51], s97 offen offset:3072 nt
    s_add_u32 s97, s97, 32768
    s_waitcnt vmcnt(3)
    s_bitcmp0_b32 s57, 20
    s_cbranch_scc1 L_sf_25
    s_waitcnt vmcnt(2)
    s_bitcmp0_b32 s58, 20
    s_cbranch_scc1 L_sf_25
    s_waitcnt vmcnt(1)
L_sf_25:
    buffer_load_dwordx4 v[120:123], v1, s[48:51], s97 offen offset:0 nt
    s_waitcnt vmcnt(3)
    s_bitcmp0_b32 s57, 21
    s_cbranch_scc1 L_sf_26
    s_waitcnt vmcnt(2)
    s_bitcmp0_b32 s58, 21
    s_cbranch_scc1 L_sf_26
    s_waitcnt vmcnt(1)
L_sf_26:
    buffer_load_dwordx4 v[124:127], v1, s[48:51], s97 offen offset:1024 nt
    s_cmp_eq_u32 s12, -1
    s_cbranch_scc1 L_k_nopf
    s_waitcnt vmcnt(3)
    s_bitcmp0_b32 s57, 22
    s_cbranch_scc1 L_sf_27
    s_waitcnt vmcnt(2)
    s_bitcmp0_b32 s58, 22
    s_cbranch_scc1 L_sf_27
    s_waitcnt vmcnt(1)
L_sf_27:
    buffer_load_dwordx4 v[128:131], v1, s[48:51], s97 offen offset:2048 nt
    s_waitcnt vmcnt(3)
    s_bitcmp0_b32 s57, 23
    s_cbranch_scc1 L_sf_28
    s_waitcnt vmcnt(2)
    s_bitcmp0_b32 s58, 23
    s_cbranch_scc1 L_sf_28
    s_waitcnt vmcnt(1)
L_sf_28:
    buffer_load_dwordx4 v[132:135], v1, s[48:51], s97 offen offset:3072 nt
    s_add_u32 s97, s97, 32768
    s_waitcnt vmcnt(3)
    s_bitcmp0_b32 s57, 24
    s_cbranch_scc1 L_sf_29
    s_waitcnt vmcnt(2)
    s_bitcmp0_b32 s58, 24
    s_cbranch_scc1 L_sf_29
    s_waitcnt vmcnt(1)
L_sf_29:
    buffer_load_dwordx4 v[136:139], v1, s[48:51], s97 offen offset:0 nt
    s_waitcnt vmcnt(3)
    s_bitcmp0_b32 s57, 25
    s_cbranch_scc1 L_sf_30
    s_waitcnt vmcnt(2)
    s_bitcmp0_b32 s58, 25
    s_cbranch_scc1 L_sf_30
    s_waitcnt vmcnt(1)
L_sf_30:
    buffer_load_dwordx4 v[140:143], v1, s[48:51], s97 offen offset:1024 nt
    s_waitcnt vmcnt(3)
    s_bitcmp0_b32 s57, 26
    s_cbranch_scc1 L_sf_31
    s_waitcnt vmcnt(2)
    s_bitcmp0_b32 s58, 26
    s_cbranch_scc1 L_sf_31
    s_waitcnt vmcnt(1)
L_sf_31:
    buffer_load_dwordx4 v[144:147], v1, s[48:51], s97 offen offset:2048 nt
    s_waitcnt vmcnt(3)
    s_bitcmp0_b32 s57, 27
    s_cbranch_scc1 L_sf_32
    s_waitcnt vmcnt(2)
    s_bitcmp0_b32 s58, 27
    s_cbranch_scc1 L_sf_32
    s_waitcnt vmcnt(1)
L_sf_32:
    buffer_load_dwordx4 v[148:151], v1, s[48:51], s97 offen offset:3072 nt
    s_add_u32 s97, s97, 32768
    s_waitcnt vmcnt(3)
    s_bitcmp0_b32 s57, 28
    s_cbranch_scc1 L_sf_33
    s_waitcnt vmcnt(2)
    s_bitcmp0_b32 s58, 28
    s_cbranch_scc1 L_sf_33
    s_waitcnt vmcnt(1)
L_sf_33:
    buffer_load_dwordx4 v[152:155], v1, s[48:51], s97 offen offset:0 nt
    s_waitcnt vmcnt(3)
    s_bitcmp0_b32 s57, 29
    s_cbranch_scc1 L_sf_34
    s_waitcnt vmcnt(2)
    s_bitcmp0_b32 s58, 29
    s_cbranch_scc1 L_sf_34
    s_waitcnt vmcnt(1)
L_sf_34:
    buffer_load_dwordx4 v[156:159], v1, s[48:51], s97 offen offset:1024 nt
    s_waitcnt vmcnt(3)
    s_bitcmp0_b32 s57, 30
    s_cbranch_scc1 L_sf_35
    s_waitcnt vmcnt(2)
    s_bitcmp0_b32 s58, 30
    s_cbranch_scc1 L_sf_35
    s_waitcnt vmcnt(1)
L_sf_35:
    buffer_load_dwordx4 v[160:163], v1, s[48:51], s97 offen offset:2048 nt
    buffer_load_dword v37, v36, s[44:47], 0 offen sc1
    s_waitcnt vmcnt(4)
    s_bitcmp0_b32 s57, 31
    s_cbranch_scc1 L_sf_36
    s_waitcnt vmcnt(3)
    s_bitcmp0_b32 s58, 31
    s_cbranch_scc1 L_sf_36
    s_waitcnt vmcnt(2)
L_sf_36:
    buffer_load_dwordx4 v[164:167], v1, s[48:51], s97 offen offset:3072 nt
    s_mov_b32 s97, 0
    s_waitcnt vmcnt(4)
    s_bitcmp0_b32 s14, 0
    s_cbranch_scc1 L_sf_37
    s_waitcnt vmcnt(3)
    s_bitcmp0_b32 s15, 0
    s_cbranch_scc1 L_sf_37
    s_waitcnt vmcnt(2)
L_sf_37:
    s_add_u32 m0, s12, 0
    s_nop 0
    buffer_load_dwordx4 v1, s[52:55], s97 offen offset:0 nt lds
    s_waitcnt vmcnt(4)
    s_bitcmp0_b32 s14, 1
    s_cbranch_scc1 L_sf_38
    s_waitcnt vmcnt(3)
    s_bitcmp0_b32 s15, 1
    s_cbranch_scc1 L_sf_38
    s_waitcnt vmcnt(1)
L_sf_38:
    buffer_load_dwordx4 v1, s[52:55], s97 offen offset:1024 nt lds
    s_waitcnt vmcnt(4)
    s_bitcmp0_b32 s14, 2
    s_cbranch_scc1 L_sf_39
    s_waitcnt vmcnt(2)
    s_bitcmp0_b32 s15, 2
    s_cbranch_scc1 L_sf_39
    s_waitcnt vmcnt(1)
L_sf_39:
    buffer_load_dwordx4 v1, s[52:55], s97 offen offset:2048 nt lds
    s_waitcnt vmcnt(3)
    s_bitcmp0_b32 s14, 3
    s_cbranch_scc1 L_sf_40
    s_waitcnt vmcnt(2)
    s_bitcmp0_b32 s15, 3
    s_cbranch_scc1 L_sf_40
    s_waitcnt vmcnt(1)
L_sf_40:
    buffer_load_dwordx4 v1, s[52:55], s97 offen offset:3072 nt lds
    s_add_u32 s97, s97, 32768
    v_readfirstlane_b32 s96, v37
    buffer_load_dwordx4 v[4:7], v2, s[40:43], s98 offen sc1
    s_waitcnt vmcnt(4)
    s_bitcmp0_b32 s14, 4
    s_cbranch_scc1 L_sf_41
    s_waitcnt vmcnt(3)
    s_bitcmp0_b32 s15, 4
    s_cbranch_scc1 L_sf_41
    s_waitcnt vmcnt(2)
L_sf_41:
    s_add_u32 m0, s12, 4096
    s_nop 0
    buffer_load_dwordx4 v1, s[52:55], s97 offen offset:0 nt lds
    s_waitcnt vmcnt(4)
    s_bitcmp0_b32 s14, 5
    s_cbranch_scc1 L_sf_42
    s_waitcnt vmcnt(3)
    s_bitcmp0_b32 s15, 5
    s_cbranch_scc1 L_sf_42
    s_waitcnt vmcnt(2)
L_sf_42:
    buffer_load_dwordx4 v1, s[52:55], s97 offen offset:1024 nt lds
    s_waitcnt vmcnt(4)
    s_bitcmp0_b32 s14, 6
    s_cbranch_scc1 L_sf_43
    s_waitcnt vmcnt(3)
    s_bitcmp0_b32 s15, 6
    s_cbranch_scc1 L_sf_43
    s_waitcnt vmcnt(1)
L_sf_43:
    buffer_load_dwordx4 v1, s[52:55], s97 offen offset:2048 nt lds
    s_waitcnt vmcnt(4)
    s_bitcmp0_b32 s14, 7
    s_cbranch_scc1 L_sf_44
    s_waitcnt vmcnt(2)
    s_bitcmp0_b32 s15, 7
    s_cbranch_scc1 L_sf_44
    s_waitcnt vmcnt(1)
L_sf_44:
    buffer_load_dwordx4 v1, s[52:55], s97 offen offset:3072 nt lds
    s_add_u32 s97, s97, 32768
L_k_join:
    s_waitcnt vmcnt(4)
    v_max3_u32 v38, v4, v5, v6
    v_max_u32 v38, v38, v7
    v_cmp_eq_u32 vcc, -1, v38
    s_cmp_lg_u32 s96, 5253184
    s_cbranch_scc1 L_qslow
    s_cbranch_vccnz L_qslow2
L_qok:
    v_dot2_f32_bf16 v8, v72, v4, 0
    v_dot2_f32_bf16 v9, v76, v4, 0
    v_dot2_f32_bf16 v10, v80, v4, 0
    v_dot2_f32_bf16 v11, v84, v4, 0
    v_dot2_f32_bf16 v24, v88, v4, 0
    v_dot2_f32_bf16 v25, v92, v4, 0
    v_dot2_f32_bf16 v26, v96, v4, 0
    v_dot2_f32_bf16 v27, v100, v4, 0
    v_dot2_f32_bf16 v8, v73, v5, v8
    v_dot2_f32_bf16 v9, v77, v5, v9
    v_dot2_f32_bf16 v10, v81, v5, v10
    v_dot2_f32_bf16 v11, v85, v5, v11
    v_dot2_f32_bf16 v24, v89, v5, v24
    v_dot2_f32_bf16 v25, v93, v5, v25
    v_dot2_f32_bf16 v26, v97, v5, v26
    v_dot2_f32_bf16 v27, v101, v5, v27
    v_dot2_f32_bf16 v8, v74, v6, v8
    v_dot2_f32_bf16 v9, v78, v6, v9
    v_dot2_f32_bf16 v10, v82, v6, v10
    v_dot2_f32_bf16 v11, v86, v6, v11
    v_dot2_f32_bf16 v24, v90, v6, v24
    v_dot2_f32_bf16 v25, v94, v6, v25
    v_dot2_f32_bf16 v26, v98, v6, v26
    v_dot2_f32_bf16 v27, v102, v6, v27
    v_dot2_f32_bf16 v8, v75, v7, v8
    v_dot2_f32_bf16 v9, v79, v7, v9
    v_dot2_f32_bf16 v10, v83, v7, v10
    v_dot2_f32_bf16 v11, v87, v7, v11
    v_dot2_f32_bf16 v24, v91, v7, v24
    v_dot2_f32_bf16 v25, v95, v7, v25
    v_dot2_f32_bf16 v26, v99, v7, v26
    v_dot2_f32_bf16 v27, v103, v7, v27
    v_add_f32_dpp v8, v8, v8 row_ror:8 row_mask:0xf bank_mask:0x3
    v_add_f32_dpp v10, v10, v10 row_ror:8 row_mask:0xf bank_mask:0x3
    v_add_f32_dpp v24, v24, v24 row_ror:8 row_mask:0xf bank_mask:0x3
    v_add_f32_dpp v26, v26, v26 row_ror:8 row_mask:0xf bank_mask:0x3
    v_add_f32_dpp v8, v9, v9 row_ror:8 row_mask:0xf bank_mask:0xc
    v_add_f32_dpp v10, v11, v11 row_ror:8 row_mask:0xf bank_mask:0xc
    v_add_f32_dpp v24, v25, v25 row_ror:8 row_mask:0xf bank_mask:0xc
    v_add_f32_dpp v26, v27, v27 row_ror:8 row_mask:0xf bank_mask:0xc
    v_add_f32_dpp v14, v8, v8 row_half_mirror row_mask:0xf bank_mask:0x5
    v_add_f32_dpp v15, v24, v24 row_half_mirror row_mask:0xf bank_mask:0x5
    v_add_f32_dpp v14, v10, v10 row_half_mirror row_mask:0xf bank_mask:0xa
    v_add_f32_dpp v15, v26, v26 row_half_mirror row_mask:0xf bank_mask:0xa
    s_nop 0
    v_add_f32_dpp v14, v14, v14 quad_perm:[1,0,3,2] row_mask:0xf bank_mask:0xf
    v_add_f32_dpp v15, v15, v15 quad_perm:[1,0,3,2] row_mask:0xf bank_mask:0xf
    s_nop 0
    v_add_f32_dpp v14, v14, v14 quad_perm:[2,3,0,1] row_mask:0xf bank_mask:0xf
    v_add_f32_dpp v15, v15, v15 quad_perm:[2,3,0,1] row_mask:0xf bank_mask:0xf
    s_waitcnt vmcnt(3)
    s_bitcmp0_b32 s14, 8
    s_cbranch_scc1 L_sf_55
    s_waitcnt vmcnt(2)
    s_bitcmp0_b32 s15, 8
    s_cbranch_scc1 L_sf_55
    s_waitcnt vmcnt(1)
L_sf_55:
    buffer_load_dwordx4 v[72:75], v1, s[52:55], s97 offen offset:0 nt
    v_dot2_f32_bf16 v8, v40, v4, 0
    v_dot2_f32_bf16 v9, v44, v4, 0
    v_dot2_f32_bf16 v10, v48, v4, 0
    v_dot2_f32_bf16 v11, v52, v4, 0
    v_dot2_f32_bf16 v24, v56, v4, 0
    v_dot2_f32_bf16 v25, v60, v4, 0
    v_dot2_f32_bf16 v26, v64, v4, 0
    v_dot2_f32_bf16 v27, v68, v4, 0
    v_dot2_f32_bf16 v28, v104, v4, 0
    v_dot2_f32_bf16 v29, v108, v4, 0
    v_dot2_f32_bf16 v30, v112, v4, 0
    v_dot2_f32_bf16 v31, v116, v4, 0
    v_dot2_f32_bf16 v8, v41, v5, v8
    v_dot2_f32_bf16 v9, v45, v5, v9
    v_dot2_f32_bf16 v10, v49, v5, v10
    v_dot2_f32_bf16 v11, v53, v5, v11
    v_dot2_f32_bf16 v24, v57, v5, v24
    v_dot2_f32_bf16 v25, v61, v5, v25
    v_dot2_f32_bf16 v26, v65, v5, v26
    v_dot2_f32_bf16 v27, v69, v5, v27
    v_dot2_f32_bf16 v28, v105, v5, v28
    v_dot2_f32_bf16 v29, v109, v5, v29
    v_dot2_f32_bf16 v30, v113, v5, v30
    v_dot2_f32_bf16 v31, v117, v5, v31
    v_dot2_f32_bf16 v8, v42, v6, v8
    v_dot2_f32_bf16 v9, v46, v6, v9
    v_dot2_f32_bf16 v10, v50, v6, v10
    v_dot2_f32_bf16 v11, v54, v6, v11
    v_dot2_f32_bf16 v24, v58, v6, v24
    v_dot2_f32_bf16 v25, v62, v6, v25
    v_dot2_f32_bf16 v26, v66, v6, v26
    v_dot2_f32_bf16 v27, v70, v6, v27
    v_dot2_f32_bf16 v28, v106, v6, v28
    v_dot2_f32_bf16 v29, v110, v6, v29
    v_dot2_f32_bf16 v30, v114, v6, v30
    v_dot2_f32_bf16 v31, v118, v6, v31
    v_dot2_f32_bf16 v8, v43, v7, v8
    v_dot2_f32_bf16 v9, v47, v7, v9
    v_dot2_f32_bf16 v10, v51, v7, v10
    v_dot2_f32_bf16 v11, v55, v7, v11
    v_dot2_f32_bf16 v24, v59, v7, v24
    v_dot2_f32_bf16 v25, v63, v7, v25
    v_dot2_f32_bf16 v26, v67, v7, v26
    v_dot2_f32_bf16 v27, v71, v7, v27
    v_dot2_f32_bf16 v28, v107, v7, v28
    v_dot2_f32_bf16 v29, v111, v7, v29
    v_dot2_f32_bf16 v30, v115, v7, v30
    v_dot2_f32_bf16 v31, v119, v7, v31
    v_add_f32_dpp v8, v8, v8 row_ror:8 row_mask:0xf bank_mask:0x3
    v_add_f32_dpp v10, v10, v10 row_ror:8 row_mask:0xf bank_mask:0x3
    v_add_f32_dpp v24, v24, v24 row_ror:8 row_mask:0xf bank_mask:0x3
    v_add_f32_dpp v26, v26, v26 row_ror:8 row_mask:0xf bank_mask:0x3
    v_add_f32_dpp v28, v28, v28 row_ror:8 row_mask:0xf bank_mask:0x3
    v_add_f32_dpp v30, v30, v30 row_ror:8 row_mask:0xf bank_mask:0x3
    v_add_f32_dpp v8, v9, v9 row_ror:8 row_mask:0xf bank_mask:0xc
    v_add_f32_dpp v10, v11, v11 row_ror:8 row_mask:0xf bank_mask:0xc
    v_add_f32_dpp v24, v25, v25 row_ror:8 row_mask:0xf bank_mask:0xc
    v_add_f32_dpp v26, v27, v27 row_ror:8 row_mask:0xf bank_mask:0xc
    v_add_f32_dpp v28, v29, v29 row_ror:8 row_mask:0xf bank_mask:0xc
    v_add_f32_dpp v30, v31, v31 row_ror:8 row_mask:0xf bank_mask:0xc
    v_add_f32_dpp v12, v8, v8 row_half_mirror row_mask:0xf bank_mask:0x5
    v_add_f32_dpp v13, v24, v24 row_half_mirror row_mask:0xf bank_mask:0x5
    v_add_f32_dpp v16, v28, v28 row_half_mirror row_mask:0xf bank_mask:0x5
    v_add_f32_dpp v12, v10, v10 row_half_mirror row_mask:0xf bank_mask:0xa
    v_add_f32_dpp v13, v26, v26 row_half_mirror row_mask:0xf bank_mask:0xa
    v_add_f32_dpp v16, v30, v30 row_half_mirror row_mask:0xf bank_mask:0xa
    v_add_f32_dpp v12, v12, v12 quad_perm:[1,0,3,2] row_mask:0xf bank_mask:0xf
    v_add_f32_dpp v13, v13, v13 quad_perm:[1,0,3,2] row_mask:0xf bank_mask:0xf
    v_add_f32_dpp v16, v16, v16 quad_perm:[1,0,3,2] row_mask:0xf bank_mask:0xf
    v_add_f32_dpp v12, v12, v12 quad_perm:[2,3,0,1] row_mask:0xf bank_mask:0xf
    v_add_f32_dpp v13, v13, v13 quad_perm:[2,3,0,1] row_mask:0xf bank_mask:0xf
    v_add_f32_dpp v16, v16, v16 quad_perm:[2,3,0,1] row_mask:0xf bank_mask:0xf
    s_waitcnt vmcnt(3)
    s_bitcmp0_b32 s14, 9
    s_cbranch_scc1 L_sf_56
    s_waitcnt vmcnt(2)
    s_bitcmp0_b32 s15, 9
    s_cbranch_scc1 L_sf_56
    s_waitcnt vmcnt(1)
L_sf_56:
    buffer_load_dwordx4 v[76:79], v1, s[52:55], s97 offen offset:1024 nt
    v_dot2_f32_bf16 v8, v120, v4, 0
    v_dot2_f32_bf16 v9, v124, v4, 0
    v_dot2_f32_bf16 v10, v128, v4, 0
    v_dot2_f32_bf16 v11, v132, v4, 0
    v_dot2_f32_bf16 v24, v136, v4, 0
    v_dot2_f32_bf16 v25, v140, v4, 0
    v_dot2_f32_bf16 v26, v144, v4, 0
    v_dot2_f32_bf16 v27, v148, v4, 0
    v_dot2_f32_bf16 v8, v121, v5, v8
    v_dot2_f32_bf16 v9, v125, v5, v9
    v_dot2_f32_bf16 v10, v129, v5, v10
    v_dot2_f32_bf16 v11, v133, v5, v11
    v_dot2_f32_bf16 v24, v137, v5, v24
    v_dot2_f32_bf16 v25, v141, v5, v25
    v_dot2_f32_bf16 v26, v145, v5, v26
    v_dot2_f32_bf16 v27, v149, v5, v27
    v_dot2_f32_bf16 v8, v122, v6, v8
    v_dot2_f32_bf16 v9, v126, v6, v9
    v_dot2_f32_bf16 v10, v130, v6, v10
    v_dot2_f32_bf16 v11, v134, v6, v11
    v_dot2_f32_bf16 v24, v138, v6, v24
    v_dot2_f32_bf16 v25, v142, v6, v25
    v_dot2_f32_bf16 v26, v146, v6, v26
    v_dot2_f32_bf16 v27, v150, v6, v27
    v_dot2_f32_bf16 v8, v123, v7, v8
    v_dot2_f32_bf16 v9, v127, v7, v9
    v_dot2_f32_bf16 v10, v131, v7, v10
    v_dot2_f32_bf16 v11, v135, v7, v11
    v_dot2_f32_bf16 v24, v139, v7, v24
    v_dot2_f32_bf16 v25, v143, v7, v25
    v_dot2_f32_bf16 v26, v147, v7, v26
    v_dot2_f32_bf16 v27, v151, v7, v27
    v_add_f32_dpp v8, v8, v8 row_ror:8 row_mask:0xf bank_mask:0x3
    v_add_f32_dpp v10, v10, v10 row_ror:8 row_mask:0xf bank_mask:0x3
    v_add_f32_dpp v24, v24, v24 row_ror:8 row_mask:0xf bank_mask:0x3
    v_add_f32_dpp v26, v26, v26 row_ror:8 row_mask:0xf bank_mask:0x3
    v_add_f32_dpp v8, v9, v9 row_ror:8 row_mask:0xf bank_mask:0xc
    v_add_f32_dpp v10, v11, v11 row_ror:8 row_mask:0xf bank_mask:0xc
    v_add_f32_dpp v24, v25, v25 row_ror:8 row_mask:0xf bank_mask:0xc
    v_add_f32_dpp v26, v27, v27 row_ror:8 row_mask:0xf bank_mask:0xc
    v_add_f32_dpp v17, v8, v8 row_half_mirror row_mask:0xf bank_mask:0x5
    v_add_f32_dpp v18, v24, v24 row_half_mirror row_mask:0xf bank_mask:0x5
    v_add_f32_dpp v17, v10, v10 row_half_mirror row_mask:0xf bank_mask:0xa
    v_add_f32_dpp v18, v26, v26 row_half_mirror row_mask:0xf bank_mask:0xa
    s_nop 0
    v_add_f32_dpp v17, v17, v17 quad_perm:[1,0,3,2] row_mask:0xf bank_mask:0xf
    v_add_f32_dpp v18, v18, v18 quad_perm:[1,0,3,2] row_mask:0xf bank_mask:0xf
    s_nop 0
    v_add_f32_dpp v17, v17, v17 quad_perm:[2,3,0,1] row_mask:0xf bank_mask:0xf
    v_add_f32_dpp v18, v18, v18 quad_perm:[2,3,0,1] row_mask:0xf bank_mask:0xf
    s_waitcnt vmcnt(3)
    s_bitcmp0_b32 s14, 10
    s_cbranch_scc1 L_sf_57
    s_waitcnt vmcnt(2)
    s_bitcmp0_b32 s15, 10
    s_cbranch_scc1 L_sf_57
    s_waitcnt vmcnt(1)
L_sf_57:
    buffer_load_dwordx4 v[80:83], v1, s[52:55], s97 offen offset:2048 nt
    s_waitcnt vmcnt(3)
    s_bitcmp0_b32 s14, 11
    s_cbranch_scc1 L_sf_58
    s_waitcnt vmcnt(2)
    s_bitcmp0_b32 s15, 11
    s_cbranch_scc1 L_sf_58
    s_waitcnt vmcnt(1)
L_sf_58:
    buffer_load_dwordx4 v[84:87], v1, s[52:55], s97 offen offset:3072 nt
    s_add_u32 s97, s97, 32768
    s_cmp_eq_u32 s12, -1
    s_cbranch_scc1 L_nopfrd
    v_lshl_add_u32 v38, v0, 4, s12
    ds_read_b128 v[40:43], v38 offset:0
    ds_read_b128 v[44:47], v38 offset:1024
    ds_read_b128 v[48:51], v38 offset:2048
    ds_read_b128 v[52:55], v38 offset:3072
    ds_read_b128 v[56:59], v38 offset:4096
    ds_read_b128 v[60:63], v38 offset:5120
    ds_read_b128 v[64:67], v38 offset:6144
    ds_read_b128 v[68:71], v38 offset:7168
L_nopfrd:
    v_dot2_f32_bf16 v8, v152, v4, 0
    v_dot2_f32_bf16 v9, v156, v4, 0
    v_dot2_f32_bf16 v10, v160, v4, 0
    v_dot2_f32_bf16 v11, v164, v4, 0
    v_dot2_f32_bf16 v8, v153, v5, v8
    v_dot2_f32_bf16 v9, v157, v5, v9
    v_dot2_f32_bf16 v10, v161, v5, v10
    v_dot2_f32_bf16 v11, v165, v5, v11
    v_dot2_f32_bf16 v8, v154, v6, v8
    v_dot2_f32_bf16 v9, v158, v6, v9
    v_dot2_f32_bf16 v10, v162, v6, v10
    v_dot2_f32_bf16 v11, v166, v6, v11
    v_dot2_f32_bf16 v8, v155, v7, v8
    v_dot2_f32_bf16 v9, v159, v7, v9
    v_dot2_f32_bf16 v10, v163, v7, v10
    v_dot2_f32_bf16 v11, v167, v7, v11
    v_add_f32_dpp v8, v8, v8 row_ror:8 row_mask:0xf bank_mask:0x3
    s_nop 0
    v_add_f32_dpp v10, v10, v10 row_ror:8 row_mask:0xf bank_mask:0x3
    v_add_f32_dpp v8, v9, v9 row_ror:8 row_mask:0xf bank_mask:0xc
    v_add_f32_dpp v10, v11, v11 row_ror:8 row_mask:0xf bank_mask:0xc
    s_nop 0
    v_add_f32_dpp v19, v8, v8 row_half_mirror row_mask:0xf bank_mask:0x5
    v_add_f32_dpp v19, v10, v10 row_half_mirror row_mask:0xf bank_mask:0xa
    s_nop 1
    v_add_f32_dpp v19, v19, v19 quad_perm:[1,0,3,2] row_mask:0xf bank_mask:0xf
    s_nop 1
    v_add_f32_dpp v19, v19, v19 quad_perm:[2,3,0,1] row_mask:0xf bank_mask:0xf
    v_max3_f32 v3, v12, v13, v14
    v_max3_f32 v8, v15, v16, v17
    v_max3_f32 v3, v3, v18, v19
    v_max_f32 v3, v3, v8
    s_nop 1
    v_max_f32_dpp v3, v3, v3 row_ror:4 row_mask:0xf bank_mask:0xf
    s_nop 1
    v_max_f32_dpp v3, v3, v3 row_ror:8 row_mask:0xf bank_mask:0xf
    v_mov_b32 v8, v3
    s_nop 1
    v_permlane16_swap_b32 v3, v8
    v_max_f32 v3, v3, v8
    v_mov_b32 v8, v3
    s_nop 1
    v_permlane32_swap_b32 v3, v8
    v_max_f32 v3, v3, v8
    s_mov_b32 s96, 0x3e0293ee
    v_mul_f32 v8, s96, v3
    v_fma_f32 v12, v12, s96, -v8
    v_fma_f32 v13, v13, s96, -v8
    v_fma_f32 v14, v14, s96, -v8
    v_fma_f32 v15, v15, s96, -v8
    v_fma_f32 v16, v16, s96, -v8
    v_fma_f32 v17, v17, s96, -v8
    v_fma_f32 v18, v18, s96, -v8
    v_fma_f32 v19, v19, s96, -v8
    v_exp_f32 v12, v12
    v_exp_f32 v13, v13
    v_exp_f32 v14, v14
    v_exp_f32 v15, v15
    v_exp_f32 v16, v16
    v_exp_f32 v17, v17
    v_exp_f32 v18, v18
    v_exp_f32 v19, v19
    v_add_f32 v9, v12, v13
    v_add_f32 v10, v14, v15
    v_add_f32 v11, v16, v17
    v_add_f32 v3, v18, v19
    v_add_f32 v9, v9, v10
    v_add_f32 v3, v3, v11
    v_add_f32 v9, v9, v3
    v_cvt_pk_bf16_f32 v12, v12, v12
    v_cvt_pk_bf16_f32 v13, v13, v13
    v_cvt_pk_bf16_f32 v14, v14, v14
    v_cvt_pk_bf16_f32 v15, v15, v15
    v_cvt_pk_bf16_f32 v16, v16, v16
    v_cvt_pk_bf16_f32 v17, v17, v17
    v_cvt_pk_bf16_f32 v18, v18, v18
    v_cvt_pk_bf16_f32 v19, v19, v19
    v_add_f32_dpp v9, v9, v9 row_ror:4 row_mask:0xf bank_mask:0xf
    s_nop 1
    v_add_f32_dpp v9, v9, v9 row_ror:8 row_mask:0xf bank_mask:0xf
    v_mov_b32 v10, v9
    s_nop 1
    v_permlane16_swap_b32 v9, v10
    v_add_f32 v9, v9, v10
    v_mov_b32 v10, v9
    s_nop 1
    v_permlane32_swap_b32 v9, v10
    v_add_f32 v9, v9, v10
    s_lshl_b32 s96, s38, 3
    s_add_u32 s96, s96, s3
    s_lshl3_add_u32 s96, s96, s99
    s_getreg_b32 s62, hwreg(HW_REG_XCC_ID, 0, 4)
    v_mov_b32 v10, s62
    s_lshl_b32 s63, s34, 5
    s_add_u32 s63, s63, s35
    s_lshl_b32 s63, s63, 2
    s_add_u32 s63, s63, 204800
    s_cmp_eq_u32 s3, 0
    s_cselect_b32 s62, s63, 589824
    v_mov_b32 v11, s62
    s_mov_b64 exec, 1
    buffer_store_dwordx2 v[8:9], v36, s[40:43], s96 offen sc1
    buffer_store_dword v10, v11, s[40:43], 0 offen sc1
    s_mov_b64 exec, -1
    v_mov_b32 v3, v8
    v_lshrrev_b32 v2, 1, v2
    v_and_b32_dpp v24, v14, v20 row_newbcast:0 row_mask:0xf bank_mask:0xf
    v_and_b32_dpp v25, v14, v21 row_newbcast:0 row_mask:0xf bank_mask:0xf
    v_and_b32_dpp v26, v14, v22 row_newbcast:0 row_mask:0xf bank_mask:0xf
    v_and_b32_dpp v27, v14, v23 row_newbcast:0 row_mask:0xf bank_mask:0xf
    s_waitcnt vmcnt(5)
    s_bitcmp0_b32 s14, 12
    s_cbranch_scc1 L_sf_59
    s_waitcnt vmcnt(4)
    s_bitcmp0_b32 s15, 12
    s_cbranch_scc1 L_sf_59
    s_waitcnt vmcnt(3)
L_sf_59:
    buffer_load_dwordx4 v[88:91], v1, s[52:55], s97 offen offset:0 nt
    v_mfma_f32_16x16x32_bf16 v[32:35], v[24:27], v[72:75], v[32:35]
    s_cmp_eq_u32 s12, -1
    s_cbranch_scc1 L_nopfpv8
    s_waitcnt lgkmcnt(0)
    v_and_b32_dpp v24, v12, v20 row_newbcast:0 row_mask:0xf bank_mask:0xf
    v_and_b32_dpp v25, v12, v21 row_newbcast:0 row_mask:0xf bank_mask:0xf
    v_and_b32_dpp v26, v12, v22 row_newbcast:0 row_mask:0xf bank_mask:0xf
    v_and_b32_dpp v27, v12, v23 row_newbcast:0 row_mask:0xf bank_mask:0xf
    s_nop 1
    v_mfma_f32_16x16x32_bf16 v[32:35], v[24:27], v[40:43], v[32:35]
    v_and_b32_dpp v28, v12, v20 row_newbcast:8 row_mask:0xf bank_mask:0xf
    v_and_b32_dpp v29, v12, v21 row_newbcast:8 row_mask:0xf bank_mask:0xf
    v_and_b32_dpp v30, v12, v22 row_newbcast:8 row_mask:0xf bank_mask:0xf
    v_and_b32_dpp v31, v12, v23 row_newbcast:8 row_mask:0xf bank_mask:0xf
    s_nop 1
    v_mfma_f32_16x16x32_bf16 v[32:35], v[28:31], v[44:47], v[32:35]
    v_and_b32_dpp v24, v12, v20 row_newbcast:4 row_mask:0xf bank_mask:0xf
    v_and_b32_dpp v25, v12, v21 row_newbcast:4 row_mask:0xf bank_mask:0xf
    v_and_b32_dpp v26, v12, v22 row_newbcast:4 row_mask:0xf bank_mask:0xf
    v_and_b32_dpp v27, v12, v23 row_newbcast:4 row_mask:0xf bank_mask:0xf
    s_nop 1
    v_mfma_f32_16x16x32_bf16 v[32:35], v[24:27], v[48:51], v[32:35]
    v_and_b32_dpp v28, v12, v20 row_newbcast:12 row_mask:0xf bank_mask:0xf
    v_and_b32_dpp v29, v12, v21 row_newbcast:12 row_mask:0xf bank_mask:0xf
    v_and_b32_dpp v30, v12, v22 row_newbcast:12 row_mask:0xf bank_mask:0xf
    v_and_b32_dpp v31, v12, v23 row_newbcast:12 row_mask:0xf bank_mask:0xf
    s_nop 1
    v_mfma_f32_16x16x32_bf16 v[32:35], v[28:31], v[52:55], v[32:35]
L_nopfpv8:
    v_and_b32_dpp v28, v14, v20 row_newbcast:8 row_mask:0xf bank_mask:0xf
    v_and_b32_dpp v29, v14, v21 row_newbcast:8 row_mask:0xf bank_mask:0xf
    v_and_b32_dpp v30, v14, v22 row_newbcast:8 row_mask:0xf bank_mask:0xf
    v_and_b32_dpp v31, v14, v23 row_newbcast:8 row_mask:0xf bank_mask:0xf
    s_waitcnt vmcnt(5)
    s_bitcmp0_b32 s14, 13
    s_cbranch_scc1 L_sf_60
    s_waitcnt vmcnt(4)
    s_bitcmp0_b32 s15, 13
    s_cbranch_scc1 L_sf_60
    s_waitcnt vmcnt(3)
L_sf_60:
    buffer_load_dwordx4 v[92:95], v1, s[52:55], s97 offen offset:1024 nt
    v_mfma_f32_16x16x32_bf16 v[32:35], v[28:31], v[76:79], v[32:35]
    s_cmp_eq_u32 s12, -1
    s_cbranch_scc1 L_nopfpv9
    s_waitcnt lgkmcnt(0)
    v_and_b32_dpp v24, v13, v20 row_newbcast:0 row_mask:0xf bank_mask:0xf
    v_and_b32_dpp v25, v13, v21 row_newbcast:0 row_mask:0xf bank_mask:0xf
    v_and_b32_dpp v26, v13, v22 row_newbcast:0 row_mask:0xf bank_mask:0xf
    v_and_b32_dpp v27, v13, v23 row_newbcast:0 row_mask:0xf bank_mask:0xf
    s_nop 1
    v_mfma_f32_16x16x32_bf16 v[32:35], v[24:27], v[56:59], v[32:35]
    v_and_b32_dpp v28, v13, v20 row_newbcast:8 row_mask:0xf bank_mask:0xf
    v_and_b32_dpp v29, v13, v21 row_newbcast:8 row_mask:0xf bank_mask:0xf
    v_and_b32_dpp v30, v13, v22 row_newbcast:8 row_mask:0xf bank_mask:0xf
    v_and_b32_dpp v31, v13, v23 row_newbcast:8 row_mask:0xf bank_mask:0xf
    s_nop 1
    v_mfma_f32_16x16x32_bf16 v[32:35], v[28:31], v[60:63], v[32:35]
    v_and_b32_dpp v24, v13, v20 row_newbcast:4 row_mask:0xf bank_mask:0xf
    v_and_b32_dpp v25, v13, v21 row_newbcast:4 row_mask:0xf bank_mask:0xf
    v_and_b32_dpp v26, v13, v22 row_newbcast:4 row_mask:0xf bank_mask:0xf
    v_and_b32_dpp v27, v13, v23 row_newbcast:4 row_mask:0xf bank_mask:0xf
    s_nop 1
    v_mfma_f32_16x16x32_bf16 v[32:35], v[24:27], v[64:67], v[32:35]
    v_and_b32_dpp v28, v13, v20 row_newbcast:12 row_mask:0xf bank_mask:0xf
    v_and_b32_dpp v29, v13, v21 row_newbcast:12 row_mask:0xf bank_mask:0xf
    v_and_b32_dpp v30, v13, v22 row_newbcast:12 row_mask:0xf bank_mask:0xf
    v_and_b32_dpp v31, v13, v23 row_newbcast:12 row_mask:0xf bank_mask:0xf
    s_nop 1
    v_mfma_f32_16x16x32_bf16 v[32:35], v[28:31], v[68:71], v[32:35]
L_nopfpv9:
    v_and_b32_dpp v24, v14, v20 row_newbcast:4 row_mask:0xf bank_mask:0xf
    v_and_b32_dpp v25, v14, v21 row_newbcast:4 row_mask:0xf bank_mask:0xf
    v_and_b32_dpp v26, v14, v22 row_newbcast:4 row_mask:0xf bank_mask:0xf
    v_and_b32_dpp v27, v14, v23 row_newbcast:4 row_mask:0xf bank_mask:0xf
    s_waitcnt vmcnt(5)
    s_bitcmp0_b32 s14, 14
    s_cbranch_scc1 L_sf_61
    s_waitcnt vmcnt(4)
    s_bitcmp0_b32 s15, 14
    s_cbranch_scc1 L_sf_61
    s_waitcnt vmcnt(1)
L_sf_61:
    buffer_load_dwordx4 v[96:99], v1, s[52:55], s97 offen offset:2048 nt
    v_mfma_f32_16x16x32_bf16 v[32:35], v[24:27], v[80:83], v[32:35]
    v_and_b32_dpp v28, v14, v20 row_newbcast:12 row_mask:0xf bank_mask:0xf
    v_and_b32_dpp v29, v14, v21 row_newbcast:12 row_mask:0xf bank_mask:0xf
    v_and_b32_dpp v30, v14, v22 row_newbcast:12 row_mask:0xf bank_mask:0xf
    v_and_b32_dpp v31, v14, v23 row_newbcast:12 row_mask:0xf bank_mask:0xf
    s_waitcnt vmcnt(5)
    s_bitcmp0_b32 s14, 15
    s_cbranch_scc1 L_sf_62
    s_waitcnt vmcnt(2)
    s_bitcmp0_b32 s15, 15
    s_cbranch_scc1 L_sf_62
    s_waitcnt vmcnt(1)
L_sf_62:
    buffer_load_dwordx4 v[100:103], v1, s[52:55], s97 offen offset:3072 nt
    s_add_u32 s97, s97, 32768
    v_mfma_f32_16x16x32_bf16 v[32:35], v[28:31], v[84:87], v[32:35]
    v_and_b32_dpp v24, v15, v20 row_newbcast:0 row_mask:0xf bank_mask:0xf
    v_and_b32_dpp v25, v15, v21 row_newbcast:0 row_mask:0xf bank_mask:0xf
    v_and_b32_dpp v26, v15, v22 row_newbcast:0 row_mask:0xf bank_mask:0xf
    v_and_b32_dpp v27, v15, v23 row_newbcast:0 row_mask:0xf bank_mask:0xf
    s_waitcnt vmcnt(3)
    s_bitcmp0_b32 s14, 16
    s_cbranch_scc1 L_sf_63
    s_waitcnt vmcnt(2)
    s_bitcmp0_b32 s15, 16
    s_cbranch_scc1 L_sf_63
    s_waitcnt vmcnt(1)
L_sf_63:
    buffer_load_dwordx4 v[104:107], v1, s[52:55], s97 offen offset:0 nt
    v_mfma_f32_16x16x32_bf16 v[32:35], v[24:27], v[88:91], v[32:35]
    v_and_b32_dpp v28, v15, v20 row_newbcast:8 row_mask:0xf bank_mask:0xf
    v_and_b32_dpp v29, v15, v21 row_newbcast:8 row_mask:0xf bank_mask:0xf
    v_and_b32_dpp v30, v15, v22 row_newbcast:8 row_mask:0xf bank_mask:0xf
    v_and_b32_dpp v31, v15, v23 row_newbcast:8 row_mask:0xf bank_mask:0xf
    s_waitcnt vmcnt(3)
    s_bitcmp0_b32 s14, 17
    s_cbranch_scc1 L_sf_64
    s_waitcnt vmcnt(2)
    s_bitcmp0_b32 s15, 17
    s_cbranch_scc1 L_sf_64
    s_waitcnt vmcnt(1)
L_sf_64:
    buffer_load_dwordx4 v[108:111], v1, s[52:55], s97 offen offset:1024 nt
    v_mfma_f32_16x16x32_bf16 v[32:35], v[28:31], v[92:95], v[32:35]
    v_and_b32_dpp v24, v15, v20 row_newbcast:4 row_mask:0xf bank_mask:0xf
    v_and_b32_dpp v25, v15, v21 row_newbcast:4 row_mask:0xf bank_mask:0xf
    v_and_b32_dpp v26, v15, v22 row_newbcast:4 row_mask:0xf bank_mask:0xf
    v_and_b32_dpp v27, v15, v23 row_newbcast:4 row_mask:0xf bank_mask:0xf
    s_waitcnt vmcnt(3)
    s_bitcmp0_b32 s14, 18
    s_cbranch_scc1 L_sf_65
    s_waitcnt vmcnt(2)
    s_bitcmp0_b32 s15, 18
    s_cbranch_scc1 L_sf_65
    s_waitcnt vmcnt(1)
L_sf_65:
    buffer_load_dwordx4 v[112:115], v1, s[52:55], s97 offen offset:2048 nt
    v_mfma_f32_16x16x32_bf16 v[32:35], v[24:27], v[96:99], v[32:35]
    v_and_b32_dpp v28, v15, v20 row_newbcast:12 row_mask:0xf bank_mask:0xf
    v_and_b32_dpp v29, v15, v21 row_newbcast:12 row_mask:0xf bank_mask:0xf
    v_and_b32_dpp v30, v15, v22 row_newbcast:12 row_mask:0xf bank_mask:0xf
    v_and_b32_dpp v31, v15, v23 row_newbcast:12 row_mask:0xf bank_mask:0xf
    s_waitcnt vmcnt(3)
    s_bitcmp0_b32 s14, 19
    s_cbranch_scc1 L_sf_66
    s_waitcnt vmcnt(2)
    s_bitcmp0_b32 s15, 19
    s_cbranch_scc1 L_sf_66
    s_waitcnt vmcnt(1)
L_sf_66:
    buffer_load_dwordx4 v[116:119], v1, s[52:55], s97 offen offset:3072 nt
    s_add_u32 s97, s97, 32768
    v_mfma_f32_16x16x32_bf16 v[32:35], v[28:31], v[100:103], v[32:35]
    v_and_b32_dpp v24, v16, v20 row_newbcast:0 row_mask:0xf bank_mask:0xf
    v_and_b32_dpp v25, v16, v21 row_newbcast:0 row_mask:0xf bank_mask:0xf
    v_and_b32_dpp v26, v16, v22 row_newbcast:0 row_mask:0xf bank_mask:0xf
    v_and_b32_dpp v27, v16, v23 row_newbcast:0 row_mask:0xf bank_mask:0xf
    s_waitcnt vmcnt(3)
    s_bitcmp0_b32 s14, 20
    s_cbranch_scc1 L_sf_67
    s_waitcnt vmcnt(2)
    s_bitcmp0_b32 s15, 20
    s_cbranch_scc1 L_sf_67
    s_waitcnt vmcnt(1)
L_sf_67:
    buffer_load_dwordx4 v[120:123], v1, s[52:55], s97 offen offset:0 nt
    v_mfma_f32_16x16x32_bf16 v[32:35], v[24:27], v[104:107], v[32:35]
    v_and_b32_dpp v28, v16, v20 row_newbcast:8 row_mask:0xf bank_mask:0xf
    v_and_b32_dpp v29, v16, v21 row_newbcast:8 row_mask:0xf bank_mask:0xf
    v_and_b32_dpp v30, v16, v22 row_newbcast:8 row_mask:0xf bank_mask:0xf
    v_and_b32_dpp v31, v16, v23 row_newbcast:8 row_mask:0xf bank_mask:0xf
    s_waitcnt vmcnt(3)
    s_bitcmp0_b32 s14, 21
    s_cbranch_scc1 L_sf_68
    s_waitcnt vmcnt(2)
    s_bitcmp0_b32 s15, 21
    s_cbranch_scc1 L_sf_68
    s_waitcnt vmcnt(1)
L_sf_68:
    buffer_load_dwordx4 v[124:127], v1, s[52:55], s97 offen offset:1024 nt
    v_mfma_f32_16x16x32_bf16 v[32:35], v[28:31], v[108:111], v[32:35]
    v_and_b32_dpp v24, v16, v20 row_newbcast:4 row_mask:0xf bank_mask:0xf
    v_and_b32_dpp v25, v16, v21 row_newbcast:4 row_mask:0xf bank_mask:0xf
    v_and_b32_dpp v26, v16, v22 row_newbcast:4 row_mask:0xf bank_mask:0xf
    v_and_b32_dpp v27, v16, v23 row_newbcast:4 row_mask:0xf bank_mask:0xf
    s_waitcnt vmcnt(3)
    s_bitcmp0_b32 s14, 22
    s_cbranch_scc1 L_sf_69
    s_waitcnt vmcnt(2)
    s_bitcmp0_b32 s15, 22
    s_cbranch_scc1 L_sf_69
    s_waitcnt vmcnt(1)
L_sf_69:
    buffer_load_dwordx4 v[128:131], v1, s[52:55], s97 offen offset:2048 nt
    v_mfma_f32_16x16x32_bf16 v[32:35], v[24:27], v[112:115], v[32:35]
    v_and_b32_dpp v28, v16, v20 row_newbcast:12 row_mask:0xf bank_mask:0xf
    v_and_b32_dpp v29, v16, v21 row_newbcast:12 row_mask:0xf bank_mask:0xf
    v_and_b32_dpp v30, v16, v22 row_newbcast:12 row_mask:0xf bank_mask:0xf
    v_and_b32_dpp v31, v16, v23 row_newbcast:12 row_mask:0xf bank_mask:0xf
    s_waitcnt vmcnt(3)
    s_bitcmp0_b32 s14, 23
    s_cbranch_scc1 L_sf_70
    s_waitcnt vmcnt(2)
    s_bitcmp0_b32 s15, 23
    s_cbranch_scc1 L_sf_70
    s_waitcnt vmcnt(1)
L_sf_70:
    buffer_load_dwordx4 v[132:135], v1, s[52:55], s97 offen offset:3072 nt
    s_add_u32 s97, s97, 32768
    buffer_load_dwordx2 v[8:9], v2, s[40:43], s99 offen sc1
    s_lshl_b32 s98, s34, 5
    s_add_u32 s98, s98, s35
    s_lshl_b32 s98, s98, 8
    s_add_u32 s98, s98, 81920
    s_cmp_lg_u32 s13, 0
    s_cselect_b32 s98, s13, s98
    v_lshlrev_b32 v39, 2, v0
    buffer_load_dword v10, v39, s[40:43], s98 offen sc1
    v_and_b32 v38, 31, v0
    v_lshlrev_b32 v38, 2, v38
    s_lshl_b32 s63, s34, 7
    s_add_u32 s63, s63, 204800
    buffer_load_dword v11, v38, s[40:43], s63 offen sc1
    v_mfma_f32_16x16x32_bf16 v[32:35], v[28:31], v[116:119], v[32:35]
    v_and_b32_dpp v24, v17, v20 row_newbcast:0 row_mask:0xf bank_mask:0xf
    v_and_b32_dpp v25, v17, v21 row_newbcast:0 row_mask:0xf bank_mask:0xf
    v_and_b32_dpp v26, v17, v22 row_newbcast:0 row_mask:0xf bank_mask:0xf
    v_and_b32_dpp v27, v17, v23 row_newbcast:0 row_mask:0xf bank_mask:0xf
    s_waitcnt vmcnt(6)
    s_bitcmp0_b32 s14, 24
    s_cbranch_scc1 L_sf_71
    s_waitcnt vmcnt(5)
    s_bitcmp0_b32 s15, 24
    s_cbranch_scc1 L_sf_71
    s_waitcnt vmcnt(4)
L_sf_71:
    buffer_load_dwordx4 v[136:139], v1, s[52:55], s97 offen offset:0 nt
    v_mfma_f32_16x16x32_bf16 v[32:35], v[24:27], v[120:123], v[32:35]
    s_or_b32 s96, s59, s39
    s_cbranch_scc0 L_nofrag_72
    v_mov_b32 v104, 162060
L_lw_73:
    ds_read_b32 v105, v104
    s_waitcnt lgkmcnt(0)
    v_cmp_gt_u32 vcc, 4, v105
    s_cbranch_vccz L_lw_73e
    s_sleep 2
    s_sub_u32 s60, s60, 1
    s_cbranch_scc0 L_lw_73
    s_mov_b32 s60, 0
L_lw_73e:
    s_cmp_eq_u32 s59, 0
    s_cbranch_scc1 L_nofrag_72
    v_lshrrev_b32 v109, 4, v0
    v_bfe_u32 v104, v0, 1, 1
    v_lshl_add_u32 v104, v109, 1, v104
    v_bfe_u32 v110, v0, 2, 2
    v_lshl_add_u32 v104, v104, 3, v110
    v_lshlrev_b32 v104, 7, v104
    v_and_b32 v110, 1, v0
    v_lshl_add_u32 v104, v110, 3, v104
    s_lshl_b32 s96, s3, 13
    s_add_u32 s96, s96, 81920
    v_add_u32 v104, s96, v104
    ds_read_b64_tr_b16 v[72:73], v104 offset:0
    ds_read_b64_tr_b16 v[74:75], v104 offset:512
    ds_read_b64_tr_b16 v[76:77], v104 offset:16
    ds_read_b64_tr_b16 v[78:79], v104 offset:528
    ds_read_b64_tr_b16 v[80:81], v104 offset:32
    ds_read_b64_tr_b16 v[82:83], v104 offset:544
    ds_read_b64_tr_b16 v[84:85], v104 offset:48
    ds_read_b64_tr_b16 v[86:87], v104 offset:560
    ds_read_b64_tr_b16 v[88:89], v104 offset:64
    ds_read_b64_tr_b16 v[90:91], v104 offset:576
    ds_read_b64_tr_b16 v[92:93], v104 offset:80
    ds_read_b64_tr_b16 v[94:95], v104 offset:592
    ds_read_b64_tr_b16 v[96:97], v104 offset:96
    ds_read_b64_tr_b16 v[98:99], v104 offset:608
    ds_read_b64_tr_b16 v[100:101], v104 offset:112
    ds_read_b64_tr_b16 v[102:103], v104 offset:624
    v_bfe_u32 v105, v0, 1, 3
    v_lshlrev_b32 v105, 8, v105
    v_lshl_add_u32 v105, v109, 5, v105
    v_lshl_add_u32 v105, v110, 4, v105
    v_mul_u32_u24 v106, 320, v109
    v_bfe_u32 v110, v0, 3, 1
    v_mul_u32_u24 v110, 160, v110
    v_add_u32 v106, v106, v110
    v_and_b32 v110, 7, v0
    v_lshl_add_u32 v107, v110, 4, v106
    v_add_u32 v107, 81920, v107
    v_lshl_add_u32 v106, v110, 2, v106
    v_add_u32 v106, s96, v106
    v_mul_u32_u24 v108, 1280, v109
    v_add_u32 v108, v108, v2
    s_lshr_b32 s96, s3, 1
    s_lshl_b32 s96, s96, 11
    s_and_b32 s100, s3, 1
    s_lshl_b32 s100, s100, 7
    s_add_u32 s100, s100, s96
    s_lshl_b32 s96, s34, 13
    s_add_u32 s100, s100, s96
    s_add_u32 s100, s100, 81920
    s_mul_i32 s101, s34, 5120
    s_lshl_b32 s96, s35, 7
    s_add_u32 s101, s101, s96
    s_add_u32 s101, s101, 144640
L_nofrag_72:
    v_and_b32_dpp v28, v17, v20 row_newbcast:8 row_mask:0xf bank_mask:0xf
    v_and_b32_dpp v29, v17, v21 row_newbcast:8 row_mask:0xf bank_mask:0xf
    v_and_b32_dpp v30, v17, v22 row_newbcast:8 row_mask:0xf bank_mask:0xf
    v_and_b32_dpp v31, v17, v23 row_newbcast:8 row_mask:0xf bank_mask:0xf
    s_waitcnt vmcnt(6)
    s_bitcmp0_b32 s14, 25
    s_cbranch_scc1 L_sf_74
    s_waitcnt vmcnt(5)
    s_bitcmp0_b32 s15, 25
    s_cbranch_scc1 L_sf_74
    s_waitcnt vmcnt(4)
L_sf_74:
    buffer_load_dwordx4 v[140:143], v1, s[52:55], s97 offen offset:1024 nt
    v_mfma_f32_16x16x32_bf16 v[32:35], v[28:31], v[124:127], v[32:35]
    v_and_b32_dpp v24, v17, v20 row_newbcast:4 row_mask:0xf bank_mask:0xf
    v_and_b32_dpp v25, v17, v21 row_newbcast:4 row_mask:0xf bank_mask:0xf
    v_and_b32_dpp v26, v17, v22 row_newbcast:4 row_mask:0xf bank_mask:0xf
    v_and_b32_dpp v27, v17, v23 row_newbcast:4 row_mask:0xf bank_mask:0xf
    s_waitcnt vmcnt(6)
    s_bitcmp0_b32 s14, 26
    s_cbranch_scc1 L_sf_75
    s_waitcnt vmcnt(5)
    s_bitcmp0_b32 s15, 26
    s_cbranch_scc1 L_sf_75
    s_waitcnt vmcnt(1)
L_sf_75:
    buffer_load_dwordx4 v[144:147], v1, s[52:55], s97 offen offset:2048 nt
    v_mfma_f32_16x16x32_bf16 v[32:35], v[24:27], v[128:131], v[32:35]
    v_and_b32_dpp v28, v17, v20 row_newbcast:12 row_mask:0xf bank_mask:0xf
    v_and_b32_dpp v29, v17, v21 row_newbcast:12 row_mask:0xf bank_mask:0xf
    v_and_b32_dpp v30, v17, v22 row_newbcast:12 row_mask:0xf bank_mask:0xf
    v_and_b32_dpp v31, v17, v23 row_newbcast:12 row_mask:0xf bank_mask:0xf
    s_waitcnt vmcnt(6)
    s_bitcmp0_b32 s14, 27
    s_cbranch_scc1 L_sf_76
    s_waitcnt vmcnt(2)
    s_bitcmp0_b32 s15, 27
    s_cbranch_scc1 L_sf_76
    s_waitcnt vmcnt(1)
L_sf_76:
    buffer_load_dwordx4 v[148:151], v1, s[52:55], s97 offen offset:3072 nt
    s_add_u32 s97, s97, 32768
    v_mfma_f32_16x16x32_bf16 v[32:35], v[28:31], v[132:135], v[32:35]
    v_and_b32_dpp v24, v18, v20 row_newbcast:0 row_mask:0xf bank_mask:0xf
    v_and_b32_dpp v25, v18, v21 row_newbcast:0 row_mask:0xf bank_mask:0xf
    v_and_b32_dpp v26, v18, v22 row_newbcast:0 row_mask:0xf bank_mask:0xf
    v_and_b32_dpp v27, v18, v23 row_newbcast:0 row_mask:0xf bank_mask:0xf
    s_waitcnt vmcnt(3)
    s_bitcmp0_b32 s14, 28
    s_cbranch_scc1 L_sf_77
    s_waitcnt vmcnt(2)
    s_bitcmp0_b32 s15, 28
    s_cbranch_scc1 L_sf_77
    s_waitcnt vmcnt(1)
L_sf_77:
    buffer_load_dwordx4 v[152:155], v1, s[52:55], s97 offen offset:0 nt
    v_mfma_f32_16x16x32_bf16 v[32:35], v[24:27], v[136:139], v[32:35]
    v_and_b32_dpp v28, v18, v20 row_newbcast:8 row_mask:0xf bank_mask:0xf
    v_and_b32_dpp v29, v18, v21 row_newbcast:8 row_mask:0xf bank_mask:0xf
    v_and_b32_dpp v30, v18, v22 row_newbcast:8 row_mask:0xf bank_mask:0xf
    v_and_b32_dpp v31, v18, v23 row_newbcast:8 row_mask:0xf bank_mask:0xf
    s_waitcnt vmcnt(3)
    s_bitcmp0_b32 s14, 29
    s_cbranch_scc1 L_sf_78
    s_waitcnt vmcnt(2)
    s_bitcmp0_b32 s15, 29
    s_cbranch_scc1 L_sf_78
    s_waitcnt vmcnt(1)
L_sf_78:
    buffer_load_dwordx4 v[156:159], v1, s[52:55], s97 offen offset:1024 nt
    v_mfma_f32_16x16x32_bf16 v[32:35], v[28:31], v[140:143], v[32:35]
    v_max_u32 v38, v8, v9
    v_cmp_eq_u32 vcc, -1, v38
    s_cbranch_vccnz L_mlslow
L_mlok:
    v_mov_b32 v37, v8
    s_nop 1
    v_max_f32_dpp v37, v37, v37 quad_perm:[1,0,3,2] row_mask:0xf bank_mask:0xf
    s_nop 1
    v_max_f32_dpp v37, v37, v37 quad_perm:[2,3,0,1] row_mask:0xf bank_mask:0xf
    s_nop 1
    v_max_f32_dpp v37, v37, v37 row_ror:4 row_mask:0xf bank_mask:0xf
    s_nop 1
    v_max_f32_dpp v37, v37, v37 row_ror:8 row_mask:0xf bank_mask:0xf
    v_sub_f32 v8, v8, v37
    v_sub_f32 v3, v3, v37
    v_exp_f32 v8, v8
    v_exp_f32 v3, v3
    v_mul_f32 v8, v8, v9
    s_nop 1
    v_add_f32_dpp v8, v8, v8 quad_perm:[1,0,3,2] row_mask:0xf bank_mask:0xf
    s_nop 1
    v_add_f32_dpp v8, v8, v8 quad_perm:[2,3,0,1] row_mask:0xf bank_mask:0xf
    s_nop 1
    v_add_f32_dpp v8, v8, v8 row_ror:4 row_mask:0xf bank_mask:0xf
    s_nop 1
    v_add_f32_dpp v8, v8, v8 row_ror:8 row_mask:0xf bank_mask:0xf
    v_rcp_f32 v8, v8
    s_nop 0
    v_mul_f32 v3, v3, v8
    s_getreg_b32 s62, hwreg(HW_REG_XCC_ID, 0, 4)
    v_cmp_ne_u32 vcc, s62, v11
    s_nop 0
    s_cmp_eq_u64 vcc, 0
    s_cselect_b32 s61, 1, 0
    v_lshrrev_b32 v9, 4, v0
    v_lshl_add_u32 v8, v9, 2, v2
    s_lshl_b32 s96, s3, 9
    s_add_u32 s96, s96, 157824
    v_lshl_add_u32 v8, v8, 2, s96
    v_lshlrev_b32 v9, 3, v0
    v_add_u32 v9, 157824, v9
    v_mov_b32 v10, 162048
    v_mov_b32 v11, 1
    v_and_b32_dpp v24, v18, v20 row_newbcast:4 row_mask:0xf bank_mask:0xf
    v_and_b32_dpp v25, v18, v21 row_newbcast:4 row_mask:0xf bank_mask:0xf
    v_and_b32_dpp v26, v18, v22 row_newbcast:4 row_mask:0xf bank_mask:0xf
    v_and_b32_dpp v27, v18, v23 row_newbcast:4 row_mask:0xf bank_mask:0xf
    s_waitcnt vmcnt(3)
    s_bitcmp0_b32 s14, 30
    s_cbranch_scc1 L_sf_79
    s_waitcnt vmcnt(2)
    s_bitcmp0_b32 s15, 30
    s_cbranch_scc1 L_sf_79
    s_waitcnt vmcnt(1)
L_sf_79:
    buffer_load_dwordx4 v[160:163], v1, s[52:55], s97 offen offset:2048 nt
    v_mfma_f32_16x16x32_bf16 v[32:35], v[24:27], v[144:147], v[32:35]
    v_and_b32_dpp v28, v18, v20 row_newbcast:12 row_mask:0xf bank_mask:0xf
    v_and_b32_dpp v29, v18, v21 row_newbcast:12 row_mask:0xf bank_mask:0xf
    v_and_b32_dpp v30, v18, v22 row_newbcast:12 row_mask:0xf bank_mask:0xf
    v_and_b32_dpp v31, v18, v23 row_newbcast:12 row_mask:0xf bank_mask:0xf
    s_waitcnt vmcnt(3)
    s_bitcmp0_b32 s14, 31
    s_cbranch_scc1 L_sf_80
    s_waitcnt vmcnt(2)
    s_bitcmp0_b32 s15, 31
    s_cbranch_scc1 L_sf_80
    s_waitcnt vmcnt(1)
L_sf_80:
    buffer_load_dwordx4 v[164:167], v1, s[52:55], s97 offen offset:3072 nt
    s_mov_b32 s97, 0
    v_mfma_f32_16x16x32_bf16 v[32:35], v[28:31], v[148:151], v[32:35]
    s_cmp_eq_u32 s12, -1
    s_cbranch_scc1 L_v_nopf
    v_and_b32_dpp v24, v19, v20 row_newbcast:0 row_mask:0xf bank_mask:0xf
    v_and_b32_dpp v25, v19, v21 row_newbcast:0 row_mask:0xf bank_mask:0xf
    v_and_b32_dpp v26, v19, v22 row_newbcast:0 row_mask:0xf bank_mask:0xf
    v_and_b32_dpp v27, v19, v23 row_newbcast:0 row_mask:0xf bank_mask:0xf
    s_waitcnt vmcnt(3)
    s_nop 0
    v_mfma_f32_16x16x32_bf16 v[32:35], v[24:27], v[152:155], v[32:35]
    v_and_b32_dpp v28, v19, v20 row_newbcast:8 row_mask:0xf bank_mask:0xf
    v_and_b32_dpp v29, v19, v21 row_newbcast:8 row_mask:0xf bank_mask:0xf
    v_and_b32_dpp v30, v19, v22 row_newbcast:8 row_mask:0xf bank_mask:0xf
    v_and_b32_dpp v31, v19, v23 row_newbcast:8 row_mask:0xf bank_mask:0xf
    s_waitcnt vmcnt(2)
    s_nop 0
    v_mfma_f32_16x16x32_bf16 v[32:35], v[28:31], v[156:159], v[32:35]
    v_and_b32_dpp v24, v19, v20 row_newbcast:4 row_mask:0xf bank_mask:0xf
    v_and_b32_dpp v25, v19, v21 row_newbcast:4 row_mask:0xf bank_mask:0xf
    v_and_b32_dpp v26, v19, v22 row_newbcast:4 row_mask:0xf bank_mask:0xf
    v_and_b32_dpp v27, v19, v23 row_newbcast:4 row_mask:0xf bank_mask:0xf
    s_waitcnt vmcnt(1)
    s_nop 0
    v_mfma_f32_16x16x32_bf16 v[32:35], v[24:27], v[160:163], v[32:35]
    v_and_b32_dpp v28, v19, v20 row_newbcast:12 row_mask:0xf bank_mask:0xf
    v_and_b32_dpp v29, v19, v21 row_newbcast:12 row_mask:0xf bank_mask:0xf
    v_and_b32_dpp v30, v19, v22 row_newbcast:12 row_mask:0xf bank_mask:0xf
    v_and_b32_dpp v31, v19, v23 row_newbcast:12 row_mask:0xf bank_mask:0xf
    s_waitcnt vmcnt(0)
    s_nop 0
    v_mfma_f32_16x16x32_bf16 v[32:35], v[28:31], v[164:167], v[32:35]
L_v_join:
    s_cmp_lg_u32 s13, 0
    s_nop 6
    v_mul_f32 v32, v32, v3
    v_mul_f32 v33, v33, v3
    v_mul_f32 v34, v34, v3
    v_mul_f32 v35, v35, v3
    s_cbranch_scc1 L_jobend
L_t0:
    s_mov_b32 exec_hi, 0
    ds_write_b128 v8, v[32:35]
    s_mov_b64 exec, 1
    ds_add_rtn_u32 v37, v10, v11
    s_mov_b64 exec, -1
    ds_read_b64 v[144:145], v9 offset:0
    ds_read_b64 v[146:147], v9 offset:512
    ds_read_b64 v[148:149], v9 offset:1024
    ds_read_b64 v[150:151], v9 offset:1536
    ds_read_b64 v[152:153], v9 offset:2048
    ds_read_b64 v[154:155], v9 offset:2560
    ds_read_b64 v[156:157], v9 offset:3072
    ds_read_b64 v[158:159], v9 offset:3584
    s_waitcnt lgkmcnt(8)
    v_readfirstlane_b32 s96, v37
    s_nop 0
    s_cmp_lg_u32 s96, 7
    s_cbranch_scc1 L_nopub
    s_waitcnt lgkmcnt(6)
    v_pk_add_f32 v[144:145], v[144:145], v[146:147]
    s_waitcnt lgkmcnt(4)
    v_pk_add_f32 v[148:149], v[148:149], v[150:151]
    s_waitcnt lgkmcnt(2)
    v_pk_add_f32 v[152:153], v[152:153], v[154:155]
    v_pk_add_f32 v[144:145], v[144:145], v[148:149]
    s_waitcnt lgkmcnt(0)
    v_pk_add_f32 v[156:157], v[156:157], v[158:159]
    v_pk_add_f32 v[144:145], v[144:145], v[152:153]
    v_pk_add_f32 v[144:145], v[144:145], v[156:157]
    v_cvt_pk_bf16_f32 v32, v144, v145
    s_cmp_eq_u32 s61, 1
    s_cbranch_scc1 L_st_89f
    buffer_store_dword v32, v39, s[40:43], s98 offen sc1
    s_branch L_st_89e
L_st_89f:
    buffer_store_dword v32, v39, s[40:43], s98 offen
L_st_89e:
L_nopub:
    s_cmp_eq_u32 s59, 0
    s_cbranch_scc1 L_not1
L_poll_90:
    buffer_load_dwordx4 v[16:19], v105, s[40:43], s100 offen sc1
    s_waitcnt vmcnt(0)
    v_max3_u32 v38, v16, v17, v18
    v_max_u32 v38, v38, v19
    v_cmp_eq_u32 vcc, -1, v38
    s_cbranch_vccz L_poll_90e
    s_sub_u32 s60, s60, 1
    s_cbranch_scc0 L_poll_90
    s_mov_b32 s60, 0
L_poll_90e:
    v_mfma_f32_16x16x32_bf16 v[112:115], v[16:19], v[72:75], 0
    v_mfma_f32_16x16x32_bf16 v[128:131], v[16:19], v[88:91], 0
    v_mfma_f32_16x16x32_bf16 v[116:119], v[16:19], v[76:79], 0
    v_mfma_f32_16x16x32_bf16 v[132:135], v[16:19], v[92:95], 0
    v_mfma_f32_16x16x32_bf16 v[120:123], v[16:19], v[80:83], 0
    v_mfma_f32_16x16x32_bf16 v[136:139], v[16:19], v[96:99], 0
    v_mfma_f32_16x16x32_bf16 v[124:127], v[16:19], v[84:87], 0
    v_mfma_f32_16x16x32_bf16 v[140:143], v[16:19], v[100:103], 0
    s_nop 0
    v_pk_add_f32 v[112:113], v[112:113], v[114:115]
    v_pk_add_f32 v[128:129], v[128:129], v[130:131]
    v_pk_add_f32 v[116:117], v[116:117], v[118:119]
    v_pk_add_f32 v[132:133], v[132:133], v[134:135]
    v_add_f32_dpp v12, v113, v112 row_ror:8 row_mask:0xf bank_mask:0x3
    v_add_f32_dpp v12, v128, v129 row_ror:8 row_mask:0xf bank_mask:0xc
    ds_write_b32 v106, v12 offset:0
    v_pk_add_f32 v[120:121], v[120:121], v[122:123]
    v_pk_add_f32 v[136:137], v[136:137], v[138:139]
    v_add_f32_dpp v13, v117, v116 row_ror:8 row_mask:0xf bank_mask:0x3
    v_add_f32_dpp v13, v132, v133 row_ror:8 row_mask:0xf bank_mask:0xc
    ds_write_b32 v106, v13 offset:32
    v_pk_add_f32 v[124:125], v[124:125], v[126:127]
    v_pk_add_f32 v[140:141], v[140:141], v[142:143]
    v_add_f32_dpp v14, v121, v120 row_ror:8 row_mask:0xf bank_mask:0x3
    v_add_f32_dpp v14, v136, v137 row_ror:8 row_mask:0xf bank_mask:0xc
    ds_write_b32 v106, v14 offset:64
    v_add_f32_dpp v15, v125, v124 row_ror:8 row_mask:0xf bank_mask:0x3
    v_add_f32_dpp v15, v140, v141 row_ror:8 row_mask:0xf bank_mask:0xc
    ds_write_b32 v106, v15 offset:96
    s_mov_b64 exec, 1
    ds_add_rtn_u32 v37, v10, v11 offset:4
    s_mov_b64 exec, -1
    ds_read_b128 v[72:75], v107 offset:0
    ds_read_b128 v[76:79], v107 offset:8192
    ds_read_b128 v[80:83], v107 offset:16384
    ds_read_b128 v[84:87], v107 offset:24576
    ds_read_b128 v[88:91], v107 offset:32768
    ds_read_b128 v[92:95], v107 offset:40960
    ds_read_b128 v[96:99], v107 offset:49152
    ds_read_b128 v[100:103], v107 offset:57344
    s_waitcnt lgkmcnt(8)
    v_readfirstlane_b32 s96, v37
    s_nop 0
    s_cmp_lg_u32 s96, 7
    s_cbranch_scc1 L_not1
    s_waitcnt lgkmcnt(6)
    v_pk_add_f32 v[72:73], v[72:73], v[76:77]
    v_pk_add_f32 v[74:75], v[74:75], v[78:79]
    s_waitcnt lgkmcnt(4)
    v_pk_add_f32 v[80:81], v[80:81], v[84:85]
    v_pk_add_f32 v[82:83], v[82:83], v[86:87]
    v_pk_add_f32 v[72:73], v[72:73], v[80:81]
    v_pk_add_f32 v[74:75], v[74:75], v[82:83]
    s_waitcnt lgkmcnt(2)
    v_pk_add_f32 v[88:89], v[88:89], v[92:93]
    v_pk_add_f32 v[90:91], v[90:91], v[94:95]
    v_pk_add_f32 v[72:73], v[72:73], v[88:89]
    v_pk_add_f32 v[74:75], v[74:75], v[90:91]
    s_waitcnt lgkmcnt(0)
    v_pk_add_f32 v[96:97], v[96:97], v[100:101]
    v_pk_add_f32 v[98:99], v[98:99], v[102:103]
    v_pk_add_f32 v[72:73], v[72:73], v[96:97]
    v_pk_add_f32 v[74:75], v[74:75], v[98:99]
    v_cvt_pk_bf16_f32 v12, v72, v73
    v_cvt_pk_bf16_f32 v13, v74, v75
    buffer_store_dwordx2 v[12:13], v108, s[40:43], s101 offen sc1
L_not1:
    s_waitcnt lgkmcnt(0)
    s_cmp_eq_u32 s39, 1
    s_cbranch_scc1 L_s_role
    s_endpgm
L_k_nopf:
    s_waitcnt vmcnt(3)
    s_bitcmp0_b32 s57, 22
    s_cbranch_scc1 L_sf_45
    s_waitcnt vmcnt(2)
    s_bitcmp0_b32 s58, 22
    s_cbranch_scc1 L_sf_45
    s_waitcnt vmcnt(1)
L_sf_45:
    buffer_load_dwordx4 v[128:131], v1, s[48:51], s97 offen offset:2048 nt
    buffer_load_dword v37, v36, s[44:47], 0 offen sc1
    s_waitcnt vmcnt(4)
    s_bitcmp0_b32 s57, 23
    s_cbranch_scc1 L_sf_46
    s_waitcnt vmcnt(3)
    s_bitcmp0_b32 s58, 23
    s_cbranch_scc1 L_sf_46
    s_waitcnt vmcnt(2)
L_sf_46:
    buffer_load_dwordx4 v[132:135], v1, s[48:51], s97 offen offset:3072 nt
    s_add_u32 s97, s97, 32768
    s_waitcnt vmcnt(4)
    s_bitcmp0_b32 s57, 24
    s_cbranch_scc1 L_sf_47
    s_waitcnt vmcnt(3)
    s_bitcmp0_b32 s58, 24
    s_cbranch_scc1 L_sf_47
    s_waitcnt vmcnt(2)
L_sf_47:
    buffer_load_dwordx4 v[136:139], v1, s[48:51], s97 offen offset:0 nt
    s_waitcnt vmcnt(4)
    s_bitcmp0_b32 s57, 25
    s_cbranch_scc1 L_sf_48
    s_waitcnt vmcnt(3)
    s_bitcmp0_b32 s58, 25
    s_cbranch_scc1 L_sf_48
    s_waitcnt vmcnt(1)
L_sf_48:
    buffer_load_dwordx4 v[140:143], v1, s[48:51], s97 offen offset:1024 nt
    s_waitcnt vmcnt(4)
    s_bitcmp0_b32 s57, 26
    s_cbranch_scc1 L_sf_49
    s_waitcnt vmcnt(2)
    s_bitcmp0_b32 s58, 26
    s_cbranch_scc1 L_sf_49
    s_waitcnt vmcnt(1)
L_sf_49:
    buffer_load_dwordx4 v[144:147], v1, s[48:51], s97 offen offset:2048 nt
    s_waitcnt vmcnt(3)
    s_bitcmp0_b32 s57, 27
    s_cbranch_scc1 L_sf_50
    s_waitcnt vmcnt(2)
    s_bitcmp0_b32 s58, 27
    s_cbranch_scc1 L_sf_50
    s_waitcnt vmcnt(1)
L_sf_50:
    buffer_load_dwordx4 v[148:151], v1, s[48:51], s97 offen offset:3072 nt
    s_add_u32 s97, s97, 32768
    v_readfirstlane_b32 s96, v37
    buffer_load_dwordx4 v[4:7], v2, s[40:43], s98 offen sc1
    s_waitcnt vmcnt(4)
    s_bitcmp0_b32 s57, 28
    s_cbranch_scc1 L_sf_51
    s_waitcnt vmcnt(3)
    s_bitcmp0_b32 s58, 28
    s_cbranch_scc1 L_sf_51
    s_waitcnt vmcnt(2)
L_sf_51:
    buffer_load_dwordx4 v[152:155], v1, s[48:51], s97 offen offset:0 nt
    s_waitcnt vmcnt(4)
    s_bitcmp0_b32 s57, 29
    s_cbranch_scc1 L_sf_52
    s_waitcnt vmcnt(3)
    s_bitcmp0_b32 s58, 29
    s_cbranch_scc1 L_sf_52
    s_waitcnt vmcnt(2)
L_sf_52:
    buffer_load_dwordx4 v[156:159], v1, s[48:51], s97 offen offset:1024 nt
    s_waitcnt vmcnt(4)
    s_bitcmp0_b32 s57, 30
    s_cbranch_scc1 L_sf_53
    s_waitcnt vmcnt(3)
    s_bitcmp0_b32 s58, 30
    s_cbranch_scc1 L_sf_53
    s_waitcnt vmcnt(1)
L_sf_53:
    buffer_load_dwordx4 v[160:163], v1, s[48:51], s97 offen offset:2048 nt
    s_waitcnt vmcnt(4)
    s_bitcmp0_b32 s57, 31
    s_cbranch_scc1 L_sf_54
    s_waitcnt vmcnt(2)
    s_bitcmp0_b32 s58, 31
    s_cbranch_scc1 L_sf_54
    s_waitcnt vmcnt(1)
L_sf_54:
    buffer_load_dwordx4 v[164:167], v1, s[48:51], s97 offen offset:3072 nt
    s_mov_b32 s97, 0
    s_mov_b32 s97, 65536
    s_branch L_k_join
L_v_nopf:
    v_and_b32_dpp v24, v19, v20 row_newbcast:0 row_mask:0xf bank_mask:0xf
    v_and_b32_dpp v25, v19, v21 row_newbcast:0 row_mask:0xf bank_mask:0xf
    v_and_b32_dpp v26, v19, v22 row_newbcast:0 row_mask:0xf bank_mask:0xf
    v_and_b32_dpp v27, v19, v23 row_newbcast:0 row_mask:0xf bank_mask:0xf
    s_waitcnt vmcnt(3)
    s_bitcmp0_b32 s14, 0
    s_cbranch_scc1 L_sf_81
    s_waitcnt vmcnt(2)
    s_bitcmp0_b32 s15, 0
    s_cbranch_scc1 L_sf_81
    s_waitcnt vmcnt(1)
L_sf_81:
    buffer_load_dwordx4 v[40:43], v1, s[52:55], s97 offen offset:0 nt
    v_mfma_f32_16x16x32_bf16 v[32:35], v[24:27], v[152:155], v[32:35]
    v_and_b32_dpp v28, v19, v20 row_newbcast:8 row_mask:0xf bank_mask:0xf
    v_and_b32_dpp v29, v19, v21 row_newbcast:8 row_mask:0xf bank_mask:0xf
    v_and_b32_dpp v30, v19, v22 row_newbcast:8 row_mask:0xf bank_mask:0xf
    v_and_b32_dpp v31, v19, v23 row_newbcast:8 row_mask:0xf bank_mask:0xf
    s_waitcnt vmcnt(3)
    s_bitcmp0_b32 s14, 1
    s_cbranch_scc1 L_sf_82
    s_waitcnt vmcnt(2)
    s_bitcmp0_b32 s15, 1
    s_cbranch_scc1 L_sf_82
    s_waitcnt vmcnt(1)
L_sf_82:
    buffer_load_dwordx4 v[44:47], v1, s[52:55], s97 offen offset:1024 nt
    v_mfma_f32_16x16x32_bf16 v[32:35], v[28:31], v[156:159], v[32:35]
    v_and_b32_dpp v24, v19, v20 row_newbcast:4 row_mask:0xf bank_mask:0xf
    v_and_b32_dpp v25, v19, v21 row_newbcast:4 row_mask:0xf bank_mask:0xf
    v_and_b32_dpp v26, v19, v22 row_newbcast:4 row_mask:0xf bank_mask:0xf
    v_and_b32_dpp v27, v19, v23 row_newbcast:4 row_mask:0xf bank_mask:0xf
    s_waitcnt vmcnt(3)
    s_bitcmp0_b32 s14, 2
    s_cbranch_scc1 L_sf_83
    s_waitcnt vmcnt(2)
    s_bitcmp0_b32 s15, 2
    s_cbranch_scc1 L_sf_83
    s_waitcnt vmcnt(1)
L_sf_83:
    buffer_load_dwordx4 v[48:51], v1, s[52:55], s97 offen offset:2048 nt
    v_mfma_f32_16x16x32_bf16 v[32:35], v[24:27], v[160:163], v[32:35]
    v_and_b32_dpp v28, v19, v20 row_newbcast:12 row_mask:0xf bank_mask:0xf
    v_and_b32_dpp v29, v19, v21 row_newbcast:12 row_mask:0xf bank_mask:0xf
    v_and_b32_dpp v30, v19, v22 row_newbcast:12 row_mask:0xf bank_mask:0xf
    v_and_b32_dpp v31, v19, v23 row_newbcast:12 row_mask:0xf bank_mask:0xf
    s_waitcnt vmcnt(3)
    s_bitcmp0_b32 s14, 3
    s_cbranch_scc1 L_sf_84
    s_waitcnt vmcnt(2)
    s_bitcmp0_b32 s15, 3
    s_cbranch_scc1 L_sf_84
    s_waitcnt vmcnt(1)
L_sf_84:
    buffer_load_dwordx4 v[52:55], v1, s[52:55], s97 offen offset:3072 nt
    s_add_u32 s97, s97, 32768
    v_mfma_f32_16x16x32_bf16 v[32:35], v[28:31], v[164:167], v[32:35]
    v_and_b32_dpp v24, v12, v20 row_newbcast:0 row_mask:0xf bank_mask:0xf
    v_and_b32_dpp v25, v12, v21 row_newbcast:0 row_mask:0xf bank_mask:0xf
    v_and_b32_dpp v26, v12, v22 row_newbcast:0 row_mask:0xf bank_mask:0xf
    v_and_b32_dpp v27, v12, v23 row_newbcast:0 row_mask:0xf bank_mask:0xf
    s_waitcnt vmcnt(3)
    s_bitcmp0_b32 s14, 4
    s_cbranch_scc1 L_sf_85
    s_waitcnt vmcnt(2)
    s_bitcmp0_b32 s15, 4
    s_cbranch_scc1 L_sf_85
    s_waitcnt vmcnt(1)
L_sf_85:
    buffer_load_dwordx4 v[56:59], v1, s[52:55], s97 offen offset:0 nt
    v_mfma_f32_16x16x32_bf16 v[32:35], v[24:27], v[40:43], v[32:35]
    v_and_b32_dpp v28, v12, v20 row_newbcast:8 row_mask:0xf bank_mask:0xf
    v_and_b32_dpp v29, v12, v21 row_newbcast:8 row_mask:0xf bank_mask:0xf
    v_and_b32_dpp v30, v12, v22 row_newbcast:8 row_mask:0xf bank_mask:0xf
    v_and_b32_dpp v31, v12, v23 row_newbcast:8 row_mask:0xf bank_mask:0xf
    s_waitcnt vmcnt(3)
    s_bitcmp0_b32 s14, 5
    s_cbranch_scc1 L_sf_86
    s_waitcnt vmcnt(2)
    s_bitcmp0_b32 s15, 5
    s_cbranch_scc1 L_sf_86
    s_waitcnt vmcnt(1)
L_sf_86:
    buffer_load_dwordx4 v[60:63], v1, s[52:55], s97 offen offset:1024 nt
    v_mfma_f32_16x16x32_bf16 v[32:35], v[28:31], v[44:47], v[32:35]
    v_and_b32_dpp v24, v12, v20 row_newbcast:4 row_mask:0xf bank_mask:0xf
    v_and_b32_dpp v25, v12, v21 row_newbcast:4 row_mask:0xf bank_mask:0xf
    v_and_b32_dpp v26, v12, v22 row_newbcast:4 row_mask:0xf bank_mask:0xf
    v_and_b32_dpp v27, v12, v23 row_newbcast:4 row_mask:0xf bank_mask:0xf
    s_waitcnt vmcnt(3)
    s_bitcmp0_b32 s14, 6
    s_cbranch_scc1 L_sf_87
    s_waitcnt vmcnt(2)
    s_bitcmp0_b32 s15, 6
    s_cbranch_scc1 L_sf_87
    s_waitcnt vmcnt(1)
L_sf_87:
    buffer_load_dwordx4 v[64:67], v1, s[52:55], s97 offen offset:2048 nt
    v_mfma_f32_16x16x32_bf16 v[32:35], v[24:27], v[48:51], v[32:35]
    v_and_b32_dpp v28, v12, v20 row_newbcast:12 row_mask:0xf bank_mask:0xf
    v_and_b32_dpp v29, v12, v21 row_newbcast:12 row_mask:0xf bank_mask:0xf
    v_and_b32_dpp v30, v12, v22 row_newbcast:12 row_mask:0xf bank_mask:0xf
    v_and_b32_dpp v31, v12, v23 row_newbcast:12 row_mask:0xf bank_mask:0xf
    s_waitcnt vmcnt(3)
    s_bitcmp0_b32 s14, 7
    s_cbranch_scc1 L_sf_88
    s_waitcnt vmcnt(2)
    s_bitcmp0_b32 s15, 7
    s_cbranch_scc1 L_sf_88
    s_waitcnt vmcnt(1)
L_sf_88:
    buffer_load_dwordx4 v[68:71], v1, s[52:55], s97 offen offset:3072 nt
    s_add_u32 s97, s97, 32768
    v_mfma_f32_16x16x32_bf16 v[32:35], v[28:31], v[52:55], v[32:35]
    v_and_b32_dpp v24, v13, v20 row_newbcast:0 row_mask:0xf bank_mask:0xf
    v_and_b32_dpp v25, v13, v21 row_newbcast:0 row_mask:0xf bank_mask:0xf
    v_and_b32_dpp v26, v13, v22 row_newbcast:0 row_mask:0xf bank_mask:0xf
    v_and_b32_dpp v27, v13, v23 row_newbcast:0 row_mask:0xf bank_mask:0xf
    s_waitcnt vmcnt(3)
    s_nop 0
    v_mfma_f32_16x16x32_bf16 v[32:35], v[24:27], v[56:59], v[32:35]
    v_and_b32_dpp v28, v13, v20 row_newbcast:8 row_mask:0xf bank_mask:0xf
    v_and_b32_dpp v29, v13, v21 row_newbcast:8 row_mask:0xf bank_mask:0xf
    v_and_b32_dpp v30, v13, v22 row_newbcast:8 row_mask:0xf bank_mask:0xf
    v_and_b32_dpp v31, v13, v23 row_newbcast:8 row_mask:0xf bank_mask:0xf
    s_waitcnt vmcnt(2)
    s_nop 0
    v_mfma_f32_16x16x32_bf16 v[32:35], v[28:31], v[60:63], v[32:35]
    v_and_b32_dpp v24, v13, v20 row_newbcast:4 row_mask:0xf bank_mask:0xf
    v_and_b32_dpp v25, v13, v21 row_newbcast:4 row_mask:0xf bank_mask:0xf
    v_and_b32_dpp v26, v13, v22 row_newbcast:4 row_mask:0xf bank_mask:0xf
    v_and_b32_dpp v27, v13, v23 row_newbcast:4 row_mask:0xf bank_mask:0xf
    s_waitcnt vmcnt(1)
    s_nop 0
    v_mfma_f32_16x16x32_bf16 v[32:35], v[24:27], v[64:67], v[32:35]
    v_and_b32_dpp v28, v13, v20 row_newbcast:12 row_mask:0xf bank_mask:0xf
    v_and_b32_dpp v29, v13, v21 row_newbcast:12 row_mask:0xf bank_mask:0xf
    v_and_b32_dpp v30, v13, v22 row_newbcast:12 row_mask:0xf bank_mask:0xf
    v_and_b32_dpp v31, v13, v23 row_newbcast:12 row_mask:0xf bank_mask:0xf
    s_waitcnt vmcnt(0)
    s_nop 0
    v_mfma_f32_16x16x32_bf16 v[32:35], v[28:31], v[68:71], v[32:35]
    s_branch L_v_join
L_qslow:
L_wy_91:
    buffer_load_dword v37, v36, s[44:47], 0 offen offset:0 sc1
    s_waitcnt vmcnt(0)
    v_cmp_ne_u32 vcc, 5253184, v37
    s_cbranch_vccz L_wy_91e
    s_sleep 4
    s_sub_u32 s60, s60, 1
    s_cbranch_scc0 L_wy_91
    s_mov_b32 s60, 0
L_wy_91e:
L_qslow2:
L_poll_92:
    buffer_load_dwordx4 v[4:7], v2, s[40:43], s98 offen sc1
    s_waitcnt vmcnt(0)
    v_max3_u32 v38, v4, v5, v6
    v_max_u32 v38, v38, v7
    v_cmp_eq_u32 vcc, -1, v38
    s_cbranch_vccz L_poll_92e
    s_sleep 2
    s_sub_u32 s60, s60, 1
    s_cbranch_scc0 L_poll_92
    s_mov_b32 s60, 0
L_poll_92e:
    s_branch L_qok
L_mlslow:
L_poll_93:
    buffer_load_dwordx2 v[8:9], v2, s[40:43], s99 offen sc1
    s_waitcnt vmcnt(0)
    v_max_u32 v38, v8, v9
    v_cmp_eq_u32 vcc, -1, v38
    s_cbranch_vccz L_poll_93e
    s_sleep 8
    s_sub_u32 s60, s60, 1
    s_cbranch_scc0 L_poll_93
    s_mov_b32 s60, 0
L_poll_93e:
    s_branch L_mlok
L_jobend:
    v_lshrrev_b32 v9, 4, v0
    v_lshl_add_u32 v9, v9, 2, v2
    v_lshlrev_b32 v9, 2, v9
    s_mov_b32 exec_hi, 0
    buffer_store_dwordx4 v[32:35], v9, s[40:43], s13 offen sc1
    s_endpgm
L_proxy:
    v_mov_b32 v105, 0
    v_mov_b32 v108, 0
    v_mov_b32 v160, 0
    s_barrier
    s_add_u32 s97, s35, 5
    s_cmp_eq_u32 s3, 7
    s_cselect_b32 s97, s35, s97
    s_lshl_b32 s97, s97, 9
    s_add_u32 s97, s97, 188416
    v_mov_b32 v8, 162060
L_lw_94:
    ds_read_b32 v9, v8
    s_waitcnt lgkmcnt(0)
    v_cmp_gt_u32 vcc, 4, v9
    s_cbranch_vccz L_lw_94e
    s_sleep 32
    s_sub_u32 s60, s60, 1
    s_cbranch_scc0 L_lw_94
    s_mov_b32 s60, 0
L_lw_94e:
L_wy_95:
    buffer_load_dword v37, v36, s[44:47], 0 offen offset:0 sc1
    s_waitcnt vmcnt(0)
    v_cmp_ne_u32 vcc, 5253184, v37
    s_cbranch_vccz L_wy_95e
    s_sleep 32
    s_sub_u32 s60, s60, 1
    s_cbranch_scc0 L_wy_95
    s_mov_b32 s60, 0
L_wy_95e:
    s_mov_b32 s100, 4
    s_lshl_b32 s63, s100, 8
    v_and_b32 v8, 15, v0
    v_lshl_add_u32 v8, v8, 4, s63
    v_lshrrev_b32 v9, 4, v0
    v_mul_u32_u24 v5, 1280, v9
    v_add_u32 v5, v5, v8
    v_mul_u32_u24 v4, 1296, v9
    v_add_u32 v4, v4, v8
    v_add_u32 v4, 81920, v4
    v_lshlrev_b32 v6, 1, v5
    v_add_u32 v6, 87104, v6
    s_lshl_b32 s62, s100, 3
    s_add_u32 s62, s62, 97344
    v_lshl_add_u32 v7, v9, 6, s62
    s_mov_b32 s48, s4
    s_mov_b32 s49, s5
    s_mov_b32 s50, 5120
    s_mov_b32 s51, 0x20000
    buffer_load_dwordx4 v[8:11], v5, s[48:51], 0 offen
    s_mov_b32 s62, 43008
    s_mov_b32 s63, 53248
L_poll_96:
    buffer_load_dwordx4 v[12:15], v5, s[40:43], s62 offen sc1
    buffer_load_dwordx4 v[16:19], v5, s[40:43], s63 offen sc1
    s_waitcnt vmcnt(0)
    v_max3_u32 v38, v12, v13, v14
    v_max3_u32 v38, v38, v15, v16
    v_max3_u32 v38, v38, v17, v18
    v_max_u32 v38, v38, v19
    v_cmp_eq_u32 vcc, -1, v38
    s_cbranch_vccz L_poll_96e
    s_sleep 32
    s_sub_u32 s60, s60, 1
    s_cbranch_scc0 L_poll_96
    s_mov_b32 s60, 0
L_poll_96e:
    v_lshlrev_b32 v40, 16, v8
    v_and_b32 v41, 0xffff0000, v8
    v_lshlrev_b32 v42, 16, v9
    v_and_b32 v43, 0xffff0000, v9
    v_lshlrev_b32 v44, 16, v10
    v_and_b32 v45, 0xffff0000, v10
    v_lshlrev_b32 v46, 16, v11
    v_and_b32 v47, 0xffff0000, v11
    v_lshlrev_b32 v48, 16, v12
    v_and_b32 v49, 0xffff0000, v12
    v_lshlrev_b32 v50, 16, v13
    v_and_b32 v51, 0xffff0000, v13
    v_lshlrev_b32 v52, 16, v14
    v_and_b32 v53, 0xffff0000, v14
    v_lshlrev_b32 v54, 16, v15
    v_and_b32 v55, 0xffff0000, v15
    v_lshlrev_b32 v56, 16, v16
    v_and_b32 v57, 0xffff0000, v16
    v_lshlrev_b32 v58, 16, v17
    v_and_b32 v59, 0xffff0000, v17
    v_lshlrev_b32 v60, 16, v18
    v_and_b32 v61, 0xffff0000, v18
    v_lshlrev_b32 v62, 16, v19
    v_and_b32 v63, 0xffff0000, v19
    v_mov_b32 v64, 0
    v_mov_b32 v65, 0
    v_mov_b32 v66, 0
    v_mov_b32 v67, 0
    v_mov_b32 v68, 0
    v_mov_b32 v69, 0
    v_mov_b32 v70, 0
    v_mov_b32 v71, 0
    v_and_b32 v2, 15, v0
    v_lshlrev_b32 v2, 3, v2
    v_bfe_u32 v9, v0, 4, 1
    v_lshl_add_u32 v9, v9, 2, v2
    v_lshlrev_b32 v9, 2, v9
    s_or_b32 s96, s59, s39
    s_cbranch_scc0 L_nofrag_97
    v_mov_b32 v104, 162060
L_lw_98:
    ds_read_b32 v105, v104
    s_waitcnt lgkmcnt(0)
    v_cmp_gt_u32 vcc, 4, v105
    s_cbranch_vccz L_lw_98e
    s_sleep 2
    s_sub_u32 s60, s60, 1
    s_cbranch_scc0 L_lw_98
    s_mov_b32 s60, 0
L_lw_98e:
    s_cmp_eq_u32 s59, 0
    s_cbranch_scc1 L_nofrag_97
    v_lshrrev_b32 v109, 4, v0
    v_bfe_u32 v104, v0, 1, 1
    v_lshl_add_u32 v104, v109, 1, v104
    v_bfe_u32 v110, v0, 2, 2
    v_lshl_add_u32 v104, v104, 3, v110
    v_lshlrev_b32 v104, 7, v104
    v_and_b32 v110, 1, v0
    v_lshl_add_u32 v104, v110, 3, v104
    s_lshl_b32 s96, s3, 13
    s_add_u32 s96, s96, 81920
    v_add_u32 v104, s96, v104
    ds_read_b64_tr_b16 v[72:73], v104 offset:0
    ds_read_b64_tr_b16 v[74:75], v104 offset:512
    ds_read_b64_tr_b16 v[76:77], v104 offset:16
    ds_read_b64_tr_b16 v[78:79], v104 offset:528
    ds_read_b64_tr_b16 v[80:81], v104 offset:32
    ds_read_b64_tr_b16 v[82:83], v104 offset:544
    ds_read_b64_tr_b16 v[84:85], v104 offset:48
    ds_read_b64_tr_b16 v[86:87], v104 offset:560
    ds_read_b64_tr_b16 v[88:89], v104 offset:64
    ds_read_b64_tr_b16 v[90:91], v104 offset:576
    ds_read_b64_tr_b16 v[92:93], v104 offset:80
    ds_read_b64_tr_b16 v[94:95], v104 offset:592
    ds_read_b64_tr_b16 v[96:97], v104 offset:96
    ds_read_b64_tr_b16 v[98:99], v104 offset:608
    ds_read_b64_tr_b16 v[100:101], v104 offset:112
    ds_read_b64_tr_b16 v[102:103], v104 offset:624
    v_bfe_u32 v105, v0, 1, 3
    v_lshlrev_b32 v105, 8, v105
    v_lshl_add_u32 v105, v109, 5, v105
    v_lshl_add_u32 v105, v110, 4, v105
    v_mul_u32_u24 v106, 320, v109
    v_bfe_u32 v110, v0, 3, 1
    v_mul_u32_u24 v110, 160, v110
    v_add_u32 v106, v106, v110
    v_and_b32 v110, 7, v0
    v_lshl_add_u32 v107, v110, 4, v106
    v_add_u32 v107, 81920, v107
    v_lshl_add_u32 v106, v110, 2, v106
    v_add_u32 v106, s96, v106
    v_mul_u32_u24 v108, 1280, v109
    v_add_u32 v108, v108, v2
    s_lshr_b32 s96, s3, 1
    s_lshl_b32 s96, s96, 11
    s_and_b32 s100, s3, 1
    s_lshl_b32 s100, s100, 7
    s_add_u32 s100, s100, s96
    s_lshl_b32 s96, s34, 13
    s_add_u32 s100, s100, s96
    s_add_u32 s100, s100, 81920
    s_mul_i32 s101, s34, 5120
    s_lshl_b32 s96, s35, 7
    s_add_u32 s101, s101, s96
    s_add_u32 s101, s101, 144640
L_nofrag_97:
L_poll_99:
    buffer_load_dwordx4 v[32:35], v9, s[40:43], s97 offen sc1
    s_waitcnt vmcnt(0)
    v_max3_u32 v38, v32, v33, v34
    v_max_u32 v38, v38, v35
    v_cmp_eq_u32 vcc, -1, v38
    s_cbranch_vccz L_poll_99e
    s_sleep 32
    s_sub_u32 s60, s60, 1
    s_cbranch_scc0 L_poll_99
    s_mov_b32 s60, 0
L_poll_99e:
    s_lshl_b32 s98, s34, 5
    s_add_u32 s98, s98, s35
    s_lshl_b32 s98, s98, 8
    s_add_u32 s98, s98, 81920
    s_cmp_lg_u32 s13, 0
    s_cselect_b32 s98, s13, s98
    v_lshlrev_b32 v39, 2, v0
    v_and_b32 v38, 31, v0
    v_lshlrev_b32 v38, 2, v38
    s_lshl_b32 s63, s34, 7
    s_add_u32 s63, s63, 204800
    buffer_load_dword v11, v38, s[40:43], s63 offen sc1
    s_waitcnt vmcnt(0)
    s_getreg_b32 s62, hwreg(HW_REG_XCC_ID, 0, 4)
    v_cmp_ne_u32 vcc, s62, v11
    s_nop 0
    s_cmp_eq_u64 vcc, 0
    s_cselect_b32 s61, 1, 0
    v_mov_b32 v8, 162048
L_lw_100:
    ds_read_b32 v9, v8
    s_waitcnt lgkmcnt(0)
    v_cmp_gt_u32 vcc, 3, v9
    s_cbranch_vccz L_lw_100e
    s_sleep 2
    s_sub_u32 s60, s60, 1
    s_cbranch_scc0 L_lw_100
    s_mov_b32 s60, 0
L_lw_100e:
    v_lshrrev_b32 v9, 4, v0
    v_lshl_add_u32 v8, v9, 2, v2
    s_lshl_b32 s96, s3, 9
    s_add_u32 s96, s96, 157824
    v_lshl_add_u32 v8, v8, 2, s96
    v_lshlrev_b32 v9, 3, v0
    v_add_u32 v9, 157824, v9
    v_mov_b32 v10, 162048
    v_mov_b32 v11, 1
    s_branch L_t0
L_s_role:
    s_cmp_eq_u32 s3, 7
    s_cbranch_scc1 L_t2gate
    s_cmp_gt_u32 s3, 3
    s_cbranch_scc1 L_fin_prep
    s_mov_b32 s48, s18
    s_mov_b32 s49, s19
    s_mov_b32 s50, 3456
    s_mov_b32 s51, 0x20000
    v_lshrrev_b32 v3, 4, v0
    v_lshlrev_b32 v4, 3, v3
    s_lshl_b32 s62, s35, 7
    s_lshl_b32 s63, s3, 5
    s_add_u32 s62, s62, s63
    buffer_load_dwordx2 v[82:83], v4, s[48:51], s62 offen
    v_mov_b32 v72, 162064
L_lw_101:
    ds_read_b32 v73, v72
    s_waitcnt lgkmcnt(0)
    v_cmp_gt_u32 vcc, 4, v73
    s_cbranch_vccz L_lw_101e
    s_sleep 2
    s_sub_u32 s60, s60, 1
    s_cbranch_scc0 L_lw_101
    s_mov_b32 s60, 0
L_lw_101e:
    v_lshrrev_b32 v72, 4, v0
    v_lshlrev_b32 v72, 10, v72
    v_bfe_u32 v73, v0, 2, 2
    v_lshl_add_u32 v72, v73, 7, v72
    v_and_b32 v73, 3, v0
    v_lshl_add_u32 v72, v73, 3, v72
    v_bfe_u32 v73, v0, 3, 2
    v_lshl_add_u32 v72, v73, 5, v72
    v_xor_b32 v72, s63, v72
    v_add_u32 v73, 40960, v72
    ds_read_b64_tr_b16 v[88:89], v72 offset:0
    ds_read_b64_tr_b16 v[90:91], v72 offset:512
    ds_read_b64_tr_b16 v[92:93], v72 offset:4096
    ds_read_b64_tr_b16 v[94:95], v72 offset:4608
    ds_read_b64_tr_b16 v[96:97], v72 offset:8192
    ds_read_b64_tr_b16 v[98:99], v72 offset:8704
    ds_read_b64_tr_b16 v[100:101], v72 offset:12288
    ds_read_b64_tr_b16 v[102:103], v72 offset:12800
    ds_read_b64_tr_b16 v[104:105], v72 offset:16384
    ds_read_b64_tr_b16 v[106:107], v72 offset:16896
    ds_read_b64_tr_b16 v[108:109], v72 offset:20480
    ds_read_b64_tr_b16 v[110:111], v72 offset:20992
    ds_read_b64_tr_b16 v[112:113], v72 offset:24576
    ds_read_b64_tr_b16 v[114:115], v72 offset:25088
    ds_read_b64_tr_b16 v[116:117], v72 offset:28672
    ds_read_b64_tr_b16 v[118:119], v72 offset:29184
    ds_read_b64_tr_b16 v[120:121], v72 offset:32768
    ds_read_b64_tr_b16 v[122:123], v72 offset:33280
    ds_read_b64_tr_b16 v[124:125], v72 offset:36864
    ds_read_b64_tr_b16 v[126:127], v72 offset:37376
    ds_read_b64_tr_b16 v[128:129], v73 offset:0
    ds_read_b64_tr_b16 v[130:131], v73 offset:512
    ds_read_b64_tr_b16 v[132:133], v73 offset:4096
    ds_read_b64_tr_b16 v[134:135], v73 offset:4608
    ds_read_b64_tr_b16 v[136:137], v73 offset:8192
    ds_read_b64_tr_b16 v[138:139], v73 offset:8704
    ds_read_b64_tr_b16 v[140:141], v73 offset:12288
    ds_read_b64_tr_b16 v[142:143], v73 offset:12800
    ds_read_b64_tr_b16 v[144:145], v73 offset:16384
    ds_read_b64_tr_b16 v[146:147], v73 offset:16896
    ds_read_b64_tr_b16 v[148:149], v73 offset:20480
    ds_read_b64_tr_b16 v[150:151], v73 offset:20992
    ds_read_b64_tr_b16 v[152:153], v73 offset:24576
    ds_read_b64_tr_b16 v[154:155], v73 offset:25088
    ds_read_b64_tr_b16 v[156:157], v73 offset:28672
    ds_read_b64_tr_b16 v[158:159], v73 offset:29184
    ds_read_b64_tr_b16 v[160:161], v73 offset:32768
    ds_read_b64_tr_b16 v[162:163], v73 offset:33280
    ds_read_b64_tr_b16 v[164:165], v73 offset:36864
    ds_read_b64_tr_b16 v[166:167], v73 offset:37376
    v_and_b32 v1, 15, v0
    v_min_u32 v79, 11, v1
    v_mul_u32_u24 v79, 1296, v79
    v_lshl_add_u32 v79, v3, 4, v79
    v_mov_b32 v5, 81920
    v_mov_b32 v6, 142272
    v_cmp_gt_u32 vcc, 4, v1
    v_mul_u32_u24 v80, 144, v1
    v_add3_u32 v80, v80, v4, s63
    v_cndmask_b32 v5, v6, v5, vcc
    v_add_u32 v79, v79, v5
    v_add_u32 v80, 97600, v80
    v_and_b32 v81, 3, v0
    v_lshlrev_b32 v81, 6, v81
    v_add_u32 v81, 97344, v81
    s_waitcnt lgkmcnt(0)
    s_branch L_ffn1
L_fin_prep:
    s_mul_i32 s62, s35, 3
    s_add_u32 s62, s62, s3
    s_sub_u32 s62, s62, 4
    s_cmp_ge_u32 s62, 80
    s_cbranch_scc1 L_end
    s_lshl_b32 s96, s62, 7
    s_lshl_b32 s57, s62, 6
    s_mul_i32 s63, s62, 0xccd
    s_lshr_b32 s63, s63, 16
    s_mul_i32 s63, s63, 1280
    s_sub_u32 s63, s57, s63
    s_add_u32 s96, s96, 262144
    s_add_u32 s97, s96, 81920
    s_add_u32 s98, s96, 163840
    s_add_u32 s99, s96, 245760
    v_lshrrev_b32 v72, 3, v0
    v_mul_u32_u24 v72, 10240, v72
    v_and_b32 v1, 7, v0
    v_lshl_add_u32 v72, v1, 4, v72
    v_mov_b32 v100, 0
    v_mov_b32 v101, 0
    v_mov_b32 v102, 0
    v_mov_b32 v103, 0
    v_bfe_u32 v3, v0, 4, 1
    v_lshrrev_b32 v4, 5, v0
    v_lshl_add_u32 v3, v3, 1, v4
    v_lshl_add_u32 v73, v1, 2, v3
    v_lshlrev_b32 v73, 1, v73
    s_lshl_b32 s62, s57, 1
    s_add_u32 s62, s62, 87104
    v_lshl_add_u32 v74, v73, 1, s62
    s_mov_b32 s48, s22
    s_mov_b32 s49, s23
    s_mov_b32 s50, 1280
    s_mov_b32 s51, 0x20000
    s_mov_b32 s52, s28
    s_mov_b32 s53, s29
    s_mov_b32 s54, 5120
    s_mov_b32 s55, 0x20000
    buffer_load_dwordx4 v[88:91], v72, s[40:43], s96 offen sc1
    buffer_load_dwordx4 v[92:95], v72, s[40:43], s97 offen sc1
    buffer_load_dwordx4 v[96:99], v72, s[40:43], s98 offen sc1
    s_mov_b64 exec, 0xffffff
    buffer_load_dwordx4 v[100:103], v72, s[40:43], s99 offen sc1
    s_mov_b64 exec, -1
    buffer_load_ushort v75, v73, s[48:51], s63 offen
    v_and_b32 v77, 0xfffc, v73
    s_add_u32 s62, s57, 58368
    buffer_load_dword v76, v77, s[40:43], s62 offen sc1
    s_barrier
    s_waitcnt vmcnt(0)
    v_cmp_eq_u32 vcc, -1, v76
    s_cbranch_vccz L_gbok
L_poll_102:
    buffer_load_dword v76, v77, s[40:43], s62 offen sc1
    s_waitcnt vmcnt(0)
    v_cmp_eq_u32 vcc, -1, v76
    s_cbranch_vccz L_poll_102e
    s_sleep 2
    s_sub_u32 s60, s60, 1
    s_cbranch_scc0 L_poll_102
    s_mov_b32 s60, 0
L_poll_102e:
L_gbok:
    v_lshlrev_b32 v75, 16, v75
    v_and_b32 v77, 2, v73
    v_lshlrev_b32 v77, 3, v77
    v_lshrrev_b32 v76, v77, v76
    v_lshlrev_b32 v76, 16, v76
    s_barrier
    ds_read_b32 v78, v74
    s_barrier
L_poll_103:
    buffer_load_dwordx4 v[88:91], v72, s[40:43], s96 offen sc1
    buffer_load_dwordx4 v[92:95], v72, s[40:43], s97 offen sc1
    buffer_load_dwordx4 v[96:99], v72, s[40:43], s98 offen sc1
    s_mov_b64 exec, 0xffffff
    buffer_load_dwordx4 v[100:103], v72, s[40:43], s99 offen sc1
    s_mov_b64 exec, -1
    s_waitcnt vmcnt(0)
    v_max3_u32 v3, v88, v89, v90
    v_max3_u32 v3, v3, v91, v92
    v_max3_u32 v3, v3, v93, v94
    v_max3_u32 v3, v3, v95, v96
    v_max3_u32 v3, v3, v97, v98
    v_max3_u32 v3, v3, v99, v100
    v_max3_u32 v3, v3, v101, v102
    v_max_u32 v3, v3, v103
    v_cmp_eq_u32 vcc, -1, v3
    s_cbranch_vccz L_poll_103e
    s_sub_u32 s60, s60, 1
    s_cbranch_scc0 L_poll_103
    s_mov_b32 s60, 0
L_poll_103e:
    v_pk_add_f32 v[88:89], v[88:89], v[92:93]
    v_pk_add_f32 v[90:91], v[90:91], v[94:95]
    v_pk_add_f32 v[96:97], v[96:97], v[100:101]
    v_pk_add_f32 v[98:99], v[98:99], v[102:103]
    v_pk_add_f32 v[88:89], v[88:89], v[96:97]
    v_pk_add_f32 v[90:91], v[90:91], v[98:99]
    s_nop 0
    v_permlane32_swap_b32 v88, v89
    v_permlane32_swap_b32 v90, v91
    v_add_f32 v88, v88, v89
    v_add_f32 v90, v90, v91
    s_nop 1
    v_permlane16_swap_b32 v88, v90
    v_add_f32 v88, v88, v90
    s_waitcnt lgkmcnt(0)
    s_nop 0
    v_add_f32_dpp v88, v88, v88 row_ror:8 row_mask:0xf bank_mask:0xf
    v_add_f32 v88, v88, v75
    v_fma_f32 v88, v88, v76, v78
    v_cvt_pk_bf16_f32 v88, v88, v88
    s_mov_b32 exec_lo, 0x00ff00ff
    s_mov_b32 exec_hi, 0x00ff00ff
    buffer_store_short v88, v73, s[52:55], s57 offen
    s_endpgm
L_t2gate:
    v_mov_b32 v8, 162048
L_lw_104:
    ds_read_b32 v9, v8
    s_waitcnt lgkmcnt(0)
    v_cmp_gt_u32 vcc, 8, v9
    s_cbranch_vccz L_lw_104e
    s_sleep 2
    s_sub_u32 s60, s60, 1
    s_cbranch_scc0 L_lw_104
    s_mov_b32 s60, 0
L_lw_104e:
    s_mov_b32 s58, 0x3f80
    s_mov_b32 s59, 0x3f800000
    s_mov_b32 s63, 0xff
L_pg:
    s_bitcmp0_b32 s63, 0
    s_cbranch_scc1 L_pgi0
    s_mov_b32 s62, 147456
    buffer_load_dwordx4 v[8:11], v5, s[40:43], s62 offen sc1
L_pgi0:
    s_bitcmp0_b32 s63, 1
    s_cbranch_scc1 L_pgi1
    s_mov_b32 s62, 152576
    buffer_load_dwordx4 v[12:15], v5, s[40:43], s62 offen sc1
L_pgi1:
    s_bitcmp0_b32 s63, 2
    s_cbranch_scc1 L_pgi2
    s_mov_b32 s62, 157696
    buffer_load_dwordx4 v[16:19], v5, s[40:43], s62 offen sc1
L_pgi2:
    s_bitcmp0_b32 s63, 3
    s_cbranch_scc1 L_pgi3
    s_mov_b32 s62, 162816
    buffer_load_dwordx4 v[20:23], v5, s[40:43], s62 offen sc1
L_pgi3:
    s_bitcmp0_b32 s63, 4
    s_cbranch_scc1 L_pgi4
    s_mov_b32 s62, 167936
    buffer_load_dwordx4 v[24:27], v5, s[40:43], s62 offen sc1
L_pgi4:
    s_bitcmp0_b32 s63, 5
    s_cbranch_scc1 L_pgi5
    s_mov_b32 s62, 173056
    buffer_load_dwordx4 v[28:31], v5, s[40:43], s62 offen sc1
L_pgi5:
    s_bitcmp0_b32 s63, 6
    s_cbranch_scc1 L_pgi6
    s_mov_b32 s62, 178176
    buffer_load_dwordx4 v[32:35], v5, s[40:43], s62 offen sc1
L_pgi6:
    s_bitcmp0_b32 s63, 7
    s_cbranch_scc1 L_pgi7
    s_mov_b32 s62, 183296
    buffer_load_dwordx4 v[36:39], v5, s[40:43], s62 offen sc1
L_pgi7:
    s_sub_u32 s60, s60, 1
    s_cselect_b32 s62, 0, -1
    s_cselect_b32 s60, 0, s60
    s_waitcnt vmcnt(0)
    s_bitcmp0_b32 s63, 0
    s_cbranch_scc1 L_pgc0
    v_max3_u32 v3, v8, v9, v10
    v_max_u32 v3, v3, v11
    v_and_b32 v3, s62, v3
    v_cmp_eq_u32 vcc, -1, v3
    s_cbranch_vccnz L_pgc0
    v_dot2c_f32_bf16 v64, s58, v8
    v_dot2c_f32_bf16 v65, s59, v8
    v_dot2c_f32_bf16 v66, s58, v9
    v_dot2c_f32_bf16 v67, s59, v9
    v_dot2c_f32_bf16 v68, s58, v10
    v_dot2c_f32_bf16 v69, s59, v10
    v_dot2c_f32_bf16 v70, s58, v11
    v_dot2c_f32_bf16 v71, s59, v11
    s_bitset0_b32 s63, 0
L_pgc0:
    s_bitcmp0_b32 s63, 1
    s_cbranch_scc1 L_pgc1
    v_max3_u32 v3, v12, v13, v14
    v_max_u32 v3, v3, v15
    v_and_b32 v3, s62, v3
    v_cmp_eq_u32 vcc, -1, v3
    s_cbranch_vccnz L_pgc1
    v_dot2c_f32_bf16 v64, s58, v12
    v_dot2c_f32_bf16 v65, s59, v12
    v_dot2c_f32_bf16 v66, s58, v13
    v_dot2c_f32_bf16 v67, s59, v13
    v_dot2c_f32_bf16 v68, s58, v14
    v_dot2c_f32_bf16 v69, s59, v14
    v_dot2c_f32_bf16 v70, s58, v15
    v_dot2c_f32_bf16 v71, s59, v15
    s_bitset0_b32 s63, 1
L_pgc1:
    s_bitcmp0_b32 s63, 2
    s_cbranch_scc1 L_pgc2
    v_max3_u32 v3, v16, v17, v18
    v_max_u32 v3, v3, v19
    v_and_b32 v3, s62, v3
    v_cmp_eq_u32 vcc, -1, v3
    s_cbranch_vccnz L_pgc2
    v_dot2c_f32_bf16 v64, s58, v16
    v_dot2c_f32_bf16 v65, s59, v16
    v_dot2c_f32_bf16 v66, s58, v17
    v_dot2c_f32_bf16 v67, s59, v17
    v_dot2c_f32_bf16 v68, s58, v18
    v_dot2c_f32_bf16 v69, s59, v18
    v_dot2c_f32_bf16 v70, s58, v19
    v_dot2c_f32_bf16 v71, s59, v19
    s_bitset0_b32 s63, 2
L_pgc2:
    s_bitcmp0_b32 s63, 3
    s_cbranch_scc1 L_pgc3
    v_max3_u32 v3, v20, v21, v22
    v_max_u32 v3, v3, v23
    v_and_b32 v3, s62, v3
    v_cmp_eq_u32 vcc, -1, v3
    s_cbranch_vccnz L_pgc3
    v_dot2c_f32_bf16 v64, s58, v20
    v_dot2c_f32_bf16 v65, s59, v20
    v_dot2c_f32_bf16 v66, s58, v21
    v_dot2c_f32_bf16 v67, s59, v21
    v_dot2c_f32_bf16 v68, s58, v22
    v_dot2c_f32_bf16 v69, s59, v22
    v_dot2c_f32_bf16 v70, s58, v23
    v_dot2c_f32_bf16 v71, s59, v23
    s_bitset0_b32 s63, 3
L_pgc3:
    s_bitcmp0_b32 s63, 4
    s_cbranch_scc1 L_pgc4
    v_max3_u32 v3, v24, v25, v26
    v_max_u32 v3, v3, v27
    v_and_b32 v3, s62, v3
    v_cmp_eq_u32 vcc, -1, v3
    s_cbranch_vccnz L_pgc4
    v_dot2c_f32_bf16 v64, s58, v24
    v_dot2c_f32_bf16 v65, s59, v24
    v_dot2c_f32_bf16 v66, s58, v25
    v_dot2c_f32_bf16 v67, s59, v25
    v_dot2c_f32_bf16 v68, s58, v26
    v_dot2c_f32_bf16 v69, s59, v26
    v_dot2c_f32_bf16 v70, s58, v27
    v_dot2c_f32_bf16 v71, s59, v27
    s_bitset0_b32 s63, 4
L_pgc4:
    s_bitcmp0_b32 s63, 5
    s_cbranch_scc1 L_pgc5
    v_max3_u32 v3, v28, v29, v30
    v_max_u32 v3, v3, v31
    v_and_b32 v3, s62, v3
    v_cmp_eq_u32 vcc, -1, v3
    s_cbranch_vccnz L_pgc5
    v_dot2c_f32_bf16 v64, s58, v28
    v_dot2c_f32_bf16 v65, s59, v28
    v_dot2c_f32_bf16 v66, s58, v29
    v_dot2c_f32_bf16 v67, s59, v29
    v_dot2c_f32_bf16 v68, s58, v30
    v_dot2c_f32_bf16 v69, s59, v30
    v_dot2c_f32_bf16 v70, s58, v31
    v_dot2c_f32_bf16 v71, s59, v31
    s_bitset0_b32 s63, 5
L_pgc5:
    s_bitcmp0_b32 s63, 6
    s_cbranch_scc1 L_pgc6
    v_max3_u32 v3, v32, v33, v34
    v_max_u32 v3, v3, v35
    v_and_b32 v3, s62, v3
    v_cmp_eq_u32 vcc, -1, v3
    s_cbranch_vccnz L_pgc6
    v_dot2c_f32_bf16 v64, s58, v32
    v_dot2c_f32_bf16 v65, s59, v32
    v_dot2c_f32_bf16 v66, s58, v33
    v_dot2c_f32_bf16 v67, s59, v33
    v_dot2c_f32_bf16 v68, s58, v34
    v_dot2c_f32_bf16 v69, s59, v34
    v_dot2c_f32_bf16 v70, s58, v35
    v_dot2c_f32_bf16 v71, s59, v35
    s_bitset0_b32 s63, 6
L_pgc6:
    s_bitcmp0_b32 s63, 7
    s_cbranch_scc1 L_pgc7
    v_max3_u32 v3, v36, v37, v38
    v_max_u32 v3, v3, v39
    v_and_b32 v3, s62, v3
    v_cmp_eq_u32 vcc, -1, v3
    s_cbranch_vccnz L_pgc7
    v_dot2c_f32_bf16 v64, s58, v36
    v_dot2c_f32_bf16 v65, s59, v36
    v_dot2c_f32_bf16 v66, s58, v37
    v_dot2c_f32_bf16 v67, s59, v37
    v_dot2c_f32_bf16 v68, s58, v38
    v_dot2c_f32_bf16 v69, s59, v38
    v_dot2c_f32_bf16 v70, s58, v39
    v_dot2c_f32_bf16 v71, s59, v39
    s_bitset0_b32 s63, 7
L_pgc7:
    s_cmp_lg_u32 s63, 0
    s_cbranch_scc1 L_pg
    v_pk_fma_f32 v[64:65], v[64:65], v[48:49], v[40:41]
    v_pk_fma_f32 v[66:67], v[66:67], v[50:51], v[42:43]
    v_pk_fma_f32 v[68:69], v[68:69], v[52:53], v[44:45]
    v_pk_fma_f32 v[70:71], v[70:71], v[54:55], v[46:47]
    v_pk_mul_f32 v[56:57], v[64:65], v[56:57]
    v_pk_mul_f32 v[58:59], v[66:67], v[58:59]
    v_pk_mul_f32 v[60:61], v[68:69], v[60:61]
    v_pk_mul_f32 v[62:63], v[70:71], v[62:63]
    v_cvt_pk_bf16_f32 v8, v56, v57
    v_cvt_pk_bf16_f32 v9, v58, v59
    v_cvt_pk_bf16_f32 v10, v60, v61
    v_cvt_pk_bf16_f32 v11, v62, v63
    ds_write_b128 v4, v[8:11]
    s_waitcnt lgkmcnt(0)
    s_barrier
    ds_write_b128 v6, v[64:67]
    ds_write_b128 v6, v[68:71] offset:16
    v_pk_add_f32 v[8:9], v[64:65], v[66:67]
    v_pk_add_f32 v[10:11], v[68:69], v[70:71]
    v_pk_mul_f32 v[12:13], v[64:65], v[64:65]
    v_pk_add_f32 v[8:9], v[8:9], v[10:11]
    v_pk_fma_f32 v[12:13], v[66:67], v[66:67], v[12:13]
    v_pk_fma_f32 v[12:13], v[68:69], v[68:69], v[12:13]
    v_pk_fma_f32 v[12:13], v[70:71], v[70:71], v[12:13]
    v_add_f32 v8, v8, v9
    v_add_f32 v9, v12, v13
    s_nop 0
    v_add_f32_dpp v8, v8, v8 quad_perm:[1,0,3,2] row_mask:0xf bank_mask:0xf
    v_add_f32_dpp v9, v9, v9 quad_perm:[1,0,3,2] row_mask:0xf bank_mask:0xf
    s_nop 0
    v_add_f32_dpp v8, v8, v8 quad_perm:[2,3,0,1] row_mask:0xf bank_mask:0xf
    v_add_f32_dpp v9, v9, v9 quad_perm:[2,3,0,1] row_mask:0xf bank_mask:0xf
    s_nop 0
    v_add_f32_dpp v8, v8, v8 row_ror:4 row_mask:0xf bank_mask:0xf
    v_add_f32_dpp v9, v9, v9 row_ror:4 row_mask:0xf bank_mask:0xf
    s_nop 0
    v_add_f32_dpp v8, v8, v8 row_ror:8 row_mask:0xf bank_mask:0xf
    v_add_f32_dpp v9, v9, v9 row_ror:8 row_mask:0xf bank_mask:0xf
    ds_write_b64 v7, v[8:9]
    s_waitcnt lgkmcnt(0)
    s_cmp_lg_u32 s3, 7
    s_cbranch_scc1 L_ffn2
    s_endpgm
L_ffn1:
    s_barrier
    ds_read_b128 v[8:11], v79 offset:0
    ds_read_b128 v[12:15], v79 offset:64
    ds_read_b128 v[16:19], v79 offset:128
    ds_read_b128 v[20:23], v79 offset:192
    ds_read_b128 v[24:27], v79 offset:256
    ds_read_b128 v[28:31], v79 offset:320
    ds_read_b128 v[32:35], v79 offset:384
    ds_read_b128 v[36:39], v79 offset:448
    ds_read_b128 v[40:43], v79 offset:512
    ds_read_b128 v[44:47], v79 offset:576
    s_waitcnt lgkmcnt(9)
    v_mfma_f32_16x16x32_bf16 v[4:7], v[88:91], v[8:11], 0
    ds_read_b128 v[8:11], v79 offset:640
    s_waitcnt lgkmcnt(9)
    v_mfma_f32_16x16x32_bf16 v[4:7], v[92:95], v[12:15], v[4:7]
    ds_read_b128 v[12:15], v79 offset:704
    s_waitcnt lgkmcnt(9)
    v_mfma_f32_16x16x32_bf16 v[4:7], v[96:99], v[16:19], v[4:7]
    ds_read_b128 v[16:19], v79 offset:768
    s_waitcnt lgkmcnt(9)
    v_mfma_f32_16x16x32_bf16 v[4:7], v[100:103], v[20:23], v[4:7]
    ds_read_b128 v[20:23], v79 offset:832
    s_waitcnt lgkmcnt(9)
    v_mfma_f32_16x16x32_bf16 v[4:7], v[104:107], v[24:27], v[4:7]
    ds_read_b128 v[24:27], v79 offset:896
    s_waitcnt lgkmcnt(9)
    v_mfma_f32_16x16x32_bf16 v[4:7], v[108:111], v[28:31], v[4:7]
    ds_read_b128 v[28:31], v79 offset:960
    s_waitcnt lgkmcnt(9)
    v_mfma_f32_16x16x32_bf16 v[4:7], v[112:115], v[32:35], v[4:7]
    ds_read_b128 v[32:35], v79 offset:1024
    s_waitcnt lgkmcnt(9)
    v_mfma_f32_16x16x32_bf16 v[4:7], v[116:119], v[36:39], v[4:7]
    ds_read_b128 v[36:39], v79 offset:1088
    s_waitcnt lgkmcnt(9)
    v_mfma_f32_16x16x32_bf16 v[4:7], v[120:123], v[40:43], v[4:7]
    ds_read_b128 v[40:43], v79 offset:1152
    s_waitcnt lgkmcnt(9)
    v_mfma_f32_16x16x32_bf16 v[4:7], v[124:127], v[44:47], v[4:7]
    ds_read_b128 v[44:47], v79 offset:1216
    s_waitcnt vmcnt(0)
    v_lshlrev_b32 v84, 16, v82
    v_and_b32 v85, 0xffff0000, v82
    v_lshlrev_b32 v86, 16, v83
    v_and_b32 v87, 0xffff0000, v83
    s_barrier
    ds_read_b128 v[48:51], v81
    ds_read_b128 v[52:55], v81 offset:16
    ds_read_b64 v[56:57], v81 offset:32
    s_waitcnt lgkmcnt(12)
    v_mfma_f32_16x16x32_bf16 v[4:7], v[128:131], v[8:11], v[4:7]
    s_waitcnt lgkmcnt(11)
    v_mfma_f32_16x16x32_bf16 v[4:7], v[132:135], v[12:15], v[4:7]
    s_waitcnt lgkmcnt(10)
    v_mfma_f32_16x16x32_bf16 v[4:7], v[136:139], v[16:19], v[4:7]
    s_waitcnt lgkmcnt(9)
    v_mfma_f32_16x16x32_bf16 v[4:7], v[140:143], v[20:23], v[4:7]
    s_waitcnt lgkmcnt(8)
    v_mfma_f32_16x16x32_bf16 v[4:7], v[144:147], v[24:27], v[4:7]
    s_waitcnt lgkmcnt(7)
    v_mfma_f32_16x16x32_bf16 v[4:7], v[148:151], v[28:31], v[4:7]
    s_waitcnt lgkmcnt(6)
    v_mfma_f32_16x16x32_bf16 v[4:7], v[152:155], v[32:35], v[4:7]
    s_waitcnt lgkmcnt(5)
    v_mfma_f32_16x16x32_bf16 v[4:7], v[156:159], v[36:39], v[4:7]
    s_waitcnt lgkmcnt(4)
    v_mfma_f32_16x16x32_bf16 v[4:7], v[160:163], v[40:43], v[4:7]
    s_waitcnt lgkmcnt(3)
    v_mfma_f32_16x16x32_bf16 v[4:7], v[164:167], v[44:47], v[4:7]
    s_waitcnt lgkmcnt(0)
    v_pk_add_f32 v[48:49], v[48:49], v[50:51]
    v_pk_add_f32 v[52:53], v[52:53], v[54:55]
    v_pk_add_f32 v[48:49], v[48:49], v[56:57]
    v_pk_add_f32 v[48:49], v[48:49], v[52:53]
    s_mov_b32 s62, 0xbacccccd
    v_mul_f32 v48, s62, v48
    v_mul_f32 v49, s62, v49
    v_fma_f32 v49, -v48, v48, -v49
    v_max_f32 v49, 0, v49
    v_add_f32 v49, 0x3727c5ac, v49
    v_rsq_f32 v49, v49
    v_add_f32_dpp v84, v4, v84 row_shl:8 row_mask:0xf bank_mask:0x1
    v_add_f32_dpp v85, v5, v85 row_shl:8 row_mask:0xf bank_mask:0x1
    v_add_f32_dpp v86, v6, v86 row_shl:8 row_mask:0xf bank_mask:0x1
    v_add_f32_dpp v87, v7, v87 row_shl:8 row_mask:0xf bank_mask:0x1
    v_fmac_f32_dpp v4, v4, v48 row_shl:4 row_mask:0xf bank_mask:0x1
    v_fmac_f32_dpp v5, v5, v48 row_shl:4 row_mask:0xf bank_mask:0x1
    v_fmac_f32_dpp v6, v6, v48 row_shl:4 row_mask:0xf bank_mask:0x1
    v_fmac_f32_dpp v7, v7, v48 row_shl:4 row_mask:0xf bank_mask:0x1
    v_fma_f32 v4, v4, v49, v84
    v_fma_f32 v5, v5, v49, v85
    v_fma_f32 v6, v6, v49, v86
    v_fma_f32 v7, v7, v49, v87
    s_mov_b32 s62, 0xbdd2d3e8
    v_mov_b32 v50, 0xc0135761
    v_mul_f32 v8, v4, v4
    v_mul_f32 v9, v5, v5
    v_mul_f32 v10, v6, v6
    v_mul_f32 v11, v7, v7
    v_fma_f32 v8, v8, s62, v50
    v_fma_f32 v9, v9, s62, v50
    v_fma_f32 v10, v10, s62, v50
    v_fma_f32 v11, v11, s62, v50
    v_mul_f32 v8, v8, v4
    v_mul_f32 v9, v9, v5
    v_mul_f32 v10, v10, v6
    v_mul_f32 v11, v11, v7
    v_exp_f32 v8, v8
    v_exp_f32 v9, v9
    v_exp_f32 v10, v10
    v_exp_f32 v11, v11
    v_add_f32 v8, 1.0, v8
    v_add_f32 v9, 1.0, v9
    v_add_f32 v10, 1.0, v10
    v_add_f32 v11, 1.0, v11
    v_rcp_f32 v8, v8
    v_rcp_f32 v9, v9
    v_rcp_f32 v10, v10
    v_rcp_f32 v11, v11
    v_mul_f32 v4, v4, v8
    v_mul_f32 v5, v5, v9
    v_mul_f32 v6, v6, v10
    v_mul_f32 v7, v7, v11
    v_cvt_pk_bf16_f32 v4, v4, v5
    v_cvt_pk_bf16_f32 v5, v6, v7
    s_mov_b32 exec_lo, 0x000f000f
    s_mov_b32 exec_hi, 0x000f000f
    ds_write_b64 v80, v[4:5]
    s_waitcnt lgkmcnt(0)
    s_barrier
    s_endpgm
L_helpers:
    s_cmp_lg_u32 s3, 0
    s_cbranch_scc1 L_noinit
    v_lshlrev_b32 v1, 2, v0
    v_add_u32 v1, 161920, v1
    ds_write_b32 v1, v36
    s_waitcnt lgkmcnt(0)
L_noinit:
    s_mul_i32 s101, s3, 20480
    s_mov_b32 s96, s56
    s_cmp_lt_u32 s56, 84
    s_cbranch_scc1 L_unit
    s_sub_u32 s62, s56, 124
    s_cmp_lt_u32 s62, 30
    s_cbranch_scc0 L_nojob
    s_mul_i32 s63, s3, 30
    s_add_u32 s62, s62, s63
    s_cmp_lt_u32 s62, 32
    s_cbranch_scc0 L_nojob
    s_lshl_b32 s12, s3, 13
    s_lshl_b32 s13, s62, 9
    s_add_u32 s13, s13, 188416
    s_sub_u32 s63, s62, 5
    s_cmp_lt_u32 s62, 27
    s_cselect_b32 s35, s62, s63
    s_cselect_b32 s3, 7, 6
    s_mov_b32 s34, 2
    s_lshr_b32 s36, s35, 3
    s_add_u32 s36, s36, 8
    s_bfe_u32 s37, s35, 0x20001
    s_and_b32 s38, s35, 1
    s_mov_b32 s59, 0
    s_branch L_stream
L_nojob:
    s_barrier
    s_cmp_ge_u32 s35, 22
    s_cbranch_scc1 L_h_t1
    s_cmp_eq_u32 s39, 1
    s_cbranch_scc1 L_h_role
    s_cmp_ge_u32 s96, 124
    s_cbranch_scc1 L_end
L_unit:
    v_lshrrev_b32 v3, 4, v0
    v_and_b32 v4, 3, v0
    v_bfe_u32 v7, v0, 2, 2
    v_lshlrev_b32 v64, 5, v7
    v_lshl_add_u32 v64, v3, 3, v64
    s_sub_u32 s62, s96, 20
    s_cmp_lt_u32 s62, 64
    s_cbranch_scc1 L_u_q
    s_cmp_lt_u32 s96, 20
    s_cselect_b32 s100, 0, 1
    s_cselect_b32 s62, 0, 64
    s_cselect_b32 s14, 128, 0
    s_cselect_b32 s15, 1, 0x100
    s_sub_u32 s96, s96, s62
    s_mov_b32 s97, 0
    s_mov_b32 s99, 7680
    s_mov_b32 s48, s26
    s_mov_b32 s49, s27
    s_mov_b32 s50, 4915200
    s_mov_b32 s51, 0x20000
    s_mov_b32 s52, s24
    s_mov_b32 s53, s25
    s_mov_b32 s54, 5120
    s_mov_b32 s55, 0x20000
    v_and_b32 v6, 15, v0
    v_lshlrev_b32 v6, 4, v6
    v_mul_u32_u24 v5, 1280, v3
    v_add_u32 v5, v5, v6
    s_mul_i32 s62, s3, 320
    buffer_load_dwordx4 v[8:11], v5, s[52:55], s62 offen
    s_mov_b32 exec_lo, 0x000f000f
    s_mov_b32 exec_hi, 0x000f000f
    buffer_load_dwordx4 v[12:15], v5, s[52:55], s62 offen offset:256
    s_mov_b64 exec, -1
    s_lshl_b32 s98, s96, 7
    s_mul_i32 s13, s96, 0x199a
    s_lshr_b32 s13, s13, 16
    s_mul_i32 s63, s13, 3840
    s_add_u32 s57, s98, s63
    s_add_u32 s57, s57, 32768
    v_mul_u32_u24 v5, 1280, v4
    v_add_u32 v64, v64, v5
    s_branch L_u_go
L_u_q:
    s_mov_b32 s97, 1
    s_mov_b32 s99, 8192
    s_mov_b32 s100, 0
    s_mov_b32 s14, 0
    s_mov_b32 s15, 1
    s_lshl_b32 s98, s62, 7
    s_mov_b32 s57, s98
    v_lshl_add_u32 v64, v4, 13, v64
    s_mov_b32 s48, s10
    s_mov_b32 s49, s11
    s_mov_b32 s50, 5242880
    s_mov_b32 s51, 0x20000
L_u_go:
    s_cmp_lg_u32 s3, 0
    s_cbranch_scc1 L_u_noclr
    v_mov_b32 v66, -1
    v_mov_b32 v67, -1
    buffer_store_dwordx2 v[66:67], v64, s[40:43], s57 offen sc1
L_u_noclr:
    v_lshrrev_b32 v6, 3, v0
    v_mul_lo_u32 v1, v6, s99
    v_and_b32 v6, 2, v6
    v_xor_b32 v6, v6, v0
    v_and_b32 v6, 7, v6
    v_lshl_add_u32 v1, v6, 4, v1
    v_add_u32 v1, s98, v1
    v_xor_b32 v2, 64, v1
    s_mul_i32 s63, s99, s3
    s_mul_i32 s63, s63, 160
    s_lshl_b32 s59, s99, 3
    s_mov_b32 m0, s101
    s_mov_b32 s62, 10
L_dma_105:
    buffer_load_dwordx4 v1, s[48:51], s63 offen nt lds
    s_add_u32 m0, m0, 1024
    s_add_u32 s63, s63, s59
    s_cmp_eq_u32 s100, 0
    s_cbranch_scc1 L_dma_105n0
    s_waitcnt vmcnt(1)
    s_cmp_eq_u32 s100, 2
    s_cbranch_scc1 L_dma_105n0
    s_waitcnt vmcnt(1)
L_dma_105n0:
    buffer_load_dwordx4 v2, s[48:51], s63 offen nt lds
    s_add_u32 m0, m0, 1024
    s_add_u32 s63, s63, s59
    s_cmp_eq_u32 s100, 0
    s_cbranch_scc1 L_dma_105n1
    s_waitcnt vmcnt(1)
    s_cmp_eq_u32 s100, 2
    s_cbranch_scc1 L_dma_105n1
    s_waitcnt vmcnt(1)
L_dma_105n1:
    s_cmp_lg_u32 s3, 0
    s_cbranch_scc1 L_u_noarr
    s_cmp_lg_u32 s62, 8
    s_cbranch_scc1 L_u_noarr
    s_waitcnt vmcnt(6)
    v_mov_b32 v38, s15
    s_mov_b64 exec, 1
    buffer_atomic_add v38, v36, s[44:47], s14 offen sc1
    s_mov_b64 exec, -1
L_u_noarr:
    s_sub_u32 s62, s62, 1
    s_cmp_lg_u32 s62, 0
    s_cbranch_scc1 L_dma_105
    s_cmp_lt_u32 s56, 84
    s_cbranch_scc0 L_u_nob
    s_barrier
L_u_nob:
    v_lshrrev_b32 v60, 4, v0
    v_lshlrev_b32 v60, 10, v60
    v_bfe_u32 v6, v0, 2, 2
    v_lshl_add_u32 v60, v6, 7, v60
    v_and_b32 v6, 3, v0
    v_lshl_add_u32 v60, v6, 3, v60
    v_bfe_u32 v6, v0, 3, 2
    v_lshl_add_u32 v60, v6, 5, v60
    v_xor_b32 v61, 32, v60
    v_xor_b32 v62, 64, v60
    v_xor_b32 v63, 0x60, v60
    v_add_u32 v60, s101, v60
    v_add_u32 v61, s101, v61
    v_add_u32 v62, s101, v62
    v_add_u32 v63, s101, v63
    v_mov_b32 v56, 1.0
    v_mov_b32 v57, 1.0
    v_mov_b32 v58, 1.0
    v_mov_b32 v59, 1.0
    s_mov_b32 s58, 0
    s_cmp_eq_u32 s97, 1
    s_cbranch_scc1 L_u_q2
    s_cmp_eq_u32 s13, 4
    s_cselect_b32 s58, 1.0, 0
    s_cmp_eq_u32 s13, 1
    s_cselect_b32 s58, 1.0, s58
    s_cselect_b32 s56, 1, 0
    s_cbranch_scc0 L_u_nox
    s_mov_b32 s52, s4
    s_mov_b32 s53, s5
    s_mov_b32 s54, 5120
    s_mov_b32 s55, 0x20000
    v_lshrrev_b32 v6, 2, v0
    v_lshl_add_u32 v6, v6, 4, v5
    s_sub_u32 s62, s98, 1280
    buffer_load_dwordx4 v[16:19], v6, s[52:55], 0 offen offset:0
    buffer_load_dwordx4 v[20:23], v6, s[52:55], 0 offen offset:256
    buffer_load_dwordx4 v[24:27], v6, s[52:55], 0 offen offset:512
    buffer_load_dwordx4 v[28:31], v6, s[52:55], 0 offen offset:768
    buffer_load_dwordx4 v[32:35], v6, s[52:55], 0 offen offset:1024
    buffer_load_dwordx2 v[66:67], v64, s[52:55], s62 offen
    s_waitcnt vmcnt(26)
    s_branch L_u_silu
L_u_nox:
    s_waitcnt vmcnt(20)
L_u_silu:
    s_mov_b32 s62, 0xbfb8aa3b
    v_lshlrev_b32 v40, 16, v8
    v_and_b32 v41, 0xffff0000, v8
    v_lshlrev_b32 v42, 16, v9
    v_and_b32 v43, 0xffff0000, v9
    v_lshlrev_b32 v44, 16, v10
    v_and_b32 v45, 0xffff0000, v10
    v_lshlrev_b32 v46, 16, v11
    v_and_b32 v47, 0xffff0000, v11
    v_mul_f32 v48, s62, v40
    v_mul_f32 v49, s62, v41
    v_mul_f32 v50, s62, v42
    v_mul_f32 v51, s62, v43
    v_mul_f32 v52, s62, v44
    v_mul_f32 v53, s62, v45
    v_mul_f32 v54, s62, v46
    v_mul_f32 v55, s62, v47
    v_exp_f32 v48, v48
    v_exp_f32 v49, v49
    v_exp_f32 v50, v50
    v_exp_f32 v51, v51
    v_exp_f32 v52, v52
    v_exp_f32 v53, v53
    v_exp_f32 v54, v54
    v_exp_f32 v55, v55
    v_add_f32 v48, 1.0, v48
    v_add_f32 v49, 1.0, v49
    v_add_f32 v50, 1.0, v50
    v_add_f32 v51, 1.0, v51
    v_add_f32 v52, 1.0, v52
    v_add_f32 v53, 1.0, v53
    v_add_f32 v54, 1.0, v54
    v_add_f32 v55, 1.0, v55
    v_rcp_f32 v48, v48
    v_rcp_f32 v49, v49
    v_rcp_f32 v50, v50
    v_rcp_f32 v51, v51
    v_rcp_f32 v52, v52
    v_rcp_f32 v53, v53
    v_rcp_f32 v54, v54
    v_rcp_f32 v55, v55
    v_mul_f32 v40, v40, v48
    v_mul_f32 v41, v41, v49
    v_mul_f32 v42, v42, v50
    v_mul_f32 v43, v43, v51
    v_mul_f32 v44, v44, v52
    v_mul_f32 v45, v45, v53
    v_mul_f32 v46, v46, v54
    v_mul_f32 v47, v47, v55
    v_cvt_pk_bf16_f32 v8, v40, v41
    v_cvt_pk_bf16_f32 v9, v42, v43
    v_cvt_pk_bf16_f32 v10, v44, v45
    v_cvt_pk_bf16_f32 v11, v46, v47
    v_lshlrev_b32 v40, 16, v12
    v_and_b32 v41, 0xffff0000, v12
    v_lshlrev_b32 v42, 16, v13
    v_and_b32 v43, 0xffff0000, v13
    v_lshlrev_b32 v44, 16, v14
    v_and_b32 v45, 0xffff0000, v14
    v_lshlrev_b32 v46, 16, v15
    v_and_b32 v47, 0xffff0000, v15
    v_mul_f32 v48, s62, v40
    v_mul_f32 v49, s62, v41
    v_mul_f32 v50, s62, v42
    v_mul_f32 v51, s62, v43
    v_mul_f32 v52, s62, v44
    v_mul_f32 v53, s62, v45
    v_mul_f32 v54, s62, v46
    v_mul_f32 v55, s62, v47
    v_exp_f32 v48, v48
    v_exp_f32 v49, v49
    v_exp_f32 v50, v50
    v_exp_f32 v51, v51
    v_exp_f32 v52, v52
    v_exp_f32 v53, v53
    v_exp_f32 v54, v54
    v_exp_f32 v55, v55
    v_add_f32 v48, 1.0, v48
    v_add_f32 v49, 1.0, v49
    v_add_f32 v50, 1.0, v50
    v_add_f32 v51, 1.0, v51
    v_add_f32 v52, 1.0, v52
    v_add_f32 v53, 1.0, v53
    v_add_f32 v54, 1.0, v54
    v_add_f32 v55, 1.0, v55
    v_rcp_f32 v48, v48
    v_rcp_f32 v49, v49
    v_rcp_f32 v50, v50
    v_rcp_f32 v51, v51
    v_rcp_f32 v52, v52
    v_rcp_f32 v53, v53
    v_rcp_f32 v54, v54
    v_rcp_f32 v55, v55
    v_mul_f32 v40, v40, v48
    v_mul_f32 v41, v41, v49
    v_mul_f32 v42, v42, v50
    v_mul_f32 v43, v43, v51
    v_mul_f32 v44, v44, v52
    v_mul_f32 v45, v45, v53
    v_mul_f32 v46, v46, v54
    v_mul_f32 v47, v47, v55
    v_cvt_pk_bf16_f32 v12, v40, v41
    v_cvt_pk_bf16_f32 v13, v42, v43
    v_cvt_pk_bf16_f32 v14, v44, v45
    v_cvt_pk_bf16_f32 v15, v46, v47
    s_mul_i32 s62, s3, 1344
    s_add_u32 s62, s62, 151552
    v_mul_u32_u24 v5, 336, v3
    v_and_b32 v6, 15, v0
    v_lshl_add_u32 v5, v6, 4, v5
    v_add_u32 v5, s62, v5
    ds_write_b128 v5, v[8:11]
    s_mov_b32 exec_lo, 0x000f000f
    s_mov_b32 exec_hi, 0x000f000f
    ds_write_b128 v5, v[12:15] offset:256
    s_mov_b64 exec, -1
    v_mul_u32_u24 v5, 336, v4
    v_lshl_add_u32 v5, v3, 4, v5
    v_add_u32 v5, s62, v5
    s_mov_b32 s59, 0.5
    s_cmp_eq_u32 s56, 0
    s_cbranch_scc1 L_u_nost
    s_waitcnt vmcnt(0)
    v_mov_b32 v40, 0
    v_mov_b32 v41, 0
    s_mov_b32 s62, 0x3f803f80
    v_dot2c_f32_bf16 v40, s62, v16
    v_dot2c_f32_bf16 v41, v16, v16
    v_dot2c_f32_bf16 v40, s62, v17
    v_dot2c_f32_bf16 v41, v17, v17
    v_dot2c_f32_bf16 v40, s62, v18
    v_dot2c_f32_bf16 v41, v18, v18
    v_dot2c_f32_bf16 v40, s62, v19
    v_dot2c_f32_bf16 v41, v19, v19
    v_dot2c_f32_bf16 v40, s62, v20
    v_dot2c_f32_bf16 v41, v20, v20
    v_dot2c_f32_bf16 v40, s62, v21
    v_dot2c_f32_bf16 v41, v21, v21
    v_dot2c_f32_bf16 v40, s62, v22
    v_dot2c_f32_bf16 v41, v22, v22
    v_dot2c_f32_bf16 v40, s62, v23
    v_dot2c_f32_bf16 v41, v23, v23
    v_dot2c_f32_bf16 v40, s62, v24
    v_dot2c_f32_bf16 v41, v24, v24
    v_dot2c_f32_bf16 v40, s62, v25
    v_dot2c_f32_bf16 v41, v25, v25
    v_dot2c_f32_bf16 v40, s62, v26
    v_dot2c_f32_bf16 v41, v26, v26
    v_dot2c_f32_bf16 v40, s62, v27
    v_dot2c_f32_bf16 v41, v27, v27
    v_dot2c_f32_bf16 v40, s62, v28
    v_dot2c_f32_bf16 v41, v28, v28
    v_dot2c_f32_bf16 v40, s62, v29
    v_dot2c_f32_bf16 v41, v29, v29
    v_dot2c_f32_bf16 v40, s62, v30
    v_dot2c_f32_bf16 v41, v30, v30
    v_dot2c_f32_bf16 v40, s62, v31
    v_dot2c_f32_bf16 v41, v31, v31
    v_dot2c_f32_bf16 v40, s62, v32
    v_dot2c_f32_bf16 v41, v32, v32
    v_dot2c_f32_bf16 v40, s62, v33
    v_dot2c_f32_bf16 v41, v33, v33
    v_dot2c_f32_bf16 v40, s62, v34
    v_dot2c_f32_bf16 v41, v34, v34
    v_dot2c_f32_bf16 v40, s62, v35
    v_dot2c_f32_bf16 v41, v35, v35
    s_nop 1
    v_add_f32_dpp v40, v40, v40 row_ror:4 row_mask:0xf bank_mask:0xf
    v_add_f32_dpp v41, v41, v41 row_ror:4 row_mask:0xf bank_mask:0xf
    s_nop 0
    v_add_f32_dpp v40, v40, v40 row_ror:8 row_mask:0xf bank_mask:0xf
    v_add_f32_dpp v41, v41, v41 row_ror:8 row_mask:0xf bank_mask:0xf
    v_mov_b32 v42, v40
    v_mov_b32 v43, v41
    s_nop 0
    v_permlane16_swap_b32 v40, v42
    v_permlane16_swap_b32 v41, v43
    v_add_f32 v40, v40, v42
    v_add_f32 v41, v41, v43
    v_mov_b32 v42, v40
    v_mov_b32 v43, v41
    s_nop 0
    v_permlane32_swap_b32 v40, v42
    v_permlane32_swap_b32 v41, v43
    v_add_f32 v40, v40, v42
    v_add_f32 v41, v41, v43
    s_mov_b32 s62, 0x3acccccd
    v_mul_f32 v40, s62, v40
    v_mul_f32 v41, s62, v41
    v_fma_f32 v41, -v40, v40, v41
    v_max_f32 v41, 0, v41
    v_add_f32 v41, 0x3727c5ac, v41
    v_rsq_f32 v41, v41
    v_lshlrev_b32 v56, 16, v66
    v_and_b32 v57, 0xffff0000, v66
    v_lshlrev_b32 v58, 16, v67
    v_and_b32 v59, 0xffff0000, v67
    v_sub_f32 v56, v56, v40
    v_sub_f32 v57, v57, v40
    v_sub_f32 v58, v58, v40
    v_sub_f32 v59, v59, v40
    v_mul_f32 v56, v56, v41
    v_mul_f32 v57, v57, v41
    v_mul_f32 v58, v58, v41
    v_mul_f32 v59, v59, v41
L_u_nost:
    ds_read_b128 v[8:11], v5 offset:0
    ds_read_b128 v[12:15], v5 offset:64
    ds_read_b128 v[16:19], v5 offset:128
    ds_read_b128 v[20:23], v5 offset:192
    ds_read_b128 v[24:27], v5 offset:256
    s_waitcnt vmcnt(0)
    s_branch L_u_frag
L_u_q2:
    s_mov_b32 s59, 1.0
L_wy_106:
    buffer_load_dword v37, v36, s[44:47], 0 offen offset:128 sc1
    s_waitcnt vmcnt(0)
    v_cmp_ne_u32 vcc, 20, v37
    s_cbranch_vccz L_wy_106e
    s_sleep 4
    s_sub_u32 s60, s60, 1
    s_cbranch_scc0 L_wy_106
    s_mov_b32 s60, 0
L_wy_106e:
L_u_frag:
    ds_read_b64_tr_b16 v[80:81], v60 offset:0
    ds_read_b64_tr_b16 v[82:83], v60 offset:512
    ds_read_b64_tr_b16 v[84:85], v61 offset:0
    ds_read_b64_tr_b16 v[86:87], v61 offset:512
    ds_read_b64_tr_b16 v[88:89], v62 offset:0
    ds_read_b64_tr_b16 v[90:91], v62 offset:512
    ds_read_b64_tr_b16 v[92:93], v63 offset:0
    ds_read_b64_tr_b16 v[94:95], v63 offset:512
    ds_read_b64_tr_b16 v[96:97], v60 offset:4096
    ds_read_b64_tr_b16 v[98:99], v60 offset:4608
    ds_read_b64_tr_b16 v[100:101], v61 offset:4096
    ds_read_b64_tr_b16 v[102:103], v61 offset:4608
    ds_read_b64_tr_b16 v[104:105], v62 offset:4096
    ds_read_b64_tr_b16 v[106:107], v62 offset:4608
    ds_read_b64_tr_b16 v[108:109], v63 offset:4096
    ds_read_b64_tr_b16 v[110:111], v63 offset:4608
    ds_read_b64_tr_b16 v[112:113], v60 offset:8192
    ds_read_b64_tr_b16 v[114:115], v60 offset:8704
    ds_read_b64_tr_b16 v[116:117], v61 offset:8192
    ds_read_b64_tr_b16 v[118:119], v61 offset:8704
    ds_read_b64_tr_b16 v[120:121], v62 offset:8192
    ds_read_b64_tr_b16 v[122:123], v62 offset:8704
    ds_read_b64_tr_b16 v[124:125], v63 offset:8192
    ds_read_b64_tr_b16 v[126:127], v63 offset:8704
    ds_read_b64_tr_b16 v[128:129], v60 offset:12288
    ds_read_b64_tr_b16 v[130:131], v60 offset:12800
    ds_read_b64_tr_b16 v[132:133], v61 offset:12288
    ds_read_b64_tr_b16 v[134:135], v61 offset:12800
    ds_read_b64_tr_b16 v[136:137], v62 offset:12288
    ds_read_b64_tr_b16 v[138:139], v62 offset:12800
    ds_read_b64_tr_b16 v[140:141], v63 offset:12288
    ds_read_b64_tr_b16 v[142:143], v63 offset:12800
    ds_read_b64_tr_b16 v[144:145], v60 offset:16384
    ds_read_b64_tr_b16 v[146:147], v60 offset:16896
    ds_read_b64_tr_b16 v[148:149], v61 offset:16384
    ds_read_b64_tr_b16 v[150:151], v61 offset:16896
    ds_read_b64_tr_b16 v[152:153], v62 offset:16384
    ds_read_b64_tr_b16 v[154:155], v62 offset:16896
    ds_read_b64_tr_b16 v[156:157], v63 offset:16384
    ds_read_b64_tr_b16 v[158:159], v63 offset:16896
    s_cmp_eq_u32 s97, 0
    s_cbranch_scc1 L_u_mm
    v_and_b32 v5, 7, v0
    v_mul_u32_u24 v5, 1280, v5
    v_lshl_add_u32 v5, v3, 4, v5
    s_mul_i32 s63, s3, 320
    s_add_u32 s63, s63, 32768
L_poll_107:
    buffer_load_dwordx4 v[8:11], v5, s[40:43], s63 offen offset:0 sc1
    buffer_load_dwordx4 v[12:15], v5, s[40:43], s63 offen offset:64 sc1
    buffer_load_dwordx4 v[16:19], v5, s[40:43], s63 offen offset:128 sc1
    buffer_load_dwordx4 v[20:23], v5, s[40:43], s63 offen offset:192 sc1
    buffer_load_dwordx4 v[24:27], v5, s[40:43], s63 offen offset:256 sc1
    s_waitcnt vmcnt(0)
    v_max3_u32 v37, v8, v9, v10
    v_max3_u32 v37, v37, v11, v12
    v_max3_u32 v37, v37, v13, v14
    v_max3_u32 v37, v37, v15, v16
    v_max3_u32 v37, v37, v17, v18
    v_max3_u32 v37, v37, v19, v20
    v_max3_u32 v37, v37, v21, v22
    v_max3_u32 v37, v37, v23, v24
    v_max3_u32 v37, v37, v25, v26
    v_max_u32 v37, v37, v27
    v_cmp_eq_u32 vcc, -1, v37
    s_cbranch_vccz L_poll_107e
    s_sleep 1
    s_sub_u32 s60, s60, 1
    s_cbranch_scc0 L_poll_107
    s_mov_b32 s60, 0
L_poll_107e:
L_u_mm:
    s_waitcnt lgkmcnt(0)
    v_mfma_f32_16x16x32_bf16 v[40:43], v[80:83], v[8:11], 0
    v_mfma_f32_16x16x32_bf16 v[44:47], v[84:87], v[8:11], 0
    v_mfma_f32_16x16x32_bf16 v[48:51], v[88:91], v[8:11], 0
    v_mfma_f32_16x16x32_bf16 v[52:55], v[92:95], v[8:11], 0
    v_mfma_f32_16x16x32_bf16 v[40:43], v[96:99], v[12:15], v[40:43]
    v_mfma_f32_16x16x32_bf16 v[44:47], v[100:103], v[12:15], v[44:47]
    v_mfma_f32_16x16x32_bf16 v[48:51], v[104:107], v[12:15], v[48:51]
    v_mfma_f32_16x16x32_bf16 v[52:55], v[108:111], v[12:15], v[52:55]
    v_mfma_f32_16x16x32_bf16 v[40:43], v[112:115], v[16:19], v[40:43]
    v_mfma_f32_16x16x32_bf16 v[44:47], v[116:119], v[16:19], v[44:47]
    v_mfma_f32_16x16x32_bf16 v[48:51], v[120:123], v[16:19], v[48:51]
    v_mfma_f32_16x16x32_bf16 v[52:55], v[124:127], v[16:19], v[52:55]
    v_mfma_f32_16x16x32_bf16 v[40:43], v[128:131], v[20:23], v[40:43]
    v_mfma_f32_16x16x32_bf16 v[44:47], v[132:135], v[20:23], v[44:47]
    v_mfma_f32_16x16x32_bf16 v[48:51], v[136:139], v[20:23], v[48:51]
    v_mfma_f32_16x16x32_bf16 v[52:55], v[140:143], v[20:23], v[52:55]
    v_mfma_f32_16x16x32_bf16 v[40:43], v[144:147], v[24:27], v[40:43]
    v_mfma_f32_16x16x32_bf16 v[44:47], v[148:151], v[24:27], v[44:47]
    v_mfma_f32_16x16x32_bf16 v[48:51], v[152:155], v[24:27], v[48:51]
    v_mfma_f32_16x16x32_bf16 v[52:55], v[156:159], v[24:27], v[52:55]
    v_lshlrev_b32 v5, 4, v0
    v_add_u32 v5, 147456, v5
    s_lshl_b32 s62, s3, 10
    v_add_u32 v6, s62, v5
    v_mov_b32 v32, 162056
    v_mov_b32 v33, 1
    v_add_f32_dpp v28, v40, v40 row_ror:4 row_mask:0xf bank_mask:0x1
    v_add_f32_dpp v29, v41, v41 row_ror:4 row_mask:0xf bank_mask:0x1
    v_add_f32_dpp v30, v42, v42 row_ror:4 row_mask:0xf bank_mask:0x1
    v_add_f32_dpp v31, v43, v43 row_ror:4 row_mask:0xf bank_mask:0x1
    v_add_f32_dpp v28, v44, v44 row_ror:4 row_mask:0xf bank_mask:0x2
    v_add_f32_dpp v29, v45, v45 row_ror:4 row_mask:0xf bank_mask:0x2
    v_add_f32_dpp v30, v46, v46 row_ror:4 row_mask:0xf bank_mask:0x2
    v_add_f32_dpp v31, v47, v47 row_ror:4 row_mask:0xf bank_mask:0x2
    v_add_f32_dpp v28, v48, v48 row_ror:4 row_mask:0xf bank_mask:0x4
    v_add_f32_dpp v29, v49, v49 row_ror:4 row_mask:0xf bank_mask:0x4
    v_add_f32_dpp v30, v50, v50 row_ror:4 row_mask:0xf bank_mask:0x4
    v_add_f32_dpp v31, v51, v51 row_ror:4 row_mask:0xf bank_mask:0x4
    v_add_f32_dpp v28, v52, v52 row_ror:4 row_mask:0xf bank_mask:0x8
    v_add_f32_dpp v29, v53, v53 row_ror:4 row_mask:0xf bank_mask:0x8
    v_add_f32_dpp v30, v54, v54 row_ror:4 row_mask:0xf bank_mask:0x8
    v_add_f32_dpp v31, v55, v55 row_ror:4 row_mask:0xf bank_mask:0x8
    ds_write_b128 v6, v[28:31]
    s_mov_b64 exec, 1
    ds_add_rtn_u32 v34, v32, v33
    s_mov_b64 exec, -1
    ds_read_b128 v[8:11], v5
    ds_read_b128 v[12:15], v5 offset:1024
    ds_read_b128 v[16:19], v5 offset:2048
    ds_read_b128 v[20:23], v5 offset:3072
    s_waitcnt lgkmcnt(0)
    v_readfirstlane_b32 s62, v34
    v_mov_b32 v24, s58
    s_cmp_lg_u32 s62, 3
    s_cbranch_scc1 L_end
    v_add_f32 v8, v8, v12
    v_add_f32 v16, v16, v20
    v_add_f32 v9, v9, v13
    v_add_f32 v17, v17, v21
    v_add_f32 v10, v10, v14
    v_add_f32 v18, v18, v22
    v_add_f32 v11, v11, v15
    v_add_f32 v19, v19, v23
    v_add_f32 v8, v8, v16
    v_add_f32 v9, v9, v17
    v_add_f32 v10, v10, v18
    v_add_f32 v11, v11, v19
    v_fma_f32 v8, v8, s59, v24
    v_fma_f32 v9, v9, s59, v24
    v_fma_f32 v10, v10, s59, v24
    v_fma_f32 v11, v11, s59, v24
    v_mul_f32 v8, v8, v56
    v_mul_f32 v9, v9, v57
    v_mul_f32 v10, v10, v58
    v_mul_f32 v11, v11, v59
    v_cvt_pk_bf16_f32 v8, v8, v9
    v_cvt_pk_bf16_f32 v9, v10, v11
    buffer_store_dwordx2 v[8:9], v64, s[40:43], s57 offen sc1
    s_endpgm
L_h_t1:
    s_cmp_lg_u32 s3, 3
    s_cbranch_scc1 L_h_noclr
    v_mov_b32 v4, -1
    v_mov_b32 v5, -1
    v_mov_b32 v6, -1
    v_mov_b32 v7, -1
    v_lshlrev_b32 v8, 4, v0
    s_mul_i32 s62, s34, 10
    s_add_u32 s62, s62, s35
    s_lshl_b32 s62, s62, 11
    s_add_u32 s62, s62, 20480
    buffer_store_dwordx4 v[4:7], v8, s[40:43], s62 offen sc1
    buffer_store_dwordx4 v[4:7], v8, s[40:43], s62 offen offset:1024 sc1
    v_mov_b32 v38, 0x10000
    s_waitcnt vmcnt(0)
    s_mov_b64 exec, 1
    buffer_atomic_add v38, v36, s[44:47], 0 offen sc1
    s_mov_b64 exec, -1
L_h_noclr:
    v_lshrrev_b32 v1, 3, v0
    v_mul_u32_u24 v1, 1280, v1
    v_and_b32 v2, 7, v0
    v_lshl_add_u32 v1, v2, 4, v1
    s_lshl2_add_u32 s63, s34, s3
    s_mul_i32 s63, s63, 163840
    s_lshl_b32 s62, s35, 7
    s_add_u32 s63, s63, s62
    s_sub_u32 s63, s63, 2816
    s_lshl_b32 s62, s3, 14
    s_add_u32 s62, s62, 81920
    s_mov_b32 m0, s62
    s_mov_b32 s48, s12
    s_mov_b32 s49, s13
    s_mov_b32 s50, 5242880
    s_mov_b32 s51, 0x20000
    s_add_u32 s100, s39, 1
    s_mov_b32 s62, 8
L_dma_108:
    buffer_load_dwordx4 v1, s[48:51], s63 offen nt lds
    s_add_u32 m0, m0, 1024
    s_add_u32 s63, s63, 10240
    s_cmp_eq_u32 s100, 0
    s_cbranch_scc1 L_dma_108n0
    s_waitcnt vmcnt(4)
    s_cmp_eq_u32 s100, 2
    s_cbranch_scc1 L_dma_108n0
    s_waitcnt vmcnt(1)
L_dma_108n0:
    buffer_load_dwordx4 v1, s[48:51], s63 offen nt lds
    s_add_u32 m0, m0, 1024
    s_add_u32 s63, s63, 10240
    s_cmp_eq_u32 s100, 0
    s_cbranch_scc1 L_dma_108n1
    s_waitcnt vmcnt(4)
    s_cmp_eq_u32 s100, 2
    s_cbranch_scc1 L_dma_108n1
    s_waitcnt vmcnt(1)
L_dma_108n1:
    s_sub_u32 s62, s62, 1
    s_cmp_lg_u32 s62, 0
    s_cbranch_scc1 L_dma_108
    s_cmp_eq_u32 s39, 1
    s_cbranch_scc1 L_h_role
    s_waitcnt vmcnt(0)
    v_mov_b32 v4, 162060
    v_mov_b32 v5, 1
    s_mov_b64 exec, 1
    ds_add_u32 v4, v5
    s_mov_b64 exec, -1
    s_endpgm
L_h_role:
    v_lshrrev_b32 v3, 4, v0
    v_and_b32 v2, 3, v0
    v_bfe_u32 v1, v0, 2, 2
    v_mul_u32_u24 v160, 2560, v2
    v_lshl_add_u32 v160, v1, 6, v160
    v_lshl_add_u32 v160, v3, 4, v160
    s_mul_i32 s57, s35, 10240
    s_mul_i32 s62, s3, 640
    s_add_u32 s57, s57, s62
    s_add_u32 s57, s57, 262144
    v_mov_b32 v4, -1
    v_mov_b32 v5, -1
    v_mov_b32 v6, -1
    v_mov_b32 v7, -1
    buffer_store_dwordx4 v[4:7], v160, s[40:43], s57 offen sc1
    buffer_store_dwordx4 v[4:7], v160, s[40:43], s57 offen offset:256 sc1
    s_mov_b32 exec_lo, 0x00ff00ff
    s_mov_b32 exec_hi, 0x00ff00ff
    buffer_store_dwordx4 v[4:7], v160, s[40:43], s57 offen offset:512 sc1
    s_mov_b64 exec, -1
    v_add_u32 v8, 0, v0
    v_mul_u32_u24 v10, 0xccd, v8
    v_lshrrev_b32 v10, 16, v10
    v_mul_u32_u24 v9, 20, v10
    v_sub_u32 v8, v8, v9
    v_mul_u32_u24 v10, 1280, v10
    v_lshl_add_u32 v10, v8, 4, v10
    v_add_u32 v8, 64, v0
    v_mul_u32_u24 v11, 0xccd, v8
    v_lshrrev_b32 v11, 16, v11
    v_mul_u32_u24 v9, 20, v11
    v_sub_u32 v8, v8, v9
    v_mul_u32_u24 v11, 1280, v11
    v_lshl_add_u32 v11, v8, 4, v11
    v_add_u32 v8, 128, v0
    v_mul_u32_u24 v12, 0xccd, v8
    v_lshrrev_b32 v12, 16, v12
    v_mul_u32_u24 v9, 20, v12
    v_sub_u32 v8, v8, v9
    v_mul_u32_u24 v12, 1280, v12
    v_lshl_add_u32 v12, v8, 4, v12
    v_add_u32 v8, 192, v0
    v_mul_u32_u24 v13, 0xccd, v8
    v_lshrrev_b32 v13, 16, v13
    v_mul_u32_u24 v9, 20, v13
    v_sub_u32 v8, v8, v9
    v_mul_u32_u24 v13, 1280, v13
    v_lshl_add_u32 v13, v8, 4, v13
    v_add_u32 v8, 256, v0
    v_mul_u32_u24 v14, 0xccd, v8
    v_lshrrev_b32 v14, 16, v14
    v_mul_u32_u24 v9, 20, v14
    v_sub_u32 v8, v8, v9
    v_mul_u32_u24 v14, 1280, v14
    v_lshl_add_u32 v14, v8, 4, v14
    s_waitcnt vmcnt(0)
    v_mov_b32 v8, 162060
    v_mov_b32 v9, 1
    s_mov_b64 exec, 1
    ds_add_u32 v8, v9
    s_mov_b64 exec, -1
    s_mov_b32 s48, s20
    s_mov_b32 s49, s21
    s_mov_b32 s50, 2211840
    s_mov_b32 s51, 0x20000
    s_mul_i32 s63, s35, 81920
    s_mul_i32 s62, s3, 320
    s_add_u32 s63, s63, s62
    s_mov_b32 m0, s101
    s_mov_b32 s62, 4
L_w2dma:
    buffer_load_dwordx4 v10, s[48:51], s63 offen nt lds
    s_add_u32 m0, m0, 1024
    s_waitcnt vmcnt(4)
    s_cmp_ge_u32 s35, 22
    s_cbranch_scc1 L_w2n0
    s_waitcnt vmcnt(2)
L_w2n0:
    buffer_load_dwordx4 v11, s[48:51], s63 offen nt lds
    s_add_u32 m0, m0, 1024
    s_waitcnt vmcnt(4)
    s_cmp_ge_u32 s35, 22
    s_cbranch_scc1 L_w2n1
    s_waitcnt vmcnt(2)
L_w2n1:
    buffer_load_dwordx4 v12, s[48:51], s63 offen nt lds
    s_add_u32 m0, m0, 1024
    s_waitcnt vmcnt(4)
    s_cmp_ge_u32 s35, 22
    s_cbranch_scc1 L_w2n2
    s_waitcnt vmcnt(2)
L_w2n2:
    buffer_load_dwordx4 v13, s[48:51], s63 offen nt lds
    s_add_u32 m0, m0, 1024
    s_waitcnt vmcnt(4)
    s_cmp_ge_u32 s35, 22
    s_cbranch_scc1 L_w2n3
    s_waitcnt vmcnt(2)
L_w2n3:
    buffer_load_dwordx4 v14, s[48:51], s63 offen nt lds
    s_add_u32 m0, m0, 1024
    s_waitcnt vmcnt(4)
    s_cmp_ge_u32 s35, 22
    s_cbranch_scc1 L_w2n4
    s_waitcnt vmcnt(2)
L_w2n4:
    s_add_u32 s63, s63, 20480
    s_sub_u32 s62, s62, 1
    s_cmp_lg_u32 s62, 0
    s_cbranch_scc1 L_w2dma
    v_lshl_add_u32 v8, v3, 3, v1
    v_mul_u32_u24 v8, 320, v8
    v_lshl_add_u32 v8, v2, 3, v8
    v_add_u32 v8, s101, v8
    s_waitcnt vmcnt(0)
    ds_read_b64_tr_b16 v[80:81], v8 offset:0
    ds_read_b64_tr_b16 v[82:83], v8 offset:1280
    ds_read_b64_tr_b16 v[84:85], v8 offset:10240
    ds_read_b64_tr_b16 v[86:87], v8 offset:11520
    ds_read_b64_tr_b16 v[88:89], v8 offset:32
    ds_read_b64_tr_b16 v[90:91], v8 offset:1312
    ds_read_b64_tr_b16 v[92:93], v8 offset:10272
    ds_read_b64_tr_b16 v[94:95], v8 offset:11552
    ds_read_b64_tr_b16 v[96:97], v8 offset:64
    ds_read_b64_tr_b16 v[98:99], v8 offset:1344
    ds_read_b64_tr_b16 v[100:101], v8 offset:10304
    ds_read_b64_tr_b16 v[102:103], v8 offset:11584
    ds_read_b64_tr_b16 v[104:105], v8 offset:96
    ds_read_b64_tr_b16 v[106:107], v8 offset:1376
    ds_read_b64_tr_b16 v[108:109], v8 offset:10336
    ds_read_b64_tr_b16 v[110:111], v8 offset:11616
    ds_read_b64_tr_b16 v[112:113], v8 offset:128
    ds_read_b64_tr_b16 v[114:115], v8 offset:1408
    ds_read_b64_tr_b16 v[116:117], v8 offset:10368
    ds_read_b64_tr_b16 v[118:119], v8 offset:11648
    ds_read_b64_tr_b16 v[120:121], v8 offset:160
    ds_read_b64_tr_b16 v[122:123], v8 offset:1440
    ds_read_b64_tr_b16 v[124:125], v8 offset:10400
    ds_read_b64_tr_b16 v[126:127], v8 offset:11680
    ds_read_b64_tr_b16 v[128:129], v8 offset:192
    ds_read_b64_tr_b16 v[130:131], v8 offset:1472
    ds_read_b64_tr_b16 v[132:133], v8 offset:10432
    ds_read_b64_tr_b16 v[134:135], v8 offset:11712
    ds_read_b64_tr_b16 v[136:137], v8 offset:224
    ds_read_b64_tr_b16 v[138:139], v8 offset:1504
    ds_read_b64_tr_b16 v[140:141], v8 offset:10464
    ds_read_b64_tr_b16 v[142:143], v8 offset:11744
    ds_read_b64_tr_b16 v[144:145], v8 offset:256
    ds_read_b64_tr_b16 v[146:147], v8 offset:1536
    ds_read_b64_tr_b16 v[148:149], v8 offset:10496
    ds_read_b64_tr_b16 v[150:151], v8 offset:11776
    ds_read_b64_tr_b16 v[152:153], v8 offset:288
    ds_read_b64_tr_b16 v[154:155], v8 offset:1568
    ds_read_b64_tr_b16 v[156:157], v8 offset:10528
    ds_read_b64_tr_b16 v[158:159], v8 offset:11808
    s_mov_b32 s48, s16
    s_mov_b32 s49, s17
    s_mov_b32 s50, 2211840
    s_mov_b32 s51, 0x20000
    s_lshl_b32 s98, s35, 7
    s_mov_b32 s99, 3456
    v_lshrrev_b32 v9, 3, v0
    v_mul_lo_u32 v10, v9, s99
    v_and_b32 v9, 2, v9
    v_xor_b32 v9, v9, v0
    v_and_b32 v9, 7, v9
    v_lshl_add_u32 v10, v9, 4, v10
    v_add_u32 v10, s98, v10
    v_xor_b32 v11, 64, v10
    s_mul_i32 s63, s3, 552960
    s_mov_b32 m0, s101
    s_waitcnt lgkmcnt(0)
    s_cmp_ge_u32 s35, 22
    s_cselect_b32 s100, 2, 1
    s_mov_b32 s62, 10
L_dma_109:
    buffer_load_dwordx4 v10, s[48:51], s63 offen nt lds
    s_add_u32 m0, m0, 1024
    s_add_u32 s63, s63, 27648
    s_cmp_eq_u32 s100, 0
    s_cbranch_scc1 L_dma_109n0
    s_waitcnt vmcnt(4)
    s_cmp_eq_u32 s100, 2
    s_cbranch_scc1 L_dma_109n0
    s_waitcnt vmcnt(2)
L_dma_109n0:
    buffer_load_dwordx4 v11, s[48:51], s63 offen nt lds
    s_add_u32 m0, m0, 1024
    s_add_u32 s63, s63, 27648
    s_cmp_eq_u32 s100, 0
    s_cbranch_scc1 L_dma_109n1
    s_waitcnt vmcnt(4)
    s_cmp_eq_u32 s100, 2
    s_cbranch_scc1 L_dma_109n1
    s_waitcnt vmcnt(2)
L_dma_109n1:
    s_sub_u32 s62, s62, 1
    s_cmp_lg_u32 s62, 0
    s_cbranch_scc1 L_dma_109
L_wy_110:
    buffer_load_dword v37, v36, s[44:47], 0 offen offset:0 sc1
    s_waitcnt vmcnt(0)
    v_cmp_ne_u32 vcc, 5253184, v37
    s_cbranch_vccz L_wy_110e
    s_sleep 4
    s_sub_u32 s60, s60, 1
    s_cbranch_scc0 L_wy_110
    s_mov_b32 s60, 0
L_wy_110e:
    s_cmp_lg_u32 s3, 3
    s_cbranch_scc1 L_h_nomo
    v_and_b32 v4, 15, v0
    v_lshlrev_b32 v4, 4, v4
    v_mul_u32_u24 v5, 1280, v3
    v_add_u32 v5, v5, v4
    v_mul_u32_u24 v6, 1296, v3
    v_add_u32 v6, v6, v4
    v_add_u32 v6, 147456, v6
    s_mov_b32 s62, 53248
    s_mov_b32 s63, 48128
L_poll_111:
    buffer_load_dwordx4 v[40:43], v5, s[40:43], s62 offen offset:0 sc1
    buffer_load_dwordx4 v[44:47], v5, s[40:43], s62 offen offset:256 sc1
    buffer_load_dwordx4 v[48:51], v5, s[40:43], s62 offen offset:512 sc1
    buffer_load_dwordx4 v[52:55], v5, s[40:43], s62 offen offset:768 sc1
    buffer_load_dwordx4 v[56:59], v5, s[40:43], s62 offen offset:1024 sc1
    buffer_load_dwordx4 v[60:63], v5, s[40:43], s63 offen offset:0 sc1
    buffer_load_dwordx4 v[64:67], v5, s[40:43], s63 offen offset:256 sc1
    buffer_load_dwordx4 v[68:71], v5, s[40:43], s63 offen offset:512 sc1
    buffer_load_dwordx4 v[72:75], v5, s[40:43], s63 offen offset:768 sc1
    buffer_load_dwordx4 v[76:79], v5, s[40:43], s63 offen offset:1024 sc1
    s_waitcnt vmcnt(0)
    v_max3_u32 v7, v40, v41, v42
    v_max3_u32 v7, v7, v43, v44
    v_max3_u32 v7, v7, v45, v46
    v_max3_u32 v7, v7, v47, v48
    v_max3_u32 v7, v7, v49, v50
    v_max3_u32 v7, v7, v51, v52
    v_max3_u32 v7, v7, v53, v54
    v_max3_u32 v7, v7, v55, v56
    v_max3_u32 v7, v7, v57, v58
    v_max3_u32 v7, v7, v59, v60
    v_max3_u32 v7, v7, v61, v62
    v_max3_u32 v7, v7, v63, v64
    v_max3_u32 v7, v7, v65, v66
    v_max3_u32 v7, v7, v67, v68
    v_max3_u32 v7, v7, v69, v70
    v_max3_u32 v7, v7, v71, v72
    v_max3_u32 v7, v7, v73, v74
    v_max3_u32 v7, v7, v75, v76
    v_max3_u32 v7, v7, v77, v78
    v_max_u32 v7, v7, v79
    v_cmp_eq_u32 vcc, -1, v7
    s_cbranch_vccz L_poll_111e
    s_sleep 8
    s_sub_u32 s60, s60, 1
    s_cbranch_scc0 L_poll_111
    s_mov_b32 s60, 0
L_poll_111e:
    ds_write_b128 v6, v[40:43] offset:0
    ds_write_b128 v6, v[44:47] offset:256
    ds_write_b128 v6, v[48:51] offset:512
    ds_write_b128 v6, v[52:55] offset:768
    ds_write_b128 v6, v[56:59] offset:1024
    ds_write_b128 v6, v[60:63] offset:5184
    ds_write_b128 v6, v[64:67] offset:5440
    ds_write_b128 v6, v[68:71] offset:5696
    ds_write_b128 v6, v[72:75] offset:5952
    ds_write_b128 v6, v[76:79] offset:6208
L_h_nomo:
    v_mul_u32_u24 v4, 144, v2
    v_lshl_add_u32 v4, v3, 4, v4
    v_add_u32 v4, 97600, v4
    v_mov_b32 v5, 161920
    v_cmp_eq_u32 vcc, 0, v1
    s_nop 1
    v_cndmask_b32 v161, v5, v4, vcc
    v_cmp_eq_u32 vcc, 1, v1
    s_nop 1
    v_cndmask_b32 v162, v5, v4, vcc
    v_cmp_eq_u32 vcc, 2, v1
    s_nop 1
    v_cndmask_b32 v163, v5, v4, vcc
    v_cmp_eq_u32 vcc, 3, v1
    s_nop 1
    v_cndmask_b32 v164, v5, v4, vcc
    s_waitcnt vmcnt(0) lgkmcnt(0)
    v_mov_b32 v8, 162064
    v_mov_b32 v9, 1
    s_mov_b64 exec, 1
    ds_add_u32 v8, v9
    s_mov_b64 exec, -1
    s_mov_b32 s100, s3
    s_lshl_b32 s63, s100, 8
    v_and_b32 v8, 15, v0
    v_lshl_add_u32 v8, v8, 4, s63
    v_lshrrev_b32 v9, 4, v0
    v_mul_u32_u24 v5, 1280, v9
    v_add_u32 v5, v5, v8
    v_mul_u32_u24 v4, 1296, v9
    v_add_u32 v4, v4, v8
    v_add_u32 v4, 81920, v4
    v_lshlrev_b32 v6, 1, v5
    v_add_u32 v6, 87104, v6
    s_lshl_b32 s62, s100, 3
    s_add_u32 s62, s62, 97344
    v_lshl_add_u32 v7, v9, 6, s62
    s_mov_b32 s48, s4
    s_mov_b32 s49, s5
    s_mov_b32 s50, 5120
    s_mov_b32 s51, 0x20000
    buffer_load_dwordx4 v[8:11], v5, s[48:51], 0 offen
    s_mov_b32 s62, 43008
    s_mov_b32 s63, 53248
L_poll_112:
    buffer_load_dwordx4 v[12:15], v5, s[40:43], s62 offen sc1
    buffer_load_dwordx4 v[16:19], v5, s[40:43], s63 offen sc1
    s_waitcnt vmcnt(0)
    v_max3_u32 v38, v12, v13, v14
    v_max3_u32 v38, v38, v15, v16
    v_max3_u32 v38, v38, v17, v18
    v_max_u32 v38, v38, v19
    v_cmp_eq_u32 vcc, -1, v38
    s_cbranch_vccz L_poll_112e
    s_sleep 8
    s_sub_u32 s60, s60, 1
    s_cbranch_scc0 L_poll_112
    s_mov_b32 s60, 0
L_poll_112e:
    v_lshlrev_b32 v40, 16, v8
    v_and_b32 v41, 0xffff0000, v8
    v_lshlrev_b32 v42, 16, v9
    v_and_b32 v43, 0xffff0000, v9
    v_lshlrev_b32 v44, 16, v10
    v_and_b32 v45, 0xffff0000, v10
    v_lshlrev_b32 v46, 16, v11
    v_and_b32 v47, 0xffff0000, v11
    v_lshlrev_b32 v48, 16, v12
    v_and_b32 v49, 0xffff0000, v12
    v_lshlrev_b32 v50, 16, v13
    v_and_b32 v51, 0xffff0000, v13
    v_lshlrev_b32 v52, 16, v14
    v_and_b32 v53, 0xffff0000, v14
    v_lshlrev_b32 v54, 16, v15
    v_and_b32 v55, 0xffff0000, v15
    v_lshlrev_b32 v56, 16, v16
    v_and_b32 v57, 0xffff0000, v16
    v_lshlrev_b32 v58, 16, v17
    v_and_b32 v59, 0xffff0000, v17
    v_lshlrev_b32 v60, 16, v18
    v_and_b32 v61, 0xffff0000, v18
    v_lshlrev_b32 v62, 16, v19
    v_and_b32 v63, 0xffff0000, v19
    v_mov_b32 v64, 0
    v_mov_b32 v65, 0
    v_mov_b32 v66, 0
    v_mov_b32 v67, 0
    v_mov_b32 v68, 0
    v_mov_b32 v69, 0
    v_mov_b32 v70, 0
    v_mov_b32 v71, 0
    v_mov_b32 v8, 162048
L_lw_113:
    ds_read_b32 v9, v8
    s_waitcnt lgkmcnt(0)
    v_cmp_gt_u32 vcc, 1, v9
    s_cbranch_vccz L_lw_113e
    s_sleep 8
    s_sub_u32 s60, s60, 1
    s_cbranch_scc0 L_lw_113
    s_mov_b32 s60, 0
L_lw_113e:
    v_and_b32 v38, 31, v0
    v_lshlrev_b32 v38, 2, v38
    s_lshl_b32 s63, s34, 7
    s_add_u32 s63, s63, 204800
    buffer_load_dword v37, v38, s[40:43], s63 offen sc1
    s_waitcnt vmcnt(0)
    s_getreg_b32 s62, hwreg(HW_REG_XCC_ID, 0, 4)
    v_cmp_ne_u32 vcc, s62, v37
    s_nop 0
    s_cmp_eq_u64 vcc, 0
    s_cselect_b32 s61, 1, 0
    s_branch L_t2gate
L_ffn2:
    s_barrier
    s_barrier
    ds_read_b128 v[8:11], v161 offset:0
    ds_read_b128 v[12:15], v161 offset:64
    ds_read_b128 v[16:19], v162 offset:0
    ds_read_b128 v[20:23], v162 offset:64
    ds_read_b128 v[24:27], v163 offset:0
    ds_read_b128 v[28:31], v163 offset:64
    ds_read_b128 v[32:35], v164 offset:0
    ds_read_b128 v[36:39], v164 offset:64
    s_waitcnt lgkmcnt(7)
    v_mfma_f32_16x16x32_bf16 v[40:43], v[80:83], v[8:11], 0
    s_waitcnt lgkmcnt(6)
    v_mfma_f32_16x16x32_bf16 v[40:43], v[84:87], v[12:15], v[40:43]
    s_waitcnt lgkmcnt(5)
    v_mfma_f32_16x16x32_bf16 v[40:43], v[88:91], v[16:19], v[40:43]
    s_waitcnt lgkmcnt(4)
    v_mfma_f32_16x16x32_bf16 v[40:43], v[92:95], v[20:23], v[40:43]
    s_waitcnt lgkmcnt(3)
    v_mfma_f32_16x16x32_bf16 v[40:43], v[96:99], v[24:27], v[40:43]
    s_waitcnt lgkmcnt(2)
    v_mfma_f32_16x16x32_bf16 v[40:43], v[100:103], v[28:31], v[40:43]
    s_waitcnt lgkmcnt(1)
    v_mfma_f32_16x16x32_bf16 v[40:43], v[104:107], v[32:35], v[40:43]
    s_waitcnt lgkmcnt(0)
    v_mfma_f32_16x16x32_bf16 v[40:43], v[108:111], v[36:39], v[40:43]
    v_mfma_f32_16x16x32_bf16 v[44:47], v[112:115], v[8:11], 0
    v_mfma_f32_16x16x32_bf16 v[44:47], v[116:119], v[12:15], v[44:47]
    v_mfma_f32_16x16x32_bf16 v[44:47], v[120:123], v[16:19], v[44:47]
    v_mfma_f32_16x16x32_bf16 v[44:47], v[124:127], v[20:23], v[44:47]
    v_mfma_f32_16x16x32_bf16 v[44:47], v[128:131], v[24:27], v[44:47]
    v_mfma_f32_16x16x32_bf16 v[44:47], v[132:135], v[28:31], v[44:47]
    v_mfma_f32_16x16x32_bf16 v[44:47], v[136:139], v[32:35], v[44:47]
    v_mfma_f32_16x16x32_bf16 v[44:47], v[140:143], v[36:39], v[44:47]
    s_cmp_eq_u32 s61, 1
    s_cbranch_scc1 L_st_114f
    buffer_store_dwordx4 v[40:43], v160, s[40:43], s57 offen sc1
    s_branch L_st_114e
L_st_114f:
    buffer_store_dwordx4 v[40:43], v160, s[40:43], s57 offen
L_st_114e:
    v_mfma_f32_16x16x32_bf16 v[48:51], v[144:147], v[8:11], 0
    v_mfma_f32_16x16x32_bf16 v[48:51], v[148:151], v[12:15], v[48:51]
    v_mfma_f32_16x16x32_bf16 v[48:51], v[152:155], v[16:19], v[48:51]
    v_mfma_f32_16x16x32_bf16 v[48:51], v[156:159], v[20:23], v[48:51]
    s_cmp_eq_u32 s61, 1
    s_cbranch_scc1 L_st_115f
    buffer_store_dwordx4 v[44:47], v160, s[40:43], s57 offen offset:256 sc1
    s_branch L_st_115e
L_st_115f:
    buffer_store_dwordx4 v[44:47], v160, s[40:43], s57 offen offset:256
L_st_115e:
    s_mov_b32 exec_lo, 0x00ff00ff
    s_mov_b32 exec_hi, 0x00ff00ff
    s_cmp_eq_u32 s61, 1
    s_cbranch_scc1 L_st_116f
    s_nop 0
    buffer_store_dwordx4 v[48:51], v160, s[40:43], s57 offen offset:512 sc1
    s_branch L_st_116e
L_st_116f:
    s_nop 0
    buffer_store_dwordx4 v[48:51], v160, s[40:43], s57 offen offset:512
L_st_116e:
L_end:
    s_endpgm
L_codeend:
.section .rodata,"a"
.p2align 6
.amdhsa_kernel adaLN_cond__sliding_block_cached__dense_activation_gelu__decode_kernel
  .amdhsa_next_free_vgpr 168
  .amdhsa_next_free_sgpr 102
  .amdhsa_accum_offset 168
  .amdhsa_group_segment_fixed_size 0
  .amdhsa_kernarg_size 120
  .amdhsa_user_sgpr_count 2
  .amdhsa_user_sgpr_kernarg_segment_ptr 1
  .amdhsa_system_sgpr_workgroup_id_x 1
.end_amdhsa_kernel
```

```asm
; @launch grid=(256,1,1) block=(768,1,1) lds=162176
.amdgcn_target "amdgcn-amd-amdhsa--gfx950"
.text
.globl adaLN_cond__sliding_block_cached__dense_activation_gelu__decode_kernel
.p2align 8
.type adaLN_cond__sliding_block_cached__dense_activation_gelu__decode_kernel,@function
adaLN_cond__sliding_block_cached__dense_activation_gelu__decode_kernel:
    s_cmp_ge_u32 s2, 256
    s_cbranch_scc1 L_end
    s_load_dwordx16 s[4:19], s[0:1], 0
    s_load_dwordx8 s[20:27], s[0:1], 64
    s_load_dwordx4 s[28:31], s[0:1], 96
    s_load_dwordx2 s[32:33], s[0:1], 112
    v_lshrrev_b32 v1, 6, v0
    v_lshlrev_b32 v2, 4, v0
    v_readfirstlane_b32 s3, v1
    v_and_b32 v0, 63, v0
    s_and_b32 s34, s2, 7
    s_lshr_b32 s35, s2, 3
    s_cmp_lg_u32 s35, 21
    s_cbranch_scc1 L_nopf
    s_getpc_b64 s[48:49]
    s_and_b32 s48, s48, 0xffffff00
    s_mov_b32 s50, L_codeend-adaLN_cond__sliding_block_cached__dense_activation_gelu__decode_kernel
    s_mov_b32 s51, 0x20000
    s_mov_b32 s52, 12288
    buffer_load_dwordx4 v[152:155], v2, s[48:51], 0 offen
    buffer_load_dwordx4 v[156:159], v2, s[48:51], s52 offen
L_nopf:
    s_lshr_b32 s36, s35, 3
    s_lshl2_add_u32 s36, s34, s36
    s_bfe_u32 s37, s35, 0x20001
    s_and_b32 s38, s35, 1
    s_cmp_lt_u32 s35, 27
    s_cselect_b32 s39, 1, 0
    s_cmp_eq_u32 s34, 2
    s_cselect_b32 s39, s39, 0
    s_sub_u32 s62, s34, 3
    s_and_b32 s62, s62, 7
    s_mul_i32 s56, s35, 7
    s_add_u32 s56, s56, s62
    s_cmp_eq_u32 s62, 7
    s_cselect_b32 s56, 255, s56
    s_mov_b32 s60, 400000
    s_mov_b32 s61, 0
    v_mov_b32 v36, 0
    s_waitcnt lgkmcnt(0)
    s_mov_b32 s40, s32
    s_mov_b32 s41, s33
    s_mov_b32 s42, 589824
    s_mov_b32 s43, 0x20000
    s_mov_b32 s44, s30
    s_mov_b32 s45, s31
    s_mov_b32 s46, 256
    s_mov_b32 s47, 0x20000
    s_cmp_lt_u32 s3, 4
    s_cbranch_scc1 L_helpers
    s_sub_u32 s3, s3, 4
    s_cmp_ge_u32 s35, 22
    s_cselect_b32 s59, 1, 0
    s_mov_b32 s13, 0
    s_add_u32 s62, s3, s59
    s_cmp_ge_u32 s62, 6
    s_cselect_b32 s62, s39, 0
    s_cmp_eq_u32 s62, 1
    s_cbranch_scc1 L_proxy
    s_cmp_eq_u32 s59, 1
    s_cselect_b32 s12, 0, 81920
    s_lshl_b32 s62, s3, 13
    s_add_u32 s12, s12, s62
    s_and_b32 s62, s39, s59
    s_cselect_b32 s12, -1, s12
L_stream:
    s_lshl_b32 s62, s37, 5
    s_add_u32 s62, s62, s36
    s_lshl_b32 s63, s62, 21
    s_lshl_b32 s96, s38, 18
    s_add_u32 s63, s63, s96
    s_add_u32 s63, s63, 1572864
    s_add_u32 s48, s6, s63
    s_addc_u32 s49, s7, 0
    s_mov_b32 s50, 262144
    s_mov_b32 s51, 0x20000
    v_lshlrev_b32 v1, 4, v0
    s_lshl_b32 s96, s3, 12
    v_add_u32 v1, s96, v1
    s_mov_b32 s97, 0
    s_cmp_lt_u32 s56, 84
    s_cbranch_scc0 L_nob0
    s_barrier
L_nob0:
    buffer_load_dwordx4 v[40:43], v1, s[48:51], s97 offen offset:0 nt
    buffer_load_dwordx4 v[44:47], v1, s[48:51], s97 offen offset:1024 nt
    s_bitcmp1_b32 s3, 0
    s_mov_b32 s57, 0xffffffff
    s_mov_b32 s58, 0xff00ff
    s_cselect_b32 s58, 0xff00ff00, s58
    s_mov_b32 s14, 0xffffffff
    s_mov_b32 s15, 0x0
L_pm_1:
    s_cmp_lt_u32 s56, 84
    s_cbranch_scc0 L_pm_2
    s_bitcmp1_b32 s3, 0
    s_mov_b32 s57, 0xffff
    s_mov_b32 s58, 0x0
    s_mov_b32 s14, 0xffffffff
    s_mov_b32 s15, 0x0
L_pm_2:
    s_sub_u32 s96, s56, 23
    s_and_b32 s96, s96, 0xffffffc7
    s_cmp_eq_u32 s96, 0
    s_cbranch_scc0 L_pm_3
    s_bitcmp1_b32 s3, 0
    s_mov_b32 s57, 0x0
    s_mov_b32 s58, 0x0
    s_mov_b32 s14, 0x0
    s_mov_b32 s15, 0x0
L_pm_3:
    s_cmp_lt_u32 s56, 20
    s_cbranch_scc0 L_pm_4
    s_bitcmp1_b32 s3, 0
    s_mov_b32 s57, 0xf000000f
    s_mov_b32 s58, 0xf
    s_mov_b32 s14, 0xffffffff
    s_mov_b32 s15, 0x0
L_pm_4:
    s_cmp_eq_u32 s39, 1
    s_cbranch_scc0 L_pm_5
    s_bitcmp1_b32 s3, 0
    s_mov_b32 s57, 0xffffffff
    s_mov_b32 s58, 0x0
    s_mov_b32 s14, 0xffffffff
    s_mov_b32 s15, 0x0
L_pm_5:
    s_cmp_lg_u32 s13, 0
    s_cbranch_scc0 L_pm_6
    s_bitcmp1_b32 s3, 0
    s_mov_b32 s57, 0x0
    s_mov_b32 s58, 0x0
    s_mov_b32 s14, 0x0
    s_mov_b32 s15, 0x0
L_pm_6:
    s_and_b32 s96, s39, s59
    s_cbranch_scc0 L_pm_7
    s_bitcmp1_b32 s3, 0
    s_mov_b32 s57, 0xffffffff
    s_mov_b32 s58, 0x0
    s_mov_b32 s14, 0x0
    s_mov_b32 s15, 0x0
L_pm_7:
    s_cmp_lt_u32 s56, 84
    s_cbranch_scc1 L_nob1
    s_barrier
L_nob1:
    s_add_u32 s52, s8, s63
    s_addc_u32 s53, s9, 0
    s_mov_b32 s54, 262144
    s_mov_b32 s55, 0x20000
    v_and_b32 v2, 15, v0
    v_lshrrev_b32 v3, 1, v2
    v_and_b32 v37, 1, v2
    v_lshlrev_b32 v37, 4, v37
    v_mov_b32 v38, 0xffff
    v_lshlrev_b32 v37, v37, v38
    v_cmp_eq_u32 vcc, 0, v3
    v_mov_b32 v32, 0
    s_nop 0
    v_cndmask_b32 v20, 0, v37, vcc
    v_cmp_eq_u32 vcc, 1, v3
    v_mov_b32 v33, 0
    s_nop 0
    v_cndmask_b32 v21, 0, v37, vcc
    v_cmp_eq_u32 vcc, 2, v3
    v_mov_b32 v34, 0
    s_nop 0
    v_cndmask_b32 v22, 0, v37, vcc
    v_cmp_eq_u32 vcc, 3, v3
    v_mov_b32 v35, 0
    s_nop 0
    v_cndmask_b32 v23, 0, v37, vcc
    v_lshlrev_b32 v2, 4, v2
    s_lshl_b32 s98, s62, 8
    s_add_u32 s98, s98, 32768
    s_lshl_b32 s99, s62, 7
    s_add_u32 s99, s99, 65536
    s_bitcmp0_b32 s57, 2
    s_cbranch_scc1 L_sf_8
    s_bitcmp0_b32 s58, 2
    s_cbranch_scc1 L_sf_8
    s_waitcnt vmcnt(1)
L_sf_8:
    buffer_load_dwordx4 v[48:51], v1, s[48:51], s97 offen offset:2048 nt
    s_bitcmp0_b32 s57, 3
    s_cbranch_scc1 L_sf_9
    s_waitcnt vmcnt(2)
    s_bitcmp0_b32 s58, 3
    s_cbranch_scc1 L_sf_9
    s_waitcnt vmcnt(1)
L_sf_9:
    buffer_load_dwordx4 v[52:55], v1, s[48:51], s97 offen offset:3072 nt
    s_add_u32 s97, s97, 32768
    v_add_u32 v1, 4096, v1
    v_and_b32 v1, 0x7fff, v1
    s_waitcnt vmcnt(3)
    s_bitcmp0_b32 s57, 4
    s_cbranch_scc1 L_sf_10
    s_waitcnt vmcnt(2)
    s_bitcmp0_b32 s58, 4
    s_cbranch_scc1 L_sf_10
    s_waitcnt vmcnt(1)
L_sf_10:
    buffer_load_dwordx4 v[56:59], v1, s[48:51], s97 offen offset:0 nt
    s_waitcnt vmcnt(3)
    s_bitcmp0_b32 s57, 5
    s_cbranch_scc1 L_sf_11
    s_waitcnt vmcnt(2)
    s_bitcmp0_b32 s58, 5
    s_cbranch_scc1 L_sf_11
    s_waitcnt vmcnt(1)
L_sf_11:
    buffer_load_dwordx4 v[60:63], v1, s[48:51], s97 offen offset:1024 nt
    s_waitcnt vmcnt(3)
    s_bitcmp0_b32 s57, 6
    s_cbranch_scc1 L_sf_12
    s_waitcnt vmcnt(2)
    s_bitcmp0_b32 s58, 6
    s_cbranch_scc1 L_sf_12
    s_waitcnt vmcnt(1)
L_sf_12:
    buffer_load_dwordx4 v[64:67], v1, s[48:51], s97 offen offset:2048 nt
    s_waitcnt vmcnt(3)
    s_bitcmp0_b32 s57, 7
    s_cbranch_scc1 L_sf_13
    s_waitcnt vmcnt(2)
    s_bitcmp0_b32 s58, 7
    s_cbranch_scc1 L_sf_13
    s_waitcnt vmcnt(1)
L_sf_13:
    buffer_load_dwordx4 v[68:71], v1, s[48:51], s97 offen offset:3072 nt
    s_add_u32 s97, s97, 32768
    v_add_u32 v1, 4096, v1
    v_and_b32 v1, 0x7fff, v1
    s_waitcnt vmcnt(3)
    s_bitcmp0_b32 s57, 8
    s_cbranch_scc1 L_sf_14
    s_waitcnt vmcnt(2)
    s_bitcmp0_b32 s58, 8
    s_cbranch_scc1 L_sf_14
    s_waitcnt vmcnt(1)
L_sf_14:
    buffer_load_dwordx4 v[72:75], v1, s[48:51], s97 offen offset:0 nt
    s_waitcnt vmcnt(3)
    s_bitcmp0_b32 s57, 9
    s_cbranch_scc1 L_sf_15
    s_waitcnt vmcnt(2)
    s_bitcmp0_b32 s58, 9
    s_cbranch_scc1 L_sf_15
    s_waitcnt vmcnt(1)
L_sf_15:
    buffer_load_dwordx4 v[76:79], v1, s[48:51], s97 offen offset:1024 nt
    s_waitcnt vmcnt(3)
    s_bitcmp0_b32 s57, 10
    s_cbranch_scc1 L_sf_16
    s_waitcnt vmcnt(2)
    s_bitcmp0_b32 s58, 10
    s_cbranch_scc1 L_sf_16
    s_waitcnt vmcnt(1)
L_sf_16:
    buffer_load_dwordx4 v[80:83], v1, s[48:51], s97 offen offset:2048 nt
    s_waitcnt vmcnt(3)
    s_bitcmp0_b32 s57, 11
    s_cbranch_scc1 L_sf_17
    s_waitcnt vmcnt(2)
    s_bitcmp0_b32 s58, 11
    s_cbranch_scc1 L_sf_17
    s_waitcnt vmcnt(1)
L_sf_17:
    buffer_load_dwordx4 v[84:87], v1, s[48:51], s97 offen offset:3072 nt
    s_add_u32 s97, s97, 32768
    v_add_u32 v1, 4096, v1
    v_and_b32 v1, 0x7fff, v1
    s_waitcnt vmcnt(3)
    s_bitcmp0_b32 s57, 12
    s_cbranch_scc1 L_sf_18
    s_waitcnt vmcnt(2)
    s_bitcmp0_b32 s58, 12
    s_cbranch_scc1 L_sf_18
    s_waitcnt vmcnt(1)
L_sf_18:
    buffer_load_dwordx4 v[88:91], v1, s[48:51], s97 offen offset:0 nt
    s_waitcnt vmcnt(3)
    s_bitcmp0_b32 s57, 13
    s_cbranch_scc1 L_sf_19
    s_waitcnt vmcnt(2)
    s_bitcmp0_b32 s58, 13
    s_cbranch_scc1 L_sf_19
    s_waitcnt vmcnt(1)
L_sf_19:
    buffer_load_dwordx4 v[92:95], v1, s[48:51], s97 offen offset:1024 nt
    s_waitcnt vmcnt(3)
    s_bitcmp0_b32 s57, 14
    s_cbranch_scc1 L_sf_20
    s_waitcnt vmcnt(2)
    s_bitcmp0_b32 s58, 14
    s_cbranch_scc1 L_sf_20
    s_waitcnt vmcnt(1)
L_sf_20:
    buffer_load_dwordx4 v[96:99], v1, s[48:51], s97 offen offset:2048 nt
    s_waitcnt vmcnt(3)
    s_bitcmp0_b32 s57, 15
    s_cbranch_scc1 L_sf_21
    s_waitcnt vmcnt(2)
    s_bitcmp0_b32 s58, 15
    s_cbranch_scc1 L_sf_21
    s_waitcnt vmcnt(1)
L_sf_21:
    buffer_load_dwordx4 v[100:103], v1, s[48:51], s97 offen offset:3072 nt
    s_add_u32 s97, s97, 32768
    v_add_u32 v1, 4096, v1
    v_and_b32 v1, 0x7fff, v1
    s_waitcnt vmcnt(3)
    s_bitcmp0_b32 s57, 16
    s_cbranch_scc1 L_sf_22
    s_waitcnt vmcnt(2)
    s_bitcmp0_b32 s58, 16
    s_cbranch_scc1 L_sf_22
    s_waitcnt vmcnt(1)
L_sf_22:
    buffer_load_dwordx4 v[104:107], v1, s[48:51], s97 offen offset:0 nt
    s_waitcnt vmcnt(3)
    s_bitcmp0_b32 s57, 17
    s_cbranch_scc1 L_sf_23
    s_waitcnt vmcnt(2)
    s_bitcmp0_b32 s58, 17
    s_cbranch_scc1 L_sf_23
    s_waitcnt vmcnt(1)
L_sf_23:
    buffer_load_dwordx4 v[108:111], v1, s[48:51], s97 offen offset:1024 nt
    s_waitcnt vmcnt(3)
    s_bitcmp0_b32 s57, 18
    s_cbranch_scc1 L_sf_24
    s_waitcnt vmcnt(2)
    s_bitcmp0_b32 s58, 18
    s_cbranch_scc1 L_sf_24
    s_waitcnt vmcnt(1)
L_sf_24:
    buffer_load_dwordx4 v[112:115], v1, s[48:51], s97 offen offset:2048 nt
    s_waitcnt vmcnt(3)
    s_bitcmp0_b32 s57, 19
    s_cbranch_scc1 L_sf_25
    s_waitcnt vmcnt(2)
    s_bitcmp0_b32 s58, 19
    s_cbranch_scc1 L_sf_25
    s_waitcnt vmcnt(1)
L_sf_25:
    buffer_load_dwordx4 v[116:119], v1, s[48:51], s97 offen offset:3072 nt
    s_add_u32 s97, s97, 32768
    v_add_u32 v1, 4096, v1
    v_and_b32 v1, 0x7fff, v1
    s_waitcnt vmcnt(3)
    s_bitcmp0_b32 s57, 20
    s_cbranch_scc1 L_sf_26
    s_waitcnt vmcnt(2)
    s_bitcmp0_b32 s58, 20
    s_cbranch_scc1 L_sf_26
    s_waitcnt vmcnt(1)
L_sf_26:
    buffer_load_dwordx4 v[120:123], v1, s[48:51], s97 offen offset:0 nt
    s_waitcnt vmcnt(3)
    s_bitcmp0_b32 s57, 21
    s_cbranch_scc1 L_sf_27
    s_waitcnt vmcnt(2)
    s_bitcmp0_b32 s58, 21
    s_cbranch_scc1 L_sf_27
    s_waitcnt vmcnt(1)
L_sf_27:
    buffer_load_dwordx4 v[124:127], v1, s[48:51], s97 offen offset:1024 nt
    s_cmp_eq_u32 s12, -1
    s_cbranch_scc1 L_k_nopf
    s_waitcnt vmcnt(3)
    s_bitcmp0_b32 s57, 22
    s_cbranch_scc1 L_sf_28
    s_waitcnt vmcnt(2)
    s_bitcmp0_b32 s58, 22
    s_cbranch_scc1 L_sf_28
    s_waitcnt vmcnt(1)
L_sf_28:
    buffer_load_dwordx4 v[128:131], v1, s[48:51], s97 offen offset:2048 nt
    s_waitcnt vmcnt(3)
    s_bitcmp0_b32 s57, 23
    s_cbranch_scc1 L_sf_29
    s_waitcnt vmcnt(2)
    s_bitcmp0_b32 s58, 23
    s_cbranch_scc1 L_sf_29
    s_waitcnt vmcnt(1)
L_sf_29:
    buffer_load_dwordx4 v[132:135], v1, s[48:51], s97 offen offset:3072 nt
    s_add_u32 s97, s97, 32768
    v_add_u32 v1, 4096, v1
    v_and_b32 v1, 0x7fff, v1
    s_waitcnt vmcnt(3)
    s_bitcmp0_b32 s57, 24
    s_cbranch_scc1 L_sf_30
    s_waitcnt vmcnt(2)
    s_bitcmp0_b32 s58, 24
    s_cbranch_scc1 L_sf_30
    s_waitcnt vmcnt(1)
L_sf_30:
    buffer_load_dwordx4 v[136:139], v1, s[48:51], s97 offen offset:0 nt
    s_waitcnt vmcnt(3)
    s_bitcmp0_b32 s57, 25
    s_cbranch_scc1 L_sf_31
    s_waitcnt vmcnt(2)
    s_bitcmp0_b32 s58, 25
    s_cbranch_scc1 L_sf_31
    s_waitcnt vmcnt(1)
L_sf_31:
    buffer_load_dwordx4 v[140:143], v1, s[48:51], s97 offen offset:1024 nt
    s_waitcnt vmcnt(3)
    s_bitcmp0_b32 s57, 26
    s_cbranch_scc1 L_sf_32
    s_waitcnt vmcnt(2)
    s_bitcmp0_b32 s58, 26
    s_cbranch_scc1 L_sf_32
    s_waitcnt vmcnt(1)
L_sf_32:
    buffer_load_dwordx4 v[144:147], v1, s[48:51], s97 offen offset:2048 nt
    s_waitcnt vmcnt(3)
    s_bitcmp0_b32 s57, 27
    s_cbranch_scc1 L_sf_33
    s_waitcnt vmcnt(2)
    s_bitcmp0_b32 s58, 27
    s_cbranch_scc1 L_sf_33
    s_waitcnt vmcnt(1)
L_sf_33:
    buffer_load_dwordx4 v[148:151], v1, s[48:51], s97 offen offset:3072 nt
    s_add_u32 s97, s97, 32768
    v_add_u32 v1, 4096, v1
    v_and_b32 v1, 0x7fff, v1
    s_waitcnt vmcnt(3)
    s_bitcmp0_b32 s57, 28
    s_cbranch_scc1 L_sf_34
    s_waitcnt vmcnt(2)
    s_bitcmp0_b32 s58, 28
    s_cbranch_scc1 L_sf_34
    s_waitcnt vmcnt(1)
L_sf_34:
    buffer_load_dwordx4 v[152:155], v1, s[48:51], s97 offen offset:0 nt
    s_waitcnt vmcnt(3)
    s_bitcmp0_b32 s57, 29
    s_cbranch_scc1 L_sf_35
    s_waitcnt vmcnt(2)
    s_bitcmp0_b32 s58, 29
    s_cbranch_scc1 L_sf_35
    s_waitcnt vmcnt(1)
L_sf_35:
    buffer_load_dwordx4 v[156:159], v1, s[48:51], s97 offen offset:1024 nt
    s_waitcnt vmcnt(3)
    s_bitcmp0_b32 s57, 30
    s_cbranch_scc1 L_sf_36
    s_waitcnt vmcnt(2)
    s_bitcmp0_b32 s58, 30
    s_cbranch_scc1 L_sf_36
    s_waitcnt vmcnt(1)
L_sf_36:
    buffer_load_dwordx4 v[160:163], v1, s[48:51], s97 offen offset:2048 nt
    v_min_u32 v39, 29, v0
    v_lshlrev_b32 v39, 2, v39
    buffer_load_dword v37, v39, s[44:47], 0 offen sc1
    s_waitcnt vmcnt(4)
    s_bitcmp0_b32 s57, 31
    s_cbranch_scc1 L_sf_37
    s_waitcnt vmcnt(3)
    s_bitcmp0_b32 s58, 31
    s_cbranch_scc1 L_sf_37
    s_waitcnt vmcnt(2)
L_sf_37:
    buffer_load_dwordx4 v[164:167], v1, s[48:51], s97 offen offset:3072 nt
    s_mov_b32 s97, 0
    v_add_u32 v1, 4096, v1
    v_and_b32 v1, 0x7fff, v1
    s_waitcnt vmcnt(4)
    s_bitcmp0_b32 s14, 0
    s_cbranch_scc1 L_sf_38
    s_waitcnt vmcnt(3)
    s_bitcmp0_b32 s15, 0
    s_cbranch_scc1 L_sf_38
    s_waitcnt vmcnt(2)
L_sf_38:
    s_add_u32 m0, s12, 0
    s_nop 0
    buffer_load_dwordx4 v1, s[52:55], s97 offen offset:0 nt lds
    s_waitcnt vmcnt(4)
    s_bitcmp0_b32 s14, 1
    s_cbranch_scc1 L_sf_39
    s_waitcnt vmcnt(3)
    s_bitcmp0_b32 s15, 1
    s_cbranch_scc1 L_sf_39
    s_waitcnt vmcnt(1)
L_sf_39:
    buffer_load_dwordx4 v1, s[52:55], s97 offen offset:1024 nt lds
    s_waitcnt vmcnt(4)
    s_bitcmp0_b32 s14, 2
    s_cbranch_scc1 L_sf_40
    s_waitcnt vmcnt(2)
    s_bitcmp0_b32 s15, 2
    s_cbranch_scc1 L_sf_40
    s_waitcnt vmcnt(1)
L_sf_40:
    buffer_load_dwordx4 v1, s[52:55], s97 offen offset:2048 nt lds
    s_waitcnt vmcnt(3)
    s_bitcmp0_b32 s14, 3
    s_cbranch_scc1 L_sf_41
    s_waitcnt vmcnt(2)
    s_bitcmp0_b32 s15, 3
    s_cbranch_scc1 L_sf_41
    s_waitcnt vmcnt(1)
L_sf_41:
    buffer_load_dwordx4 v1, s[52:55], s97 offen offset:3072 nt lds
    s_add_u32 s97, s97, 32768
    v_add_u32 v1, 4096, v1
    v_and_b32 v1, 0x7fff, v1
    v_cmp_eq_u32 vcc, 0, v37
    s_nop 0
    s_or_b32 s96, vcc_lo, vcc_hi
    buffer_load_dwordx4 v[4:7], v2, s[40:43], s98 offen sc1
    s_waitcnt vmcnt(4)
    s_bitcmp0_b32 s14, 4
    s_cbranch_scc1 L_sf_42
    s_waitcnt vmcnt(3)
    s_bitcmp0_b32 s15, 4
    s_cbranch_scc1 L_sf_42
    s_waitcnt vmcnt(2)
L_sf_42:
    s_add_u32 m0, s12, 4096
    s_nop 0
    buffer_load_dwordx4 v1, s[52:55], s97 offen offset:0 nt lds
    s_waitcnt vmcnt(4)
    s_bitcmp0_b32 s14, 5
    s_cbranch_scc1 L_sf_43
    s_waitcnt vmcnt(3)
    s_bitcmp0_b32 s15, 5
    s_cbranch_scc1 L_sf_43
    s_waitcnt vmcnt(2)
L_sf_43:
    buffer_load_dwordx4 v1, s[52:55], s97 offen offset:1024 nt lds
    s_waitcnt vmcnt(4)
    s_bitcmp0_b32 s14, 6
    s_cbranch_scc1 L_sf_44
    s_waitcnt vmcnt(3)
    s_bitcmp0_b32 s15, 6
    s_cbranch_scc1 L_sf_44
    s_waitcnt vmcnt(1)
L_sf_44:
    buffer_load_dwordx4 v1, s[52:55], s97 offen offset:2048 nt lds
    s_waitcnt vmcnt(4)
    s_bitcmp0_b32 s14, 7
    s_cbranch_scc1 L_sf_45
    s_waitcnt vmcnt(2)
    s_bitcmp0_b32 s15, 7
    s_cbranch_scc1 L_sf_45
    s_waitcnt vmcnt(1)
L_sf_45:
    buffer_load_dwordx4 v1, s[52:55], s97 offen offset:3072 nt lds
    s_add_u32 s97, s97, 32768
    v_add_u32 v1, 4096, v1
    v_and_b32 v1, 0x7fff, v1
L_k_join:
    s_waitcnt vmcnt(4)
    v_max3_u32 v38, v4, v5, v6
    v_max_u32 v38, v38, v7
    v_cmp_eq_u32 vcc, -1, v38
    s_cmp_lg_u32 s96, 0
    s_cbranch_scc1 L_qslow
    s_cbranch_vccnz L_qslow2
L_qok:
    v_dot2_f32_bf16 v8, v72, v4, 0
    v_dot2_f32_bf16 v9, v76, v4, 0
    v_dot2_f32_bf16 v10, v80, v4, 0
    v_dot2_f32_bf16 v11, v84, v4, 0
    v_dot2_f32_bf16 v24, v88, v4, 0
    v_dot2_f32_bf16 v25, v92, v4, 0
    v_dot2_f32_bf16 v26, v96, v4, 0
    v_dot2_f32_bf16 v27, v100, v4, 0
    v_dot2_f32_bf16 v8, v73, v5, v8
    v_dot2_f32_bf16 v9, v77, v5, v9
    v_dot2_f32_bf16 v10, v81, v5, v10
    v_dot2_f32_bf16 v11, v85, v5, v11
    v_dot2_f32_bf16 v24, v89, v5, v24
    v_dot2_f32_bf16 v25, v93, v5, v25
    v_dot2_f32_bf16 v26, v97, v5, v26
    v_dot2_f32_bf16 v27, v101, v5, v27
    v_dot2_f32_bf16 v8, v74, v6, v8
    v_dot2_f32_bf16 v9, v78, v6, v9
    v_dot2_f32_bf16 v10, v82, v6, v10
    v_dot2_f32_bf16 v11, v86, v6, v11
    v_dot2_f32_bf16 v24, v90, v6, v24
    v_dot2_f32_bf16 v25, v94, v6, v25
    v_dot2_f32_bf16 v26, v98, v6, v26
    v_dot2_f32_bf16 v27, v102, v6, v27
    v_dot2_f32_bf16 v8, v75, v7, v8
    v_dot2_f32_bf16 v9, v79, v7, v9
    v_dot2_f32_bf16 v10, v83, v7, v10
    v_dot2_f32_bf16 v11, v87, v7, v11
    v_dot2_f32_bf16 v24, v91, v7, v24
    v_dot2_f32_bf16 v25, v95, v7, v25
    v_dot2_f32_bf16 v26, v99, v7, v26
    v_dot2_f32_bf16 v27, v103, v7, v27
    v_add_f32_dpp v8, v8, v8 row_ror:8 row_mask:0xf bank_mask:0x3
    v_add_f32_dpp v10, v10, v10 row_ror:8 row_mask:0xf bank_mask:0x3
    v_add_f32_dpp v24, v24, v24 row_ror:8 row_mask:0xf bank_mask:0x3
    v_add_f32_dpp v26, v26, v26 row_ror:8 row_mask:0xf bank_mask:0x3
    v_add_f32_dpp v8, v9, v9 row_ror:8 row_mask:0xf bank_mask:0xc
    v_add_f32_dpp v10, v11, v11 row_ror:8 row_mask:0xf bank_mask:0xc
    v_add_f32_dpp v24, v25, v25 row_ror:8 row_mask:0xf bank_mask:0xc
    v_add_f32_dpp v26, v27, v27 row_ror:8 row_mask:0xf bank_mask:0xc
    v_add_f32_dpp v14, v8, v8 row_half_mirror row_mask:0xf bank_mask:0x5
    v_add_f32_dpp v15, v24, v24 row_half_mirror row_mask:0xf bank_mask:0x5
    v_add_f32_dpp v14, v10, v10 row_half_mirror row_mask:0xf bank_mask:0xa
    v_add_f32_dpp v15, v26, v26 row_half_mirror row_mask:0xf bank_mask:0xa
    s_nop 0
    v_add_f32_dpp v14, v14, v14 quad_perm:[1,0,3,2] row_mask:0xf bank_mask:0xf
    v_add_f32_dpp v15, v15, v15 quad_perm:[1,0,3,2] row_mask:0xf bank_mask:0xf
    s_nop 0
    v_add_f32_dpp v14, v14, v14 quad_perm:[2,3,0,1] row_mask:0xf bank_mask:0xf
    v_add_f32_dpp v15, v15, v15 quad_perm:[2,3,0,1] row_mask:0xf bank_mask:0xf
    s_waitcnt vmcnt(3)
    s_bitcmp0_b32 s14, 8
    s_cbranch_scc1 L_sf_56
    s_waitcnt vmcnt(2)
    s_bitcmp0_b32 s15, 8
    s_cbranch_scc1 L_sf_56
    s_waitcnt vmcnt(1)
L_sf_56:
    buffer_load_dwordx4 v[72:75], v1, s[52:55], s97 offen offset:0 nt
    v_dot2_f32_bf16 v8, v40, v4, 0
    v_dot2_f32_bf16 v9, v44, v4, 0
    v_dot2_f32_bf16 v10, v48, v4, 0
    v_dot2_f32_bf16 v11, v52, v4, 0
    v_dot2_f32_bf16 v24, v56, v4, 0
    v_dot2_f32_bf16 v25, v60, v4, 0
    v_dot2_f32_bf16 v26, v64, v4, 0
    v_dot2_f32_bf16 v27, v68, v4, 0
    v_dot2_f32_bf16 v28, v104, v4, 0
    v_dot2_f32_bf16 v29, v108, v4, 0
    v_dot2_f32_bf16 v30, v112, v4, 0
    v_dot2_f32_bf16 v31, v116, v4, 0
    v_dot2_f32_bf16 v8, v41, v5, v8
    v_dot2_f32_bf16 v9, v45, v5, v9
    v_dot2_f32_bf16 v10, v49, v5, v10
    v_dot2_f32_bf16 v11, v53, v5, v11
    v_dot2_f32_bf16 v24, v57, v5, v24
    v_dot2_f32_bf16 v25, v61, v5, v25
    v_dot2_f32_bf16 v26, v65, v5, v26
    v_dot2_f32_bf16 v27, v69, v5, v27
    v_dot2_f32_bf16 v28, v105, v5, v28
    v_dot2_f32_bf16 v29, v109, v5, v29
    v_dot2_f32_bf16 v30, v113, v5, v30
    v_dot2_f32_bf16 v31, v117, v5, v31
    v_dot2_f32_bf16 v8, v42, v6, v8
    v_dot2_f32_bf16 v9, v46, v6, v9
    v_dot2_f32_bf16 v10, v50, v6, v10
    v_dot2_f32_bf16 v11, v54, v6, v11
    v_dot2_f32_bf16 v24, v58, v6, v24
    v_dot2_f32_bf16 v25, v62, v6, v25
    v_dot2_f32_bf16 v26, v66, v6, v26
    v_dot2_f32_bf16 v27, v70, v6, v27
    v_dot2_f32_bf16 v28, v106, v6, v28
    v_dot2_f32_bf16 v29, v110, v6, v29
    v_dot2_f32_bf16 v30, v114, v6, v30
    v_dot2_f32_bf16 v31, v118, v6, v31
    v_dot2_f32_bf16 v8, v43, v7, v8
    v_dot2_f32_bf16 v9, v47, v7, v9
    v_dot2_f32_bf16 v10, v51, v7, v10
    v_dot2_f32_bf16 v11, v55, v7, v11
    v_dot2_f32_bf16 v24, v59, v7, v24
    v_dot2_f32_bf16 v25, v63, v7, v25
    v_dot2_f32_bf16 v26, v67, v7, v26
    v_dot2_f32_bf16 v27, v71, v7, v27
    v_dot2_f32_bf16 v28, v107, v7, v28
    v_dot2_f32_bf16 v29, v111, v7, v29
    v_dot2_f32_bf16 v30, v115, v7, v30
    v_dot2_f32_bf16 v31, v119, v7, v31
    v_add_f32_dpp v8, v8, v8 row_ror:8 row_mask:0xf bank_mask:0x3
    v_add_f32_dpp v10, v10, v10 row_ror:8 row_mask:0xf bank_mask:0x3
    v_add_f32_dpp v24, v24, v24 row_ror:8 row_mask:0xf bank_mask:0x3
    v_add_f32_dpp v26, v26, v26 row_ror:8 row_mask:0xf bank_mask:0x3
    v_add_f32_dpp v28, v28, v28 row_ror:8 row_mask:0xf bank_mask:0x3
    v_add_f32_dpp v30, v30, v30 row_ror:8 row_mask:0xf bank_mask:0x3
    v_add_f32_dpp v8, v9, v9 row_ror:8 row_mask:0xf bank_mask:0xc
    v_add_f32_dpp v10, v11, v11 row_ror:8 row_mask:0xf bank_mask:0xc
    v_add_f32_dpp v24, v25, v25 row_ror:8 row_mask:0xf bank_mask:0xc
    v_add_f32_dpp v26, v27, v27 row_ror:8 row_mask:0xf bank_mask:0xc
    v_add_f32_dpp v28, v29, v29 row_ror:8 row_mask:0xf bank_mask:0xc
    v_add_f32_dpp v30, v31, v31 row_ror:8 row_mask:0xf bank_mask:0xc
    v_add_f32_dpp v12, v8, v8 row_half_mirror row_mask:0xf bank_mask:0x5
    v_add_f32_dpp v13, v24, v24 row_half_mirror row_mask:0xf bank_mask:0x5
    v_add_f32_dpp v16, v28, v28 row_half_mirror row_mask:0xf bank_mask:0x5
    v_add_f32_dpp v12, v10, v10 row_half_mirror row_mask:0xf bank_mask:0xa
    v_add_f32_dpp v13, v26, v26 row_half_mirror row_mask:0xf bank_mask:0xa
    v_add_f32_dpp v16, v30, v30 row_half_mirror row_mask:0xf bank_mask:0xa
    v_add_f32_dpp v12, v12, v12 quad_perm:[1,0,3,2] row_mask:0xf bank_mask:0xf
    v_add_f32_dpp v13, v13, v13 quad_perm:[1,0,3,2] row_mask:0xf bank_mask:0xf
    v_add_f32_dpp v16, v16, v16 quad_perm:[1,0,3,2] row_mask:0xf bank_mask:0xf
    v_add_f32_dpp v12, v12, v12 quad_perm:[2,3,0,1] row_mask:0xf bank_mask:0xf
    v_add_f32_dpp v13, v13, v13 quad_perm:[2,3,0,1] row_mask:0xf bank_mask:0xf
    v_add_f32_dpp v16, v16, v16 quad_perm:[2,3,0,1] row_mask:0xf bank_mask:0xf
    s_waitcnt vmcnt(3)
    s_bitcmp0_b32 s14, 9
    s_cbranch_scc1 L_sf_57
    s_waitcnt vmcnt(2)
    s_bitcmp0_b32 s15, 9
    s_cbranch_scc1 L_sf_57
    s_waitcnt vmcnt(1)
L_sf_57:
    buffer_load_dwordx4 v[76:79], v1, s[52:55], s97 offen offset:1024 nt
    v_dot2_f32_bf16 v8, v120, v4, 0
    v_dot2_f32_bf16 v9, v124, v4, 0
    v_dot2_f32_bf16 v10, v128, v4, 0
    v_dot2_f32_bf16 v11, v132, v4, 0
    v_dot2_f32_bf16 v24, v136, v4, 0
    v_dot2_f32_bf16 v25, v140, v4, 0
    v_dot2_f32_bf16 v26, v144, v4, 0
    v_dot2_f32_bf16 v27, v148, v4, 0
    v_dot2_f32_bf16 v8, v121, v5, v8
    v_dot2_f32_bf16 v9, v125, v5, v9
    v_dot2_f32_bf16 v10, v129, v5, v10
    v_dot2_f32_bf16 v11, v133, v5, v11
    v_dot2_f32_bf16 v24, v137, v5, v24
    v_dot2_f32_bf16 v25, v141, v5, v25
    v_dot2_f32_bf16 v26, v145, v5, v26
    v_dot2_f32_bf16 v27, v149, v5, v27
    v_dot2_f32_bf16 v8, v122, v6, v8
    v_dot2_f32_bf16 v9, v126, v6, v9
    v_dot2_f32_bf16 v10, v130, v6, v10
    v_dot2_f32_bf16 v11, v134, v6, v11
    v_dot2_f32_bf16 v24, v138, v6, v24
    v_dot2_f32_bf16 v25, v142, v6, v25
    v_dot2_f32_bf16 v26, v146, v6, v26
    v_dot2_f32_bf16 v27, v150, v6, v27
    v_dot2_f32_bf16 v8, v123, v7, v8
    v_dot2_f32_bf16 v9, v127, v7, v9
    v_dot2_f32_bf16 v10, v131, v7, v10
    v_dot2_f32_bf16 v11, v135, v7, v11
    v_dot2_f32_bf16 v24, v139, v7, v24
    v_dot2_f32_bf16 v25, v143, v7, v25
    v_dot2_f32_bf16 v26, v147, v7, v26
    v_dot2_f32_bf16 v27, v151, v7, v27
    v_add_f32_dpp v8, v8, v8 row_ror:8 row_mask:0xf bank_mask:0x3
    v_add_f32_dpp v10, v10, v10 row_ror:8 row_mask:0xf bank_mask:0x3
    v_add_f32_dpp v24, v24, v24 row_ror:8 row_mask:0xf bank_mask:0x3
    v_add_f32_dpp v26, v26, v26 row_ror:8 row_mask:0xf bank_mask:0x3
    v_add_f32_dpp v8, v9, v9 row_ror:8 row_mask:0xf bank_mask:0xc
    v_add_f32_dpp v10, v11, v11 row_ror:8 row_mask:0xf bank_mask:0xc
    v_add_f32_dpp v24, v25, v25 row_ror:8 row_mask:0xf bank_mask:0xc
    v_add_f32_dpp v26, v27, v27 row_ror:8 row_mask:0xf bank_mask:0xc
    v_add_f32_dpp v17, v8, v8 row_half_mirror row_mask:0xf bank_mask:0x5
    v_add_f32_dpp v18, v24, v24 row_half_mirror row_mask:0xf bank_mask:0x5
    v_add_f32_dpp v17, v10, v10 row_half_mirror row_mask:0xf bank_mask:0xa
    v_add_f32_dpp v18, v26, v26 row_half_mirror row_mask:0xf bank_mask:0xa
    s_nop 0
    v_add_f32_dpp v17, v17, v17 quad_perm:[1,0,3,2] row_mask:0xf bank_mask:0xf
    v_add_f32_dpp v18, v18, v18 quad_perm:[1,0,3,2] row_mask:0xf bank_mask:0xf
    s_nop 0
    v_add_f32_dpp v17, v17, v17 quad_perm:[2,3,0,1] row_mask:0xf bank_mask:0xf
    v_add_f32_dpp v18, v18, v18 quad_perm:[2,3,0,1] row_mask:0xf bank_mask:0xf
    s_waitcnt vmcnt(3)
    s_bitcmp0_b32 s14, 10
    s_cbranch_scc1 L_sf_58
    s_waitcnt vmcnt(2)
    s_bitcmp0_b32 s15, 10
    s_cbranch_scc1 L_sf_58
    s_waitcnt vmcnt(1)
L_sf_58:
    buffer_load_dwordx4 v[80:83], v1, s[52:55], s97 offen offset:2048 nt
    s_waitcnt vmcnt(3)
    s_bitcmp0_b32 s14, 11
    s_cbranch_scc1 L_sf_59
    s_waitcnt vmcnt(2)
    s_bitcmp0_b32 s15, 11
    s_cbranch_scc1 L_sf_59
    s_waitcnt vmcnt(1)
L_sf_59:
    buffer_load_dwordx4 v[84:87], v1, s[52:55], s97 offen offset:3072 nt
    s_add_u32 s97, s97, 32768
    v_add_u32 v1, 4096, v1
    v_and_b32 v1, 0x7fff, v1
    s_cmp_eq_u32 s12, -1
    s_cbranch_scc1 L_nopfrd
    v_lshl_add_u32 v38, v0, 4, s12
    ds_read_b128 v[40:43], v38 offset:0
    ds_read_b128 v[44:47], v38 offset:1024
    ds_read_b128 v[48:51], v38 offset:2048
    ds_read_b128 v[52:55], v38 offset:3072
    ds_read_b128 v[56:59], v38 offset:4096
    ds_read_b128 v[60:63], v38 offset:5120
    ds_read_b128 v[64:67], v38 offset:6144
    ds_read_b128 v[68:71], v38 offset:7168
L_nopfrd:
    v_dot2_f32_bf16 v8, v152, v4, 0
    v_dot2_f32_bf16 v9, v156, v4, 0
    v_dot2_f32_bf16 v10, v160, v4, 0
    v_dot2_f32_bf16 v11, v164, v4, 0
    v_dot2_f32_bf16 v8, v153, v5, v8
    v_dot2_f32_bf16 v9, v157, v5, v9
    v_dot2_f32_bf16 v10, v161, v5, v10
    v_dot2_f32_bf16 v11, v165, v5, v11
    v_dot2_f32_bf16 v8, v154, v6, v8
    v_dot2_f32_bf16 v9, v158, v6, v9
    v_dot2_f32_bf16 v10, v162, v6, v10
    v_dot2_f32_bf16 v11, v166, v6, v11
    v_dot2_f32_bf16 v8, v155, v7, v8
    v_dot2_f32_bf16 v9, v159, v7, v9
    v_dot2_f32_bf16 v10, v163, v7, v10
    v_dot2_f32_bf16 v11, v167, v7, v11
    v_add_f32_dpp v8, v8, v8 row_ror:8 row_mask:0xf bank_mask:0x3
    s_nop 0
    v_add_f32_dpp v10, v10, v10 row_ror:8 row_mask:0xf bank_mask:0x3
    v_add_f32_dpp v8, v9, v9 row_ror:8 row_mask:0xf bank_mask:0xc
    v_add_f32_dpp v10, v11, v11 row_ror:8 row_mask:0xf bank_mask:0xc
    s_nop 0
    v_add_f32_dpp v19, v8, v8 row_half_mirror row_mask:0xf bank_mask:0x5
    v_add_f32_dpp v19, v10, v10 row_half_mirror row_mask:0xf bank_mask:0xa
    s_nop 1
    v_add_f32_dpp v19, v19, v19 quad_perm:[1,0,3,2] row_mask:0xf bank_mask:0xf
    s_nop 1
    v_add_f32_dpp v19, v19, v19 quad_perm:[2,3,0,1] row_mask:0xf bank_mask:0xf
    v_max3_f32 v3, v12, v13, v14
    v_max3_f32 v8, v15, v16, v17
    v_max3_f32 v3, v3, v18, v19
    v_max_f32 v3, v3, v8
    s_nop 1
    v_max_f32_dpp v3, v3, v3 row_ror:4 row_mask:0xf bank_mask:0xf
    s_nop 1
    v_max_f32_dpp v3, v3, v3 row_ror:8 row_mask:0xf bank_mask:0xf
    v_mov_b32 v8, v3
    s_nop 1
    v_permlane16_swap_b32 v3, v8
    v_max_f32 v3, v3, v8
    v_mov_b32 v8, v3
    s_nop 1
    v_permlane32_swap_b32 v3, v8
    v_max_f32 v3, v3, v8
    s_mov_b32 s96, 0x3e0293ee
    v_mul_f32 v8, s96, v3
    v_fma_f32 v12, v12, s96, -v8
    v_fma_f32 v13, v13, s96, -v8
    v_fma_f32 v14, v14, s96, -v8
    v_fma_f32 v15, v15, s96, -v8
    v_fma_f32 v16, v16, s96, -v8
    v_fma_f32 v17, v17, s96, -v8
    v_fma_f32 v18, v18, s96, -v8
    v_fma_f32 v19, v19, s96, -v8
    v_exp_f32 v12, v12
    v_exp_f32 v13, v13
    v_exp_f32 v14, v14
    v_exp_f32 v15, v15
    v_exp_f32 v16, v16
    v_exp_f32 v17, v17
    v_exp_f32 v18, v18
    v_exp_f32 v19, v19
    v_add_f32 v9, v12, v13
    v_add_f32 v10, v14, v15
    v_add_f32 v11, v16, v17
    v_add_f32 v3, v18, v19
    v_add_f32 v9, v9, v10
    v_add_f32 v3, v3, v11
    v_add_f32 v9, v9, v3
    v_cvt_pk_bf16_f32 v12, v12, v12
    v_cvt_pk_bf16_f32 v13, v13, v13
    v_cvt_pk_bf16_f32 v14, v14, v14
    v_cvt_pk_bf16_f32 v15, v15, v15
    v_cvt_pk_bf16_f32 v16, v16, v16
    v_cvt_pk_bf16_f32 v17, v17, v17
    v_cvt_pk_bf16_f32 v18, v18, v18
    v_cvt_pk_bf16_f32 v19, v19, v19
    v_add_f32_dpp v9, v9, v9 row_ror:4 row_mask:0xf bank_mask:0xf
    s_nop 1
    v_add_f32_dpp v9, v9, v9 row_ror:8 row_mask:0xf bank_mask:0xf
    v_mov_b32 v10, v9
    s_nop 1
    v_permlane16_swap_b32 v9, v10
    v_add_f32 v9, v9, v10
    v_mov_b32 v10, v9
    s_nop 1
    v_permlane32_swap_b32 v9, v10
    v_add_f32 v9, v9, v10
    s_mov_b64 exec, 1
    s_cmp_lg_u32 s13, 0
    s_cbranch_scc1 L_mljob
    s_lshl_b32 s96, s3, 3
    s_add_u32 s96, s96, 161920
    v_mov_b32 v10, s96
    v_mov_b32 v11, 162068
    v_mov_b32 v3, 1
    ds_write_b64 v10, v[8:9]
    ds_add_u32 v11, v3
L_mldone:
    s_mov_b64 exec, -1
    v_lshrrev_b32 v2, 1, v2
    v_and_b32_dpp v24, v14, v20 row_newbcast:0 row_mask:0xf bank_mask:0xf
    v_and_b32_dpp v25, v14, v21 row_newbcast:0 row_mask:0xf bank_mask:0xf
    v_and_b32_dpp v26, v14, v22 row_newbcast:0 row_mask:0xf bank_mask:0xf
    v_and_b32_dpp v27, v14, v23 row_newbcast:0 row_mask:0xf bank_mask:0xf
    s_waitcnt vmcnt(3)
    s_bitcmp0_b32 s14, 12
    s_cbranch_scc1 L_sf_60
    s_waitcnt vmcnt(2)
    s_bitcmp0_b32 s15, 12
    s_cbranch_scc1 L_sf_60
    s_waitcnt vmcnt(1)
L_sf_60:
    buffer_load_dwordx4 v[88:91], v1, s[52:55], s97 offen offset:0 nt
    v_mfma_f32_16x16x32_bf16 v[32:35], v[24:27], v[72:75], v[32:35]
    s_cmp_eq_u32 s12, -1
    s_cbranch_scc1 L_nopfpv8
    s_waitcnt lgkmcnt(0)
    v_and_b32_dpp v24, v12, v20 row_newbcast:0 row_mask:0xf bank_mask:0xf
    v_and_b32_dpp v25, v12, v21 row_newbcast:0 row_mask:0xf bank_mask:0xf
    v_and_b32_dpp v26, v12, v22 row_newbcast:0 row_mask:0xf bank_mask:0xf
    v_and_b32_dpp v27, v12, v23 row_newbcast:0 row_mask:0xf bank_mask:0xf
    s_nop 1
    v_mfma_f32_16x16x32_bf16 v[32:35], v[24:27], v[40:43], v[32:35]
    v_and_b32_dpp v28, v12, v20 row_newbcast:8 row_mask:0xf bank_mask:0xf
    v_and_b32_dpp v29, v12, v21 row_newbcast:8 row_mask:0xf bank_mask:0xf
    v_and_b32_dpp v30, v12, v22 row_newbcast:8 row_mask:0xf bank_mask:0xf
    v_and_b32_dpp v31, v12, v23 row_newbcast:8 row_mask:0xf bank_mask:0xf
    s_nop 1
    v_mfma_f32_16x16x32_bf16 v[32:35], v[28:31], v[44:47], v[32:35]
    v_and_b32_dpp v24, v12, v20 row_newbcast:4 row_mask:0xf bank_mask:0xf
    v_and_b32_dpp v25, v12, v21 row_newbcast:4 row_mask:0xf bank_mask:0xf
    v_and_b32_dpp v26, v12, v22 row_newbcast:4 row_mask:0xf bank_mask:0xf
    v_and_b32_dpp v27, v12, v23 row_newbcast:4 row_mask:0xf bank_mask:0xf
    s_nop 1
    v_mfma_f32_16x16x32_bf16 v[32:35], v[24:27], v[48:51], v[32:35]
    v_and_b32_dpp v28, v12, v20 row_newbcast:12 row_mask:0xf bank_mask:0xf
    v_and_b32_dpp v29, v12, v21 row_newbcast:12 row_mask:0xf bank_mask:0xf
    v_and_b32_dpp v30, v12, v22 row_newbcast:12 row_mask:0xf bank_mask:0xf
    v_and_b32_dpp v31, v12, v23 row_newbcast:12 row_mask:0xf bank_mask:0xf
    s_nop 1
    v_mfma_f32_16x16x32_bf16 v[32:35], v[28:31], v[52:55], v[32:35]
L_nopfpv8:
    v_and_b32_dpp v28, v14, v20 row_newbcast:8 row_mask:0xf bank_mask:0xf
    v_and_b32_dpp v29, v14, v21 row_newbcast:8 row_mask:0xf bank_mask:0xf
    v_and_b32_dpp v30, v14, v22 row_newbcast:8 row_mask:0xf bank_mask:0xf
    v_and_b32_dpp v31, v14, v23 row_newbcast:8 row_mask:0xf bank_mask:0xf
    s_waitcnt vmcnt(3)
    s_bitcmp0_b32 s14, 13
    s_cbranch_scc1 L_sf_61
    s_waitcnt vmcnt(2)
    s_bitcmp0_b32 s15, 13
    s_cbranch_scc1 L_sf_61
    s_waitcnt vmcnt(1)
L_sf_61:
    buffer_load_dwordx4 v[92:95], v1, s[52:55], s97 offen offset:1024 nt
    v_mfma_f32_16x16x32_bf16 v[32:35], v[28:31], v[76:79], v[32:35]
    s_cmp_eq_u32 s12, -1
    s_cbranch_scc1 L_nopfpv9
    s_waitcnt lgkmcnt(0)
    v_and_b32_dpp v24, v13, v20 row_newbcast:0 row_mask:0xf bank_mask:0xf
    v_and_b32_dpp v25, v13, v21 row_newbcast:0 row_mask:0xf bank_mask:0xf
    v_and_b32_dpp v26, v13, v22 row_newbcast:0 row_mask:0xf bank_mask:0xf
    v_and_b32_dpp v27, v13, v23 row_newbcast:0 row_mask:0xf bank_mask:0xf
    s_nop 1
    v_mfma_f32_16x16x32_bf16 v[32:35], v[24:27], v[56:59], v[32:35]
    v_and_b32_dpp v28, v13, v20 row_newbcast:8 row_mask:0xf bank_mask:0xf
    v_and_b32_dpp v29, v13, v21 row_newbcast:8 row_mask:0xf bank_mask:0xf
    v_and_b32_dpp v30, v13, v22 row_newbcast:8 row_mask:0xf bank_mask:0xf
    v_and_b32_dpp v31, v13, v23 row_newbcast:8 row_mask:0xf bank_mask:0xf
    s_nop 1
    v_mfma_f32_16x16x32_bf16 v[32:35], v[28:31], v[60:63], v[32:35]
    v_and_b32_dpp v24, v13, v20 row_newbcast:4 row_mask:0xf bank_mask:0xf
    v_and_b32_dpp v25, v13, v21 row_newbcast:4 row_mask:0xf bank_mask:0xf
    v_and_b32_dpp v26, v13, v22 row_newbcast:4 row_mask:0xf bank_mask:0xf
    v_and_b32_dpp v27, v13, v23 row_newbcast:4 row_mask:0xf bank_mask:0xf
    s_nop 1
    v_mfma_f32_16x16x32_bf16 v[32:35], v[24:27], v[64:67], v[32:35]
    v_and_b32_dpp v28, v13, v20 row_newbcast:12 row_mask:0xf bank_mask:0xf
    v_and_b32_dpp v29, v13, v21 row_newbcast:12 row_mask:0xf bank_mask:0xf
    v_and_b32_dpp v30, v13, v22 row_newbcast:12 row_mask:0xf bank_mask:0xf
    v_and_b32_dpp v31, v13, v23 row_newbcast:12 row_mask:0xf bank_mask:0xf
    s_nop 1
    v_mfma_f32_16x16x32_bf16 v[32:35], v[28:31], v[68:71], v[32:35]
L_nopfpv9:
    v_and_b32_dpp v24, v14, v20 row_newbcast:4 row_mask:0xf bank_mask:0xf
    v_and_b32_dpp v25, v14, v21 row_newbcast:4 row_mask:0xf bank_mask:0xf
    v_and_b32_dpp v26, v14, v22 row_newbcast:4 row_mask:0xf bank_mask:0xf
    v_and_b32_dpp v27, v14, v23 row_newbcast:4 row_mask:0xf bank_mask:0xf
    s_waitcnt vmcnt(3)
    s_bitcmp0_b32 s14, 14
    s_cbranch_scc1 L_sf_62
    s_waitcnt vmcnt(2)
    s_bitcmp0_b32 s15, 14
    s_cbranch_scc1 L_sf_62
    s_waitcnt vmcnt(1)
L_sf_62:
    buffer_load_dwordx4 v[96:99], v1, s[52:55], s97 offen offset:2048 nt
    v_mfma_f32_16x16x32_bf16 v[32:35], v[24:27], v[80:83], v[32:35]
    v_and_b32_dpp v28, v14, v20 row_newbcast:12 row_mask:0xf bank_mask:0xf
    v_and_b32_dpp v29, v14, v21 row_newbcast:12 row_mask:0xf bank_mask:0xf
    v_and_b32_dpp v30, v14, v22 row_newbcast:12 row_mask:0xf bank_mask:0xf
    v_and_b32_dpp v31, v14, v23 row_newbcast:12 row_mask:0xf bank_mask:0xf
    s_waitcnt vmcnt(3)
    s_bitcmp0_b32 s14, 15
    s_cbranch_scc1 L_sf_63
    s_waitcnt vmcnt(2)
    s_bitcmp0_b32 s15, 15
    s_cbranch_scc1 L_sf_63
    s_waitcnt vmcnt(1)
L_sf_63:
    buffer_load_dwordx4 v[100:103], v1, s[52:55], s97 offen offset:3072 nt
    s_add_u32 s97, s97, 32768
    v_add_u32 v1, 4096, v1
    v_and_b32 v1, 0x7fff, v1
    v_mfma_f32_16x16x32_bf16 v[32:35], v[28:31], v[84:87], v[32:35]
    v_and_b32_dpp v24, v15, v20 row_newbcast:0 row_mask:0xf bank_mask:0xf
    v_and_b32_dpp v25, v15, v21 row_newbcast:0 row_mask:0xf bank_mask:0xf
    v_and_b32_dpp v26, v15, v22 row_newbcast:0 row_mask:0xf bank_mask:0xf
    v_and_b32_dpp v27, v15, v23 row_newbcast:0 row_mask:0xf bank_mask:0xf
    s_waitcnt vmcnt(3)
    s_bitcmp0_b32 s14, 16
    s_cbranch_scc1 L_sf_64
    s_waitcnt vmcnt(2)
    s_bitcmp0_b32 s15, 16
    s_cbranch_scc1 L_sf_64
    s_waitcnt vmcnt(1)
L_sf_64:
    buffer_load_dwordx4 v[104:107], v1, s[52:55], s97 offen offset:0 nt
    v_mfma_f32_16x16x32_bf16 v[32:35], v[24:27], v[88:91], v[32:35]
    v_and_b32_dpp v28, v15, v20 row_newbcast:8 row_mask:0xf bank_mask:0xf
    v_and_b32_dpp v29, v15, v21 row_newbcast:8 row_mask:0xf bank_mask:0xf
    v_and_b32_dpp v30, v15, v22 row_newbcast:8 row_mask:0xf bank_mask:0xf
    v_and_b32_dpp v31, v15, v23 row_newbcast:8 row_mask:0xf bank_mask:0xf
    s_waitcnt vmcnt(3)
    s_bitcmp0_b32 s14, 17
    s_cbranch_scc1 L_sf_65
    s_waitcnt vmcnt(2)
    s_bitcmp0_b32 s15, 17
    s_cbranch_scc1 L_sf_65
    s_waitcnt vmcnt(1)
L_sf_65:
    buffer_load_dwordx4 v[108:111], v1, s[52:55], s97 offen offset:1024 nt
    v_mfma_f32_16x16x32_bf16 v[32:35], v[28:31], v[92:95], v[32:35]
    v_and_b32_dpp v24, v15, v20 row_newbcast:4 row_mask:0xf bank_mask:0xf
    v_and_b32_dpp v25, v15, v21 row_newbcast:4 row_mask:0xf bank_mask:0xf
    v_and_b32_dpp v26, v15, v22 row_newbcast:4 row_mask:0xf bank_mask:0xf
    v_and_b32_dpp v27, v15, v23 row_newbcast:4 row_mask:0xf bank_mask:0xf
    s_waitcnt vmcnt(3)
    s_bitcmp0_b32 s14, 18
    s_cbranch_scc1 L_sf_66
    s_waitcnt vmcnt(2)
    s_bitcmp0_b32 s15, 18
    s_cbranch_scc1 L_sf_66
    s_waitcnt vmcnt(1)
L_sf_66:
    buffer_load_dwordx4 v[112:115], v1, s[52:55], s97 offen offset:2048 nt
    v_mfma_f32_16x16x32_bf16 v[32:35], v[24:27], v[96:99], v[32:35]
    v_and_b32_dpp v28, v15, v20 row_newbcast:12 row_mask:0xf bank_mask:0xf
    v_and_b32_dpp v29, v15, v21 row_newbcast:12 row_mask:0xf bank_mask:0xf
    v_and_b32_dpp v30, v15, v22 row_newbcast:12 row_mask:0xf bank_mask:0xf
    v_and_b32_dpp v31, v15, v23 row_newbcast:12 row_mask:0xf bank_mask:0xf
    s_waitcnt vmcnt(3)
    s_bitcmp0_b32 s14, 19
    s_cbranch_scc1 L_sf_67
    s_waitcnt vmcnt(2)
    s_bitcmp0_b32 s15, 19
    s_cbranch_scc1 L_sf_67
    s_waitcnt vmcnt(1)
L_sf_67:
    buffer_load_dwordx4 v[116:119], v1, s[52:55], s97 offen offset:3072 nt
    s_add_u32 s97, s97, 32768
    v_add_u32 v1, 4096, v1
    v_and_b32 v1, 0x7fff, v1
    v_mfma_f32_16x16x32_bf16 v[32:35], v[28:31], v[100:103], v[32:35]
    v_and_b32_dpp v24, v16, v20 row_newbcast:0 row_mask:0xf bank_mask:0xf
    v_and_b32_dpp v25, v16, v21 row_newbcast:0 row_mask:0xf bank_mask:0xf
    v_and_b32_dpp v26, v16, v22 row_newbcast:0 row_mask:0xf bank_mask:0xf
    v_and_b32_dpp v27, v16, v23 row_newbcast:0 row_mask:0xf bank_mask:0xf
    s_waitcnt vmcnt(3)
    s_bitcmp0_b32 s14, 20
    s_cbranch_scc1 L_sf_68
    s_waitcnt vmcnt(2)
    s_bitcmp0_b32 s15, 20
    s_cbranch_scc1 L_sf_68
    s_waitcnt vmcnt(1)
L_sf_68:
    buffer_load_dwordx4 v[120:123], v1, s[52:55], s97 offen offset:0 nt
    v_mfma_f32_16x16x32_bf16 v[32:35], v[24:27], v[104:107], v[32:35]
    v_and_b32_dpp v28, v16, v20 row_newbcast:8 row_mask:0xf bank_mask:0xf
    v_and_b32_dpp v29, v16, v21 row_newbcast:8 row_mask:0xf bank_mask:0xf
    v_and_b32_dpp v30, v16, v22 row_newbcast:8 row_mask:0xf bank_mask:0xf
    v_and_b32_dpp v31, v16, v23 row_newbcast:8 row_mask:0xf bank_mask:0xf
    s_waitcnt vmcnt(3)
    s_bitcmp0_b32 s14, 21
    s_cbranch_scc1 L_sf_69
    s_waitcnt vmcnt(2)
    s_bitcmp0_b32 s15, 21
    s_cbranch_scc1 L_sf_69
    s_waitcnt vmcnt(1)
L_sf_69:
    buffer_load_dwordx4 v[124:127], v1, s[52:55], s97 offen offset:1024 nt
    v_mfma_f32_16x16x32_bf16 v[32:35], v[28:31], v[108:111], v[32:35]
    v_and_b32_dpp v24, v16, v20 row_newbcast:4 row_mask:0xf bank_mask:0xf
    v_and_b32_dpp v25, v16, v21 row_newbcast:4 row_mask:0xf bank_mask:0xf
    v_and_b32_dpp v26, v16, v22 row_newbcast:4 row_mask:0xf bank_mask:0xf
    v_and_b32_dpp v27, v16, v23 row_newbcast:4 row_mask:0xf bank_mask:0xf
    s_waitcnt vmcnt(3)
    s_bitcmp0_b32 s14, 22
    s_cbranch_scc1 L_sf_70
    s_waitcnt vmcnt(2)
    s_bitcmp0_b32 s15, 22
    s_cbranch_scc1 L_sf_70
    s_waitcnt vmcnt(1)
L_sf_70:
    buffer_load_dwordx4 v[128:131], v1, s[52:55], s97 offen offset:2048 nt
    v_mfma_f32_16x16x32_bf16 v[32:35], v[24:27], v[112:115], v[32:35]
    v_and_b32_dpp v28, v16, v20 row_newbcast:12 row_mask:0xf bank_mask:0xf
    v_and_b32_dpp v29, v16, v21 row_newbcast:12 row_mask:0xf bank_mask:0xf
    v_and_b32_dpp v30, v16, v22 row_newbcast:12 row_mask:0xf bank_mask:0xf
    v_and_b32_dpp v31, v16, v23 row_newbcast:12 row_mask:0xf bank_mask:0xf
    s_waitcnt vmcnt(3)
    s_bitcmp0_b32 s14, 23
    s_cbranch_scc1 L_sf_71
    s_waitcnt vmcnt(2)
    s_bitcmp0_b32 s15, 23
    s_cbranch_scc1 L_sf_71
    s_waitcnt vmcnt(1)
L_sf_71:
    buffer_load_dwordx4 v[132:135], v1, s[52:55], s97 offen offset:3072 nt
    s_add_u32 s97, s97, 32768
    v_add_u32 v1, 4096, v1
    v_and_b32 v1, 0x7fff, v1
    v_mfma_f32_16x16x32_bf16 v[32:35], v[28:31], v[116:119], v[32:35]
    v_and_b32_dpp v24, v17, v20 row_newbcast:0 row_mask:0xf bank_mask:0xf
    v_and_b32_dpp v25, v17, v21 row_newbcast:0 row_mask:0xf bank_mask:0xf
    v_and_b32_dpp v26, v17, v22 row_newbcast:0 row_mask:0xf bank_mask:0xf
    v_and_b32_dpp v27, v17, v23 row_newbcast:0 row_mask:0xf bank_mask:0xf
    s_waitcnt vmcnt(3)
    s_bitcmp0_b32 s14, 24
    s_cbranch_scc1 L_sf_72
    s_waitcnt vmcnt(2)
    s_bitcmp0_b32 s15, 24
    s_cbranch_scc1 L_sf_72
    s_waitcnt vmcnt(1)
L_sf_72:
    buffer_load_dwordx4 v[136:139], v1, s[52:55], s97 offen offset:0 nt
    v_mfma_f32_16x16x32_bf16 v[32:35], v[24:27], v[120:123], v[32:35]
    s_or_b32 s96, s59, s39
    s_cbranch_scc0 L_nofrag_73
    v_mov_b32 v104, 162060
L_lw_74:
    ds_read_b32 v105, v104
    s_waitcnt lgkmcnt(0)
    v_cmp_gt_u32 vcc, 4, v105
    s_cbranch_vccz L_lw_74e
    s_sleep 2
    s_sub_u32 s60, s60, 1
    s_cbranch_scc0 L_lw_74
    s_mov_b32 s60, 0
L_lw_74e:
    s_cmp_eq_u32 s59, 0
    s_cbranch_scc1 L_nofrag_73
    v_lshrrev_b32 v109, 4, v0
    v_bfe_u32 v104, v0, 1, 1
    v_lshl_add_u32 v104, v109, 1, v104
    v_bfe_u32 v110, v0, 2, 2
    v_lshl_add_u32 v104, v104, 3, v110
    v_lshlrev_b32 v104, 7, v104
    v_and_b32 v110, 1, v0
    v_lshl_add_u32 v104, v110, 3, v104
    s_lshl_b32 s96, s3, 13
    s_add_u32 s96, s96, 81920
    v_add_u32 v104, s96, v104
    ds_read_b64_tr_b16 v[72:73], v104 offset:0
    ds_read_b64_tr_b16 v[74:75], v104 offset:512
    ds_read_b64_tr_b16 v[76:77], v104 offset:16
    ds_read_b64_tr_b16 v[78:79], v104 offset:528
    ds_read_b64_tr_b16 v[80:81], v104 offset:32
    ds_read_b64_tr_b16 v[82:83], v104 offset:544
    ds_read_b64_tr_b16 v[84:85], v104 offset:48
    ds_read_b64_tr_b16 v[86:87], v104 offset:560
    ds_read_b64_tr_b16 v[88:89], v104 offset:64
    ds_read_b64_tr_b16 v[90:91], v104 offset:576
    ds_read_b64_tr_b16 v[92:93], v104 offset:80
    ds_read_b64_tr_b16 v[94:95], v104 offset:592
    ds_read_b64_tr_b16 v[96:97], v104 offset:96
    ds_read_b64_tr_b16 v[98:99], v104 offset:608
    ds_read_b64_tr_b16 v[100:101], v104 offset:112
    ds_read_b64_tr_b16 v[102:103], v104 offset:624
    v_bfe_u32 v105, v0, 1, 3
    v_lshlrev_b32 v105, 8, v105
    v_lshl_add_u32 v105, v109, 5, v105
    v_lshl_add_u32 v105, v110, 4, v105
    v_mul_u32_u24 v106, 320, v109
    v_bfe_u32 v110, v0, 3, 1
    v_mul_u32_u24 v110, 160, v110
    v_add_u32 v106, v106, v110
    v_and_b32 v110, 7, v0
    v_lshl_add_u32 v107, v110, 4, v106
    v_add_u32 v107, 81920, v107
    v_lshl_add_u32 v106, v110, 2, v106
    v_add_u32 v106, s96, v106
    v_mul_u32_u24 v108, 1280, v109
    v_add_u32 v108, v108, v2
    s_lshr_b32 s96, s3, 1
    s_lshl_b32 s96, s96, 11
    s_and_b32 s100, s3, 1
    s_lshl_b32 s100, s100, 7
    s_add_u32 s100, s100, s96
    s_lshl_b32 s96, s34, 13
    s_add_u32 s100, s100, s96
    s_add_u32 s100, s100, 81920
    s_mul_i32 s101, s34, 5120
    s_lshl_b32 s96, s35, 7
    s_add_u32 s101, s101, s96
    s_add_u32 s101, s101, 144640
L_nofrag_73:
    v_mov_b32 v10, 162076
    v_mov_b32 v11, 1
    s_mov_b64 exec, 1
    ds_add_u32 v10, v11
    s_mov_b64 exec, -1
    v_and_b32_dpp v28, v17, v20 row_newbcast:8 row_mask:0xf bank_mask:0xf
    v_and_b32_dpp v29, v17, v21 row_newbcast:8 row_mask:0xf bank_mask:0xf
    v_and_b32_dpp v30, v17, v22 row_newbcast:8 row_mask:0xf bank_mask:0xf
    v_and_b32_dpp v31, v17, v23 row_newbcast:8 row_mask:0xf bank_mask:0xf
    s_waitcnt vmcnt(3)
    s_bitcmp0_b32 s14, 25
    s_cbranch_scc1 L_sf_75
    s_waitcnt vmcnt(2)
    s_bitcmp0_b32 s15, 25
    s_cbranch_scc1 L_sf_75
    s_waitcnt vmcnt(1)
L_sf_75:
    buffer_load_dwordx4 v[140:143], v1, s[52:55], s97 offen offset:1024 nt
    v_mfma_f32_16x16x32_bf16 v[32:35], v[28:31], v[124:127], v[32:35]
    v_and_b32_dpp v24, v17, v20 row_newbcast:4 row_mask:0xf bank_mask:0xf
    v_and_b32_dpp v25, v17, v21 row_newbcast:4 row_mask:0xf bank_mask:0xf
    v_and_b32_dpp v26, v17, v22 row_newbcast:4 row_mask:0xf bank_mask:0xf
    v_and_b32_dpp v27, v17, v23 row_newbcast:4 row_mask:0xf bank_mask:0xf
    s_waitcnt vmcnt(3)
    s_bitcmp0_b32 s14, 26
    s_cbranch_scc1 L_sf_76
    s_waitcnt vmcnt(2)
    s_bitcmp0_b32 s15, 26
    s_cbranch_scc1 L_sf_76
    s_waitcnt vmcnt(1)
L_sf_76:
    buffer_load_dwordx4 v[144:147], v1, s[52:55], s97 offen offset:2048 nt
    v_mfma_f32_16x16x32_bf16 v[32:35], v[24:27], v[128:131], v[32:35]
    v_and_b32_dpp v28, v17, v20 row_newbcast:12 row_mask:0xf bank_mask:0xf
    v_and_b32_dpp v29, v17, v21 row_newbcast:12 row_mask:0xf bank_mask:0xf
    v_and_b32_dpp v30, v17, v22 row_newbcast:12 row_mask:0xf bank_mask:0xf
    v_and_b32_dpp v31, v17, v23 row_newbcast:12 row_mask:0xf bank_mask:0xf
    s_waitcnt vmcnt(3)
    s_bitcmp0_b32 s14, 27
    s_cbranch_scc1 L_sf_77
    s_waitcnt vmcnt(2)
    s_bitcmp0_b32 s15, 27
    s_cbranch_scc1 L_sf_77
    s_waitcnt vmcnt(1)
L_sf_77:
    buffer_load_dwordx4 v[148:151], v1, s[52:55], s97 offen offset:3072 nt
    s_add_u32 s97, s97, 32768
    v_add_u32 v1, 4096, v1
    v_and_b32 v1, 0x7fff, v1
    v_mfma_f32_16x16x32_bf16 v[32:35], v[28:31], v[132:135], v[32:35]
    v_and_b32_dpp v24, v18, v20 row_newbcast:0 row_mask:0xf bank_mask:0xf
    v_and_b32_dpp v25, v18, v21 row_newbcast:0 row_mask:0xf bank_mask:0xf
    v_and_b32_dpp v26, v18, v22 row_newbcast:0 row_mask:0xf bank_mask:0xf
    v_and_b32_dpp v27, v18, v23 row_newbcast:0 row_mask:0xf bank_mask:0xf
    s_waitcnt vmcnt(3)
    s_bitcmp0_b32 s14, 28
    s_cbranch_scc1 L_sf_78
    s_waitcnt vmcnt(2)
    s_bitcmp0_b32 s15, 28
    s_cbranch_scc1 L_sf_78
    s_waitcnt vmcnt(1)
L_sf_78:
    buffer_load_dwordx4 v[152:155], v1, s[52:55], s97 offen offset:0 nt
    v_mfma_f32_16x16x32_bf16 v[32:35], v[24:27], v[136:139], v[32:35]
    v_and_b32_dpp v28, v18, v20 row_newbcast:8 row_mask:0xf bank_mask:0xf
    v_and_b32_dpp v29, v18, v21 row_newbcast:8 row_mask:0xf bank_mask:0xf
    v_and_b32_dpp v30, v18, v22 row_newbcast:8 row_mask:0xf bank_mask:0xf
    v_and_b32_dpp v31, v18, v23 row_newbcast:8 row_mask:0xf bank_mask:0xf
    s_waitcnt vmcnt(3)
    s_bitcmp0_b32 s14, 29
    s_cbranch_scc1 L_sf_79
    s_waitcnt vmcnt(2)
    s_bitcmp0_b32 s15, 29
    s_cbranch_scc1 L_sf_79
    s_waitcnt vmcnt(1)
L_sf_79:
    buffer_load_dwordx4 v[156:159], v1, s[52:55], s97 offen offset:1024 nt
    v_mfma_f32_16x16x32_bf16 v[32:35], v[28:31], v[140:143], v[32:35]
    v_and_b32_dpp v24, v18, v20 row_newbcast:4 row_mask:0xf bank_mask:0xf
    v_and_b32_dpp v25, v18, v21 row_newbcast:4 row_mask:0xf bank_mask:0xf
    v_and_b32_dpp v26, v18, v22 row_newbcast:4 row_mask:0xf bank_mask:0xf
    v_and_b32_dpp v27, v18, v23 row_newbcast:4 row_mask:0xf bank_mask:0xf
    s_waitcnt vmcnt(3)
    s_bitcmp0_b32 s14, 30
    s_cbranch_scc1 L_sf_80
    s_waitcnt vmcnt(2)
    s_bitcmp0_b32 s15, 30
    s_cbranch_scc1 L_sf_80
    s_waitcnt vmcnt(1)
L_sf_80:
    buffer_load_dwordx4 v[160:163], v1, s[52:55], s97 offen offset:2048 nt
    v_mfma_f32_16x16x32_bf16 v[32:35], v[24:27], v[144:147], v[32:35]
    v_lshrrev_b32 v9, 4, v0
    v_lshl_add_u32 v8, v9, 2, v2
    s_lshl_b32 s96, s3, 9
    s_add_u32 s96, s96, 157824
    v_lshl_add_u32 v8, v8, 2, s96
    v_lshlrev_b32 v9, 3, v0
    v_add_u32 v9, 157824, v9
    v_mov_b32 v10, 162048
    v_mov_b32 v11, 1
    s_lshl_b32 s96, s38, 5
    s_add_u32 s96, s96, 161984
    v_mov_b32 v3, s96
    s_sub_u32 s62, 8, s39
    s_lshl_b32 s98, s34, 5
    s_add_u32 s98, s98, s35
    s_lshl_b32 s98, s98, 8
    s_add_u32 s98, s98, 81920
    v_lshlrev_b32 v39, 2, v0
    v_and_b32_dpp v28, v18, v20 row_newbcast:12 row_mask:0xf bank_mask:0xf
    v_and_b32_dpp v29, v18, v21 row_newbcast:12 row_mask:0xf bank_mask:0xf
    v_and_b32_dpp v30, v18, v22 row_newbcast:12 row_mask:0xf bank_mask:0xf
    v_and_b32_dpp v31, v18, v23 row_newbcast:12 row_mask:0xf bank_mask:0xf
    s_waitcnt vmcnt(3)
    s_bitcmp0_b32 s14, 31
    s_cbranch_scc1 L_sf_81
    s_waitcnt vmcnt(2)
    s_bitcmp0_b32 s15, 31
    s_cbranch_scc1 L_sf_81
    s_waitcnt vmcnt(1)
L_sf_81:
    buffer_load_dwordx4 v[164:167], v1, s[52:55], s97 offen offset:3072 nt
    s_mov_b32 s97, 0
    v_add_u32 v1, 4096, v1
    v_and_b32 v1, 0x7fff, v1
    v_mfma_f32_16x16x32_bf16 v[32:35], v[28:31], v[148:151], v[32:35]
    s_cmp_eq_u32 s12, -1
    s_cbranch_scc1 L_v_nopf
    v_and_b32_dpp v24, v19, v20 row_newbcast:0 row_mask:0xf bank_mask:0xf
    v_and_b32_dpp v25, v19, v21 row_newbcast:0 row_mask:0xf bank_mask:0xf
    v_and_b32_dpp v26, v19, v22 row_newbcast:0 row_mask:0xf bank_mask:0xf
    v_and_b32_dpp v27, v19, v23 row_newbcast:0 row_mask:0xf bank_mask:0xf
    s_waitcnt vmcnt(3)
    s_nop 0
    v_mfma_f32_16x16x32_bf16 v[32:35], v[24:27], v[152:155], v[32:35]
    v_and_b32_dpp v28, v19, v20 row_newbcast:8 row_mask:0xf bank_mask:0xf
    v_and_b32_dpp v29, v19, v21 row_newbcast:8 row_mask:0xf bank_mask:0xf
    v_and_b32_dpp v30, v19, v22 row_newbcast:8 row_mask:0xf bank_mask:0xf
    v_and_b32_dpp v31, v19, v23 row_newbcast:8 row_mask:0xf bank_mask:0xf
    s_waitcnt vmcnt(2)
    s_nop 0
    v_mfma_f32_16x16x32_bf16 v[32:35], v[28:31], v[156:159], v[32:35]
    v_and_b32_dpp v24, v19, v20 row_newbcast:4 row_mask:0xf bank_mask:0xf
    v_and_b32_dpp v25, v19, v21 row_newbcast:4 row_mask:0xf bank_mask:0xf
    v_and_b32_dpp v26, v19, v22 row_newbcast:4 row_mask:0xf bank_mask:0xf
    v_and_b32_dpp v27, v19, v23 row_newbcast:4 row_mask:0xf bank_mask:0xf
    s_waitcnt vmcnt(1)
    s_nop 0
    v_mfma_f32_16x16x32_bf16 v[32:35], v[24:27], v[160:163], v[32:35]
    v_and_b32_dpp v28, v19, v20 row_newbcast:12 row_mask:0xf bank_mask:0xf
    v_and_b32_dpp v29, v19, v21 row_newbcast:12 row_mask:0xf bank_mask:0xf
    v_and_b32_dpp v30, v19, v22 row_newbcast:12 row_mask:0xf bank_mask:0xf
    v_and_b32_dpp v31, v19, v23 row_newbcast:12 row_mask:0xf bank_mask:0xf
    s_waitcnt vmcnt(0)
    s_nop 0
    v_mfma_f32_16x16x32_bf16 v[32:35], v[28:31], v[164:167], v[32:35]
L_v_join:
    s_cmp_lg_u32 s13, 0
    s_cbranch_scc1 L_jobend
L_t0:
    s_mov_b32 exec_hi, 0
    s_nop 4
    ds_write_b128 v8, v[32:35]
L_t0b:
    s_mov_b64 exec, 1
    ds_add_rtn_u32 v37, v10, v11
    s_mov_b64 exec, -1
    ds_read_b32 v38, v10 offset:24
    ds_read_b128 v[24:27], v3
    ds_read_b128 v[28:31], v3 offset:16
    ds_read_b64 v[144:145], v9 offset:0
    ds_read_b64 v[146:147], v9 offset:512
    ds_read_b64 v[148:149], v9 offset:1024
    ds_read_b64 v[150:151], v9 offset:1536
    ds_read_b64 v[152:153], v9 offset:2048
    ds_read_b64 v[154:155], v9 offset:2560
    ds_read_b64 v[156:157], v9 offset:3072
    ds_read_b64 v[158:159], v9 offset:3584
    s_waitcnt lgkmcnt(10)
    v_readfirstlane_b32 s96, v37
    v_readfirstlane_b32 s61, v38
    s_cmp_lg_u32 s96, s62
    s_cbranch_scc1 L_nopub
    s_waitcnt lgkmcnt(6)
    v_pk_mul_f32 v[144:145], v[144:145], v[24:25] op_sel:[0,0] op_sel_hi:[1,0]
    v_pk_mul_f32 v[146:147], v[146:147], v[24:25] op_sel:[0,1] op_sel_hi:[1,1]
    s_waitcnt lgkmcnt(4)
    v_pk_fma_f32 v[144:145], v[148:149], v[26:27], v[144:145] op_sel:[0,0,0] op_sel_hi:[1,0,1]
    v_pk_fma_f32 v[146:147], v[150:151], v[26:27], v[146:147] op_sel:[0,1,0] op_sel_hi:[1,1,1]
    s_waitcnt lgkmcnt(2)
    v_pk_fma_f32 v[144:145], v[152:153], v[28:29], v[144:145] op_sel:[0,0,0] op_sel_hi:[1,0,1]
    v_pk_fma_f32 v[146:147], v[154:155], v[28:29], v[146:147] op_sel:[0,1,0] op_sel_hi:[1,1,1]
    s_waitcnt lgkmcnt(0)
    v_pk_fma_f32 v[144:145], v[156:157], v[30:31], v[144:145] op_sel:[0,0,0] op_sel_hi:[1,0,1]
    v_pk_fma_f32 v[146:147], v[158:159], v[30:31], v[146:147] op_sel:[0,1,0] op_sel_hi:[1,1,1]
    s_cmp_eq_u32 s61, 1
    v_pk_add_f32 v[144:145], v[144:145], v[146:147]
    v_cvt_pk_bf16_f32 v32, v144, v145
    s_cbranch_scc0 L_oslow
    buffer_store_dword v32, v39, s[40:43], s98 offen
L_odone:
L_nopub:
    s_cmp_eq_u32 s59, 0
    s_cbranch_scc1 L_not1
L_poll_90:
    buffer_load_dwordx4 v[16:19], v105, s[40:43], s100 offen sc1
    s_waitcnt vmcnt(0)
    v_max3_u32 v38, v16, v17, v18
    v_max_u32 v38, v38, v19
    v_cmp_eq_u32 vcc, -1, v38
    s_cbranch_vccz L_poll_90e
    s_sub_u32 s60, s60, 1
    s_cbranch_scc0 L_poll_90
    s_mov_b32 s60, 0
L_poll_90e:
    v_mfma_f32_16x16x32_bf16 v[112:115], v[16:19], v[72:75], 0
    v_mfma_f32_16x16x32_bf16 v[128:131], v[16:19], v[88:91], 0
    v_mfma_f32_16x16x32_bf16 v[116:119], v[16:19], v[76:79], 0
    v_mfma_f32_16x16x32_bf16 v[132:135], v[16:19], v[92:95], 0
    v_mfma_f32_16x16x32_bf16 v[120:123], v[16:19], v[80:83], 0
    v_mfma_f32_16x16x32_bf16 v[136:139], v[16:19], v[96:99], 0
    v_mfma_f32_16x16x32_bf16 v[124:127], v[16:19], v[84:87], 0
    v_mfma_f32_16x16x32_bf16 v[140:143], v[16:19], v[100:103], 0
    s_nop 0
    v_pk_add_f32 v[112:113], v[112:113], v[114:115]
    v_pk_add_f32 v[128:129], v[128:129], v[130:131]
    v_pk_add_f32 v[116:117], v[116:117], v[118:119]
    v_pk_add_f32 v[132:133], v[132:133], v[134:135]
    v_add_f32_dpp v12, v113, v112 row_ror:8 row_mask:0xf bank_mask:0x3
    v_add_f32_dpp v12, v128, v129 row_ror:8 row_mask:0xf bank_mask:0xc
    ds_write_b32 v106, v12 offset:0
    v_pk_add_f32 v[120:121], v[120:121], v[122:123]
    v_pk_add_f32 v[136:137], v[136:137], v[138:139]
    v_add_f32_dpp v13, v117, v116 row_ror:8 row_mask:0xf bank_mask:0x3
    v_add_f32_dpp v13, v132, v133 row_ror:8 row_mask:0xf bank_mask:0xc
    ds_write_b32 v106, v13 offset:32
    v_pk_add_f32 v[124:125], v[124:125], v[126:127]
    v_pk_add_f32 v[140:141], v[140:141], v[142:143]
    v_add_f32_dpp v14, v121, v120 row_ror:8 row_mask:0xf bank_mask:0x3
    v_add_f32_dpp v14, v136, v137 row_ror:8 row_mask:0xf bank_mask:0xc
    ds_write_b32 v106, v14 offset:64
    v_add_f32_dpp v15, v125, v124 row_ror:8 row_mask:0xf bank_mask:0x3
    v_add_f32_dpp v15, v140, v141 row_ror:8 row_mask:0xf bank_mask:0xc
    ds_write_b32 v106, v15 offset:96
    s_mov_b64 exec, 1
    ds_add_rtn_u32 v37, v10, v11 offset:4
    s_mov_b64 exec, -1
    ds_read_b128 v[72:75], v107 offset:0
    ds_read_b128 v[76:79], v107 offset:8192
    ds_read_b128 v[80:83], v107 offset:16384
    ds_read_b128 v[84:87], v107 offset:24576
    ds_read_b128 v[88:91], v107 offset:32768
    ds_read_b128 v[92:95], v107 offset:40960
    ds_read_b128 v[96:99], v107 offset:49152
    ds_read_b128 v[100:103], v107 offset:57344
    s_waitcnt lgkmcnt(8)
    v_readfirstlane_b32 s96, v37
    s_nop 0
    s_cmp_lg_u32 s96, 7
    s_cbranch_scc1 L_not1
    s_waitcnt lgkmcnt(6)
    v_pk_add_f32 v[72:73], v[72:73], v[76:77]
    v_pk_add_f32 v[74:75], v[74:75], v[78:79]
    s_waitcnt lgkmcnt(4)
    v_pk_add_f32 v[80:81], v[80:81], v[84:85]
    v_pk_add_f32 v[82:83], v[82:83], v[86:87]
    v_pk_add_f32 v[72:73], v[72:73], v[80:81]
    v_pk_add_f32 v[74:75], v[74:75], v[82:83]
    s_waitcnt lgkmcnt(2)
    v_pk_add_f32 v[88:89], v[88:89], v[92:93]
    v_pk_add_f32 v[90:91], v[90:91], v[94:95]
    v_pk_add_f32 v[72:73], v[72:73], v[88:89]
    v_pk_add_f32 v[74:75], v[74:75], v[90:91]
    s_waitcnt lgkmcnt(0)
    v_pk_add_f32 v[96:97], v[96:97], v[100:101]
    v_pk_add_f32 v[98:99], v[98:99], v[102:103]
    v_pk_add_f32 v[72:73], v[72:73], v[96:97]
    v_pk_add_f32 v[74:75], v[74:75], v[98:99]
    v_cvt_pk_bf16_f32 v12, v72, v73
    v_cvt_pk_bf16_f32 v13, v74, v75
    buffer_store_dwordx2 v[12:13], v108, s[40:43], s101 offen sc1
L_not1:
    s_waitcnt lgkmcnt(0)
    s_cmp_eq_u32 s39, 1
    s_cbranch_scc1 L_s_role
    s_endpgm
L_k_nopf:
    s_waitcnt vmcnt(3)
    s_bitcmp0_b32 s57, 22
    s_cbranch_scc1 L_sf_46
    s_waitcnt vmcnt(2)
    s_bitcmp0_b32 s58, 22
    s_cbranch_scc1 L_sf_46
    s_waitcnt vmcnt(1)
L_sf_46:
    buffer_load_dwordx4 v[128:131], v1, s[48:51], s97 offen offset:2048 nt
    v_min_u32 v39, 29, v0
    v_lshlrev_b32 v39, 2, v39
    buffer_load_dword v37, v39, s[44:47], 0 offen sc1
    s_waitcnt vmcnt(4)
    s_bitcmp0_b32 s57, 23
    s_cbranch_scc1 L_sf_47
    s_waitcnt vmcnt(3)
    s_bitcmp0_b32 s58, 23
    s_cbranch_scc1 L_sf_47
    s_waitcnt vmcnt(2)
L_sf_47:
    buffer_load_dwordx4 v[132:135], v1, s[48:51], s97 offen offset:3072 nt
    s_add_u32 s97, s97, 32768
    v_add_u32 v1, 4096, v1
    v_and_b32 v1, 0x7fff, v1
    s_waitcnt vmcnt(4)
    s_bitcmp0_b32 s57, 24
    s_cbranch_scc1 L_sf_48
    s_waitcnt vmcnt(3)
    s_bitcmp0_b32 s58, 24
    s_cbranch_scc1 L_sf_48
    s_waitcnt vmcnt(2)
L_sf_48:
    buffer_load_dwordx4 v[136:139], v1, s[48:51], s97 offen offset:0 nt
    s_waitcnt vmcnt(4)
    s_bitcmp0_b32 s57, 25
    s_cbranch_scc1 L_sf_49
    s_waitcnt vmcnt(3)
    s_bitcmp0_b32 s58, 25
    s_cbranch_scc1 L_sf_49
    s_waitcnt vmcnt(1)
L_sf_49:
    buffer_load_dwordx4 v[140:143], v1, s[48:51], s97 offen offset:1024 nt
    s_waitcnt vmcnt(4)
    s_bitcmp0_b32 s57, 26
    s_cbranch_scc1 L_sf_50
    s_waitcnt vmcnt(2)
    s_bitcmp0_b32 s58, 26
    s_cbranch_scc1 L_sf_50
    s_waitcnt vmcnt(1)
L_sf_50:
    buffer_load_dwordx4 v[144:147], v1, s[48:51], s97 offen offset:2048 nt
    s_waitcnt vmcnt(3)
    s_bitcmp0_b32 s57, 27
    s_cbranch_scc1 L_sf_51
    s_waitcnt vmcnt(2)
    s_bitcmp0_b32 s58, 27
    s_cbranch_scc1 L_sf_51
    s_waitcnt vmcnt(1)
L_sf_51:
    buffer_load_dwordx4 v[148:151], v1, s[48:51], s97 offen offset:3072 nt
    s_add_u32 s97, s97, 32768
    v_add_u32 v1, 4096, v1
    v_and_b32 v1, 0x7fff, v1
    v_cmp_eq_u32 vcc, 0, v37
    s_nop 0
    s_or_b32 s96, vcc_lo, vcc_hi
    buffer_load_dwordx4 v[4:7], v2, s[40:43], s98 offen sc1
    s_waitcnt vmcnt(4)
    s_bitcmp0_b32 s57, 28
    s_cbranch_scc1 L_sf_52
    s_waitcnt vmcnt(3)
    s_bitcmp0_b32 s58, 28
    s_cbranch_scc1 L_sf_52
    s_waitcnt vmcnt(2)
L_sf_52:
    buffer_load_dwordx4 v[152:155], v1, s[48:51], s97 offen offset:0 nt
    s_waitcnt vmcnt(4)
    s_bitcmp0_b32 s57, 29
    s_cbranch_scc1 L_sf_53
    s_waitcnt vmcnt(3)
    s_bitcmp0_b32 s58, 29
    s_cbranch_scc1 L_sf_53
    s_waitcnt vmcnt(2)
L_sf_53:
    buffer_load_dwordx4 v[156:159], v1, s[48:51], s97 offen offset:1024 nt
    s_waitcnt vmcnt(4)
    s_bitcmp0_b32 s57, 30
    s_cbranch_scc1 L_sf_54
    s_waitcnt vmcnt(3)
    s_bitcmp0_b32 s58, 30
    s_cbranch_scc1 L_sf_54
    s_waitcnt vmcnt(1)
L_sf_54:
    buffer_load_dwordx4 v[160:163], v1, s[48:51], s97 offen offset:2048 nt
    s_waitcnt vmcnt(4)
    s_bitcmp0_b32 s57, 31
    s_cbranch_scc1 L_sf_55
    s_waitcnt vmcnt(2)
    s_bitcmp0_b32 s58, 31
    s_cbranch_scc1 L_sf_55
    s_waitcnt vmcnt(1)
L_sf_55:
    buffer_load_dwordx4 v[164:167], v1, s[48:51], s97 offen offset:3072 nt
    s_mov_b32 s97, 0
    v_add_u32 v1, 4096, v1
    v_and_b32 v1, 0x7fff, v1
    v_add_u32 v1, 8192, v1
    v_and_b32 v1, 0x7fff, v1
    s_mov_b32 s97, 65536
    s_branch L_k_join
L_v_nopf:
    v_and_b32_dpp v24, v19, v20 row_newbcast:0 row_mask:0xf bank_mask:0xf
    v_and_b32_dpp v25, v19, v21 row_newbcast:0 row_mask:0xf bank_mask:0xf
    v_and_b32_dpp v26, v19, v22 row_newbcast:0 row_mask:0xf bank_mask:0xf
    v_and_b32_dpp v27, v19, v23 row_newbcast:0 row_mask:0xf bank_mask:0xf
    s_waitcnt vmcnt(3)
    s_bitcmp0_b32 s14, 0
    s_cbranch_scc1 L_sf_82
    s_waitcnt vmcnt(2)
    s_bitcmp0_b32 s15, 0
    s_cbranch_scc1 L_sf_82
    s_waitcnt vmcnt(1)
L_sf_82:
    buffer_load_dwordx4 v[40:43], v1, s[52:55], s97 offen offset:0 nt
    v_mfma_f32_16x16x32_bf16 v[32:35], v[24:27], v[152:155], v[32:35]
    v_and_b32_dpp v28, v19, v20 row_newbcast:8 row_mask:0xf bank_mask:0xf
    v_and_b32_dpp v29, v19, v21 row_newbcast:8 row_mask:0xf bank_mask:0xf
    v_and_b32_dpp v30, v19, v22 row_newbcast:8 row_mask:0xf bank_mask:0xf
    v_and_b32_dpp v31, v19, v23 row_newbcast:8 row_mask:0xf bank_mask:0xf
    s_waitcnt vmcnt(3)
    s_bitcmp0_b32 s14, 1
    s_cbranch_scc1 L_sf_83
    s_waitcnt vmcnt(2)
    s_bitcmp0_b32 s15, 1
    s_cbranch_scc1 L_sf_83
    s_waitcnt vmcnt(1)
L_sf_83:
    buffer_load_dwordx4 v[44:47], v1, s[52:55], s97 offen offset:1024 nt
    v_mfma_f32_16x16x32_bf16 v[32:35], v[28:31], v[156:159], v[32:35]
    v_and_b32_dpp v24, v19, v20 row_newbcast:4 row_mask:0xf bank_mask:0xf
    v_and_b32_dpp v25, v19, v21 row_newbcast:4 row_mask:0xf bank_mask:0xf
    v_and_b32_dpp v26, v19, v22 row_newbcast:4 row_mask:0xf bank_mask:0xf
    v_and_b32_dpp v27, v19, v23 row_newbcast:4 row_mask:0xf bank_mask:0xf
    s_waitcnt vmcnt(3)
    s_bitcmp0_b32 s14, 2
    s_cbranch_scc1 L_sf_84
    s_waitcnt vmcnt(2)
    s_bitcmp0_b32 s15, 2
    s_cbranch_scc1 L_sf_84
    s_waitcnt vmcnt(1)
L_sf_84:
    buffer_load_dwordx4 v[48:51], v1, s[52:55], s97 offen offset:2048 nt
    v_mfma_f32_16x16x32_bf16 v[32:35], v[24:27], v[160:163], v[32:35]
    v_and_b32_dpp v28, v19, v20 row_newbcast:12 row_mask:0xf bank_mask:0xf
    v_and_b32_dpp v29, v19, v21 row_newbcast:12 row_mask:0xf bank_mask:0xf
    v_and_b32_dpp v30, v19, v22 row_newbcast:12 row_mask:0xf bank_mask:0xf
    v_and_b32_dpp v31, v19, v23 row_newbcast:12 row_mask:0xf bank_mask:0xf
    s_waitcnt vmcnt(3)
    s_bitcmp0_b32 s14, 3
    s_cbranch_scc1 L_sf_85
    s_waitcnt vmcnt(2)
    s_bitcmp0_b32 s15, 3
    s_cbranch_scc1 L_sf_85
    s_waitcnt vmcnt(1)
L_sf_85:
    buffer_load_dwordx4 v[52:55], v1, s[52:55], s97 offen offset:3072 nt
    s_add_u32 s97, s97, 32768
    v_add_u32 v1, 4096, v1
    v_and_b32 v1, 0x7fff, v1
    v_mfma_f32_16x16x32_bf16 v[32:35], v[28:31], v[164:167], v[32:35]
    v_and_b32_dpp v24, v12, v20 row_newbcast:0 row_mask:0xf bank_mask:0xf
    v_and_b32_dpp v25, v12, v21 row_newbcast:0 row_mask:0xf bank_mask:0xf
    v_and_b32_dpp v26, v12, v22 row_newbcast:0 row_mask:0xf bank_mask:0xf
    v_and_b32_dpp v27, v12, v23 row_newbcast:0 row_mask:0xf bank_mask:0xf
    s_waitcnt vmcnt(3)
    s_bitcmp0_b32 s14, 4
    s_cbranch_scc1 L_sf_86
    s_waitcnt vmcnt(2)
    s_bitcmp0_b32 s15, 4
    s_cbranch_scc1 L_sf_86
    s_waitcnt vmcnt(1)
L_sf_86:
    buffer_load_dwordx4 v[56:59], v1, s[52:55], s97 offen offset:0 nt
    v_mfma_f32_16x16x32_bf16 v[32:35], v[24:27], v[40:43], v[32:35]
    v_and_b32_dpp v28, v12, v20 row_newbcast:8 row_mask:0xf bank_mask:0xf
    v_and_b32_dpp v29, v12, v21 row_newbcast:8 row_mask:0xf bank_mask:0xf
    v_and_b32_dpp v30, v12, v22 row_newbcast:8 row_mask:0xf bank_mask:0xf
    v_and_b32_dpp v31, v12, v23 row_newbcast:8 row_mask:0xf bank_mask:0xf
    s_waitcnt vmcnt(3)
    s_bitcmp0_b32 s14, 5
    s_cbranch_scc1 L_sf_87
    s_waitcnt vmcnt(2)
    s_bitcmp0_b32 s15, 5
    s_cbranch_scc1 L_sf_87
    s_waitcnt vmcnt(1)
L_sf_87:
    buffer_load_dwordx4 v[60:63], v1, s[52:55], s97 offen offset:1024 nt
    v_mfma_f32_16x16x32_bf16 v[32:35], v[28:31], v[44:47], v[32:35]
    v_and_b32_dpp v24, v12, v20 row_newbcast:4 row_mask:0xf bank_mask:0xf
    v_and_b32_dpp v25, v12, v21 row_newbcast:4 row_mask:0xf bank_mask:0xf
    v_and_b32_dpp v26, v12, v22 row_newbcast:4 row_mask:0xf bank_mask:0xf
    v_and_b32_dpp v27, v12, v23 row_newbcast:4 row_mask:0xf bank_mask:0xf
    s_waitcnt vmcnt(3)
    s_bitcmp0_b32 s14, 6
    s_cbranch_scc1 L_sf_88
    s_waitcnt vmcnt(2)
    s_bitcmp0_b32 s15, 6
    s_cbranch_scc1 L_sf_88
    s_waitcnt vmcnt(1)
L_sf_88:
    buffer_load_dwordx4 v[64:67], v1, s[52:55], s97 offen offset:2048 nt
    v_mfma_f32_16x16x32_bf16 v[32:35], v[24:27], v[48:51], v[32:35]
    v_and_b32_dpp v28, v12, v20 row_newbcast:12 row_mask:0xf bank_mask:0xf
    v_and_b32_dpp v29, v12, v21 row_newbcast:12 row_mask:0xf bank_mask:0xf
    v_and_b32_dpp v30, v12, v22 row_newbcast:12 row_mask:0xf bank_mask:0xf
    v_and_b32_dpp v31, v12, v23 row_newbcast:12 row_mask:0xf bank_mask:0xf
    s_waitcnt vmcnt(3)
    s_bitcmp0_b32 s14, 7
    s_cbranch_scc1 L_sf_89
    s_waitcnt vmcnt(2)
    s_bitcmp0_b32 s15, 7
    s_cbranch_scc1 L_sf_89
    s_waitcnt vmcnt(1)
L_sf_89:
    buffer_load_dwordx4 v[68:71], v1, s[52:55], s97 offen offset:3072 nt
    s_add_u32 s97, s97, 32768
    v_add_u32 v1, 4096, v1
    v_and_b32 v1, 0x7fff, v1
    v_mfma_f32_16x16x32_bf16 v[32:35], v[28:31], v[52:55], v[32:35]
    v_and_b32_dpp v24, v13, v20 row_newbcast:0 row_mask:0xf bank_mask:0xf
    v_and_b32_dpp v25, v13, v21 row_newbcast:0 row_mask:0xf bank_mask:0xf
    v_and_b32_dpp v26, v13, v22 row_newbcast:0 row_mask:0xf bank_mask:0xf
    v_and_b32_dpp v27, v13, v23 row_newbcast:0 row_mask:0xf bank_mask:0xf
    s_waitcnt vmcnt(3)
    s_nop 0
    v_mfma_f32_16x16x32_bf16 v[32:35], v[24:27], v[56:59], v[32:35]
    v_and_b32_dpp v28, v13, v20 row_newbcast:8 row_mask:0xf bank_mask:0xf
    v_and_b32_dpp v29, v13, v21 row_newbcast:8 row_mask:0xf bank_mask:0xf
    v_and_b32_dpp v30, v13, v22 row_newbcast:8 row_mask:0xf bank_mask:0xf
    v_and_b32_dpp v31, v13, v23 row_newbcast:8 row_mask:0xf bank_mask:0xf
    s_waitcnt vmcnt(2)
    s_nop 0
    v_mfma_f32_16x16x32_bf16 v[32:35], v[28:31], v[60:63], v[32:35]
    v_and_b32_dpp v24, v13, v20 row_newbcast:4 row_mask:0xf bank_mask:0xf
    v_and_b32_dpp v25, v13, v21 row_newbcast:4 row_mask:0xf bank_mask:0xf
    v_and_b32_dpp v26, v13, v22 row_newbcast:4 row_mask:0xf bank_mask:0xf
    v_and_b32_dpp v27, v13, v23 row_newbcast:4 row_mask:0xf bank_mask:0xf
    s_waitcnt vmcnt(1)
    s_nop 0
    v_mfma_f32_16x16x32_bf16 v[32:35], v[24:27], v[64:67], v[32:35]
    v_and_b32_dpp v28, v13, v20 row_newbcast:12 row_mask:0xf bank_mask:0xf
    v_and_b32_dpp v29, v13, v21 row_newbcast:12 row_mask:0xf bank_mask:0xf
    v_and_b32_dpp v30, v13, v22 row_newbcast:12 row_mask:0xf bank_mask:0xf
    v_and_b32_dpp v31, v13, v23 row_newbcast:12 row_mask:0xf bank_mask:0xf
    s_waitcnt vmcnt(0)
    s_nop 0
    v_mfma_f32_16x16x32_bf16 v[32:35], v[28:31], v[68:71], v[32:35]
    s_branch L_v_join
L_oslow:
    buffer_store_dword v32, v39, s[40:43], s98 offen sc1
    s_branch L_odone
L_qslow:
L_wy_91:
    buffer_load_dword v37, v39, s[44:47], 0 offen sc1
    s_waitcnt vmcnt(0)
    v_cmp_eq_u32 vcc, 0, v37
    s_cbranch_vccz L_wy_91e
    s_sleep 4
    s_sub_u32 s60, s60, 1
    s_cbranch_scc0 L_wy_91
    s_mov_b32 s60, 0
L_wy_91e:
L_qslow2:
L_poll_92:
    buffer_load_dwordx4 v[4:7], v2, s[40:43], s98 offen sc1
    s_waitcnt vmcnt(0)
    v_max3_u32 v38, v4, v5, v6
    v_max_u32 v38, v38, v7
    v_cmp_eq_u32 vcc, -1, v38
    s_cbranch_vccz L_poll_92e
    s_sleep 2
    s_sub_u32 s60, s60, 1
    s_cbranch_scc0 L_poll_92
    s_mov_b32 s60, 0
L_poll_92e:
    s_branch L_qok
L_mljob:
    s_lshl_b32 s96, s38, 3
    s_add_u32 s96, s96, s3
    s_lshl3_add_u32 s96, s96, s99
    buffer_store_dwordx2 v[8:9], v36, s[40:43], s96 offen sc1
    s_branch L_mldone
L_service:
    s_mov_b32 s59, 0
    v_mov_b32 v5, 0
    v_mov_b32 v105, 0
    v_mov_b32 v108, 0
    v_mov_b32 v160, 0
    v_mov_b32 v8, 162068
L_lw_93:
    ds_read_b32 v9, v8
    s_waitcnt lgkmcnt(0)
    v_cmp_gt_u32 vcc, 8, v9
    s_cbranch_vccz L_lw_93e
    s_sleep 8
    s_sub_u32 s60, s60, 1
    s_cbranch_scc0 L_lw_93
    s_mov_b32 s60, 0
L_lw_93e:
    v_and_b32 v2, 15, v0
    v_lshlrev_b32 v2, 3, v2
    v_add_u32 v3, 161920, v2
    ds_read_b64 v[8:9], v3
    s_lshl_b32 s99, s37, 5
    s_add_u32 s99, s99, s36
    s_lshl_b32 s99, s99, 7
    s_add_u32 s99, s99, 65536
    s_lshl_b32 s62, s38, 6
    s_add_u32 s62, s62, s99
    s_getreg_b32 s58, hwreg(HW_REG_XCC_ID, 0, 4)
    v_mov_b32 v10, s58
    s_lshl_b32 s98, s34, 5
    s_add_u32 s98, s98, s35
    s_lshl_b32 s63, s98, 2
    s_add_u32 s63, s63, 221184
    s_lshl_b32 s98, s98, 8
    s_add_u32 s98, s98, 81920
    v_lshlrev_b32 v39, 2, v0
    s_bfm_b64 exec, 8, 0
    s_waitcnt lgkmcnt(0)
    buffer_store_dwordx2 v[8:9], v2, s[40:43], s62 offen sc1
    s_mov_b64 exec, 1
    buffer_store_dword v10, v36, s[40:43], s63 offen sc1
    s_mov_b64 exec, -1
    v_mov_b32 v12, 162076
L_lw_94:
    ds_read_b32 v13, v12
    s_waitcnt lgkmcnt(0)
    v_cmp_gt_u32 vcc, 4, v13
    s_cbranch_vccz L_lw_94e
    s_sleep 4
    s_sub_u32 s60, s60, 1
    s_cbranch_scc0 L_lw_94
    s_mov_b32 s60, 0
L_lw_94e:
    v_and_b32 v11, 31, v0
    v_lshlrev_b32 v11, 2, v11
    s_lshl_b32 s63, s34, 7
    s_add_u32 s63, s63, 221184
    buffer_load_dword v12, v39, s[40:43], s98 offen sc1
L_poll_95:
    buffer_load_dwordx2 v[8:9], v2, s[40:43], s99 offen sc1
    buffer_load_dword v10, v11, s[40:43], s63 offen sc1
    s_waitcnt vmcnt(0)
    v_max3_u32 v38, v8, v9, v10
    v_cmp_eq_u32 vcc, -1, v38
    s_cbranch_vccz L_poll_95e
    s_sleep 16
    s_sub_u32 s60, s60, 1
    s_cbranch_scc0 L_poll_95
    s_mov_b32 s60, 0
L_poll_95e:
    v_mov_b32 v37, v8
    s_nop 1
    v_max_f32_dpp v37, v37, v37 quad_perm:[1,0,3,2] row_mask:0xf bank_mask:0xf
    s_nop 1
    v_max_f32_dpp v37, v37, v37 quad_perm:[2,3,0,1] row_mask:0xf bank_mask:0xf
    s_nop 1
    v_max_f32_dpp v37, v37, v37 row_ror:4 row_mask:0xf bank_mask:0xf
    s_nop 1
    v_max_f32_dpp v37, v37, v37 row_ror:8 row_mask:0xf bank_mask:0xf
    v_sub_f32 v8, v8, v37
    v_exp_f32 v8, v8
    s_nop 0
    v_mul_f32 v9, v8, v9
    s_nop 1
    v_add_f32_dpp v9, v9, v9 quad_perm:[1,0,3,2] row_mask:0xf bank_mask:0xf
    s_nop 1
    v_add_f32_dpp v9, v9, v9 quad_perm:[2,3,0,1] row_mask:0xf bank_mask:0xf
    s_nop 1
    v_add_f32_dpp v9, v9, v9 row_ror:4 row_mask:0xf bank_mask:0xf
    s_nop 1
    v_add_f32_dpp v9, v9, v9 row_ror:8 row_mask:0xf bank_mask:0xf
    s_getreg_b32 s62, hwreg(HW_REG_XCC_ID, 0, 4)
    v_cmp_ne_u32 vcc, s62, v10
    s_nop 0
    s_cmp_eq_u64 vcc, 0
    s_cselect_b32 s61, 1, 0
    v_rcp_f32 v9, v9
    v_lshrrev_b32 v3, 1, v2
    v_add_u32 v3, 161984, v3
    v_mul_f32 v8, v8, v9
    v_mov_b32 v10, 162072
    v_mov_b32 v11, s61
    ds_write_b32 v3, v8
    ds_write_b32 v10, v11
    s_mov_b32 s3, 1
    v_lshrrev_b32 v9, 4, v0
    v_lshl_add_u32 v8, v9, 2, v2
    s_lshl_b32 s96, s3, 9
    s_add_u32 s96, s96, 157824
    v_lshl_add_u32 v8, v8, 2, s96
    v_lshlrev_b32 v9, 3, v0
    v_add_u32 v9, 157824, v9
    v_mov_b32 v10, 162048
    v_mov_b32 v11, 1
    s_lshl_b32 s96, s38, 5
    s_add_u32 s96, s96, 161984
    v_mov_b32 v3, s96
    s_sub_u32 s62, 8, s39
    s_lshl_b32 s98, s34, 5
    s_add_u32 s98, s98, s35
    s_lshl_b32 s98, s98, 8
    s_add_u32 s98, s98, 81920
    v_lshlrev_b32 v39, 2, v0
    s_branch L_t0b
L_jobend:
    v_lshrrev_b32 v9, 4, v0
    v_lshl_add_u32 v9, v9, 2, v2
    v_lshlrev_b32 v9, 2, v9
    s_mov_b32 exec_hi, 0
    s_nop 1
    buffer_store_dwordx4 v[32:35], v9, s[40:43], s13 offen sc1
    s_endpgm
L_proxy:
    v_mov_b32 v5, 0
    v_mov_b32 v105, 0
    v_mov_b32 v108, 0
    v_mov_b32 v160, 0
    s_barrier
    s_sub_u32 s97, 7, s3
    s_mul_i32 s97, s97, 27
    s_cmp_eq_u32 s3, 5
    s_cselect_b32 s97, 32, s97
    s_add_u32 s97, s97, s35
    s_lshl_b32 s97, s97, 9
    s_add_u32 s97, s97, 188416
    v_and_b32 v2, 15, v0
    v_lshlrev_b32 v2, 3, v2
    v_bfe_u32 v20, v0, 4, 1
    v_lshl_add_u32 v20, v20, 2, v2
    v_lshlrev_b32 v20, 2, v20
    s_cmp_lg_u32 s3, 7
    s_cbranch_scc1 L_px6
    s_sub_u32 s96, 6, s59
    v_mov_b32 v8, 162068
L_lw_96:
    ds_read_b32 v9, v8
    s_waitcnt lgkmcnt(0)
    v_cmp_gt_u32 vcc, s96, v9
    s_cbranch_vccz L_lw_96e
    s_sleep 8
    s_sub_u32 s60, s60, 1
    s_cbranch_scc0 L_lw_96
    s_mov_b32 s60, 0
L_lw_96e:
    v_and_b32 v2, 15, v0
    v_lshlrev_b32 v2, 3, v2
    v_add_u32 v3, 161920, v2
    ds_read_b64 v[8:9], v3
    s_lshl_b32 s99, s37, 5
    s_add_u32 s99, s99, s36
    s_lshl_b32 s99, s99, 7
    s_add_u32 s99, s99, 65536
    s_lshl_b32 s62, s38, 6
    s_add_u32 s62, s62, s99
    s_getreg_b32 s58, hwreg(HW_REG_XCC_ID, 0, 4)
    v_mov_b32 v10, s58
    s_lshl_b32 s98, s34, 5
    s_add_u32 s98, s98, s35
    s_lshl_b32 s63, s98, 2
    s_add_u32 s63, s63, 221184
    s_lshl_b32 s98, s98, 8
    s_add_u32 s98, s98, 81920
    v_lshlrev_b32 v39, 2, v0
    s_bfm_b64 exec, s96, 0
    s_waitcnt lgkmcnt(0)
    buffer_store_dwordx2 v[8:9], v2, s[40:43], s62 offen sc1
    s_mov_b64 exec, 1
    buffer_store_dword v10, v36, s[40:43], s63 offen sc1
    s_mov_b64 exec, -1
    s_mov_b32 s100, 4
    s_lshl_b32 s63, s100, 8
    v_and_b32 v8, 15, v0
    v_lshl_add_u32 v8, v8, 4, s63
    v_lshrrev_b32 v9, 4, v0
    v_mul_u32_u24 v5, 1280, v9
    v_add_u32 v5, v5, v8
    v_mul_u32_u24 v4, 1296, v9
    v_add_u32 v4, v4, v8
    v_add_u32 v4, 81920, v4
    v_lshlrev_b32 v6, 1, v5
    v_add_u32 v6, 87104, v6
    s_lshl_b32 s62, s100, 3
    s_add_u32 s62, s62, 97344
    v_lshl_add_u32 v7, v9, 6, s62
    s_mov_b32 s48, s4
    s_mov_b32 s49, s5
    s_mov_b32 s50, 5120
    s_mov_b32 s51, 0x20000
    buffer_load_dwordx4 v[8:11], v5, s[48:51], 0 offen
    s_mov_b32 s62, 10240
    s_mov_b32 s63, 20480
L_poll_97:
    buffer_load_dwordx4 v[12:15], v5, s[40:43], s62 offen sc1
    buffer_load_dwordx4 v[16:19], v5, s[40:43], s63 offen sc1
    s_waitcnt vmcnt(0)
    v_max3_u32 v38, v12, v13, v14
    v_max3_u32 v38, v38, v15, v16
    v_max3_u32 v38, v38, v17, v18
    v_max_u32 v38, v38, v19
    v_cmp_eq_u32 vcc, -1, v38
    s_cbranch_vccz L_poll_97e
    s_sleep 32
    s_sub_u32 s60, s60, 1
    s_cbranch_scc0 L_poll_97
    s_mov_b32 s60, 0
L_poll_97e:
    v_lshlrev_b32 v40, 16, v8
    v_and_b32 v41, 0xffff0000, v8
    v_lshlrev_b32 v42, 16, v9
    v_and_b32 v43, 0xffff0000, v9
    v_lshlrev_b32 v44, 16, v10
    v_and_b32 v45, 0xffff0000, v10
    v_lshlrev_b32 v46, 16, v11
    v_and_b32 v47, 0xffff0000, v11
    v_lshlrev_b32 v48, 16, v12
    v_and_b32 v49, 0xffff0000, v12
    v_lshlrev_b32 v50, 16, v13
    v_and_b32 v51, 0xffff0000, v13
    v_lshlrev_b32 v52, 16, v14
    v_and_b32 v53, 0xffff0000, v14
    v_lshlrev_b32 v54, 16, v15
    v_and_b32 v55, 0xffff0000, v15
    v_lshlrev_b32 v56, 16, v16
    v_and_b32 v57, 0xffff0000, v16
    v_lshlrev_b32 v58, 16, v17
    v_and_b32 v59, 0xffff0000, v17
    v_lshlrev_b32 v60, 16, v18
    v_and_b32 v61, 0xffff0000, v18
    v_lshlrev_b32 v62, 16, v19
    v_and_b32 v63, 0xffff0000, v19
    v_mov_b32 v64, 0
    v_mov_b32 v65, 0
    v_mov_b32 v66, 0
    v_mov_b32 v67, 0
    v_mov_b32 v68, 0
    v_mov_b32 v69, 0
    v_mov_b32 v70, 0
    v_mov_b32 v71, 0
    s_or_b32 s96, s59, s39
    s_cbranch_scc0 L_nofrag_98
    v_mov_b32 v104, 162060
L_lw_99:
    ds_read_b32 v105, v104
    s_waitcnt lgkmcnt(0)
    v_cmp_gt_u32 vcc, 4, v105
    s_cbranch_vccz L_lw_99e
    s_sleep 2
    s_sub_u32 s60, s60, 1
    s_cbranch_scc0 L_lw_99
    s_mov_b32 s60, 0
L_lw_99e:
    s_cmp_eq_u32 s59, 0
    s_cbranch_scc1 L_nofrag_98
    v_lshrrev_b32 v109, 4, v0
    v_bfe_u32 v104, v0, 1, 1
    v_lshl_add_u32 v104, v109, 1, v104
    v_bfe_u32 v110, v0, 2, 2
    v_lshl_add_u32 v104, v104, 3, v110
    v_lshlrev_b32 v104, 7, v104
    v_and_b32 v110, 1, v0
    v_lshl_add_u32 v104, v110, 3, v104
    s_lshl_b32 s96, s3, 13
    s_add_u32 s96, s96, 81920
    v_add_u32 v104, s96, v104
    ds_read_b64_tr_b16 v[72:73], v104 offset:0
    ds_read_b64_tr_b16 v[74:75], v104 offset:512
    ds_read_b64_tr_b16 v[76:77], v104 offset:16
    ds_read_b64_tr_b16 v[78:79], v104 offset:528
    ds_read_b64_tr_b16 v[80:81], v104 offset:32
    ds_read_b64_tr_b16 v[82:83], v104 offset:544
    ds_read_b64_tr_b16 v[84:85], v104 offset:48
    ds_read_b64_tr_b16 v[86:87], v104 offset:560
    ds_read_b64_tr_b16 v[88:89], v104 offset:64
    ds_read_b64_tr_b16 v[90:91], v104 offset:576
    ds_read_b64_tr_b16 v[92:93], v104 offset:80
    ds_read_b64_tr_b16 v[94:95], v104 offset:592
    ds_read_b64_tr_b16 v[96:97], v104 offset:96
    ds_read_b64_tr_b16 v[98:99], v104 offset:608
    ds_read_b64_tr_b16 v[100:101], v104 offset:112
    ds_read_b64_tr_b16 v[102:103], v104 offset:624
    v_bfe_u32 v105, v0, 1, 3
    v_lshlrev_b32 v105, 8, v105
    v_lshl_add_u32 v105, v109, 5, v105
    v_lshl_add_u32 v105, v110, 4, v105
    v_mul_u32_u24 v106, 320, v109
    v_bfe_u32 v110, v0, 3, 1
    v_mul_u32_u24 v110, 160, v110
    v_add_u32 v106, v106, v110
    v_and_b32 v110, 7, v0
    v_lshl_add_u32 v107, v110, 4, v106
    v_add_u32 v107, 81920, v107
    v_lshl_add_u32 v106, v110, 2, v106
    v_add_u32 v106, s96, v106
    v_mul_u32_u24 v108, 1280, v109
    v_add_u32 v108, v108, v2
    s_lshr_b32 s96, s3, 1
    s_lshl_b32 s96, s96, 11
    s_and_b32 s100, s3, 1
    s_lshl_b32 s100, s100, 7
    s_add_u32 s100, s100, s96
    s_lshl_b32 s96, s34, 13
    s_add_u32 s100, s100, s96
    s_add_u32 s100, s100, 81920
    s_mul_i32 s101, s34, 5120
    s_lshl_b32 s96, s35, 7
    s_add_u32 s101, s101, s96
    s_add_u32 s101, s101, 144640
L_nofrag_98:
    v_mov_b32 v12, 162076
L_lw_100:
    ds_read_b32 v13, v12
    s_waitcnt lgkmcnt(0)
    v_cmp_gt_u32 vcc, 4, v13
    s_cbranch_vccz L_lw_100e
    s_sleep 4
    s_sub_u32 s60, s60, 1
    s_cbranch_scc0 L_lw_100
    s_mov_b32 s60, 0
L_lw_100e:
    v_and_b32 v11, 31, v0
    v_lshlrev_b32 v11, 2, v11
    s_lshl_b32 s63, s34, 7
    s_add_u32 s63, s63, 221184
    buffer_load_dword v12, v39, s[40:43], s98 offen sc1
L_poll_101:
    buffer_load_dwordx2 v[8:9], v2, s[40:43], s99 offen sc1
    buffer_load_dword v10, v11, s[40:43], s63 offen sc1
    buffer_load_dwordx4 v[32:35], v20, s[40:43], s97 offen sc1
    s_waitcnt vmcnt(0)
    v_max3_u32 v38, v8, v9, v10
    v_max3_u32 v38, v38, v32, v33
    v_max3_u32 v38, v38, v34, v35
    v_cmp_eq_u32 vcc, -1, v38
    s_cbranch_vccz L_poll_101e
    s_sleep 16
    s_sub_u32 s60, s60, 1
    s_cbranch_scc0 L_poll_101
    s_mov_b32 s60, 0
L_poll_101e:
    v_mov_b32 v37, v8
    s_nop 1
    v_max_f32_dpp v37, v37, v37 quad_perm:[1,0,3,2] row_mask:0xf bank_mask:0xf
    s_nop 1
    v_max_f32_dpp v37, v37, v37 quad_perm:[2,3,0,1] row_mask:0xf bank_mask:0xf
    s_nop 1
    v_max_f32_dpp v37, v37, v37 row_ror:4 row_mask:0xf bank_mask:0xf
    s_nop 1
    v_max_f32_dpp v37, v37, v37 row_ror:8 row_mask:0xf bank_mask:0xf
    v_sub_f32 v8, v8, v37
    v_exp_f32 v8, v8
    s_nop 0
    v_mul_f32 v9, v8, v9
    s_nop 1
    v_add_f32_dpp v9, v9, v9 quad_perm:[1,0,3,2] row_mask:0xf bank_mask:0xf
    s_nop 1
    v_add_f32_dpp v9, v9, v9 quad_perm:[2,3,0,1] row_mask:0xf bank_mask:0xf
    s_nop 1
    v_add_f32_dpp v9, v9, v9 row_ror:4 row_mask:0xf bank_mask:0xf
    s_nop 1
    v_add_f32_dpp v9, v9, v9 row_ror:8 row_mask:0xf bank_mask:0xf
    s_getreg_b32 s62, hwreg(HW_REG_XCC_ID, 0, 4)
    v_cmp_ne_u32 vcc, s62, v10
    s_nop 0
    s_cmp_eq_u64 vcc, 0
    s_cselect_b32 s61, 1, 0
    v_rcp_f32 v9, v9
    v_lshrrev_b32 v3, 1, v2
    v_add_u32 v3, 161984, v3
    v_mul_f32 v8, v8, v9
    v_mov_b32 v10, 162072
    v_mov_b32 v11, s61
    ds_write_b32 v3, v8
    ds_write_b32 v10, v11
    s_branch L_pxj
L_px6:
    s_or_b32 s96, s59, s39
    s_cbranch_scc0 L_nofrag_102
    v_mov_b32 v104, 162060
L_lw_103:
    ds_read_b32 v105, v104
    s_waitcnt lgkmcnt(0)
    v_cmp_gt_u32 vcc, 4, v105
    s_cbranch_vccz L_lw_103e
    s_sleep 2
    s_sub_u32 s60, s60, 1
    s_cbranch_scc0 L_lw_103
    s_mov_b32 s60, 0
L_lw_103e:
    s_cmp_eq_u32 s59, 0
    s_cbranch_scc1 L_nofrag_102
    v_lshrrev_b32 v109, 4, v0
    v_bfe_u32 v104, v0, 1, 1
    v_lshl_add_u32 v104, v109, 1, v104
    v_bfe_u32 v110, v0, 2, 2
    v_lshl_add_u32 v104, v104, 3, v110
    v_lshlrev_b32 v104, 7, v104
    v_and_b32 v110, 1, v0
    v_lshl_add_u32 v104, v110, 3, v104
    s_lshl_b32 s96, s3, 13
    s_add_u32 s96, s96, 81920
    v_add_u32 v104, s96, v104
    ds_read_b64_tr_b16 v[72:73], v104 offset:0
    ds_read_b64_tr_b16 v[74:75], v104 offset:512
    ds_read_b64_tr_b16 v[76:77], v104 offset:16
    ds_read_b64_tr_b16 v[78:79], v104 offset:528
    ds_read_b64_tr_b16 v[80:81], v104 offset:32
    ds_read_b64_tr_b16 v[82:83], v104 offset:544
    ds_read_b64_tr_b16 v[84:85], v104 offset:48
    ds_read_b64_tr_b16 v[86:87], v104 offset:560
    ds_read_b64_tr_b16 v[88:89], v104 offset:64
    ds_read_b64_tr_b16 v[90:91], v104 offset:576
    ds_read_b64_tr_b16 v[92:93], v104 offset:80
    ds_read_b64_tr_b16 v[94:95], v104 offset:592
    ds_read_b64_tr_b16 v[96:97], v104 offset:96
    ds_read_b64_tr_b16 v[98:99], v104 offset:608
    ds_read_b64_tr_b16 v[100:101], v104 offset:112
    ds_read_b64_tr_b16 v[102:103], v104 offset:624
    v_bfe_u32 v105, v0, 1, 3
    v_lshlrev_b32 v105, 8, v105
    v_lshl_add_u32 v105, v109, 5, v105
    v_lshl_add_u32 v105, v110, 4, v105
    v_mul_u32_u24 v106, 320, v109
    v_bfe_u32 v110, v0, 3, 1
    v_mul_u32_u24 v110, 160, v110
    v_add_u32 v106, v106, v110
    v_and_b32 v110, 7, v0
    v_lshl_add_u32 v107, v110, 4, v106
    v_add_u32 v107, 81920, v107
    v_lshl_add_u32 v106, v110, 2, v106
    v_add_u32 v106, s96, v106
    v_mul_u32_u24 v108, 1280, v109
    v_add_u32 v108, v108, v2
    s_lshr_b32 s96, s3, 1
    s_lshl_b32 s96, s96, 11
    s_and_b32 s100, s3, 1
    s_lshl_b32 s100, s100, 7
    s_add_u32 s100, s100, s96
    s_lshl_b32 s96, s34, 13
    s_add_u32 s100, s100, s96
    s_add_u32 s100, s100, 81920
    s_mul_i32 s101, s34, 5120
    s_lshl_b32 s96, s35, 7
    s_add_u32 s101, s101, s96
    s_add_u32 s101, s101, 144640
L_nofrag_102:
    v_mov_b32 v8, 162076
L_lw_104:
    ds_read_b32 v9, v8
    s_waitcnt lgkmcnt(0)
    v_cmp_gt_u32 vcc, 4, v9
    s_cbranch_vccz L_lw_104e
    s_sleep 16
    s_sub_u32 s60, s60, 1
    s_cbranch_scc0 L_lw_104
    s_mov_b32 s60, 0
L_lw_104e:
L_poll_105:
    buffer_load_dwordx4 v[32:35], v20, s[40:43], s97 offen sc1
    s_waitcnt vmcnt(0)
    v_max3_u32 v38, v32, v33, v34
    v_max_u32 v38, v38, v35
    v_cmp_eq_u32 vcc, -1, v38
    s_cbranch_vccz L_poll_105e
    s_sleep 16
    s_sub_u32 s60, s60, 1
    s_cbranch_scc0 L_poll_105
    s_mov_b32 s60, 0
L_poll_105e:
L_pxj:
    v_mov_b32 v8, 162048
L_lw_106:
    ds_read_b32 v9, v8
    s_waitcnt lgkmcnt(0)
    v_cmp_gt_u32 vcc, 3, v9
    s_cbranch_vccz L_lw_106e
    s_sleep 2
    s_sub_u32 s60, s60, 1
    s_cbranch_scc0 L_lw_106
    s_mov_b32 s60, 0
L_lw_106e:
    v_lshrrev_b32 v9, 4, v0
    v_lshl_add_u32 v8, v9, 2, v2
    s_lshl_b32 s96, s3, 9
    s_add_u32 s96, s96, 157824
    v_lshl_add_u32 v8, v8, 2, s96
    v_lshlrev_b32 v9, 3, v0
    v_add_u32 v9, 157824, v9
    v_mov_b32 v10, 162048
    v_mov_b32 v11, 1
    s_lshl_b32 s96, s38, 5
    s_add_u32 s96, s96, 161984
    v_mov_b32 v3, s96
    s_sub_u32 s62, 8, s39
    s_lshl_b32 s98, s34, 5
    s_add_u32 s98, s98, s35
    s_lshl_b32 s98, s98, 8
    s_add_u32 s98, s98, 81920
    v_lshlrev_b32 v39, 2, v0
    s_branch L_t0
L_s_role:
    s_cmp_eq_u32 s3, 7
    s_cbranch_scc1 L_t2gate
    s_cmp_gt_u32 s3, 3
    s_cbranch_scc1 L_fin_prep
    s_mov_b32 s48, s18
    s_mov_b32 s49, s19
    s_mov_b32 s50, 3456
    s_mov_b32 s51, 0x20000
    v_lshrrev_b32 v3, 4, v0
    v_bfe_u32 v1, v0, 2, 2
    v_and_b32 v2, 3, v0
    v_lshl_add_u32 v4, v3, 2, v1
    v_lshlrev_b32 v4, 1, v4
    s_lshl_b32 s62, s35, 7
    s_lshl_b32 s63, s3, 5
    s_add_u32 s62, s62, s63
    buffer_load_ushort v82, v4, s[48:51], s62 offen
    v_mov_b32 v72, 162064
L_lw_107:
    ds_read_b32 v73, v72
    s_waitcnt lgkmcnt(0)
    v_cmp_gt_u32 vcc, 4, v73
    s_cbranch_vccz L_lw_107e
    s_sleep 2
    s_sub_u32 s60, s60, 1
    s_cbranch_scc0 L_lw_107
    s_mov_b32 s60, 0
L_lw_107e:
    v_lshrrev_b32 v72, 4, v0
    v_lshlrev_b32 v72, 10, v72
    v_bfe_u32 v73, v0, 2, 2
    v_lshl_add_u32 v72, v73, 7, v72
    v_and_b32 v73, 3, v0
    v_lshl_add_u32 v72, v73, 3, v72
    v_bfe_u32 v73, v0, 3, 2
    v_lshl_add_u32 v72, v73, 5, v72
    v_xor_b32 v72, s63, v72
    v_add_u32 v73, 40960, v72
    v_and_b32 v5, 7, v0
    v_mul_u32_u24 v5, 1296, v5
    v_lshl_add_u32 v5, v3, 4, v5
    v_add_u32 v5, 147456, v5
    ds_read_b64_tr_b16 v[88:89], v72 offset:0
    ds_read_b64_tr_b16 v[90:91], v72 offset:512
    ds_read_b64_tr_b16 v[92:93], v72 offset:4096
    ds_read_b64_tr_b16 v[94:95], v72 offset:4608
    ds_read_b64_tr_b16 v[96:97], v72 offset:8192
    ds_read_b64_tr_b16 v[98:99], v72 offset:8704
    ds_read_b64_tr_b16 v[100:101], v72 offset:12288
    ds_read_b64_tr_b16 v[102:103], v72 offset:12800
    ds_read_b64_tr_b16 v[104:105], v72 offset:16384
    ds_read_b64_tr_b16 v[106:107], v72 offset:16896
    ds_read_b64_tr_b16 v[108:109], v72 offset:20480
    ds_read_b64_tr_b16 v[110:111], v72 offset:20992
    ds_read_b64_tr_b16 v[112:113], v72 offset:24576
    ds_read_b64_tr_b16 v[114:115], v72 offset:25088
    ds_read_b64_tr_b16 v[116:117], v72 offset:28672
    ds_read_b64_tr_b16 v[118:119], v72 offset:29184
    ds_read_b64_tr_b16 v[120:121], v72 offset:32768
    ds_read_b64_tr_b16 v[122:123], v72 offset:33280
    ds_read_b64_tr_b16 v[124:125], v72 offset:36864
    ds_read_b64_tr_b16 v[126:127], v72 offset:37376
    ds_read_b64_tr_b16 v[128:129], v73 offset:0
    ds_read_b64_tr_b16 v[130:131], v73 offset:512
    ds_read_b64_tr_b16 v[132:133], v73 offset:4096
    ds_read_b64_tr_b16 v[134:135], v73 offset:4608
    ds_read_b64_tr_b16 v[136:137], v73 offset:8192
    ds_read_b64_tr_b16 v[138:139], v73 offset:8704
    ds_read_b64_tr_b16 v[140:141], v73 offset:12288
    ds_read_b64_tr_b16 v[142:143], v73 offset:12800
    ds_read_b64_tr_b16 v[144:145], v73 offset:16384
    ds_read_b64_tr_b16 v[146:147], v73 offset:16896
    ds_read_b64_tr_b16 v[148:149], v73 offset:20480
    ds_read_b64_tr_b16 v[150:151], v73 offset:20992
    ds_read_b64_tr_b16 v[152:153], v73 offset:24576
    ds_read_b64_tr_b16 v[154:155], v73 offset:25088
    ds_read_b64_tr_b16 v[156:157], v73 offset:28672
    ds_read_b64_tr_b16 v[158:159], v73 offset:29184
    ds_read_b64_tr_b16 v[160:161], v73 offset:32768
    ds_read_b64_tr_b16 v[162:163], v73 offset:33280
    ds_read_b64_tr_b16 v[164:165], v73 offset:36864
    ds_read_b64_tr_b16 v[166:167], v73 offset:37376
    ds_read_b128 v[8:11], v5 offset:0
    ds_read_b128 v[12:15], v5 offset:64
    ds_read_b128 v[16:19], v5 offset:128
    ds_read_b128 v[20:23], v5 offset:192
    ds_read_b128 v[24:27], v5 offset:256
    ds_read_b128 v[28:31], v5 offset:320
    ds_read_b128 v[32:35], v5 offset:384
    ds_read_b128 v[36:39], v5 offset:448
    ds_read_b128 v[40:43], v5 offset:512
    ds_read_b128 v[44:47], v5 offset:576
    s_waitcnt lgkmcnt(9)
    v_mfma_f32_16x16x32_bf16 v[48:51], v[88:91], v[8:11], 0
    s_waitcnt lgkmcnt(8)
    v_mfma_f32_16x16x32_bf16 v[48:51], v[92:95], v[12:15], v[48:51]
    s_waitcnt lgkmcnt(7)
    v_mfma_f32_16x16x32_bf16 v[48:51], v[96:99], v[16:19], v[48:51]
    s_waitcnt lgkmcnt(6)
    v_mfma_f32_16x16x32_bf16 v[48:51], v[100:103], v[20:23], v[48:51]
    s_waitcnt lgkmcnt(5)
    v_mfma_f32_16x16x32_bf16 v[48:51], v[104:107], v[24:27], v[48:51]
    s_waitcnt lgkmcnt(4)
    v_mfma_f32_16x16x32_bf16 v[48:51], v[108:111], v[28:31], v[48:51]
    s_waitcnt lgkmcnt(3)
    v_mfma_f32_16x16x32_bf16 v[48:51], v[112:115], v[32:35], v[48:51]
    s_waitcnt lgkmcnt(2)
    v_mfma_f32_16x16x32_bf16 v[48:51], v[116:119], v[36:39], v[48:51]
    s_waitcnt lgkmcnt(1)
    v_mfma_f32_16x16x32_bf16 v[48:51], v[120:123], v[40:43], v[48:51]
    s_waitcnt lgkmcnt(0)
    v_mfma_f32_16x16x32_bf16 v[48:51], v[124:127], v[44:47], v[48:51]
    ds_read_b128 v[8:11], v5 offset:640
    ds_read_b128 v[12:15], v5 offset:704
    ds_read_b128 v[16:19], v5 offset:768
    ds_read_b128 v[20:23], v5 offset:832
    ds_read_b128 v[24:27], v5 offset:896
    ds_read_b128 v[28:31], v5 offset:960
    ds_read_b128 v[32:35], v5 offset:1024
    ds_read_b128 v[36:39], v5 offset:1088
    ds_read_b128 v[40:43], v5 offset:1152
    ds_read_b128 v[44:47], v5 offset:1216
    s_waitcnt lgkmcnt(9)
    v_mfma_f32_16x16x32_bf16 v[48:51], v[128:131], v[8:11], v[48:51]
    s_waitcnt lgkmcnt(8)
    v_mfma_f32_16x16x32_bf16 v[48:51], v[132:135], v[12:15], v[48:51]
    s_waitcnt lgkmcnt(7)
    v_mfma_f32_16x16x32_bf16 v[48:51], v[136:139], v[16:19], v[48:51]
    s_waitcnt lgkmcnt(6)
    v_mfma_f32_16x16x32_bf16 v[48:51], v[140:143], v[20:23], v[48:51]
    s_waitcnt lgkmcnt(5)
    v_mfma_f32_16x16x32_bf16 v[48:51], v[144:147], v[24:27], v[48:51]
    s_waitcnt lgkmcnt(4)
    v_mfma_f32_16x16x32_bf16 v[48:51], v[148:151], v[28:31], v[48:51]
    s_waitcnt lgkmcnt(3)
    v_mfma_f32_16x16x32_bf16 v[48:51], v[152:155], v[32:35], v[48:51]
    s_waitcnt lgkmcnt(2)
    v_mfma_f32_16x16x32_bf16 v[48:51], v[156:159], v[36:39], v[48:51]
    s_waitcnt lgkmcnt(1)
    v_mfma_f32_16x16x32_bf16 v[48:51], v[160:163], v[40:43], v[48:51]
    s_waitcnt lgkmcnt(0)
    v_mfma_f32_16x16x32_bf16 v[48:51], v[164:167], v[44:47], v[48:51]
    v_mul_u32_u24 v79, 1296, v2
    v_lshl_add_u32 v79, v1, 6, v79
    v_lshl_add_u32 v79, v3, 4, v79
    v_add_u32 v79, 81920, v79
    v_mul_u32_u24 v80, 144, v2
    v_add3_u32 v80, v80, v4, s63
    v_add_u32 v80, 97600, v80
    v_lshlrev_b32 v81, 6, v2
    v_add_u32 v81, 97344, v81
    v_mov_b32_dpp v84, v48 quad_perm:[0,1,2,3] row_mask:0xf bank_mask:0x1
    v_mov_b32_dpp v85, v48 row_ror:4 row_mask:0xf bank_mask:0x1
    v_mov_b32_dpp v84, v49 row_ror:4 row_mask:0xf bank_mask:0x2
    v_mov_b32_dpp v85, v49 quad_perm:[0,1,2,3] row_mask:0xf bank_mask:0x2
    v_mov_b32_dpp v84, v50 quad_perm:[0,1,2,3] row_mask:0xf bank_mask:0x4
    v_mov_b32_dpp v85, v50 row_ror:4 row_mask:0xf bank_mask:0x4
    v_mov_b32_dpp v84, v51 row_ror:4 row_mask:0xf bank_mask:0x8
    v_mov_b32_dpp v85, v51 quad_perm:[0,1,2,3] row_mask:0xf bank_mask:0x8
    s_mov_b32 s62, 0xbacccccd
    s_mov_b32 s63, 0xbdd2d3e8
    v_mov_b32 v86, 0xc0135761
    s_branch L_ffn1
L_fin_prep:
    s_mul_i32 s62, s35, 3
    s_add_u32 s62, s62, s3
    s_sub_u32 s62, s62, 4
    s_cmp_ge_u32 s62, 80
    s_cbranch_scc1 L_end
    s_lshl_b32 s96, s62, 7
    s_lshl_b32 s57, s62, 6
    s_mul_i32 s63, s62, 0xccd
    s_lshr_b32 s63, s63, 16
    s_mul_i32 s63, s63, 1280
    s_sub_u32 s63, s57, s63
    s_add_u32 s96, s96, 262144
    s_add_u32 s97, s96, 81920
    s_add_u32 s98, s96, 163840
    s_add_u32 s99, s96, 245760
    v_lshrrev_b32 v72, 3, v0
    v_mul_u32_u24 v72, 10240, v72
    v_and_b32 v1, 7, v0
    v_lshl_add_u32 v72, v1, 4, v72
    v_mov_b32 v100, 0
    v_mov_b32 v101, 0
    v_mov_b32 v102, 0
    v_mov_b32 v103, 0
    v_bfe_u32 v3, v0, 4, 1
    v_lshrrev_b32 v4, 5, v0
    v_lshl_add_u32 v3, v3, 1, v4
    v_lshl_add_u32 v73, v1, 2, v3
    v_lshlrev_b32 v73, 1, v73
    s_lshl_b32 s62, s57, 1
    s_add_u32 s62, s62, 87104
    v_lshl_add_u32 v74, v73, 1, s62
    s_mov_b32 s48, s22
    s_mov_b32 s49, s23
    s_mov_b32 s50, 1280
    s_mov_b32 s51, 0x20000
    s_mov_b32 s52, s28
    s_mov_b32 s53, s29
    s_mov_b32 s54, 5120
    s_mov_b32 s55, 0x20000
    buffer_load_dwordx4 v[88:91], v72, s[40:43], s96 offen sc1
    buffer_load_dwordx4 v[92:95], v72, s[40:43], s97 offen sc1
    buffer_load_dwordx4 v[96:99], v72, s[40:43], s98 offen sc1
    s_mov_b64 exec, 0xffffff
    buffer_load_dwordx4 v[100:103], v72, s[40:43], s99 offen sc1
    s_mov_b64 exec, -1
    buffer_load_ushort v75, v73, s[48:51], s63 offen
    v_and_b32 v77, 0xfffc, v73
    s_add_u32 s62, s57, 25600
    buffer_load_dword v76, v77, s[40:43], s62 offen sc1
    s_barrier
    s_waitcnt vmcnt(0)
    v_cmp_eq_u32 vcc, -1, v76
    s_cbranch_vccz L_gbok
L_poll_108:
    buffer_load_dword v76, v77, s[40:43], s62 offen sc1
    s_waitcnt vmcnt(0)
    v_cmp_eq_u32 vcc, -1, v76
    s_cbranch_vccz L_poll_108e
    s_sleep 2
    s_sub_u32 s60, s60, 1
    s_cbranch_scc0 L_poll_108
    s_mov_b32 s60, 0
L_poll_108e:
L_gbok:
    v_lshlrev_b32 v75, 16, v75
    v_and_b32 v77, 2, v73
    v_lshlrev_b32 v77, 3, v77
    v_lshrrev_b32 v76, v77, v76
    v_lshlrev_b32 v76, 16, v76
    s_barrier
    s_barrier
    ds_read_b32 v78, v74
    s_barrier
    s_mov_b64 s[4:5], -1
    s_mov_b64 s[6:7], -1
    s_mov_b64 s[8:9], -1
    s_mov_b64 s[10:11], 0xffffff
L_yg:
    s_mov_b64 exec, s[4:5]
    buffer_load_dwordx4 v[88:91], v72, s[40:43], s96 offen sc1
    s_mov_b64 exec, s[6:7]
    buffer_load_dwordx4 v[92:95], v72, s[40:43], s97 offen sc1
    s_mov_b64 exec, s[8:9]
    buffer_load_dwordx4 v[96:99], v72, s[40:43], s98 offen sc1
    s_mov_b64 exec, s[10:11]
    buffer_load_dwordx4 v[100:103], v72, s[40:43], s99 offen sc1
    s_mov_b64 exec, -1
    s_waitcnt vmcnt(3)
    v_max3_u32 v3, v88, v89, v90
    v_max_u32 v3, v3, v91
    v_cmp_eq_u32 s[4:5], -1, v3
    s_waitcnt vmcnt(2)
    v_max3_u32 v3, v92, v93, v94
    v_max_u32 v3, v3, v95
    v_cmp_eq_u32 s[6:7], -1, v3
    s_waitcnt vmcnt(1)
    v_max3_u32 v3, v96, v97, v98
    v_max_u32 v3, v3, v99
    v_cmp_eq_u32 s[8:9], -1, v3
    s_waitcnt vmcnt(0)
    v_max3_u32 v3, v100, v101, v102
    v_max_u32 v3, v3, v103
    v_cmp_eq_u32 s[10:11], -1, v3
    s_or_b64 s[16:17], s[4:5], s[6:7]
    s_or_b64 s[16:17], s[16:17], s[8:9]
    s_or_b64 s[16:17], s[16:17], s[10:11]
    s_cbranch_scc0 L_ygd
    s_sub_u32 s60, s60, 1
    s_cbranch_scc0 L_yg
L_ygd:
    v_pk_add_f32 v[88:89], v[88:89], v[92:93]
    v_pk_add_f32 v[90:91], v[90:91], v[94:95]
    v_pk_add_f32 v[96:97], v[96:97], v[100:101]
    v_pk_add_f32 v[98:99], v[98:99], v[102:103]
    v_pk_add_f32 v[88:89], v[88:89], v[96:97]
    v_pk_add_f32 v[90:91], v[90:91], v[98:99]
    s_nop 0
    v_permlane32_swap_b32 v88, v89
    v_permlane32_swap_b32 v90, v91
    v_add_f32 v88, v88, v89
    v_add_f32 v90, v90, v91
    s_nop 1
    v_permlane16_swap_b32 v88, v90
    v_add_f32 v88, v88, v90
    s_waitcnt lgkmcnt(0)
    s_nop 0
    v_add_f32_dpp v88, v88, v88 row_ror:8 row_mask:0xf bank_mask:0xf
    v_add_f32 v88, v88, v75
    v_fma_f32 v88, v88, v76, v78
    v_cvt_pk_bf16_f32 v88, v88, v88
    s_mov_b32 exec_lo, 0x00ff00ff
    s_mov_b32 exec_hi, 0x00ff00ff
    buffer_store_short v88, v73, s[52:55], s57 offen
    s_endpgm
L_t2gate:
    s_cmp_ge_u32 s35, 22
    s_cselect_b32 s62, 8, 0
    v_mov_b32 v8, 162052
L_lw_109:
    ds_read_b32 v9, v8
    s_waitcnt lgkmcnt(0)
    v_cmp_gt_u32 vcc, s62, v9
    s_cbranch_vccz L_lw_109e
    s_sleep 2
    s_sub_u32 s60, s60, 1
    s_cbranch_scc0 L_lw_109
    s_mov_b32 s60, 0
L_lw_109e:
    v_mov_b32 v8, 162048
L_lw_110:
    ds_read_b32 v9, v8
    s_waitcnt lgkmcnt(0)
    v_cmp_gt_u32 vcc, 8, v9
    s_cbranch_vccz L_lw_110e
    s_sleep 2
    s_sub_u32 s60, s60, 1
    s_cbranch_scc0 L_lw_110
    s_mov_b32 s60, 0
L_lw_110e:
    ds_read_b32 v9, v8 offset:24
    s_waitcnt lgkmcnt(0)
    v_readfirstlane_b32 s61, v9
    s_mov_b32 s58, 0x3f80
    s_mov_b32 s59, 0x3f800000
    s_mov_b32 s63, 0xff
L_pg:
    s_bitcmp0_b32 s63, 0
    s_cbranch_scc1 L_pgi0
    s_mov_b32 s62, 147456
    buffer_load_dwordx4 v[8:11], v5, s[40:43], s62 offen sc1
L_pgi0:
    s_bitcmp0_b32 s63, 1
    s_cbranch_scc1 L_pgi1
    s_mov_b32 s62, 152576
    buffer_load_dwordx4 v[12:15], v5, s[40:43], s62 offen sc1
L_pgi1:
    s_bitcmp0_b32 s63, 2
    s_cbranch_scc1 L_pgi2
    s_mov_b32 s62, 157696
    buffer_load_dwordx4 v[16:19], v5, s[40:43], s62 offen sc1
L_pgi2:
    s_bitcmp0_b32 s63, 3
    s_cbranch_scc1 L_pgi3
    s_mov_b32 s62, 162816
    buffer_load_dwordx4 v[20:23], v5, s[40:43], s62 offen sc1
L_pgi3:
    s_bitcmp0_b32 s63, 4
    s_cbranch_scc1 L_pgi4
    s_mov_b32 s62, 167936
    buffer_load_dwordx4 v[24:27], v5, s[40:43], s62 offen sc1
L_pgi4:
    s_bitcmp0_b32 s63, 5
    s_cbranch_scc1 L_pgi5
    s_mov_b32 s62, 173056
    buffer_load_dwordx4 v[28:31], v5, s[40:43], s62 offen sc1
L_pgi5:
    s_bitcmp0_b32 s63, 6
    s_cbranch_scc1 L_pgi6
    s_mov_b32 s62, 178176
    buffer_load_dwordx4 v[32:35], v5, s[40:43], s62 offen sc1
L_pgi6:
    s_bitcmp0_b32 s63, 7
    s_cbranch_scc1 L_pgi7
    s_mov_b32 s62, 183296
    buffer_load_dwordx4 v[36:39], v5, s[40:43], s62 offen sc1
L_pgi7:
    s_sub_u32 s60, s60, 1
    s_cselect_b32 s62, 0, -1
    s_cselect_b32 s60, 0, s60
    s_waitcnt vmcnt(0)
    s_bitcmp0_b32 s63, 0
    s_cbranch_scc1 L_pgc0
    v_max3_u32 v3, v8, v9, v10
    v_max_u32 v3, v3, v11
    v_and_b32 v3, s62, v3
    v_cmp_eq_u32 vcc, -1, v3
    s_cbranch_vccnz L_pgc0
    v_dot2c_f32_bf16 v64, s58, v8
    v_dot2c_f32_bf16 v65, s59, v8
    v_dot2c_f32_bf16 v66, s58, v9
    v_dot2c_f32_bf16 v67, s59, v9
    v_dot2c_f32_bf16 v68, s58, v10
    v_dot2c_f32_bf16 v69, s59, v10
    v_dot2c_f32_bf16 v70, s58, v11
    v_dot2c_f32_bf16 v71, s59, v11
    s_bitset0_b32 s63, 0
L_pgc0:
    s_bitcmp0_b32 s63, 1
    s_cbranch_scc1 L_pgc1
    v_max3_u32 v3, v12, v13, v14
    v_max_u32 v3, v3, v15
    v_and_b32 v3, s62, v3
    v_cmp_eq_u32 vcc, -1, v3
    s_cbranch_vccnz L_pgc1
    v_dot2c_f32_bf16 v64, s58, v12
    v_dot2c_f32_bf16 v65, s59, v12
    v_dot2c_f32_bf16 v66, s58, v13
    v_dot2c_f32_bf16 v67, s59, v13
    v_dot2c_f32_bf16 v68, s58, v14
    v_dot2c_f32_bf16 v69, s59, v14
    v_dot2c_f32_bf16 v70, s58, v15
    v_dot2c_f32_bf16 v71, s59, v15
    s_bitset0_b32 s63, 1
L_pgc1:
    s_bitcmp0_b32 s63, 2
    s_cbranch_scc1 L_pgc2
    v_max3_u32 v3, v16, v17, v18
    v_max_u32 v3, v3, v19
    v_and_b32 v3, s62, v3
    v_cmp_eq_u32 vcc, -1, v3
    s_cbranch_vccnz L_pgc2
    v_dot2c_f32_bf16 v64, s58, v16
    v_dot2c_f32_bf16 v65, s59, v16
    v_dot2c_f32_bf16 v66, s58, v17
    v_dot2c_f32_bf16 v67, s59, v17
    v_dot2c_f32_bf16 v68, s58, v18
    v_dot2c_f32_bf16 v69, s59, v18
    v_dot2c_f32_bf16 v70, s58, v19
    v_dot2c_f32_bf16 v71, s59, v19
    s_bitset0_b32 s63, 2
L_pgc2:
    s_bitcmp0_b32 s63, 3
    s_cbranch_scc1 L_pgc3
    v_max3_u32 v3, v20, v21, v22
    v_max_u32 v3, v3, v23
    v_and_b32 v3, s62, v3
    v_cmp_eq_u32 vcc, -1, v3
    s_cbranch_vccnz L_pgc3
    v_dot2c_f32_bf16 v64, s58, v20
    v_dot2c_f32_bf16 v65, s59, v20
    v_dot2c_f32_bf16 v66, s58, v21
    v_dot2c_f32_bf16 v67, s59, v21
    v_dot2c_f32_bf16 v68, s58, v22
    v_dot2c_f32_bf16 v69, s59, v22
    v_dot2c_f32_bf16 v70, s58, v23
    v_dot2c_f32_bf16 v71, s59, v23
    s_bitset0_b32 s63, 3
L_pgc3:
    s_bitcmp0_b32 s63, 4
    s_cbranch_scc1 L_pgc4
    v_max3_u32 v3, v24, v25, v26
    v_max_u32 v3, v3, v27
    v_and_b32 v3, s62, v3
    v_cmp_eq_u32 vcc, -1, v3
    s_cbranch_vccnz L_pgc4
    v_dot2c_f32_bf16 v64, s58, v24
    v_dot2c_f32_bf16 v65, s59, v24
    v_dot2c_f32_bf16 v66, s58, v25
    v_dot2c_f32_bf16 v67, s59, v25
    v_dot2c_f32_bf16 v68, s58, v26
    v_dot2c_f32_bf16 v69, s59, v26
    v_dot2c_f32_bf16 v70, s58, v27
    v_dot2c_f32_bf16 v71, s59, v27
    s_bitset0_b32 s63, 4
L_pgc4:
    s_bitcmp0_b32 s63, 5
    s_cbranch_scc1 L_pgc5
    v_max3_u32 v3, v28, v29, v30
    v_max_u32 v3, v3, v31
    v_and_b32 v3, s62, v3
    v_cmp_eq_u32 vcc, -1, v3
    s_cbranch_vccnz L_pgc5
    v_dot2c_f32_bf16 v64, s58, v28
    v_dot2c_f32_bf16 v65, s59, v28
    v_dot2c_f32_bf16 v66, s58, v29
    v_dot2c_f32_bf16 v67, s59, v29
    v_dot2c_f32_bf16 v68, s58, v30
    v_dot2c_f32_bf16 v69, s59, v30
    v_dot2c_f32_bf16 v70, s58, v31
    v_dot2c_f32_bf16 v71, s59, v31
    s_bitset0_b32 s63, 5
L_pgc5:
    s_bitcmp0_b32 s63, 6
    s_cbranch_scc1 L_pgc6
    v_max3_u32 v3, v32, v33, v34
    v_max_u32 v3, v3, v35
    v_and_b32 v3, s62, v3
    v_cmp_eq_u32 vcc, -1, v3
    s_cbranch_vccnz L_pgc6
    v_dot2c_f32_bf16 v64, s58, v32
    v_dot2c_f32_bf16 v65, s59, v32
    v_dot2c_f32_bf16 v66, s58, v33
    v_dot2c_f32_bf16 v67, s59, v33
    v_dot2c_f32_bf16 v68, s58, v34
    v_dot2c_f32_bf16 v69, s59, v34
    v_dot2c_f32_bf16 v70, s58, v35
    v_dot2c_f32_bf16 v71, s59, v35
    s_bitset0_b32 s63, 6
L_pgc6:
    s_bitcmp0_b32 s63, 7
    s_cbranch_scc1 L_pgc7
    v_max3_u32 v3, v36, v37, v38
    v_max_u32 v3, v3, v39
    v_and_b32 v3, s62, v3
    v_cmp_eq_u32 vcc, -1, v3
    s_cbranch_vccnz L_pgc7
    v_dot2c_f32_bf16 v64, s58, v36
    v_dot2c_f32_bf16 v65, s59, v36
    v_dot2c_f32_bf16 v66, s58, v37
    v_dot2c_f32_bf16 v67, s59, v37
    v_dot2c_f32_bf16 v68, s58, v38
    v_dot2c_f32_bf16 v69, s59, v38
    v_dot2c_f32_bf16 v70, s58, v39
    v_dot2c_f32_bf16 v71, s59, v39
    s_bitset0_b32 s63, 7
L_pgc7:
    s_bcnt1_i32_b32 s62, s63
    s_cbranch_scc0 L_pgd
    s_cmp_gt_u32 s62, 3
    s_cbranch_scc1 L_pg
    s_ff1_i32_b32 s96, s63
    s_bitset0_b32 s63, s96
    s_mul_i32 s96, s96, 5120
    s_add_u32 s96, s96, 147456
    s_cmp_eq_u32 s62, 1
    s_cbranch_scc1 L_pt1
    s_ff1_i32_b32 s97, s63
    s_bitset0_b32 s63, s97
    s_mul_i32 s97, s97, 5120
    s_add_u32 s97, s97, 147456
    s_cmp_eq_u32 s62, 2
    s_cbranch_scc1 L_pt2
    s_ff1_i32_b32 s98, s63
    s_bitset0_b32 s63, s98
    s_mul_i32 s98, s98, 5120
    s_add_u32 s98, s98, 147456
L_pt3:
L_ptl3:
    buffer_load_dwordx4 v[16:19], v5, s[40:43], s96 offen sc1
    buffer_load_dwordx4 v[20:23], v5, s[40:43], s97 offen sc1
    buffer_load_dwordx4 v[24:27], v5, s[40:43], s98 offen sc1
    s_waitcnt vmcnt(0)
    v_max3_u32 v3, v16, v17, v18
    v_max3_u32 v3, v3, v19, v20
    v_max3_u32 v3, v3, v21, v22
    v_max3_u32 v3, v3, v23, v24
    v_max3_u32 v3, v3, v25, v26
    v_max_u32 v3, v3, v27
    v_cmp_eq_u32 vcc, -1, v3
    s_cbranch_vccz L_pta3
    s_sub_u32 s60, s60, 1
    s_cbranch_scc0 L_ptl3
    s_mov_b32 s60, 0
    s_branch L_pta3
L_pt2:
L_ptl2:
    buffer_load_dwordx4 v[16:19], v5, s[40:43], s96 offen sc1
    buffer_load_dwordx4 v[20:23], v5, s[40:43], s97 offen sc1
    s_waitcnt vmcnt(0)
    v_max3_u32 v3, v16, v17, v18
    v_max3_u32 v3, v3, v19, v20
    v_max3_u32 v3, v3, v21, v22
    v_max_u32 v3, v3, v23
    v_cmp_eq_u32 vcc, -1, v3
    s_cbranch_vccz L_pta2
    s_sub_u32 s60, s60, 1
    s_cbranch_scc0 L_ptl2
    s_mov_b32 s60, 0
    s_branch L_pta2
L_pt1:
L_ptl1:
    buffer_load_dwordx4 v[16:19], v5, s[40:43], s96 offen sc1
    s_waitcnt vmcnt(0)
    v_max3_u32 v3, v16, v17, v18
    v_max_u32 v3, v3, v19
    v_cmp_eq_u32 vcc, -1, v3
    s_cbranch_vccz L_pta1
    s_sub_u32 s60, s60, 1
    s_cbranch_scc0 L_ptl1
    s_mov_b32 s60, 0
L_pta1:
    v_dot2c_f32_bf16 v64, s58, v16
    v_dot2c_f32_bf16 v65, s59, v16
    v_dot2c_f32_bf16 v66, s58, v17
    v_dot2c_f32_bf16 v67, s59, v17
    v_dot2c_f32_bf16 v68, s58, v18
    v_dot2c_f32_bf16 v69, s59, v18
    v_dot2c_f32_bf16 v70, s58, v19
    v_dot2c_f32_bf16 v71, s59, v19
L_pgd:
    v_pk_fma_f32 v[64:65], v[64:65], v[48:49], v[40:41]
    v_pk_fma_f32 v[66:67], v[66:67], v[50:51], v[42:43]
    v_pk_fma_f32 v[68:69], v[68:69], v[52:53], v[44:45]
    v_pk_fma_f32 v[70:71], v[70:71], v[54:55], v[46:47]
    v_pk_mul_f32 v[56:57], v[64:65], v[56:57]
    v_pk_mul_f32 v[58:59], v[66:67], v[58:59]
    v_pk_mul_f32 v[60:61], v[68:69], v[60:61]
    v_pk_mul_f32 v[62:63], v[70:71], v[62:63]
    v_cvt_pk_bf16_f32 v8, v56, v57
    v_cvt_pk_bf16_f32 v9, v58, v59
    v_cvt_pk_bf16_f32 v10, v60, v61
    v_cvt_pk_bf16_f32 v11, v62, v63
    ds_write_b128 v4, v[8:11]
    v_pk_add_f32 v[40:41], v[64:65], v[66:67]
    v_pk_add_f32 v[42:43], v[68:69], v[70:71]
    v_pk_mul_f32 v[44:45], v[64:65], v[64:65]
    v_pk_mul_f32 v[46:47], v[66:67], v[66:67]
    v_pk_add_f32 v[40:41], v[40:41], v[42:43]
    v_pk_fma_f32 v[44:45], v[68:69], v[68:69], v[44:45]
    v_pk_fma_f32 v[46:47], v[70:71], v[70:71], v[46:47]
    s_waitcnt lgkmcnt(0)
    s_barrier
    v_add_f32 v8, v40, v41
    v_pk_add_f32 v[44:45], v[44:45], v[46:47]
    v_add_f32 v9, v44, v45
    v_add_f32_dpp v8, v8, v8 quad_perm:[1,0,3,2] row_mask:0xf bank_mask:0xf
    s_nop 0
    v_add_f32_dpp v9, v9, v9 quad_perm:[1,0,3,2] row_mask:0xf bank_mask:0xf
    v_add_f32_dpp v8, v8, v8 quad_perm:[2,3,0,1] row_mask:0xf bank_mask:0xf
    s_nop 0
    v_add_f32_dpp v9, v9, v9 quad_perm:[2,3,0,1] row_mask:0xf bank_mask:0xf
    v_add_f32_dpp v8, v8, v8 row_ror:4 row_mask:0xf bank_mask:0xf
    s_nop 0
    v_add_f32_dpp v9, v9, v9 row_ror:4 row_mask:0xf bank_mask:0xf
    v_add_f32_dpp v8, v8, v8 row_ror:8 row_mask:0xf bank_mask:0xf
    s_nop 0
    v_add_f32_dpp v9, v9, v9 row_ror:8 row_mask:0xf bank_mask:0xf
    ds_write_b64 v7, v[8:9]
    s_waitcnt lgkmcnt(0)
    s_barrier
    ds_write_b128 v6, v[64:67]
    ds_write_b128 v6, v[68:71] offset:16
    s_waitcnt vmcnt(0) lgkmcnt(0)
    s_cmp_lg_u32 s3, 7
    s_cbranch_scc1 L_ffn2
    s_endpgm
L_pta3:
    v_dot2c_f32_bf16 v64, s58, v24
    v_dot2c_f32_bf16 v65, s59, v24
    v_dot2c_f32_bf16 v66, s58, v25
    v_dot2c_f32_bf16 v67, s59, v25
    v_dot2c_f32_bf16 v68, s58, v26
    v_dot2c_f32_bf16 v69, s59, v26
    v_dot2c_f32_bf16 v70, s58, v27
    v_dot2c_f32_bf16 v71, s59, v27
L_pta2:
    v_dot2c_f32_bf16 v64, s58, v20
    v_dot2c_f32_bf16 v65, s59, v20
    v_dot2c_f32_bf16 v66, s58, v21
    v_dot2c_f32_bf16 v67, s59, v21
    v_dot2c_f32_bf16 v68, s58, v22
    v_dot2c_f32_bf16 v69, s59, v22
    v_dot2c_f32_bf16 v70, s58, v23
    v_dot2c_f32_bf16 v71, s59, v23
    s_branch L_pta1
L_ffn1:
    s_barrier
    ds_read_b128 v[8:11], v79 offset:0
    ds_read_b128 v[12:15], v79 offset:256
    ds_read_b128 v[16:19], v79 offset:512
    ds_read_b128 v[20:23], v79 offset:768
    ds_read_b128 v[24:27], v79 offset:1024
    s_waitcnt vmcnt(0)
    v_lshlrev_b32 v82, 16, v82
    v_add_f32 v85, v85, v82
    s_waitcnt lgkmcnt(4)
    v_mfma_f32_16x16x32_bf16 v[32:35], v[88:91], v[8:11], 0
    v_mfma_f32_16x16x32_bf16 v[36:39], v[92:95], v[8:11], 0
    v_mfma_f32_16x16x32_bf16 v[40:43], v[96:99], v[8:11], 0
    v_mfma_f32_16x16x32_bf16 v[44:47], v[100:103], v[8:11], 0
    s_waitcnt lgkmcnt(3)
    v_mfma_f32_16x16x32_bf16 v[32:35], v[104:107], v[12:15], v[32:35]
    v_mfma_f32_16x16x32_bf16 v[36:39], v[108:111], v[12:15], v[36:39]
    v_mfma_f32_16x16x32_bf16 v[40:43], v[112:115], v[12:15], v[40:43]
    v_mfma_f32_16x16x32_bf16 v[44:47], v[116:119], v[12:15], v[44:47]
    s_waitcnt lgkmcnt(2)
    v_mfma_f32_16x16x32_bf16 v[32:35], v[120:123], v[16:19], v[32:35]
    v_mfma_f32_16x16x32_bf16 v[36:39], v[124:127], v[16:19], v[36:39]
    v_mfma_f32_16x16x32_bf16 v[40:43], v[128:131], v[16:19], v[40:43]
    v_mfma_f32_16x16x32_bf16 v[44:47], v[132:135], v[16:19], v[44:47]
    s_waitcnt lgkmcnt(1)
    s_barrier
    ds_read_b128 v[48:51], v81
    ds_read_b128 v[52:55], v81 offset:16
    ds_read_b64 v[56:57], v81 offset:32
    v_mfma_f32_16x16x32_bf16 v[32:35], v[136:139], v[20:23], v[32:35]
    v_mfma_f32_16x16x32_bf16 v[36:39], v[140:143], v[20:23], v[36:39]
    v_mfma_f32_16x16x32_bf16 v[40:43], v[144:147], v[20:23], v[40:43]
    v_mfma_f32_16x16x32_bf16 v[44:47], v[148:151], v[20:23], v[44:47]
    s_waitcnt lgkmcnt(3)
    v_mfma_f32_16x16x32_bf16 v[32:35], v[152:155], v[24:27], v[32:35]
    v_mfma_f32_16x16x32_bf16 v[36:39], v[156:159], v[24:27], v[36:39]
    s_waitcnt lgkmcnt(0)
    v_pk_add_f32 v[48:49], v[48:49], v[50:51]
    v_pk_add_f32 v[52:53], v[52:53], v[54:55]
    v_mfma_f32_16x16x32_bf16 v[40:43], v[160:163], v[24:27], v[40:43]
    v_pk_add_f32 v[48:49], v[48:49], v[56:57]
    v_pk_add_f32 v[48:49], v[48:49], v[52:53]
    v_mfma_f32_16x16x32_bf16 v[44:47], v[164:167], v[24:27], v[44:47]
    v_mul_f32 v48, s62, v48
    v_mul_f32 v49, s62, v49
    v_mul_f32 v7, v84, v48
    v_fma_f32 v49, -v48, v48, -v49
    v_max_f32 v49, 0, v49
    v_add_f32 v49, 0x3727c5ac, v49
    v_rsq_f32 v49, v49
    v_add_f32_dpp v5, v36, v7 row_ror:12 row_mask:0xf bank_mask:0x1
    v_add_f32_dpp v5, v41, v7 row_ror:12 row_mask:0xf bank_mask:0x2
    v_add_f32_dpp v5, v46, v7 row_ror:12 row_mask:0xf bank_mask:0x4
    v_add_f32_dpp v5, v35, v7 row_ror:12 row_mask:0xf bank_mask:0x8
    v_add_f32_dpp v4, v40, v32 row_ror:8 row_mask:0xf bank_mask:0x1
    v_add_f32_dpp v4, v45, v37 row_ror:8 row_mask:0xf bank_mask:0x2
    v_add_f32_dpp v4, v34, v42 row_ror:8 row_mask:0xf bank_mask:0x4
    v_add_f32_dpp v4, v39, v47 row_ror:8 row_mask:0xf bank_mask:0x8
    v_add_f32_dpp v6, v44, v5 row_ror:4 row_mask:0xf bank_mask:0x1
    v_add_f32_dpp v6, v33, v5 row_ror:4 row_mask:0xf bank_mask:0x2
    v_add_f32_dpp v6, v38, v5 row_ror:4 row_mask:0xf bank_mask:0x4
    v_add_f32_dpp v6, v43, v5 row_ror:4 row_mask:0xf bank_mask:0x8
    v_add_f32 v4, v4, v6
    v_fma_f32 v4, v4, v49, v85
    v_mul_f32 v5, v4, v4
    v_fma_f32 v5, v5, s63, v86
    v_mul_f32 v5, v5, v4
    v_exp_f32 v5, v5
    s_nop 0
    v_add_f32 v5, 1.0, v5
    v_rcp_f32 v5, v5
    s_nop 0
    v_mul_f32 v4, v4, v5
    v_cvt_pk_bf16_f32 v4, v4, v4
    ds_write_b16 v80, v4
    s_waitcnt lgkmcnt(0)
    s_barrier
    s_endpgm
L_helpers:
    s_cmp_lg_u32 s3, 0
    s_cbranch_scc1 L_noinit
    v_lshlrev_b32 v1, 2, v0
    v_add_u32 v1, 161920, v1
    ds_write_b32 v1, v36
    s_waitcnt lgkmcnt(0)
L_noinit:
    s_mul_i32 s101, s3, 20480
    s_mov_b32 s96, s56
    s_cmp_lt_u32 s56, 84
    s_cbranch_scc1 L_unit
    s_sub_u32 s62, s56, 124
    s_cmp_lt_u32 s62, 30
    s_cbranch_scc0 L_nojob
    s_cmp_eq_u32 s3, 2
    s_cbranch_scc1 L_clear
    s_mul_i32 s63, s3, 30
    s_add_u32 s62, s62, s63
    s_cmp_lt_u32 s62, 59
    s_cbranch_scc0 L_nojob
    s_lshl_b32 s12, s3, 13
    s_lshl_b32 s13, s62, 9
    s_add_u32 s13, s13, 188416
    s_cmp_lt_u32 s62, 27
    s_cselect_b32 s63, 0, 27
    s_cselect_b32 s3, 7, 6
    s_cmp_lt_u32 s62, 54
    s_cselect_b32 s63, s63, 32
    s_cselect_b32 s3, s3, 5
    s_sub_u32 s35, s62, s63
    s_mov_b32 s34, 2
    s_lshr_b32 s36, s35, 3
    s_add_u32 s36, s36, 8
    s_bfe_u32 s37, s35, 0x20001
    s_and_b32 s38, s35, 1
    s_mov_b32 s59, 0
    s_branch L_stream
L_nojob:
    s_barrier
    s_cmp_ge_u32 s35, 22
    s_cbranch_scc1 L_h_t1
    s_cmp_eq_u32 s39, 1
    s_cbranch_scc1 L_h_role
    s_cmp_lt_u32 s96, 124
    s_cbranch_scc1 L_unit
    s_cmp_eq_u32 s3, 3
    s_cbranch_scc1 L_service
    s_endpgm
L_unit:
    v_lshrrev_b32 v3, 4, v0
    v_and_b32 v4, 3, v0
    v_bfe_u32 v7, v0, 2, 2
    v_lshlrev_b32 v64, 5, v7
    v_lshl_add_u32 v64, v3, 3, v64
    s_sub_u32 s62, s96, 20
    s_cmp_lt_u32 s62, 64
    s_cbranch_scc1 L_u_q
    s_cmp_lt_u32 s96, 20
    s_cselect_b32 s100, 0, 1
    s_cselect_b32 s62, 0, 64
    s_sub_u32 s96, s96, s62
    s_mov_b32 s97, 0
    s_mov_b32 s99, 7680
    s_mov_b32 s48, s26
    s_mov_b32 s49, s27
    s_mov_b32 s50, 4915200
    s_mov_b32 s51, 0x20000
    s_mov_b32 s52, s24
    s_mov_b32 s53, s25
    s_mov_b32 s54, 5120
    s_mov_b32 s55, 0x20000
    v_and_b32 v6, 15, v0
    v_lshlrev_b32 v6, 4, v6
    v_mul_u32_u24 v5, 1280, v3
    v_add_u32 v5, v5, v6
    s_mul_i32 s62, s3, 320
    buffer_load_dwordx4 v[8:11], v5, s[52:55], s62 offen
    s_mov_b32 exec_lo, 0x000f000f
    s_mov_b32 exec_hi, 0x000f000f
    buffer_load_dwordx4 v[12:15], v5, s[52:55], s62 offen offset:256
    s_mov_b64 exec, -1
    s_lshl_b32 s98, s96, 7
    s_mul_i32 s13, s96, 0x199a
    s_lshr_b32 s13, s13, 16
    s_mul_i32 s63, s13, 3840
    s_add_u32 s57, s98, s63
    s_add_u32 s57, s57, 0
    v_mul_u32_u24 v5, 1280, v4
    v_add_u32 v64, v64, v5
    s_cmp_lg_u32 s13, 1
    s_cbranch_scc1 L_u_go
    s_mov_b32 s52, s4
    s_mov_b32 s53, s5
    s_mov_b32 s54, 5120
    s_mov_b32 s55, 0x20000
    v_lshrrev_b32 v6, 2, v0
    v_lshl_add_u32 v6, v6, 4, v5
    s_sub_u32 s62, s98, 1280
    buffer_load_dwordx4 v[16:19], v6, s[52:55], 0 offen offset:0
    buffer_load_dwordx4 v[20:23], v6, s[52:55], 0 offen offset:256
    buffer_load_dwordx4 v[24:27], v6, s[52:55], 0 offen offset:512
    buffer_load_dwordx4 v[28:31], v6, s[52:55], 0 offen offset:768
    buffer_load_dwordx4 v[32:35], v6, s[52:55], 0 offen offset:1024
    buffer_load_dwordx2 v[66:67], v64, s[52:55], s62 offen
    s_branch L_u_go
L_u_q:
    s_mov_b32 s97, 1
    s_mov_b32 s99, 8192
    s_mov_b32 s100, 0
    s_lshl_b32 s98, s62, 7
    s_add_u32 s57, s98, 32768
    v_lshl_add_u32 v64, v4, 13, v64
    s_mov_b32 s48, s10
    s_mov_b32 s49, s11
    s_mov_b32 s50, 5242880
    s_mov_b32 s51, 0x20000
L_u_go:
    v_lshrrev_b32 v6, 3, v0
    v_mul_lo_u32 v1, v6, s99
    v_and_b32 v6, 2, v6
    v_xor_b32 v6, v6, v0
    v_and_b32 v6, 7, v6
    v_lshl_add_u32 v1, v6, 4, v1
    v_add_u32 v1, s98, v1
    v_xor_b32 v2, 64, v1
    s_mul_i32 s63, s99, s3
    s_mul_i32 s63, s63, 160
    s_lshl_b32 s59, s99, 3
    s_mov_b32 m0, s101
    s_mov_b32 s62, 10
L_dma_111:
    buffer_load_dwordx4 v1, s[48:51], s63 offen nt lds
    s_add_u32 m0, m0, 1024
    s_add_u32 s63, s63, s59
    s_cmp_eq_u32 s100, 0
    s_cbranch_scc1 L_dma_111n0
    s_waitcnt vmcnt(1)
    s_cmp_eq_u32 s100, 2
    s_cbranch_scc1 L_dma_111n0
    s_waitcnt vmcnt(1)
L_dma_111n0:
    buffer_load_dwordx4 v2, s[48:51], s63 offen nt lds
    s_add_u32 m0, m0, 1024
    s_add_u32 s63, s63, s59
    s_cmp_eq_u32 s100, 0
    s_cbranch_scc1 L_dma_111n1
    s_waitcnt vmcnt(1)
    s_cmp_eq_u32 s100, 2
    s_cbranch_scc1 L_dma_111n1
    s_waitcnt vmcnt(1)
L_dma_111n1:
    s_sub_u32 s62, s62, 1
    s_cmp_lg_u32 s62, 0
    s_cbranch_scc1 L_dma_111
    v_min_u32 v65, 29, v0
    v_lshlrev_b32 v65, 2, v65
    s_cmp_lt_u32 s56, 20
    s_cselect_b32 s62, 0, 32
    s_cmp_lt_u32 s56, 84
    s_cselect_b32 s62, s62, 64
    v_mov_b32 v6, 128
    v_cmp_le_u32 vcc, s62, v0
    s_nop 1
    v_cndmask_b32 v65, v65, v6, vcc
    buffer_load_dword v68, v65, s[44:47], 0 offen sc1
    s_cmp_lt_u32 s56, 84
    s_cbranch_scc0 L_u_nob
    s_barrier
L_u_nob:
    v_lshrrev_b32 v60, 4, v0
    v_lshlrev_b32 v60, 10, v60
    v_bfe_u32 v6, v0, 2, 2
    v_lshl_add_u32 v60, v6, 7, v60
    v_and_b32 v6, 3, v0
    v_lshl_add_u32 v60, v6, 3, v60
    v_bfe_u32 v6, v0, 3, 2
    v_lshl_add_u32 v60, v6, 5, v60
    v_xor_b32 v61, 32, v60
    v_xor_b32 v62, 64, v60
    v_xor_b32 v63, 0x60, v60
    v_add_u32 v60, s101, v60
    v_add_u32 v61, s101, v61
    v_add_u32 v62, s101, v62
    v_add_u32 v63, s101, v63
    v_mov_b32 v56, 1.0
    v_mov_b32 v57, 1.0
    v_mov_b32 v58, 1.0
    v_mov_b32 v59, 1.0
    s_mov_b32 s58, 0
    s_cmp_eq_u32 s97, 1
    s_cbranch_scc1 L_u_q2
    s_cmp_eq_u32 s13, 4
    s_cselect_b32 s58, 1.0, 0
    s_cmp_eq_u32 s13, 1
    s_cselect_b32 s58, 1.0, s58
    s_cselect_b32 s56, 1, 0
    s_waitcnt vmcnt(21)
    s_mov_b32 s62, 0xbfb8aa3b
    v_lshlrev_b32 v40, 16, v8
    v_and_b32 v41, 0xffff0000, v8
    v_lshlrev_b32 v42, 16, v9
    v_and_b32 v43, 0xffff0000, v9
    v_lshlrev_b32 v44, 16, v10
    v_and_b32 v45, 0xffff0000, v10
    v_lshlrev_b32 v46, 16, v11
    v_and_b32 v47, 0xffff0000, v11
    v_mul_f32 v48, s62, v40
    v_mul_f32 v49, s62, v41
    v_mul_f32 v50, s62, v42
    v_mul_f32 v51, s62, v43
    v_mul_f32 v52, s62, v44
    v_mul_f32 v53, s62, v45
    v_mul_f32 v54, s62, v46
    v_mul_f32 v55, s62, v47
    v_exp_f32 v48, v48
    v_exp_f32 v49, v49
    v_exp_f32 v50, v50
    v_exp_f32 v51, v51
    v_exp_f32 v52, v52
    v_exp_f32 v53, v53
    v_exp_f32 v54, v54
    v_exp_f32 v55, v55
    v_add_f32 v48, 1.0, v48
    v_add_f32 v49, 1.0, v49
    v_add_f32 v50, 1.0, v50
    v_add_f32 v51, 1.0, v51
    v_add_f32 v52, 1.0, v52
    v_add_f32 v53, 1.0, v53
    v_add_f32 v54, 1.0, v54
    v_add_f32 v55, 1.0, v55
    v_rcp_f32 v48, v48
    v_rcp_f32 v49, v49
    v_rcp_f32 v50, v50
    v_rcp_f32 v51, v51
    v_rcp_f32 v52, v52
    v_rcp_f32 v53, v53
    v_rcp_f32 v54, v54
    v_rcp_f32 v55, v55
    v_mul_f32 v40, v40, v48
    v_mul_f32 v41, v41, v49
    v_mul_f32 v42, v42, v50
    v_mul_f32 v43, v43, v51
    v_mul_f32 v44, v44, v52
    v_mul_f32 v45, v45, v53
    v_mul_f32 v46, v46, v54
    v_mul_f32 v47, v47, v55
    v_cvt_pk_bf16_f32 v8, v40, v41
    v_cvt_pk_bf16_f32 v9, v42, v43
    v_cvt_pk_bf16_f32 v10, v44, v45
    v_cvt_pk_bf16_f32 v11, v46, v47
    v_lshlrev_b32 v40, 16, v12
    v_and_b32 v41, 0xffff0000, v12
    v_lshlrev_b32 v42, 16, v13
    v_and_b32 v43, 0xffff0000, v13
    v_lshlrev_b32 v44, 16, v14
    v_and_b32 v45, 0xffff0000, v14
    v_lshlrev_b32 v46, 16, v15
    v_and_b32 v47, 0xffff0000, v15
    v_mul_f32 v48, s62, v40
    v_mul_f32 v49, s62, v41
    v_mul_f32 v50, s62, v42
    v_mul_f32 v51, s62, v43
    v_mul_f32 v52, s62, v44
    v_mul_f32 v53, s62, v45
    v_mul_f32 v54, s62, v46
    v_mul_f32 v55, s62, v47
    v_exp_f32 v48, v48
    v_exp_f32 v49, v49
    v_exp_f32 v50, v50
    v_exp_f32 v51, v51
    v_exp_f32 v52, v52
    v_exp_f32 v53, v53
    v_exp_f32 v54, v54
    v_exp_f32 v55, v55
    v_add_f32 v48, 1.0, v48
    v_add_f32 v49, 1.0, v49
    v_add_f32 v50, 1.0, v50
    v_add_f32 v51, 1.0, v51
    v_add_f32 v52, 1.0, v52
    v_add_f32 v53, 1.0, v53
    v_add_f32 v54, 1.0, v54
    v_add_f32 v55, 1.0, v55
    v_rcp_f32 v48, v48
    v_rcp_f32 v49, v49
    v_rcp_f32 v50, v50
    v_rcp_f32 v51, v51
    v_rcp_f32 v52, v52
    v_rcp_f32 v53, v53
    v_rcp_f32 v54, v54
    v_rcp_f32 v55, v55
    v_mul_f32 v40, v40, v48
    v_mul_f32 v41, v41, v49
    v_mul_f32 v42, v42, v50
    v_mul_f32 v43, v43, v51
    v_mul_f32 v44, v44, v52
    v_mul_f32 v45, v45, v53
    v_mul_f32 v46, v46, v54
    v_mul_f32 v47, v47, v55
    v_cvt_pk_bf16_f32 v12, v40, v41
    v_cvt_pk_bf16_f32 v13, v42, v43
    v_cvt_pk_bf16_f32 v14, v44, v45
    v_cvt_pk_bf16_f32 v15, v46, v47
    s_mul_i32 s62, s3, 1344
    s_add_u32 s62, s62, 151552
    v_mul_u32_u24 v5, 336, v3
    v_and_b32 v6, 15, v0
    v_lshl_add_u32 v5, v6, 4, v5
    v_add_u32 v5, s62, v5
    ds_write_b128 v5, v[8:11]
    s_mov_b32 exec_lo, 0x000f000f
    s_mov_b32 exec_hi, 0x000f000f
    ds_write_b128 v5, v[12:15] offset:256
    s_mov_b64 exec, -1
    v_mul_u32_u24 v5, 336, v4
    v_lshl_add_u32 v5, v3, 4, v5
    v_add_u32 v5, s62, v5
    s_mov_b32 s59, 0.5
    s_cmp_eq_u32 s56, 0
    s_cbranch_scc1 L_u_nost
    v_mov_b32 v40, 0
    v_mov_b32 v41, 0
    s_mov_b32 s62, 0x3f803f80
    v_dot2c_f32_bf16 v40, s62, v16
    v_dot2c_f32_bf16 v41, v16, v16
    v_dot2c_f32_bf16 v40, s62, v17
    v_dot2c_f32_bf16 v41, v17, v17
    v_dot2c_f32_bf16 v40, s62, v18
    v_dot2c_f32_bf16 v41, v18, v18
    v_dot2c_f32_bf16 v40, s62, v19
    v_dot2c_f32_bf16 v41, v19, v19
    v_dot2c_f32_bf16 v40, s62, v20
    v_dot2c_f32_bf16 v41, v20, v20
    v_dot2c_f32_bf16 v40, s62, v21
    v_dot2c_f32_bf16 v41, v21, v21
    v_dot2c_f32_bf16 v40, s62, v22
    v_dot2c_f32_bf16 v41, v22, v22
    v_dot2c_f32_bf16 v40, s62, v23
    v_dot2c_f32_bf16 v41, v23, v23
    v_dot2c_f32_bf16 v40, s62, v24
    v_dot2c_f32_bf16 v41, v24, v24
    v_dot2c_f32_bf16 v40, s62, v25
    v_dot2c_f32_bf16 v41, v25, v25
    v_dot2c_f32_bf16 v40, s62, v26
    v_dot2c_f32_bf16 v41, v26, v26
    v_dot2c_f32_bf16 v40, s62, v27
    v_dot2c_f32_bf16 v41, v27, v27
    v_dot2c_f32_bf16 v40, s62, v28
    v_dot2c_f32_bf16 v41, v28, v28
    v_dot2c_f32_bf16 v40, s62, v29
    v_dot2c_f32_bf16 v41, v29, v29
    v_dot2c_f32_bf16 v40, s62, v30
    v_dot2c_f32_bf16 v41, v30, v30
    v_dot2c_f32_bf16 v40, s62, v31
    v_dot2c_f32_bf16 v41, v31, v31
    v_dot2c_f32_bf16 v40, s62, v32
    v_dot2c_f32_bf16 v41, v32, v32
    v_dot2c_f32_bf16 v40, s62, v33
    v_dot2c_f32_bf16 v41, v33, v33
    v_dot2c_f32_bf16 v40, s62, v34
    v_dot2c_f32_bf16 v41, v34, v34
    v_dot2c_f32_bf16 v40, s62, v35
    v_dot2c_f32_bf16 v41, v35, v35
    s_nop 1
    v_add_f32_dpp v40, v40, v40 row_ror:4 row_mask:0xf bank_mask:0xf
    v_add_f32_dpp v41, v41, v41 row_ror:4 row_mask:0xf bank_mask:0xf
    s_nop 0
    v_add_f32_dpp v40, v40, v40 row_ror:8 row_mask:0xf bank_mask:0xf
    v_add_f32_dpp v41, v41, v41 row_ror:8 row_mask:0xf bank_mask:0xf
    v_mov_b32 v42, v40
    v_mov_b32 v43, v41
    s_nop 0
    v_permlane16_swap_b32 v40, v42
    v_permlane16_swap_b32 v41, v43
    v_add_f32 v40, v40, v42
    v_add_f32 v41, v41, v43
    v_mov_b32 v42, v40
    v_mov_b32 v43, v41
    s_nop 0
    v_permlane32_swap_b32 v40, v42
    v_permlane32_swap_b32 v41, v43
    v_add_f32 v40, v40, v42
    v_add_f32 v41, v41, v43
    s_mov_b32 s62, 0x3acccccd
    v_mul_f32 v40, s62, v40
    v_mul_f32 v41, s62, v41
    v_fma_f32 v41, -v40, v40, v41
    v_max_f32 v41, 0, v41
    v_add_f32 v41, 0x3727c5ac, v41
    v_rsq_f32 v41, v41
    v_lshlrev_b32 v56, 16, v66
    v_and_b32 v57, 0xffff0000, v66
    v_lshlrev_b32 v58, 16, v67
    v_and_b32 v59, 0xffff0000, v67
    v_sub_f32 v56, v56, v40
    v_sub_f32 v57, v57, v40
    v_sub_f32 v58, v58, v40
    v_sub_f32 v59, v59, v40
    v_mul_f32 v56, v56, v41
    v_mul_f32 v57, v57, v41
    v_mul_f32 v58, v58, v41
    v_mul_f32 v59, v59, v41
L_u_nost:
    ds_read_b128 v[8:11], v5 offset:0
    ds_read_b128 v[12:15], v5 offset:64
    ds_read_b128 v[16:19], v5 offset:128
    ds_read_b128 v[20:23], v5 offset:192
    ds_read_b128 v[24:27], v5 offset:256
    s_branch L_u_frag
L_u_q2:
    s_mov_b32 s59, 1.0
L_u_frag:
    s_waitcnt vmcnt(0)
    v_cmp_eq_u32 vcc, 0, v68
    s_cbranch_vccz L_u_yok
L_wy_112:
    buffer_load_dword v37, v65, s[44:47], 0 offen sc1
    s_waitcnt vmcnt(0)
    v_cmp_eq_u32 vcc, 0, v37
    s_cbranch_vccz L_wy_112e
    s_sleep 4
    s_sub_u32 s60, s60, 1
    s_cbranch_scc0 L_wy_112
    s_mov_b32 s60, 0
L_wy_112e:
L_u_yok:
    ds_read_b64_tr_b16 v[80:81], v60 offset:0
    ds_read_b64_tr_b16 v[82:83], v60 offset:512
    ds_read_b64_tr_b16 v[84:85], v61 offset:0
    ds_read_b64_tr_b16 v[86:87], v61 offset:512
    ds_read_b64_tr_b16 v[88:89], v62 offset:0
    ds_read_b64_tr_b16 v[90:91], v62 offset:512
    ds_read_b64_tr_b16 v[92:93], v63 offset:0
    ds_read_b64_tr_b16 v[94:95], v63 offset:512
    ds_read_b64_tr_b16 v[96:97], v60 offset:4096
    ds_read_b64_tr_b16 v[98:99], v60 offset:4608
    ds_read_b64_tr_b16 v[100:101], v61 offset:4096
    ds_read_b64_tr_b16 v[102:103], v61 offset:4608
    ds_read_b64_tr_b16 v[104:105], v62 offset:4096
    ds_read_b64_tr_b16 v[106:107], v62 offset:4608
    ds_read_b64_tr_b16 v[108:109], v63 offset:4096
    ds_read_b64_tr_b16 v[110:111], v63 offset:4608
    ds_read_b64_tr_b16 v[112:113], v60 offset:8192
    ds_read_b64_tr_b16 v[114:115], v60 offset:8704
    ds_read_b64_tr_b16 v[116:117], v61 offset:8192
    ds_read_b64_tr_b16 v[118:119], v61 offset:8704
    ds_read_b64_tr_b16 v[120:121], v62 offset:8192
    ds_read_b64_tr_b16 v[122:123], v62 offset:8704
    ds_read_b64_tr_b16 v[124:125], v63 offset:8192
    ds_read_b64_tr_b16 v[126:127], v63 offset:8704
    ds_read_b64_tr_b16 v[128:129], v60 offset:12288
    ds_read_b64_tr_b16 v[130:131], v60 offset:12800
    ds_read_b64_tr_b16 v[132:133], v61 offset:12288
    ds_read_b64_tr_b16 v[134:135], v61 offset:12800
    ds_read_b64_tr_b16 v[136:137], v62 offset:12288
    ds_read_b64_tr_b16 v[138:139], v62 offset:12800
    ds_read_b64_tr_b16 v[140:141], v63 offset:12288
    ds_read_b64_tr_b16 v[142:143], v63 offset:12800
    ds_read_b64_tr_b16 v[144:145], v60 offset:16384
    ds_read_b64_tr_b16 v[146:147], v60 offset:16896
    ds_read_b64_tr_b16 v[148:149], v61 offset:16384
    ds_read_b64_tr_b16 v[150:151], v61 offset:16896
    ds_read_b64_tr_b16 v[152:153], v62 offset:16384
    ds_read_b64_tr_b16 v[154:155], v62 offset:16896
    ds_read_b64_tr_b16 v[156:157], v63 offset:16384
    ds_read_b64_tr_b16 v[158:159], v63 offset:16896
    s_cmp_eq_u32 s97, 0
    s_cbranch_scc1 L_u_mm
    v_and_b32 v5, 7, v0
    v_mul_u32_u24 v5, 1280, v5
    v_lshl_add_u32 v5, v3, 4, v5
    s_mul_i32 s63, s3, 320
    s_add_u32 s63, s63, 0
    v_lshrrev_b32 v6, 1, v0
    v_mul_u32_u24 v6, 158, v6
    v_and_b32 v6, 0xfffc, v6
    v_and_b32 v7, 1, v0
    v_mul_u32_u24 v7, 5120, v7
    v_add_u32 v6, v6, v7
    s_mov_b64 exec, 63
L_poll_113:
    buffer_load_dword v8, v6, s[40:43], s63 offen offset:3840 sc1
    s_waitcnt vmcnt(0)
    v_cmp_eq_u32 vcc, -1, v8
    s_cbranch_vccz L_poll_113e
    s_sleep 4
    s_sub_u32 s60, s60, 1
    s_cbranch_scc0 L_poll_113
    s_mov_b32 s60, 0
L_poll_113e:
    s_mov_b64 exec, -1
L_poll_114:
    buffer_load_dwordx4 v[8:11], v5, s[40:43], s63 offen offset:0 sc1
    buffer_load_dwordx4 v[12:15], v5, s[40:43], s63 offen offset:64 sc1
    buffer_load_dwordx4 v[16:19], v5, s[40:43], s63 offen offset:128 sc1
    buffer_load_dwordx4 v[20:23], v5, s[40:43], s63 offen offset:192 sc1
    buffer_load_dwordx4 v[24:27], v5, s[40:43], s63 offen offset:256 sc1
    s_waitcnt vmcnt(0)
    v_max3_u32 v37, v8, v9, v10
    v_max3_u32 v37, v37, v11, v12
    v_max3_u32 v37, v37, v13, v14
    v_max3_u32 v37, v37, v15, v16
    v_max3_u32 v37, v37, v17, v18
    v_max3_u32 v37, v37, v19, v20
    v_max3_u32 v37, v37, v21, v22
    v_max3_u32 v37, v37, v23, v24
    v_max3_u32 v37, v37, v25, v26
    v_max_u32 v37, v37, v27
    v_cmp_eq_u32 vcc, -1, v37
    s_cbranch_vccz L_poll_114e
    s_sleep 1
    s_sub_u32 s60, s60, 1
    s_cbranch_scc0 L_poll_114
    s_mov_b32 s60, 0
L_poll_114e:
L_u_mm:
    s_waitcnt lgkmcnt(0)
    v_mfma_f32_16x16x32_bf16 v[40:43], v[80:83], v[8:11], 0
    v_mfma_f32_16x16x32_bf16 v[44:47], v[84:87], v[8:11], 0
    v_mfma_f32_16x16x32_bf16 v[48:51], v[88:91], v[8:11], 0
    v_mfma_f32_16x16x32_bf16 v[52:55], v[92:95], v[8:11], 0
    v_mfma_f32_16x16x32_bf16 v[40:43], v[96:99], v[12:15], v[40:43]
    v_mfma_f32_16x16x32_bf16 v[44:47], v[100:103], v[12:15], v[44:47]
    v_mfma_f32_16x16x32_bf16 v[48:51], v[104:107], v[12:15], v[48:51]
    v_mfma_f32_16x16x32_bf16 v[52:55], v[108:111], v[12:15], v[52:55]
    v_mfma_f32_16x16x32_bf16 v[40:43], v[112:115], v[16:19], v[40:43]
    v_mfma_f32_16x16x32_bf16 v[44:47], v[116:119], v[16:19], v[44:47]
    v_mfma_f32_16x16x32_bf16 v[48:51], v[120:123], v[16:19], v[48:51]
    v_mfma_f32_16x16x32_bf16 v[52:55], v[124:127], v[16:19], v[52:55]
    v_mfma_f32_16x16x32_bf16 v[40:43], v[128:131], v[20:23], v[40:43]
    v_mfma_f32_16x16x32_bf16 v[44:47], v[132:135], v[20:23], v[44:47]
    v_mfma_f32_16x16x32_bf16 v[48:51], v[136:139], v[20:23], v[48:51]
    v_mfma_f32_16x16x32_bf16 v[52:55], v[140:143], v[20:23], v[52:55]
    v_mfma_f32_16x16x32_bf16 v[40:43], v[144:147], v[24:27], v[40:43]
    v_mfma_f32_16x16x32_bf16 v[44:47], v[148:151], v[24:27], v[44:47]
    v_mfma_f32_16x16x32_bf16 v[48:51], v[152:155], v[24:27], v[48:51]
    v_mfma_f32_16x16x32_bf16 v[52:55], v[156:159], v[24:27], v[52:55]
    v_lshlrev_b32 v5, 4, v0
    v_add_u32 v5, 147456, v5
    s_lshl_b32 s62, s3, 10
    v_add_u32 v6, s62, v5
    v_mov_b32 v32, 162056
    v_mov_b32 v33, 1
    v_add_f32_dpp v28, v40, v40 row_ror:4 row_mask:0xf bank_mask:0x1
    v_add_f32_dpp v29, v41, v41 row_ror:4 row_mask:0xf bank_mask:0x1
    v_add_f32_dpp v30, v42, v42 row_ror:4 row_mask:0xf bank_mask:0x1
    v_add_f32_dpp v31, v43, v43 row_ror:4 row_mask:0xf bank_mask:0x1
    v_add_f32_dpp v28, v44, v44 row_ror:4 row_mask:0xf bank_mask:0x2
    v_add_f32_dpp v29, v45, v45 row_ror:4 row_mask:0xf bank_mask:0x2
    v_add_f32_dpp v30, v46, v46 row_ror:4 row_mask:0xf bank_mask:0x2
    v_add_f32_dpp v31, v47, v47 row_ror:4 row_mask:0xf bank_mask:0x2
    v_add_f32_dpp v28, v48, v48 row_ror:4 row_mask:0xf bank_mask:0x4
    v_add_f32_dpp v29, v49, v49 row_ror:4 row_mask:0xf bank_mask:0x4
    v_add_f32_dpp v30, v50, v50 row_ror:4 row_mask:0xf bank_mask:0x4
    v_add_f32_dpp v31, v51, v51 row_ror:4 row_mask:0xf bank_mask:0x4
    v_add_f32_dpp v28, v52, v52 row_ror:4 row_mask:0xf bank_mask:0x8
    v_add_f32_dpp v29, v53, v53 row_ror:4 row_mask:0xf bank_mask:0x8
    v_add_f32_dpp v30, v54, v54 row_ror:4 row_mask:0xf bank_mask:0x8
    v_add_f32_dpp v31, v55, v55 row_ror:4 row_mask:0xf bank_mask:0x8
    ds_write_b128 v6, v[28:31]
    s_mov_b64 exec, 1
    ds_add_rtn_u32 v34, v32, v33
    s_mov_b64 exec, -1
    ds_read_b128 v[8:11], v5
    ds_read_b128 v[12:15], v5 offset:1024
    ds_read_b128 v[16:19], v5 offset:2048
    ds_read_b128 v[20:23], v5 offset:3072
    s_waitcnt lgkmcnt(0)
    v_readfirstlane_b32 s62, v34
    v_mov_b32 v24, s58
    s_cmp_eq_u32 s62, 0
    s_cbranch_scc1 L_service
    s_cmp_lg_u32 s62, 3
    s_cbranch_scc1 L_end
    v_add_f32 v8, v8, v12
    v_add_f32 v16, v16, v20
    v_add_f32 v9, v9, v13
    v_add_f32 v17, v17, v21
    v_add_f32 v10, v10, v14
    v_add_f32 v18, v18, v22
    v_add_f32 v11, v11, v15
    v_add_f32 v19, v19, v23
    v_add_f32 v8, v8, v16
    v_add_f32 v9, v9, v17
    v_add_f32 v10, v10, v18
    v_add_f32 v11, v11, v19
    v_fma_f32 v8, v8, s59, v24
    v_fma_f32 v9, v9, s59, v24
    v_fma_f32 v10, v10, s59, v24
    v_fma_f32 v11, v11, s59, v24
    v_mul_f32 v8, v8, v56
    v_mul_f32 v9, v9, v57
    v_mul_f32 v10, v10, v58
    v_mul_f32 v11, v11, v59
    v_cvt_pk_bf16_f32 v8, v8, v9
    v_cvt_pk_bf16_f32 v9, v10, v11
    buffer_store_dwordx2 v[8:9], v64, s[40:43], s57 offen sc1
    s_endpgm
L_clear:
    s_barrier
    s_lshl_b32 s63, s62, 2
    s_mul_i32 s62, s62, 7168
    s_add_u32 s62, s62, 10240
    v_mov_b32 v4, -1
    v_mov_b32 v5, -1
    v_mov_b32 v6, -1
    v_mov_b32 v7, -1
    v_lshlrev_b32 v8, 4, v0
    buffer_store_dwordx4 v[4:7], v8, s[40:43], s62 offen offset:0 sc1
    buffer_store_dwordx4 v[4:7], v8, s[40:43], s62 offen offset:1024 sc1
    buffer_store_dwordx4 v[4:7], v8, s[40:43], s62 offen offset:2048 sc1
    buffer_store_dwordx4 v[4:7], v8, s[40:43], s62 offen offset:3072 sc1
    s_add_u32 s62, s62, 4096
    buffer_store_dwordx4 v[4:7], v8, s[40:43], s62 offen offset:0 sc1
    buffer_store_dwordx4 v[4:7], v8, s[40:43], s62 offen offset:1024 sc1
    buffer_store_dwordx4 v[4:7], v8, s[40:43], s62 offen offset:2048 sc1
    v_mov_b32 v8, s63
    s_waitcnt vmcnt(0)
    s_mov_b64 exec, 1
    buffer_store_dword v4, v8, s[44:47], 0 offen sc1
    s_mov_b64 exec, -1
    s_endpgm
L_h_t1:
    s_cmp_lg_u32 s2, 250
    s_cbranch_scc1 L_h_noclr
    s_cmp_lg_u32 s3, 3
    s_cbranch_scc1 L_h_noclr
    s_mov_b32 s62, 0
    v_mov_b32 v4, -1
    v_mov_b32 v5, -1
    v_mov_b32 v6, -1
    v_mov_b32 v7, -1
    v_lshlrev_b32 v8, 4, v0
    buffer_store_dwordx4 v[4:7], v8, s[40:43], s62 offen offset:0 sc1
    buffer_store_dwordx4 v[4:7], v8, s[40:43], s62 offen offset:1024 sc1
    buffer_store_dwordx4 v[4:7], v8, s[40:43], s62 offen offset:2048 sc1
    buffer_store_dwordx4 v[4:7], v8, s[40:43], s62 offen offset:3072 sc1
    s_add_u32 s62, s62, 4096
    buffer_store_dwordx4 v[4:7], v8, s[40:43], s62 offen offset:0 sc1
    buffer_store_dwordx4 v[4:7], v8, s[40:43], s62 offen offset:1024 sc1
    buffer_store_dwordx4 v[4:7], v8, s[40:43], s62 offen offset:2048 sc1
    buffer_store_dwordx4 v[4:7], v8, s[40:43], s62 offen offset:3072 sc1
    s_add_u32 s62, s62, 4096
    buffer_store_dwordx4 v[4:7], v8, s[40:43], s62 offen offset:0 sc1
    buffer_store_dwordx4 v[4:7], v8, s[40:43], s62 offen offset:1024 sc1
    v_mov_b32 v8, 128
    s_waitcnt vmcnt(0)
    s_mov_b64 exec, 1
    buffer_store_dword v4, v8, s[44:47], 0 offen sc1
    s_mov_b64 exec, -1
L_h_noclr:
    v_lshrrev_b32 v1, 3, v0
    v_mul_u32_u24 v1, 1280, v1
    v_and_b32 v2, 7, v0
    v_lshl_add_u32 v1, v2, 4, v1
    s_lshl2_add_u32 s63, s34, s3
    s_mul_i32 s63, s63, 163840
    s_lshl_b32 s62, s35, 7
    s_add_u32 s63, s63, s62
    s_sub_u32 s63, s63, 2816
    s_lshl_b32 s62, s3, 14
    s_add_u32 s62, s62, 81920
    s_mov_b32 m0, s62
    s_mov_b32 s48, s12
    s_mov_b32 s49, s13
    s_mov_b32 s50, 5242880
    s_mov_b32 s51, 0x20000
    s_add_u32 s100, s39, 1
    s_mov_b32 s62, 8
L_dma_115:
    buffer_load_dwordx4 v1, s[48:51], s63 offen nt lds
    s_add_u32 m0, m0, 1024
    s_add_u32 s63, s63, 10240
    s_cmp_eq_u32 s100, 0
    s_cbranch_scc1 L_dma_115n0
    s_waitcnt vmcnt(4)
    s_cmp_eq_u32 s100, 2
    s_cbranch_scc1 L_dma_115n0
    s_waitcnt vmcnt(1)
L_dma_115n0:
    buffer_load_dwordx4 v1, s[48:51], s63 offen nt lds
    s_add_u32 m0, m0, 1024
    s_add_u32 s63, s63, 10240
    s_cmp_eq_u32 s100, 0
    s_cbranch_scc1 L_dma_115n1
    s_waitcnt vmcnt(4)
    s_cmp_eq_u32 s100, 2
    s_cbranch_scc1 L_dma_115n1
    s_waitcnt vmcnt(1)
L_dma_115n1:
    s_sub_u32 s62, s62, 1
    s_cmp_lg_u32 s62, 0
    s_cbranch_scc1 L_dma_115
    s_cmp_eq_u32 s39, 1
    s_cbranch_scc1 L_h_role
    s_waitcnt vmcnt(0)
    v_mov_b32 v4, 162060
    v_mov_b32 v5, 1
    s_mov_b64 exec, 1
    ds_add_u32 v4, v5
    s_mov_b64 exec, -1
    s_cmp_eq_u32 s3, 0
    s_cbranch_scc1 L_service
    s_endpgm
L_h_role:
    v_lshrrev_b32 v3, 4, v0
    v_and_b32 v2, 3, v0
    v_bfe_u32 v1, v0, 2, 2
    v_mul_u32_u24 v160, 2560, v2
    v_lshl_add_u32 v160, v1, 6, v160
    v_lshl_add_u32 v160, v3, 4, v160
    s_mul_i32 s57, s35, 10240
    s_mul_i32 s62, s3, 640
    s_add_u32 s57, s57, s62
    s_add_u32 s57, s57, 262144
    v_mov_b32 v4, -1
    v_mov_b32 v5, -1
    v_mov_b32 v6, -1
    v_mov_b32 v7, -1
    buffer_store_dwordx4 v[4:7], v160, s[40:43], s57 offen sc1
    buffer_store_dwordx4 v[4:7], v160, s[40:43], s57 offen offset:256 sc1
    s_mov_b32 exec_lo, 0x00ff00ff
    s_mov_b32 exec_hi, 0x00ff00ff
    buffer_store_dwordx4 v[4:7], v160, s[40:43], s57 offen offset:512 sc1
    s_mov_b64 exec, -1
    v_add_u32 v8, 0, v0
    v_mul_u32_u24 v10, 0xccd, v8
    v_lshrrev_b32 v10, 16, v10
    v_mul_u32_u24 v9, 20, v10
    v_sub_u32 v8, v8, v9
    v_mul_u32_u24 v10, 1280, v10
    v_lshl_add_u32 v10, v8, 4, v10
    v_add_u32 v8, 64, v0
    v_mul_u32_u24 v11, 0xccd, v8
    v_lshrrev_b32 v11, 16, v11
    v_mul_u32_u24 v9, 20, v11
    v_sub_u32 v8, v8, v9
    v_mul_u32_u24 v11, 1280, v11
    v_lshl_add_u32 v11, v8, 4, v11
    v_add_u32 v8, 128, v0
    v_mul_u32_u24 v12, 0xccd, v8
    v_lshrrev_b32 v12, 16, v12
    v_mul_u32_u24 v9, 20, v12
    v_sub_u32 v8, v8, v9
    v_mul_u32_u24 v12, 1280, v12
    v_lshl_add_u32 v12, v8, 4, v12
    v_add_u32 v8, 192, v0
    v_mul_u32_u24 v13, 0xccd, v8
    v_lshrrev_b32 v13, 16, v13
    v_mul_u32_u24 v9, 20, v13
    v_sub_u32 v8, v8, v9
    v_mul_u32_u24 v13, 1280, v13
    v_lshl_add_u32 v13, v8, 4, v13
    v_add_u32 v8, 256, v0
    v_mul_u32_u24 v14, 0xccd, v8
    v_lshrrev_b32 v14, 16, v14
    v_mul_u32_u24 v9, 20, v14
    v_sub_u32 v8, v8, v9
    v_mul_u32_u24 v14, 1280, v14
    v_lshl_add_u32 v14, v8, 4, v14
    s_waitcnt vmcnt(0)
    v_mov_b32 v8, 162060
    v_mov_b32 v9, 1
    s_mov_b64 exec, 1
    ds_add_u32 v8, v9
    s_mov_b64 exec, -1
    s_mov_b32 s48, s20
    s_mov_b32 s49, s21
    s_mov_b32 s50, 2211840
    s_mov_b32 s51, 0x20000
    s_mul_i32 s63, s35, 81920
    s_mul_i32 s62, s3, 320
    s_add_u32 s63, s63, s62
    s_mov_b32 m0, s101
    s_mov_b32 s62, 4
L_w2dma:
    buffer_load_dwordx4 v10, s[48:51], s63 offen nt lds
    s_add_u32 m0, m0, 1024
    s_waitcnt vmcnt(4)
    s_cmp_ge_u32 s35, 22
    s_cbranch_scc1 L_w2n0
    s_waitcnt vmcnt(2)
L_w2n0:
    buffer_load_dwordx4 v11, s[48:51], s63 offen nt lds
    s_add_u32 m0, m0, 1024
    s_waitcnt vmcnt(4)
    s_cmp_ge_u32 s35, 22
    s_cbranch_scc1 L_w2n1
    s_waitcnt vmcnt(2)
L_w2n1:
    buffer_load_dwordx4 v12, s[48:51], s63 offen nt lds
    s_add_u32 m0, m0, 1024
    s_waitcnt vmcnt(4)
    s_cmp_ge_u32 s35, 22
    s_cbranch_scc1 L_w2n2
    s_waitcnt vmcnt(2)
L_w2n2:
    buffer_load_dwordx4 v13, s[48:51], s63 offen nt lds
    s_add_u32 m0, m0, 1024
    s_waitcnt vmcnt(4)
    s_cmp_ge_u32 s35, 22
    s_cbranch_scc1 L_w2n3
    s_waitcnt vmcnt(2)
L_w2n3:
    buffer_load_dwordx4 v14, s[48:51], s63 offen nt lds
    s_add_u32 m0, m0, 1024
    s_waitcnt vmcnt(4)
    s_cmp_ge_u32 s35, 22
    s_cbranch_scc1 L_w2n4
    s_waitcnt vmcnt(2)
L_w2n4:
    s_add_u32 s63, s63, 20480
    s_sub_u32 s62, s62, 1
    s_cmp_lg_u32 s62, 0
    s_cbranch_scc1 L_w2dma
    v_lshl_add_u32 v8, v3, 3, v1
    v_mul_u32_u24 v8, 320, v8
    v_lshl_add_u32 v8, v2, 3, v8
    v_add_u32 v8, s101, v8
    s_waitcnt vmcnt(0)
    ds_read_b64_tr_b16 v[80:81], v8 offset:0
    ds_read_b64_tr_b16 v[82:83], v8 offset:1280
    ds_read_b64_tr_b16 v[84:85], v8 offset:10240
    ds_read_b64_tr_b16 v[86:87], v8 offset:11520
    ds_read_b64_tr_b16 v[88:89], v8 offset:32
    ds_read_b64_tr_b16 v[90:91], v8 offset:1312
    ds_read_b64_tr_b16 v[92:93], v8 offset:10272
    ds_read_b64_tr_b16 v[94:95], v8 offset:11552
    ds_read_b64_tr_b16 v[96:97], v8 offset:64
    ds_read_b64_tr_b16 v[98:99], v8 offset:1344
    ds_read_b64_tr_b16 v[100:101], v8 offset:10304
    ds_read_b64_tr_b16 v[102:103], v8 offset:11584
    ds_read_b64_tr_b16 v[104:105], v8 offset:96
    ds_read_b64_tr_b16 v[106:107], v8 offset:1376
    ds_read_b64_tr_b16 v[108:109], v8 offset:10336
    ds_read_b64_tr_b16 v[110:111], v8 offset:11616
    ds_read_b64_tr_b16 v[112:113], v8 offset:128
    ds_read_b64_tr_b16 v[114:115], v8 offset:1408
    ds_read_b64_tr_b16 v[116:117], v8 offset:10368
    ds_read_b64_tr_b16 v[118:119], v8 offset:11648
    ds_read_b64_tr_b16 v[120:121], v8 offset:160
    ds_read_b64_tr_b16 v[122:123], v8 offset:1440
    ds_read_b64_tr_b16 v[124:125], v8 offset:10400
    ds_read_b64_tr_b16 v[126:127], v8 offset:11680
    ds_read_b64_tr_b16 v[128:129], v8 offset:192
    ds_read_b64_tr_b16 v[130:131], v8 offset:1472
    ds_read_b64_tr_b16 v[132:133], v8 offset:10432
    ds_read_b64_tr_b16 v[134:135], v8 offset:11712
    ds_read_b64_tr_b16 v[136:137], v8 offset:224
    ds_read_b64_tr_b16 v[138:139], v8 offset:1504
    ds_read_b64_tr_b16 v[140:141], v8 offset:10464
    ds_read_b64_tr_b16 v[142:143], v8 offset:11744
    ds_read_b64_tr_b16 v[144:145], v8 offset:256
    ds_read_b64_tr_b16 v[146:147], v8 offset:1536
    ds_read_b64_tr_b16 v[148:149], v8 offset:10496
    ds_read_b64_tr_b16 v[150:151], v8 offset:11776
    ds_read_b64_tr_b16 v[152:153], v8 offset:288
    ds_read_b64_tr_b16 v[154:155], v8 offset:1568
    ds_read_b64_tr_b16 v[156:157], v8 offset:10528
    ds_read_b64_tr_b16 v[158:159], v8 offset:11808
    s_mov_b32 s48, s16
    s_mov_b32 s49, s17
    s_mov_b32 s50, 2211840
    s_mov_b32 s51, 0x20000
    s_lshl_b32 s98, s35, 7
    s_mov_b32 s99, 3456
    v_lshrrev_b32 v9, 3, v0
    v_mul_lo_u32 v10, v9, s99
    v_and_b32 v9, 2, v9
    v_xor_b32 v9, v9, v0
    v_and_b32 v9, 7, v9
    v_lshl_add_u32 v10, v9, 4, v10
    v_add_u32 v10, s98, v10
    v_xor_b32 v11, 64, v10
    s_mul_i32 s63, s3, 552960
    s_mov_b32 m0, s101
    s_waitcnt lgkmcnt(0)
    s_cmp_ge_u32 s35, 22
    s_cselect_b32 s100, 2, 1
    s_mov_b32 s62, 10
L_dma_116:
    buffer_load_dwordx4 v10, s[48:51], s63 offen nt lds
    s_add_u32 m0, m0, 1024
    s_add_u32 s63, s63, 27648
    s_cmp_eq_u32 s100, 0
    s_cbranch_scc1 L_dma_116n0
    s_waitcnt vmcnt(4)
    s_cmp_eq_u32 s100, 2
    s_cbranch_scc1 L_dma_116n0
    s_waitcnt vmcnt(2)
L_dma_116n0:
    buffer_load_dwordx4 v11, s[48:51], s63 offen nt lds
    s_add_u32 m0, m0, 1024
    s_add_u32 s63, s63, 27648
    s_cmp_eq_u32 s100, 0
    s_cbranch_scc1 L_dma_116n1
    s_waitcnt vmcnt(4)
    s_cmp_eq_u32 s100, 2
    s_cbranch_scc1 L_dma_116n1
    s_waitcnt vmcnt(2)
L_dma_116n1:
    s_sub_u32 s62, s62, 1
    s_cmp_lg_u32 s62, 0
    s_cbranch_scc1 L_dma_116
    v_mov_b32 v8, 162068
L_lw_117:
    ds_read_b32 v9, v8
    s_waitcnt lgkmcnt(0)
    v_cmp_gt_u32 vcc, 1, v9
    s_cbranch_vccz L_lw_117e
    s_sleep 8
    s_sub_u32 s60, s60, 1
    s_cbranch_scc0 L_lw_117
    s_mov_b32 s60, 0
L_lw_117e:
    s_cmp_lg_u32 s3, 3
    s_cbranch_scc1 L_h_nomo
    v_and_b32 v4, 15, v0
    v_lshlrev_b32 v4, 4, v4
    v_mul_u32_u24 v5, 1280, v3
    v_add_u32 v5, v5, v4
    v_mul_u32_u24 v6, 1296, v3
    v_add_u32 v6, v6, v4
    v_add_u32 v6, 147456, v6
    s_mov_b32 s62, 20480
    s_mov_b32 s63, 15360
L_poll_118:
    buffer_load_dwordx4 v[40:43], v5, s[40:43], s62 offen offset:0 sc1
    buffer_load_dwordx4 v[44:47], v5, s[40:43], s62 offen offset:256 sc1
    buffer_load_dwordx4 v[48:51], v5, s[40:43], s62 offen offset:512 sc1
    buffer_load_dwordx4 v[52:55], v5, s[40:43], s62 offen offset:768 sc1
    buffer_load_dwordx4 v[56:59], v5, s[40:43], s62 offen offset:1024 sc1
    buffer_load_dwordx4 v[60:63], v5, s[40:43], s63 offen offset:0 sc1
    buffer_load_dwordx4 v[64:67], v5, s[40:43], s63 offen offset:256 sc1
    buffer_load_dwordx4 v[68:71], v5, s[40:43], s63 offen offset:512 sc1
    buffer_load_dwordx4 v[72:75], v5, s[40:43], s63 offen offset:768 sc1
    buffer_load_dwordx4 v[76:79], v5, s[40:43], s63 offen offset:1024 sc1
    s_waitcnt vmcnt(0)
    v_max3_u32 v7, v40, v41, v42
    v_max3_u32 v7, v7, v43, v44
    v_max3_u32 v7, v7, v45, v46
    v_max3_u32 v7, v7, v47, v48
    v_max3_u32 v7, v7, v49, v50
    v_max3_u32 v7, v7, v51, v52
    v_max3_u32 v7, v7, v53, v54
    v_max3_u32 v7, v7, v55, v56
    v_max3_u32 v7, v7, v57, v58
    v_max3_u32 v7, v7, v59, v60
    v_max3_u32 v7, v7, v61, v62
    v_max3_u32 v7, v7, v63, v64
    v_max3_u32 v7, v7, v65, v66
    v_max3_u32 v7, v7, v67, v68
    v_max3_u32 v7, v7, v69, v70
    v_max3_u32 v7, v7, v71, v72
    v_max3_u32 v7, v7, v73, v74
    v_max3_u32 v7, v7, v75, v76
    v_max3_u32 v7, v7, v77, v78
    v_max_u32 v7, v7, v79
    v_cmp_eq_u32 vcc, -1, v7
    s_cbranch_vccz L_poll_118e
    s_sleep 8
    s_sub_u32 s60, s60, 1
    s_cbranch_scc0 L_poll_118
    s_mov_b32 s60, 0
L_poll_118e:
    ds_write_b128 v6, v[40:43] offset:0
    ds_write_b128 v6, v[44:47] offset:256
    ds_write_b128 v6, v[48:51] offset:512
    ds_write_b128 v6, v[52:55] offset:768
    ds_write_b128 v6, v[56:59] offset:1024
    ds_write_b128 v6, v[60:63] offset:5184
    ds_write_b128 v6, v[64:67] offset:5440
    ds_write_b128 v6, v[68:71] offset:5696
    ds_write_b128 v6, v[72:75] offset:5952
    ds_write_b128 v6, v[76:79] offset:6208
L_h_nomo:
    v_mul_u32_u24 v4, 144, v2
    v_lshl_add_u32 v4, v3, 4, v4
    v_add_u32 v161, 97600, v4
    s_waitcnt vmcnt(0) lgkmcnt(0)
    v_mov_b32 v8, 162064
    v_mov_b32 v9, 1
    s_mov_b64 exec, 1
    ds_add_u32 v8, v9
    s_mov_b64 exec, -1
    s_mov_b32 s100, s3
    s_lshl_b32 s63, s100, 8
    v_and_b32 v8, 15, v0
    v_lshl_add_u32 v8, v8, 4, s63
    v_lshrrev_b32 v9, 4, v0
    v_mul_u32_u24 v5, 1280, v9
    v_add_u32 v5, v5, v8
    v_mul_u32_u24 v4, 1296, v9
    v_add_u32 v4, v4, v8
    v_add_u32 v4, 81920, v4
    v_lshlrev_b32 v6, 1, v5
    v_add_u32 v6, 87104, v6
    s_lshl_b32 s62, s100, 3
    s_add_u32 s62, s62, 97344
    v_lshl_add_u32 v7, v9, 6, s62
    s_mov_b32 s48, s4
    s_mov_b32 s49, s5
    s_mov_b32 s50, 5120
    s_mov_b32 s51, 0x20000
    buffer_load_dwordx4 v[8:11], v5, s[48:51], 0 offen
    s_mov_b32 s62, 10240
    s_mov_b32 s63, 20480
L_poll_119:
    buffer_load_dwordx4 v[12:15], v5, s[40:43], s62 offen sc1
    buffer_load_dwordx4 v[16:19], v5, s[40:43], s63 offen sc1
    s_waitcnt vmcnt(0)
    v_max3_u32 v38, v12, v13, v14
    v_max3_u32 v38, v38, v15, v16
    v_max3_u32 v38, v38, v17, v18
    v_max_u32 v38, v38, v19
    v_cmp_eq_u32 vcc, -1, v38
    s_cbranch_vccz L_poll_119e
    s_sleep 8
    s_sub_u32 s60, s60, 1
    s_cbranch_scc0 L_poll_119
    s_mov_b32 s60, 0
L_poll_119e:
    v_lshlrev_b32 v40, 16, v8
    v_and_b32 v41, 0xffff0000, v8
    v_lshlrev_b32 v42, 16, v9
    v_and_b32 v43, 0xffff0000, v9
    v_lshlrev_b32 v44, 16, v10
    v_and_b32 v45, 0xffff0000, v10
    v_lshlrev_b32 v46, 16, v11
    v_and_b32 v47, 0xffff0000, v11
    v_lshlrev_b32 v48, 16, v12
    v_and_b32 v49, 0xffff0000, v12
    v_lshlrev_b32 v50, 16, v13
    v_and_b32 v51, 0xffff0000, v13
    v_lshlrev_b32 v52, 16, v14
    v_and_b32 v53, 0xffff0000, v14
    v_lshlrev_b32 v54, 16, v15
    v_and_b32 v55, 0xffff0000, v15
    v_lshlrev_b32 v56, 16, v16
    v_and_b32 v57, 0xffff0000, v16
    v_lshlrev_b32 v58, 16, v17
    v_and_b32 v59, 0xffff0000, v17
    v_lshlrev_b32 v60, 16, v18
    v_and_b32 v61, 0xffff0000, v18
    v_lshlrev_b32 v62, 16, v19
    v_and_b32 v63, 0xffff0000, v19
    v_mov_b32 v64, 0
    v_mov_b32 v65, 0
    v_mov_b32 v66, 0
    v_mov_b32 v67, 0
    v_mov_b32 v68, 0
    v_mov_b32 v69, 0
    v_mov_b32 v70, 0
    v_mov_b32 v71, 0
    s_branch L_t2gate
L_ffn2:
    s_barrier
    ds_read_b128 v[8:11], v161
    ds_read_b128 v[12:15], v161 offset:64
    s_cmp_eq_u32 s61, 1
    s_cbranch_scc0 L_f2slow
    s_waitcnt lgkmcnt(1)
    v_mfma_f32_16x16x32_bf16 v[16:19], v[80:83], v[8:11], 0
    v_mfma_f32_16x16x32_bf16 v[20:23], v[88:91], v[8:11], 0
    v_mfma_f32_16x16x32_bf16 v[24:27], v[96:99], v[8:11], 0
    v_mfma_f32_16x16x32_bf16 v[28:31], v[104:107], v[8:11], 0
    s_waitcnt lgkmcnt(0)
    v_mfma_f32_16x16x32_bf16 v[16:19], v[84:87], v[12:15], v[16:19]
    v_mfma_f32_16x16x32_bf16 v[20:23], v[92:95], v[12:15], v[20:23]
    v_mfma_f32_16x16x32_bf16 v[24:27], v[100:103], v[12:15], v[24:27]
    v_mfma_f32_16x16x32_bf16 v[28:31], v[108:111], v[12:15], v[28:31]
    v_mfma_f32_16x16x32_bf16 v[32:35], v[112:115], v[8:11], 0
    v_mfma_f32_16x16x32_bf16 v[36:39], v[120:123], v[8:11], 0
    v_mfma_f32_16x16x32_bf16 v[40:43], v[128:131], v[8:11], 0
    v_mfma_f32_16x16x32_bf16 v[44:47], v[136:139], v[8:11], 0
    v_mfma_f32_16x16x32_bf16 v[32:35], v[116:119], v[12:15], v[32:35]
    v_mfma_f32_16x16x32_bf16 v[36:39], v[124:127], v[12:15], v[36:39]
    v_mfma_f32_16x16x32_bf16 v[40:43], v[132:135], v[12:15], v[40:43]
    v_mfma_f32_16x16x32_bf16 v[44:47], v[140:143], v[12:15], v[44:47]
    v_mfma_f32_16x16x32_bf16 v[48:51], v[144:147], v[8:11], 0
    v_mov_b32_dpp v16, v20 quad_perm:[0,1,2,3] row_mask:0xf bank_mask:0x2
    v_mov_b32_dpp v17, v21 quad_perm:[0,1,2,3] row_mask:0xf bank_mask:0x2
    v_mov_b32_dpp v18, v22 quad_perm:[0,1,2,3] row_mask:0xf bank_mask:0x2
    v_mfma_f32_16x16x32_bf16 v[52:55], v[152:155], v[8:11], 0
    v_mov_b32_dpp v19, v23 quad_perm:[0,1,2,3] row_mask:0xf bank_mask:0x2
    v_mov_b32_dpp v16, v24 quad_perm:[0,1,2,3] row_mask:0xf bank_mask:0x4
    v_mov_b32_dpp v17, v25 quad_perm:[0,1,2,3] row_mask:0xf bank_mask:0x4
    v_mfma_f32_16x16x32_bf16 v[48:51], v[148:151], v[12:15], v[48:51]
    v_mov_b32_dpp v18, v26 quad_perm:[0,1,2,3] row_mask:0xf bank_mask:0x4
    v_mov_b32_dpp v19, v27 quad_perm:[0,1,2,3] row_mask:0xf bank_mask:0x4
    v_mov_b32_dpp v16, v28 quad_perm:[0,1,2,3] row_mask:0xf bank_mask:0x8
    v_mfma_f32_16x16x32_bf16 v[52:55], v[156:159], v[12:15], v[52:55]
    v_mov_b32_dpp v17, v29 quad_perm:[0,1,2,3] row_mask:0xf bank_mask:0x8
    v_mov_b32_dpp v18, v30 quad_perm:[0,1,2,3] row_mask:0xf bank_mask:0x8
    v_mov_b32_dpp v19, v31 quad_perm:[0,1,2,3] row_mask:0xf bank_mask:0x8
    buffer_store_dwordx4 v[16:19], v160, s[40:43], s57 offen
    v_mov_b32_dpp v32, v36 quad_perm:[0,1,2,3] row_mask:0xf bank_mask:0x2
    v_mov_b32_dpp v33, v37 quad_perm:[0,1,2,3] row_mask:0xf bank_mask:0x2
    v_mov_b32_dpp v34, v38 quad_perm:[0,1,2,3] row_mask:0xf bank_mask:0x2
    v_mov_b32_dpp v35, v39 quad_perm:[0,1,2,3] row_mask:0xf bank_mask:0x2
    v_mov_b32_dpp v32, v40 quad_perm:[0,1,2,3] row_mask:0xf bank_mask:0x4
    v_mov_b32_dpp v33, v41 quad_perm:[0,1,2,3] row_mask:0xf bank_mask:0x4
    v_mov_b32_dpp v34, v42 quad_perm:[0,1,2,3] row_mask:0xf bank_mask:0x4
    v_mov_b32_dpp v35, v43 quad_perm:[0,1,2,3] row_mask:0xf bank_mask:0x4
    v_mov_b32_dpp v32, v44 quad_perm:[0,1,2,3] row_mask:0xf bank_mask:0x8
    v_mov_b32_dpp v33, v45 quad_perm:[0,1,2,3] row_mask:0xf bank_mask:0x8
    v_mov_b32_dpp v34, v46 quad_perm:[0,1,2,3] row_mask:0xf bank_mask:0x8
    v_mov_b32_dpp v35, v47 quad_perm:[0,1,2,3] row_mask:0xf bank_mask:0x8
    buffer_store_dwordx4 v[32:35], v160, s[40:43], s57 offen offset:256
    v_mov_b32_dpp v48, v52 quad_perm:[0,1,2,3] row_mask:0xf bank_mask:0x2
    v_mov_b32_dpp v49, v53 quad_perm:[0,1,2,3] row_mask:0xf bank_mask:0x2
    v_mov_b32_dpp v50, v54 quad_perm:[0,1,2,3] row_mask:0xf bank_mask:0x2
    v_mov_b32_dpp v51, v55 quad_perm:[0,1,2,3] row_mask:0xf bank_mask:0x2
    s_mov_b32 exec_lo, 0x00ff00ff
    s_mov_b32 exec_hi, 0x00ff00ff
    buffer_store_dwordx4 v[48:51], v160, s[40:43], s57 offen offset:512
L_f2done:
    s_barrier
    s_endpgm
L_f2slow:
    s_waitcnt lgkmcnt(1)
    v_mfma_f32_16x16x32_bf16 v[16:19], v[80:83], v[8:11], 0
    v_mfma_f32_16x16x32_bf16 v[20:23], v[88:91], v[8:11], 0
    v_mfma_f32_16x16x32_bf16 v[24:27], v[96:99], v[8:11], 0
    v_mfma_f32_16x16x32_bf16 v[28:31], v[104:107], v[8:11], 0
    s_waitcnt lgkmcnt(0)
    v_mfma_f32_16x16x32_bf16 v[16:19], v[84:87], v[12:15], v[16:19]
    v_mfma_f32_16x16x32_bf16 v[20:23], v[92:95], v[12:15], v[20:23]
    v_mfma_f32_16x16x32_bf16 v[24:27], v[100:103], v[12:15], v[24:27]
    v_mfma_f32_16x16x32_bf16 v[28:31], v[108:111], v[12:15], v[28:31]
    v_mfma_f32_16x16x32_bf16 v[32:35], v[112:115], v[8:11], 0
    v_mfma_f32_16x16x32_bf16 v[36:39], v[120:123], v[8:11], 0
    v_mfma_f32_16x16x32_bf16 v[40:43], v[128:131], v[8:11], 0
    v_mfma_f32_16x16x32_bf16 v[44:47], v[136:139], v[8:11], 0
    v_mfma_f32_16x16x32_bf16 v[32:35], v[116:119], v[12:15], v[32:35]
    v_mfma_f32_16x16x32_bf16 v[36:39], v[124:127], v[12:15], v[36:39]
    v_mfma_f32_16x16x32_bf16 v[40:43], v[132:135], v[12:15], v[40:43]
    v_mfma_f32_16x16x32_bf16 v[44:47], v[140:143], v[12:15], v[44:47]
    v_mfma_f32_16x16x32_bf16 v[48:51], v[144:147], v[8:11], 0
    v_mov_b32_dpp v16, v20 quad_perm:[0,1,2,3] row_mask:0xf bank_mask:0x2
    v_mov_b32_dpp v17, v21 quad_perm:[0,1,2,3] row_mask:0xf bank_mask:0x2
    v_mov_b32_dpp v18, v22 quad_perm:[0,1,2,3] row_mask:0xf bank_mask:0x2
    v_mfma_f32_16x16x32_bf16 v[52:55], v[152:155], v[8:11], 0
    v_mov_b32_dpp v19, v23 quad_perm:[0,1,2,3] row_mask:0xf bank_mask:0x2
    v_mov_b32_dpp v16, v24 quad_perm:[0,1,2,3] row_mask:0xf bank_mask:0x4
    v_mov_b32_dpp v17, v25 quad_perm:[0,1,2,3] row_mask:0xf bank_mask:0x4
    v_mfma_f32_16x16x32_bf16 v[48:51], v[148:151], v[12:15], v[48:51]
    v_mov_b32_dpp v18, v26 quad_perm:[0,1,2,3] row_mask:0xf bank_mask:0x4
    v_mov_b32_dpp v19, v27 quad_perm:[0,1,2,3] row_mask:0xf bank_mask:0x4
    v_mov_b32_dpp v16, v28 quad_perm:[0,1,2,3] row_mask:0xf bank_mask:0x8
    v_mfma_f32_16x16x32_bf16 v[52:55], v[156:159], v[12:15], v[52:55]
    v_mov_b32_dpp v17, v29 quad_perm:[0,1,2,3] row_mask:0xf bank_mask:0x8
    v_mov_b32_dpp v18, v30 quad_perm:[0,1,2,3] row_mask:0xf bank_mask:0x8
    v_mov_b32_dpp v19, v31 quad_perm:[0,1,2,3] row_mask:0xf bank_mask:0x8
    buffer_store_dwordx4 v[16:19], v160, s[40:43], s57 offen sc1
    v_mov_b32_dpp v32, v36 quad_perm:[0,1,2,3] row_mask:0xf bank_mask:0x2
    v_mov_b32_dpp v33, v37 quad_perm:[0,1,2,3] row_mask:0xf bank_mask:0x2
    v_mov_b32_dpp v34, v38 quad_perm:[0,1,2,3] row_mask:0xf bank_mask:0x2
    v_mov_b32_dpp v35, v39 quad_perm:[0,1,2,3] row_mask:0xf bank_mask:0x2
    v_mov_b32_dpp v32, v40 quad_perm:[0,1,2,3] row_mask:0xf bank_mask:0x4
    v_mov_b32_dpp v33, v41 quad_perm:[0,1,2,3] row_mask:0xf bank_mask:0x4
    v_mov_b32_dpp v34, v42 quad_perm:[0,1,2,3] row_mask:0xf bank_mask:0x4
    v_mov_b32_dpp v35, v43 quad_perm:[0,1,2,3] row_mask:0xf bank_mask:0x4
    v_mov_b32_dpp v32, v44 quad_perm:[0,1,2,3] row_mask:0xf bank_mask:0x8
    v_mov_b32_dpp v33, v45 quad_perm:[0,1,2,3] row_mask:0xf bank_mask:0x8
    v_mov_b32_dpp v34, v46 quad_perm:[0,1,2,3] row_mask:0xf bank_mask:0x8
    v_mov_b32_dpp v35, v47 quad_perm:[0,1,2,3] row_mask:0xf bank_mask:0x8
    buffer_store_dwordx4 v[32:35], v160, s[40:43], s57 offen offset:256 sc1
    v_mov_b32_dpp v48, v52 quad_perm:[0,1,2,3] row_mask:0xf bank_mask:0x2
    v_mov_b32_dpp v49, v53 quad_perm:[0,1,2,3] row_mask:0xf bank_mask:0x2
    v_mov_b32_dpp v50, v54 quad_perm:[0,1,2,3] row_mask:0xf bank_mask:0x2
    v_mov_b32_dpp v51, v55 quad_perm:[0,1,2,3] row_mask:0xf bank_mask:0x2
    s_mov_b32 exec_lo, 0x00ff00ff
    s_mov_b32 exec_hi, 0x00ff00ff
    buffer_store_dwordx4 v[48:51], v160, s[40:43], s57 offen offset:512 sc1
    s_branch L_f2done
L_end:
    s_endpgm
L_codeend:
.section .rodata,"a"
.p2align 6
.amdhsa_kernel adaLN_cond__sliding_block_cached__dense_activation_gelu__decode_kernel
  .amdhsa_next_free_vgpr 168
  .amdhsa_next_free_sgpr 102
  .amdhsa_accum_offset 168
  .amdhsa_group_segment_fixed_size 0
  .amdhsa_kernarg_size 120
  .amdhsa_user_sgpr_count 2
  .amdhsa_user_sgpr_kernarg_segment_ptr 1
  .amdhsa_system_sgpr_workgroup_id_x 1
.end_amdhsa_kernel
```

```asm
; @launch grid=(256,1,1) block=(768,1,1) lds=162176
.amdgcn_target "amdgcn-amd-amdhsa--gfx950"
.text
.globl adaLN_cond__sliding_block_cached__dense_activation_gelu__decode_kernel
.p2align 8
.type adaLN_cond__sliding_block_cached__dense_activation_gelu__decode_kernel,@function
adaLN_cond__sliding_block_cached__dense_activation_gelu__decode_kernel:
    s_cmp_ge_u32 s2, 256
    s_cbranch_scc1 L_end
    s_load_dwordx16 s[4:19], s[0:1], 0
    s_load_dwordx8 s[20:27], s[0:1], 64
    s_load_dwordx4 s[28:31], s[0:1], 96
    s_load_dwordx2 s[32:33], s[0:1], 112
    v_lshrrev_b32 v1, 6, v0
    v_lshlrev_b32 v2, 4, v0
    v_readfirstlane_b32 s3, v1
    v_and_b32 v0, 63, v0
    s_and_b32 s34, s2, 7
    s_lshr_b32 s35, s2, 3
    s_cmp_lg_u32 s35, 21
    s_cbranch_scc1 L_nopf
    s_getpc_b64 s[48:49]
    s_and_b32 s48, s48, 0xffffff00
    s_mov_b32 s50, L_codeend-adaLN_cond__sliding_block_cached__dense_activation_gelu__decode_kernel
    s_mov_b32 s51, 0x20000
    s_mov_b32 s52, 12288
    buffer_load_dwordx4 v[152:155], v2, s[48:51], 0 offen
    buffer_load_dwordx4 v[156:159], v2, s[48:51], s52 offen
L_nopf:
    s_lshr_b32 s36, s35, 3
    s_lshl2_add_u32 s36, s34, s36
    s_bfe_u32 s37, s35, 0x20001
    s_and_b32 s38, s35, 1
    s_cmp_lt_u32 s35, 27
    s_cselect_b32 s39, 1, 0
    s_cmp_eq_u32 s34, 2
    s_cselect_b32 s39, s39, 0
    s_sub_u32 s62, s34, 3
    s_and_b32 s62, s62, 7
    s_mul_i32 s56, s35, 7
    s_add_u32 s56, s56, s62
    s_cmp_eq_u32 s62, 7
    s_cselect_b32 s56, 255, s56
    s_mov_b32 s60, 400000
    s_mov_b32 s61, 0
    v_mov_b32 v36, 0
    s_waitcnt lgkmcnt(0)
    s_mov_b32 s40, s32
    s_mov_b32 s41, s33
    s_mov_b32 s42, 589824
    s_mov_b32 s43, 0x20000
    s_mov_b32 s44, s30
    s_mov_b32 s45, s31
    s_mov_b32 s46, 256
    s_mov_b32 s47, 0x20000
    s_cmp_lt_u32 s3, 4
    s_cbranch_scc1 L_helpers
    s_sub_u32 s3, s3, 4
    s_cmp_ge_u32 s35, 22
    s_cselect_b32 s59, 1, 0
    s_mov_b32 s13, 0
    s_add_u32 s62, s3, s59
    s_cmp_ge_u32 s62, 6
    s_cselect_b32 s62, s39, 0
    s_cmp_eq_u32 s62, 1
    s_cbranch_scc1 L_proxy
    s_cmp_eq_u32 s59, 1
    s_cselect_b32 s12, 0, 81920
    s_lshl_b32 s62, s3, 13
    s_add_u32 s12, s12, s62
    s_and_b32 s62, s39, s59
    s_cselect_b32 s12, -1, s12
L_stream:
    s_lshl_b32 s62, s37, 5
    s_add_u32 s62, s62, s36
    s_lshl_b32 s63, s62, 21
    s_lshl_b32 s96, s38, 18
    s_add_u32 s63, s63, s96
    s_add_u32 s63, s63, 1572864
    s_add_u32 s48, s6, s63
    s_addc_u32 s49, s7, 0
    s_mov_b32 s50, 262144
    s_mov_b32 s51, 0x20000
    v_lshlrev_b32 v1, 4, v0
    s_lshl_b32 s96, s3, 12
    v_add_u32 v1, s96, v1
    s_mov_b32 s97, 0
    s_cmp_lt_u32 s56, 104
    s_cbranch_scc0 L_nob0
    s_barrier
L_nob0:
    buffer_load_dwordx4 v[40:43], v1, s[48:51], s97 offen offset:0 nt
    buffer_load_dwordx4 v[44:47], v1, s[48:51], s97 offen offset:1024 nt
    s_bitcmp1_b32 s3, 0
    s_mov_b32 s57, 0xffffffff
    s_mov_b32 s58, 0xff00ff
    s_cselect_b32 s58, 0xff00ff00, s58
    s_mov_b32 s14, 0xffffffff
    s_mov_b32 s15, 0x0
L_pm_1:
    s_cmp_lt_u32 s56, 104
    s_cbranch_scc0 L_pm_2
    s_bitcmp1_b32 s3, 0
    s_mov_b32 s57, 0xffff
    s_mov_b32 s58, 0x0
    s_mov_b32 s14, 0xffffffff
    s_mov_b32 s15, 0x0
L_pm_2:
    s_sub_u32 s96, s56, 43
    s_and_b32 s96, s96, 0xffffffc7
    s_cmp_eq_u32 s96, 0
    s_cbranch_scc0 L_pm_3
    s_bitcmp1_b32 s3, 0
    s_mov_b32 s57, 0x0
    s_mov_b32 s58, 0x0
    s_mov_b32 s14, 0x0
    s_mov_b32 s15, 0x0
L_pm_3:
    s_cmp_lt_u32 s56, 40
    s_cbranch_scc0 L_pm_4
    s_bitcmp1_b32 s3, 0
    s_mov_b32 s57, 0xffffffff
    s_mov_b32 s58, 0xf
    s_mov_b32 s14, 0xffffffff
    s_mov_b32 s15, 0x0
L_pm_4:
    s_cmp_eq_u32 s39, 1
    s_cbranch_scc0 L_pm_5
    s_bitcmp1_b32 s3, 0
    s_mov_b32 s57, 0xffffffff
    s_mov_b32 s58, 0x0
    s_mov_b32 s14, 0xffffffff
    s_mov_b32 s15, 0x0
L_pm_5:
    s_cmp_lg_u32 s13, 0
    s_cbranch_scc0 L_pm_6
    s_bitcmp1_b32 s3, 0
    s_mov_b32 s57, 0x0
    s_mov_b32 s58, 0x0
    s_mov_b32 s14, 0x0
    s_mov_b32 s15, 0x0
L_pm_6:
    s_and_b32 s96, s39, s59
    s_cbranch_scc0 L_pm_7
    s_bitcmp1_b32 s3, 0
    s_mov_b32 s57, 0xffffffff
    s_mov_b32 s58, 0x0
    s_mov_b32 s14, 0x0
    s_mov_b32 s15, 0x0
L_pm_7:
    s_cmp_lt_u32 s56, 104
    s_cbranch_scc1 L_nob1
    s_barrier
L_nob1:
    s_add_u32 s52, s8, s63
    s_addc_u32 s53, s9, 0
    s_mov_b32 s54, 262144
    s_mov_b32 s55, 0x20000
    v_and_b32 v2, 15, v0
    v_lshrrev_b32 v3, 1, v2
    v_and_b32 v37, 1, v2
    v_lshlrev_b32 v37, 4, v37
    v_mov_b32 v38, 0xffff
    v_lshlrev_b32 v37, v37, v38
    v_cmp_eq_u32 vcc, 0, v3
    v_mov_b32 v32, 0
    s_nop 0
    v_cndmask_b32 v20, 0, v37, vcc
    v_cmp_eq_u32 vcc, 1, v3
    v_mov_b32 v33, 0
    s_nop 0
    v_cndmask_b32 v21, 0, v37, vcc
    v_cmp_eq_u32 vcc, 2, v3
    v_mov_b32 v34, 0
    s_nop 0
    v_cndmask_b32 v22, 0, v37, vcc
    v_cmp_eq_u32 vcc, 3, v3
    v_mov_b32 v35, 0
    s_nop 0
    v_cndmask_b32 v23, 0, v37, vcc
    v_lshlrev_b32 v2, 4, v2
    s_lshl_b32 s98, s62, 8
    s_add_u32 s98, s98, 40960
    s_lshl_b32 s99, s62, 7
    s_add_u32 s99, s99, 73728
    s_bitcmp0_b32 s57, 2
    s_cbranch_scc1 L_sf_8
    s_bitcmp0_b32 s58, 2
    s_cbranch_scc1 L_sf_8
    s_waitcnt vmcnt(1)
L_sf_8:
    buffer_load_dwordx4 v[48:51], v1, s[48:51], s97 offen offset:2048 nt
    s_bitcmp0_b32 s57, 3
    s_cbranch_scc1 L_sf_9
    s_waitcnt vmcnt(2)
    s_bitcmp0_b32 s58, 3
    s_cbranch_scc1 L_sf_9
    s_waitcnt vmcnt(1)
L_sf_9:
    buffer_load_dwordx4 v[52:55], v1, s[48:51], s97 offen offset:3072 nt
    s_add_u32 s97, s97, 32768
    v_add_u32 v1, 4096, v1
    v_and_b32 v1, 0x7fff, v1
    s_waitcnt vmcnt(3)
    s_bitcmp0_b32 s57, 4
    s_cbranch_scc1 L_sf_10
    s_waitcnt vmcnt(2)
    s_bitcmp0_b32 s58, 4
    s_cbranch_scc1 L_sf_10
    s_waitcnt vmcnt(1)
L_sf_10:
    buffer_load_dwordx4 v[56:59], v1, s[48:51], s97 offen offset:0 nt
    s_waitcnt vmcnt(3)
    s_bitcmp0_b32 s57, 5
    s_cbranch_scc1 L_sf_11
    s_waitcnt vmcnt(2)
    s_bitcmp0_b32 s58, 5
    s_cbranch_scc1 L_sf_11
    s_waitcnt vmcnt(1)
L_sf_11:
    buffer_load_dwordx4 v[60:63], v1, s[48:51], s97 offen offset:1024 nt
    s_waitcnt vmcnt(3)
    s_bitcmp0_b32 s57, 6
    s_cbranch_scc1 L_sf_12
    s_waitcnt vmcnt(2)
    s_bitcmp0_b32 s58, 6
    s_cbranch_scc1 L_sf_12
    s_waitcnt vmcnt(1)
L_sf_12:
    buffer_load_dwordx4 v[64:67], v1, s[48:51], s97 offen offset:2048 nt
    s_waitcnt vmcnt(3)
    s_bitcmp0_b32 s57, 7
    s_cbranch_scc1 L_sf_13
    s_waitcnt vmcnt(2)
    s_bitcmp0_b32 s58, 7
    s_cbranch_scc1 L_sf_13
    s_waitcnt vmcnt(1)
L_sf_13:
    buffer_load_dwordx4 v[68:71], v1, s[48:51], s97 offen offset:3072 nt
    s_add_u32 s97, s97, 32768
    v_add_u32 v1, 4096, v1
    v_and_b32 v1, 0x7fff, v1
    s_waitcnt vmcnt(3)
    s_bitcmp0_b32 s57, 8
    s_cbranch_scc1 L_sf_14
    s_waitcnt vmcnt(2)
    s_bitcmp0_b32 s58, 8
    s_cbranch_scc1 L_sf_14
    s_waitcnt vmcnt(1)
L_sf_14:
    buffer_load_dwordx4 v[72:75], v1, s[48:51], s97 offen offset:0 nt
    s_waitcnt vmcnt(3)
    s_bitcmp0_b32 s57, 9
    s_cbranch_scc1 L_sf_15
    s_waitcnt vmcnt(2)
    s_bitcmp0_b32 s58, 9
    s_cbranch_scc1 L_sf_15
    s_waitcnt vmcnt(1)
L_sf_15:
    buffer_load_dwordx4 v[76:79], v1, s[48:51], s97 offen offset:1024 nt
    s_waitcnt vmcnt(3)
    s_bitcmp0_b32 s57, 10
    s_cbranch_scc1 L_sf_16
    s_waitcnt vmcnt(2)
    s_bitcmp0_b32 s58, 10
    s_cbranch_scc1 L_sf_16
    s_waitcnt vmcnt(1)
L_sf_16:
    buffer_load_dwordx4 v[80:83], v1, s[48:51], s97 offen offset:2048 nt
    s_waitcnt vmcnt(3)
    s_bitcmp0_b32 s57, 11
    s_cbranch_scc1 L_sf_17
    s_waitcnt vmcnt(2)
    s_bitcmp0_b32 s58, 11
    s_cbranch_scc1 L_sf_17
    s_waitcnt vmcnt(1)
L_sf_17:
    buffer_load_dwordx4 v[84:87], v1, s[48:51], s97 offen offset:3072 nt
    s_add_u32 s97, s97, 32768
    v_add_u32 v1, 4096, v1
    v_and_b32 v1, 0x7fff, v1
    s_waitcnt vmcnt(3)
    s_bitcmp0_b32 s57, 12
    s_cbranch_scc1 L_sf_18
    s_waitcnt vmcnt(2)
    s_bitcmp0_b32 s58, 12
    s_cbranch_scc1 L_sf_18
    s_waitcnt vmcnt(1)
L_sf_18:
    buffer_load_dwordx4 v[88:91], v1, s[48:51], s97 offen offset:0 nt
    s_waitcnt vmcnt(3)
    s_bitcmp0_b32 s57, 13
    s_cbranch_scc1 L_sf_19
    s_waitcnt vmcnt(2)
    s_bitcmp0_b32 s58, 13
    s_cbranch_scc1 L_sf_19
    s_waitcnt vmcnt(1)
L_sf_19:
    buffer_load_dwordx4 v[92:95], v1, s[48:51], s97 offen offset:1024 nt
    s_waitcnt vmcnt(3)
    s_bitcmp0_b32 s57, 14
    s_cbranch_scc1 L_sf_20
    s_waitcnt vmcnt(2)
    s_bitcmp0_b32 s58, 14
    s_cbranch_scc1 L_sf_20
    s_waitcnt vmcnt(1)
L_sf_20:
    buffer_load_dwordx4 v[96:99], v1, s[48:51], s97 offen offset:2048 nt
    s_waitcnt vmcnt(3)
    s_bitcmp0_b32 s57, 15
    s_cbranch_scc1 L_sf_21
    s_waitcnt vmcnt(2)
    s_bitcmp0_b32 s58, 15
    s_cbranch_scc1 L_sf_21
    s_waitcnt vmcnt(1)
L_sf_21:
    buffer_load_dwordx4 v[100:103], v1, s[48:51], s97 offen offset:3072 nt
    s_add_u32 s97, s97, 32768
    v_add_u32 v1, 4096, v1
    v_and_b32 v1, 0x7fff, v1
    s_waitcnt vmcnt(3)
    s_bitcmp0_b32 s57, 16
    s_cbranch_scc1 L_sf_22
    s_waitcnt vmcnt(2)
    s_bitcmp0_b32 s58, 16
    s_cbranch_scc1 L_sf_22
    s_waitcnt vmcnt(1)
L_sf_22:
    buffer_load_dwordx4 v[104:107], v1, s[48:51], s97 offen offset:0 nt
    s_waitcnt vmcnt(3)
    s_bitcmp0_b32 s57, 17
    s_cbranch_scc1 L_sf_23
    s_waitcnt vmcnt(2)
    s_bitcmp0_b32 s58, 17
    s_cbranch_scc1 L_sf_23
    s_waitcnt vmcnt(1)
L_sf_23:
    buffer_load_dwordx4 v[108:111], v1, s[48:51], s97 offen offset:1024 nt
    s_waitcnt vmcnt(3)
    s_bitcmp0_b32 s57, 18
    s_cbranch_scc1 L_sf_24
    s_waitcnt vmcnt(2)
    s_bitcmp0_b32 s58, 18
    s_cbranch_scc1 L_sf_24
    s_waitcnt vmcnt(1)
L_sf_24:
    buffer_load_dwordx4 v[112:115], v1, s[48:51], s97 offen offset:2048 nt
    s_waitcnt vmcnt(3)
    s_bitcmp0_b32 s57, 19
    s_cbranch_scc1 L_sf_25
    s_waitcnt vmcnt(2)
    s_bitcmp0_b32 s58, 19
    s_cbranch_scc1 L_sf_25
    s_waitcnt vmcnt(1)
L_sf_25:
    buffer_load_dwordx4 v[116:119], v1, s[48:51], s97 offen offset:3072 nt
    s_add_u32 s97, s97, 32768
    v_add_u32 v1, 4096, v1
    v_and_b32 v1, 0x7fff, v1
    s_waitcnt vmcnt(3)
    s_bitcmp0_b32 s57, 20
    s_cbranch_scc1 L_sf_26
    s_waitcnt vmcnt(2)
    s_bitcmp0_b32 s58, 20
    s_cbranch_scc1 L_sf_26
    s_waitcnt vmcnt(1)
L_sf_26:
    buffer_load_dwordx4 v[120:123], v1, s[48:51], s97 offen offset:0 nt
    s_waitcnt vmcnt(3)
    s_bitcmp0_b32 s57, 21
    s_cbranch_scc1 L_sf_27
    s_waitcnt vmcnt(2)
    s_bitcmp0_b32 s58, 21
    s_cbranch_scc1 L_sf_27
    s_waitcnt vmcnt(1)
L_sf_27:
    buffer_load_dwordx4 v[124:127], v1, s[48:51], s97 offen offset:1024 nt
    s_cmp_eq_u32 s12, -1
    s_cbranch_scc1 L_k_nopf
    s_waitcnt vmcnt(3)
    s_bitcmp0_b32 s57, 22
    s_cbranch_scc1 L_sf_28
    s_waitcnt vmcnt(2)
    s_bitcmp0_b32 s58, 22
    s_cbranch_scc1 L_sf_28
    s_waitcnt vmcnt(1)
L_sf_28:
    buffer_load_dwordx4 v[128:131], v1, s[48:51], s97 offen offset:2048 nt
    s_waitcnt vmcnt(3)
    s_bitcmp0_b32 s57, 23
    s_cbranch_scc1 L_sf_29
    s_waitcnt vmcnt(2)
    s_bitcmp0_b32 s58, 23
    s_cbranch_scc1 L_sf_29
    s_waitcnt vmcnt(1)
L_sf_29:
    buffer_load_dwordx4 v[132:135], v1, s[48:51], s97 offen offset:3072 nt
    s_add_u32 s97, s97, 32768
    v_add_u32 v1, 4096, v1
    v_and_b32 v1, 0x7fff, v1
    s_waitcnt vmcnt(3)
    s_bitcmp0_b32 s57, 24
    s_cbranch_scc1 L_sf_30
    s_waitcnt vmcnt(2)
    s_bitcmp0_b32 s58, 24
    s_cbranch_scc1 L_sf_30
    s_waitcnt vmcnt(1)
L_sf_30:
    buffer_load_dwordx4 v[136:139], v1, s[48:51], s97 offen offset:0 nt
    s_waitcnt vmcnt(3)
    s_bitcmp0_b32 s57, 25
    s_cbranch_scc1 L_sf_31
    s_waitcnt vmcnt(2)
    s_bitcmp0_b32 s58, 25
    s_cbranch_scc1 L_sf_31
    s_waitcnt vmcnt(1)
L_sf_31:
    buffer_load_dwordx4 v[140:143], v1, s[48:51], s97 offen offset:1024 nt
    s_waitcnt vmcnt(3)
    s_bitcmp0_b32 s57, 26
    s_cbranch_scc1 L_sf_32
    s_waitcnt vmcnt(2)
    s_bitcmp0_b32 s58, 26
    s_cbranch_scc1 L_sf_32
    s_waitcnt vmcnt(1)
L_sf_32:
    buffer_load_dwordx4 v[144:147], v1, s[48:51], s97 offen offset:2048 nt
    s_waitcnt vmcnt(3)
    s_bitcmp0_b32 s57, 27
    s_cbranch_scc1 L_sf_33
    s_waitcnt vmcnt(2)
    s_bitcmp0_b32 s58, 27
    s_cbranch_scc1 L_sf_33
    s_waitcnt vmcnt(1)
L_sf_33:
    buffer_load_dwordx4 v[148:151], v1, s[48:51], s97 offen offset:3072 nt
    s_add_u32 s97, s97, 32768
    v_add_u32 v1, 4096, v1
    v_and_b32 v1, 0x7fff, v1
    s_waitcnt vmcnt(3)
    s_bitcmp0_b32 s57, 28
    s_cbranch_scc1 L_sf_34
    s_waitcnt vmcnt(2)
    s_bitcmp0_b32 s58, 28
    s_cbranch_scc1 L_sf_34
    s_waitcnt vmcnt(1)
L_sf_34:
    buffer_load_dwordx4 v[152:155], v1, s[48:51], s97 offen offset:0 nt
    s_waitcnt vmcnt(3)
    s_bitcmp0_b32 s57, 29
    s_cbranch_scc1 L_sf_35
    s_waitcnt vmcnt(2)
    s_bitcmp0_b32 s58, 29
    s_cbranch_scc1 L_sf_35
    s_waitcnt vmcnt(1)
L_sf_35:
    buffer_load_dwordx4 v[156:159], v1, s[48:51], s97 offen offset:1024 nt
    s_waitcnt vmcnt(3)
    s_bitcmp0_b32 s57, 30
    s_cbranch_scc1 L_sf_36
    s_waitcnt vmcnt(2)
    s_bitcmp0_b32 s58, 30
    s_cbranch_scc1 L_sf_36
    s_waitcnt vmcnt(1)
L_sf_36:
    buffer_load_dwordx4 v[160:163], v1, s[48:51], s97 offen offset:2048 nt
    v_min_u32 v39, 29, v0
    v_lshlrev_b32 v39, 2, v39
    buffer_load_dword v37, v39, s[44:47], 0 offen sc1
    s_waitcnt vmcnt(4)
    s_bitcmp0_b32 s57, 31
    s_cbranch_scc1 L_sf_37
    s_waitcnt vmcnt(3)
    s_bitcmp0_b32 s58, 31
    s_cbranch_scc1 L_sf_37
    s_waitcnt vmcnt(2)
L_sf_37:
    buffer_load_dwordx4 v[164:167], v1, s[48:51], s97 offen offset:3072 nt
    s_mov_b32 s97, 0
    v_add_u32 v1, 4096, v1
    v_and_b32 v1, 0x7fff, v1
    s_waitcnt vmcnt(4)
    s_bitcmp0_b32 s14, 0
    s_cbranch_scc1 L_sf_38
    s_waitcnt vmcnt(3)
    s_bitcmp0_b32 s15, 0
    s_cbranch_scc1 L_sf_38
    s_waitcnt vmcnt(2)
L_sf_38:
    s_add_u32 m0, s12, 0
    s_nop 0
    buffer_load_dwordx4 v1, s[52:55], s97 offen offset:0 nt lds
    s_waitcnt vmcnt(4)
    s_bitcmp0_b32 s14, 1
    s_cbranch_scc1 L_sf_39
    s_waitcnt vmcnt(3)
    s_bitcmp0_b32 s15, 1
    s_cbranch_scc1 L_sf_39
    s_waitcnt vmcnt(1)
L_sf_39:
    buffer_load_dwordx4 v1, s[52:55], s97 offen offset:1024 nt lds
    s_waitcnt vmcnt(4)
    s_bitcmp0_b32 s14, 2
    s_cbranch_scc1 L_sf_40
    s_waitcnt vmcnt(2)
    s_bitcmp0_b32 s15, 2
    s_cbranch_scc1 L_sf_40
    s_waitcnt vmcnt(1)
L_sf_40:
    buffer_load_dwordx4 v1, s[52:55], s97 offen offset:2048 nt lds
    s_waitcnt vmcnt(3)
    s_bitcmp0_b32 s14, 3
    s_cbranch_scc1 L_sf_41
    s_waitcnt vmcnt(2)
    s_bitcmp0_b32 s15, 3
    s_cbranch_scc1 L_sf_41
    s_waitcnt vmcnt(1)
L_sf_41:
    buffer_load_dwordx4 v1, s[52:55], s97 offen offset:3072 nt lds
    s_add_u32 s97, s97, 32768
    v_add_u32 v1, 4096, v1
    v_and_b32 v1, 0x7fff, v1
    v_cmp_eq_u32 vcc, 0, v37
    s_nop 0
    s_or_b32 s96, vcc_lo, vcc_hi
    buffer_load_dwordx4 v[4:7], v2, s[40:43], s98 offen sc1
    s_waitcnt vmcnt(4)
    s_bitcmp0_b32 s14, 4
    s_cbranch_scc1 L_sf_42
    s_waitcnt vmcnt(3)
    s_bitcmp0_b32 s15, 4
    s_cbranch_scc1 L_sf_42
    s_waitcnt vmcnt(2)
L_sf_42:
    s_add_u32 m0, s12, 4096
    s_nop 0
    buffer_load_dwordx4 v1, s[52:55], s97 offen offset:0 nt lds
    s_waitcnt vmcnt(4)
    s_bitcmp0_b32 s14, 5
    s_cbranch_scc1 L_sf_43
    s_waitcnt vmcnt(3)
    s_bitcmp0_b32 s15, 5
    s_cbranch_scc1 L_sf_43
    s_waitcnt vmcnt(2)
L_sf_43:
    buffer_load_dwordx4 v1, s[52:55], s97 offen offset:1024 nt lds
    s_waitcnt vmcnt(4)
    s_bitcmp0_b32 s14, 6
    s_cbranch_scc1 L_sf_44
    s_waitcnt vmcnt(3)
    s_bitcmp0_b32 s15, 6
    s_cbranch_scc1 L_sf_44
    s_waitcnt vmcnt(1)
L_sf_44:
    buffer_load_dwordx4 v1, s[52:55], s97 offen offset:2048 nt lds
    s_waitcnt vmcnt(4)
    s_bitcmp0_b32 s14, 7
    s_cbranch_scc1 L_sf_45
    s_waitcnt vmcnt(2)
    s_bitcmp0_b32 s15, 7
    s_cbranch_scc1 L_sf_45
    s_waitcnt vmcnt(1)
L_sf_45:
    buffer_load_dwordx4 v1, s[52:55], s97 offen offset:3072 nt lds
    s_add_u32 s97, s97, 32768
    v_add_u32 v1, 4096, v1
    v_and_b32 v1, 0x7fff, v1
L_k_join:
    s_waitcnt vmcnt(4)
    v_max3_u32 v38, v4, v5, v6
    v_max_u32 v38, v38, v7
    v_cmp_eq_u32 vcc, -1, v38
    s_cmp_lg_u32 s96, 0
    s_cbranch_scc1 L_qslow
    s_cbranch_vccnz L_qslow2
L_qok:
    v_dot2_f32_bf16 v8, v72, v4, 0
    v_dot2_f32_bf16 v9, v76, v4, 0
    v_dot2_f32_bf16 v10, v80, v4, 0
    v_dot2_f32_bf16 v11, v84, v4, 0
    v_dot2_f32_bf16 v24, v88, v4, 0
    v_dot2_f32_bf16 v25, v92, v4, 0
    v_dot2_f32_bf16 v26, v96, v4, 0
    v_dot2_f32_bf16 v27, v100, v4, 0
    v_dot2_f32_bf16 v8, v73, v5, v8
    v_dot2_f32_bf16 v9, v77, v5, v9
    v_dot2_f32_bf16 v10, v81, v5, v10
    v_dot2_f32_bf16 v11, v85, v5, v11
    v_dot2_f32_bf16 v24, v89, v5, v24
    v_dot2_f32_bf16 v25, v93, v5, v25
    v_dot2_f32_bf16 v26, v97, v5, v26
    v_dot2_f32_bf16 v27, v101, v5, v27
    v_dot2_f32_bf16 v8, v74, v6, v8
    v_dot2_f32_bf16 v9, v78, v6, v9
    v_dot2_f32_bf16 v10, v82, v6, v10
    v_dot2_f32_bf16 v11, v86, v6, v11
    v_dot2_f32_bf16 v24, v90, v6, v24
    v_dot2_f32_bf16 v25, v94, v6, v25
    v_dot2_f32_bf16 v26, v98, v6, v26
    v_dot2_f32_bf16 v27, v102, v6, v27
    v_dot2_f32_bf16 v8, v75, v7, v8
    v_dot2_f32_bf16 v9, v79, v7, v9
    v_dot2_f32_bf16 v10, v83, v7, v10
    v_dot2_f32_bf16 v11, v87, v7, v11
    v_dot2_f32_bf16 v24, v91, v7, v24
    v_dot2_f32_bf16 v25, v95, v7, v25
    v_dot2_f32_bf16 v26, v99, v7, v26
    v_dot2_f32_bf16 v27, v103, v7, v27
    v_add_f32_dpp v8, v8, v8 row_ror:8 row_mask:0xf bank_mask:0x3
    v_add_f32_dpp v10, v10, v10 row_ror:8 row_mask:0xf bank_mask:0x3
    v_add_f32_dpp v24, v24, v24 row_ror:8 row_mask:0xf bank_mask:0x3
    v_add_f32_dpp v26, v26, v26 row_ror:8 row_mask:0xf bank_mask:0x3
    v_add_f32_dpp v8, v9, v9 row_ror:8 row_mask:0xf bank_mask:0xc
    v_add_f32_dpp v10, v11, v11 row_ror:8 row_mask:0xf bank_mask:0xc
    v_add_f32_dpp v24, v25, v25 row_ror:8 row_mask:0xf bank_mask:0xc
    v_add_f32_dpp v26, v27, v27 row_ror:8 row_mask:0xf bank_mask:0xc
    v_add_f32_dpp v14, v8, v8 row_half_mirror row_mask:0xf bank_mask:0x5
    v_add_f32_dpp v15, v24, v24 row_half_mirror row_mask:0xf bank_mask:0x5
    v_add_f32_dpp v14, v10, v10 row_half_mirror row_mask:0xf bank_mask:0xa
    v_add_f32_dpp v15, v26, v26 row_half_mirror row_mask:0xf bank_mask:0xa
    s_nop 0
    v_add_f32_dpp v14, v14, v14 quad_perm:[1,0,3,2] row_mask:0xf bank_mask:0xf
    v_add_f32_dpp v15, v15, v15 quad_perm:[1,0,3,2] row_mask:0xf bank_mask:0xf
    s_nop 0
    v_add_f32_dpp v14, v14, v14 quad_perm:[2,3,0,1] row_mask:0xf bank_mask:0xf
    v_add_f32_dpp v15, v15, v15 quad_perm:[2,3,0,1] row_mask:0xf bank_mask:0xf
    s_waitcnt vmcnt(3)
    s_bitcmp0_b32 s14, 8
    s_cbranch_scc1 L_sf_56
    s_waitcnt vmcnt(2)
    s_bitcmp0_b32 s15, 8
    s_cbranch_scc1 L_sf_56
    s_waitcnt vmcnt(1)
L_sf_56:
    buffer_load_dwordx4 v[72:75], v1, s[52:55], s97 offen offset:0 nt
    v_dot2_f32_bf16 v8, v40, v4, 0
    v_dot2_f32_bf16 v9, v44, v4, 0
    v_dot2_f32_bf16 v10, v48, v4, 0
    v_dot2_f32_bf16 v11, v52, v4, 0
    v_dot2_f32_bf16 v24, v56, v4, 0
    v_dot2_f32_bf16 v25, v60, v4, 0
    v_dot2_f32_bf16 v26, v64, v4, 0
    v_dot2_f32_bf16 v27, v68, v4, 0
    v_dot2_f32_bf16 v28, v104, v4, 0
    v_dot2_f32_bf16 v29, v108, v4, 0
    v_dot2_f32_bf16 v30, v112, v4, 0
    v_dot2_f32_bf16 v31, v116, v4, 0
    v_dot2_f32_bf16 v8, v41, v5, v8
    v_dot2_f32_bf16 v9, v45, v5, v9
    v_dot2_f32_bf16 v10, v49, v5, v10
    v_dot2_f32_bf16 v11, v53, v5, v11
    v_dot2_f32_bf16 v24, v57, v5, v24
    v_dot2_f32_bf16 v25, v61, v5, v25
    v_dot2_f32_bf16 v26, v65, v5, v26
    v_dot2_f32_bf16 v27, v69, v5, v27
    v_dot2_f32_bf16 v28, v105, v5, v28
    v_dot2_f32_bf16 v29, v109, v5, v29
    v_dot2_f32_bf16 v30, v113, v5, v30
    v_dot2_f32_bf16 v31, v117, v5, v31
    v_dot2_f32_bf16 v8, v42, v6, v8
    v_dot2_f32_bf16 v9, v46, v6, v9
    v_dot2_f32_bf16 v10, v50, v6, v10
    v_dot2_f32_bf16 v11, v54, v6, v11
    v_dot2_f32_bf16 v24, v58, v6, v24
    v_dot2_f32_bf16 v25, v62, v6, v25
    v_dot2_f32_bf16 v26, v66, v6, v26
    v_dot2_f32_bf16 v27, v70, v6, v27
    v_dot2_f32_bf16 v28, v106, v6, v28
    v_dot2_f32_bf16 v29, v110, v6, v29
    v_dot2_f32_bf16 v30, v114, v6, v30
    v_dot2_f32_bf16 v31, v118, v6, v31
    v_dot2_f32_bf16 v8, v43, v7, v8
    v_dot2_f32_bf16 v9, v47, v7, v9
    v_dot2_f32_bf16 v10, v51, v7, v10
    v_dot2_f32_bf16 v11, v55, v7, v11
    v_dot2_f32_bf16 v24, v59, v7, v24
    v_dot2_f32_bf16 v25, v63, v7, v25
    v_dot2_f32_bf16 v26, v67, v7, v26
    v_dot2_f32_bf16 v27, v71, v7, v27
    v_dot2_f32_bf16 v28, v107, v7, v28
    v_dot2_f32_bf16 v29, v111, v7, v29
    v_dot2_f32_bf16 v30, v115, v7, v30
    v_dot2_f32_bf16 v31, v119, v7, v31
    v_add_f32_dpp v8, v8, v8 row_ror:8 row_mask:0xf bank_mask:0x3
    v_add_f32_dpp v10, v10, v10 row_ror:8 row_mask:0xf bank_mask:0x3
    v_add_f32_dpp v24, v24, v24 row_ror:8 row_mask:0xf bank_mask:0x3
    v_add_f32_dpp v26, v26, v26 row_ror:8 row_mask:0xf bank_mask:0x3
    v_add_f32_dpp v28, v28, v28 row_ror:8 row_mask:0xf bank_mask:0x3
    v_add_f32_dpp v30, v30, v30 row_ror:8 row_mask:0xf bank_mask:0x3
    v_add_f32_dpp v8, v9, v9 row_ror:8 row_mask:0xf bank_mask:0xc
    v_add_f32_dpp v10, v11, v11 row_ror:8 row_mask:0xf bank_mask:0xc
    v_add_f32_dpp v24, v25, v25 row_ror:8 row_mask:0xf bank_mask:0xc
    v_add_f32_dpp v26, v27, v27 row_ror:8 row_mask:0xf bank_mask:0xc
    v_add_f32_dpp v28, v29, v29 row_ror:8 row_mask:0xf bank_mask:0xc
    v_add_f32_dpp v30, v31, v31 row_ror:8 row_mask:0xf bank_mask:0xc
    v_add_f32_dpp v12, v8, v8 row_half_mirror row_mask:0xf bank_mask:0x5
    v_add_f32_dpp v13, v24, v24 row_half_mirror row_mask:0xf bank_mask:0x5
    v_add_f32_dpp v16, v28, v28 row_half_mirror row_mask:0xf bank_mask:0x5
    v_add_f32_dpp v12, v10, v10 row_half_mirror row_mask:0xf bank_mask:0xa
    v_add_f32_dpp v13, v26, v26 row_half_mirror row_mask:0xf bank_mask:0xa
    v_add_f32_dpp v16, v30, v30 row_half_mirror row_mask:0xf bank_mask:0xa
    v_add_f32_dpp v12, v12, v12 quad_perm:[1,0,3,2] row_mask:0xf bank_mask:0xf
    v_add_f32_dpp v13, v13, v13 quad_perm:[1,0,3,2] row_mask:0xf bank_mask:0xf
    v_add_f32_dpp v16, v16, v16 quad_perm:[1,0,3,2] row_mask:0xf bank_mask:0xf
    v_add_f32_dpp v12, v12, v12 quad_perm:[2,3,0,1] row_mask:0xf bank_mask:0xf
    v_add_f32_dpp v13, v13, v13 quad_perm:[2,3,0,1] row_mask:0xf bank_mask:0xf
    v_add_f32_dpp v16, v16, v16 quad_perm:[2,3,0,1] row_mask:0xf bank_mask:0xf
    s_waitcnt vmcnt(3)
    s_bitcmp0_b32 s14, 9
    s_cbranch_scc1 L_sf_57
    s_waitcnt vmcnt(2)
    s_bitcmp0_b32 s15, 9
    s_cbranch_scc1 L_sf_57
    s_waitcnt vmcnt(1)
L_sf_57:
    buffer_load_dwordx4 v[76:79], v1, s[52:55], s97 offen offset:1024 nt
    v_dot2_f32_bf16 v8, v120, v4, 0
    v_dot2_f32_bf16 v9, v124, v4, 0
    v_dot2_f32_bf16 v10, v128, v4, 0
    v_dot2_f32_bf16 v11, v132, v4, 0
    v_dot2_f32_bf16 v24, v136, v4, 0
    v_dot2_f32_bf16 v25, v140, v4, 0
    v_dot2_f32_bf16 v26, v144, v4, 0
    v_dot2_f32_bf16 v27, v148, v4, 0
    v_dot2_f32_bf16 v8, v121, v5, v8
    v_dot2_f32_bf16 v9, v125, v5, v9
    v_dot2_f32_bf16 v10, v129, v5, v10
    v_dot2_f32_bf16 v11, v133, v5, v11
    v_dot2_f32_bf16 v24, v137, v5, v24
    v_dot2_f32_bf16 v25, v141, v5, v25
    v_dot2_f32_bf16 v26, v145, v5, v26
    v_dot2_f32_bf16 v27, v149, v5, v27
    v_dot2_f32_bf16 v8, v122, v6, v8
    v_dot2_f32_bf16 v9, v126, v6, v9
    v_dot2_f32_bf16 v10, v130, v6, v10
    v_dot2_f32_bf16 v11, v134, v6, v11
    v_dot2_f32_bf16 v24, v138, v6, v24
    v_dot2_f32_bf16 v25, v142, v6, v25
    v_dot2_f32_bf16 v26, v146, v6, v26
    v_dot2_f32_bf16 v27, v150, v6, v27
    v_dot2_f32_bf16 v8, v123, v7, v8
    v_dot2_f32_bf16 v9, v127, v7, v9
    v_dot2_f32_bf16 v10, v131, v7, v10
    v_dot2_f32_bf16 v11, v135, v7, v11
    v_dot2_f32_bf16 v24, v139, v7, v24
    v_dot2_f32_bf16 v25, v143, v7, v25
    v_dot2_f32_bf16 v26, v147, v7, v26
    v_dot2_f32_bf16 v27, v151, v7, v27
    v_add_f32_dpp v8, v8, v8 row_ror:8 row_mask:0xf bank_mask:0x3
    v_add_f32_dpp v10, v10, v10 row_ror:8 row_mask:0xf bank_mask:0x3
    v_add_f32_dpp v24, v24, v24 row_ror:8 row_mask:0xf bank_mask:0x3
    v_add_f32_dpp v26, v26, v26 row_ror:8 row_mask:0xf bank_mask:0x3
    v_add_f32_dpp v8, v9, v9 row_ror:8 row_mask:0xf bank_mask:0xc
    v_add_f32_dpp v10, v11, v11 row_ror:8 row_mask:0xf bank_mask:0xc
    v_add_f32_dpp v24, v25, v25 row_ror:8 row_mask:0xf bank_mask:0xc
    v_add_f32_dpp v26, v27, v27 row_ror:8 row_mask:0xf bank_mask:0xc
    v_add_f32_dpp v17, v8, v8 row_half_mirror row_mask:0xf bank_mask:0x5
    v_add_f32_dpp v18, v24, v24 row_half_mirror row_mask:0xf bank_mask:0x5
    v_add_f32_dpp v17, v10, v10 row_half_mirror row_mask:0xf bank_mask:0xa
    v_add_f32_dpp v18, v26, v26 row_half_mirror row_mask:0xf bank_mask:0xa
    s_nop 0
    v_add_f32_dpp v17, v17, v17 quad_perm:[1,0,3,2] row_mask:0xf bank_mask:0xf
    v_add_f32_dpp v18, v18, v18 quad_perm:[1,0,3,2] row_mask:0xf bank_mask:0xf
    s_nop 0
    v_add_f32_dpp v17, v17, v17 quad_perm:[2,3,0,1] row_mask:0xf bank_mask:0xf
    v_add_f32_dpp v18, v18, v18 quad_perm:[2,3,0,1] row_mask:0xf bank_mask:0xf
    s_waitcnt vmcnt(3)
    s_bitcmp0_b32 s14, 10
    s_cbranch_scc1 L_sf_58
    s_waitcnt vmcnt(2)
    s_bitcmp0_b32 s15, 10
    s_cbranch_scc1 L_sf_58
    s_waitcnt vmcnt(1)
L_sf_58:
    buffer_load_dwordx4 v[80:83], v1, s[52:55], s97 offen offset:2048 nt
    s_waitcnt vmcnt(3)
    s_bitcmp0_b32 s14, 11
    s_cbranch_scc1 L_sf_59
    s_waitcnt vmcnt(2)
    s_bitcmp0_b32 s15, 11
    s_cbranch_scc1 L_sf_59
    s_waitcnt vmcnt(1)
L_sf_59:
    buffer_load_dwordx4 v[84:87], v1, s[52:55], s97 offen offset:3072 nt
    s_add_u32 s97, s97, 32768
    v_add_u32 v1, 4096, v1
    v_and_b32 v1, 0x7fff, v1
    s_cmp_eq_u32 s12, -1
    s_cbranch_scc1 L_nopfrd
    v_lshl_add_u32 v38, v0, 4, s12
    ds_read_b128 v[40:43], v38 offset:0
    ds_read_b128 v[44:47], v38 offset:1024
    ds_read_b128 v[48:51], v38 offset:2048
    ds_read_b128 v[52:55], v38 offset:3072
    ds_read_b128 v[56:59], v38 offset:4096
    ds_read_b128 v[60:63], v38 offset:5120
    ds_read_b128 v[64:67], v38 offset:6144
    ds_read_b128 v[68:71], v38 offset:7168
L_nopfrd:
    v_dot2_f32_bf16 v8, v152, v4, 0
    v_dot2_f32_bf16 v9, v156, v4, 0
    v_dot2_f32_bf16 v10, v160, v4, 0
    v_dot2_f32_bf16 v11, v164, v4, 0
    v_dot2_f32_bf16 v8, v153, v5, v8
    v_dot2_f32_bf16 v9, v157, v5, v9
    v_dot2_f32_bf16 v10, v161, v5, v10
    v_dot2_f32_bf16 v11, v165, v5, v11
    v_dot2_f32_bf16 v8, v154, v6, v8
    v_dot2_f32_bf16 v9, v158, v6, v9
    v_dot2_f32_bf16 v10, v162, v6, v10
    v_dot2_f32_bf16 v11, v166, v6, v11
    v_dot2_f32_bf16 v8, v155, v7, v8
    v_dot2_f32_bf16 v9, v159, v7, v9
    v_dot2_f32_bf16 v10, v163, v7, v10
    v_dot2_f32_bf16 v11, v167, v7, v11
    v_add_f32_dpp v8, v8, v8 row_ror:8 row_mask:0xf bank_mask:0x3
    s_nop 0
    v_add_f32_dpp v10, v10, v10 row_ror:8 row_mask:0xf bank_mask:0x3
    v_add_f32_dpp v8, v9, v9 row_ror:8 row_mask:0xf bank_mask:0xc
    v_add_f32_dpp v10, v11, v11 row_ror:8 row_mask:0xf bank_mask:0xc
    s_nop 0
    v_add_f32_dpp v19, v8, v8 row_half_mirror row_mask:0xf bank_mask:0x5
    v_add_f32_dpp v19, v10, v10 row_half_mirror row_mask:0xf bank_mask:0xa
    s_nop 1
    v_add_f32_dpp v19, v19, v19 quad_perm:[1,0,3,2] row_mask:0xf bank_mask:0xf
    s_nop 1
    v_add_f32_dpp v19, v19, v19 quad_perm:[2,3,0,1] row_mask:0xf bank_mask:0xf
    v_max3_f32 v3, v12, v13, v14
    v_max3_f32 v8, v15, v16, v17
    v_max3_f32 v3, v3, v18, v19
    v_max_f32 v3, v3, v8
    s_nop 1
    v_max_f32_dpp v3, v3, v3 row_ror:4 row_mask:0xf bank_mask:0xf
    s_nop 1
    v_max_f32_dpp v3, v3, v3 row_ror:8 row_mask:0xf bank_mask:0xf
    v_mov_b32 v8, v3
    s_nop 1
    v_permlane16_swap_b32 v3, v8
    v_max_f32 v3, v3, v8
    v_mov_b32 v8, v3
    s_nop 1
    v_permlane32_swap_b32 v3, v8
    v_max_f32 v3, v3, v8
    s_mov_b32 s96, 0x3e0293ee
    v_mul_f32 v8, s96, v3
    v_fma_f32 v12, v12, s96, -v8
    v_fma_f32 v13, v13, s96, -v8
    v_fma_f32 v14, v14, s96, -v8
    v_fma_f32 v15, v15, s96, -v8
    v_fma_f32 v16, v16, s96, -v8
    v_fma_f32 v17, v17, s96, -v8
    v_fma_f32 v18, v18, s96, -v8
    v_fma_f32 v19, v19, s96, -v8
    v_exp_f32 v12, v12
    v_exp_f32 v13, v13
    v_exp_f32 v14, v14
    v_exp_f32 v15, v15
    v_exp_f32 v16, v16
    v_exp_f32 v17, v17
    v_exp_f32 v18, v18
    v_exp_f32 v19, v19
    v_add_f32 v9, v12, v13
    v_add_f32 v10, v14, v15
    v_add_f32 v11, v16, v17
    v_add_f32 v3, v18, v19
    v_add_f32 v9, v9, v10
    v_add_f32 v3, v3, v11
    v_add_f32 v9, v9, v3
    v_cvt_pk_bf16_f32 v12, v12, v12
    v_cvt_pk_bf16_f32 v13, v13, v13
    v_cvt_pk_bf16_f32 v14, v14, v14
    v_cvt_pk_bf16_f32 v15, v15, v15
    v_cvt_pk_bf16_f32 v16, v16, v16
    v_cvt_pk_bf16_f32 v17, v17, v17
    v_cvt_pk_bf16_f32 v18, v18, v18
    v_cvt_pk_bf16_f32 v19, v19, v19
    v_add_f32_dpp v9, v9, v9 row_ror:4 row_mask:0xf bank_mask:0xf
    s_nop 1
    v_add_f32_dpp v9, v9, v9 row_ror:8 row_mask:0xf bank_mask:0xf
    v_mov_b32 v10, v9
    s_nop 1
    v_permlane16_swap_b32 v9, v10
    v_add_f32 v9, v9, v10
    v_mov_b32 v10, v9
    s_nop 1
    v_permlane32_swap_b32 v9, v10
    v_add_f32 v9, v9, v10
    s_mov_b64 exec, 1
    s_cmp_lg_u32 s13, 0
    s_cbranch_scc1 L_mljob
    s_lshl_b32 s96, s3, 3
    s_add_u32 s96, s96, 161920
    v_mov_b32 v10, s96
    v_mov_b32 v11, 162068
    v_mov_b32 v3, 1
    ds_write_b64 v10, v[8:9]
    ds_add_u32 v11, v3
L_mldone:
    s_mov_b64 exec, -1
    v_lshrrev_b32 v2, 1, v2
    v_and_b32_dpp v24, v14, v20 row_newbcast:0 row_mask:0xf bank_mask:0xf
    v_and_b32_dpp v25, v14, v21 row_newbcast:0 row_mask:0xf bank_mask:0xf
    v_and_b32_dpp v26, v14, v22 row_newbcast:0 row_mask:0xf bank_mask:0xf
    v_and_b32_dpp v27, v14, v23 row_newbcast:0 row_mask:0xf bank_mask:0xf
    s_waitcnt vmcnt(3)
    s_bitcmp0_b32 s14, 12
    s_cbranch_scc1 L_sf_60
    s_waitcnt vmcnt(2)
    s_bitcmp0_b32 s15, 12
    s_cbranch_scc1 L_sf_60
    s_waitcnt vmcnt(1)
L_sf_60:
    buffer_load_dwordx4 v[88:91], v1, s[52:55], s97 offen offset:0 nt
    v_mfma_f32_16x16x32_bf16 v[32:35], v[24:27], v[72:75], v[32:35]
    s_cmp_eq_u32 s12, -1
    s_cbranch_scc1 L_nopfpv8
    s_waitcnt lgkmcnt(0)
    v_and_b32_dpp v24, v12, v20 row_newbcast:0 row_mask:0xf bank_mask:0xf
    v_and_b32_dpp v25, v12, v21 row_newbcast:0 row_mask:0xf bank_mask:0xf
    v_and_b32_dpp v26, v12, v22 row_newbcast:0 row_mask:0xf bank_mask:0xf
    v_and_b32_dpp v27, v12, v23 row_newbcast:0 row_mask:0xf bank_mask:0xf
    s_nop 1
    v_mfma_f32_16x16x32_bf16 v[32:35], v[24:27], v[40:43], v[32:35]
    v_and_b32_dpp v28, v12, v20 row_newbcast:8 row_mask:0xf bank_mask:0xf
    v_and_b32_dpp v29, v12, v21 row_newbcast:8 row_mask:0xf bank_mask:0xf
    v_and_b32_dpp v30, v12, v22 row_newbcast:8 row_mask:0xf bank_mask:0xf
    v_and_b32_dpp v31, v12, v23 row_newbcast:8 row_mask:0xf bank_mask:0xf
    s_nop 1
    v_mfma_f32_16x16x32_bf16 v[32:35], v[28:31], v[44:47], v[32:35]
    v_and_b32_dpp v24, v12, v20 row_newbcast:4 row_mask:0xf bank_mask:0xf
    v_and_b32_dpp v25, v12, v21 row_newbcast:4 row_mask:0xf bank_mask:0xf
    v_and_b32_dpp v26, v12, v22 row_newbcast:4 row_mask:0xf bank_mask:0xf
    v_and_b32_dpp v27, v12, v23 row_newbcast:4 row_mask:0xf bank_mask:0xf
    s_nop 1
    v_mfma_f32_16x16x32_bf16 v[32:35], v[24:27], v[48:51], v[32:35]
    v_and_b32_dpp v28, v12, v20 row_newbcast:12 row_mask:0xf bank_mask:0xf
    v_and_b32_dpp v29, v12, v21 row_newbcast:12 row_mask:0xf bank_mask:0xf
    v_and_b32_dpp v30, v12, v22 row_newbcast:12 row_mask:0xf bank_mask:0xf
    v_and_b32_dpp v31, v12, v23 row_newbcast:12 row_mask:0xf bank_mask:0xf
    s_nop 1
    v_mfma_f32_16x16x32_bf16 v[32:35], v[28:31], v[52:55], v[32:35]
L_nopfpv8:
    v_and_b32_dpp v28, v14, v20 row_newbcast:8 row_mask:0xf bank_mask:0xf
    v_and_b32_dpp v29, v14, v21 row_newbcast:8 row_mask:0xf bank_mask:0xf
    v_and_b32_dpp v30, v14, v22 row_newbcast:8 row_mask:0xf bank_mask:0xf
    v_and_b32_dpp v31, v14, v23 row_newbcast:8 row_mask:0xf bank_mask:0xf
    s_waitcnt vmcnt(3)
    s_bitcmp0_b32 s14, 13
    s_cbranch_scc1 L_sf_61
    s_waitcnt vmcnt(2)
    s_bitcmp0_b32 s15, 13
    s_cbranch_scc1 L_sf_61
    s_waitcnt vmcnt(1)
L_sf_61:
    buffer_load_dwordx4 v[92:95], v1, s[52:55], s97 offen offset:1024 nt
    v_mfma_f32_16x16x32_bf16 v[32:35], v[28:31], v[76:79], v[32:35]
    s_cmp_eq_u32 s12, -1
    s_cbranch_scc1 L_nopfpv9
    s_waitcnt lgkmcnt(0)
    v_and_b32_dpp v24, v13, v20 row_newbcast:0 row_mask:0xf bank_mask:0xf
    v_and_b32_dpp v25, v13, v21 row_newbcast:0 row_mask:0xf bank_mask:0xf
    v_and_b32_dpp v26, v13, v22 row_newbcast:0 row_mask:0xf bank_mask:0xf
    v_and_b32_dpp v27, v13, v23 row_newbcast:0 row_mask:0xf bank_mask:0xf
    s_nop 1
    v_mfma_f32_16x16x32_bf16 v[32:35], v[24:27], v[56:59], v[32:35]
    v_and_b32_dpp v28, v13, v20 row_newbcast:8 row_mask:0xf bank_mask:0xf
    v_and_b32_dpp v29, v13, v21 row_newbcast:8 row_mask:0xf bank_mask:0xf
    v_and_b32_dpp v30, v13, v22 row_newbcast:8 row_mask:0xf bank_mask:0xf
    v_and_b32_dpp v31, v13, v23 row_newbcast:8 row_mask:0xf bank_mask:0xf
    s_nop 1
    v_mfma_f32_16x16x32_bf16 v[32:35], v[28:31], v[60:63], v[32:35]
    v_and_b32_dpp v24, v13, v20 row_newbcast:4 row_mask:0xf bank_mask:0xf
    v_and_b32_dpp v25, v13, v21 row_newbcast:4 row_mask:0xf bank_mask:0xf
    v_and_b32_dpp v26, v13, v22 row_newbcast:4 row_mask:0xf bank_mask:0xf
    v_and_b32_dpp v27, v13, v23 row_newbcast:4 row_mask:0xf bank_mask:0xf
    s_nop 1
    v_mfma_f32_16x16x32_bf16 v[32:35], v[24:27], v[64:67], v[32:35]
    v_and_b32_dpp v28, v13, v20 row_newbcast:12 row_mask:0xf bank_mask:0xf
    v_and_b32_dpp v29, v13, v21 row_newbcast:12 row_mask:0xf bank_mask:0xf
    v_and_b32_dpp v30, v13, v22 row_newbcast:12 row_mask:0xf bank_mask:0xf
    v_and_b32_dpp v31, v13, v23 row_newbcast:12 row_mask:0xf bank_mask:0xf
    s_nop 1
    v_mfma_f32_16x16x32_bf16 v[32:35], v[28:31], v[68:71], v[32:35]
L_nopfpv9:
    v_and_b32_dpp v24, v14, v20 row_newbcast:4 row_mask:0xf bank_mask:0xf
    v_and_b32_dpp v25, v14, v21 row_newbcast:4 row_mask:0xf bank_mask:0xf
    v_and_b32_dpp v26, v14, v22 row_newbcast:4 row_mask:0xf bank_mask:0xf
    v_and_b32_dpp v27, v14, v23 row_newbcast:4 row_mask:0xf bank_mask:0xf
    s_waitcnt vmcnt(3)
    s_bitcmp0_b32 s14, 14
    s_cbranch_scc1 L_sf_62
    s_waitcnt vmcnt(2)
    s_bitcmp0_b32 s15, 14
    s_cbranch_scc1 L_sf_62
    s_waitcnt vmcnt(1)
L_sf_62:
    buffer_load_dwordx4 v[96:99], v1, s[52:55], s97 offen offset:2048 nt
    v_mfma_f32_16x16x32_bf16 v[32:35], v[24:27], v[80:83], v[32:35]
    v_and_b32_dpp v28, v14, v20 row_newbcast:12 row_mask:0xf bank_mask:0xf
    v_and_b32_dpp v29, v14, v21 row_newbcast:12 row_mask:0xf bank_mask:0xf
    v_and_b32_dpp v30, v14, v22 row_newbcast:12 row_mask:0xf bank_mask:0xf
    v_and_b32_dpp v31, v14, v23 row_newbcast:12 row_mask:0xf bank_mask:0xf
    s_waitcnt vmcnt(3)
    s_bitcmp0_b32 s14, 15
    s_cbranch_scc1 L_sf_63
    s_waitcnt vmcnt(2)
    s_bitcmp0_b32 s15, 15
    s_cbranch_scc1 L_sf_63
    s_waitcnt vmcnt(1)
L_sf_63:
    buffer_load_dwordx4 v[100:103], v1, s[52:55], s97 offen offset:3072 nt
    s_add_u32 s97, s97, 32768
    v_add_u32 v1, 4096, v1
    v_and_b32 v1, 0x7fff, v1
    v_mfma_f32_16x16x32_bf16 v[32:35], v[28:31], v[84:87], v[32:35]
    v_and_b32_dpp v24, v15, v20 row_newbcast:0 row_mask:0xf bank_mask:0xf
    v_and_b32_dpp v25, v15, v21 row_newbcast:0 row_mask:0xf bank_mask:0xf
    v_and_b32_dpp v26, v15, v22 row_newbcast:0 row_mask:0xf bank_mask:0xf
    v_and_b32_dpp v27, v15, v23 row_newbcast:0 row_mask:0xf bank_mask:0xf
    s_waitcnt vmcnt(3)
    s_bitcmp0_b32 s14, 16
    s_cbranch_scc1 L_sf_64
    s_waitcnt vmcnt(2)
    s_bitcmp0_b32 s15, 16
    s_cbranch_scc1 L_sf_64
    s_waitcnt vmcnt(1)
L_sf_64:
    buffer_load_dwordx4 v[104:107], v1, s[52:55], s97 offen offset:0 nt
    v_mfma_f32_16x16x32_bf16 v[32:35], v[24:27], v[88:91], v[32:35]
    v_and_b32_dpp v28, v15, v20 row_newbcast:8 row_mask:0xf bank_mask:0xf
    v_and_b32_dpp v29, v15, v21 row_newbcast:8 row_mask:0xf bank_mask:0xf
    v_and_b32_dpp v30, v15, v22 row_newbcast:8 row_mask:0xf bank_mask:0xf
    v_and_b32_dpp v31, v15, v23 row_newbcast:8 row_mask:0xf bank_mask:0xf
    s_waitcnt vmcnt(3)
    s_bitcmp0_b32 s14, 17
    s_cbranch_scc1 L_sf_65
    s_waitcnt vmcnt(2)
    s_bitcmp0_b32 s15, 17
    s_cbranch_scc1 L_sf_65
    s_waitcnt vmcnt(1)
L_sf_65:
    buffer_load_dwordx4 v[108:111], v1, s[52:55], s97 offen offset:1024 nt
    v_mfma_f32_16x16x32_bf16 v[32:35], v[28:31], v[92:95], v[32:35]
    v_and_b32_dpp v24, v15, v20 row_newbcast:4 row_mask:0xf bank_mask:0xf
    v_and_b32_dpp v25, v15, v21 row_newbcast:4 row_mask:0xf bank_mask:0xf
    v_and_b32_dpp v26, v15, v22 row_newbcast:4 row_mask:0xf bank_mask:0xf
    v_and_b32_dpp v27, v15, v23 row_newbcast:4 row_mask:0xf bank_mask:0xf
    s_waitcnt vmcnt(3)
    s_bitcmp0_b32 s14, 18
    s_cbranch_scc1 L_sf_66
    s_waitcnt vmcnt(2)
    s_bitcmp0_b32 s15, 18
    s_cbranch_scc1 L_sf_66
    s_waitcnt vmcnt(1)
L_sf_66:
    buffer_load_dwordx4 v[112:115], v1, s[52:55], s97 offen offset:2048 nt
    v_mfma_f32_16x16x32_bf16 v[32:35], v[24:27], v[96:99], v[32:35]
    v_and_b32_dpp v28, v15, v20 row_newbcast:12 row_mask:0xf bank_mask:0xf
    v_and_b32_dpp v29, v15, v21 row_newbcast:12 row_mask:0xf bank_mask:0xf
    v_and_b32_dpp v30, v15, v22 row_newbcast:12 row_mask:0xf bank_mask:0xf
    v_and_b32_dpp v31, v15, v23 row_newbcast:12 row_mask:0xf bank_mask:0xf
    s_waitcnt vmcnt(3)
    s_bitcmp0_b32 s14, 19
    s_cbranch_scc1 L_sf_67
    s_waitcnt vmcnt(2)
    s_bitcmp0_b32 s15, 19
    s_cbranch_scc1 L_sf_67
    s_waitcnt vmcnt(1)
L_sf_67:
    buffer_load_dwordx4 v[116:119], v1, s[52:55], s97 offen offset:3072 nt
    s_add_u32 s97, s97, 32768
    v_add_u32 v1, 4096, v1
    v_and_b32 v1, 0x7fff, v1
    v_mfma_f32_16x16x32_bf16 v[32:35], v[28:31], v[100:103], v[32:35]
    v_and_b32_dpp v24, v16, v20 row_newbcast:0 row_mask:0xf bank_mask:0xf
    v_and_b32_dpp v25, v16, v21 row_newbcast:0 row_mask:0xf bank_mask:0xf
    v_and_b32_dpp v26, v16, v22 row_newbcast:0 row_mask:0xf bank_mask:0xf
    v_and_b32_dpp v27, v16, v23 row_newbcast:0 row_mask:0xf bank_mask:0xf
    s_waitcnt vmcnt(3)
    s_bitcmp0_b32 s14, 20
    s_cbranch_scc1 L_sf_68
    s_waitcnt vmcnt(2)
    s_bitcmp0_b32 s15, 20
    s_cbranch_scc1 L_sf_68
    s_waitcnt vmcnt(1)
L_sf_68:
    buffer_load_dwordx4 v[120:123], v1, s[52:55], s97 offen offset:0 nt
    v_mfma_f32_16x16x32_bf16 v[32:35], v[24:27], v[104:107], v[32:35]
    v_and_b32_dpp v28, v16, v20 row_newbcast:8 row_mask:0xf bank_mask:0xf
    v_and_b32_dpp v29, v16, v21 row_newbcast:8 row_mask:0xf bank_mask:0xf
    v_and_b32_dpp v30, v16, v22 row_newbcast:8 row_mask:0xf bank_mask:0xf
    v_and_b32_dpp v31, v16, v23 row_newbcast:8 row_mask:0xf bank_mask:0xf
    s_waitcnt vmcnt(3)
    s_bitcmp0_b32 s14, 21
    s_cbranch_scc1 L_sf_69
    s_waitcnt vmcnt(2)
    s_bitcmp0_b32 s15, 21
    s_cbranch_scc1 L_sf_69
    s_waitcnt vmcnt(1)
L_sf_69:
    buffer_load_dwordx4 v[124:127], v1, s[52:55], s97 offen offset:1024 nt
    v_mfma_f32_16x16x32_bf16 v[32:35], v[28:31], v[108:111], v[32:35]
    v_and_b32_dpp v24, v16, v20 row_newbcast:4 row_mask:0xf bank_mask:0xf
    v_and_b32_dpp v25, v16, v21 row_newbcast:4 row_mask:0xf bank_mask:0xf
    v_and_b32_dpp v26, v16, v22 row_newbcast:4 row_mask:0xf bank_mask:0xf
    v_and_b32_dpp v27, v16, v23 row_newbcast:4 row_mask:0xf bank_mask:0xf
    s_waitcnt vmcnt(3)
    s_bitcmp0_b32 s14, 22
    s_cbranch_scc1 L_sf_70
    s_waitcnt vmcnt(2)
    s_bitcmp0_b32 s15, 22
    s_cbranch_scc1 L_sf_70
    s_waitcnt vmcnt(1)
L_sf_70:
    buffer_load_dwordx4 v[128:131], v1, s[52:55], s97 offen offset:2048 nt
    v_mfma_f32_16x16x32_bf16 v[32:35], v[24:27], v[112:115], v[32:35]
    v_and_b32_dpp v28, v16, v20 row_newbcast:12 row_mask:0xf bank_mask:0xf
    v_and_b32_dpp v29, v16, v21 row_newbcast:12 row_mask:0xf bank_mask:0xf
    v_and_b32_dpp v30, v16, v22 row_newbcast:12 row_mask:0xf bank_mask:0xf
    v_and_b32_dpp v31, v16, v23 row_newbcast:12 row_mask:0xf bank_mask:0xf
    s_waitcnt vmcnt(3)
    s_bitcmp0_b32 s14, 23
    s_cbranch_scc1 L_sf_71
    s_waitcnt vmcnt(2)
    s_bitcmp0_b32 s15, 23
    s_cbranch_scc1 L_sf_71
    s_waitcnt vmcnt(1)
L_sf_71:
    buffer_load_dwordx4 v[132:135], v1, s[52:55], s97 offen offset:3072 nt
    s_add_u32 s97, s97, 32768
    v_add_u32 v1, 4096, v1
    v_and_b32 v1, 0x7fff, v1
    v_mfma_f32_16x16x32_bf16 v[32:35], v[28:31], v[116:119], v[32:35]
    v_and_b32_dpp v24, v17, v20 row_newbcast:0 row_mask:0xf bank_mask:0xf
    v_and_b32_dpp v25, v17, v21 row_newbcast:0 row_mask:0xf bank_mask:0xf
    v_and_b32_dpp v26, v17, v22 row_newbcast:0 row_mask:0xf bank_mask:0xf
    v_and_b32_dpp v27, v17, v23 row_newbcast:0 row_mask:0xf bank_mask:0xf
    s_waitcnt vmcnt(3)
    s_bitcmp0_b32 s14, 24
    s_cbranch_scc1 L_sf_72
    s_waitcnt vmcnt(2)
    s_bitcmp0_b32 s15, 24
    s_cbranch_scc1 L_sf_72
    s_waitcnt vmcnt(1)
L_sf_72:
    buffer_load_dwordx4 v[136:139], v1, s[52:55], s97 offen offset:0 nt
    v_mfma_f32_16x16x32_bf16 v[32:35], v[24:27], v[120:123], v[32:35]
    s_or_b32 s96, s59, s39
    s_cbranch_scc0 L_nofrag_73
    v_mov_b32 v104, 162060
L_lw_74:
    ds_read_b32 v105, v104
    s_waitcnt lgkmcnt(0)
    v_cmp_gt_u32 vcc, 4, v105
    s_cbranch_vccz L_lw_74e
    s_sleep 2
    s_sub_u32 s60, s60, 1
    s_cbranch_scc0 L_lw_74
    s_mov_b32 s60, 0
L_lw_74e:
    s_cmp_eq_u32 s59, 0
    s_cbranch_scc1 L_nofrag_73
    v_lshrrev_b32 v109, 4, v0
    v_bfe_u32 v104, v0, 1, 1
    v_lshl_add_u32 v104, v109, 1, v104
    v_bfe_u32 v110, v0, 2, 2
    v_lshl_add_u32 v104, v104, 3, v110
    v_lshlrev_b32 v104, 7, v104
    v_and_b32 v110, 1, v0
    v_lshl_add_u32 v104, v110, 3, v104
    s_lshl_b32 s96, s3, 13
    s_add_u32 s96, s96, 81920
    v_add_u32 v104, s96, v104
    ds_read_b64_tr_b16 v[72:73], v104 offset:0
    ds_read_b64_tr_b16 v[74:75], v104 offset:512
    ds_read_b64_tr_b16 v[76:77], v104 offset:16
    ds_read_b64_tr_b16 v[78:79], v104 offset:528
    ds_read_b64_tr_b16 v[80:81], v104 offset:32
    ds_read_b64_tr_b16 v[82:83], v104 offset:544
    ds_read_b64_tr_b16 v[84:85], v104 offset:48
    ds_read_b64_tr_b16 v[86:87], v104 offset:560
    ds_read_b64_tr_b16 v[88:89], v104 offset:64
    ds_read_b64_tr_b16 v[90:91], v104 offset:576
    ds_read_b64_tr_b16 v[92:93], v104 offset:80
    ds_read_b64_tr_b16 v[94:95], v104 offset:592
    ds_read_b64_tr_b16 v[96:97], v104 offset:96
    ds_read_b64_tr_b16 v[98:99], v104 offset:608
    ds_read_b64_tr_b16 v[100:101], v104 offset:112
    ds_read_b64_tr_b16 v[102:103], v104 offset:624
    v_bfe_u32 v105, v0, 1, 3
    v_lshlrev_b32 v105, 8, v105
    v_lshl_add_u32 v105, v109, 5, v105
    v_lshl_add_u32 v105, v110, 4, v105
    v_mul_u32_u24 v106, 320, v109
    v_bfe_u32 v110, v0, 3, 1
    v_mul_u32_u24 v110, 160, v110
    v_add_u32 v106, v106, v110
    v_and_b32 v110, 7, v0
    v_lshl_add_u32 v107, v110, 4, v106
    v_add_u32 v107, 81920, v107
    v_lshl_add_u32 v106, v110, 2, v106
    v_add_u32 v106, s96, v106
    v_mul_u32_u24 v108, 1280, v109
    v_add_u32 v108, v108, v2
    s_lshr_b32 s96, s3, 1
    s_lshl_b32 s96, s96, 11
    s_and_b32 s100, s3, 1
    s_lshl_b32 s100, s100, 7
    s_add_u32 s100, s100, s96
    s_lshl_b32 s96, s34, 13
    s_add_u32 s100, s100, s96
    s_add_u32 s100, s100, 90112
    s_mul_i32 s101, s34, 5120
    s_lshl_b32 s96, s35, 7
    s_add_u32 s101, s101, s96
    s_add_u32 s101, s101, 152832
L_nofrag_73:
    v_mov_b32 v10, 162076
    v_mov_b32 v11, 1
    s_mov_b64 exec, 1
    ds_add_u32 v10, v11
    s_mov_b64 exec, -1
    v_and_b32_dpp v28, v17, v20 row_newbcast:8 row_mask:0xf bank_mask:0xf
    v_and_b32_dpp v29, v17, v21 row_newbcast:8 row_mask:0xf bank_mask:0xf
    v_and_b32_dpp v30, v17, v22 row_newbcast:8 row_mask:0xf bank_mask:0xf
    v_and_b32_dpp v31, v17, v23 row_newbcast:8 row_mask:0xf bank_mask:0xf
    s_waitcnt vmcnt(3)
    s_bitcmp0_b32 s14, 25
    s_cbranch_scc1 L_sf_75
    s_waitcnt vmcnt(2)
    s_bitcmp0_b32 s15, 25
    s_cbranch_scc1 L_sf_75
    s_waitcnt vmcnt(1)
L_sf_75:
    buffer_load_dwordx4 v[140:143], v1, s[52:55], s97 offen offset:1024 nt
    v_mfma_f32_16x16x32_bf16 v[32:35], v[28:31], v[124:127], v[32:35]
    v_and_b32_dpp v24, v17, v20 row_newbcast:4 row_mask:0xf bank_mask:0xf
    v_and_b32_dpp v25, v17, v21 row_newbcast:4 row_mask:0xf bank_mask:0xf
    v_and_b32_dpp v26, v17, v22 row_newbcast:4 row_mask:0xf bank_mask:0xf
    v_and_b32_dpp v27, v17, v23 row_newbcast:4 row_mask:0xf bank_mask:0xf
    s_waitcnt vmcnt(3)
    s_bitcmp0_b32 s14, 26
    s_cbranch_scc1 L_sf_76
    s_waitcnt vmcnt(2)
    s_bitcmp0_b32 s15, 26
    s_cbranch_scc1 L_sf_76
    s_waitcnt vmcnt(1)
L_sf_76:
    buffer_load_dwordx4 v[144:147], v1, s[52:55], s97 offen offset:2048 nt
    v_mfma_f32_16x16x32_bf16 v[32:35], v[24:27], v[128:131], v[32:35]
    v_and_b32_dpp v28, v17, v20 row_newbcast:12 row_mask:0xf bank_mask:0xf
    v_and_b32_dpp v29, v17, v21 row_newbcast:12 row_mask:0xf bank_mask:0xf
    v_and_b32_dpp v30, v17, v22 row_newbcast:12 row_mask:0xf bank_mask:0xf
    v_and_b32_dpp v31, v17, v23 row_newbcast:12 row_mask:0xf bank_mask:0xf
    s_waitcnt vmcnt(3)
    s_bitcmp0_b32 s14, 27
    s_cbranch_scc1 L_sf_77
    s_waitcnt vmcnt(2)
    s_bitcmp0_b32 s15, 27
    s_cbranch_scc1 L_sf_77
    s_waitcnt vmcnt(1)
L_sf_77:
    buffer_load_dwordx4 v[148:151], v1, s[52:55], s97 offen offset:3072 nt
    s_add_u32 s97, s97, 32768
    v_add_u32 v1, 4096, v1
    v_and_b32 v1, 0x7fff, v1
    v_mfma_f32_16x16x32_bf16 v[32:35], v[28:31], v[132:135], v[32:35]
    v_and_b32_dpp v24, v18, v20 row_newbcast:0 row_mask:0xf bank_mask:0xf
    v_and_b32_dpp v25, v18, v21 row_newbcast:0 row_mask:0xf bank_mask:0xf
    v_and_b32_dpp v26, v18, v22 row_newbcast:0 row_mask:0xf bank_mask:0xf
    v_and_b32_dpp v27, v18, v23 row_newbcast:0 row_mask:0xf bank_mask:0xf
    s_waitcnt vmcnt(3)
    s_bitcmp0_b32 s14, 28
    s_cbranch_scc1 L_sf_78
    s_waitcnt vmcnt(2)
    s_bitcmp0_b32 s15, 28
    s_cbranch_scc1 L_sf_78
    s_waitcnt vmcnt(1)
L_sf_78:
    buffer_load_dwordx4 v[152:155], v1, s[52:55], s97 offen offset:0 nt
    v_mfma_f32_16x16x32_bf16 v[32:35], v[24:27], v[136:139], v[32:35]
    v_and_b32_dpp v28, v18, v20 row_newbcast:8 row_mask:0xf bank_mask:0xf
    v_and_b32_dpp v29, v18, v21 row_newbcast:8 row_mask:0xf bank_mask:0xf
    v_and_b32_dpp v30, v18, v22 row_newbcast:8 row_mask:0xf bank_mask:0xf
    v_and_b32_dpp v31, v18, v23 row_newbcast:8 row_mask:0xf bank_mask:0xf
    s_waitcnt vmcnt(3)
    s_bitcmp0_b32 s14, 29
    s_cbranch_scc1 L_sf_79
    s_waitcnt vmcnt(2)
    s_bitcmp0_b32 s15, 29
    s_cbranch_scc1 L_sf_79
    s_waitcnt vmcnt(1)
L_sf_79:
    buffer_load_dwordx4 v[156:159], v1, s[52:55], s97 offen offset:1024 nt
    v_mfma_f32_16x16x32_bf16 v[32:35], v[28:31], v[140:143], v[32:35]
    v_and_b32_dpp v24, v18, v20 row_newbcast:4 row_mask:0xf bank_mask:0xf
    v_and_b32_dpp v25, v18, v21 row_newbcast:4 row_mask:0xf bank_mask:0xf
    v_and_b32_dpp v26, v18, v22 row_newbcast:4 row_mask:0xf bank_mask:0xf
    v_and_b32_dpp v27, v18, v23 row_newbcast:4 row_mask:0xf bank_mask:0xf
    s_waitcnt vmcnt(3)
    s_bitcmp0_b32 s14, 30
    s_cbranch_scc1 L_sf_80
    s_waitcnt vmcnt(2)
    s_bitcmp0_b32 s15, 30
    s_cbranch_scc1 L_sf_80
    s_waitcnt vmcnt(1)
L_sf_80:
    buffer_load_dwordx4 v[160:163], v1, s[52:55], s97 offen offset:2048 nt
    v_mfma_f32_16x16x32_bf16 v[32:35], v[24:27], v[144:147], v[32:35]
    v_lshrrev_b32 v9, 4, v0
    v_lshl_add_u32 v8, v9, 2, v2
    s_lshl_b32 s96, s3, 9
    s_add_u32 s96, s96, 157824
    v_lshl_add_u32 v8, v8, 2, s96
    v_lshlrev_b32 v9, 3, v0
    v_add_u32 v9, 157824, v9
    v_mov_b32 v10, 162048
    v_mov_b32 v11, 1
    s_lshl_b32 s96, s38, 5
    s_add_u32 s96, s96, 161984
    v_mov_b32 v3, s96
    s_sub_u32 s62, 8, s39
    s_lshl_b32 s98, s34, 5
    s_add_u32 s98, s98, s35
    s_lshl_b32 s98, s98, 8
    s_add_u32 s98, s98, 90112
    v_lshlrev_b32 v39, 2, v0
    v_and_b32_dpp v28, v18, v20 row_newbcast:12 row_mask:0xf bank_mask:0xf
    v_and_b32_dpp v29, v18, v21 row_newbcast:12 row_mask:0xf bank_mask:0xf
    v_and_b32_dpp v30, v18, v22 row_newbcast:12 row_mask:0xf bank_mask:0xf
    v_and_b32_dpp v31, v18, v23 row_newbcast:12 row_mask:0xf bank_mask:0xf
    s_waitcnt vmcnt(3)
    s_bitcmp0_b32 s14, 31
    s_cbranch_scc1 L_sf_81
    s_waitcnt vmcnt(2)
    s_bitcmp0_b32 s15, 31
    s_cbranch_scc1 L_sf_81
    s_waitcnt vmcnt(1)
L_sf_81:
    buffer_load_dwordx4 v[164:167], v1, s[52:55], s97 offen offset:3072 nt
    s_mov_b32 s97, 0
    v_add_u32 v1, 4096, v1
    v_and_b32 v1, 0x7fff, v1
    v_mfma_f32_16x16x32_bf16 v[32:35], v[28:31], v[148:151], v[32:35]
    s_cmp_eq_u32 s12, -1
    s_cbranch_scc1 L_v_nopf
    v_and_b32_dpp v24, v19, v20 row_newbcast:0 row_mask:0xf bank_mask:0xf
    v_and_b32_dpp v25, v19, v21 row_newbcast:0 row_mask:0xf bank_mask:0xf
    v_and_b32_dpp v26, v19, v22 row_newbcast:0 row_mask:0xf bank_mask:0xf
    v_and_b32_dpp v27, v19, v23 row_newbcast:0 row_mask:0xf bank_mask:0xf
    s_waitcnt vmcnt(3)
    s_nop 0
    v_mfma_f32_16x16x32_bf16 v[32:35], v[24:27], v[152:155], v[32:35]
    v_and_b32_dpp v28, v19, v20 row_newbcast:8 row_mask:0xf bank_mask:0xf
    v_and_b32_dpp v29, v19, v21 row_newbcast:8 row_mask:0xf bank_mask:0xf
    v_and_b32_dpp v30, v19, v22 row_newbcast:8 row_mask:0xf bank_mask:0xf
    v_and_b32_dpp v31, v19, v23 row_newbcast:8 row_mask:0xf bank_mask:0xf
    s_waitcnt vmcnt(2)
    s_nop 0
    v_mfma_f32_16x16x32_bf16 v[32:35], v[28:31], v[156:159], v[32:35]
    v_and_b32_dpp v24, v19, v20 row_newbcast:4 row_mask:0xf bank_mask:0xf
    v_and_b32_dpp v25, v19, v21 row_newbcast:4 row_mask:0xf bank_mask:0xf
    v_and_b32_dpp v26, v19, v22 row_newbcast:4 row_mask:0xf bank_mask:0xf
    v_and_b32_dpp v27, v19, v23 row_newbcast:4 row_mask:0xf bank_mask:0xf
    s_waitcnt vmcnt(1)
    s_nop 0
    v_mfma_f32_16x16x32_bf16 v[32:35], v[24:27], v[160:163], v[32:35]
    v_and_b32_dpp v28, v19, v20 row_newbcast:12 row_mask:0xf bank_mask:0xf
    v_and_b32_dpp v29, v19, v21 row_newbcast:12 row_mask:0xf bank_mask:0xf
    v_and_b32_dpp v30, v19, v22 row_newbcast:12 row_mask:0xf bank_mask:0xf
    v_and_b32_dpp v31, v19, v23 row_newbcast:12 row_mask:0xf bank_mask:0xf
    s_waitcnt vmcnt(0)
    s_nop 0
    v_mfma_f32_16x16x32_bf16 v[32:35], v[28:31], v[164:167], v[32:35]
L_v_join:
    s_cmp_lg_u32 s13, 0
    s_cbranch_scc1 L_jobend
L_t0:
    s_mov_b32 exec_hi, 0
    s_nop 4
    ds_write_b128 v8, v[32:35]
L_t0b:
    s_mov_b64 exec, 1
    ds_add_rtn_u32 v37, v10, v11
    s_mov_b64 exec, -1
    ds_read_b32 v38, v10 offset:24
    ds_read_b128 v[24:27], v3
    ds_read_b128 v[28:31], v3 offset:16
    ds_read_b64 v[144:145], v9 offset:0
    ds_read_b64 v[146:147], v9 offset:512
    ds_read_b64 v[148:149], v9 offset:1024
    ds_read_b64 v[150:151], v9 offset:1536
    ds_read_b64 v[152:153], v9 offset:2048
    ds_read_b64 v[154:155], v9 offset:2560
    ds_read_b64 v[156:157], v9 offset:3072
    ds_read_b64 v[158:159], v9 offset:3584
    s_waitcnt lgkmcnt(10)
    v_readfirstlane_b32 s96, v37
    v_readfirstlane_b32 s61, v38
    s_cmp_lg_u32 s96, s62
    s_cbranch_scc1 L_nopub
    s_waitcnt lgkmcnt(6)
    v_pk_mul_f32 v[144:145], v[144:145], v[24:25] op_sel:[0,0] op_sel_hi:[1,0]
    v_pk_mul_f32 v[146:147], v[146:147], v[24:25] op_sel:[0,1] op_sel_hi:[1,1]
    s_waitcnt lgkmcnt(4)
    v_pk_fma_f32 v[144:145], v[148:149], v[26:27], v[144:145] op_sel:[0,0,0] op_sel_hi:[1,0,1]
    v_pk_fma_f32 v[146:147], v[150:151], v[26:27], v[146:147] op_sel:[0,1,0] op_sel_hi:[1,1,1]
    s_waitcnt lgkmcnt(2)
    v_pk_fma_f32 v[144:145], v[152:153], v[28:29], v[144:145] op_sel:[0,0,0] op_sel_hi:[1,0,1]
    v_pk_fma_f32 v[146:147], v[154:155], v[28:29], v[146:147] op_sel:[0,1,0] op_sel_hi:[1,1,1]
    s_waitcnt lgkmcnt(0)
    v_pk_fma_f32 v[144:145], v[156:157], v[30:31], v[144:145] op_sel:[0,0,0] op_sel_hi:[1,0,1]
    v_pk_fma_f32 v[146:147], v[158:159], v[30:31], v[146:147] op_sel:[0,1,0] op_sel_hi:[1,1,1]
    s_cmp_eq_u32 s61, 1
    v_pk_add_f32 v[144:145], v[144:145], v[146:147]
    v_cvt_pk_bf16_f32 v32, v144, v145
    s_cbranch_scc0 L_oslow
    buffer_store_dword v32, v39, s[40:43], s98 offen
L_odone:
L_nopub:
    s_cmp_eq_u32 s59, 0
    s_cbranch_scc1 L_not1
L_poll_90:
    buffer_load_dwordx4 v[16:19], v105, s[40:43], s100 offen sc1
    s_waitcnt vmcnt(0)
    v_max3_u32 v38, v16, v17, v18
    v_max_u32 v38, v38, v19
    v_cmp_eq_u32 vcc, -1, v38
    s_cbranch_vccz L_poll_90e
    s_sub_u32 s60, s60, 1
    s_cbranch_scc0 L_poll_90
    s_mov_b32 s60, 0
L_poll_90e:
    v_mfma_f32_16x16x32_bf16 v[112:115], v[16:19], v[72:75], 0
    v_mfma_f32_16x16x32_bf16 v[128:131], v[16:19], v[88:91], 0
    v_mfma_f32_16x16x32_bf16 v[116:119], v[16:19], v[76:79], 0
    v_mfma_f32_16x16x32_bf16 v[132:135], v[16:19], v[92:95], 0
    v_mfma_f32_16x16x32_bf16 v[120:123], v[16:19], v[80:83], 0
    v_mfma_f32_16x16x32_bf16 v[136:139], v[16:19], v[96:99], 0
    v_mfma_f32_16x16x32_bf16 v[124:127], v[16:19], v[84:87], 0
    v_mfma_f32_16x16x32_bf16 v[140:143], v[16:19], v[100:103], 0
    s_nop 0
    v_pk_add_f32 v[112:113], v[112:113], v[114:115]
    v_pk_add_f32 v[128:129], v[128:129], v[130:131]
    v_pk_add_f32 v[116:117], v[116:117], v[118:119]
    v_pk_add_f32 v[132:133], v[132:133], v[134:135]
    v_add_f32_dpp v12, v113, v112 row_ror:8 row_mask:0xf bank_mask:0x3
    v_add_f32_dpp v12, v128, v129 row_ror:8 row_mask:0xf bank_mask:0xc
    ds_write_b32 v106, v12 offset:0
    v_pk_add_f32 v[120:121], v[120:121], v[122:123]
    v_pk_add_f32 v[136:137], v[136:137], v[138:139]
    v_add_f32_dpp v13, v117, v116 row_ror:8 row_mask:0xf bank_mask:0x3
    v_add_f32_dpp v13, v132, v133 row_ror:8 row_mask:0xf bank_mask:0xc
    ds_write_b32 v106, v13 offset:32
    v_pk_add_f32 v[124:125], v[124:125], v[126:127]
    v_pk_add_f32 v[140:141], v[140:141], v[142:143]
    v_add_f32_dpp v14, v121, v120 row_ror:8 row_mask:0xf bank_mask:0x3
    v_add_f32_dpp v14, v136, v137 row_ror:8 row_mask:0xf bank_mask:0xc
    ds_write_b32 v106, v14 offset:64
    v_add_f32_dpp v15, v125, v124 row_ror:8 row_mask:0xf bank_mask:0x3
    v_add_f32_dpp v15, v140, v141 row_ror:8 row_mask:0xf bank_mask:0xc
    ds_write_b32 v106, v15 offset:96
    s_mov_b64 exec, 1
    ds_add_rtn_u32 v37, v10, v11 offset:4
    s_mov_b64 exec, -1
    ds_read_b128 v[72:75], v107 offset:0
    ds_read_b128 v[76:79], v107 offset:8192
    ds_read_b128 v[80:83], v107 offset:16384
    ds_read_b128 v[84:87], v107 offset:24576
    ds_read_b128 v[88:91], v107 offset:32768
    ds_read_b128 v[92:95], v107 offset:40960
    ds_read_b128 v[96:99], v107 offset:49152
    ds_read_b128 v[100:103], v107 offset:57344
    s_waitcnt lgkmcnt(8)
    v_readfirstlane_b32 s96, v37
    s_nop 0
    s_cmp_lg_u32 s96, 7
    s_cbranch_scc1 L_not1
    s_waitcnt lgkmcnt(6)
    v_pk_add_f32 v[72:73], v[72:73], v[76:77]
    v_pk_add_f32 v[74:75], v[74:75], v[78:79]
    s_waitcnt lgkmcnt(4)
    v_pk_add_f32 v[80:81], v[80:81], v[84:85]
    v_pk_add_f32 v[82:83], v[82:83], v[86:87]
    v_pk_add_f32 v[72:73], v[72:73], v[80:81]
    v_pk_add_f32 v[74:75], v[74:75], v[82:83]
    s_waitcnt lgkmcnt(2)
    v_pk_add_f32 v[88:89], v[88:89], v[92:93]
    v_pk_add_f32 v[90:91], v[90:91], v[94:95]
    v_pk_add_f32 v[72:73], v[72:73], v[88:89]
    v_pk_add_f32 v[74:75], v[74:75], v[90:91]
    s_waitcnt lgkmcnt(0)
    v_pk_add_f32 v[96:97], v[96:97], v[100:101]
    v_pk_add_f32 v[98:99], v[98:99], v[102:103]
    v_pk_add_f32 v[72:73], v[72:73], v[96:97]
    v_pk_add_f32 v[74:75], v[74:75], v[98:99]
    v_cvt_pk_bf16_f32 v12, v72, v73
    v_cvt_pk_bf16_f32 v13, v74, v75
    buffer_store_dwordx2 v[12:13], v108, s[40:43], s101 offen sc1
L_not1:
    s_waitcnt lgkmcnt(0)
    s_cmp_eq_u32 s39, 1
    s_cbranch_scc1 L_s_role
    s_endpgm
L_k_nopf:
    s_waitcnt vmcnt(3)
    s_bitcmp0_b32 s57, 22
    s_cbranch_scc1 L_sf_46
    s_waitcnt vmcnt(2)
    s_bitcmp0_b32 s58, 22
    s_cbranch_scc1 L_sf_46
    s_waitcnt vmcnt(1)
L_sf_46:
    buffer_load_dwordx4 v[128:131], v1, s[48:51], s97 offen offset:2048 nt
    v_min_u32 v39, 29, v0
    v_lshlrev_b32 v39, 2, v39
    buffer_load_dword v37, v39, s[44:47], 0 offen sc1
    s_waitcnt vmcnt(4)
    s_bitcmp0_b32 s57, 23
    s_cbranch_scc1 L_sf_47
    s_waitcnt vmcnt(3)
    s_bitcmp0_b32 s58, 23
    s_cbranch_scc1 L_sf_47
    s_waitcnt vmcnt(2)
L_sf_47:
    buffer_load_dwordx4 v[132:135], v1, s[48:51], s97 offen offset:3072 nt
    s_add_u32 s97, s97, 32768
    v_add_u32 v1, 4096, v1
    v_and_b32 v1, 0x7fff, v1
    s_waitcnt vmcnt(4)
    s_bitcmp0_b32 s57, 24
    s_cbranch_scc1 L_sf_48
    s_waitcnt vmcnt(3)
    s_bitcmp0_b32 s58, 24
    s_cbranch_scc1 L_sf_48
    s_waitcnt vmcnt(2)
L_sf_48:
    buffer_load_dwordx4 v[136:139], v1, s[48:51], s97 offen offset:0 nt
    s_waitcnt vmcnt(4)
    s_bitcmp0_b32 s57, 25
    s_cbranch_scc1 L_sf_49
    s_waitcnt vmcnt(3)
    s_bitcmp0_b32 s58, 25
    s_cbranch_scc1 L_sf_49
    s_waitcnt vmcnt(1)
L_sf_49:
    buffer_load_dwordx4 v[140:143], v1, s[48:51], s97 offen offset:1024 nt
    s_waitcnt vmcnt(4)
    s_bitcmp0_b32 s57, 26
    s_cbranch_scc1 L_sf_50
    s_waitcnt vmcnt(2)
    s_bitcmp0_b32 s58, 26
    s_cbranch_scc1 L_sf_50
    s_waitcnt vmcnt(1)
L_sf_50:
    buffer_load_dwordx4 v[144:147], v1, s[48:51], s97 offen offset:2048 nt
    s_waitcnt vmcnt(3)
    s_bitcmp0_b32 s57, 27
    s_cbranch_scc1 L_sf_51
    s_waitcnt vmcnt(2)
    s_bitcmp0_b32 s58, 27
    s_cbranch_scc1 L_sf_51
    s_waitcnt vmcnt(1)
L_sf_51:
    buffer_load_dwordx4 v[148:151], v1, s[48:51], s97 offen offset:3072 nt
    s_add_u32 s97, s97, 32768
    v_add_u32 v1, 4096, v1
    v_and_b32 v1, 0x7fff, v1
    v_cmp_eq_u32 vcc, 0, v37
    s_nop 0
    s_or_b32 s96, vcc_lo, vcc_hi
    buffer_load_dwordx4 v[4:7], v2, s[40:43], s98 offen sc1
    s_waitcnt vmcnt(4)
    s_bitcmp0_b32 s57, 28
    s_cbranch_scc1 L_sf_52
    s_waitcnt vmcnt(3)
    s_bitcmp0_b32 s58, 28
    s_cbranch_scc1 L_sf_52
    s_waitcnt vmcnt(2)
L_sf_52:
    buffer_load_dwordx4 v[152:155], v1, s[48:51], s97 offen offset:0 nt
    s_waitcnt vmcnt(4)
    s_bitcmp0_b32 s57, 29
    s_cbranch_scc1 L_sf_53
    s_waitcnt vmcnt(3)
    s_bitcmp0_b32 s58, 29
    s_cbranch_scc1 L_sf_53
    s_waitcnt vmcnt(2)
L_sf_53:
    buffer_load_dwordx4 v[156:159], v1, s[48:51], s97 offen offset:1024 nt
    s_waitcnt vmcnt(4)
    s_bitcmp0_b32 s57, 30
    s_cbranch_scc1 L_sf_54
    s_waitcnt vmcnt(3)
    s_bitcmp0_b32 s58, 30
    s_cbranch_scc1 L_sf_54
    s_waitcnt vmcnt(1)
L_sf_54:
    buffer_load_dwordx4 v[160:163], v1, s[48:51], s97 offen offset:2048 nt
    s_waitcnt vmcnt(4)
    s_bitcmp0_b32 s57, 31
    s_cbranch_scc1 L_sf_55
    s_waitcnt vmcnt(2)
    s_bitcmp0_b32 s58, 31
    s_cbranch_scc1 L_sf_55
    s_waitcnt vmcnt(1)
L_sf_55:
    buffer_load_dwordx4 v[164:167], v1, s[48:51], s97 offen offset:3072 nt
    s_mov_b32 s97, 0
    v_add_u32 v1, 4096, v1
    v_and_b32 v1, 0x7fff, v1
    v_add_u32 v1, 8192, v1
    v_and_b32 v1, 0x7fff, v1
    s_mov_b32 s97, 65536
    s_branch L_k_join
L_v_nopf:
    v_and_b32_dpp v24, v19, v20 row_newbcast:0 row_mask:0xf bank_mask:0xf
    v_and_b32_dpp v25, v19, v21 row_newbcast:0 row_mask:0xf bank_mask:0xf
    v_and_b32_dpp v26, v19, v22 row_newbcast:0 row_mask:0xf bank_mask:0xf
    v_and_b32_dpp v27, v19, v23 row_newbcast:0 row_mask:0xf bank_mask:0xf
    s_waitcnt vmcnt(3)
    s_bitcmp0_b32 s14, 0
    s_cbranch_scc1 L_sf_82
    s_waitcnt vmcnt(2)
    s_bitcmp0_b32 s15, 0
    s_cbranch_scc1 L_sf_82
    s_waitcnt vmcnt(1)
L_sf_82:
    buffer_load_dwordx4 v[40:43], v1, s[52:55], s97 offen offset:0 nt
    v_mfma_f32_16x16x32_bf16 v[32:35], v[24:27], v[152:155], v[32:35]
    v_and_b32_dpp v28, v19, v20 row_newbcast:8 row_mask:0xf bank_mask:0xf
    v_and_b32_dpp v29, v19, v21 row_newbcast:8 row_mask:0xf bank_mask:0xf
    v_and_b32_dpp v30, v19, v22 row_newbcast:8 row_mask:0xf bank_mask:0xf
    v_and_b32_dpp v31, v19, v23 row_newbcast:8 row_mask:0xf bank_mask:0xf
    s_waitcnt vmcnt(3)
    s_bitcmp0_b32 s14, 1
    s_cbranch_scc1 L_sf_83
    s_waitcnt vmcnt(2)
    s_bitcmp0_b32 s15, 1
    s_cbranch_scc1 L_sf_83
    s_waitcnt vmcnt(1)
L_sf_83:
    buffer_load_dwordx4 v[44:47], v1, s[52:55], s97 offen offset:1024 nt
    v_mfma_f32_16x16x32_bf16 v[32:35], v[28:31], v[156:159], v[32:35]
    v_and_b32_dpp v24, v19, v20 row_newbcast:4 row_mask:0xf bank_mask:0xf
    v_and_b32_dpp v25, v19, v21 row_newbcast:4 row_mask:0xf bank_mask:0xf
    v_and_b32_dpp v26, v19, v22 row_newbcast:4 row_mask:0xf bank_mask:0xf
    v_and_b32_dpp v27, v19, v23 row_newbcast:4 row_mask:0xf bank_mask:0xf
    s_waitcnt vmcnt(3)
    s_bitcmp0_b32 s14, 2
    s_cbranch_scc1 L_sf_84
    s_waitcnt vmcnt(2)
    s_bitcmp0_b32 s15, 2
    s_cbranch_scc1 L_sf_84
    s_waitcnt vmcnt(1)
L_sf_84:
    buffer_load_dwordx4 v[48:51], v1, s[52:55], s97 offen offset:2048 nt
    v_mfma_f32_16x16x32_bf16 v[32:35], v[24:27], v[160:163], v[32:35]
    v_and_b32_dpp v28, v19, v20 row_newbcast:12 row_mask:0xf bank_mask:0xf
    v_and_b32_dpp v29, v19, v21 row_newbcast:12 row_mask:0xf bank_mask:0xf
    v_and_b32_dpp v30, v19, v22 row_newbcast:12 row_mask:0xf bank_mask:0xf
    v_and_b32_dpp v31, v19, v23 row_newbcast:12 row_mask:0xf bank_mask:0xf
    s_waitcnt vmcnt(3)
    s_bitcmp0_b32 s14, 3
    s_cbranch_scc1 L_sf_85
    s_waitcnt vmcnt(2)
    s_bitcmp0_b32 s15, 3
    s_cbranch_scc1 L_sf_85
    s_waitcnt vmcnt(1)
L_sf_85:
    buffer_load_dwordx4 v[52:55], v1, s[52:55], s97 offen offset:3072 nt
    s_add_u32 s97, s97, 32768
    v_add_u32 v1, 4096, v1
    v_and_b32 v1, 0x7fff, v1
    v_mfma_f32_16x16x32_bf16 v[32:35], v[28:31], v[164:167], v[32:35]
    v_and_b32_dpp v24, v12, v20 row_newbcast:0 row_mask:0xf bank_mask:0xf
    v_and_b32_dpp v25, v12, v21 row_newbcast:0 row_mask:0xf bank_mask:0xf
    v_and_b32_dpp v26, v12, v22 row_newbcast:0 row_mask:0xf bank_mask:0xf
    v_and_b32_dpp v27, v12, v23 row_newbcast:0 row_mask:0xf bank_mask:0xf
    s_waitcnt vmcnt(3)
    s_bitcmp0_b32 s14, 4
    s_cbranch_scc1 L_sf_86
    s_waitcnt vmcnt(2)
    s_bitcmp0_b32 s15, 4
    s_cbranch_scc1 L_sf_86
    s_waitcnt vmcnt(1)
L_sf_86:
    buffer_load_dwordx4 v[56:59], v1, s[52:55], s97 offen offset:0 nt
    v_mfma_f32_16x16x32_bf16 v[32:35], v[24:27], v[40:43], v[32:35]
    v_and_b32_dpp v28, v12, v20 row_newbcast:8 row_mask:0xf bank_mask:0xf
    v_and_b32_dpp v29, v12, v21 row_newbcast:8 row_mask:0xf bank_mask:0xf
    v_and_b32_dpp v30, v12, v22 row_newbcast:8 row_mask:0xf bank_mask:0xf
    v_and_b32_dpp v31, v12, v23 row_newbcast:8 row_mask:0xf bank_mask:0xf
    s_waitcnt vmcnt(3)
    s_bitcmp0_b32 s14, 5
    s_cbranch_scc1 L_sf_87
    s_waitcnt vmcnt(2)
    s_bitcmp0_b32 s15, 5
    s_cbranch_scc1 L_sf_87
    s_waitcnt vmcnt(1)
L_sf_87:
    buffer_load_dwordx4 v[60:63], v1, s[52:55], s97 offen offset:1024 nt
    v_mfma_f32_16x16x32_bf16 v[32:35], v[28:31], v[44:47], v[32:35]
    v_and_b32_dpp v24, v12, v20 row_newbcast:4 row_mask:0xf bank_mask:0xf
    v_and_b32_dpp v25, v12, v21 row_newbcast:4 row_mask:0xf bank_mask:0xf
    v_and_b32_dpp v26, v12, v22 row_newbcast:4 row_mask:0xf bank_mask:0xf
    v_and_b32_dpp v27, v12, v23 row_newbcast:4 row_mask:0xf bank_mask:0xf
    s_waitcnt vmcnt(3)
    s_bitcmp0_b32 s14, 6
    s_cbranch_scc1 L_sf_88
    s_waitcnt vmcnt(2)
    s_bitcmp0_b32 s15, 6
    s_cbranch_scc1 L_sf_88
    s_waitcnt vmcnt(1)
L_sf_88:
    buffer_load_dwordx4 v[64:67], v1, s[52:55], s97 offen offset:2048 nt
    v_mfma_f32_16x16x32_bf16 v[32:35], v[24:27], v[48:51], v[32:35]
    v_and_b32_dpp v28, v12, v20 row_newbcast:12 row_mask:0xf bank_mask:0xf
    v_and_b32_dpp v29, v12, v21 row_newbcast:12 row_mask:0xf bank_mask:0xf
    v_and_b32_dpp v30, v12, v22 row_newbcast:12 row_mask:0xf bank_mask:0xf
    v_and_b32_dpp v31, v12, v23 row_newbcast:12 row_mask:0xf bank_mask:0xf
    s_waitcnt vmcnt(3)
    s_bitcmp0_b32 s14, 7
    s_cbranch_scc1 L_sf_89
    s_waitcnt vmcnt(2)
    s_bitcmp0_b32 s15, 7
    s_cbranch_scc1 L_sf_89
    s_waitcnt vmcnt(1)
L_sf_89:
    buffer_load_dwordx4 v[68:71], v1, s[52:55], s97 offen offset:3072 nt
    s_add_u32 s97, s97, 32768
    v_add_u32 v1, 4096, v1
    v_and_b32 v1, 0x7fff, v1
    v_mfma_f32_16x16x32_bf16 v[32:35], v[28:31], v[52:55], v[32:35]
    v_and_b32_dpp v24, v13, v20 row_newbcast:0 row_mask:0xf bank_mask:0xf
    v_and_b32_dpp v25, v13, v21 row_newbcast:0 row_mask:0xf bank_mask:0xf
    v_and_b32_dpp v26, v13, v22 row_newbcast:0 row_mask:0xf bank_mask:0xf
    v_and_b32_dpp v27, v13, v23 row_newbcast:0 row_mask:0xf bank_mask:0xf
    s_waitcnt vmcnt(3)
    s_nop 0
    v_mfma_f32_16x16x32_bf16 v[32:35], v[24:27], v[56:59], v[32:35]
    v_and_b32_dpp v28, v13, v20 row_newbcast:8 row_mask:0xf bank_mask:0xf
    v_and_b32_dpp v29, v13, v21 row_newbcast:8 row_mask:0xf bank_mask:0xf
    v_and_b32_dpp v30, v13, v22 row_newbcast:8 row_mask:0xf bank_mask:0xf
    v_and_b32_dpp v31, v13, v23 row_newbcast:8 row_mask:0xf bank_mask:0xf
    s_waitcnt vmcnt(2)
    s_nop 0
    v_mfma_f32_16x16x32_bf16 v[32:35], v[28:31], v[60:63], v[32:35]
    v_and_b32_dpp v24, v13, v20 row_newbcast:4 row_mask:0xf bank_mask:0xf
    v_and_b32_dpp v25, v13, v21 row_newbcast:4 row_mask:0xf bank_mask:0xf
    v_and_b32_dpp v26, v13, v22 row_newbcast:4 row_mask:0xf bank_mask:0xf
    v_and_b32_dpp v27, v13, v23 row_newbcast:4 row_mask:0xf bank_mask:0xf
    s_waitcnt vmcnt(1)
    s_nop 0
    v_mfma_f32_16x16x32_bf16 v[32:35], v[24:27], v[64:67], v[32:35]
    v_and_b32_dpp v28, v13, v20 row_newbcast:12 row_mask:0xf bank_mask:0xf
    v_and_b32_dpp v29, v13, v21 row_newbcast:12 row_mask:0xf bank_mask:0xf
    v_and_b32_dpp v30, v13, v22 row_newbcast:12 row_mask:0xf bank_mask:0xf
    v_and_b32_dpp v31, v13, v23 row_newbcast:12 row_mask:0xf bank_mask:0xf
    s_waitcnt vmcnt(0)
    s_nop 0
    v_mfma_f32_16x16x32_bf16 v[32:35], v[28:31], v[68:71], v[32:35]
    s_branch L_v_join
L_oslow:
    buffer_store_dword v32, v39, s[40:43], s98 offen sc1
    s_branch L_odone
L_qslow:
L_wy_91:
    buffer_load_dword v37, v39, s[44:47], 0 offen sc1
    s_waitcnt vmcnt(0)
    v_cmp_ne_u32 vcc, -1, v37
    s_cbranch_vccz L_wy_91e
    s_sleep 4
    s_sub_u32 s60, s60, 1
    s_cbranch_scc0 L_wy_91
    s_mov_b32 s60, 0
L_wy_91e:
L_qslow2:
L_poll_92:
    buffer_load_dwordx4 v[4:7], v2, s[40:43], s98 offen sc1
    s_waitcnt vmcnt(0)
    v_max3_u32 v38, v4, v5, v6
    v_max_u32 v38, v38, v7
    v_cmp_eq_u32 vcc, -1, v38
    s_cbranch_vccz L_poll_92e
    s_sleep 2
    s_sub_u32 s60, s60, 1
    s_cbranch_scc0 L_poll_92
    s_mov_b32 s60, 0
L_poll_92e:
    s_branch L_qok
L_mljob:
    s_lshl_b32 s96, s38, 3
    s_add_u32 s96, s96, s3
    s_lshl3_add_u32 s96, s96, s99
    buffer_store_dwordx2 v[8:9], v36, s[40:43], s96 offen sc1
    s_branch L_mldone
L_service:
    s_mov_b32 s59, 0
    v_mov_b32 v5, 0
    v_mov_b32 v105, 0
    v_mov_b32 v108, 0
    v_mov_b32 v160, 0
    v_mov_b32 v8, 162068
L_lw_93:
    ds_read_b32 v9, v8
    s_waitcnt lgkmcnt(0)
    v_cmp_gt_u32 vcc, 8, v9
    s_cbranch_vccz L_lw_93e
    s_sleep 8
    s_sub_u32 s60, s60, 1
    s_cbranch_scc0 L_lw_93
    s_mov_b32 s60, 0
L_lw_93e:
    v_and_b32 v2, 15, v0
    v_lshlrev_b32 v2, 3, v2
    v_add_u32 v3, 161920, v2
    ds_read_b64 v[8:9], v3
    s_lshl_b32 s99, s37, 5
    s_add_u32 s99, s99, s36
    s_lshl_b32 s99, s99, 7
    s_add_u32 s99, s99, 73728
    s_lshl_b32 s62, s38, 6
    s_add_u32 s62, s62, s99
    s_getreg_b32 s58, hwreg(HW_REG_XCC_ID, 0, 4)
    v_mov_b32 v10, s58
    s_lshl_b32 s98, s34, 5
    s_add_u32 s98, s98, s35
    s_lshl_b32 s63, s98, 2
    s_add_u32 s63, s63, 229376
    s_lshl_b32 s98, s98, 8
    s_add_u32 s98, s98, 90112
    v_lshlrev_b32 v39, 2, v0
    s_bfm_b64 exec, 8, 0
    s_waitcnt lgkmcnt(0)
    buffer_store_dwordx2 v[8:9], v2, s[40:43], s62 offen sc1
    s_mov_b64 exec, 1
    buffer_store_dword v10, v36, s[40:43], s63 offen sc1
    s_mov_b64 exec, -1
    v_mov_b32 v12, 162076
L_lw_94:
    ds_read_b32 v13, v12
    s_waitcnt lgkmcnt(0)
    v_cmp_gt_u32 vcc, 4, v13
    s_cbranch_vccz L_lw_94e
    s_sleep 4
    s_sub_u32 s60, s60, 1
    s_cbranch_scc0 L_lw_94
    s_mov_b32 s60, 0
L_lw_94e:
    v_and_b32 v11, 31, v0
    v_lshlrev_b32 v11, 2, v11
    s_lshl_b32 s63, s34, 7
    s_add_u32 s63, s63, 229376
    buffer_load_dword v12, v39, s[40:43], s98 offen sc1
L_poll_95:
    buffer_load_dwordx2 v[8:9], v2, s[40:43], s99 offen sc1
    buffer_load_dword v10, v11, s[40:43], s63 offen sc1
    s_waitcnt vmcnt(0)
    v_max3_u32 v38, v8, v9, v10
    v_cmp_eq_u32 vcc, -1, v38
    s_cbranch_vccz L_poll_95e
    s_sleep 16
    s_sub_u32 s60, s60, 1
    s_cbranch_scc0 L_poll_95
    s_mov_b32 s60, 0
L_poll_95e:
    v_mov_b32 v37, v8
    s_nop 1
    v_max_f32_dpp v37, v37, v37 quad_perm:[1,0,3,2] row_mask:0xf bank_mask:0xf
    s_nop 1
    v_max_f32_dpp v37, v37, v37 quad_perm:[2,3,0,1] row_mask:0xf bank_mask:0xf
    s_nop 1
    v_max_f32_dpp v37, v37, v37 row_ror:4 row_mask:0xf bank_mask:0xf
    s_nop 1
    v_max_f32_dpp v37, v37, v37 row_ror:8 row_mask:0xf bank_mask:0xf
    v_sub_f32 v8, v8, v37
    v_exp_f32 v8, v8
    s_nop 0
    v_mul_f32 v9, v8, v9
    s_nop 1
    v_add_f32_dpp v9, v9, v9 quad_perm:[1,0,3,2] row_mask:0xf bank_mask:0xf
    s_nop 1
    v_add_f32_dpp v9, v9, v9 quad_perm:[2,3,0,1] row_mask:0xf bank_mask:0xf
    s_nop 1
    v_add_f32_dpp v9, v9, v9 row_ror:4 row_mask:0xf bank_mask:0xf
    s_nop 1
    v_add_f32_dpp v9, v9, v9 row_ror:8 row_mask:0xf bank_mask:0xf
    s_getreg_b32 s62, hwreg(HW_REG_XCC_ID, 0, 4)
    v_cmp_ne_u32 vcc, s62, v10
    s_nop 0
    s_cmp_eq_u64 vcc, 0
    s_cselect_b32 s61, 1, 0
    v_rcp_f32 v9, v9
    v_lshrrev_b32 v3, 1, v2
    v_add_u32 v3, 161984, v3
    v_mul_f32 v8, v8, v9
    v_mov_b32 v10, 162072
    v_mov_b32 v11, s61
    ds_write_b32 v3, v8
    ds_write_b32 v10, v11
    s_mov_b32 s3, 1
    v_lshrrev_b32 v9, 4, v0
    v_lshl_add_u32 v8, v9, 2, v2
    s_lshl_b32 s96, s3, 9
    s_add_u32 s96, s96, 157824
    v_lshl_add_u32 v8, v8, 2, s96
    v_lshlrev_b32 v9, 3, v0
    v_add_u32 v9, 157824, v9
    v_mov_b32 v10, 162048
    v_mov_b32 v11, 1
    s_lshl_b32 s96, s38, 5
    s_add_u32 s96, s96, 161984
    v_mov_b32 v3, s96
    s_sub_u32 s62, 8, s39
    s_lshl_b32 s98, s34, 5
    s_add_u32 s98, s98, s35
    s_lshl_b32 s98, s98, 8
    s_add_u32 s98, s98, 90112
    v_lshlrev_b32 v39, 2, v0
    s_branch L_t0b
L_jobend:
    v_lshrrev_b32 v9, 4, v0
    v_lshl_add_u32 v9, v9, 2, v2
    v_lshlrev_b32 v9, 2, v9
    s_mov_b32 exec_hi, 0
    s_nop 1
    buffer_store_dwordx4 v[32:35], v9, s[40:43], s13 offen sc1
    s_endpgm
L_proxy:
    v_mov_b32 v5, 0
    v_mov_b32 v105, 0
    v_mov_b32 v108, 0
    v_mov_b32 v160, 0
    s_barrier
    s_sub_u32 s97, 7, s3
    s_mul_i32 s97, s97, 27
    s_cmp_eq_u32 s3, 5
    s_cselect_b32 s97, 32, s97
    s_add_u32 s97, s97, s35
    s_lshl_b32 s97, s97, 9
    s_add_u32 s97, s97, 196608
    v_and_b32 v2, 15, v0
    v_lshlrev_b32 v2, 3, v2
    v_bfe_u32 v20, v0, 4, 1
    v_lshl_add_u32 v20, v20, 2, v2
    v_lshlrev_b32 v20, 2, v20
    s_cmp_lg_u32 s3, 7
    s_cbranch_scc1 L_px6
    s_sub_u32 s96, 6, s59
    v_mov_b32 v8, 162068
L_lw_96:
    ds_read_b32 v9, v8
    s_waitcnt lgkmcnt(0)
    v_cmp_gt_u32 vcc, s96, v9
    s_cbranch_vccz L_lw_96e
    s_sleep 8
    s_sub_u32 s60, s60, 1
    s_cbranch_scc0 L_lw_96
    s_mov_b32 s60, 0
L_lw_96e:
    v_and_b32 v2, 15, v0
    v_lshlrev_b32 v2, 3, v2
    v_add_u32 v3, 161920, v2
    ds_read_b64 v[8:9], v3
    s_lshl_b32 s99, s37, 5
    s_add_u32 s99, s99, s36
    s_lshl_b32 s99, s99, 7
    s_add_u32 s99, s99, 73728
    s_lshl_b32 s62, s38, 6
    s_add_u32 s62, s62, s99
    s_getreg_b32 s58, hwreg(HW_REG_XCC_ID, 0, 4)
    v_mov_b32 v10, s58
    s_lshl_b32 s98, s34, 5
    s_add_u32 s98, s98, s35
    s_lshl_b32 s63, s98, 2
    s_add_u32 s63, s63, 229376
    s_lshl_b32 s98, s98, 8
    s_add_u32 s98, s98, 90112
    v_lshlrev_b32 v39, 2, v0
    s_bfm_b64 exec, s96, 0
    s_waitcnt lgkmcnt(0)
    buffer_store_dwordx2 v[8:9], v2, s[40:43], s62 offen sc1
    s_mov_b64 exec, 1
    buffer_store_dword v10, v36, s[40:43], s63 offen sc1
    s_mov_b64 exec, -1
    s_mov_b32 s100, 4
    s_lshl_b32 s63, s100, 8
    v_and_b32 v8, 15, v0
    v_lshl_add_u32 v8, v8, 4, s63
    v_lshrrev_b32 v9, 4, v0
    v_mul_u32_u24 v5, 1280, v9
    v_add_u32 v5, v5, v8
    v_mul_u32_u24 v4, 1296, v9
    v_add_u32 v4, v4, v8
    v_add_u32 v4, 81920, v4
    v_lshlrev_b32 v6, 1, v5
    v_add_u32 v6, 87104, v6
    s_lshl_b32 s62, s100, 3
    s_add_u32 s62, s62, 97344
    v_lshl_add_u32 v7, v9, 6, s62
    s_mov_b32 s48, s4
    s_mov_b32 s49, s5
    s_mov_b32 s50, 5120
    s_mov_b32 s51, 0x20000
    buffer_load_dwordx4 v[8:11], v5, s[48:51], 0 offen
    s_mov_b32 s62, 20480
    s_mov_b32 s63, 30720
L_poll_97:
    buffer_load_dwordx4 v[12:15], v5, s[40:43], s62 offen sc1
    buffer_load_dwordx4 v[16:19], v5, s[40:43], s63 offen sc1
    s_waitcnt vmcnt(0)
    v_max3_u32 v38, v12, v13, v14
    v_max3_u32 v38, v38, v15, v16
    v_max3_u32 v38, v38, v17, v18
    v_max_u32 v38, v38, v19
    v_cmp_eq_u32 vcc, -1, v38
    s_cbranch_vccz L_poll_97e
    s_sleep 32
    s_sub_u32 s60, s60, 1
    s_cbranch_scc0 L_poll_97
    s_mov_b32 s60, 0
L_poll_97e:
    v_lshlrev_b32 v40, 16, v8
    v_and_b32 v41, 0xffff0000, v8
    v_lshlrev_b32 v42, 16, v9
    v_and_b32 v43, 0xffff0000, v9
    v_lshlrev_b32 v44, 16, v10
    v_and_b32 v45, 0xffff0000, v10
    v_lshlrev_b32 v46, 16, v11
    v_and_b32 v47, 0xffff0000, v11
    v_lshlrev_b32 v48, 16, v12
    v_and_b32 v49, 0xffff0000, v12
    v_lshlrev_b32 v50, 16, v13
    v_and_b32 v51, 0xffff0000, v13
    v_lshlrev_b32 v52, 16, v14
    v_and_b32 v53, 0xffff0000, v14
    v_lshlrev_b32 v54, 16, v15
    v_and_b32 v55, 0xffff0000, v15
    v_lshlrev_b32 v56, 16, v16
    v_and_b32 v57, 0xffff0000, v16
    v_lshlrev_b32 v58, 16, v17
    v_and_b32 v59, 0xffff0000, v17
    v_lshlrev_b32 v60, 16, v18
    v_and_b32 v61, 0xffff0000, v18
    v_lshlrev_b32 v62, 16, v19
    v_and_b32 v63, 0xffff0000, v19
    v_mov_b32 v64, 0
    v_mov_b32 v65, 0
    v_mov_b32 v66, 0
    v_mov_b32 v67, 0
    v_mov_b32 v68, 0
    v_mov_b32 v69, 0
    v_mov_b32 v70, 0
    v_mov_b32 v71, 0
    s_or_b32 s96, s59, s39
    s_cbranch_scc0 L_nofrag_98
    v_mov_b32 v104, 162060
L_lw_99:
    ds_read_b32 v105, v104
    s_waitcnt lgkmcnt(0)
    v_cmp_gt_u32 vcc, 4, v105
    s_cbranch_vccz L_lw_99e
    s_sleep 2
    s_sub_u32 s60, s60, 1
    s_cbranch_scc0 L_lw_99
    s_mov_b32 s60, 0
L_lw_99e:
    s_cmp_eq_u32 s59, 0
    s_cbranch_scc1 L_nofrag_98
    v_lshrrev_b32 v109, 4, v0
    v_bfe_u32 v104, v0, 1, 1
    v_lshl_add_u32 v104, v109, 1, v104
    v_bfe_u32 v110, v0, 2, 2
    v_lshl_add_u32 v104, v104, 3, v110
    v_lshlrev_b32 v104, 7, v104
    v_and_b32 v110, 1, v0
    v_lshl_add_u32 v104, v110, 3, v104
    s_lshl_b32 s96, s3, 13
    s_add_u32 s96, s96, 81920
    v_add_u32 v104, s96, v104
    ds_read_b64_tr_b16 v[72:73], v104 offset:0
    ds_read_b64_tr_b16 v[74:75], v104 offset:512
    ds_read_b64_tr_b16 v[76:77], v104 offset:16
    ds_read_b64_tr_b16 v[78:79], v104 offset:528
    ds_read_b64_tr_b16 v[80:81], v104 offset:32
    ds_read_b64_tr_b16 v[82:83], v104 offset:544
    ds_read_b64_tr_b16 v[84:85], v104 offset:48
    ds_read_b64_tr_b16 v[86:87], v104 offset:560
    ds_read_b64_tr_b16 v[88:89], v104 offset:64
    ds_read_b64_tr_b16 v[90:91], v104 offset:576
    ds_read_b64_tr_b16 v[92:93], v104 offset:80
    ds_read_b64_tr_b16 v[94:95], v104 offset:592
    ds_read_b64_tr_b16 v[96:97], v104 offset:96
    ds_read_b64_tr_b16 v[98:99], v104 offset:608
    ds_read_b64_tr_b16 v[100:101], v104 offset:112
    ds_read_b64_tr_b16 v[102:103], v104 offset:624
    v_bfe_u32 v105, v0, 1, 3
    v_lshlrev_b32 v105, 8, v105
    v_lshl_add_u32 v105, v109, 5, v105
    v_lshl_add_u32 v105, v110, 4, v105
    v_mul_u32_u24 v106, 320, v109
    v_bfe_u32 v110, v0, 3, 1
    v_mul_u32_u24 v110, 160, v110
    v_add_u32 v106, v106, v110
    v_and_b32 v110, 7, v0
    v_lshl_add_u32 v107, v110, 4, v106
    v_add_u32 v107, 81920, v107
    v_lshl_add_u32 v106, v110, 2, v106
    v_add_u32 v106, s96, v106
    v_mul_u32_u24 v108, 1280, v109
    v_add_u32 v108, v108, v2
    s_lshr_b32 s96, s3, 1
    s_lshl_b32 s96, s96, 11
    s_and_b32 s100, s3, 1
    s_lshl_b32 s100, s100, 7
    s_add_u32 s100, s100, s96
    s_lshl_b32 s96, s34, 13
    s_add_u32 s100, s100, s96
    s_add_u32 s100, s100, 90112
    s_mul_i32 s101, s34, 5120
    s_lshl_b32 s96, s35, 7
    s_add_u32 s101, s101, s96
    s_add_u32 s101, s101, 152832
L_nofrag_98:
    v_mov_b32 v12, 162076
L_lw_100:
    ds_read_b32 v13, v12
    s_waitcnt lgkmcnt(0)
    v_cmp_gt_u32 vcc, 4, v13
    s_cbranch_vccz L_lw_100e
    s_sleep 4
    s_sub_u32 s60, s60, 1
    s_cbranch_scc0 L_lw_100
    s_mov_b32 s60, 0
L_lw_100e:
    v_and_b32 v11, 31, v0
    v_lshlrev_b32 v11, 2, v11
    s_lshl_b32 s63, s34, 7
    s_add_u32 s63, s63, 229376
    buffer_load_dword v12, v39, s[40:43], s98 offen sc1
L_poll_101:
    buffer_load_dwordx2 v[8:9], v2, s[40:43], s99 offen sc1
    buffer_load_dword v10, v11, s[40:43], s63 offen sc1
    buffer_load_dwordx4 v[32:35], v20, s[40:43], s97 offen sc1
    s_waitcnt vmcnt(0)
    v_max3_u32 v38, v8, v9, v10
    v_max3_u32 v38, v38, v32, v33
    v_max3_u32 v38, v38, v34, v35
    v_cmp_eq_u32 vcc, -1, v38
    s_cbranch_vccz L_poll_101e
    s_sleep 16
    s_sub_u32 s60, s60, 1
    s_cbranch_scc0 L_poll_101
    s_mov_b32 s60, 0
L_poll_101e:
    v_mov_b32 v37, v8
    s_nop 1
    v_max_f32_dpp v37, v37, v37 quad_perm:[1,0,3,2] row_mask:0xf bank_mask:0xf
    s_nop 1
    v_max_f32_dpp v37, v37, v37 quad_perm:[2,3,0,1] row_mask:0xf bank_mask:0xf
    s_nop 1
    v_max_f32_dpp v37, v37, v37 row_ror:4 row_mask:0xf bank_mask:0xf
    s_nop 1
    v_max_f32_dpp v37, v37, v37 row_ror:8 row_mask:0xf bank_mask:0xf
    v_sub_f32 v8, v8, v37
    v_exp_f32 v8, v8
    s_nop 0
    v_mul_f32 v9, v8, v9
    s_nop 1
    v_add_f32_dpp v9, v9, v9 quad_perm:[1,0,3,2] row_mask:0xf bank_mask:0xf
    s_nop 1
    v_add_f32_dpp v9, v9, v9 quad_perm:[2,3,0,1] row_mask:0xf bank_mask:0xf
    s_nop 1
    v_add_f32_dpp v9, v9, v9 row_ror:4 row_mask:0xf bank_mask:0xf
    s_nop 1
    v_add_f32_dpp v9, v9, v9 row_ror:8 row_mask:0xf bank_mask:0xf
    s_getreg_b32 s62, hwreg(HW_REG_XCC_ID, 0, 4)
    v_cmp_ne_u32 vcc, s62, v10
    s_nop 0
    s_cmp_eq_u64 vcc, 0
    s_cselect_b32 s61, 1, 0
    v_rcp_f32 v9, v9
    v_lshrrev_b32 v3, 1, v2
    v_add_u32 v3, 161984, v3
    v_mul_f32 v8, v8, v9
    v_mov_b32 v10, 162072
    v_mov_b32 v11, s61
    ds_write_b32 v3, v8
    ds_write_b32 v10, v11
    s_branch L_pxj
L_px6:
    s_or_b32 s96, s59, s39
    s_cbranch_scc0 L_nofrag_102
    v_mov_b32 v104, 162060
L_lw_103:
    ds_read_b32 v105, v104
    s_waitcnt lgkmcnt(0)
    v_cmp_gt_u32 vcc, 4, v105
    s_cbranch_vccz L_lw_103e
    s_sleep 2
    s_sub_u32 s60, s60, 1
    s_cbranch_scc0 L_lw_103
    s_mov_b32 s60, 0
L_lw_103e:
    s_cmp_eq_u32 s59, 0
    s_cbranch_scc1 L_nofrag_102
    v_lshrrev_b32 v109, 4, v0
    v_bfe_u32 v104, v0, 1, 1
    v_lshl_add_u32 v104, v109, 1, v104
    v_bfe_u32 v110, v0, 2, 2
    v_lshl_add_u32 v104, v104, 3, v110
    v_lshlrev_b32 v104, 7, v104
    v_and_b32 v110, 1, v0
    v_lshl_add_u32 v104, v110, 3, v104
    s_lshl_b32 s96, s3, 13
    s_add_u32 s96, s96, 81920
    v_add_u32 v104, s96, v104
    ds_read_b64_tr_b16 v[72:73], v104 offset:0
    ds_read_b64_tr_b16 v[74:75], v104 offset:512
    ds_read_b64_tr_b16 v[76:77], v104 offset:16
    ds_read_b64_tr_b16 v[78:79], v104 offset:528
    ds_read_b64_tr_b16 v[80:81], v104 offset:32
    ds_read_b64_tr_b16 v[82:83], v104 offset:544
    ds_read_b64_tr_b16 v[84:85], v104 offset:48
    ds_read_b64_tr_b16 v[86:87], v104 offset:560
    ds_read_b64_tr_b16 v[88:89], v104 offset:64
    ds_read_b64_tr_b16 v[90:91], v104 offset:576
    ds_read_b64_tr_b16 v[92:93], v104 offset:80
    ds_read_b64_tr_b16 v[94:95], v104 offset:592
    ds_read_b64_tr_b16 v[96:97], v104 offset:96
    ds_read_b64_tr_b16 v[98:99], v104 offset:608
    ds_read_b64_tr_b16 v[100:101], v104 offset:112
    ds_read_b64_tr_b16 v[102:103], v104 offset:624
    v_bfe_u32 v105, v0, 1, 3
    v_lshlrev_b32 v105, 8, v105
    v_lshl_add_u32 v105, v109, 5, v105
    v_lshl_add_u32 v105, v110, 4, v105
    v_mul_u32_u24 v106, 320, v109
    v_bfe_u32 v110, v0, 3, 1
    v_mul_u32_u24 v110, 160, v110
    v_add_u32 v106, v106, v110
    v_and_b32 v110, 7, v0
    v_lshl_add_u32 v107, v110, 4, v106
    v_add_u32 v107, 81920, v107
    v_lshl_add_u32 v106, v110, 2, v106
    v_add_u32 v106, s96, v106
    v_mul_u32_u24 v108, 1280, v109
    v_add_u32 v108, v108, v2
    s_lshr_b32 s96, s3, 1
    s_lshl_b32 s96, s96, 11
    s_and_b32 s100, s3, 1
    s_lshl_b32 s100, s100, 7
    s_add_u32 s100, s100, s96
    s_lshl_b32 s96, s34, 13
    s_add_u32 s100, s100, s96
    s_add_u32 s100, s100, 90112
    s_mul_i32 s101, s34, 5120
    s_lshl_b32 s96, s35, 7
    s_add_u32 s101, s101, s96
    s_add_u32 s101, s101, 152832
L_nofrag_102:
    v_mov_b32 v8, 162076
L_lw_104:
    ds_read_b32 v9, v8
    s_waitcnt lgkmcnt(0)
    v_cmp_gt_u32 vcc, 4, v9
    s_cbranch_vccz L_lw_104e
    s_sleep 16
    s_sub_u32 s60, s60, 1
    s_cbranch_scc0 L_lw_104
    s_mov_b32 s60, 0
L_lw_104e:
L_poll_105:
    buffer_load_dwordx4 v[32:35], v20, s[40:43], s97 offen sc1
    s_waitcnt vmcnt(0)
    v_max3_u32 v38, v32, v33, v34
    v_max_u32 v38, v38, v35
    v_cmp_eq_u32 vcc, -1, v38
    s_cbranch_vccz L_poll_105e
    s_sleep 16
    s_sub_u32 s60, s60, 1
    s_cbranch_scc0 L_poll_105
    s_mov_b32 s60, 0
L_poll_105e:
L_pxj:
    v_mov_b32 v8, 162048
L_lw_106:
    ds_read_b32 v9, v8
    s_waitcnt lgkmcnt(0)
    v_cmp_gt_u32 vcc, 3, v9
    s_cbranch_vccz L_lw_106e
    s_sleep 2
    s_sub_u32 s60, s60, 1
    s_cbranch_scc0 L_lw_106
    s_mov_b32 s60, 0
L_lw_106e:
    v_lshrrev_b32 v9, 4, v0
    v_lshl_add_u32 v8, v9, 2, v2
    s_lshl_b32 s96, s3, 9
    s_add_u32 s96, s96, 157824
    v_lshl_add_u32 v8, v8, 2, s96
    v_lshlrev_b32 v9, 3, v0
    v_add_u32 v9, 157824, v9
    v_mov_b32 v10, 162048
    v_mov_b32 v11, 1
    s_lshl_b32 s96, s38, 5
    s_add_u32 s96, s96, 161984
    v_mov_b32 v3, s96
    s_sub_u32 s62, 8, s39
    s_lshl_b32 s98, s34, 5
    s_add_u32 s98, s98, s35
    s_lshl_b32 s98, s98, 8
    s_add_u32 s98, s98, 90112
    v_lshlrev_b32 v39, 2, v0
    s_branch L_t0
L_s_role:
    s_cmp_eq_u32 s3, 7
    s_cbranch_scc1 L_t2gate
    s_cmp_gt_u32 s3, 3
    s_cbranch_scc1 L_fin_prep
    s_mov_b32 s48, s18
    s_mov_b32 s49, s19
    s_mov_b32 s50, 3456
    s_mov_b32 s51, 0x20000
    v_lshrrev_b32 v3, 4, v0
    v_bfe_u32 v1, v0, 2, 2
    v_and_b32 v2, 3, v0
    v_lshl_add_u32 v4, v3, 2, v1
    v_lshlrev_b32 v4, 1, v4
    s_lshl_b32 s62, s35, 7
    s_lshl_b32 s63, s3, 5
    s_add_u32 s62, s62, s63
    buffer_load_ushort v82, v4, s[48:51], s62 offen
    v_mov_b32 v72, 162064
L_lw_107:
    ds_read_b32 v73, v72
    s_waitcnt lgkmcnt(0)
    v_cmp_gt_u32 vcc, 4, v73
    s_cbranch_vccz L_lw_107e
    s_sleep 2
    s_sub_u32 s60, s60, 1
    s_cbranch_scc0 L_lw_107
    s_mov_b32 s60, 0
L_lw_107e:
    v_lshrrev_b32 v72, 4, v0
    v_lshlrev_b32 v72, 10, v72
    v_bfe_u32 v73, v0, 2, 2
    v_lshl_add_u32 v72, v73, 7, v72
    v_and_b32 v73, 3, v0
    v_lshl_add_u32 v72, v73, 3, v72
    v_bfe_u32 v73, v0, 3, 2
    v_lshl_add_u32 v72, v73, 5, v72
    v_xor_b32 v72, s63, v72
    v_add_u32 v73, 40960, v72
    v_and_b32 v5, 7, v0
    v_mul_u32_u24 v5, 1296, v5
    v_lshl_add_u32 v5, v3, 4, v5
    v_add_u32 v5, 147456, v5
    ds_read_b64_tr_b16 v[88:89], v72 offset:0
    ds_read_b64_tr_b16 v[90:91], v72 offset:512
    ds_read_b64_tr_b16 v[92:93], v72 offset:4096
    ds_read_b64_tr_b16 v[94:95], v72 offset:4608
    ds_read_b64_tr_b16 v[96:97], v72 offset:8192
    ds_read_b64_tr_b16 v[98:99], v72 offset:8704
    ds_read_b64_tr_b16 v[100:101], v72 offset:12288
    ds_read_b64_tr_b16 v[102:103], v72 offset:12800
    ds_read_b64_tr_b16 v[104:105], v72 offset:16384
    ds_read_b64_tr_b16 v[106:107], v72 offset:16896
    ds_read_b64_tr_b16 v[108:109], v72 offset:20480
    ds_read_b64_tr_b16 v[110:111], v72 offset:20992
    ds_read_b64_tr_b16 v[112:113], v72 offset:24576
    ds_read_b64_tr_b16 v[114:115], v72 offset:25088
    ds_read_b64_tr_b16 v[116:117], v72 offset:28672
    ds_read_b64_tr_b16 v[118:119], v72 offset:29184
    ds_read_b64_tr_b16 v[120:121], v72 offset:32768
    ds_read_b64_tr_b16 v[122:123], v72 offset:33280
    ds_read_b64_tr_b16 v[124:125], v72 offset:36864
    ds_read_b64_tr_b16 v[126:127], v72 offset:37376
    ds_read_b64_tr_b16 v[128:129], v73 offset:0
    ds_read_b64_tr_b16 v[130:131], v73 offset:512
    ds_read_b64_tr_b16 v[132:133], v73 offset:4096
    ds_read_b64_tr_b16 v[134:135], v73 offset:4608
    ds_read_b64_tr_b16 v[136:137], v73 offset:8192
    ds_read_b64_tr_b16 v[138:139], v73 offset:8704
    ds_read_b64_tr_b16 v[140:141], v73 offset:12288
    ds_read_b64_tr_b16 v[142:143], v73 offset:12800
    ds_read_b64_tr_b16 v[144:145], v73 offset:16384
    ds_read_b64_tr_b16 v[146:147], v73 offset:16896
    ds_read_b64_tr_b16 v[148:149], v73 offset:20480
    ds_read_b64_tr_b16 v[150:151], v73 offset:20992
    ds_read_b64_tr_b16 v[152:153], v73 offset:24576
    ds_read_b64_tr_b16 v[154:155], v73 offset:25088
    ds_read_b64_tr_b16 v[156:157], v73 offset:28672
    ds_read_b64_tr_b16 v[158:159], v73 offset:29184
    ds_read_b64_tr_b16 v[160:161], v73 offset:32768
    ds_read_b64_tr_b16 v[162:163], v73 offset:33280
    ds_read_b64_tr_b16 v[164:165], v73 offset:36864
    ds_read_b64_tr_b16 v[166:167], v73 offset:37376
    ds_read_b128 v[8:11], v5 offset:0
    ds_read_b128 v[12:15], v5 offset:64
    ds_read_b128 v[16:19], v5 offset:128
    ds_read_b128 v[20:23], v5 offset:192
    ds_read_b128 v[24:27], v5 offset:256
    ds_read_b128 v[28:31], v5 offset:320
    ds_read_b128 v[32:35], v5 offset:384
    ds_read_b128 v[36:39], v5 offset:448
    ds_read_b128 v[40:43], v5 offset:512
    ds_read_b128 v[44:47], v5 offset:576
    s_waitcnt lgkmcnt(9)
    v_mfma_f32_16x16x32_bf16 v[48:51], v[88:91], v[8:11], 0
    s_waitcnt lgkmcnt(8)
    v_mfma_f32_16x16x32_bf16 v[48:51], v[92:95], v[12:15], v[48:51]
    s_waitcnt lgkmcnt(7)
    v_mfma_f32_16x16x32_bf16 v[48:51], v[96:99], v[16:19], v[48:51]
    s_waitcnt lgkmcnt(6)
    v_mfma_f32_16x16x32_bf16 v[48:51], v[100:103], v[20:23], v[48:51]
    s_waitcnt lgkmcnt(5)
    v_mfma_f32_16x16x32_bf16 v[48:51], v[104:107], v[24:27], v[48:51]
    s_waitcnt lgkmcnt(4)
    v_mfma_f32_16x16x32_bf16 v[48:51], v[108:111], v[28:31], v[48:51]
    s_waitcnt lgkmcnt(3)
    v_mfma_f32_16x16x32_bf16 v[48:51], v[112:115], v[32:35], v[48:51]
    s_waitcnt lgkmcnt(2)
    v_mfma_f32_16x16x32_bf16 v[48:51], v[116:119], v[36:39], v[48:51]
    s_waitcnt lgkmcnt(1)
    v_mfma_f32_16x16x32_bf16 v[48:51], v[120:123], v[40:43], v[48:51]
    s_waitcnt lgkmcnt(0)
    v_mfma_f32_16x16x32_bf16 v[48:51], v[124:127], v[44:47], v[48:51]
    ds_read_b128 v[8:11], v5 offset:640
    ds_read_b128 v[12:15], v5 offset:704
    ds_read_b128 v[16:19], v5 offset:768
    ds_read_b128 v[20:23], v5 offset:832
    ds_read_b128 v[24:27], v5 offset:896
    ds_read_b128 v[28:31], v5 offset:960
    ds_read_b128 v[32:35], v5 offset:1024
    ds_read_b128 v[36:39], v5 offset:1088
    ds_read_b128 v[40:43], v5 offset:1152
    ds_read_b128 v[44:47], v5 offset:1216
    s_waitcnt lgkmcnt(9)
    v_mfma_f32_16x16x32_bf16 v[48:51], v[128:131], v[8:11], v[48:51]
    s_waitcnt lgkmcnt(8)
    v_mfma_f32_16x16x32_bf16 v[48:51], v[132:135], v[12:15], v[48:51]
    s_waitcnt lgkmcnt(7)
    v_mfma_f32_16x16x32_bf16 v[48:51], v[136:139], v[16:19], v[48:51]
    s_waitcnt lgkmcnt(6)
    v_mfma_f32_16x16x32_bf16 v[48:51], v[140:143], v[20:23], v[48:51]
    s_waitcnt lgkmcnt(5)
    v_mfma_f32_16x16x32_bf16 v[48:51], v[144:147], v[24:27], v[48:51]
    s_waitcnt lgkmcnt(4)
    v_mfma_f32_16x16x32_bf16 v[48:51], v[148:151], v[28:31], v[48:51]
    s_waitcnt lgkmcnt(3)
    v_mfma_f32_16x16x32_bf16 v[48:51], v[152:155], v[32:35], v[48:51]
    s_waitcnt lgkmcnt(2)
    v_mfma_f32_16x16x32_bf16 v[48:51], v[156:159], v[36:39], v[48:51]
    s_waitcnt lgkmcnt(1)
    v_mfma_f32_16x16x32_bf16 v[48:51], v[160:163], v[40:43], v[48:51]
    s_waitcnt lgkmcnt(0)
    v_mfma_f32_16x16x32_bf16 v[48:51], v[164:167], v[44:47], v[48:51]
    v_mul_u32_u24 v79, 1296, v2
    v_lshl_add_u32 v79, v1, 6, v79
    v_lshl_add_u32 v79, v3, 4, v79
    v_add_u32 v79, 81920, v79
    v_mul_u32_u24 v80, 144, v2
    v_add3_u32 v80, v80, v4, s63
    v_add_u32 v80, 97600, v80
    v_lshlrev_b32 v81, 6, v2
    v_add_u32 v81, 97344, v81
    v_mov_b32_dpp v84, v48 quad_perm:[0,1,2,3] row_mask:0xf bank_mask:0x1
    v_mov_b32_dpp v85, v48 row_ror:4 row_mask:0xf bank_mask:0x1
    v_mov_b32_dpp v84, v49 row_ror:4 row_mask:0xf bank_mask:0x2
    v_mov_b32_dpp v85, v49 quad_perm:[0,1,2,3] row_mask:0xf bank_mask:0x2
    v_mov_b32_dpp v84, v50 quad_perm:[0,1,2,3] row_mask:0xf bank_mask:0x4
    v_mov_b32_dpp v85, v50 row_ror:4 row_mask:0xf bank_mask:0x4
    v_mov_b32_dpp v84, v51 row_ror:4 row_mask:0xf bank_mask:0x8
    v_mov_b32_dpp v85, v51 quad_perm:[0,1,2,3] row_mask:0xf bank_mask:0x8
    s_mov_b32 s62, 0xbacccccd
    s_mov_b32 s63, 0xbdd2d3e8
    v_mov_b32 v86, 0xc0135761
    s_branch L_ffn1
L_fin_prep:
    s_mul_i32 s62, s35, 3
    s_add_u32 s62, s62, s3
    s_sub_u32 s62, s62, 4
    s_cmp_ge_u32 s62, 80
    s_cbranch_scc1 L_end
    s_lshl_b32 s96, s62, 7
    s_lshl_b32 s57, s62, 6
    s_mul_i32 s63, s62, 0xccd
    s_lshr_b32 s63, s63, 16
    s_mul_i32 s63, s63, 1280
    s_sub_u32 s63, s57, s63
    s_add_u32 s96, s96, 262144
    s_add_u32 s97, s96, 81920
    s_add_u32 s98, s96, 163840
    s_add_u32 s99, s96, 245760
    v_lshrrev_b32 v72, 3, v0
    v_mul_u32_u24 v72, 10240, v72
    v_and_b32 v1, 7, v0
    v_lshl_add_u32 v72, v1, 4, v72
    v_mov_b32 v100, 0
    v_mov_b32 v101, 0
    v_mov_b32 v102, 0
    v_mov_b32 v103, 0
    v_bfe_u32 v3, v0, 4, 1
    v_lshrrev_b32 v4, 5, v0
    v_lshl_add_u32 v3, v3, 1, v4
    v_lshl_add_u32 v73, v1, 2, v3
    v_lshlrev_b32 v73, 1, v73
    s_lshl_b32 s62, s57, 1
    s_add_u32 s62, s62, 87104
    v_lshl_add_u32 v74, v73, 1, s62
    s_mov_b32 s48, s22
    s_mov_b32 s49, s23
    s_mov_b32 s50, 1280
    s_mov_b32 s51, 0x20000
    s_mov_b32 s52, s28
    s_mov_b32 s53, s29
    s_mov_b32 s54, 5120
    s_mov_b32 s55, 0x20000
    buffer_load_dwordx4 v[88:91], v72, s[40:43], s96 offen sc1
    buffer_load_dwordx4 v[92:95], v72, s[40:43], s97 offen sc1
    buffer_load_dwordx4 v[96:99], v72, s[40:43], s98 offen sc1
    s_mov_b64 exec, 0xffffff
    buffer_load_dwordx4 v[100:103], v72, s[40:43], s99 offen sc1
    s_mov_b64 exec, -1
    buffer_load_ushort v75, v73, s[48:51], s63 offen
    v_and_b32 v77, 0xfffc, v73
    s_add_u32 s62, s57, 35840
    buffer_load_dword v76, v77, s[40:43], s62 offen sc1
    s_barrier
    s_waitcnt vmcnt(0)
    v_cmp_eq_u32 vcc, -1, v76
    s_cbranch_vccz L_gbok
L_poll_108:
    buffer_load_dword v76, v77, s[40:43], s62 offen sc1
    s_waitcnt vmcnt(0)
    v_cmp_eq_u32 vcc, -1, v76
    s_cbranch_vccz L_poll_108e
    s_sleep 2
    s_sub_u32 s60, s60, 1
    s_cbranch_scc0 L_poll_108
    s_mov_b32 s60, 0
L_poll_108e:
L_gbok:
    v_lshlrev_b32 v75, 16, v75
    v_and_b32 v77, 2, v73
    v_lshlrev_b32 v77, 3, v77
    v_lshrrev_b32 v76, v77, v76
    v_lshlrev_b32 v76, 16, v76
    s_barrier
    s_barrier
    ds_read_b32 v78, v74
    s_barrier
    s_mov_b64 s[4:5], -1
    s_mov_b64 s[6:7], -1
    s_mov_b64 s[8:9], -1
    s_mov_b64 s[10:11], 0xffffff
L_yg:
    s_mov_b64 exec, s[4:5]
    buffer_load_dwordx4 v[88:91], v72, s[40:43], s96 offen sc1
    s_mov_b64 exec, s[6:7]
    buffer_load_dwordx4 v[92:95], v72, s[40:43], s97 offen sc1
    s_mov_b64 exec, s[8:9]
    buffer_load_dwordx4 v[96:99], v72, s[40:43], s98 offen sc1
    s_mov_b64 exec, s[10:11]
    buffer_load_dwordx4 v[100:103], v72, s[40:43], s99 offen sc1
    s_mov_b64 exec, -1
    s_waitcnt vmcnt(3)
    v_max3_u32 v3, v88, v89, v90
    v_max_u32 v3, v3, v91
    v_cmp_eq_u32 s[4:5], -1, v3
    s_waitcnt vmcnt(2)
    v_max3_u32 v3, v92, v93, v94
    v_max_u32 v3, v3, v95
    v_cmp_eq_u32 s[6:7], -1, v3
    s_waitcnt vmcnt(1)
    v_max3_u32 v3, v96, v97, v98
    v_max_u32 v3, v3, v99
    v_cmp_eq_u32 s[8:9], -1, v3
    s_waitcnt vmcnt(0)
    v_max3_u32 v3, v100, v101, v102
    v_max_u32 v3, v3, v103
    v_cmp_eq_u32 s[10:11], -1, v3
    s_or_b64 s[16:17], s[4:5], s[6:7]
    s_or_b64 s[16:17], s[16:17], s[8:9]
    s_or_b64 s[16:17], s[16:17], s[10:11]
    s_cbranch_scc0 L_ygd
    s_sub_u32 s60, s60, 1
    s_cbranch_scc0 L_yg
L_ygd:
    v_pk_add_f32 v[88:89], v[88:89], v[92:93]
    v_pk_add_f32 v[90:91], v[90:91], v[94:95]
    v_pk_add_f32 v[96:97], v[96:97], v[100:101]
    v_pk_add_f32 v[98:99], v[98:99], v[102:103]
    v_pk_add_f32 v[88:89], v[88:89], v[96:97]
    v_pk_add_f32 v[90:91], v[90:91], v[98:99]
    s_nop 0
    v_permlane32_swap_b32 v88, v89
    v_permlane32_swap_b32 v90, v91
    v_add_f32 v88, v88, v89
    v_add_f32 v90, v90, v91
    s_nop 1
    v_permlane16_swap_b32 v88, v90
    v_add_f32 v88, v88, v90
    s_waitcnt lgkmcnt(0)
    s_nop 0
    v_add_f32_dpp v88, v88, v88 row_ror:8 row_mask:0xf bank_mask:0xf
    v_add_f32 v88, v88, v75
    v_fma_f32 v88, v88, v76, v78
    v_cvt_pk_bf16_f32 v88, v88, v88
    s_mov_b32 exec_lo, 0x00ff00ff
    s_mov_b32 exec_hi, 0x00ff00ff
    buffer_store_short v88, v73, s[52:55], s57 offen
    s_endpgm
L_t2gate:
    s_cmp_ge_u32 s35, 22
    s_cselect_b32 s62, 8, 0
    v_mov_b32 v8, 162052
L_lw_109:
    ds_read_b32 v9, v8
    s_waitcnt lgkmcnt(0)
    v_cmp_gt_u32 vcc, s62, v9
    s_cbranch_vccz L_lw_109e
    s_sleep 2
    s_sub_u32 s60, s60, 1
    s_cbranch_scc0 L_lw_109
    s_mov_b32 s60, 0
L_lw_109e:
    v_mov_b32 v8, 162048
L_lw_110:
    ds_read_b32 v9, v8
    s_waitcnt lgkmcnt(0)
    v_cmp_gt_u32 vcc, 8, v9
    s_cbranch_vccz L_lw_110e
    s_sleep 2
    s_sub_u32 s60, s60, 1
    s_cbranch_scc0 L_lw_110
    s_mov_b32 s60, 0
L_lw_110e:
    ds_read_b32 v9, v8 offset:24
    s_waitcnt lgkmcnt(0)
    v_readfirstlane_b32 s61, v9
    s_mov_b32 s58, 0x3f80
    s_mov_b32 s59, 0x3f800000
    s_mov_b32 s63, 0xff
L_pg:
    s_bitcmp0_b32 s63, 0
    s_cbranch_scc1 L_pgi0
    s_mov_b32 s62, 155648
    buffer_load_dwordx4 v[8:11], v5, s[40:43], s62 offen sc1
L_pgi0:
    s_bitcmp0_b32 s63, 1
    s_cbranch_scc1 L_pgi1
    s_mov_b32 s62, 160768
    buffer_load_dwordx4 v[12:15], v5, s[40:43], s62 offen sc1
L_pgi1:
    s_bitcmp0_b32 s63, 2
    s_cbranch_scc1 L_pgi2
    s_mov_b32 s62, 165888
    buffer_load_dwordx4 v[16:19], v5, s[40:43], s62 offen sc1
L_pgi2:
    s_bitcmp0_b32 s63, 3
    s_cbranch_scc1 L_pgi3
    s_mov_b32 s62, 171008
    buffer_load_dwordx4 v[20:23], v5, s[40:43], s62 offen sc1
L_pgi3:
    s_bitcmp0_b32 s63, 4
    s_cbranch_scc1 L_pgi4
    s_mov_b32 s62, 176128
    buffer_load_dwordx4 v[24:27], v5, s[40:43], s62 offen sc1
L_pgi4:
    s_bitcmp0_b32 s63, 5
    s_cbranch_scc1 L_pgi5
    s_mov_b32 s62, 181248
    buffer_load_dwordx4 v[28:31], v5, s[40:43], s62 offen sc1
L_pgi5:
    s_bitcmp0_b32 s63, 6
    s_cbranch_scc1 L_pgi6
    s_mov_b32 s62, 186368
    buffer_load_dwordx4 v[32:35], v5, s[40:43], s62 offen sc1
L_pgi6:
    s_bitcmp0_b32 s63, 7
    s_cbranch_scc1 L_pgi7
    s_mov_b32 s62, 191488
    buffer_load_dwordx4 v[36:39], v5, s[40:43], s62 offen sc1
L_pgi7:
    s_sub_u32 s60, s60, 1
    s_cselect_b32 s62, 0, -1
    s_cselect_b32 s60, 0, s60
    s_waitcnt vmcnt(0)
    s_bitcmp0_b32 s63, 0
    s_cbranch_scc1 L_pgc0
    v_max3_u32 v3, v8, v9, v10
    v_max_u32 v3, v3, v11
    v_and_b32 v3, s62, v3
    v_cmp_eq_u32 vcc, -1, v3
    s_cbranch_vccnz L_pgc0
    v_dot2c_f32_bf16 v64, s58, v8
    v_dot2c_f32_bf16 v65, s59, v8
    v_dot2c_f32_bf16 v66, s58, v9
    v_dot2c_f32_bf16 v67, s59, v9
    v_dot2c_f32_bf16 v68, s58, v10
    v_dot2c_f32_bf16 v69, s59, v10
    v_dot2c_f32_bf16 v70, s58, v11
    v_dot2c_f32_bf16 v71, s59, v11
    s_bitset0_b32 s63, 0
L_pgc0:
    s_bitcmp0_b32 s63, 1
    s_cbranch_scc1 L_pgc1
    v_max3_u32 v3, v12, v13, v14
    v_max_u32 v3, v3, v15
    v_and_b32 v3, s62, v3
    v_cmp_eq_u32 vcc, -1, v3
    s_cbranch_vccnz L_pgc1
    v_dot2c_f32_bf16 v64, s58, v12
    v_dot2c_f32_bf16 v65, s59, v12
    v_dot2c_f32_bf16 v66, s58, v13
    v_dot2c_f32_bf16 v67, s59, v13
    v_dot2c_f32_bf16 v68, s58, v14
    v_dot2c_f32_bf16 v69, s59, v14
    v_dot2c_f32_bf16 v70, s58, v15
    v_dot2c_f32_bf16 v71, s59, v15
    s_bitset0_b32 s63, 1
L_pgc1:
    s_bitcmp0_b32 s63, 2
    s_cbranch_scc1 L_pgc2
    v_max3_u32 v3, v16, v17, v18
    v_max_u32 v3, v3, v19
    v_and_b32 v3, s62, v3
    v_cmp_eq_u32 vcc, -1, v3
    s_cbranch_vccnz L_pgc2
    v_dot2c_f32_bf16 v64, s58, v16
    v_dot2c_f32_bf16 v65, s59, v16
    v_dot2c_f32_bf16 v66, s58, v17
    v_dot2c_f32_bf16 v67, s59, v17
    v_dot2c_f32_bf16 v68, s58, v18
    v_dot2c_f32_bf16 v69, s59, v18
    v_dot2c_f32_bf16 v70, s58, v19
    v_dot2c_f32_bf16 v71, s59, v19
    s_bitset0_b32 s63, 2
L_pgc2:
    s_bitcmp0_b32 s63, 3
    s_cbranch_scc1 L_pgc3
    v_max3_u32 v3, v20, v21, v22
    v_max_u32 v3, v3, v23
    v_and_b32 v3, s62, v3
    v_cmp_eq_u32 vcc, -1, v3
    s_cbranch_vccnz L_pgc3
    v_dot2c_f32_bf16 v64, s58, v20
    v_dot2c_f32_bf16 v65, s59, v20
    v_dot2c_f32_bf16 v66, s58, v21
    v_dot2c_f32_bf16 v67, s59, v21
    v_dot2c_f32_bf16 v68, s58, v22
    v_dot2c_f32_bf16 v69, s59, v22
    v_dot2c_f32_bf16 v70, s58, v23
    v_dot2c_f32_bf16 v71, s59, v23
    s_bitset0_b32 s63, 3
L_pgc3:
    s_bitcmp0_b32 s63, 4
    s_cbranch_scc1 L_pgc4
    v_max3_u32 v3, v24, v25, v26
    v_max_u32 v3, v3, v27
    v_and_b32 v3, s62, v3
    v_cmp_eq_u32 vcc, -1, v3
    s_cbranch_vccnz L_pgc4
    v_dot2c_f32_bf16 v64, s58, v24
    v_dot2c_f32_bf16 v65, s59, v24
    v_dot2c_f32_bf16 v66, s58, v25
    v_dot2c_f32_bf16 v67, s59, v25
    v_dot2c_f32_bf16 v68, s58, v26
    v_dot2c_f32_bf16 v69, s59, v26
    v_dot2c_f32_bf16 v70, s58, v27
    v_dot2c_f32_bf16 v71, s59, v27
    s_bitset0_b32 s63, 4
L_pgc4:
    s_bitcmp0_b32 s63, 5
    s_cbranch_scc1 L_pgc5
    v_max3_u32 v3, v28, v29, v30
    v_max_u32 v3, v3, v31
    v_and_b32 v3, s62, v3
    v_cmp_eq_u32 vcc, -1, v3
    s_cbranch_vccnz L_pgc5
    v_dot2c_f32_bf16 v64, s58, v28
    v_dot2c_f32_bf16 v65, s59, v28
    v_dot2c_f32_bf16 v66, s58, v29
    v_dot2c_f32_bf16 v67, s59, v29
    v_dot2c_f32_bf16 v68, s58, v30
    v_dot2c_f32_bf16 v69, s59, v30
    v_dot2c_f32_bf16 v70, s58, v31
    v_dot2c_f32_bf16 v71, s59, v31
    s_bitset0_b32 s63, 5
L_pgc5:
    s_bitcmp0_b32 s63, 6
    s_cbranch_scc1 L_pgc6
    v_max3_u32 v3, v32, v33, v34
    v_max_u32 v3, v3, v35
    v_and_b32 v3, s62, v3
    v_cmp_eq_u32 vcc, -1, v3
    s_cbranch_vccnz L_pgc6
    v_dot2c_f32_bf16 v64, s58, v32
    v_dot2c_f32_bf16 v65, s59, v32
    v_dot2c_f32_bf16 v66, s58, v33
    v_dot2c_f32_bf16 v67, s59, v33
    v_dot2c_f32_bf16 v68, s58, v34
    v_dot2c_f32_bf16 v69, s59, v34
    v_dot2c_f32_bf16 v70, s58, v35
    v_dot2c_f32_bf16 v71, s59, v35
    s_bitset0_b32 s63, 6
L_pgc6:
    s_bitcmp0_b32 s63, 7
    s_cbranch_scc1 L_pgc7
    v_max3_u32 v3, v36, v37, v38
    v_max_u32 v3, v3, v39
    v_and_b32 v3, s62, v3
    v_cmp_eq_u32 vcc, -1, v3
    s_cbranch_vccnz L_pgc7
    v_dot2c_f32_bf16 v64, s58, v36
    v_dot2c_f32_bf16 v65, s59, v36
    v_dot2c_f32_bf16 v66, s58, v37
    v_dot2c_f32_bf16 v67, s59, v37
    v_dot2c_f32_bf16 v68, s58, v38
    v_dot2c_f32_bf16 v69, s59, v38
    v_dot2c_f32_bf16 v70, s58, v39
    v_dot2c_f32_bf16 v71, s59, v39
    s_bitset0_b32 s63, 7
L_pgc7:
    s_bcnt1_i32_b32 s62, s63
    s_cbranch_scc0 L_pgd
    s_cmp_gt_u32 s62, 3
    s_cbranch_scc1 L_pg
    s_ff1_i32_b32 s96, s63
    s_bitset0_b32 s63, s96
    s_mul_i32 s96, s96, 5120
    s_add_u32 s96, s96, 155648
    s_cmp_eq_u32 s62, 1
    s_cbranch_scc1 L_pt1
    s_ff1_i32_b32 s97, s63
    s_bitset0_b32 s63, s97
    s_mul_i32 s97, s97, 5120
    s_add_u32 s97, s97, 155648
    s_cmp_eq_u32 s62, 2
    s_cbranch_scc1 L_pt2
    s_ff1_i32_b32 s98, s63
    s_bitset0_b32 s63, s98
    s_mul_i32 s98, s98, 5120
    s_add_u32 s98, s98, 155648
L_pt3:
L_ptl3:
    buffer_load_dwordx4 v[16:19], v5, s[40:43], s96 offen sc1
    buffer_load_dwordx4 v[20:23], v5, s[40:43], s97 offen sc1
    buffer_load_dwordx4 v[24:27], v5, s[40:43], s98 offen sc1
    s_waitcnt vmcnt(0)
    v_max3_u32 v3, v16, v17, v18
    v_max3_u32 v3, v3, v19, v20
    v_max3_u32 v3, v3, v21, v22
    v_max3_u32 v3, v3, v23, v24
    v_max3_u32 v3, v3, v25, v26
    v_max_u32 v3, v3, v27
    v_cmp_eq_u32 vcc, -1, v3
    s_cbranch_vccz L_pta3
    s_sub_u32 s60, s60, 1
    s_cbranch_scc0 L_ptl3
    s_mov_b32 s60, 0
    s_branch L_pta3
L_pt2:
L_ptl2:
    buffer_load_dwordx4 v[16:19], v5, s[40:43], s96 offen sc1
    buffer_load_dwordx4 v[20:23], v5, s[40:43], s97 offen sc1
    s_waitcnt vmcnt(0)
    v_max3_u32 v3, v16, v17, v18
    v_max3_u32 v3, v3, v19, v20
    v_max3_u32 v3, v3, v21, v22
    v_max_u32 v3, v3, v23
    v_cmp_eq_u32 vcc, -1, v3
    s_cbranch_vccz L_pta2
    s_sub_u32 s60, s60, 1
    s_cbranch_scc0 L_ptl2
    s_mov_b32 s60, 0
    s_branch L_pta2
L_pt1:
L_ptl1:
    buffer_load_dwordx4 v[16:19], v5, s[40:43], s96 offen sc1
    s_waitcnt vmcnt(0)
    v_max3_u32 v3, v16, v17, v18
    v_max_u32 v3, v3, v19
    v_cmp_eq_u32 vcc, -1, v3
    s_cbranch_vccz L_pta1
    s_sub_u32 s60, s60, 1
    s_cbranch_scc0 L_ptl1
    s_mov_b32 s60, 0
L_pta1:
    v_dot2c_f32_bf16 v64, s58, v16
    v_dot2c_f32_bf16 v65, s59, v16
    v_dot2c_f32_bf16 v66, s58, v17
    v_dot2c_f32_bf16 v67, s59, v17
    v_dot2c_f32_bf16 v68, s58, v18
    v_dot2c_f32_bf16 v69, s59, v18
    v_dot2c_f32_bf16 v70, s58, v19
    v_dot2c_f32_bf16 v71, s59, v19
L_pgd:
    v_pk_fma_f32 v[64:65], v[64:65], v[48:49], v[40:41]
    v_pk_fma_f32 v[66:67], v[66:67], v[50:51], v[42:43]
    v_pk_fma_f32 v[68:69], v[68:69], v[52:53], v[44:45]
    v_pk_fma_f32 v[70:71], v[70:71], v[54:55], v[46:47]
    v_pk_mul_f32 v[56:57], v[64:65], v[56:57]
    v_pk_mul_f32 v[58:59], v[66:67], v[58:59]
    v_pk_mul_f32 v[60:61], v[68:69], v[60:61]
    v_pk_mul_f32 v[62:63], v[70:71], v[62:63]
    v_cvt_pk_bf16_f32 v8, v56, v57
    v_cvt_pk_bf16_f32 v9, v58, v59
    v_cvt_pk_bf16_f32 v10, v60, v61
    v_cvt_pk_bf16_f32 v11, v62, v63
    ds_write_b128 v4, v[8:11]
    v_pk_add_f32 v[40:41], v[64:65], v[66:67]
    v_pk_add_f32 v[42:43], v[68:69], v[70:71]
    v_pk_mul_f32 v[44:45], v[64:65], v[64:65]
    v_pk_mul_f32 v[46:47], v[66:67], v[66:67]
    v_pk_add_f32 v[40:41], v[40:41], v[42:43]
    v_pk_fma_f32 v[44:45], v[68:69], v[68:69], v[44:45]
    v_pk_fma_f32 v[46:47], v[70:71], v[70:71], v[46:47]
    s_waitcnt lgkmcnt(0)
    s_barrier
    v_add_f32 v8, v40, v41
    v_pk_add_f32 v[44:45], v[44:45], v[46:47]
    v_add_f32 v9, v44, v45
    v_add_f32_dpp v8, v8, v8 quad_perm:[1,0,3,2] row_mask:0xf bank_mask:0xf
    s_nop 0
    v_add_f32_dpp v9, v9, v9 quad_perm:[1,0,3,2] row_mask:0xf bank_mask:0xf
    v_add_f32_dpp v8, v8, v8 quad_perm:[2,3,0,1] row_mask:0xf bank_mask:0xf
    s_nop 0
    v_add_f32_dpp v9, v9, v9 quad_perm:[2,3,0,1] row_mask:0xf bank_mask:0xf
    v_add_f32_dpp v8, v8, v8 row_ror:4 row_mask:0xf bank_mask:0xf
    s_nop 0
    v_add_f32_dpp v9, v9, v9 row_ror:4 row_mask:0xf bank_mask:0xf
    v_add_f32_dpp v8, v8, v8 row_ror:8 row_mask:0xf bank_mask:0xf
    s_nop 0
    v_add_f32_dpp v9, v9, v9 row_ror:8 row_mask:0xf bank_mask:0xf
    ds_write_b64 v7, v[8:9]
    s_waitcnt lgkmcnt(0)
    s_barrier
    ds_write_b128 v6, v[64:67]
    ds_write_b128 v6, v[68:71] offset:16
    s_waitcnt vmcnt(0) lgkmcnt(0)
    s_cmp_lg_u32 s3, 7
    s_cbranch_scc1 L_ffn2
    s_endpgm
L_pta3:
    v_dot2c_f32_bf16 v64, s58, v24
    v_dot2c_f32_bf16 v65, s59, v24
    v_dot2c_f32_bf16 v66, s58, v25
    v_dot2c_f32_bf16 v67, s59, v25
    v_dot2c_f32_bf16 v68, s58, v26
    v_dot2c_f32_bf16 v69, s59, v26
    v_dot2c_f32_bf16 v70, s58, v27
    v_dot2c_f32_bf16 v71, s59, v27
L_pta2:
    v_dot2c_f32_bf16 v64, s58, v20
    v_dot2c_f32_bf16 v65, s59, v20
    v_dot2c_f32_bf16 v66, s58, v21
    v_dot2c_f32_bf16 v67, s59, v21
    v_dot2c_f32_bf16 v68, s58, v22
    v_dot2c_f32_bf16 v69, s59, v22
    v_dot2c_f32_bf16 v70, s58, v23
    v_dot2c_f32_bf16 v71, s59, v23
    s_branch L_pta1
L_ffn1:
    s_barrier
    ds_read_b128 v[8:11], v79 offset:0
    ds_read_b128 v[12:15], v79 offset:256
    ds_read_b128 v[16:19], v79 offset:512
    ds_read_b128 v[20:23], v79 offset:768
    ds_read_b128 v[24:27], v79 offset:1024
    s_waitcnt vmcnt(0)
    v_lshlrev_b32 v82, 16, v82
    v_add_f32 v85, v85, v82
    s_waitcnt lgkmcnt(4)
    v_mfma_f32_16x16x32_bf16 v[32:35], v[88:91], v[8:11], 0
    v_mfma_f32_16x16x32_bf16 v[36:39], v[92:95], v[8:11], 0
    v_mfma_f32_16x16x32_bf16 v[40:43], v[96:99], v[8:11], 0
    v_mfma_f32_16x16x32_bf16 v[44:47], v[100:103], v[8:11], 0
    s_waitcnt lgkmcnt(3)
    v_mfma_f32_16x16x32_bf16 v[32:35], v[104:107], v[12:15], v[32:35]
    v_mfma_f32_16x16x32_bf16 v[36:39], v[108:111], v[12:15], v[36:39]
    v_mfma_f32_16x16x32_bf16 v[40:43], v[112:115], v[12:15], v[40:43]
    v_mfma_f32_16x16x32_bf16 v[44:47], v[116:119], v[12:15], v[44:47]
    s_waitcnt lgkmcnt(2)
    v_mfma_f32_16x16x32_bf16 v[32:35], v[120:123], v[16:19], v[32:35]
    v_mfma_f32_16x16x32_bf16 v[36:39], v[124:127], v[16:19], v[36:39]
    v_mfma_f32_16x16x32_bf16 v[40:43], v[128:131], v[16:19], v[40:43]
    v_mfma_f32_16x16x32_bf16 v[44:47], v[132:135], v[16:19], v[44:47]
    s_waitcnt lgkmcnt(1)
    s_barrier
    ds_read_b128 v[48:51], v81
    ds_read_b128 v[52:55], v81 offset:16
    ds_read_b64 v[56:57], v81 offset:32
    v_mfma_f32_16x16x32_bf16 v[32:35], v[136:139], v[20:23], v[32:35]
    v_mfma_f32_16x16x32_bf16 v[36:39], v[140:143], v[20:23], v[36:39]
    v_mfma_f32_16x16x32_bf16 v[40:43], v[144:147], v[20:23], v[40:43]
    v_mfma_f32_16x16x32_bf16 v[44:47], v[148:151], v[20:23], v[44:47]
    s_waitcnt lgkmcnt(3)
    v_mfma_f32_16x16x32_bf16 v[32:35], v[152:155], v[24:27], v[32:35]
    v_mfma_f32_16x16x32_bf16 v[36:39], v[156:159], v[24:27], v[36:39]
    s_waitcnt lgkmcnt(0)
    v_pk_add_f32 v[48:49], v[48:49], v[50:51]
    v_pk_add_f32 v[52:53], v[52:53], v[54:55]
    v_mfma_f32_16x16x32_bf16 v[40:43], v[160:163], v[24:27], v[40:43]
    v_pk_add_f32 v[48:49], v[48:49], v[56:57]
    v_pk_add_f32 v[48:49], v[48:49], v[52:53]
    v_mfma_f32_16x16x32_bf16 v[44:47], v[164:167], v[24:27], v[44:47]
    v_mul_f32 v48, s62, v48
    v_mul_f32 v49, s62, v49
    v_mul_f32 v7, v84, v48
    v_fma_f32 v49, -v48, v48, -v49
    v_max_f32 v49, 0, v49
    v_add_f32 v49, 0x3727c5ac, v49
    v_rsq_f32 v49, v49
    v_add_f32_dpp v5, v36, v7 row_ror:12 row_mask:0xf bank_mask:0x1
    v_add_f32_dpp v5, v41, v7 row_ror:12 row_mask:0xf bank_mask:0x2
    v_add_f32_dpp v5, v46, v7 row_ror:12 row_mask:0xf bank_mask:0x4
    v_add_f32_dpp v5, v35, v7 row_ror:12 row_mask:0xf bank_mask:0x8
    v_add_f32_dpp v4, v40, v32 row_ror:8 row_mask:0xf bank_mask:0x1
    v_add_f32_dpp v4, v45, v37 row_ror:8 row_mask:0xf bank_mask:0x2
    v_add_f32_dpp v4, v34, v42 row_ror:8 row_mask:0xf bank_mask:0x4
    v_add_f32_dpp v4, v39, v47 row_ror:8 row_mask:0xf bank_mask:0x8
    v_add_f32_dpp v6, v44, v5 row_ror:4 row_mask:0xf bank_mask:0x1
    v_add_f32_dpp v6, v33, v5 row_ror:4 row_mask:0xf bank_mask:0x2
    v_add_f32_dpp v6, v38, v5 row_ror:4 row_mask:0xf bank_mask:0x4
    v_add_f32_dpp v6, v43, v5 row_ror:4 row_mask:0xf bank_mask:0x8
    v_add_f32 v4, v4, v6
    v_fma_f32 v4, v4, v49, v85
    v_mul_f32 v5, v4, v4
    v_fma_f32 v5, v5, s63, v86
    v_mul_f32 v5, v5, v4
    v_exp_f32 v5, v5
    s_nop 0
    v_add_f32 v5, 1.0, v5
    v_rcp_f32 v5, v5
    s_nop 0
    v_mul_f32 v4, v4, v5
    v_cvt_pk_bf16_f32 v4, v4, v4
    ds_write_b16 v80, v4
    s_waitcnt lgkmcnt(0)
    s_barrier
    s_endpgm
L_helpers:
    s_cmp_lg_u32 s3, 0
    s_cbranch_scc1 L_noinit
    v_lshlrev_b32 v1, 2, v0
    v_add_u32 v1, 161920, v1
    ds_write_b32 v1, v36
    s_waitcnt lgkmcnt(0)
L_noinit:
    s_mul_i32 s101, s3, 20480
    s_mov_b32 s96, s56
    s_cmp_lt_u32 s56, 40
    s_cbranch_scc0 L_nothalf
    s_cmp_lt_u32 s3, 2
    s_cbranch_scc1 L_unit
    s_add_u32 s62, s56, 20
    s_cmp_eq_u32 s3, 2
    s_cbranch_scc1 L_job
    s_lshr_b32 s62, s56, 1
    s_and_b32 s63, s56, 1
    s_mul_i32 s63, s63, 5120
    s_lshl_b32 s96, s62, 7
    s_add_u32 s63, s63, s96
    s_cmp_ge_u32 s62, 10
    s_cselect_b32 s62, 8960, 0
    s_add_u32 s63, s63, s62
    v_lshrrev_b32 v1, 4, v0
    v_mul_u32_u24 v1, 1280, v1
    v_and_b32 v2, 15, v0
    v_lshl_add_u32 v1, v2, 3, v1
    v_mov_b32 v4, -1
    v_mov_b32 v5, -1
    buffer_store_dwordx2 v[4:5], v1, s[40:43], s63 offen sc1
    s_lshl_b32 s62, s56, 1
    s_waitcnt vmcnt(0)
    s_mov_b64 exec, 1
    buffer_store_short v4, v36, s[44:47], s62 offen offset:128 sc1
    s_mov_b64 exec, -1
    s_barrier
    s_branch L_service
L_nothalf:
    s_cmp_lt_u32 s56, 104
    s_cbranch_scc1 L_unit
    s_sub_u32 s62, s56, 144
    s_cmp_lt_u32 s62, 10
    s_cbranch_scc0 L_nojob
    s_cmp_lt_u32 s3, 2
    s_cbranch_scc0 L_nojob
    s_mul_i32 s63, s3, 10
    s_add_u32 s62, s62, s63
L_job:
    s_cmp_lt_u32 s62, 59
    s_cbranch_scc0 L_end
    s_mov_b32 s12, s101
    s_lshl_b32 s13, s62, 9
    s_add_u32 s13, s13, 196608
    s_cmp_lt_u32 s62, 27
    s_cselect_b32 s63, 0, 27
    s_cselect_b32 s3, 7, 6
    s_cmp_lt_u32 s62, 54
    s_cselect_b32 s63, s63, 32
    s_cselect_b32 s3, s3, 5
    s_sub_u32 s35, s62, s63
    s_mov_b32 s34, 2
    s_lshr_b32 s36, s35, 3
    s_add_u32 s36, s36, 8
    s_bfe_u32 s37, s35, 0x20001
    s_and_b32 s38, s35, 1
    s_mov_b32 s59, 0
    s_branch L_stream
L_nojob:
    s_barrier
    s_cmp_ge_u32 s35, 22
    s_cbranch_scc1 L_h_t1
    s_cmp_eq_u32 s39, 1
    s_cbranch_scc1 L_h_role
    s_cmp_lt_u32 s96, 144
    s_cbranch_scc1 L_unit
    s_cmp_eq_u32 s3, 3
    s_cbranch_scc1 L_service
    s_endpgm
L_unit:
    v_lshrrev_b32 v3, 4, v0
    v_and_b32 v4, 3, v0
    v_bfe_u32 v7, v0, 2, 2
    v_lshlrev_b32 v64, 5, v7
    v_lshl_add_u32 v64, v3, 3, v64
    s_mov_b32 s14, s3
    s_mov_b32 s15, 3
    s_sub_u32 s62, s96, 40
    s_cmp_lt_u32 s62, 64
    s_cbranch_scc1 L_u_q
    s_mov_b32 s100, 1
    s_sub_u32 s96, s96, 84
    s_mov_b32 s12, 10240
    s_cmp_lt_u32 s56, 40
    s_cbranch_scc0 L_u_full
    s_mov_b32 s100, 0
    s_lshr_b32 s96, s56, 1
    s_and_b32 s62, s56, 1
    s_lshl1_add_u32 s14, s62, s14
    s_mov_b32 s15, 1
    s_cmp_ge_u32 s96, 10
    s_addc_u32 s62, s62, 0
    s_mul_i32 s12, s62, 5120
    s_add_u32 s12, s12, 0
L_u_full:
    s_mov_b32 s97, 0
    s_mov_b32 s99, 7680
    s_mov_b32 s48, s26
    s_mov_b32 s49, s27
    s_mov_b32 s50, 4915200
    s_mov_b32 s51, 0x20000
    s_mov_b32 s52, s24
    s_mov_b32 s53, s25
    s_mov_b32 s54, 5120
    s_mov_b32 s55, 0x20000
    v_and_b32 v6, 15, v0
    v_lshlrev_b32 v6, 4, v6
    v_mul_u32_u24 v5, 1280, v3
    v_add_u32 v5, v5, v6
    s_mul_i32 s62, s14, 320
    buffer_load_dwordx4 v[8:11], v5, s[52:55], s62 offen
    s_mov_b32 exec_lo, 0x000f000f
    s_mov_b32 exec_hi, 0x000f000f
    buffer_load_dwordx4 v[12:15], v5, s[52:55], s62 offen offset:256
    s_mov_b64 exec, -1
    s_lshl_b32 s98, s96, 7
    s_mul_i32 s13, s96, 0x199a
    s_lshr_b32 s13, s13, 16
    s_mul_i32 s63, s13, 3840
    s_add_u32 s57, s98, s63
    s_add_u32 s57, s57, s12
    v_mul_u32_u24 v5, 1280, v4
    v_add_u32 v64, v64, v5
    s_cmp_lg_u32 s13, 1
    s_cbranch_scc1 L_u_go
    s_mov_b32 s52, s4
    s_mov_b32 s53, s5
    s_mov_b32 s54, 5120
    s_mov_b32 s55, 0x20000
    v_lshrrev_b32 v6, 2, v0
    v_lshl_add_u32 v6, v6, 4, v5
    s_sub_u32 s62, s98, 1280
    buffer_load_dwordx4 v[16:19], v6, s[52:55], 0 offen offset:0
    buffer_load_dwordx4 v[20:23], v6, s[52:55], 0 offen offset:256
    buffer_load_dwordx4 v[24:27], v6, s[52:55], 0 offen offset:512
    buffer_load_dwordx4 v[28:31], v6, s[52:55], 0 offen offset:768
    buffer_load_dwordx4 v[32:35], v6, s[52:55], 0 offen offset:1024
    buffer_load_dwordx2 v[66:67], v64, s[52:55], s62 offen
    s_branch L_u_go
L_u_q:
    s_mov_b32 s97, 1
    s_mov_b32 s99, 8192
    s_mov_b32 s100, 0
    s_lshl_b32 s98, s62, 7
    s_add_u32 s57, s98, 40960
    v_lshl_add_u32 v64, v4, 13, v64
    s_mov_b32 s48, s10
    s_mov_b32 s49, s11
    s_mov_b32 s50, 5242880
    s_mov_b32 s51, 0x20000
L_u_go:
    v_lshrrev_b32 v6, 3, v0
    v_mul_lo_u32 v1, v6, s99
    v_and_b32 v6, 2, v6
    v_xor_b32 v6, v6, v0
    v_and_b32 v6, 7, v6
    v_lshl_add_u32 v1, v6, 4, v1
    v_add_u32 v1, s98, v1
    v_xor_b32 v2, 64, v1
    s_mul_i32 s63, s99, s14
    s_mul_i32 s63, s63, 160
    s_lshl_b32 s59, s99, 3
    s_mov_b32 m0, s101
    s_mov_b32 s62, 10
L_dma_111:
    buffer_load_dwordx4 v1, s[48:51], s63 offen nt lds
    s_add_u32 m0, m0, 1024
    s_add_u32 s63, s63, s59
    s_cmp_eq_u32 s100, 0
    s_cbranch_scc1 L_dma_111n0
    s_waitcnt vmcnt(1)
    s_cmp_eq_u32 s100, 2
    s_cbranch_scc1 L_dma_111n0
    s_waitcnt vmcnt(1)
L_dma_111n0:
    buffer_load_dwordx4 v2, s[48:51], s63 offen nt lds
    s_add_u32 m0, m0, 1024
    s_add_u32 s63, s63, s59
    s_cmp_eq_u32 s100, 0
    s_cbranch_scc1 L_dma_111n1
    s_waitcnt vmcnt(1)
    s_cmp_eq_u32 s100, 2
    s_cbranch_scc1 L_dma_111n1
    s_waitcnt vmcnt(1)
L_dma_111n1:
    s_sub_u32 s62, s62, 1
    s_cmp_lg_u32 s62, 0
    s_cbranch_scc1 L_dma_111
    v_min_u32 v65, 29, v0
    v_lshlrev_b32 v65, 2, v65
    s_cmp_lt_u32 s56, 104
    s_cselect_b32 s62, 32, 64
    v_min_u32 v6, 51, v0
    v_lshlrev_b32 v6, 2, v6
    v_cmp_le_u32 vcc, s62, v0
    s_nop 1
    v_cndmask_b32 v65, v65, v6, vcc
    v_mov_b32 v68, -1
    s_cmp_lt_u32 s56, 40
    s_cbranch_scc1 L_u_nofl
    buffer_load_dword v68, v65, s[44:47], 0 offen sc1
L_u_nofl:
    s_cmp_lt_u32 s56, 104
    s_cbranch_scc0 L_u_nob
    s_barrier
L_u_nob:
    v_lshrrev_b32 v60, 4, v0
    v_lshlrev_b32 v60, 10, v60
    v_bfe_u32 v6, v0, 2, 2
    v_lshl_add_u32 v60, v6, 7, v60
    v_and_b32 v6, 3, v0
    v_lshl_add_u32 v60, v6, 3, v60
    v_bfe_u32 v6, v0, 3, 2
    v_lshl_add_u32 v60, v6, 5, v60
    v_xor_b32 v61, 32, v60
    v_xor_b32 v62, 64, v60
    v_xor_b32 v63, 0x60, v60
    v_add_u32 v60, s101, v60
    v_add_u32 v61, s101, v61
    v_add_u32 v62, s101, v62
    v_add_u32 v63, s101, v63
    v_mov_b32 v56, 1.0
    v_mov_b32 v57, 1.0
    v_mov_b32 v58, 1.0
    v_mov_b32 v59, 1.0
    s_mov_b32 s58, 0
    s_cmp_eq_u32 s97, 1
    s_cbranch_scc1 L_u_q2
    s_cmp_eq_u32 s13, 4
    s_cselect_b32 s58, 1.0, 0
    s_cmp_lt_u32 s14, 2
    s_cselect_b32 s62, 1.0, 0
    s_cmp_eq_u32 s13, 1
    s_cselect_b32 s58, s62, s58
    s_cselect_b32 s56, 1, 0
    s_waitcnt vmcnt(20)
    s_mov_b32 s62, 0xbfb8aa3b
    v_lshlrev_b32 v40, 16, v8
    v_and_b32 v41, 0xffff0000, v8
    v_lshlrev_b32 v42, 16, v9
    v_and_b32 v43, 0xffff0000, v9
    v_lshlrev_b32 v44, 16, v10
    v_and_b32 v45, 0xffff0000, v10
    v_lshlrev_b32 v46, 16, v11
    v_and_b32 v47, 0xffff0000, v11
    v_mul_f32 v48, s62, v40
    v_mul_f32 v49, s62, v41
    v_mul_f32 v50, s62, v42
    v_mul_f32 v51, s62, v43
    v_mul_f32 v52, s62, v44
    v_mul_f32 v53, s62, v45
    v_mul_f32 v54, s62, v46
    v_mul_f32 v55, s62, v47
    v_exp_f32 v48, v48
    v_exp_f32 v49, v49
    v_exp_f32 v50, v50
    v_exp_f32 v51, v51
    v_exp_f32 v52, v52
    v_exp_f32 v53, v53
    v_exp_f32 v54, v54
    v_exp_f32 v55, v55
    v_add_f32 v48, 1.0, v48
    v_add_f32 v49, 1.0, v49
    v_add_f32 v50, 1.0, v50
    v_add_f32 v51, 1.0, v51
    v_add_f32 v52, 1.0, v52
    v_add_f32 v53, 1.0, v53
    v_add_f32 v54, 1.0, v54
    v_add_f32 v55, 1.0, v55
    v_rcp_f32 v48, v48
    v_rcp_f32 v49, v49
    v_rcp_f32 v50, v50
    v_rcp_f32 v51, v51
    v_rcp_f32 v52, v52
    v_rcp_f32 v53, v53
    v_rcp_f32 v54, v54
    v_rcp_f32 v55, v55
    v_mul_f32 v40, v40, v48
    v_mul_f32 v41, v41, v49
    v_mul_f32 v42, v42, v50
    v_mul_f32 v43, v43, v51
    v_mul_f32 v44, v44, v52
    v_mul_f32 v45, v45, v53
    v_mul_f32 v46, v46, v54
    v_mul_f32 v47, v47, v55
    v_cvt_pk_bf16_f32 v8, v40, v41
    v_cvt_pk_bf16_f32 v9, v42, v43
    v_cvt_pk_bf16_f32 v10, v44, v45
    v_cvt_pk_bf16_f32 v11, v46, v47
    v_lshlrev_b32 v40, 16, v12
    v_and_b32 v41, 0xffff0000, v12
    v_lshlrev_b32 v42, 16, v13
    v_and_b32 v43, 0xffff0000, v13
    v_lshlrev_b32 v44, 16, v14
    v_and_b32 v45, 0xffff0000, v14
    v_lshlrev_b32 v46, 16, v15
    v_and_b32 v47, 0xffff0000, v15
    v_mul_f32 v48, s62, v40
    v_mul_f32 v49, s62, v41
    v_mul_f32 v50, s62, v42
    v_mul_f32 v51, s62, v43
    v_mul_f32 v52, s62, v44
    v_mul_f32 v53, s62, v45
    v_mul_f32 v54, s62, v46
    v_mul_f32 v55, s62, v47
    v_exp_f32 v48, v48
    v_exp_f32 v49, v49
    v_exp_f32 v50, v50
    v_exp_f32 v51, v51
    v_exp_f32 v52, v52
    v_exp_f32 v53, v53
    v_exp_f32 v54, v54
    v_exp_f32 v55, v55
    v_add_f32 v48, 1.0, v48
    v_add_f32 v49, 1.0, v49
    v_add_f32 v50, 1.0, v50
    v_add_f32 v51, 1.0, v51
    v_add_f32 v52, 1.0, v52
    v_add_f32 v53, 1.0, v53
    v_add_f32 v54, 1.0, v54
    v_add_f32 v55, 1.0, v55
    v_rcp_f32 v48, v48
    v_rcp_f32 v49, v49
    v_rcp_f32 v50, v50
    v_rcp_f32 v51, v51
    v_rcp_f32 v52, v52
    v_rcp_f32 v53, v53
    v_rcp_f32 v54, v54
    v_rcp_f32 v55, v55
    v_mul_f32 v40, v40, v48
    v_mul_f32 v41, v41, v49
    v_mul_f32 v42, v42, v50
    v_mul_f32 v43, v43, v51
    v_mul_f32 v44, v44, v52
    v_mul_f32 v45, v45, v53
    v_mul_f32 v46, v46, v54
    v_mul_f32 v47, v47, v55
    v_cvt_pk_bf16_f32 v12, v40, v41
    v_cvt_pk_bf16_f32 v13, v42, v43
    v_cvt_pk_bf16_f32 v14, v44, v45
    v_cvt_pk_bf16_f32 v15, v46, v47
    s_mul_i32 s62, s3, 1344
    s_add_u32 s62, s62, 151552
    v_mul_u32_u24 v5, 336, v3
    v_and_b32 v6, 15, v0
    v_lshl_add_u32 v5, v6, 4, v5
    v_add_u32 v5, s62, v5
    ds_write_b128 v5, v[8:11]
    s_mov_b32 exec_lo, 0x000f000f
    s_mov_b32 exec_hi, 0x000f000f
    ds_write_b128 v5, v[12:15] offset:256
    s_mov_b64 exec, -1
    v_mul_u32_u24 v5, 336, v4
    v_lshl_add_u32 v5, v3, 4, v5
    v_add_u32 v5, s62, v5
    s_mov_b32 s59, 0x3e800000
    s_cmp_eq_u32 s56, 0
    s_cbranch_scc1 L_u_nost
    v_mov_b32 v40, 0
    v_mov_b32 v41, 0
    s_mov_b32 s62, 0x3f803f80
    v_dot2c_f32_bf16 v40, s62, v16
    v_dot2c_f32_bf16 v41, v16, v16
    v_dot2c_f32_bf16 v40, s62, v17
    v_dot2c_f32_bf16 v41, v17, v17
    v_dot2c_f32_bf16 v40, s62, v18
    v_dot2c_f32_bf16 v41, v18, v18
    v_dot2c_f32_bf16 v40, s62, v19
    v_dot2c_f32_bf16 v41, v19, v19
    v_dot2c_f32_bf16 v40, s62, v20
    v_dot2c_f32_bf16 v41, v20, v20
    v_dot2c_f32_bf16 v40, s62, v21
    v_dot2c_f32_bf16 v41, v21, v21
    v_dot2c_f32_bf16 v40, s62, v22
    v_dot2c_f32_bf16 v41, v22, v22
    v_dot2c_f32_bf16 v40, s62, v23
    v_dot2c_f32_bf16 v41, v23, v23
    v_dot2c_f32_bf16 v40, s62, v24
    v_dot2c_f32_bf16 v41, v24, v24
    v_dot2c_f32_bf16 v40, s62, v25
    v_dot2c_f32_bf16 v41, v25, v25
    v_dot2c_f32_bf16 v40, s62, v26
    v_dot2c_f32_bf16 v41, v26, v26
    v_dot2c_f32_bf16 v40, s62, v27
    v_dot2c_f32_bf16 v41, v27, v27
    v_dot2c_f32_bf16 v40, s62, v28
    v_dot2c_f32_bf16 v41, v28, v28
    v_dot2c_f32_bf16 v40, s62, v29
    v_dot2c_f32_bf16 v41, v29, v29
    v_dot2c_f32_bf16 v40, s62, v30
    v_dot2c_f32_bf16 v41, v30, v30
    v_dot2c_f32_bf16 v40, s62, v31
    v_dot2c_f32_bf16 v41, v31, v31
    v_dot2c_f32_bf16 v40, s62, v32
    v_dot2c_f32_bf16 v41, v32, v32
    v_dot2c_f32_bf16 v40, s62, v33
    v_dot2c_f32_bf16 v41, v33, v33
    v_dot2c_f32_bf16 v40, s62, v34
    v_dot2c_f32_bf16 v41, v34, v34
    v_dot2c_f32_bf16 v40, s62, v35
    v_dot2c_f32_bf16 v41, v35, v35
    s_nop 1
    v_add_f32_dpp v40, v40, v40 row_ror:4 row_mask:0xf bank_mask:0xf
    v_add_f32_dpp v41, v41, v41 row_ror:4 row_mask:0xf bank_mask:0xf
    s_nop 0
    v_add_f32_dpp v40, v40, v40 row_ror:8 row_mask:0xf bank_mask:0xf
    v_add_f32_dpp v41, v41, v41 row_ror:8 row_mask:0xf bank_mask:0xf
    v_mov_b32 v42, v40
    v_mov_b32 v43, v41
    s_nop 0
    v_permlane16_swap_b32 v40, v42
    v_permlane16_swap_b32 v41, v43
    v_add_f32 v40, v40, v42
    v_add_f32 v41, v41, v43
    v_mov_b32 v42, v40
    v_mov_b32 v43, v41
    s_nop 0
    v_permlane32_swap_b32 v40, v42
    v_permlane32_swap_b32 v41, v43
    v_add_f32 v40, v40, v42
    v_add_f32 v41, v41, v43
    s_mov_b32 s62, 0x3acccccd
    v_mul_f32 v40, s62, v40
    v_mul_f32 v41, s62, v41
    v_fma_f32 v41, -v40, v40, v41
    v_max_f32 v41, 0, v41
    v_add_f32 v41, 0x3727c5ac, v41
    v_rsq_f32 v41, v41
    v_lshlrev_b32 v56, 16, v66
    v_and_b32 v57, 0xffff0000, v66
    v_lshlrev_b32 v58, 16, v67
    v_and_b32 v59, 0xffff0000, v67
    v_sub_f32 v56, v56, v40
    v_sub_f32 v57, v57, v40
    v_sub_f32 v58, v58, v40
    v_sub_f32 v59, v59, v40
    v_mul_f32 v56, v56, v41
    v_mul_f32 v57, v57, v41
    v_mul_f32 v58, v58, v41
    v_mul_f32 v59, v59, v41
L_u_nost:
    ds_read_b128 v[8:11], v5 offset:0
    ds_read_b128 v[12:15], v5 offset:64
    ds_read_b128 v[16:19], v5 offset:128
    ds_read_b128 v[20:23], v5 offset:192
    ds_read_b128 v[24:27], v5 offset:256
    s_branch L_u_frag
L_u_q2:
    v_and_b32 v5, 15, v0
    v_mul_u32_u24 v5, 1280, v5
    v_lshl_add_u32 v5, v3, 4, v5
    s_mul_i32 s63, s3, 320
    s_add_u32 s63, s63, 0
    s_mov_b32 s59, 1.0
L_u_frag:
    s_waitcnt vmcnt(0)
    v_cmp_ne_u32 vcc, -1, v68
    s_cbranch_vccz L_u_yok
L_wy_112:
    buffer_load_dword v37, v65, s[44:47], 0 offen sc1
    s_waitcnt vmcnt(0)
    v_cmp_ne_u32 vcc, -1, v37
    s_cbranch_vccz L_wy_112e
    s_sleep 4
    s_sub_u32 s60, s60, 1
    s_cbranch_scc0 L_wy_112
    s_mov_b32 s60, 0
L_wy_112e:
L_u_yok:
    ds_read_b64_tr_b16 v[80:81], v60 offset:0
    ds_read_b64_tr_b16 v[82:83], v60 offset:512
    ds_read_b64_tr_b16 v[84:85], v61 offset:0
    ds_read_b64_tr_b16 v[86:87], v61 offset:512
    ds_read_b64_tr_b16 v[88:89], v62 offset:0
    ds_read_b64_tr_b16 v[90:91], v62 offset:512
    ds_read_b64_tr_b16 v[92:93], v63 offset:0
    ds_read_b64_tr_b16 v[94:95], v63 offset:512
    ds_read_b64_tr_b16 v[96:97], v60 offset:4096
    ds_read_b64_tr_b16 v[98:99], v60 offset:4608
    ds_read_b64_tr_b16 v[100:101], v61 offset:4096
    ds_read_b64_tr_b16 v[102:103], v61 offset:4608
    ds_read_b64_tr_b16 v[104:105], v62 offset:4096
    ds_read_b64_tr_b16 v[106:107], v62 offset:4608
    ds_read_b64_tr_b16 v[108:109], v63 offset:4096
    ds_read_b64_tr_b16 v[110:111], v63 offset:4608
    ds_read_b64_tr_b16 v[112:113], v60 offset:8192
    ds_read_b64_tr_b16 v[114:115], v60 offset:8704
    ds_read_b64_tr_b16 v[116:117], v61 offset:8192
    ds_read_b64_tr_b16 v[118:119], v61 offset:8704
    ds_read_b64_tr_b16 v[120:121], v62 offset:8192
    ds_read_b64_tr_b16 v[122:123], v62 offset:8704
    ds_read_b64_tr_b16 v[124:125], v63 offset:8192
    ds_read_b64_tr_b16 v[126:127], v63 offset:8704
    ds_read_b64_tr_b16 v[128:129], v60 offset:12288
    ds_read_b64_tr_b16 v[130:131], v60 offset:12800
    ds_read_b64_tr_b16 v[132:133], v61 offset:12288
    ds_read_b64_tr_b16 v[134:135], v61 offset:12800
    ds_read_b64_tr_b16 v[136:137], v62 offset:12288
    ds_read_b64_tr_b16 v[138:139], v62 offset:12800
    ds_read_b64_tr_b16 v[140:141], v63 offset:12288
    ds_read_b64_tr_b16 v[142:143], v63 offset:12800
    ds_read_b64_tr_b16 v[144:145], v60 offset:16384
    ds_read_b64_tr_b16 v[146:147], v60 offset:16896
    ds_read_b64_tr_b16 v[148:149], v61 offset:16384
    ds_read_b64_tr_b16 v[150:151], v61 offset:16896
    ds_read_b64_tr_b16 v[152:153], v62 offset:16384
    ds_read_b64_tr_b16 v[154:155], v62 offset:16896
    ds_read_b64_tr_b16 v[156:157], v63 offset:16384
    ds_read_b64_tr_b16 v[158:159], v63 offset:16896
    s_cmp_eq_u32 s97, 0
    s_cbranch_scc1 L_u_mm
    v_lshrrev_b32 v6, 2, v0
    v_mul_u32_u24 v6, 158, v6
    v_and_b32 v6, 0xfffc, v6
    v_and_b32 v7, 3, v0
    v_mul_u32_u24 v7, 5120, v7
    v_add_u32 v6, v6, v7
    s_mov_b64 exec, 0xfff
L_poll_113:
    buffer_load_dword v8, v6, s[40:43], s63 offen offset:3840 sc1
    s_waitcnt vmcnt(0)
    v_cmp_eq_u32 vcc, -1, v8
    s_cbranch_vccz L_poll_113e
    s_sleep 4
    s_sub_u32 s60, s60, 1
    s_cbranch_scc0 L_poll_113
    s_mov_b32 s60, 0
L_poll_113e:
    s_mov_b64 exec, -1
L_poll_114:
    buffer_load_dwordx4 v[8:11], v5, s[40:43], s63 offen offset:0 sc1
    buffer_load_dwordx4 v[12:15], v5, s[40:43], s63 offen offset:64 sc1
    buffer_load_dwordx4 v[16:19], v5, s[40:43], s63 offen offset:128 sc1
    buffer_load_dwordx4 v[20:23], v5, s[40:43], s63 offen offset:192 sc1
    buffer_load_dwordx4 v[24:27], v5, s[40:43], s63 offen offset:256 sc1
    s_waitcnt vmcnt(0)
    v_max3_u32 v37, v8, v9, v10
    v_max3_u32 v37, v37, v11, v12
    v_max3_u32 v37, v37, v13, v14
    v_max3_u32 v37, v37, v15, v16
    v_max3_u32 v37, v37, v17, v18
    v_max3_u32 v37, v37, v19, v20
    v_max3_u32 v37, v37, v21, v22
    v_max3_u32 v37, v37, v23, v24
    v_max3_u32 v37, v37, v25, v26
    v_max_u32 v37, v37, v27
    v_cmp_eq_u32 vcc, -1, v37
    s_cbranch_vccz L_poll_114e
    s_sleep 1
    s_sub_u32 s60, s60, 1
    s_cbranch_scc0 L_poll_114
    s_mov_b32 s60, 0
L_poll_114e:
L_u_got:
L_u_mm:
    s_waitcnt lgkmcnt(0)
    v_mfma_f32_16x16x32_bf16 v[40:43], v[80:83], v[8:11], 0
    v_mfma_f32_16x16x32_bf16 v[44:47], v[84:87], v[8:11], 0
    v_mfma_f32_16x16x32_bf16 v[48:51], v[88:91], v[8:11], 0
    v_mfma_f32_16x16x32_bf16 v[52:55], v[92:95], v[8:11], 0
    v_mfma_f32_16x16x32_bf16 v[40:43], v[96:99], v[12:15], v[40:43]
    v_mfma_f32_16x16x32_bf16 v[44:47], v[100:103], v[12:15], v[44:47]
    v_mfma_f32_16x16x32_bf16 v[48:51], v[104:107], v[12:15], v[48:51]
    v_mfma_f32_16x16x32_bf16 v[52:55], v[108:111], v[12:15], v[52:55]
    v_mfma_f32_16x16x32_bf16 v[40:43], v[112:115], v[16:19], v[40:43]
    v_mfma_f32_16x16x32_bf16 v[44:47], v[116:119], v[16:19], v[44:47]
    v_mfma_f32_16x16x32_bf16 v[48:51], v[120:123], v[16:19], v[48:51]
    v_mfma_f32_16x16x32_bf16 v[52:55], v[124:127], v[16:19], v[52:55]
    v_mfma_f32_16x16x32_bf16 v[40:43], v[128:131], v[20:23], v[40:43]
    v_mfma_f32_16x16x32_bf16 v[44:47], v[132:135], v[20:23], v[44:47]
    v_mfma_f32_16x16x32_bf16 v[48:51], v[136:139], v[20:23], v[48:51]
    v_mfma_f32_16x16x32_bf16 v[52:55], v[140:143], v[20:23], v[52:55]
    v_mfma_f32_16x16x32_bf16 v[40:43], v[144:147], v[24:27], v[40:43]
    v_mfma_f32_16x16x32_bf16 v[44:47], v[148:151], v[24:27], v[44:47]
    v_mfma_f32_16x16x32_bf16 v[48:51], v[152:155], v[24:27], v[48:51]
    v_mfma_f32_16x16x32_bf16 v[52:55], v[156:159], v[24:27], v[52:55]
    v_lshlrev_b32 v5, 4, v0
    v_add_u32 v5, 147456, v5
    s_lshl_b32 s62, s3, 10
    v_add_u32 v6, s62, v5
    v_mov_b32 v32, 162056
    v_mov_b32 v33, 1
    v_add_f32_dpp v40, v40, v40 row_ror:8 row_mask:0xf bank_mask:0xf
    v_add_f32_dpp v41, v41, v41 row_ror:8 row_mask:0xf bank_mask:0xf
    v_add_f32_dpp v42, v42, v42 row_ror:8 row_mask:0xf bank_mask:0xf
    v_add_f32_dpp v43, v43, v43 row_ror:8 row_mask:0xf bank_mask:0xf
    v_add_f32_dpp v44, v44, v44 row_ror:8 row_mask:0xf bank_mask:0xf
    v_add_f32_dpp v45, v45, v45 row_ror:8 row_mask:0xf bank_mask:0xf
    v_add_f32_dpp v46, v46, v46 row_ror:8 row_mask:0xf bank_mask:0xf
    v_add_f32_dpp v47, v47, v47 row_ror:8 row_mask:0xf bank_mask:0xf
    v_add_f32_dpp v48, v48, v48 row_ror:8 row_mask:0xf bank_mask:0xf
    v_add_f32_dpp v49, v49, v49 row_ror:8 row_mask:0xf bank_mask:0xf
    v_add_f32_dpp v50, v50, v50 row_ror:8 row_mask:0xf bank_mask:0xf
    v_add_f32_dpp v51, v51, v51 row_ror:8 row_mask:0xf bank_mask:0xf
    v_add_f32_dpp v52, v52, v52 row_ror:8 row_mask:0xf bank_mask:0xf
    v_add_f32_dpp v53, v53, v53 row_ror:8 row_mask:0xf bank_mask:0xf
    v_add_f32_dpp v54, v54, v54 row_ror:8 row_mask:0xf bank_mask:0xf
    v_add_f32_dpp v55, v55, v55 row_ror:8 row_mask:0xf bank_mask:0xf
    v_add_f32_dpp v28, v40, v40 row_ror:4 row_mask:0xf bank_mask:0x1
    v_add_f32_dpp v29, v41, v41 row_ror:4 row_mask:0xf bank_mask:0x1
    v_add_f32_dpp v30, v42, v42 row_ror:4 row_mask:0xf bank_mask:0x1
    v_add_f32_dpp v31, v43, v43 row_ror:4 row_mask:0xf bank_mask:0x1
    v_add_f32_dpp v28, v44, v44 row_ror:4 row_mask:0xf bank_mask:0x2
    v_add_f32_dpp v29, v45, v45 row_ror:4 row_mask:0xf bank_mask:0x2
    v_add_f32_dpp v30, v46, v46 row_ror:4 row_mask:0xf bank_mask:0x2
    v_add_f32_dpp v31, v47, v47 row_ror:4 row_mask:0xf bank_mask:0x2
    v_add_f32_dpp v28, v48, v48 row_ror:4 row_mask:0xf bank_mask:0x4
    v_add_f32_dpp v29, v49, v49 row_ror:4 row_mask:0xf bank_mask:0x4
    v_add_f32_dpp v30, v50, v50 row_ror:4 row_mask:0xf bank_mask:0x4
    v_add_f32_dpp v31, v51, v51 row_ror:4 row_mask:0xf bank_mask:0x4
    v_add_f32_dpp v28, v52, v52 row_ror:4 row_mask:0xf bank_mask:0x8
    v_add_f32_dpp v29, v53, v53 row_ror:4 row_mask:0xf bank_mask:0x8
    v_add_f32_dpp v30, v54, v54 row_ror:4 row_mask:0xf bank_mask:0x8
    v_add_f32_dpp v31, v55, v55 row_ror:4 row_mask:0xf bank_mask:0x8
    ds_write_b128 v6, v[28:31]
    s_mov_b64 exec, 1
    ds_add_rtn_u32 v34, v32, v33
    s_mov_b64 exec, -1
    ds_read_b128 v[8:11], v5
    ds_read_b128 v[12:15], v5 offset:1024
    ds_read_b128 v[16:19], v5 offset:2048
    ds_read_b128 v[20:23], v5 offset:3072
    s_waitcnt lgkmcnt(0)
    v_readfirstlane_b32 s62, v34
    v_mov_b32 v24, s58
    s_cmp_eq_u32 s62, s15
    s_cbranch_scc1 L_u_last
    s_cmp_eq_u32 s62, 1
    s_cbranch_scc1 L_service
    s_endpgm
L_u_last:
    v_add_f32 v8, v8, v12
    v_add_f32 v9, v9, v13
    v_add_f32 v10, v10, v14
    v_add_f32 v11, v11, v15
    s_cmp_eq_u32 s15, 1
    s_cbranch_scc1 L_u_two
    v_add_f32 v16, v16, v20
    v_add_f32 v17, v17, v21
    v_add_f32 v18, v18, v22
    v_add_f32 v19, v19, v23
    v_add_f32 v8, v8, v16
    v_add_f32 v9, v9, v17
    v_add_f32 v10, v10, v18
    v_add_f32 v11, v11, v19
L_u_two:
    v_fma_f32 v8, v8, s59, v24
    v_fma_f32 v9, v9, s59, v24
    v_fma_f32 v10, v10, s59, v24
    v_fma_f32 v11, v11, s59, v24
    v_mul_f32 v8, v8, v56
    v_mul_f32 v9, v9, v57
    v_mul_f32 v10, v10, v58
    v_mul_f32 v11, v11, v59
    v_cvt_pk_bf16_f32 v8, v8, v9
    v_cvt_pk_bf16_f32 v9, v10, v11
    buffer_store_dwordx2 v[8:9], v64, s[40:43], s57 offen sc1
    s_endpgm
L_h_t1:
    s_cmp_lg_u32 s3, 3
    s_cbranch_scc1 L_h_noclr
    s_sub_u32 s62, s56, 154
    s_cmp_lt_u32 s62, 30
    s_cbranch_scc0 L_h_noclr
    s_lshl_b32 s63, s62, 2
    s_mul_i32 s62, s62, 7168
    s_add_u32 s62, s62, 20480
    v_mov_b32 v4, -1
    v_mov_b32 v5, -1
    v_mov_b32 v6, -1
    v_mov_b32 v7, -1
    v_lshlrev_b32 v8, 4, v0
    buffer_store_dwordx4 v[4:7], v8, s[40:43], s62 offen offset:0 sc1
    buffer_store_dwordx4 v[4:7], v8, s[40:43], s62 offen offset:1024 sc1
    buffer_store_dwordx4 v[4:7], v8, s[40:43], s62 offen offset:2048 sc1
    buffer_store_dwordx4 v[4:7], v8, s[40:43], s62 offen offset:3072 sc1
    s_add_u32 s62, s62, 4096
    buffer_store_dwordx4 v[4:7], v8, s[40:43], s62 offen offset:0 sc1
    buffer_store_dwordx4 v[4:7], v8, s[40:43], s62 offen offset:1024 sc1
    buffer_store_dwordx4 v[4:7], v8, s[40:43], s62 offen offset:2048 sc1
    v_mov_b32 v8, s63
    s_waitcnt vmcnt(0)
    s_mov_b64 exec, 1
    buffer_store_dword v4, v8, s[44:47], 0 offen sc1
    s_mov_b64 exec, -1
L_h_noclr:
    v_lshrrev_b32 v1, 3, v0
    v_mul_u32_u24 v1, 1280, v1
    v_and_b32 v2, 7, v0
    v_lshl_add_u32 v1, v2, 4, v1
    s_lshl2_add_u32 s63, s34, s3
    s_mul_i32 s63, s63, 163840
    s_lshl_b32 s62, s35, 7
    s_add_u32 s63, s63, s62
    s_sub_u32 s63, s63, 2816
    s_lshl_b32 s62, s3, 14
    s_add_u32 s62, s62, 81920
    s_mov_b32 m0, s62
    s_mov_b32 s48, s12
    s_mov_b32 s49, s13
    s_mov_b32 s50, 5242880
    s_mov_b32 s51, 0x20000
    s_add_u32 s100, s39, 1
    s_mov_b32 s62, 8
L_dma_115:
    buffer_load_dwordx4 v1, s[48:51], s63 offen nt lds
    s_add_u32 m0, m0, 1024
    s_add_u32 s63, s63, 10240
    s_cmp_eq_u32 s100, 0
    s_cbranch_scc1 L_dma_115n0
    s_waitcnt vmcnt(4)
    s_cmp_eq_u32 s100, 2
    s_cbranch_scc1 L_dma_115n0
    s_waitcnt vmcnt(1)
L_dma_115n0:
    buffer_load_dwordx4 v1, s[48:51], s63 offen nt lds
    s_add_u32 m0, m0, 1024
    s_add_u32 s63, s63, 10240
    s_cmp_eq_u32 s100, 0
    s_cbranch_scc1 L_dma_115n1
    s_waitcnt vmcnt(4)
    s_cmp_eq_u32 s100, 2
    s_cbranch_scc1 L_dma_115n1
    s_waitcnt vmcnt(1)
L_dma_115n1:
    s_sub_u32 s62, s62, 1
    s_cmp_lg_u32 s62, 0
    s_cbranch_scc1 L_dma_115
    s_cmp_eq_u32 s39, 1
    s_cbranch_scc1 L_h_role
    s_waitcnt vmcnt(0)
    v_mov_b32 v4, 162060
    v_mov_b32 v5, 1
    s_mov_b64 exec, 1
    ds_add_u32 v4, v5
    s_mov_b64 exec, -1
    s_cmp_eq_u32 s3, 0
    s_cbranch_scc1 L_service
    s_endpgm
L_h_role:
    v_lshrrev_b32 v3, 4, v0
    v_and_b32 v2, 3, v0
    v_bfe_u32 v1, v0, 2, 2
    v_mul_u32_u24 v160, 2560, v2
    v_lshl_add_u32 v160, v1, 6, v160
    v_lshl_add_u32 v160, v3, 4, v160
    s_mul_i32 s57, s35, 10240
    s_mul_i32 s62, s3, 640
    s_add_u32 s57, s57, s62
    s_add_u32 s57, s57, 262144
    v_mov_b32 v4, -1
    v_mov_b32 v5, -1
    v_mov_b32 v6, -1
    v_mov_b32 v7, -1
    buffer_store_dwordx4 v[4:7], v160, s[40:43], s57 offen sc1
    buffer_store_dwordx4 v[4:7], v160, s[40:43], s57 offen offset:256 sc1
    s_mov_b32 exec_lo, 0x00ff00ff
    s_mov_b32 exec_hi, 0x00ff00ff
    buffer_store_dwordx4 v[4:7], v160, s[40:43], s57 offen offset:512 sc1
    s_mov_b64 exec, -1
    v_add_u32 v8, 0, v0
    v_mul_u32_u24 v10, 0xccd, v8
    v_lshrrev_b32 v10, 16, v10
    v_mul_u32_u24 v9, 20, v10
    v_sub_u32 v8, v8, v9
    v_mul_u32_u24 v10, 1280, v10
    v_lshl_add_u32 v10, v8, 4, v10
    v_add_u32 v8, 64, v0
    v_mul_u32_u24 v11, 0xccd, v8
    v_lshrrev_b32 v11, 16, v11
    v_mul_u32_u24 v9, 20, v11
    v_sub_u32 v8, v8, v9
    v_mul_u32_u24 v11, 1280, v11
    v_lshl_add_u32 v11, v8, 4, v11
    v_add_u32 v8, 128, v0
    v_mul_u32_u24 v12, 0xccd, v8
    v_lshrrev_b32 v12, 16, v12
    v_mul_u32_u24 v9, 20, v12
    v_sub_u32 v8, v8, v9
    v_mul_u32_u24 v12, 1280, v12
    v_lshl_add_u32 v12, v8, 4, v12
    v_add_u32 v8, 192, v0
    v_mul_u32_u24 v13, 0xccd, v8
    v_lshrrev_b32 v13, 16, v13
    v_mul_u32_u24 v9, 20, v13
    v_sub_u32 v8, v8, v9
    v_mul_u32_u24 v13, 1280, v13
    v_lshl_add_u32 v13, v8, 4, v13
    v_add_u32 v8, 256, v0
    v_mul_u32_u24 v14, 0xccd, v8
    v_lshrrev_b32 v14, 16, v14
    v_mul_u32_u24 v9, 20, v14
    v_sub_u32 v8, v8, v9
    v_mul_u32_u24 v14, 1280, v14
    v_lshl_add_u32 v14, v8, 4, v14
    s_waitcnt vmcnt(0)
    v_mov_b32 v8, 162060
    v_mov_b32 v9, 1
    s_mov_b64 exec, 1
    ds_add_u32 v8, v9
    s_mov_b64 exec, -1
    s_mov_b32 s48, s20
    s_mov_b32 s49, s21
    s_mov_b32 s50, 2211840
    s_mov_b32 s51, 0x20000
    s_mul_i32 s63, s35, 81920
    s_mul_i32 s62, s3, 320
    s_add_u32 s63, s63, s62
    s_mov_b32 m0, s101
    s_mov_b32 s62, 4
L_w2dma:
    buffer_load_dwordx4 v10, s[48:51], s63 offen nt lds
    s_add_u32 m0, m0, 1024
    s_waitcnt vmcnt(4)
    s_cmp_ge_u32 s35, 22
    s_cbranch_scc1 L_w2n0
    s_waitcnt vmcnt(2)
L_w2n0:
    buffer_load_dwordx4 v11, s[48:51], s63 offen nt lds
    s_add_u32 m0, m0, 1024
    s_waitcnt vmcnt(4)
    s_cmp_ge_u32 s35, 22
    s_cbranch_scc1 L_w2n1
    s_waitcnt vmcnt(2)
L_w2n1:
    buffer_load_dwordx4 v12, s[48:51], s63 offen nt lds
    s_add_u32 m0, m0, 1024
    s_waitcnt vmcnt(4)
    s_cmp_ge_u32 s35, 22
    s_cbranch_scc1 L_w2n2
    s_waitcnt vmcnt(2)
L_w2n2:
    buffer_load_dwordx4 v13, s[48:51], s63 offen nt lds
    s_add_u32 m0, m0, 1024
    s_waitcnt vmcnt(4)
    s_cmp_ge_u32 s35, 22
    s_cbranch_scc1 L_w2n3
    s_waitcnt vmcnt(2)
L_w2n3:
    buffer_load_dwordx4 v14, s[48:51], s63 offen nt lds
    s_add_u32 m0, m0, 1024
    s_waitcnt vmcnt(4)
    s_cmp_ge_u32 s35, 22
    s_cbranch_scc1 L_w2n4
    s_waitcnt vmcnt(2)
L_w2n4:
    s_add_u32 s63, s63, 20480
    s_sub_u32 s62, s62, 1
    s_cmp_lg_u32 s62, 0
    s_cbranch_scc1 L_w2dma
    v_lshl_add_u32 v8, v3, 3, v1
    v_mul_u32_u24 v8, 320, v8
    v_lshl_add_u32 v8, v2, 3, v8
    v_add_u32 v8, s101, v8
    s_waitcnt vmcnt(0)
    ds_read_b64_tr_b16 v[80:81], v8 offset:0
    ds_read_b64_tr_b16 v[82:83], v8 offset:1280
    ds_read_b64_tr_b16 v[84:85], v8 offset:10240
    ds_read_b64_tr_b16 v[86:87], v8 offset:11520
    ds_read_b64_tr_b16 v[88:89], v8 offset:32
    ds_read_b64_tr_b16 v[90:91], v8 offset:1312
    ds_read_b64_tr_b16 v[92:93], v8 offset:10272
    ds_read_b64_tr_b16 v[94:95], v8 offset:11552
    ds_read_b64_tr_b16 v[96:97], v8 offset:64
    ds_read_b64_tr_b16 v[98:99], v8 offset:1344
    ds_read_b64_tr_b16 v[100:101], v8 offset:10304
    ds_read_b64_tr_b16 v[102:103], v8 offset:11584
    ds_read_b64_tr_b16 v[104:105], v8 offset:96
    ds_read_b64_tr_b16 v[106:107], v8 offset:1376
    ds_read_b64_tr_b16 v[108:109], v8 offset:10336
    ds_read_b64_tr_b16 v[110:111], v8 offset:11616
    ds_read_b64_tr_b16 v[112:113], v8 offset:128
    ds_read_b64_tr_b16 v[114:115], v8 offset:1408
    ds_read_b64_tr_b16 v[116:117], v8 offset:10368
    ds_read_b64_tr_b16 v[118:119], v8 offset:11648
    ds_read_b64_tr_b16 v[120:121], v8 offset:160
    ds_read_b64_tr_b16 v[122:123], v8 offset:1440
    ds_read_b64_tr_b16 v[124:125], v8 offset:10400
    ds_read_b64_tr_b16 v[126:127], v8 offset:11680
    ds_read_b64_tr_b16 v[128:129], v8 offset:192
    ds_read_b64_tr_b16 v[130:131], v8 offset:1472
    ds_read_b64_tr_b16 v[132:133], v8 offset:10432
    ds_read_b64_tr_b16 v[134:135], v8 offset:11712
    ds_read_b64_tr_b16 v[136:137], v8 offset:224
    ds_read_b64_tr_b16 v[138:139], v8 offset:1504
    ds_read_b64_tr_b16 v[140:141], v8 offset:10464
    ds_read_b64_tr_b16 v[142:143], v8 offset:11744
    ds_read_b64_tr_b16 v[144:145], v8 offset:256
    ds_read_b64_tr_b16 v[146:147], v8 offset:1536
    ds_read_b64_tr_b16 v[148:149], v8 offset:10496
    ds_read_b64_tr_b16 v[150:151], v8 offset:11776
    ds_read_b64_tr_b16 v[152:153], v8 offset:288
    ds_read_b64_tr_b16 v[154:155], v8 offset:1568
    ds_read_b64_tr_b16 v[156:157], v8 offset:10528
    ds_read_b64_tr_b16 v[158:159], v8 offset:11808
    s_mov_b32 s48, s16
    s_mov_b32 s49, s17
    s_mov_b32 s50, 2211840
    s_mov_b32 s51, 0x20000
    s_lshl_b32 s98, s35, 7
    s_mov_b32 s99, 3456
    v_lshrrev_b32 v9, 3, v0
    v_mul_lo_u32 v10, v9, s99
    v_and_b32 v9, 2, v9
    v_xor_b32 v9, v9, v0
    v_and_b32 v9, 7, v9
    v_lshl_add_u32 v10, v9, 4, v10
    v_add_u32 v10, s98, v10
    v_xor_b32 v11, 64, v10
    s_mul_i32 s63, s3, 552960
    s_mov_b32 m0, s101
    s_waitcnt lgkmcnt(0)
    s_cmp_ge_u32 s35, 22
    s_cselect_b32 s100, 2, 1
    s_mov_b32 s62, 10
L_dma_116:
    buffer_load_dwordx4 v10, s[48:51], s63 offen nt lds
    s_add_u32 m0, m0, 1024
    s_add_u32 s63, s63, 27648
    s_cmp_eq_u32 s100, 0
    s_cbranch_scc1 L_dma_116n0
    s_waitcnt vmcnt(4)
    s_cmp_eq_u32 s100, 2
    s_cbranch_scc1 L_dma_116n0
    s_waitcnt vmcnt(2)
L_dma_116n0:
    buffer_load_dwordx4 v11, s[48:51], s63 offen nt lds
    s_add_u32 m0, m0, 1024
    s_add_u32 s63, s63, 27648
    s_cmp_eq_u32 s100, 0
    s_cbranch_scc1 L_dma_116n1
    s_waitcnt vmcnt(4)
    s_cmp_eq_u32 s100, 2
    s_cbranch_scc1 L_dma_116n1
    s_waitcnt vmcnt(2)
L_dma_116n1:
    s_sub_u32 s62, s62, 1
    s_cmp_lg_u32 s62, 0
    s_cbranch_scc1 L_dma_116
    v_mov_b32 v8, 162068
L_lw_117:
    ds_read_b32 v9, v8
    s_waitcnt lgkmcnt(0)
    v_cmp_gt_u32 vcc, 1, v9
    s_cbranch_vccz L_lw_117e
    s_sleep 8
    s_sub_u32 s60, s60, 1
    s_cbranch_scc0 L_lw_117
    s_mov_b32 s60, 0
L_lw_117e:
    s_cmp_lg_u32 s3, 3
    s_cbranch_scc1 L_h_nomo
    v_and_b32 v4, 15, v0
    v_lshlrev_b32 v4, 4, v4
    v_mul_u32_u24 v5, 1280, v3
    v_add_u32 v5, v5, v4
    v_mul_u32_u24 v6, 1296, v3
    v_add_u32 v6, v6, v4
    v_add_u32 v6, 147456, v6
    s_mov_b32 s62, 30720
    s_mov_b32 s63, 25600
L_poll_118:
    buffer_load_dwordx4 v[40:43], v5, s[40:43], s62 offen offset:0 sc1
    buffer_load_dwordx4 v[44:47], v5, s[40:43], s62 offen offset:256 sc1
    buffer_load_dwordx4 v[48:51], v5, s[40:43], s62 offen offset:512 sc1
    buffer_load_dwordx4 v[52:55], v5, s[40:43], s62 offen offset:768 sc1
    buffer_load_dwordx4 v[56:59], v5, s[40:43], s62 offen offset:1024 sc1
    buffer_load_dwordx4 v[60:63], v5, s[40:43], s63 offen offset:0 sc1
    buffer_load_dwordx4 v[64:67], v5, s[40:43], s63 offen offset:256 sc1
    buffer_load_dwordx4 v[68:71], v5, s[40:43], s63 offen offset:512 sc1
    buffer_load_dwordx4 v[72:75], v5, s[40:43], s63 offen offset:768 sc1
    buffer_load_dwordx4 v[76:79], v5, s[40:43], s63 offen offset:1024 sc1
    s_waitcnt vmcnt(0)
    v_max3_u32 v7, v40, v41, v42
    v_max3_u32 v7, v7, v43, v44
    v_max3_u32 v7, v7, v45, v46
    v_max3_u32 v7, v7, v47, v48
    v_max3_u32 v7, v7, v49, v50
    v_max3_u32 v7, v7, v51, v52
    v_max3_u32 v7, v7, v53, v54
    v_max3_u32 v7, v7, v55, v56
    v_max3_u32 v7, v7, v57, v58
    v_max3_u32 v7, v7, v59, v60
    v_max3_u32 v7, v7, v61, v62
    v_max3_u32 v7, v7, v63, v64
    v_max3_u32 v7, v7, v65, v66
    v_max3_u32 v7, v7, v67, v68
    v_max3_u32 v7, v7, v69, v70
    v_max3_u32 v7, v7, v71, v72
    v_max3_u32 v7, v7, v73, v74
    v_max3_u32 v7, v7, v75, v76
    v_max3_u32 v7, v7, v77, v78
    v_max_u32 v7, v7, v79
    v_cmp_eq_u32 vcc, -1, v7
    s_cbranch_vccz L_poll_118e
    s_sleep 8
    s_sub_u32 s60, s60, 1
    s_cbranch_scc0 L_poll_118
    s_mov_b32 s60, 0
L_poll_118e:
    ds_write_b128 v6, v[40:43] offset:0
    ds_write_b128 v6, v[44:47] offset:256
    ds_write_b128 v6, v[48:51] offset:512
    ds_write_b128 v6, v[52:55] offset:768
    ds_write_b128 v6, v[56:59] offset:1024
    ds_write_b128 v6, v[60:63] offset:5184
    ds_write_b128 v6, v[64:67] offset:5440
    ds_write_b128 v6, v[68:71] offset:5696
    ds_write_b128 v6, v[72:75] offset:5952
    ds_write_b128 v6, v[76:79] offset:6208
L_h_nomo:
    v_mul_u32_u24 v4, 144, v2
    v_lshl_add_u32 v4, v3, 4, v4
    v_add_u32 v161, 97600, v4
    s_mov_b32 s100, s3
    s_lshl_b32 s63, s100, 8
    v_and_b32 v8, 15, v0
    v_lshl_add_u32 v8, v8, 4, s63
    v_lshrrev_b32 v9, 4, v0
    v_mul_u32_u24 v5, 1280, v9
    v_add_u32 v5, v5, v8
    v_mul_u32_u24 v4, 1296, v9
    v_add_u32 v4, v4, v8
    v_add_u32 v4, 81920, v4
    v_lshlrev_b32 v6, 1, v5
    v_add_u32 v6, 87104, v6
    s_lshl_b32 s62, s100, 3
    s_add_u32 s62, s62, 97344
    v_lshl_add_u32 v7, v9, 6, s62
    s_mov_b32 s48, s4
    s_mov_b32 s49, s5
    s_mov_b32 s50, 5120
    s_mov_b32 s51, 0x20000
    buffer_load_dwordx4 v[8:11], v5, s[48:51], 0 offen
    s_mov_b32 s62, 20480
    s_mov_b32 s63, 30720
L_poll_119:
    buffer_load_dwordx4 v[12:15], v5, s[40:43], s62 offen sc1
    buffer_load_dwordx4 v[16:19], v5, s[40:43], s63 offen sc1
    s_waitcnt vmcnt(0)
    v_max3_u32 v38, v12, v13, v14
    v_max3_u32 v38, v38, v15, v16
    v_max3_u32 v38, v38, v17, v18
    v_max_u32 v38, v38, v19
    v_cmp_eq_u32 vcc, -1, v38
    s_cbranch_vccz L_poll_119e
    s_sleep 8
    s_sub_u32 s60, s60, 1
    s_cbranch_scc0 L_poll_119
    s_mov_b32 s60, 0
L_poll_119e:
    v_lshlrev_b32 v40, 16, v8
    v_and_b32 v41, 0xffff0000, v8
    v_lshlrev_b32 v42, 16, v9
    v_and_b32 v43, 0xffff0000, v9
    v_lshlrev_b32 v44, 16, v10
    v_and_b32 v45, 0xffff0000, v10
    v_lshlrev_b32 v46, 16, v11
    v_and_b32 v47, 0xffff0000, v11
    v_lshlrev_b32 v48, 16, v12
    v_and_b32 v49, 0xffff0000, v12
    v_lshlrev_b32 v50, 16, v13
    v_and_b32 v51, 0xffff0000, v13
    v_lshlrev_b32 v52, 16, v14
    v_and_b32 v53, 0xffff0000, v14
    v_lshlrev_b32 v54, 16, v15
    v_and_b32 v55, 0xffff0000, v15
    v_lshlrev_b32 v56, 16, v16
    v_and_b32 v57, 0xffff0000, v16
    v_lshlrev_b32 v58, 16, v17
    v_and_b32 v59, 0xffff0000, v17
    v_lshlrev_b32 v60, 16, v18
    v_and_b32 v61, 0xffff0000, v18
    v_lshlrev_b32 v62, 16, v19
    v_and_b32 v63, 0xffff0000, v19
    v_mov_b32 v64, 0
    v_mov_b32 v65, 0
    v_mov_b32 v66, 0
    v_mov_b32 v67, 0
    v_mov_b32 v68, 0
    v_mov_b32 v69, 0
    v_mov_b32 v70, 0
    v_mov_b32 v71, 0
    s_waitcnt vmcnt(0) lgkmcnt(0)
    v_mov_b32 v8, 162064
    v_mov_b32 v9, 1
    s_mov_b64 exec, 1
    ds_add_u32 v8, v9
    s_mov_b64 exec, -1
    s_branch L_t2gate
L_ffn2:
    s_barrier
    ds_read_b128 v[8:11], v161
    ds_read_b128 v[12:15], v161 offset:64
    s_cmp_eq_u32 s61, 1
    s_cbranch_scc0 L_f2slow
    s_waitcnt lgkmcnt(1)
    v_mfma_f32_16x16x32_bf16 v[16:19], v[80:83], v[8:11], 0
    v_mfma_f32_16x16x32_bf16 v[20:23], v[88:91], v[8:11], 0
    v_mfma_f32_16x16x32_bf16 v[24:27], v[96:99], v[8:11], 0
    v_mfma_f32_16x16x32_bf16 v[28:31], v[104:107], v[8:11], 0
    s_waitcnt lgkmcnt(0)
    v_mfma_f32_16x16x32_bf16 v[16:19], v[84:87], v[12:15], v[16:19]
    v_mfma_f32_16x16x32_bf16 v[20:23], v[92:95], v[12:15], v[20:23]
    v_mfma_f32_16x16x32_bf16 v[24:27], v[100:103], v[12:15], v[24:27]
    v_mfma_f32_16x16x32_bf16 v[28:31], v[108:111], v[12:15], v[28:31]
    v_mfma_f32_16x16x32_bf16 v[32:35], v[112:115], v[8:11], 0
    v_mfma_f32_16x16x32_bf16 v[36:39], v[120:123], v[8:11], 0
    v_mfma_f32_16x16x32_bf16 v[40:43], v[128:131], v[8:11], 0
    v_mfma_f32_16x16x32_bf16 v[44:47], v[136:139], v[8:11], 0
    v_mfma_f32_16x16x32_bf16 v[32:35], v[116:119], v[12:15], v[32:35]
    v_mfma_f32_16x16x32_bf16 v[36:39], v[124:127], v[12:15], v[36:39]
    v_mfma_f32_16x16x32_bf16 v[40:43], v[132:135], v[12:15], v[40:43]
    v_mfma_f32_16x16x32_bf16 v[44:47], v[140:143], v[12:15], v[44:47]
    v_mfma_f32_16x16x32_bf16 v[48:51], v[144:147], v[8:11], 0
    v_mov_b32_dpp v16, v20 quad_perm:[0,1,2,3] row_mask:0xf bank_mask:0x2
    v_mov_b32_dpp v17, v21 quad_perm:[0,1,2,3] row_mask:0xf bank_mask:0x2
    v_mov_b32_dpp v18, v22 quad_perm:[0,1,2,3] row_mask:0xf bank_mask:0x2
    v_mfma_f32_16x16x32_bf16 v[52:55], v[152:155], v[8:11], 0
    v_mov_b32_dpp v19, v23 quad_perm:[0,1,2,3] row_mask:0xf bank_mask:0x2
    v_mov_b32_dpp v16, v24 quad_perm:[0,1,2,3] row_mask:0xf bank_mask:0x4
    v_mov_b32_dpp v17, v25 quad_perm:[0,1,2,3] row_mask:0xf bank_mask:0x4
    v_mfma_f32_16x16x32_bf16 v[48:51], v[148:151], v[12:15], v[48:51]
    v_mov_b32_dpp v18, v26 quad_perm:[0,1,2,3] row_mask:0xf bank_mask:0x4
    v_mov_b32_dpp v19, v27 quad_perm:[0,1,2,3] row_mask:0xf bank_mask:0x4
    v_mov_b32_dpp v16, v28 quad_perm:[0,1,2,3] row_mask:0xf bank_mask:0x8
    v_mfma_f32_16x16x32_bf16 v[52:55], v[156:159], v[12:15], v[52:55]
    v_mov_b32_dpp v17, v29 quad_perm:[0,1,2,3] row_mask:0xf bank_mask:0x8
    v_mov_b32_dpp v18, v30 quad_perm:[0,1,2,3] row_mask:0xf bank_mask:0x8
    v_mov_b32_dpp v19, v31 quad_perm:[0,1,2,3] row_mask:0xf bank_mask:0x8
    buffer_store_dwordx4 v[16:19], v160, s[40:43], s57 offen
    v_mov_b32_dpp v32, v36 quad_perm:[0,1,2,3] row_mask:0xf bank_mask:0x2
    v_mov_b32_dpp v33, v37 quad_perm:[0,1,2,3] row_mask:0xf bank_mask:0x2
    v_mov_b32_dpp v34, v38 quad_perm:[0,1,2,3] row_mask:0xf bank_mask:0x2
    v_mov_b32_dpp v35, v39 quad_perm:[0,1,2,3] row_mask:0xf bank_mask:0x2
    v_mov_b32_dpp v32, v40 quad_perm:[0,1,2,3] row_mask:0xf bank_mask:0x4
    v_mov_b32_dpp v33, v41 quad_perm:[0,1,2,3] row_mask:0xf bank_mask:0x4
    v_mov_b32_dpp v34, v42 quad_perm:[0,1,2,3] row_mask:0xf bank_mask:0x4
    v_mov_b32_dpp v35, v43 quad_perm:[0,1,2,3] row_mask:0xf bank_mask:0x4
    v_mov_b32_dpp v32, v44 quad_perm:[0,1,2,3] row_mask:0xf bank_mask:0x8
    v_mov_b32_dpp v33, v45 quad_perm:[0,1,2,3] row_mask:0xf bank_mask:0x8
    v_mov_b32_dpp v34, v46 quad_perm:[0,1,2,3] row_mask:0xf bank_mask:0x8
    v_mov_b32_dpp v35, v47 quad_perm:[0,1,2,3] row_mask:0xf bank_mask:0x8
    buffer_store_dwordx4 v[32:35], v160, s[40:43], s57 offen offset:256
    v_mov_b32_dpp v48, v52 quad_perm:[0,1,2,3] row_mask:0xf bank_mask:0x2
    v_mov_b32_dpp v49, v53 quad_perm:[0,1,2,3] row_mask:0xf bank_mask:0x2
    v_mov_b32_dpp v50, v54 quad_perm:[0,1,2,3] row_mask:0xf bank_mask:0x2
    v_mov_b32_dpp v51, v55 quad_perm:[0,1,2,3] row_mask:0xf bank_mask:0x2
    s_mov_b32 exec_lo, 0x00ff00ff
    s_mov_b32 exec_hi, 0x00ff00ff
    buffer_store_dwordx4 v[48:51], v160, s[40:43], s57 offen offset:512
L_f2done:
    s_barrier
    s_endpgm
L_f2slow:
    s_waitcnt lgkmcnt(1)
    v_mfma_f32_16x16x32_bf16 v[16:19], v[80:83], v[8:11], 0
    v_mfma_f32_16x16x32_bf16 v[20:23], v[88:91], v[8:11], 0
    v_mfma_f32_16x16x32_bf16 v[24:27], v[96:99], v[8:11], 0
    v_mfma_f32_16x16x32_bf16 v[28:31], v[104:107], v[8:11], 0
    s_waitcnt lgkmcnt(0)
    v_mfma_f32_16x16x32_bf16 v[16:19], v[84:87], v[12:15], v[16:19]
    v_mfma_f32_16x16x32_bf16 v[20:23], v[92:95], v[12:15], v[20:23]
    v_mfma_f32_16x16x32_bf16 v[24:27], v[100:103], v[12:15], v[24:27]
    v_mfma_f32_16x16x32_bf16 v[28:31], v[108:111], v[12:15], v[28:31]
    v_mfma_f32_16x16x32_bf16 v[32:35], v[112:115], v[8:11], 0
    v_mfma_f32_16x16x32_bf16 v[36:39], v[120:123], v[8:11], 0
    v_mfma_f32_16x16x32_bf16 v[40:43], v[128:131], v[8:11], 0
    v_mfma_f32_16x16x32_bf16 v[44:47], v[136:139], v[8:11], 0
    v_mfma_f32_16x16x32_bf16 v[32:35], v[116:119], v[12:15], v[32:35]
    v_mfma_f32_16x16x32_bf16 v[36:39], v[124:127], v[12:15], v[36:39]
    v_mfma_f32_16x16x32_bf16 v[40:43], v[132:135], v[12:15], v[40:43]
    v_mfma_f32_16x16x32_bf16 v[44:47], v[140:143], v[12:15], v[44:47]
    v_mfma_f32_16x16x32_bf16 v[48:51], v[144:147], v[8:11], 0
    v_mov_b32_dpp v16, v20 quad_perm:[0,1,2,3] row_mask:0xf bank_mask:0x2
    v_mov_b32_dpp v17, v21 quad_perm:[0,1,2,3] row_mask:0xf bank_mask:0x2
    v_mov_b32_dpp v18, v22 quad_perm:[0,1,2,3] row_mask:0xf bank_mask:0x2
    v_mfma_f32_16x16x32_bf16 v[52:55], v[152:155], v[8:11], 0
    v_mov_b32_dpp v19, v23 quad_perm:[0,1,2,3] row_mask:0xf bank_mask:0x2
    v_mov_b32_dpp v16, v24 quad_perm:[0,1,2,3] row_mask:0xf bank_mask:0x4
    v_mov_b32_dpp v17, v25 quad_perm:[0,1,2,3] row_mask:0xf bank_mask:0x4
    v_mfma_f32_16x16x32_bf16 v[48:51], v[148:151], v[12:15], v[48:51]
    v_mov_b32_dpp v18, v26 quad_perm:[0,1,2,3] row_mask:0xf bank_mask:0x4
    v_mov_b32_dpp v19, v27 quad_perm:[0,1,2,3] row_mask:0xf bank_mask:0x4
    v_mov_b32_dpp v16, v28 quad_perm:[0,1,2,3] row_mask:0xf bank_mask:0x8
    v_mfma_f32_16x16x32_bf16 v[52:55], v[156:159], v[12:15], v[52:55]
    v_mov_b32_dpp v17, v29 quad_perm:[0,1,2,3] row_mask:0xf bank_mask:0x8
    v_mov_b32_dpp v18, v30 quad_perm:[0,1,2,3] row_mask:0xf bank_mask:0x8
    v_mov_b32_dpp v19, v31 quad_perm:[0,1,2,3] row_mask:0xf bank_mask:0x8
    buffer_store_dwordx4 v[16:19], v160, s[40:43], s57 offen sc1
    v_mov_b32_dpp v32, v36 quad_perm:[0,1,2,3] row_mask:0xf bank_mask:0x2
    v_mov_b32_dpp v33, v37 quad_perm:[0,1,2,3] row_mask:0xf bank_mask:0x2
    v_mov_b32_dpp v34, v38 quad_perm:[0,1,2,3] row_mask:0xf bank_mask:0x2
    v_mov_b32_dpp v35, v39 quad_perm:[0,1,2,3] row_mask:0xf bank_mask:0x2
    v_mov_b32_dpp v32, v40 quad_perm:[0,1,2,3] row_mask:0xf bank_mask:0x4
    v_mov_b32_dpp v33, v41 quad_perm:[0,1,2,3] row_mask:0xf bank_mask:0x4
    v_mov_b32_dpp v34, v42 quad_perm:[0,1,2,3] row_mask:0xf bank_mask:0x4
    v_mov_b32_dpp v35, v43 quad_perm:[0,1,2,3] row_mask:0xf bank_mask:0x4
    v_mov_b32_dpp v32, v44 quad_perm:[0,1,2,3] row_mask:0xf bank_mask:0x8
    v_mov_b32_dpp v33, v45 quad_perm:[0,1,2,3] row_mask:0xf bank_mask:0x8
    v_mov_b32_dpp v34, v46 quad_perm:[0,1,2,3] row_mask:0xf bank_mask:0x8
    v_mov_b32_dpp v35, v47 quad_perm:[0,1,2,3] row_mask:0xf bank_mask:0x8
    buffer_store_dwordx4 v[32:35], v160, s[40:43], s57 offen offset:256 sc1
    v_mov_b32_dpp v48, v52 quad_perm:[0,1,2,3] row_mask:0xf bank_mask:0x2
    v_mov_b32_dpp v49, v53 quad_perm:[0,1,2,3] row_mask:0xf bank_mask:0x2
    v_mov_b32_dpp v50, v54 quad_perm:[0,1,2,3] row_mask:0xf bank_mask:0x2
    v_mov_b32_dpp v51, v55 quad_perm:[0,1,2,3] row_mask:0xf bank_mask:0x2
    s_mov_b32 exec_lo, 0x00ff00ff
    s_mov_b32 exec_hi, 0x00ff00ff
    buffer_store_dwordx4 v[48:51], v160, s[40:43], s57 offen offset:512 sc1
    s_branch L_f2done
L_end:
    s_endpgm
L_codeend:
.section .rodata,"a"
.p2align 6
.amdhsa_kernel adaLN_cond__sliding_block_cached__dense_activation_gelu__decode_kernel
  .amdhsa_next_free_vgpr 168
  .amdhsa_next_free_sgpr 102
  .amdhsa_accum_offset 168
  .amdhsa_group_segment_fixed_size 0
  .amdhsa_kernarg_size 120
  .amdhsa_user_sgpr_count 2
  .amdhsa_user_sgpr_kernarg_segment_ptr 1
  .amdhsa_system_sgpr_workgroup_id_x 1
.end_amdhsa_kernel
```

```asm
; @launch grid=(256,1,1) block=(768,1,1) lds=162176
.amdgcn_target "amdgcn-amd-amdhsa--gfx950"
.text
.globl adaLN_cond__sliding_block_cached__dense_activation_gelu__decode_kernel
.p2align 8
.type adaLN_cond__sliding_block_cached__dense_activation_gelu__decode_kernel,@function
adaLN_cond__sliding_block_cached__dense_activation_gelu__decode_kernel:
    s_load_dwordx16 s[4:19], s[0:1], 0
    s_load_dwordx8 s[20:27], s[0:1], 64
    s_load_dwordx4 s[28:31], s[0:1], 96
    s_load_dwordx2 s[32:33], s[0:1], 112
    s_cmp_ge_u32 s2, 256
    s_cbranch_scc1 L_end
    v_lshrrev_b32 v1, 6, v0
    v_lshlrev_b32 v2, 4, v0
    v_readfirstlane_b32 s3, v1
    v_and_b32 v0, 63, v0
    s_and_b32 s34, s2, 7
    s_lshr_b32 s35, s2, 3
    s_cmp_lg_u32 s35, 21
    s_cbranch_scc1 L_nopf
    s_getpc_b64 s[48:49]
    s_and_b32 s48, s48, 0xffffff00
    s_mov_b32 s50, L_codeend-adaLN_cond__sliding_block_cached__dense_activation_gelu__decode_kernel
    s_mov_b32 s51, 0x20000
    s_mov_b32 s52, 12288
    buffer_load_dwordx4 v[152:155], v2, s[48:51], 0 offen
    buffer_load_dwordx4 v[156:159], v2, s[48:51], s52 offen
L_nopf:
    s_lshr_b32 s36, s35, 3
    s_lshl2_add_u32 s36, s34, s36
    s_bfe_u32 s37, s35, 0x20001
    s_and_b32 s38, s35, 1
    s_cmp_lt_u32 s35, 27
    s_cselect_b32 s39, 1, 0
    s_cmp_eq_u32 s34, 2
    s_cselect_b32 s39, s39, 0
    s_sub_u32 s62, s34, 3
    s_and_b32 s62, s62, 7
    s_mul_i32 s56, s35, 7
    s_add_u32 s56, s56, s62
    s_cmp_eq_u32 s62, 7
    s_cselect_b32 s56, 255, s56
    s_mov_b32 s60, 400000
    s_mov_b32 s61, 0
    v_mov_b32 v36, 0
    s_cmp_lt_u32 s3, 4
    s_cbranch_scc1 L_helpers
    s_sub_u32 s3, s3, 4
    s_cmp_ge_u32 s35, 22
    s_cselect_b32 s59, 1, 0
    s_add_u32 s62, s3, s59
    s_cmp_ge_u32 s62, 6
    s_cselect_b32 s62, s39, 0
    s_cmp_eq_u32 s62, 1
    s_cbranch_scc1 L_proxy
    s_cmp_eq_u32 s59, 1
    s_cselect_b32 s100, 0, 81920
    s_lshl_b32 s62, s3, 13
    s_add_u32 s100, s100, s62
    s_and_b32 s62, s39, s59
    s_cselect_b32 s100, -1, s100
    s_mov_b32 s101, 0
L_stream:
    s_lshl_b32 s62, s37, 5
    s_add_u32 s62, s62, s36
    s_lshl_b32 s63, s62, 21
    s_lshl_b32 s96, s38, 18
    s_add_u32 s63, s63, s96
    s_add_u32 s63, s63, 1572864
    v_lshlrev_b32 v1, 4, v0
    s_lshl_b32 s96, s3, 12
    v_add_u32 v1, s96, v1
    s_mov_b32 s97, 0
    s_mov_b32 s50, 262144
    s_mov_b32 s51, 0x20000
    s_waitcnt lgkmcnt(0)
    s_add_u32 s48, s6, s63
    s_addc_u32 s49, s7, 0
    buffer_load_dwordx4 v[40:43], v1, s[48:51], s97 offen offset:0 nt
    buffer_load_dwordx4 v[44:47], v1, s[48:51], s97 offen offset:1024 nt
    s_barrier
    s_branch L_stream2
L_helpers:
    s_cmp_lg_u32 s3, 0
    s_cbranch_scc1 L_noinit
    v_lshlrev_b32 v1, 2, v0
    v_add_u32 v1, 161920, v1
    ds_write_b32 v1, v36
L_noinit:
    s_waitcnt lgkmcnt(0)
    s_mov_b32 s40, s32
    s_mov_b32 s41, s33
    s_mov_b32 s42, 589824
    s_mov_b32 s43, 0x20000
    s_mov_b32 s44, s30
    s_mov_b32 s45, s31
    s_mov_b32 s46, 256
    s_mov_b32 s47, 0x20000
    s_lshl2_add_u32 s62, s35, s3
    s_cmp_eq_u32 s62, 87
    s_cbranch_scc1 L_touch
L_notp:
    s_mul_i32 s101, s3, 20480
    s_mov_b32 s96, s56
    s_cmp_lt_u32 s56, 40
    s_cbranch_scc0 L_nothalf
    s_cmp_lt_u32 s3, 2
    s_cbranch_scc1 L_unit
    s_add_u32 s62, s56, 20
    s_cmp_eq_u32 s3, 2
    s_cbranch_scc1 L_job
    s_lshr_b32 s62, s56, 1
    s_and_b32 s63, s56, 1
    s_mul_i32 s63, s63, 5120
    s_lshl_b32 s96, s62, 7
    s_add_u32 s63, s63, s96
    s_cmp_ge_u32 s62, 10
    s_cselect_b32 s62, 8960, 0
    s_add_u32 s63, s63, s62
    v_lshrrev_b32 v1, 4, v0
    v_mul_u32_u24 v1, 1280, v1
    v_and_b32 v2, 15, v0
    v_lshl_add_u32 v1, v2, 3, v1
    v_mov_b32 v4, -1
    v_mov_b32 v5, -1
    buffer_store_dwordx2 v[4:5], v1, s[40:43], s63 offen sc1
    s_lshl_b32 s62, s56, 1
    s_waitcnt vmcnt(0)
    s_mov_b64 exec, 1
    buffer_store_short v4, v36, s[44:47], s62 offen offset:128 sc1
    s_mov_b64 exec, -1
    s_barrier
    s_branch L_service
L_nothalf:
    s_cmp_lt_u32 s56, 104
    s_cbranch_scc1 L_unit
    s_sub_u32 s62, s56, 144
    s_cmp_lt_u32 s62, 10
    s_cbranch_scc0 L_nojob
    s_cmp_lt_u32 s3, 2
    s_cbranch_scc0 L_nojob
    s_mul_i32 s63, s3, 10
    s_add_u32 s62, s62, s63
L_job:
    s_cmp_lt_u32 s62, 59
    s_cbranch_scc0 L_end
    s_mov_b32 s100, s101
    s_lshl_b32 s101, s62, 9
    s_add_u32 s101, s101, 196608
    s_cmp_lt_u32 s62, 27
    s_cselect_b32 s63, 0, 27
    s_cselect_b32 s3, 7, 6
    s_cmp_lt_u32 s62, 54
    s_cselect_b32 s63, s63, 32
    s_cselect_b32 s3, s3, 5
    s_sub_u32 s35, s62, s63
    s_mov_b32 s34, 2
    s_lshr_b32 s36, s35, 3
    s_add_u32 s36, s36, 8
    s_bfe_u32 s37, s35, 0x20001
    s_and_b32 s38, s35, 1
    s_mov_b32 s59, 0
    s_branch L_stream
L_nojob:
    s_barrier
    s_cmp_ge_u32 s35, 22
    s_cbranch_scc1 L_h_t1
    s_cmp_eq_u32 s39, 1
    s_cbranch_scc1 L_h_role
    s_cmp_lt_u32 s96, 144
    s_cbranch_scc1 L_unit
    s_cmp_eq_u32 s3, 3
    s_cbranch_scc1 L_service
    s_endpgm
L_unit:
    v_lshrrev_b32 v3, 4, v0
    v_and_b32 v4, 3, v0
    v_bfe_u32 v7, v0, 2, 2
    v_lshlrev_b32 v64, 5, v7
    v_lshl_add_u32 v64, v3, 3, v64
    s_mov_b32 s14, s3
    s_mov_b32 s15, 3
    s_sub_u32 s62, s96, 40
    s_cmp_lt_u32 s62, 64
    s_cbranch_scc1 L_u_q
    s_mov_b32 s100, 1
    s_sub_u32 s96, s96, 84
    s_mov_b32 s12, 10240
    s_cmp_lt_u32 s56, 40
    s_cbranch_scc0 L_u_full
    s_mov_b32 s100, 0
    s_lshr_b32 s96, s56, 1
    s_and_b32 s62, s56, 1
    s_lshl1_add_u32 s14, s62, s14
    s_mov_b32 s15, 1
    s_cmp_ge_u32 s96, 10
    s_addc_u32 s62, s62, 0
    s_mul_i32 s12, s62, 5120
    s_add_u32 s12, s12, 0
L_u_full:
    s_mov_b32 s97, 0
    s_mov_b32 s99, 7680
    s_mov_b32 s48, s26
    s_mov_b32 s49, s27
    s_mov_b32 s50, 4915200
    s_mov_b32 s51, 0x20000
    s_mov_b32 s52, s24
    s_mov_b32 s53, s25
    s_mov_b32 s54, 5120
    s_mov_b32 s55, 0x20000
    v_and_b32 v6, 15, v0
    v_lshlrev_b32 v6, 4, v6
    v_mul_u32_u24 v5, 1280, v3
    v_add_u32 v5, v5, v6
    s_mul_i32 s62, s14, 320
    buffer_load_dwordx4 v[8:11], v5, s[52:55], s62 offen
    s_mov_b32 exec_lo, 0x000f000f
    s_mov_b32 exec_hi, 0x000f000f
    buffer_load_dwordx4 v[12:15], v5, s[52:55], s62 offen offset:256
    s_mov_b64 exec, -1
    s_lshl_b32 s98, s96, 7
    s_mul_i32 s13, s96, 0x199a
    s_lshr_b32 s13, s13, 16
    s_mul_i32 s63, s13, 3840
    s_add_u32 s57, s98, s63
    s_add_u32 s57, s57, s12
    v_mul_u32_u24 v5, 1280, v4
    v_add_u32 v64, v64, v5
    s_cmp_lg_u32 s13, 1
    s_cbranch_scc1 L_u_go
    s_mov_b32 s52, s4
    s_mov_b32 s53, s5
    s_mov_b32 s54, 5120
    s_mov_b32 s55, 0x20000
    v_lshrrev_b32 v6, 2, v0
    v_lshl_add_u32 v6, v6, 4, v5
    s_sub_u32 s62, s98, 1280
    buffer_load_dwordx4 v[16:19], v6, s[52:55], 0 offen offset:0
    buffer_load_dwordx4 v[20:23], v6, s[52:55], 0 offen offset:256
    buffer_load_dwordx4 v[24:27], v6, s[52:55], 0 offen offset:512
    buffer_load_dwordx4 v[28:31], v6, s[52:55], 0 offen offset:768
    buffer_load_dwordx4 v[32:35], v6, s[52:55], 0 offen offset:1024
    buffer_load_dwordx2 v[66:67], v64, s[52:55], s62 offen
    s_branch L_u_go
L_u_q:
    s_mov_b32 s97, 1
    s_mov_b32 s99, 8192
    s_mov_b32 s100, 0
    s_lshl_b32 s98, s62, 7
    s_add_u32 s57, s98, 40960
    v_lshl_add_u32 v64, v4, 13, v64
    s_mov_b32 s48, s10
    s_mov_b32 s49, s11
    s_mov_b32 s50, 5242880
    s_mov_b32 s51, 0x20000
L_u_go:
    v_lshrrev_b32 v6, 3, v0
    v_mul_lo_u32 v1, v6, s99
    v_and_b32 v6, 2, v6
    v_xor_b32 v6, v6, v0
    v_and_b32 v6, 7, v6
    v_lshl_add_u32 v1, v6, 4, v1
    v_add_u32 v1, s98, v1
    v_xor_b32 v2, 64, v1
    s_mul_i32 s63, s99, s14
    s_mul_i32 s63, s63, 160
    s_lshl_b32 s59, s99, 3
    s_mov_b32 m0, s101
    s_mov_b32 s62, 10
L_dma_1:
    buffer_load_dwordx4 v1, s[48:51], s63 offen nt lds
    s_add_u32 m0, m0, 1024
    s_add_u32 s63, s63, s59
    s_cmp_eq_u32 s100, 0
    s_cbranch_scc1 L_dma_1n0
    s_waitcnt vmcnt(1)
    s_cmp_eq_u32 s100, 2
    s_cbranch_scc1 L_dma_1n0
    s_waitcnt vmcnt(1)
L_dma_1n0:
    buffer_load_dwordx4 v2, s[48:51], s63 offen nt lds
    s_add_u32 m0, m0, 1024
    s_add_u32 s63, s63, s59
    s_cmp_eq_u32 s100, 0
    s_cbranch_scc1 L_dma_1n1
    s_waitcnt vmcnt(1)
    s_cmp_eq_u32 s100, 2
    s_cbranch_scc1 L_dma_1n1
    s_waitcnt vmcnt(1)
L_dma_1n1:
    s_sub_u32 s62, s62, 1
    s_cmp_lg_u32 s62, 0
    s_cbranch_scc1 L_dma_1
    v_min_u32 v65, 29, v0
    v_lshlrev_b32 v65, 2, v65
    s_cmp_lt_u32 s56, 104
    s_cselect_b32 s62, 32, 64
    v_min_u32 v6, 51, v0
    v_lshlrev_b32 v6, 2, v6
    v_cmp_le_u32 vcc, s62, v0
    s_nop 1
    v_cndmask_b32 v65, v65, v6, vcc
    v_mov_b32 v68, -1
    s_cmp_lt_u32 s56, 40
    s_cbranch_scc1 L_u_nofl
    buffer_load_dword v68, v65, s[44:47], 0 offen sc1
L_u_nofl:
    s_cmp_lt_u32 s56, 104
    s_cbranch_scc0 L_u_nob
    s_barrier
L_u_nob:
    v_lshrrev_b32 v60, 4, v0
    v_lshlrev_b32 v60, 10, v60
    v_bfe_u32 v6, v0, 2, 2
    v_lshl_add_u32 v60, v6, 7, v60
    v_and_b32 v6, 3, v0
    v_lshl_add_u32 v60, v6, 3, v60
    v_bfe_u32 v6, v0, 3, 2
    v_lshl_add_u32 v60, v6, 5, v60
    v_xor_b32 v61, 32, v60
    v_xor_b32 v62, 64, v60
    v_xor_b32 v63, 0x60, v60
    v_add_u32 v60, s101, v60
    v_add_u32 v61, s101, v61
    v_add_u32 v62, s101, v62
    v_add_u32 v63, s101, v63
    v_mov_b32 v56, 1.0
    v_mov_b32 v57, 1.0
    v_mov_b32 v58, 1.0
    v_mov_b32 v59, 1.0
    s_mov_b32 s58, 0
    s_cmp_eq_u32 s97, 1
    s_cbranch_scc1 L_u_q2
    s_cmp_eq_u32 s13, 4
    s_cselect_b32 s58, 1.0, 0
    s_cmp_lt_u32 s14, 2
    s_cselect_b32 s62, 1.0, 0
    s_cmp_eq_u32 s13, 1
    s_cselect_b32 s58, s62, s58
    s_cselect_b32 s56, 1, 0
    s_waitcnt vmcnt(20)
    s_mov_b32 s62, 0xbfb8aa3b
    v_lshlrev_b32 v40, 16, v8
    v_and_b32 v41, 0xffff0000, v8
    v_lshlrev_b32 v42, 16, v9
    v_and_b32 v43, 0xffff0000, v9
    v_lshlrev_b32 v44, 16, v10
    v_and_b32 v45, 0xffff0000, v10
    v_lshlrev_b32 v46, 16, v11
    v_and_b32 v47, 0xffff0000, v11
    v_mul_f32 v48, s62, v40
    v_mul_f32 v49, s62, v41
    v_mul_f32 v50, s62, v42
    v_mul_f32 v51, s62, v43
    v_mul_f32 v52, s62, v44
    v_mul_f32 v53, s62, v45
    v_mul_f32 v54, s62, v46
    v_mul_f32 v55, s62, v47
    v_exp_f32 v48, v48
    v_exp_f32 v49, v49
    v_exp_f32 v50, v50
    v_exp_f32 v51, v51
    v_exp_f32 v52, v52
    v_exp_f32 v53, v53
    v_exp_f32 v54, v54
    v_exp_f32 v55, v55
    v_add_f32 v48, 1.0, v48
    v_add_f32 v49, 1.0, v49
    v_add_f32 v50, 1.0, v50
    v_add_f32 v51, 1.0, v51
    v_add_f32 v52, 1.0, v52
    v_add_f32 v53, 1.0, v53
    v_add_f32 v54, 1.0, v54
    v_add_f32 v55, 1.0, v55
    v_rcp_f32 v48, v48
    v_rcp_f32 v49, v49
    v_rcp_f32 v50, v50
    v_rcp_f32 v51, v51
    v_rcp_f32 v52, v52
    v_rcp_f32 v53, v53
    v_rcp_f32 v54, v54
    v_rcp_f32 v55, v55
    v_mul_f32 v40, v40, v48
    v_mul_f32 v41, v41, v49
    v_mul_f32 v42, v42, v50
    v_mul_f32 v43, v43, v51
    v_mul_f32 v44, v44, v52
    v_mul_f32 v45, v45, v53
    v_mul_f32 v46, v46, v54
    v_mul_f32 v47, v47, v55
    v_cvt_pk_bf16_f32 v8, v40, v41
    v_cvt_pk_bf16_f32 v9, v42, v43
    v_cvt_pk_bf16_f32 v10, v44, v45
    v_cvt_pk_bf16_f32 v11, v46, v47
    v_lshlrev_b32 v40, 16, v12
    v_and_b32 v41, 0xffff0000, v12
    v_lshlrev_b32 v42, 16, v13
    v_and_b32 v43, 0xffff0000, v13
    v_lshlrev_b32 v44, 16, v14
    v_and_b32 v45, 0xffff0000, v14
    v_lshlrev_b32 v46, 16, v15
    v_and_b32 v47, 0xffff0000, v15
    v_mul_f32 v48, s62, v40
    v_mul_f32 v49, s62, v41
    v_mul_f32 v50, s62, v42
    v_mul_f32 v51, s62, v43
    v_mul_f32 v52, s62, v44
    v_mul_f32 v53, s62, v45
    v_mul_f32 v54, s62, v46
    v_mul_f32 v55, s62, v47
    v_exp_f32 v48, v48
    v_exp_f32 v49, v49
    v_exp_f32 v50, v50
    v_exp_f32 v51, v51
    v_exp_f32 v52, v52
    v_exp_f32 v53, v53
    v_exp_f32 v54, v54
    v_exp_f32 v55, v55
    v_add_f32 v48, 1.0, v48
    v_add_f32 v49, 1.0, v49
    v_add_f32 v50, 1.0, v50
    v_add_f32 v51, 1.0, v51
    v_add_f32 v52, 1.0, v52
    v_add_f32 v53, 1.0, v53
    v_add_f32 v54, 1.0, v54
    v_add_f32 v55, 1.0, v55
    v_rcp_f32 v48, v48
    v_rcp_f32 v49, v49
    v_rcp_f32 v50, v50
    v_rcp_f32 v51, v51
    v_rcp_f32 v52, v52
    v_rcp_f32 v53, v53
    v_rcp_f32 v54, v54
    v_rcp_f32 v55, v55
    v_mul_f32 v40, v40, v48
    v_mul_f32 v41, v41, v49
    v_mul_f32 v42, v42, v50
    v_mul_f32 v43, v43, v51
    v_mul_f32 v44, v44, v52
    v_mul_f32 v45, v45, v53
    v_mul_f32 v46, v46, v54
    v_mul_f32 v47, v47, v55
    v_cvt_pk_bf16_f32 v12, v40, v41
    v_cvt_pk_bf16_f32 v13, v42, v43
    v_cvt_pk_bf16_f32 v14, v44, v45
    v_cvt_pk_bf16_f32 v15, v46, v47
    s_mul_i32 s62, s3, 1344
    s_add_u32 s62, s62, 151552
    v_mul_u32_u24 v5, 336, v3
    v_and_b32 v6, 15, v0
    v_lshl_add_u32 v5, v6, 4, v5
    v_add_u32 v5, s62, v5
    ds_write_b128 v5, v[8:11]
    s_mov_b32 exec_lo, 0x000f000f
    s_mov_b32 exec_hi, 0x000f000f
    ds_write_b128 v5, v[12:15] offset:256
    s_mov_b64 exec, -1
    v_mul_u32_u24 v5, 336, v4
    v_lshl_add_u32 v5, v3, 4, v5
    v_add_u32 v5, s62, v5
    s_mov_b32 s59, 0x3e800000
    s_cmp_eq_u32 s56, 0
    s_cbranch_scc1 L_u_nost
    v_mov_b32 v40, 0
    v_mov_b32 v41, 0
    s_mov_b32 s62, 0x3f803f80
    v_dot2c_f32_bf16 v40, s62, v16
    v_dot2c_f32_bf16 v41, v16, v16
    v_dot2c_f32_bf16 v40, s62, v17
    v_dot2c_f32_bf16 v41, v17, v17
    v_dot2c_f32_bf16 v40, s62, v18
    v_dot2c_f32_bf16 v41, v18, v18
    v_dot2c_f32_bf16 v40, s62, v19
    v_dot2c_f32_bf16 v41, v19, v19
    v_dot2c_f32_bf16 v40, s62, v20
    v_dot2c_f32_bf16 v41, v20, v20
    v_dot2c_f32_bf16 v40, s62, v21
    v_dot2c_f32_bf16 v41, v21, v21
    v_dot2c_f32_bf16 v40, s62, v22
    v_dot2c_f32_bf16 v41, v22, v22
    v_dot2c_f32_bf16 v40, s62, v23
    v_dot2c_f32_bf16 v41, v23, v23
    v_dot2c_f32_bf16 v40, s62, v24
    v_dot2c_f32_bf16 v41, v24, v24
    v_dot2c_f32_bf16 v40, s62, v25
    v_dot2c_f32_bf16 v41, v25, v25
    v_dot2c_f32_bf16 v40, s62, v26
    v_dot2c_f32_bf16 v41, v26, v26
    v_dot2c_f32_bf16 v40, s62, v27
    v_dot2c_f32_bf16 v41, v27, v27
    v_dot2c_f32_bf16 v40, s62, v28
    v_dot2c_f32_bf16 v41, v28, v28
    v_dot2c_f32_bf16 v40, s62, v29
    v_dot2c_f32_bf16 v41, v29, v29
    v_dot2c_f32_bf16 v40, s62, v30
    v_dot2c_f32_bf16 v41, v30, v30
    v_dot2c_f32_bf16 v40, s62, v31
    v_dot2c_f32_bf16 v41, v31, v31
    v_dot2c_f32_bf16 v40, s62, v32
    v_dot2c_f32_bf16 v41, v32, v32
    v_dot2c_f32_bf16 v40, s62, v33
    v_dot2c_f32_bf16 v41, v33, v33
    v_dot2c_f32_bf16 v40, s62, v34
    v_dot2c_f32_bf16 v41, v34, v34
    v_dot2c_f32_bf16 v40, s62, v35
    v_dot2c_f32_bf16 v41, v35, v35
    s_nop 1
    v_add_f32_dpp v40, v40, v40 row_ror:4 row_mask:0xf bank_mask:0xf
    v_add_f32_dpp v41, v41, v41 row_ror:4 row_mask:0xf bank_mask:0xf
    s_nop 0
    v_add_f32_dpp v40, v40, v40 row_ror:8 row_mask:0xf bank_mask:0xf
    v_add_f32_dpp v41, v41, v41 row_ror:8 row_mask:0xf bank_mask:0xf
    v_mov_b32 v42, v40
    v_mov_b32 v43, v41
    s_nop 0
    v_permlane16_swap_b32 v40, v42
    v_permlane16_swap_b32 v41, v43
    v_add_f32 v40, v40, v42
    v_add_f32 v41, v41, v43
    v_mov_b32 v42, v40
    v_mov_b32 v43, v41
    s_nop 0
    v_permlane32_swap_b32 v40, v42
    v_permlane32_swap_b32 v41, v43
    v_add_f32 v40, v40, v42
    v_add_f32 v41, v41, v43
    s_mov_b32 s62, 0x3acccccd
    v_mul_f32 v40, s62, v40
    v_mul_f32 v41, s62, v41
    v_fma_f32 v41, -v40, v40, v41
    v_max_f32 v41, 0, v41
    v_add_f32 v41, 0x3727c5ac, v41
    v_rsq_f32 v41, v41
    v_lshlrev_b32 v56, 16, v66
    v_and_b32 v57, 0xffff0000, v66
    v_lshlrev_b32 v58, 16, v67
    v_and_b32 v59, 0xffff0000, v67
    v_sub_f32 v56, v56, v40
    v_sub_f32 v57, v57, v40
    v_sub_f32 v58, v58, v40
    v_sub_f32 v59, v59, v40
    v_mul_f32 v56, v56, v41
    v_mul_f32 v57, v57, v41
    v_mul_f32 v58, v58, v41
    v_mul_f32 v59, v59, v41
L_u_nost:
    ds_read_b128 v[8:11], v5 offset:0
    ds_read_b128 v[12:15], v5 offset:64
    ds_read_b128 v[16:19], v5 offset:128
    ds_read_b128 v[20:23], v5 offset:192
    ds_read_b128 v[24:27], v5 offset:256
    s_branch L_u_frag
L_u_q2:
    v_and_b32 v5, 15, v0
    v_mul_u32_u24 v5, 1280, v5
    v_lshl_add_u32 v5, v3, 4, v5
    s_mul_i32 s63, s3, 320
    s_add_u32 s63, s63, 0
    s_mov_b32 s59, 1.0
L_u_frag:
    s_waitcnt vmcnt(0)
    v_cmp_ne_u32 vcc, -1, v68
    s_cbranch_vccz L_u_yok
L_wy_2:
    buffer_load_dword v37, v65, s[44:47], 0 offen sc1
    s_waitcnt vmcnt(0)
    v_cmp_ne_u32 vcc, -1, v37
    s_cbranch_vccz L_wy_2e
    s_sleep 4
    s_sub_u32 s60, s60, 1
    s_cbranch_scc0 L_wy_2
    s_mov_b32 s60, 0
L_wy_2e:
L_u_yok:
    ds_read_b64_tr_b16 v[80:81], v60 offset:0
    ds_read_b64_tr_b16 v[82:83], v60 offset:512
    ds_read_b64_tr_b16 v[84:85], v61 offset:0
    ds_read_b64_tr_b16 v[86:87], v61 offset:512
    ds_read_b64_tr_b16 v[88:89], v62 offset:0
    ds_read_b64_tr_b16 v[90:91], v62 offset:512
    ds_read_b64_tr_b16 v[92:93], v63 offset:0
    ds_read_b64_tr_b16 v[94:95], v63 offset:512
    ds_read_b64_tr_b16 v[96:97], v60 offset:4096
    ds_read_b64_tr_b16 v[98:99], v60 offset:4608
    ds_read_b64_tr_b16 v[100:101], v61 offset:4096
    ds_read_b64_tr_b16 v[102:103], v61 offset:4608
    ds_read_b64_tr_b16 v[104:105], v62 offset:4096
    ds_read_b64_tr_b16 v[106:107], v62 offset:4608
    ds_read_b64_tr_b16 v[108:109], v63 offset:4096
    ds_read_b64_tr_b16 v[110:111], v63 offset:4608
    ds_read_b64_tr_b16 v[112:113], v60 offset:8192
    ds_read_b64_tr_b16 v[114:115], v60 offset:8704
    ds_read_b64_tr_b16 v[116:117], v61 offset:8192
    ds_read_b64_tr_b16 v[118:119], v61 offset:8704
    ds_read_b64_tr_b16 v[120:121], v62 offset:8192
    ds_read_b64_tr_b16 v[122:123], v62 offset:8704
    ds_read_b64_tr_b16 v[124:125], v63 offset:8192
    ds_read_b64_tr_b16 v[126:127], v63 offset:8704
    ds_read_b64_tr_b16 v[128:129], v60 offset:12288
    ds_read_b64_tr_b16 v[130:131], v60 offset:12800
    ds_read_b64_tr_b16 v[132:133], v61 offset:12288
    ds_read_b64_tr_b16 v[134:135], v61 offset:12800
    ds_read_b64_tr_b16 v[136:137], v62 offset:12288
    ds_read_b64_tr_b16 v[138:139], v62 offset:12800
    ds_read_b64_tr_b16 v[140:141], v63 offset:12288
    ds_read_b64_tr_b16 v[142:143], v63 offset:12800
    ds_read_b64_tr_b16 v[144:145], v60 offset:16384
    ds_read_b64_tr_b16 v[146:147], v60 offset:16896
    ds_read_b64_tr_b16 v[148:149], v61 offset:16384
    ds_read_b64_tr_b16 v[150:151], v61 offset:16896
    ds_read_b64_tr_b16 v[152:153], v62 offset:16384
    ds_read_b64_tr_b16 v[154:155], v62 offset:16896
    ds_read_b64_tr_b16 v[156:157], v63 offset:16384
    ds_read_b64_tr_b16 v[158:159], v63 offset:16896
    s_cmp_eq_u32 s97, 0
    s_cbranch_scc1 L_u_mm
    v_lshrrev_b32 v6, 2, v0
    v_mul_u32_u24 v6, 158, v6
    v_and_b32 v6, 0xfffc, v6
    v_and_b32 v7, 3, v0
    v_mul_u32_u24 v7, 5120, v7
    v_add_u32 v6, v6, v7
    s_mov_b64 exec, 0xfff
L_poll_3:
    buffer_load_dword v8, v6, s[40:43], s63 offen offset:3840 sc1
    s_waitcnt vmcnt(0)
    v_cmp_eq_u32 vcc, -1, v8
    s_cbranch_vccz L_poll_3e
    s_sleep 4
    s_sub_u32 s60, s60, 1
    s_cbranch_scc0 L_poll_3
    s_mov_b32 s60, 0
L_poll_3e:
    s_mov_b64 exec, -1
L_poll_4:
    buffer_load_dwordx4 v[8:11], v5, s[40:43], s63 offen offset:0 sc1
    buffer_load_dwordx4 v[12:15], v5, s[40:43], s63 offen offset:64 sc1
    buffer_load_dwordx4 v[16:19], v5, s[40:43], s63 offen offset:128 sc1
    buffer_load_dwordx4 v[20:23], v5, s[40:43], s63 offen offset:192 sc1
    buffer_load_dwordx4 v[24:27], v5, s[40:43], s63 offen offset:256 sc1
    s_waitcnt vmcnt(0)
    v_max3_u32 v37, v8, v9, v10
    v_max3_u32 v37, v37, v11, v12
    v_max3_u32 v37, v37, v13, v14
    v_max3_u32 v37, v37, v15, v16
    v_max3_u32 v37, v37, v17, v18
    v_max3_u32 v37, v37, v19, v20
    v_max3_u32 v37, v37, v21, v22
    v_max3_u32 v37, v37, v23, v24
    v_max3_u32 v37, v37, v25, v26
    v_max_u32 v37, v37, v27
    v_cmp_eq_u32 vcc, -1, v37
    s_cbranch_vccz L_poll_4e
    s_sleep 1
    s_sub_u32 s60, s60, 1
    s_cbranch_scc0 L_poll_4
    s_mov_b32 s60, 0
L_poll_4e:
L_u_got:
L_u_mm:
    s_waitcnt lgkmcnt(0)
    v_mfma_f32_16x16x32_bf16 v[40:43], v[80:83], v[8:11], 0
    v_mfma_f32_16x16x32_bf16 v[44:47], v[84:87], v[8:11], 0
    v_mfma_f32_16x16x32_bf16 v[48:51], v[88:91], v[8:11], 0
    v_mfma_f32_16x16x32_bf16 v[52:55], v[92:95], v[8:11], 0
    v_mfma_f32_16x16x32_bf16 v[40:43], v[96:99], v[12:15], v[40:43]
    v_mfma_f32_16x16x32_bf16 v[44:47], v[100:103], v[12:15], v[44:47]
    v_mfma_f32_16x16x32_bf16 v[48:51], v[104:107], v[12:15], v[48:51]
    v_mfma_f32_16x16x32_bf16 v[52:55], v[108:111], v[12:15], v[52:55]
    v_mfma_f32_16x16x32_bf16 v[40:43], v[112:115], v[16:19], v[40:43]
    v_mfma_f32_16x16x32_bf16 v[44:47], v[116:119], v[16:19], v[44:47]
    v_mfma_f32_16x16x32_bf16 v[48:51], v[120:123], v[16:19], v[48:51]
    v_mfma_f32_16x16x32_bf16 v[52:55], v[124:127], v[16:19], v[52:55]
    v_mfma_f32_16x16x32_bf16 v[40:43], v[128:131], v[20:23], v[40:43]
    v_mfma_f32_16x16x32_bf16 v[44:47], v[132:135], v[20:23], v[44:47]
    v_mfma_f32_16x16x32_bf16 v[48:51], v[136:139], v[20:23], v[48:51]
    v_mfma_f32_16x16x32_bf16 v[52:55], v[140:143], v[20:23], v[52:55]
    v_mfma_f32_16x16x32_bf16 v[40:43], v[144:147], v[24:27], v[40:43]
    v_mfma_f32_16x16x32_bf16 v[44:47], v[148:151], v[24:27], v[44:47]
    v_mfma_f32_16x16x32_bf16 v[48:51], v[152:155], v[24:27], v[48:51]
    v_mfma_f32_16x16x32_bf16 v[52:55], v[156:159], v[24:27], v[52:55]
    v_lshlrev_b32 v5, 4, v0
    v_add_u32 v5, 147456, v5
    s_lshl_b32 s62, s3, 10
    v_add_u32 v6, s62, v5
    v_mov_b32 v32, 162056
    v_mov_b32 v33, 1
    v_add_f32_dpp v40, v40, v40 row_ror:8 row_mask:0xf bank_mask:0xf
    v_add_f32_dpp v41, v41, v41 row_ror:8 row_mask:0xf bank_mask:0xf
    v_add_f32_dpp v42, v42, v42 row_ror:8 row_mask:0xf bank_mask:0xf
    v_add_f32_dpp v43, v43, v43 row_ror:8 row_mask:0xf bank_mask:0xf
    v_add_f32_dpp v44, v44, v44 row_ror:8 row_mask:0xf bank_mask:0xf
    v_add_f32_dpp v45, v45, v45 row_ror:8 row_mask:0xf bank_mask:0xf
    v_add_f32_dpp v46, v46, v46 row_ror:8 row_mask:0xf bank_mask:0xf
    v_add_f32_dpp v47, v47, v47 row_ror:8 row_mask:0xf bank_mask:0xf
    v_add_f32_dpp v48, v48, v48 row_ror:8 row_mask:0xf bank_mask:0xf
    v_add_f32_dpp v49, v49, v49 row_ror:8 row_mask:0xf bank_mask:0xf
    v_add_f32_dpp v50, v50, v50 row_ror:8 row_mask:0xf bank_mask:0xf
    v_add_f32_dpp v51, v51, v51 row_ror:8 row_mask:0xf bank_mask:0xf
    v_add_f32_dpp v52, v52, v52 row_ror:8 row_mask:0xf bank_mask:0xf
    v_add_f32_dpp v53, v53, v53 row_ror:8 row_mask:0xf bank_mask:0xf
    v_add_f32_dpp v54, v54, v54 row_ror:8 row_mask:0xf bank_mask:0xf
    v_add_f32_dpp v55, v55, v55 row_ror:8 row_mask:0xf bank_mask:0xf
    v_add_f32_dpp v28, v40, v40 row_ror:4 row_mask:0xf bank_mask:0x1
    v_add_f32_dpp v29, v41, v41 row_ror:4 row_mask:0xf bank_mask:0x1
    v_add_f32_dpp v30, v42, v42 row_ror:4 row_mask:0xf bank_mask:0x1
    v_add_f32_dpp v31, v43, v43 row_ror:4 row_mask:0xf bank_mask:0x1
    v_add_f32_dpp v28, v44, v44 row_ror:4 row_mask:0xf bank_mask:0x2
    v_add_f32_dpp v29, v45, v45 row_ror:4 row_mask:0xf bank_mask:0x2
    v_add_f32_dpp v30, v46, v46 row_ror:4 row_mask:0xf bank_mask:0x2
    v_add_f32_dpp v31, v47, v47 row_ror:4 row_mask:0xf bank_mask:0x2
    v_add_f32_dpp v28, v48, v48 row_ror:4 row_mask:0xf bank_mask:0x4
    v_add_f32_dpp v29, v49, v49 row_ror:4 row_mask:0xf bank_mask:0x4
    v_add_f32_dpp v30, v50, v50 row_ror:4 row_mask:0xf bank_mask:0x4
    v_add_f32_dpp v31, v51, v51 row_ror:4 row_mask:0xf bank_mask:0x4
    v_add_f32_dpp v28, v52, v52 row_ror:4 row_mask:0xf bank_mask:0x8
    v_add_f32_dpp v29, v53, v53 row_ror:4 row_mask:0xf bank_mask:0x8
    v_add_f32_dpp v30, v54, v54 row_ror:4 row_mask:0xf bank_mask:0x8
    v_add_f32_dpp v31, v55, v55 row_ror:4 row_mask:0xf bank_mask:0x8
    ds_write_b128 v6, v[28:31]
    s_mov_b64 exec, 1
    ds_add_rtn_u32 v34, v32, v33
    s_mov_b64 exec, -1
    ds_read_b128 v[8:11], v5
    ds_read_b128 v[12:15], v5 offset:1024
    ds_read_b128 v[16:19], v5 offset:2048
    ds_read_b128 v[20:23], v5 offset:3072
    s_waitcnt lgkmcnt(0)
    v_readfirstlane_b32 s62, v34
    v_mov_b32 v24, s58
    s_cmp_eq_u32 s62, s15
    s_cbranch_scc1 L_u_last
    s_cmp_eq_u32 s62, 1
    s_cbranch_scc1 L_service
    s_endpgm
L_u_last:
    v_add_f32 v8, v8, v12
    v_add_f32 v9, v9, v13
    v_add_f32 v10, v10, v14
    v_add_f32 v11, v11, v15
    s_cmp_eq_u32 s15, 1
    s_cbranch_scc1 L_u_two
    v_add_f32 v16, v16, v20
    v_add_f32 v17, v17, v21
    v_add_f32 v18, v18, v22
    v_add_f32 v19, v19, v23
    v_add_f32 v8, v8, v16
    v_add_f32 v9, v9, v17
    v_add_f32 v10, v10, v18
    v_add_f32 v11, v11, v19
L_u_two:
    v_fma_f32 v8, v8, s59, v24
    v_fma_f32 v9, v9, s59, v24
    v_fma_f32 v10, v10, s59, v24
    v_fma_f32 v11, v11, s59, v24
    v_mul_f32 v8, v8, v56
    v_mul_f32 v9, v9, v57
    v_mul_f32 v10, v10, v58
    v_mul_f32 v11, v11, v59
    v_cvt_pk_bf16_f32 v8, v8, v9
    v_cvt_pk_bf16_f32 v9, v10, v11
    buffer_store_dwordx2 v[8:9], v64, s[40:43], s57 offen sc1
    s_endpgm
L_touch:
    s_load_dword s0, s[32:33], 0
    s_load_dword s0, s[30:31], 0
    s_cmp_eq_u32 s39, 1
    s_cbranch_scc1 L_tpr
    s_mov_b32 s62, 16777216
    s_load_dword s0, s[8:9], s62
    s_mov_b32 s62, 83886080
    s_load_dword s0, s[8:9], s62
    s_mov_b32 s62, 150994944
    s_load_dword s0, s[8:9], s62
    s_mov_b32 s62, 218103808
    s_load_dword s0, s[8:9], s62
    s_branch L_tpv
L_tpr:
    s_load_dword s0, s[20:21], 0
    s_mov_b32 s62, 2211836
    s_load_dword s0, s[20:21], s62
    s_load_dword s0, s[16:17], 0
    s_mov_b32 s62, 2211836
    s_load_dword s0, s[16:17], s62
    s_load_dword s0, s[18:19], 0
    s_load_dword s0, s[22:23], 0
    s_load_dword s0, s[28:29], 0
    s_load_dword s0, s[4:5], 0
L_tpv:
    s_lshl_b32 s62, s34, 23
    s_load_dword s0, s[8:9], s62
    s_add_u32 s62, s62, 67108864
    s_load_dword s0, s[8:9], s62
    s_add_u32 s62, s62, 67108864
    s_load_dword s0, s[8:9], s62
    s_add_u32 s62, s62, 67108864
    s_load_dword s0, s[8:9], s62
    s_add_u32 s62, s62, 67108864
    s_branch L_notp
L_stream2:
    s_mov_b32 s12, s100
    s_mov_b32 s13, s101
    s_mov_b32 s40, s32
    s_mov_b32 s41, s33
    s_mov_b32 s42, 589824
    s_mov_b32 s43, 0x20000
    s_mov_b32 s44, s30
    s_mov_b32 s45, s31
    s_mov_b32 s46, 256
    s_mov_b32 s47, 0x20000
    s_bitcmp1_b32 s3, 0
    s_mov_b32 s57, 0xffffffff
    s_mov_b32 s58, 0xff00ff
    s_cselect_b32 s58, 0xff00ff00, s58
    s_mov_b32 s14, 0xffffffff
    s_mov_b32 s15, 0x0
L_pm_10:
    s_cmp_lt_u32 s56, 104
    s_cbranch_scc0 L_pm_11
    s_bitcmp1_b32 s3, 0
    s_mov_b32 s57, 0xffff
    s_mov_b32 s58, 0x0
    s_mov_b32 s14, 0xffffffff
    s_mov_b32 s15, 0x0
L_pm_11:
    s_sub_u32 s96, s56, 43
    s_and_b32 s96, s96, 0xffffffc7
    s_cmp_eq_u32 s96, 0
    s_cbranch_scc0 L_pm_12
    s_bitcmp1_b32 s3, 0
    s_mov_b32 s57, 0x0
    s_mov_b32 s58, 0x0
    s_mov_b32 s14, 0x0
    s_mov_b32 s15, 0x0
L_pm_12:
    s_cmp_lt_u32 s56, 40
    s_cbranch_scc0 L_pm_13
    s_bitcmp1_b32 s3, 0
    s_mov_b32 s57, 0xffffffff
    s_mov_b32 s58, 0xf
    s_mov_b32 s14, 0xffffffff
    s_mov_b32 s15, 0x0
L_pm_13:
    s_cmp_eq_u32 s39, 1
    s_cbranch_scc0 L_pm_14
    s_bitcmp1_b32 s3, 0
    s_mov_b32 s57, 0xffffffff
    s_mov_b32 s58, 0x0
    s_mov_b32 s14, 0xffffffff
    s_mov_b32 s15, 0x0
L_pm_14:
    s_cmp_lg_u32 s13, 0
    s_cbranch_scc0 L_pm_15
    s_bitcmp1_b32 s3, 0
    s_mov_b32 s57, 0x0
    s_mov_b32 s58, 0x0
    s_mov_b32 s14, 0x0
    s_mov_b32 s15, 0x0
L_pm_15:
    s_and_b32 s96, s39, s59
    s_cbranch_scc0 L_pm_16
    s_bitcmp1_b32 s3, 0
    s_mov_b32 s57, 0xffffffff
    s_mov_b32 s58, 0x0
    s_mov_b32 s14, 0x0
    s_mov_b32 s15, 0x0
L_pm_16:
    s_add_u32 s52, s8, s63
    s_addc_u32 s53, s9, 0
    s_mov_b32 s54, 262144
    s_mov_b32 s55, 0x20000
    v_and_b32 v2, 15, v0
    v_lshrrev_b32 v3, 1, v2
    v_and_b32 v37, 1, v2
    v_lshlrev_b32 v37, 4, v37
    v_mov_b32 v38, 0xffff
    v_lshlrev_b32 v37, v37, v38
    v_cmp_eq_u32 vcc, 0, v3
    v_mov_b32 v32, 0
    s_nop 0
    v_cndmask_b32 v20, 0, v37, vcc
    v_cmp_eq_u32 vcc, 1, v3
    v_mov_b32 v33, 0
    s_nop 0
    v_cndmask_b32 v21, 0, v37, vcc
    v_cmp_eq_u32 vcc, 2, v3
    v_mov_b32 v34, 0
    s_nop 0
    v_cndmask_b32 v22, 0, v37, vcc
    v_cmp_eq_u32 vcc, 3, v3
    v_mov_b32 v35, 0
    s_nop 0
    v_cndmask_b32 v23, 0, v37, vcc
    v_lshlrev_b32 v2, 4, v2
    s_lshl_b32 s98, s62, 8
    s_add_u32 s98, s98, 40960
    s_lshl_b32 s99, s62, 7
    s_add_u32 s99, s99, 73728
    s_bitcmp0_b32 s57, 2
    s_cbranch_scc1 L_sf_17
    s_bitcmp0_b32 s58, 2
    s_cbranch_scc1 L_sf_17
    s_waitcnt vmcnt(1)
L_sf_17:
    buffer_load_dwordx4 v[48:51], v1, s[48:51], s97 offen offset:2048 nt
    s_bitcmp0_b32 s57, 3
    s_cbranch_scc1 L_sf_18
    s_waitcnt vmcnt(2)
    s_bitcmp0_b32 s58, 3
    s_cbranch_scc1 L_sf_18
    s_waitcnt vmcnt(1)
L_sf_18:
    buffer_load_dwordx4 v[52:55], v1, s[48:51], s97 offen offset:3072 nt
    s_add_u32 s97, s97, 32768
    v_add_u32 v1, 4096, v1
    v_and_b32 v1, 0x7fff, v1
    s_waitcnt vmcnt(3)
    s_bitcmp0_b32 s57, 4
    s_cbranch_scc1 L_sf_19
    s_waitcnt vmcnt(2)
    s_bitcmp0_b32 s58, 4
    s_cbranch_scc1 L_sf_19
    s_waitcnt vmcnt(1)
L_sf_19:
    buffer_load_dwordx4 v[56:59], v1, s[48:51], s97 offen offset:0 nt
    s_waitcnt vmcnt(3)
    s_bitcmp0_b32 s57, 5
    s_cbranch_scc1 L_sf_20
    s_waitcnt vmcnt(2)
    s_bitcmp0_b32 s58, 5
    s_cbranch_scc1 L_sf_20
    s_waitcnt vmcnt(1)
L_sf_20:
    buffer_load_dwordx4 v[60:63], v1, s[48:51], s97 offen offset:1024 nt
    s_waitcnt vmcnt(3)
    s_bitcmp0_b32 s57, 6
    s_cbranch_scc1 L_sf_21
    s_waitcnt vmcnt(2)
    s_bitcmp0_b32 s58, 6
    s_cbranch_scc1 L_sf_21
    s_waitcnt vmcnt(1)
L_sf_21:
    buffer_load_dwordx4 v[64:67], v1, s[48:51], s97 offen offset:2048 nt
    s_waitcnt vmcnt(3)
    s_bitcmp0_b32 s57, 7
    s_cbranch_scc1 L_sf_22
    s_waitcnt vmcnt(2)
    s_bitcmp0_b32 s58, 7
    s_cbranch_scc1 L_sf_22
    s_waitcnt vmcnt(1)
L_sf_22:
    buffer_load_dwordx4 v[68:71], v1, s[48:51], s97 offen offset:3072 nt
    s_add_u32 s97, s97, 32768
    v_add_u32 v1, 4096, v1
    v_and_b32 v1, 0x7fff, v1
    s_waitcnt vmcnt(3)
    s_bitcmp0_b32 s57, 8
    s_cbranch_scc1 L_sf_23
    s_waitcnt vmcnt(2)
    s_bitcmp0_b32 s58, 8
    s_cbranch_scc1 L_sf_23
    s_waitcnt vmcnt(1)
L_sf_23:
    buffer_load_dwordx4 v[72:75], v1, s[48:51], s97 offen offset:0 nt
    s_waitcnt vmcnt(3)
    s_bitcmp0_b32 s57, 9
    s_cbranch_scc1 L_sf_24
    s_waitcnt vmcnt(2)
    s_bitcmp0_b32 s58, 9
    s_cbranch_scc1 L_sf_24
    s_waitcnt vmcnt(1)
L_sf_24:
    buffer_load_dwordx4 v[76:79], v1, s[48:51], s97 offen offset:1024 nt
    s_waitcnt vmcnt(3)
    s_bitcmp0_b32 s57, 10
    s_cbranch_scc1 L_sf_25
    s_waitcnt vmcnt(2)
    s_bitcmp0_b32 s58, 10
    s_cbranch_scc1 L_sf_25
    s_waitcnt vmcnt(1)
L_sf_25:
    buffer_load_dwordx4 v[80:83], v1, s[48:51], s97 offen offset:2048 nt
    s_waitcnt vmcnt(3)
    s_bitcmp0_b32 s57, 11
    s_cbranch_scc1 L_sf_26
    s_waitcnt vmcnt(2)
    s_bitcmp0_b32 s58, 11
    s_cbranch_scc1 L_sf_26
    s_waitcnt vmcnt(1)
L_sf_26:
    buffer_load_dwordx4 v[84:87], v1, s[48:51], s97 offen offset:3072 nt
    s_add_u32 s97, s97, 32768
    v_add_u32 v1, 4096, v1
    v_and_b32 v1, 0x7fff, v1
    s_waitcnt vmcnt(3)
    s_bitcmp0_b32 s57, 12
    s_cbranch_scc1 L_sf_27
    s_waitcnt vmcnt(2)
    s_bitcmp0_b32 s58, 12
    s_cbranch_scc1 L_sf_27
    s_waitcnt vmcnt(1)
L_sf_27:
    buffer_load_dwordx4 v[88:91], v1, s[48:51], s97 offen offset:0 nt
    s_waitcnt vmcnt(3)
    s_bitcmp0_b32 s57, 13
    s_cbranch_scc1 L_sf_28
    s_waitcnt vmcnt(2)
    s_bitcmp0_b32 s58, 13
    s_cbranch_scc1 L_sf_28
    s_waitcnt vmcnt(1)
L_sf_28:
    buffer_load_dwordx4 v[92:95], v1, s[48:51], s97 offen offset:1024 nt
    s_waitcnt vmcnt(3)
    s_bitcmp0_b32 s57, 14
    s_cbranch_scc1 L_sf_29
    s_waitcnt vmcnt(2)
    s_bitcmp0_b32 s58, 14
    s_cbranch_scc1 L_sf_29
    s_waitcnt vmcnt(1)
L_sf_29:
    buffer_load_dwordx4 v[96:99], v1, s[48:51], s97 offen offset:2048 nt
    s_waitcnt vmcnt(3)
    s_bitcmp0_b32 s57, 15
    s_cbranch_scc1 L_sf_30
    s_waitcnt vmcnt(2)
    s_bitcmp0_b32 s58, 15
    s_cbranch_scc1 L_sf_30
    s_waitcnt vmcnt(1)
L_sf_30:
    buffer_load_dwordx4 v[100:103], v1, s[48:51], s97 offen offset:3072 nt
    s_add_u32 s97, s97, 32768
    v_add_u32 v1, 4096, v1
    v_and_b32 v1, 0x7fff, v1
    s_waitcnt vmcnt(3)
    s_bitcmp0_b32 s57, 16
    s_cbranch_scc1 L_sf_31
    s_waitcnt vmcnt(2)
    s_bitcmp0_b32 s58, 16
    s_cbranch_scc1 L_sf_31
    s_waitcnt vmcnt(1)
L_sf_31:
    buffer_load_dwordx4 v[104:107], v1, s[48:51], s97 offen offset:0 nt
    s_waitcnt vmcnt(3)
    s_bitcmp0_b32 s57, 17
    s_cbranch_scc1 L_sf_32
    s_waitcnt vmcnt(2)
    s_bitcmp0_b32 s58, 17
    s_cbranch_scc1 L_sf_32
    s_waitcnt vmcnt(1)
L_sf_32:
    buffer_load_dwordx4 v[108:111], v1, s[48:51], s97 offen offset:1024 nt
    s_waitcnt vmcnt(3)
    s_bitcmp0_b32 s57, 18
    s_cbranch_scc1 L_sf_33
    s_waitcnt vmcnt(2)
    s_bitcmp0_b32 s58, 18
    s_cbranch_scc1 L_sf_33
    s_waitcnt vmcnt(1)
L_sf_33:
    buffer_load_dwordx4 v[112:115], v1, s[48:51], s97 offen offset:2048 nt
    s_waitcnt vmcnt(3)
    s_bitcmp0_b32 s57, 19
    s_cbranch_scc1 L_sf_34
    s_waitcnt vmcnt(2)
    s_bitcmp0_b32 s58, 19
    s_cbranch_scc1 L_sf_34
    s_waitcnt vmcnt(1)
L_sf_34:
    buffer_load_dwordx4 v[116:119], v1, s[48:51], s97 offen offset:3072 nt
    s_add_u32 s97, s97, 32768
    v_add_u32 v1, 4096, v1
    v_and_b32 v1, 0x7fff, v1
    s_waitcnt vmcnt(3)
    s_bitcmp0_b32 s57, 20
    s_cbranch_scc1 L_sf_35
    s_waitcnt vmcnt(2)
    s_bitcmp0_b32 s58, 20
    s_cbranch_scc1 L_sf_35
    s_waitcnt vmcnt(1)
L_sf_35:
    buffer_load_dwordx4 v[120:123], v1, s[48:51], s97 offen offset:0 nt
    s_waitcnt vmcnt(3)
    s_bitcmp0_b32 s57, 21
    s_cbranch_scc1 L_sf_36
    s_waitcnt vmcnt(2)
    s_bitcmp0_b32 s58, 21
    s_cbranch_scc1 L_sf_36
    s_waitcnt vmcnt(1)
L_sf_36:
    buffer_load_dwordx4 v[124:127], v1, s[48:51], s97 offen offset:1024 nt
    s_cmp_eq_u32 s12, -1
    s_cbranch_scc1 L_k_nopf
    s_waitcnt vmcnt(3)
    s_bitcmp0_b32 s57, 22
    s_cbranch_scc1 L_sf_37
    s_waitcnt vmcnt(2)
    s_bitcmp0_b32 s58, 22
    s_cbranch_scc1 L_sf_37
    s_waitcnt vmcnt(1)
L_sf_37:
    buffer_load_dwordx4 v[128:131], v1, s[48:51], s97 offen offset:2048 nt
    s_waitcnt vmcnt(3)
    s_bitcmp0_b32 s57, 23
    s_cbranch_scc1 L_sf_38
    s_waitcnt vmcnt(2)
    s_bitcmp0_b32 s58, 23
    s_cbranch_scc1 L_sf_38
    s_waitcnt vmcnt(1)
L_sf_38:
    buffer_load_dwordx4 v[132:135], v1, s[48:51], s97 offen offset:3072 nt
    s_add_u32 s97, s97, 32768
    v_add_u32 v1, 4096, v1
    v_and_b32 v1, 0x7fff, v1
    s_waitcnt vmcnt(3)
    s_bitcmp0_b32 s57, 24
    s_cbranch_scc1 L_sf_39
    s_waitcnt vmcnt(2)
    s_bitcmp0_b32 s58, 24
    s_cbranch_scc1 L_sf_39
    s_waitcnt vmcnt(1)
L_sf_39:
    buffer_load_dwordx4 v[136:139], v1, s[48:51], s97 offen offset:0 nt
    s_waitcnt vmcnt(3)
    s_bitcmp0_b32 s57, 25
    s_cbranch_scc1 L_sf_40
    s_waitcnt vmcnt(2)
    s_bitcmp0_b32 s58, 25
    s_cbranch_scc1 L_sf_40
    s_waitcnt vmcnt(1)
L_sf_40:
    buffer_load_dwordx4 v[140:143], v1, s[48:51], s97 offen offset:1024 nt
    s_waitcnt vmcnt(3)
    s_bitcmp0_b32 s57, 26
    s_cbranch_scc1 L_sf_41
    s_waitcnt vmcnt(2)
    s_bitcmp0_b32 s58, 26
    s_cbranch_scc1 L_sf_41
    s_waitcnt vmcnt(1)
L_sf_41:
    buffer_load_dwordx4 v[144:147], v1, s[48:51], s97 offen offset:2048 nt
    s_waitcnt vmcnt(3)
    s_bitcmp0_b32 s57, 27
    s_cbranch_scc1 L_sf_42
    s_waitcnt vmcnt(2)
    s_bitcmp0_b32 s58, 27
    s_cbranch_scc1 L_sf_42
    s_waitcnt vmcnt(1)
L_sf_42:
    buffer_load_dwordx4 v[148:151], v1, s[48:51], s97 offen offset:3072 nt
    s_add_u32 s97, s97, 32768
    v_add_u32 v1, 4096, v1
    v_and_b32 v1, 0x7fff, v1
    s_waitcnt vmcnt(3)
    s_bitcmp0_b32 s57, 28
    s_cbranch_scc1 L_sf_43
    s_waitcnt vmcnt(2)
    s_bitcmp0_b32 s58, 28
    s_cbranch_scc1 L_sf_43
    s_waitcnt vmcnt(1)
L_sf_43:
    buffer_load_dwordx4 v[152:155], v1, s[48:51], s97 offen offset:0 nt
    s_waitcnt vmcnt(3)
    s_bitcmp0_b32 s57, 29
    s_cbranch_scc1 L_sf_44
    s_waitcnt vmcnt(2)
    s_bitcmp0_b32 s58, 29
    s_cbranch_scc1 L_sf_44
    s_waitcnt vmcnt(1)
L_sf_44:
    buffer_load_dwordx4 v[156:159], v1, s[48:51], s97 offen offset:1024 nt
    s_waitcnt vmcnt(3)
    s_bitcmp0_b32 s57, 30
    s_cbranch_scc1 L_sf_45
    s_waitcnt vmcnt(2)
    s_bitcmp0_b32 s58, 30
    s_cbranch_scc1 L_sf_45
    s_waitcnt vmcnt(1)
L_sf_45:
    buffer_load_dwordx4 v[160:163], v1, s[48:51], s97 offen offset:2048 nt
    v_min_u32 v39, 29, v0
    v_lshlrev_b32 v39, 2, v39
    buffer_load_dword v37, v39, s[44:47], 0 offen sc1
    s_waitcnt vmcnt(4)
    s_bitcmp0_b32 s57, 31
    s_cbranch_scc1 L_sf_46
    s_waitcnt vmcnt(3)
    s_bitcmp0_b32 s58, 31
    s_cbranch_scc1 L_sf_46
    s_waitcnt vmcnt(2)
L_sf_46:
    buffer_load_dwordx4 v[164:167], v1, s[48:51], s97 offen offset:3072 nt
    s_mov_b32 s97, 0
    v_add_u32 v1, 4096, v1
    v_and_b32 v1, 0x7fff, v1
    s_waitcnt vmcnt(4)
    s_bitcmp0_b32 s14, 0
    s_cbranch_scc1 L_sf_47
    s_waitcnt vmcnt(3)
    s_bitcmp0_b32 s15, 0
    s_cbranch_scc1 L_sf_47
    s_waitcnt vmcnt(2)
L_sf_47:
    s_add_u32 m0, s12, 0
    s_nop 0
    buffer_load_dwordx4 v1, s[52:55], s97 offen offset:0 nt lds
    s_waitcnt vmcnt(4)
    s_bitcmp0_b32 s14, 1
    s_cbranch_scc1 L_sf_48
    s_waitcnt vmcnt(3)
    s_bitcmp0_b32 s15, 1
    s_cbranch_scc1 L_sf_48
    s_waitcnt vmcnt(1)
L_sf_48:
    buffer_load_dwordx4 v1, s[52:55], s97 offen offset:1024 nt lds
    s_waitcnt vmcnt(4)
    s_bitcmp0_b32 s14, 2
    s_cbranch_scc1 L_sf_49
    s_waitcnt vmcnt(2)
    s_bitcmp0_b32 s15, 2
    s_cbranch_scc1 L_sf_49
    s_waitcnt vmcnt(1)
L_sf_49:
    buffer_load_dwordx4 v1, s[52:55], s97 offen offset:2048 nt lds
    s_waitcnt vmcnt(3)
    s_bitcmp0_b32 s14, 3
    s_cbranch_scc1 L_sf_50
    s_waitcnt vmcnt(2)
    s_bitcmp0_b32 s15, 3
    s_cbranch_scc1 L_sf_50
    s_waitcnt vmcnt(1)
L_sf_50:
    buffer_load_dwordx4 v1, s[52:55], s97 offen offset:3072 nt lds
    s_add_u32 s97, s97, 32768
    v_add_u32 v1, 4096, v1
    v_and_b32 v1, 0x7fff, v1
    v_cmp_eq_u32 vcc, 0, v37
    s_nop 0
    s_or_b32 s96, vcc_lo, vcc_hi
    buffer_load_dwordx4 v[4:7], v2, s[40:43], s98 offen sc1
    s_waitcnt vmcnt(4)
    s_bitcmp0_b32 s14, 4
    s_cbranch_scc1 L_sf_51
    s_waitcnt vmcnt(3)
    s_bitcmp0_b32 s15, 4
    s_cbranch_scc1 L_sf_51
    s_waitcnt vmcnt(2)
L_sf_51:
    s_add_u32 m0, s12, 4096
    s_nop 0
    buffer_load_dwordx4 v1, s[52:55], s97 offen offset:0 nt lds
    s_waitcnt vmcnt(4)
    s_bitcmp0_b32 s14, 5
    s_cbranch_scc1 L_sf_52
    s_waitcnt vmcnt(3)
    s_bitcmp0_b32 s15, 5
    s_cbranch_scc1 L_sf_52
    s_waitcnt vmcnt(2)
L_sf_52:
    buffer_load_dwordx4 v1, s[52:55], s97 offen offset:1024 nt lds
    s_waitcnt vmcnt(4)
    s_bitcmp0_b32 s14, 6
    s_cbranch_scc1 L_sf_53
    s_waitcnt vmcnt(3)
    s_bitcmp0_b32 s15, 6
    s_cbranch_scc1 L_sf_53
    s_waitcnt vmcnt(1)
L_sf_53:
    buffer_load_dwordx4 v1, s[52:55], s97 offen offset:2048 nt lds
    s_waitcnt vmcnt(4)
    s_bitcmp0_b32 s14, 7
    s_cbranch_scc1 L_sf_54
    s_waitcnt vmcnt(2)
    s_bitcmp0_b32 s15, 7
    s_cbranch_scc1 L_sf_54
    s_waitcnt vmcnt(1)
L_sf_54:
    buffer_load_dwordx4 v1, s[52:55], s97 offen offset:3072 nt lds
    s_add_u32 s97, s97, 32768
    v_add_u32 v1, 4096, v1
    v_and_b32 v1, 0x7fff, v1
L_k_join:
    s_waitcnt vmcnt(4)
    v_max3_u32 v38, v4, v5, v6
    v_max_u32 v38, v38, v7
    v_cmp_eq_u32 vcc, -1, v38
    s_cmp_lg_u32 s96, 0
    s_cbranch_scc1 L_qslow
    s_cbranch_vccnz L_qslow2
L_qok:
    v_dot2_f32_bf16 v8, v72, v4, 0
    v_dot2_f32_bf16 v9, v76, v4, 0
    v_dot2_f32_bf16 v10, v80, v4, 0
    v_dot2_f32_bf16 v11, v84, v4, 0
    v_dot2_f32_bf16 v24, v88, v4, 0
    v_dot2_f32_bf16 v25, v92, v4, 0
    v_dot2_f32_bf16 v26, v96, v4, 0
    v_dot2_f32_bf16 v27, v100, v4, 0
    v_dot2_f32_bf16 v8, v73, v5, v8
    v_dot2_f32_bf16 v9, v77, v5, v9
    v_dot2_f32_bf16 v10, v81, v5, v10
    v_dot2_f32_bf16 v11, v85, v5, v11
    v_dot2_f32_bf16 v24, v89, v5, v24
    v_dot2_f32_bf16 v25, v93, v5, v25
    v_dot2_f32_bf16 v26, v97, v5, v26
    v_dot2_f32_bf16 v27, v101, v5, v27
    v_dot2_f32_bf16 v8, v74, v6, v8
    v_dot2_f32_bf16 v9, v78, v6, v9
    v_dot2_f32_bf16 v10, v82, v6, v10
    v_dot2_f32_bf16 v11, v86, v6, v11
    v_dot2_f32_bf16 v24, v90, v6, v24
    v_dot2_f32_bf16 v25, v94, v6, v25
    v_dot2_f32_bf16 v26, v98, v6, v26
    v_dot2_f32_bf16 v27, v102, v6, v27
    v_dot2_f32_bf16 v8, v75, v7, v8
    v_dot2_f32_bf16 v9, v79, v7, v9
    v_dot2_f32_bf16 v10, v83, v7, v10
    v_dot2_f32_bf16 v11, v87, v7, v11
    v_dot2_f32_bf16 v24, v91, v7, v24
    v_dot2_f32_bf16 v25, v95, v7, v25
    v_dot2_f32_bf16 v26, v99, v7, v26
    v_dot2_f32_bf16 v27, v103, v7, v27
    v_add_f32_dpp v8, v8, v8 row_ror:8 row_mask:0xf bank_mask:0x3
    v_add_f32_dpp v10, v10, v10 row_ror:8 row_mask:0xf bank_mask:0x3
    v_add_f32_dpp v24, v24, v24 row_ror:8 row_mask:0xf bank_mask:0x3
    v_add_f32_dpp v26, v26, v26 row_ror:8 row_mask:0xf bank_mask:0x3
    v_add_f32_dpp v8, v9, v9 row_ror:8 row_mask:0xf bank_mask:0xc
    v_add_f32_dpp v10, v11, v11 row_ror:8 row_mask:0xf bank_mask:0xc
    v_add_f32_dpp v24, v25, v25 row_ror:8 row_mask:0xf bank_mask:0xc
    v_add_f32_dpp v26, v27, v27 row_ror:8 row_mask:0xf bank_mask:0xc
    v_add_f32_dpp v14, v8, v8 row_half_mirror row_mask:0xf bank_mask:0x5
    v_add_f32_dpp v15, v24, v24 row_half_mirror row_mask:0xf bank_mask:0x5
    v_add_f32_dpp v14, v10, v10 row_half_mirror row_mask:0xf bank_mask:0xa
    v_add_f32_dpp v15, v26, v26 row_half_mirror row_mask:0xf bank_mask:0xa
    s_nop 0
    v_add_f32_dpp v14, v14, v14 quad_perm:[1,0,3,2] row_mask:0xf bank_mask:0xf
    v_add_f32_dpp v15, v15, v15 quad_perm:[1,0,3,2] row_mask:0xf bank_mask:0xf
    s_nop 0
    v_add_f32_dpp v14, v14, v14 quad_perm:[2,3,0,1] row_mask:0xf bank_mask:0xf
    v_add_f32_dpp v15, v15, v15 quad_perm:[2,3,0,1] row_mask:0xf bank_mask:0xf
    s_waitcnt vmcnt(3)
    s_bitcmp0_b32 s14, 8
    s_cbranch_scc1 L_sf_65
    s_waitcnt vmcnt(2)
    s_bitcmp0_b32 s15, 8
    s_cbranch_scc1 L_sf_65
    s_waitcnt vmcnt(1)
L_sf_65:
    buffer_load_dwordx4 v[72:75], v1, s[52:55], s97 offen offset:0 nt
    v_dot2_f32_bf16 v8, v40, v4, 0
    v_dot2_f32_bf16 v9, v44, v4, 0
    v_dot2_f32_bf16 v10, v48, v4, 0
    v_dot2_f32_bf16 v11, v52, v4, 0
    v_dot2_f32_bf16 v24, v56, v4, 0
    v_dot2_f32_bf16 v25, v60, v4, 0
    v_dot2_f32_bf16 v26, v64, v4, 0
    v_dot2_f32_bf16 v27, v68, v4, 0
    v_dot2_f32_bf16 v28, v104, v4, 0
    v_dot2_f32_bf16 v29, v108, v4, 0
    v_dot2_f32_bf16 v30, v112, v4, 0
    v_dot2_f32_bf16 v31, v116, v4, 0
    v_dot2_f32_bf16 v8, v41, v5, v8
    v_dot2_f32_bf16 v9, v45, v5, v9
    v_dot2_f32_bf16 v10, v49, v5, v10
    v_dot2_f32_bf16 v11, v53, v5, v11
    v_dot2_f32_bf16 v24, v57, v5, v24
    v_dot2_f32_bf16 v25, v61, v5, v25
    v_dot2_f32_bf16 v26, v65, v5, v26
    v_dot2_f32_bf16 v27, v69, v5, v27
    v_dot2_f32_bf16 v28, v105, v5, v28
    v_dot2_f32_bf16 v29, v109, v5, v29
    v_dot2_f32_bf16 v30, v113, v5, v30
    v_dot2_f32_bf16 v31, v117, v5, v31
    v_dot2_f32_bf16 v8, v42, v6, v8
    v_dot2_f32_bf16 v9, v46, v6, v9
    v_dot2_f32_bf16 v10, v50, v6, v10
    v_dot2_f32_bf16 v11, v54, v6, v11
    v_dot2_f32_bf16 v24, v58, v6, v24
    v_dot2_f32_bf16 v25, v62, v6, v25
    v_dot2_f32_bf16 v26, v66, v6, v26
    v_dot2_f32_bf16 v27, v70, v6, v27
    v_dot2_f32_bf16 v28, v106, v6, v28
    v_dot2_f32_bf16 v29, v110, v6, v29
    v_dot2_f32_bf16 v30, v114, v6, v30
    v_dot2_f32_bf16 v31, v118, v6, v31
    v_dot2_f32_bf16 v8, v43, v7, v8
    v_dot2_f32_bf16 v9, v47, v7, v9
    v_dot2_f32_bf16 v10, v51, v7, v10
    v_dot2_f32_bf16 v11, v55, v7, v11
    v_dot2_f32_bf16 v24, v59, v7, v24
    v_dot2_f32_bf16 v25, v63, v7, v25
    v_dot2_f32_bf16 v26, v67, v7, v26
    v_dot2_f32_bf16 v27, v71, v7, v27
    v_dot2_f32_bf16 v28, v107, v7, v28
    v_dot2_f32_bf16 v29, v111, v7, v29
    v_dot2_f32_bf16 v30, v115, v7, v30
    v_dot2_f32_bf16 v31, v119, v7, v31
    v_add_f32_dpp v8, v8, v8 row_ror:8 row_mask:0xf bank_mask:0x3
    v_add_f32_dpp v10, v10, v10 row_ror:8 row_mask:0xf bank_mask:0x3
    v_add_f32_dpp v24, v24, v24 row_ror:8 row_mask:0xf bank_mask:0x3
    v_add_f32_dpp v26, v26, v26 row_ror:8 row_mask:0xf bank_mask:0x3
    v_add_f32_dpp v28, v28, v28 row_ror:8 row_mask:0xf bank_mask:0x3
    v_add_f32_dpp v30, v30, v30 row_ror:8 row_mask:0xf bank_mask:0x3
    v_add_f32_dpp v8, v9, v9 row_ror:8 row_mask:0xf bank_mask:0xc
    v_add_f32_dpp v10, v11, v11 row_ror:8 row_mask:0xf bank_mask:0xc
    v_add_f32_dpp v24, v25, v25 row_ror:8 row_mask:0xf bank_mask:0xc
    v_add_f32_dpp v26, v27, v27 row_ror:8 row_mask:0xf bank_mask:0xc
    v_add_f32_dpp v28, v29, v29 row_ror:8 row_mask:0xf bank_mask:0xc
    v_add_f32_dpp v30, v31, v31 row_ror:8 row_mask:0xf bank_mask:0xc
    v_add_f32_dpp v12, v8, v8 row_half_mirror row_mask:0xf bank_mask:0x5
    v_add_f32_dpp v13, v24, v24 row_half_mirror row_mask:0xf bank_mask:0x5
    v_add_f32_dpp v16, v28, v28 row_half_mirror row_mask:0xf bank_mask:0x5
    v_add_f32_dpp v12, v10, v10 row_half_mirror row_mask:0xf bank_mask:0xa
    v_add_f32_dpp v13, v26, v26 row_half_mirror row_mask:0xf bank_mask:0xa
    v_add_f32_dpp v16, v30, v30 row_half_mirror row_mask:0xf bank_mask:0xa
    v_add_f32_dpp v12, v12, v12 quad_perm:[1,0,3,2] row_mask:0xf bank_mask:0xf
    v_add_f32_dpp v13, v13, v13 quad_perm:[1,0,3,2] row_mask:0xf bank_mask:0xf
    v_add_f32_dpp v16, v16, v16 quad_perm:[1,0,3,2] row_mask:0xf bank_mask:0xf
    v_add_f32_dpp v12, v12, v12 quad_perm:[2,3,0,1] row_mask:0xf bank_mask:0xf
    v_add_f32_dpp v13, v13, v13 quad_perm:[2,3,0,1] row_mask:0xf bank_mask:0xf
    v_add_f32_dpp v16, v16, v16 quad_perm:[2,3,0,1] row_mask:0xf bank_mask:0xf
    s_waitcnt vmcnt(3)
    s_bitcmp0_b32 s14, 9
    s_cbranch_scc1 L_sf_66
    s_waitcnt vmcnt(2)
    s_bitcmp0_b32 s15, 9
    s_cbranch_scc1 L_sf_66
    s_waitcnt vmcnt(1)
L_sf_66:
    buffer_load_dwordx4 v[76:79], v1, s[52:55], s97 offen offset:1024 nt
    v_dot2_f32_bf16 v8, v120, v4, 0
    v_dot2_f32_bf16 v9, v124, v4, 0
    v_dot2_f32_bf16 v10, v128, v4, 0
    v_dot2_f32_bf16 v11, v132, v4, 0
    v_dot2_f32_bf16 v24, v136, v4, 0
    v_dot2_f32_bf16 v25, v140, v4, 0
    v_dot2_f32_bf16 v26, v144, v4, 0
    v_dot2_f32_bf16 v27, v148, v4, 0
    v_dot2_f32_bf16 v8, v121, v5, v8
    v_dot2_f32_bf16 v9, v125, v5, v9
    v_dot2_f32_bf16 v10, v129, v5, v10
    v_dot2_f32_bf16 v11, v133, v5, v11
    v_dot2_f32_bf16 v24, v137, v5, v24
    v_dot2_f32_bf16 v25, v141, v5, v25
    v_dot2_f32_bf16 v26, v145, v5, v26
    v_dot2_f32_bf16 v27, v149, v5, v27
    v_dot2_f32_bf16 v8, v122, v6, v8
    v_dot2_f32_bf16 v9, v126, v6, v9
    v_dot2_f32_bf16 v10, v130, v6, v10
    v_dot2_f32_bf16 v11, v134, v6, v11
    v_dot2_f32_bf16 v24, v138, v6, v24
    v_dot2_f32_bf16 v25, v142, v6, v25
    v_dot2_f32_bf16 v26, v146, v6, v26
    v_dot2_f32_bf16 v27, v150, v6, v27
    v_dot2_f32_bf16 v8, v123, v7, v8
    v_dot2_f32_bf16 v9, v127, v7, v9
    v_dot2_f32_bf16 v10, v131, v7, v10
    v_dot2_f32_bf16 v11, v135, v7, v11
    v_dot2_f32_bf16 v24, v139, v7, v24
    v_dot2_f32_bf16 v25, v143, v7, v25
    v_dot2_f32_bf16 v26, v147, v7, v26
    v_dot2_f32_bf16 v27, v151, v7, v27
    v_add_f32_dpp v8, v8, v8 row_ror:8 row_mask:0xf bank_mask:0x3
    v_add_f32_dpp v10, v10, v10 row_ror:8 row_mask:0xf bank_mask:0x3
    v_add_f32_dpp v24, v24, v24 row_ror:8 row_mask:0xf bank_mask:0x3
    v_add_f32_dpp v26, v26, v26 row_ror:8 row_mask:0xf bank_mask:0x3
    v_add_f32_dpp v8, v9, v9 row_ror:8 row_mask:0xf bank_mask:0xc
    v_add_f32_dpp v10, v11, v11 row_ror:8 row_mask:0xf bank_mask:0xc
    v_add_f32_dpp v24, v25, v25 row_ror:8 row_mask:0xf bank_mask:0xc
    v_add_f32_dpp v26, v27, v27 row_ror:8 row_mask:0xf bank_mask:0xc
    v_add_f32_dpp v17, v8, v8 row_half_mirror row_mask:0xf bank_mask:0x5
    v_add_f32_dpp v18, v24, v24 row_half_mirror row_mask:0xf bank_mask:0x5
    v_add_f32_dpp v17, v10, v10 row_half_mirror row_mask:0xf bank_mask:0xa
    v_add_f32_dpp v18, v26, v26 row_half_mirror row_mask:0xf bank_mask:0xa
    s_nop 0
    v_add_f32_dpp v17, v17, v17 quad_perm:[1,0,3,2] row_mask:0xf bank_mask:0xf
    v_add_f32_dpp v18, v18, v18 quad_perm:[1,0,3,2] row_mask:0xf bank_mask:0xf
    s_nop 0
    v_add_f32_dpp v17, v17, v17 quad_perm:[2,3,0,1] row_mask:0xf bank_mask:0xf
    v_add_f32_dpp v18, v18, v18 quad_perm:[2,3,0,1] row_mask:0xf bank_mask:0xf
    s_waitcnt vmcnt(3)
    s_bitcmp0_b32 s14, 10
    s_cbranch_scc1 L_sf_67
    s_waitcnt vmcnt(2)
    s_bitcmp0_b32 s15, 10
    s_cbranch_scc1 L_sf_67
    s_waitcnt vmcnt(1)
L_sf_67:
    buffer_load_dwordx4 v[80:83], v1, s[52:55], s97 offen offset:2048 nt
    s_waitcnt vmcnt(3)
    s_bitcmp0_b32 s14, 11
    s_cbranch_scc1 L_sf_68
    s_waitcnt vmcnt(2)
    s_bitcmp0_b32 s15, 11
    s_cbranch_scc1 L_sf_68
    s_waitcnt vmcnt(1)
L_sf_68:
    buffer_load_dwordx4 v[84:87], v1, s[52:55], s97 offen offset:3072 nt
    s_add_u32 s97, s97, 32768
    v_add_u32 v1, 4096, v1
    v_and_b32 v1, 0x7fff, v1
    s_cmp_eq_u32 s12, -1
    s_cbranch_scc1 L_nopfrd
    v_lshl_add_u32 v38, v0, 4, s12
    ds_read_b128 v[40:43], v38 offset:0
    ds_read_b128 v[44:47], v38 offset:1024
    ds_read_b128 v[48:51], v38 offset:2048
    ds_read_b128 v[52:55], v38 offset:3072
    ds_read_b128 v[56:59], v38 offset:4096
    ds_read_b128 v[60:63], v38 offset:5120
    ds_read_b128 v[64:67], v38 offset:6144
    ds_read_b128 v[68:71], v38 offset:7168
L_nopfrd:
    v_dot2_f32_bf16 v8, v152, v4, 0
    v_dot2_f32_bf16 v9, v156, v4, 0
    v_dot2_f32_bf16 v10, v160, v4, 0
    v_dot2_f32_bf16 v11, v164, v4, 0
    v_dot2_f32_bf16 v8, v153, v5, v8
    v_dot2_f32_bf16 v9, v157, v5, v9
    v_dot2_f32_bf16 v10, v161, v5, v10
    v_dot2_f32_bf16 v11, v165, v5, v11
    v_dot2_f32_bf16 v8, v154, v6, v8
    v_dot2_f32_bf16 v9, v158, v6, v9
    v_dot2_f32_bf16 v10, v162, v6, v10
    v_dot2_f32_bf16 v11, v166, v6, v11
    v_dot2_f32_bf16 v8, v155, v7, v8
    v_dot2_f32_bf16 v9, v159, v7, v9
    v_dot2_f32_bf16 v10, v163, v7, v10
    v_dot2_f32_bf16 v11, v167, v7, v11
    v_add_f32_dpp v8, v8, v8 row_ror:8 row_mask:0xf bank_mask:0x3
    s_nop 0
    v_add_f32_dpp v10, v10, v10 row_ror:8 row_mask:0xf bank_mask:0x3
    v_add_f32_dpp v8, v9, v9 row_ror:8 row_mask:0xf bank_mask:0xc
    v_add_f32_dpp v10, v11, v11 row_ror:8 row_mask:0xf bank_mask:0xc
    s_nop 0
    v_add_f32_dpp v19, v8, v8 row_half_mirror row_mask:0xf bank_mask:0x5
    v_add_f32_dpp v19, v10, v10 row_half_mirror row_mask:0xf bank_mask:0xa
    s_nop 1
    v_add_f32_dpp v19, v19, v19 quad_perm:[1,0,3,2] row_mask:0xf bank_mask:0xf
    s_nop 1
    v_add_f32_dpp v19, v19, v19 quad_perm:[2,3,0,1] row_mask:0xf bank_mask:0xf
    v_max3_f32 v3, v12, v13, v14
    v_max3_f32 v8, v15, v16, v17
    v_max3_f32 v3, v3, v18, v19
    v_max_f32 v3, v3, v8
    s_nop 1
    v_max_f32_dpp v3, v3, v3 row_ror:4 row_mask:0xf bank_mask:0xf
    s_nop 1
    v_max_f32_dpp v3, v3, v3 row_ror:8 row_mask:0xf bank_mask:0xf
    v_mov_b32 v8, v3
    s_nop 1
    v_permlane16_swap_b32 v3, v8
    v_max_f32 v3, v3, v8
    v_mov_b32 v8, v3
    s_nop 1
    v_permlane32_swap_b32 v3, v8
    v_max_f32 v3, v3, v8
    s_mov_b32 s96, 0x3e0293ee
    v_mul_f32 v8, s96, v3
    v_fma_f32 v12, v12, s96, -v8
    v_fma_f32 v13, v13, s96, -v8
    v_fma_f32 v14, v14, s96, -v8
    v_fma_f32 v15, v15, s96, -v8
    v_fma_f32 v16, v16, s96, -v8
    v_fma_f32 v17, v17, s96, -v8
    v_fma_f32 v18, v18, s96, -v8
    v_fma_f32 v19, v19, s96, -v8
    v_exp_f32 v12, v12
    v_exp_f32 v13, v13
    v_exp_f32 v14, v14
    v_exp_f32 v15, v15
    v_exp_f32 v16, v16
    v_exp_f32 v17, v17
    v_exp_f32 v18, v18
    v_exp_f32 v19, v19
    v_add_f32 v9, v12, v13
    v_add_f32 v10, v14, v15
    v_add_f32 v11, v16, v17
    v_add_f32 v3, v18, v19
    v_add_f32 v9, v9, v10
    v_add_f32 v3, v3, v11
    v_add_f32 v9, v9, v3
    v_cvt_pk_bf16_f32 v12, v12, v12
    v_cvt_pk_bf16_f32 v13, v13, v13
    v_cvt_pk_bf16_f32 v14, v14, v14
    v_cvt_pk_bf16_f32 v15, v15, v15
    v_cvt_pk_bf16_f32 v16, v16, v16
    v_cvt_pk_bf16_f32 v17, v17, v17
    v_cvt_pk_bf16_f32 v18, v18, v18
    v_cvt_pk_bf16_f32 v19, v19, v19
    v_add_f32_dpp v9, v9, v9 row_ror:4 row_mask:0xf bank_mask:0xf
    s_nop 1
    v_add_f32_dpp v9, v9, v9 row_ror:8 row_mask:0xf bank_mask:0xf
    v_mov_b32 v10, v9
    s_nop 1
    v_permlane16_swap_b32 v9, v10
    v_add_f32 v9, v9, v10
    v_mov_b32 v10, v9
    s_nop 1
    v_permlane32_swap_b32 v9, v10
    v_add_f32 v9, v9, v10
    s_mov_b64 exec, 1
    s_cmp_lg_u32 s13, 0
    s_cbranch_scc1 L_mljob
    s_lshl_b32 s96, s3, 3
    s_add_u32 s96, s96, 161920
    v_mov_b32 v10, s96
    v_mov_b32 v11, 162068
    v_mov_b32 v3, 1
    ds_write_b64 v10, v[8:9]
    ds_add_u32 v11, v3
L_mldone:
    s_mov_b64 exec, -1
    v_lshrrev_b32 v2, 1, v2
    v_and_b32_dpp v24, v14, v20 row_newbcast:0 row_mask:0xf bank_mask:0xf
    v_and_b32_dpp v25, v14, v21 row_newbcast:0 row_mask:0xf bank_mask:0xf
    v_and_b32_dpp v26, v14, v22 row_newbcast:0 row_mask:0xf bank_mask:0xf
    v_and_b32_dpp v27, v14, v23 row_newbcast:0 row_mask:0xf bank_mask:0xf
    s_waitcnt vmcnt(3)
    s_bitcmp0_b32 s14, 12
    s_cbranch_scc1 L_sf_69
    s_waitcnt vmcnt(2)
    s_bitcmp0_b32 s15, 12
    s_cbranch_scc1 L_sf_69
    s_waitcnt vmcnt(1)
L_sf_69:
    buffer_load_dwordx4 v[88:91], v1, s[52:55], s97 offen offset:0 nt
    v_mfma_f32_16x16x32_bf16 v[32:35], v[24:27], v[72:75], v[32:35]
    s_cmp_eq_u32 s12, -1
    s_cbranch_scc1 L_nopfpv8
    s_waitcnt lgkmcnt(0)
    v_and_b32_dpp v24, v12, v20 row_newbcast:0 row_mask:0xf bank_mask:0xf
    v_and_b32_dpp v25, v12, v21 row_newbcast:0 row_mask:0xf bank_mask:0xf
    v_and_b32_dpp v26, v12, v22 row_newbcast:0 row_mask:0xf bank_mask:0xf
    v_and_b32_dpp v27, v12, v23 row_newbcast:0 row_mask:0xf bank_mask:0xf
    s_nop 1
    v_mfma_f32_16x16x32_bf16 v[32:35], v[24:27], v[40:43], v[32:35]
    v_and_b32_dpp v28, v12, v20 row_newbcast:8 row_mask:0xf bank_mask:0xf
    v_and_b32_dpp v29, v12, v21 row_newbcast:8 row_mask:0xf bank_mask:0xf
    v_and_b32_dpp v30, v12, v22 row_newbcast:8 row_mask:0xf bank_mask:0xf
    v_and_b32_dpp v31, v12, v23 row_newbcast:8 row_mask:0xf bank_mask:0xf
    s_nop 1
    v_mfma_f32_16x16x32_bf16 v[32:35], v[28:31], v[44:47], v[32:35]
    v_and_b32_dpp v24, v12, v20 row_newbcast:4 row_mask:0xf bank_mask:0xf
    v_and_b32_dpp v25, v12, v21 row_newbcast:4 row_mask:0xf bank_mask:0xf
    v_and_b32_dpp v26, v12, v22 row_newbcast:4 row_mask:0xf bank_mask:0xf
    v_and_b32_dpp v27, v12, v23 row_newbcast:4 row_mask:0xf bank_mask:0xf
    s_nop 1
    v_mfma_f32_16x16x32_bf16 v[32:35], v[24:27], v[48:51], v[32:35]
    v_and_b32_dpp v28, v12, v20 row_newbcast:12 row_mask:0xf bank_mask:0xf
    v_and_b32_dpp v29, v12, v21 row_newbcast:12 row_mask:0xf bank_mask:0xf
    v_and_b32_dpp v30, v12, v22 row_newbcast:12 row_mask:0xf bank_mask:0xf
    v_and_b32_dpp v31, v12, v23 row_newbcast:12 row_mask:0xf bank_mask:0xf
    s_nop 1
    v_mfma_f32_16x16x32_bf16 v[32:35], v[28:31], v[52:55], v[32:35]
L_nopfpv8:
    v_and_b32_dpp v28, v14, v20 row_newbcast:8 row_mask:0xf bank_mask:0xf
    v_and_b32_dpp v29, v14, v21 row_newbcast:8 row_mask:0xf bank_mask:0xf
    v_and_b32_dpp v30, v14, v22 row_newbcast:8 row_mask:0xf bank_mask:0xf
    v_and_b32_dpp v31, v14, v23 row_newbcast:8 row_mask:0xf bank_mask:0xf
    s_waitcnt vmcnt(3)
    s_bitcmp0_b32 s14, 13
    s_cbranch_scc1 L_sf_70
    s_waitcnt vmcnt(2)
    s_bitcmp0_b32 s15, 13
    s_cbranch_scc1 L_sf_70
    s_waitcnt vmcnt(1)
L_sf_70:
    buffer_load_dwordx4 v[92:95], v1, s[52:55], s97 offen offset:1024 nt
    v_mfma_f32_16x16x32_bf16 v[32:35], v[28:31], v[76:79], v[32:35]
    s_cmp_eq_u32 s12, -1
    s_cbranch_scc1 L_nopfpv9
    s_waitcnt lgkmcnt(0)
    v_and_b32_dpp v24, v13, v20 row_newbcast:0 row_mask:0xf bank_mask:0xf
    v_and_b32_dpp v25, v13, v21 row_newbcast:0 row_mask:0xf bank_mask:0xf
    v_and_b32_dpp v26, v13, v22 row_newbcast:0 row_mask:0xf bank_mask:0xf
    v_and_b32_dpp v27, v13, v23 row_newbcast:0 row_mask:0xf bank_mask:0xf
    s_nop 1
    v_mfma_f32_16x16x32_bf16 v[32:35], v[24:27], v[56:59], v[32:35]
    v_and_b32_dpp v28, v13, v20 row_newbcast:8 row_mask:0xf bank_mask:0xf
    v_and_b32_dpp v29, v13, v21 row_newbcast:8 row_mask:0xf bank_mask:0xf
    v_and_b32_dpp v30, v13, v22 row_newbcast:8 row_mask:0xf bank_mask:0xf
    v_and_b32_dpp v31, v13, v23 row_newbcast:8 row_mask:0xf bank_mask:0xf
    s_nop 1
    v_mfma_f32_16x16x32_bf16 v[32:35], v[28:31], v[60:63], v[32:35]
    v_and_b32_dpp v24, v13, v20 row_newbcast:4 row_mask:0xf bank_mask:0xf
    v_and_b32_dpp v25, v13, v21 row_newbcast:4 row_mask:0xf bank_mask:0xf
    v_and_b32_dpp v26, v13, v22 row_newbcast:4 row_mask:0xf bank_mask:0xf
    v_and_b32_dpp v27, v13, v23 row_newbcast:4 row_mask:0xf bank_mask:0xf
    s_nop 1
    v_mfma_f32_16x16x32_bf16 v[32:35], v[24:27], v[64:67], v[32:35]
    v_and_b32_dpp v28, v13, v20 row_newbcast:12 row_mask:0xf bank_mask:0xf
    v_and_b32_dpp v29, v13, v21 row_newbcast:12 row_mask:0xf bank_mask:0xf
    v_and_b32_dpp v30, v13, v22 row_newbcast:12 row_mask:0xf bank_mask:0xf
    v_and_b32_dpp v31, v13, v23 row_newbcast:12 row_mask:0xf bank_mask:0xf
    s_nop 1
    v_mfma_f32_16x16x32_bf16 v[32:35], v[28:31], v[68:71], v[32:35]
L_nopfpv9:
    v_and_b32_dpp v24, v14, v20 row_newbcast:4 row_mask:0xf bank_mask:0xf
    v_and_b32_dpp v25, v14, v21 row_newbcast:4 row_mask:0xf bank_mask:0xf
    v_and_b32_dpp v26, v14, v22 row_newbcast:4 row_mask:0xf bank_mask:0xf
    v_and_b32_dpp v27, v14, v23 row_newbcast:4 row_mask:0xf bank_mask:0xf
    s_waitcnt vmcnt(3)
    s_bitcmp0_b32 s14, 14
    s_cbranch_scc1 L_sf_71
    s_waitcnt vmcnt(2)
    s_bitcmp0_b32 s15, 14
    s_cbranch_scc1 L_sf_71
    s_waitcnt vmcnt(1)
L_sf_71:
    buffer_load_dwordx4 v[96:99], v1, s[52:55], s97 offen offset:2048 nt
    v_mfma_f32_16x16x32_bf16 v[32:35], v[24:27], v[80:83], v[32:35]
    v_and_b32_dpp v28, v14, v20 row_newbcast:12 row_mask:0xf bank_mask:0xf
    v_and_b32_dpp v29, v14, v21 row_newbcast:12 row_mask:0xf bank_mask:0xf
    v_and_b32_dpp v30, v14, v22 row_newbcast:12 row_mask:0xf bank_mask:0xf
    v_and_b32_dpp v31, v14, v23 row_newbcast:12 row_mask:0xf bank_mask:0xf
    s_waitcnt vmcnt(3)
    s_bitcmp0_b32 s14, 15
    s_cbranch_scc1 L_sf_72
    s_waitcnt vmcnt(2)
    s_bitcmp0_b32 s15, 15
    s_cbranch_scc1 L_sf_72
    s_waitcnt vmcnt(1)
L_sf_72:
    buffer_load_dwordx4 v[100:103], v1, s[52:55], s97 offen offset:3072 nt
    s_add_u32 s97, s97, 32768
    v_add_u32 v1, 4096, v1
    v_and_b32 v1, 0x7fff, v1
    v_mfma_f32_16x16x32_bf16 v[32:35], v[28:31], v[84:87], v[32:35]
    v_and_b32_dpp v24, v15, v20 row_newbcast:0 row_mask:0xf bank_mask:0xf
    v_and_b32_dpp v25, v15, v21 row_newbcast:0 row_mask:0xf bank_mask:0xf
    v_and_b32_dpp v26, v15, v22 row_newbcast:0 row_mask:0xf bank_mask:0xf
    v_and_b32_dpp v27, v15, v23 row_newbcast:0 row_mask:0xf bank_mask:0xf
    s_waitcnt vmcnt(3)
    s_bitcmp0_b32 s14, 16
    s_cbranch_scc1 L_sf_73
    s_waitcnt vmcnt(2)
    s_bitcmp0_b32 s15, 16
    s_cbranch_scc1 L_sf_73
    s_waitcnt vmcnt(1)
L_sf_73:
    buffer_load_dwordx4 v[104:107], v1, s[52:55], s97 offen offset:0 nt
    v_mfma_f32_16x16x32_bf16 v[32:35], v[24:27], v[88:91], v[32:35]
    v_and_b32_dpp v28, v15, v20 row_newbcast:8 row_mask:0xf bank_mask:0xf
    v_and_b32_dpp v29, v15, v21 row_newbcast:8 row_mask:0xf bank_mask:0xf
    v_and_b32_dpp v30, v15, v22 row_newbcast:8 row_mask:0xf bank_mask:0xf
    v_and_b32_dpp v31, v15, v23 row_newbcast:8 row_mask:0xf bank_mask:0xf
    s_waitcnt vmcnt(3)
    s_bitcmp0_b32 s14, 17
    s_cbranch_scc1 L_sf_74
    s_waitcnt vmcnt(2)
    s_bitcmp0_b32 s15, 17
    s_cbranch_scc1 L_sf_74
    s_waitcnt vmcnt(1)
L_sf_74:
    buffer_load_dwordx4 v[108:111], v1, s[52:55], s97 offen offset:1024 nt
    v_mfma_f32_16x16x32_bf16 v[32:35], v[28:31], v[92:95], v[32:35]
    v_and_b32_dpp v24, v15, v20 row_newbcast:4 row_mask:0xf bank_mask:0xf
    v_and_b32_dpp v25, v15, v21 row_newbcast:4 row_mask:0xf bank_mask:0xf
    v_and_b32_dpp v26, v15, v22 row_newbcast:4 row_mask:0xf bank_mask:0xf
    v_and_b32_dpp v27, v15, v23 row_newbcast:4 row_mask:0xf bank_mask:0xf
    s_waitcnt vmcnt(3)
    s_bitcmp0_b32 s14, 18
    s_cbranch_scc1 L_sf_75
    s_waitcnt vmcnt(2)
    s_bitcmp0_b32 s15, 18
    s_cbranch_scc1 L_sf_75
    s_waitcnt vmcnt(1)
L_sf_75:
    buffer_load_dwordx4 v[112:115], v1, s[52:55], s97 offen offset:2048 nt
    v_mfma_f32_16x16x32_bf16 v[32:35], v[24:27], v[96:99], v[32:35]
    v_and_b32_dpp v28, v15, v20 row_newbcast:12 row_mask:0xf bank_mask:0xf
    v_and_b32_dpp v29, v15, v21 row_newbcast:12 row_mask:0xf bank_mask:0xf
    v_and_b32_dpp v30, v15, v22 row_newbcast:12 row_mask:0xf bank_mask:0xf
    v_and_b32_dpp v31, v15, v23 row_newbcast:12 row_mask:0xf bank_mask:0xf
    s_waitcnt vmcnt(3)
    s_bitcmp0_b32 s14, 19
    s_cbranch_scc1 L_sf_76
    s_waitcnt vmcnt(2)
    s_bitcmp0_b32 s15, 19
    s_cbranch_scc1 L_sf_76
    s_waitcnt vmcnt(1)
L_sf_76:
    buffer_load_dwordx4 v[116:119], v1, s[52:55], s97 offen offset:3072 nt
    s_add_u32 s97, s97, 32768
    v_add_u32 v1, 4096, v1
    v_and_b32 v1, 0x7fff, v1
    v_mfma_f32_16x16x32_bf16 v[32:35], v[28:31], v[100:103], v[32:35]
    v_and_b32_dpp v24, v16, v20 row_newbcast:0 row_mask:0xf bank_mask:0xf
    v_and_b32_dpp v25, v16, v21 row_newbcast:0 row_mask:0xf bank_mask:0xf
    v_and_b32_dpp v26, v16, v22 row_newbcast:0 row_mask:0xf bank_mask:0xf
    v_and_b32_dpp v27, v16, v23 row_newbcast:0 row_mask:0xf bank_mask:0xf
    s_waitcnt vmcnt(3)
    s_bitcmp0_b32 s14, 20
    s_cbranch_scc1 L_sf_77
    s_waitcnt vmcnt(2)
    s_bitcmp0_b32 s15, 20
    s_cbranch_scc1 L_sf_77
    s_waitcnt vmcnt(1)
L_sf_77:
    buffer_load_dwordx4 v[120:123], v1, s[52:55], s97 offen offset:0 nt
    v_mfma_f32_16x16x32_bf16 v[32:35], v[24:27], v[104:107], v[32:35]
    v_and_b32_dpp v28, v16, v20 row_newbcast:8 row_mask:0xf bank_mask:0xf
    v_and_b32_dpp v29, v16, v21 row_newbcast:8 row_mask:0xf bank_mask:0xf
    v_and_b32_dpp v30, v16, v22 row_newbcast:8 row_mask:0xf bank_mask:0xf
    v_and_b32_dpp v31, v16, v23 row_newbcast:8 row_mask:0xf bank_mask:0xf
    s_waitcnt vmcnt(3)
    s_bitcmp0_b32 s14, 21
    s_cbranch_scc1 L_sf_78
    s_waitcnt vmcnt(2)
    s_bitcmp0_b32 s15, 21
    s_cbranch_scc1 L_sf_78
    s_waitcnt vmcnt(1)
L_sf_78:
    buffer_load_dwordx4 v[124:127], v1, s[52:55], s97 offen offset:1024 nt
    v_mfma_f32_16x16x32_bf16 v[32:35], v[28:31], v[108:111], v[32:35]
    v_and_b32_dpp v24, v16, v20 row_newbcast:4 row_mask:0xf bank_mask:0xf
    v_and_b32_dpp v25, v16, v21 row_newbcast:4 row_mask:0xf bank_mask:0xf
    v_and_b32_dpp v26, v16, v22 row_newbcast:4 row_mask:0xf bank_mask:0xf
    v_and_b32_dpp v27, v16, v23 row_newbcast:4 row_mask:0xf bank_mask:0xf
    s_waitcnt vmcnt(3)
    s_bitcmp0_b32 s14, 22
    s_cbranch_scc1 L_sf_79
    s_waitcnt vmcnt(2)
    s_bitcmp0_b32 s15, 22
    s_cbranch_scc1 L_sf_79
    s_waitcnt vmcnt(1)
L_sf_79:
    buffer_load_dwordx4 v[128:131], v1, s[52:55], s97 offen offset:2048 nt
    v_mfma_f32_16x16x32_bf16 v[32:35], v[24:27], v[112:115], v[32:35]
    v_and_b32_dpp v28, v16, v20 row_newbcast:12 row_mask:0xf bank_mask:0xf
    v_and_b32_dpp v29, v16, v21 row_newbcast:12 row_mask:0xf bank_mask:0xf
    v_and_b32_dpp v30, v16, v22 row_newbcast:12 row_mask:0xf bank_mask:0xf
    v_and_b32_dpp v31, v16, v23 row_newbcast:12 row_mask:0xf bank_mask:0xf
    s_waitcnt vmcnt(3)
    s_bitcmp0_b32 s14, 23
    s_cbranch_scc1 L_sf_80
    s_waitcnt vmcnt(2)
    s_bitcmp0_b32 s15, 23
    s_cbranch_scc1 L_sf_80
    s_waitcnt vmcnt(1)
L_sf_80:
    buffer_load_dwordx4 v[132:135], v1, s[52:55], s97 offen offset:3072 nt
    s_add_u32 s97, s97, 32768
    v_add_u32 v1, 4096, v1
    v_and_b32 v1, 0x7fff, v1
    v_mfma_f32_16x16x32_bf16 v[32:35], v[28:31], v[116:119], v[32:35]
    v_and_b32_dpp v24, v17, v20 row_newbcast:0 row_mask:0xf bank_mask:0xf
    v_and_b32_dpp v25, v17, v21 row_newbcast:0 row_mask:0xf bank_mask:0xf
    v_and_b32_dpp v26, v17, v22 row_newbcast:0 row_mask:0xf bank_mask:0xf
    v_and_b32_dpp v27, v17, v23 row_newbcast:0 row_mask:0xf bank_mask:0xf
    s_waitcnt vmcnt(3)
    s_bitcmp0_b32 s14, 24
    s_cbranch_scc1 L_sf_81
    s_waitcnt vmcnt(2)
    s_bitcmp0_b32 s15, 24
    s_cbranch_scc1 L_sf_81
    s_waitcnt vmcnt(1)
L_sf_81:
    buffer_load_dwordx4 v[136:139], v1, s[52:55], s97 offen offset:0 nt
    v_mfma_f32_16x16x32_bf16 v[32:35], v[24:27], v[120:123], v[32:35]
    s_or_b32 s96, s59, s39
    s_cbranch_scc0 L_nofrag_82
    v_mov_b32 v104, 162060
L_lw_83:
    ds_read_b32 v105, v104
    s_waitcnt lgkmcnt(0)
    v_cmp_gt_u32 vcc, 4, v105
    s_cbranch_vccz L_lw_83e
    s_sleep 2
    s_sub_u32 s60, s60, 1
    s_cbranch_scc0 L_lw_83
    s_mov_b32 s60, 0
L_lw_83e:
    s_cmp_eq_u32 s59, 0
    s_cbranch_scc1 L_nofrag_82
    v_lshrrev_b32 v109, 4, v0
    v_bfe_u32 v104, v0, 1, 1
    v_lshl_add_u32 v104, v109, 1, v104
    v_bfe_u32 v110, v0, 2, 2
    v_lshl_add_u32 v104, v104, 3, v110
    v_lshlrev_b32 v104, 7, v104
    v_and_b32 v110, 1, v0
    v_lshl_add_u32 v104, v110, 3, v104
    s_lshl_b32 s96, s3, 13
    s_add_u32 s96, s96, 81920
    v_add_u32 v104, s96, v104
    ds_read_b64_tr_b16 v[72:73], v104 offset:0
    ds_read_b64_tr_b16 v[74:75], v104 offset:512
    ds_read_b64_tr_b16 v[76:77], v104 offset:16
    ds_read_b64_tr_b16 v[78:79], v104 offset:528
    ds_read_b64_tr_b16 v[80:81], v104 offset:32
    ds_read_b64_tr_b16 v[82:83], v104 offset:544
    ds_read_b64_tr_b16 v[84:85], v104 offset:48
    ds_read_b64_tr_b16 v[86:87], v104 offset:560
    ds_read_b64_tr_b16 v[88:89], v104 offset:64
    ds_read_b64_tr_b16 v[90:91], v104 offset:576
    ds_read_b64_tr_b16 v[92:93], v104 offset:80
    ds_read_b64_tr_b16 v[94:95], v104 offset:592
    ds_read_b64_tr_b16 v[96:97], v104 offset:96
    ds_read_b64_tr_b16 v[98:99], v104 offset:608
    ds_read_b64_tr_b16 v[100:101], v104 offset:112
    ds_read_b64_tr_b16 v[102:103], v104 offset:624
    v_bfe_u32 v105, v0, 1, 3
    v_lshlrev_b32 v105, 8, v105
    v_lshl_add_u32 v105, v109, 5, v105
    v_lshl_add_u32 v105, v110, 4, v105
    v_mul_u32_u24 v106, 320, v109
    v_bfe_u32 v110, v0, 3, 1
    v_mul_u32_u24 v110, 160, v110
    v_add_u32 v106, v106, v110
    v_and_b32 v110, 7, v0
    v_lshl_add_u32 v107, v110, 4, v106
    v_add_u32 v107, 81920, v107
    v_lshl_add_u32 v106, v110, 2, v106
    v_add_u32 v106, s96, v106
    v_mul_u32_u24 v108, 1280, v109
    v_add_u32 v108, v108, v2
    s_lshr_b32 s96, s3, 1
    s_lshl_b32 s96, s96, 11
    s_and_b32 s100, s3, 1
    s_lshl_b32 s100, s100, 7
    s_add_u32 s100, s100, s96
    s_lshl_b32 s96, s34, 13
    s_add_u32 s100, s100, s96
    s_add_u32 s100, s100, 90112
    s_mul_i32 s101, s34, 5120
    s_lshl_b32 s96, s35, 7
    s_add_u32 s101, s101, s96
    s_add_u32 s101, s101, 152832
L_nofrag_82:
    v_mov_b32 v10, 162076
    v_mov_b32 v11, 1
    s_mov_b64 exec, 1
    ds_add_u32 v10, v11
    s_mov_b64 exec, -1
    v_and_b32_dpp v28, v17, v20 row_newbcast:8 row_mask:0xf bank_mask:0xf
    v_and_b32_dpp v29, v17, v21 row_newbcast:8 row_mask:0xf bank_mask:0xf
    v_and_b32_dpp v30, v17, v22 row_newbcast:8 row_mask:0xf bank_mask:0xf
    v_and_b32_dpp v31, v17, v23 row_newbcast:8 row_mask:0xf bank_mask:0xf
    s_waitcnt vmcnt(3)
    s_bitcmp0_b32 s14, 25
    s_cbranch_scc1 L_sf_84
    s_waitcnt vmcnt(2)
    s_bitcmp0_b32 s15, 25
    s_cbranch_scc1 L_sf_84
    s_waitcnt vmcnt(1)
L_sf_84:
    buffer_load_dwordx4 v[140:143], v1, s[52:55], s97 offen offset:1024 nt
    v_mfma_f32_16x16x32_bf16 v[32:35], v[28:31], v[124:127], v[32:35]
    v_and_b32_dpp v24, v17, v20 row_newbcast:4 row_mask:0xf bank_mask:0xf
    v_and_b32_dpp v25, v17, v21 row_newbcast:4 row_mask:0xf bank_mask:0xf
    v_and_b32_dpp v26, v17, v22 row_newbcast:4 row_mask:0xf bank_mask:0xf
    v_and_b32_dpp v27, v17, v23 row_newbcast:4 row_mask:0xf bank_mask:0xf
    s_waitcnt vmcnt(3)
    s_bitcmp0_b32 s14, 26
    s_cbranch_scc1 L_sf_85
    s_waitcnt vmcnt(2)
    s_bitcmp0_b32 s15, 26
    s_cbranch_scc1 L_sf_85
    s_waitcnt vmcnt(1)
L_sf_85:
    buffer_load_dwordx4 v[144:147], v1, s[52:55], s97 offen offset:2048 nt
    v_mfma_f32_16x16x32_bf16 v[32:35], v[24:27], v[128:131], v[32:35]
    v_and_b32_dpp v28, v17, v20 row_newbcast:12 row_mask:0xf bank_mask:0xf
    v_and_b32_dpp v29, v17, v21 row_newbcast:12 row_mask:0xf bank_mask:0xf
    v_and_b32_dpp v30, v17, v22 row_newbcast:12 row_mask:0xf bank_mask:0xf
    v_and_b32_dpp v31, v17, v23 row_newbcast:12 row_mask:0xf bank_mask:0xf
    s_waitcnt vmcnt(3)
    s_bitcmp0_b32 s14, 27
    s_cbranch_scc1 L_sf_86
    s_waitcnt vmcnt(2)
    s_bitcmp0_b32 s15, 27
    s_cbranch_scc1 L_sf_86
    s_waitcnt vmcnt(1)
L_sf_86:
    buffer_load_dwordx4 v[148:151], v1, s[52:55], s97 offen offset:3072 nt
    s_add_u32 s97, s97, 32768
    v_add_u32 v1, 4096, v1
    v_and_b32 v1, 0x7fff, v1
    v_mfma_f32_16x16x32_bf16 v[32:35], v[28:31], v[132:135], v[32:35]
    v_and_b32_dpp v24, v18, v20 row_newbcast:0 row_mask:0xf bank_mask:0xf
    v_and_b32_dpp v25, v18, v21 row_newbcast:0 row_mask:0xf bank_mask:0xf
    v_and_b32_dpp v26, v18, v22 row_newbcast:0 row_mask:0xf bank_mask:0xf
    v_and_b32_dpp v27, v18, v23 row_newbcast:0 row_mask:0xf bank_mask:0xf
    s_waitcnt vmcnt(3)
    s_bitcmp0_b32 s14, 28
    s_cbranch_scc1 L_sf_87
    s_waitcnt vmcnt(2)
    s_bitcmp0_b32 s15, 28
    s_cbranch_scc1 L_sf_87
    s_waitcnt vmcnt(1)
L_sf_87:
    buffer_load_dwordx4 v[152:155], v1, s[52:55], s97 offen offset:0 nt
    v_mfma_f32_16x16x32_bf16 v[32:35], v[24:27], v[136:139], v[32:35]
    v_and_b32_dpp v28, v18, v20 row_newbcast:8 row_mask:0xf bank_mask:0xf
    v_and_b32_dpp v29, v18, v21 row_newbcast:8 row_mask:0xf bank_mask:0xf
    v_and_b32_dpp v30, v18, v22 row_newbcast:8 row_mask:0xf bank_mask:0xf
    v_and_b32_dpp v31, v18, v23 row_newbcast:8 row_mask:0xf bank_mask:0xf
    s_waitcnt vmcnt(3)
    s_bitcmp0_b32 s14, 29
    s_cbranch_scc1 L_sf_88
    s_waitcnt vmcnt(2)
    s_bitcmp0_b32 s15, 29
    s_cbranch_scc1 L_sf_88
    s_waitcnt vmcnt(1)
L_sf_88:
    buffer_load_dwordx4 v[156:159], v1, s[52:55], s97 offen offset:1024 nt
    v_mfma_f32_16x16x32_bf16 v[32:35], v[28:31], v[140:143], v[32:35]
    v_and_b32_dpp v24, v18, v20 row_newbcast:4 row_mask:0xf bank_mask:0xf
    v_and_b32_dpp v25, v18, v21 row_newbcast:4 row_mask:0xf bank_mask:0xf
    v_and_b32_dpp v26, v18, v22 row_newbcast:4 row_mask:0xf bank_mask:0xf
    v_and_b32_dpp v27, v18, v23 row_newbcast:4 row_mask:0xf bank_mask:0xf
    s_waitcnt vmcnt(3)
    s_bitcmp0_b32 s14, 30
    s_cbranch_scc1 L_sf_89
    s_waitcnt vmcnt(2)
    s_bitcmp0_b32 s15, 30
    s_cbranch_scc1 L_sf_89
    s_waitcnt vmcnt(1)
L_sf_89:
    buffer_load_dwordx4 v[160:163], v1, s[52:55], s97 offen offset:2048 nt
    v_mfma_f32_16x16x32_bf16 v[32:35], v[24:27], v[144:147], v[32:35]
    v_lshrrev_b32 v9, 4, v0
    v_lshl_add_u32 v8, v9, 2, v2
    s_lshl_b32 s96, s3, 9
    s_add_u32 s96, s96, 157824
    v_lshl_add_u32 v8, v8, 2, s96
    v_lshlrev_b32 v9, 3, v0
    v_add_u32 v9, 157824, v9
    v_mov_b32 v10, 162048
    v_mov_b32 v11, 1
    s_lshl_b32 s96, s38, 5
    s_add_u32 s96, s96, 161984
    v_mov_b32 v3, s96
    s_sub_u32 s62, 8, s39
    s_lshl_b32 s98, s34, 5
    s_add_u32 s98, s98, s35
    s_lshl_b32 s98, s98, 8
    s_add_u32 s98, s98, 90112
    v_lshlrev_b32 v39, 2, v0
    v_and_b32_dpp v28, v18, v20 row_newbcast:12 row_mask:0xf bank_mask:0xf
    v_and_b32_dpp v29, v18, v21 row_newbcast:12 row_mask:0xf bank_mask:0xf
    v_and_b32_dpp v30, v18, v22 row_newbcast:12 row_mask:0xf bank_mask:0xf
    v_and_b32_dpp v31, v18, v23 row_newbcast:12 row_mask:0xf bank_mask:0xf
    s_waitcnt vmcnt(3)
    s_bitcmp0_b32 s14, 31
    s_cbranch_scc1 L_sf_90
    s_waitcnt vmcnt(2)
    s_bitcmp0_b32 s15, 31
    s_cbranch_scc1 L_sf_90
    s_waitcnt vmcnt(1)
L_sf_90:
    buffer_load_dwordx4 v[164:167], v1, s[52:55], s97 offen offset:3072 nt
    s_mov_b32 s97, 0
    v_add_u32 v1, 4096, v1
    v_and_b32 v1, 0x7fff, v1
    v_mfma_f32_16x16x32_bf16 v[32:35], v[28:31], v[148:151], v[32:35]
    s_cmp_eq_u32 s12, -1
    s_cbranch_scc1 L_v_nopf
    v_and_b32_dpp v24, v19, v20 row_newbcast:0 row_mask:0xf bank_mask:0xf
    v_and_b32_dpp v25, v19, v21 row_newbcast:0 row_mask:0xf bank_mask:0xf
    v_and_b32_dpp v26, v19, v22 row_newbcast:0 row_mask:0xf bank_mask:0xf
    v_and_b32_dpp v27, v19, v23 row_newbcast:0 row_mask:0xf bank_mask:0xf
    s_waitcnt vmcnt(3)
    s_nop 0
    v_mfma_f32_16x16x32_bf16 v[32:35], v[24:27], v[152:155], v[32:35]
    v_and_b32_dpp v28, v19, v20 row_newbcast:8 row_mask:0xf bank_mask:0xf
    v_and_b32_dpp v29, v19, v21 row_newbcast:8 row_mask:0xf bank_mask:0xf
    v_and_b32_dpp v30, v19, v22 row_newbcast:8 row_mask:0xf bank_mask:0xf
    v_and_b32_dpp v31, v19, v23 row_newbcast:8 row_mask:0xf bank_mask:0xf
    s_waitcnt vmcnt(2)
    s_nop 0
    v_mfma_f32_16x16x32_bf16 v[32:35], v[28:31], v[156:159], v[32:35]
    v_and_b32_dpp v24, v19, v20 row_newbcast:4 row_mask:0xf bank_mask:0xf
    v_and_b32_dpp v25, v19, v21 row_newbcast:4 row_mask:0xf bank_mask:0xf
    v_and_b32_dpp v26, v19, v22 row_newbcast:4 row_mask:0xf bank_mask:0xf
    v_and_b32_dpp v27, v19, v23 row_newbcast:4 row_mask:0xf bank_mask:0xf
    s_waitcnt vmcnt(1)
    s_nop 0
    v_mfma_f32_16x16x32_bf16 v[32:35], v[24:27], v[160:163], v[32:35]
    v_and_b32_dpp v28, v19, v20 row_newbcast:12 row_mask:0xf bank_mask:0xf
    v_and_b32_dpp v29, v19, v21 row_newbcast:12 row_mask:0xf bank_mask:0xf
    v_and_b32_dpp v30, v19, v22 row_newbcast:12 row_mask:0xf bank_mask:0xf
    v_and_b32_dpp v31, v19, v23 row_newbcast:12 row_mask:0xf bank_mask:0xf
    s_waitcnt vmcnt(0)
    s_nop 0
    v_mfma_f32_16x16x32_bf16 v[32:35], v[28:31], v[164:167], v[32:35]
L_v_join:
    s_cmp_lg_u32 s13, 0
    s_cbranch_scc1 L_jobend
L_t0:
    s_mov_b32 exec_hi, 0
    s_nop 4
    ds_write_b128 v8, v[32:35]
L_t0b:
    s_mov_b64 exec, 1
    ds_add_rtn_u32 v37, v10, v11
    s_mov_b64 exec, -1
    ds_read_b32 v38, v10 offset:24
    ds_read_b128 v[24:27], v3
    ds_read_b128 v[28:31], v3 offset:16
    ds_read_b64 v[144:145], v9 offset:0
    ds_read_b64 v[146:147], v9 offset:512
    ds_read_b64 v[148:149], v9 offset:1024
    ds_read_b64 v[150:151], v9 offset:1536
    ds_read_b64 v[152:153], v9 offset:2048
    ds_read_b64 v[154:155], v9 offset:2560
    ds_read_b64 v[156:157], v9 offset:3072
    ds_read_b64 v[158:159], v9 offset:3584
    s_waitcnt lgkmcnt(10)
    v_readfirstlane_b32 s96, v37
    v_readfirstlane_b32 s61, v38
    s_cmp_lg_u32 s96, s62
    s_cbranch_scc1 L_nopub
    s_waitcnt lgkmcnt(6)
    v_pk_mul_f32 v[144:145], v[144:145], v[24:25] op_sel:[0,0] op_sel_hi:[1,0]
    v_pk_mul_f32 v[146:147], v[146:147], v[24:25] op_sel:[0,1] op_sel_hi:[1,1]
    s_waitcnt lgkmcnt(4)
    v_pk_fma_f32 v[144:145], v[148:149], v[26:27], v[144:145] op_sel:[0,0,0] op_sel_hi:[1,0,1]
    v_pk_fma_f32 v[146:147], v[150:151], v[26:27], v[146:147] op_sel:[0,1,0] op_sel_hi:[1,1,1]
    s_waitcnt lgkmcnt(2)
    v_pk_fma_f32 v[144:145], v[152:153], v[28:29], v[144:145] op_sel:[0,0,0] op_sel_hi:[1,0,1]
    v_pk_fma_f32 v[146:147], v[154:155], v[28:29], v[146:147] op_sel:[0,1,0] op_sel_hi:[1,1,1]
    s_waitcnt lgkmcnt(0)
    v_pk_fma_f32 v[144:145], v[156:157], v[30:31], v[144:145] op_sel:[0,0,0] op_sel_hi:[1,0,1]
    v_pk_fma_f32 v[146:147], v[158:159], v[30:31], v[146:147] op_sel:[0,1,0] op_sel_hi:[1,1,1]
    s_cmp_eq_u32 s61, 1
    v_pk_add_f32 v[144:145], v[144:145], v[146:147]
    v_cvt_pk_bf16_f32 v32, v144, v145
    s_cbranch_scc0 L_oslow
    buffer_store_dword v32, v39, s[40:43], s98 offen
L_odone:
L_nopub:
    s_cmp_eq_u32 s59, 0
    s_cbranch_scc1 L_not1
L_poll_99:
    buffer_load_dwordx4 v[16:19], v105, s[40:43], s100 offen sc1
    s_waitcnt vmcnt(0)
    v_max3_u32 v38, v16, v17, v18
    v_max_u32 v38, v38, v19
    v_cmp_eq_u32 vcc, -1, v38
    s_cbranch_vccz L_poll_99e
    s_sub_u32 s60, s60, 1
    s_cbranch_scc0 L_poll_99
    s_mov_b32 s60, 0
L_poll_99e:
    v_mfma_f32_16x16x32_bf16 v[112:115], v[16:19], v[72:75], 0
    v_mfma_f32_16x16x32_bf16 v[128:131], v[16:19], v[88:91], 0
    v_mfma_f32_16x16x32_bf16 v[116:119], v[16:19], v[76:79], 0
    v_mfma_f32_16x16x32_bf16 v[132:135], v[16:19], v[92:95], 0
    v_mfma_f32_16x16x32_bf16 v[120:123], v[16:19], v[80:83], 0
    v_mfma_f32_16x16x32_bf16 v[136:139], v[16:19], v[96:99], 0
    v_mfma_f32_16x16x32_bf16 v[124:127], v[16:19], v[84:87], 0
    v_mfma_f32_16x16x32_bf16 v[140:143], v[16:19], v[100:103], 0
    s_nop 0
    v_pk_add_f32 v[112:113], v[112:113], v[114:115]
    v_pk_add_f32 v[128:129], v[128:129], v[130:131]
    v_pk_add_f32 v[116:117], v[116:117], v[118:119]
    v_pk_add_f32 v[132:133], v[132:133], v[134:135]
    v_add_f32_dpp v12, v113, v112 row_ror:8 row_mask:0xf bank_mask:0x3
    v_add_f32_dpp v12, v128, v129 row_ror:8 row_mask:0xf bank_mask:0xc
    ds_write_b32 v106, v12 offset:0
    v_pk_add_f32 v[120:121], v[120:121], v[122:123]
    v_pk_add_f32 v[136:137], v[136:137], v[138:139]
    v_add_f32_dpp v13, v117, v116 row_ror:8 row_mask:0xf bank_mask:0x3
    v_add_f32_dpp v13, v132, v133 row_ror:8 row_mask:0xf bank_mask:0xc
    ds_write_b32 v106, v13 offset:32
    v_pk_add_f32 v[124:125], v[124:125], v[126:127]
    v_pk_add_f32 v[140:141], v[140:141], v[142:143]
    v_add_f32_dpp v14, v121, v120 row_ror:8 row_mask:0xf bank_mask:0x3
    v_add_f32_dpp v14, v136, v137 row_ror:8 row_mask:0xf bank_mask:0xc
    ds_write_b32 v106, v14 offset:64
    v_add_f32_dpp v15, v125, v124 row_ror:8 row_mask:0xf bank_mask:0x3
    v_add_f32_dpp v15, v140, v141 row_ror:8 row_mask:0xf bank_mask:0xc
    ds_write_b32 v106, v15 offset:96
    s_mov_b64 exec, 1
    ds_add_rtn_u32 v37, v10, v11 offset:4
    s_mov_b64 exec, -1
    ds_read_b128 v[72:75], v107 offset:0
    ds_read_b128 v[76:79], v107 offset:8192
    ds_read_b128 v[80:83], v107 offset:16384
    ds_read_b128 v[84:87], v107 offset:24576
    ds_read_b128 v[88:91], v107 offset:32768
    ds_read_b128 v[92:95], v107 offset:40960
    ds_read_b128 v[96:99], v107 offset:49152
    ds_read_b128 v[100:103], v107 offset:57344
    s_waitcnt lgkmcnt(8)
    v_readfirstlane_b32 s96, v37
    s_nop 0
    s_cmp_lg_u32 s96, 7
    s_cbranch_scc1 L_not1
    s_waitcnt lgkmcnt(6)
    v_pk_add_f32 v[72:73], v[72:73], v[76:77]
    v_pk_add_f32 v[74:75], v[74:75], v[78:79]
    s_waitcnt lgkmcnt(4)
    v_pk_add_f32 v[80:81], v[80:81], v[84:85]
    v_pk_add_f32 v[82:83], v[82:83], v[86:87]
    v_pk_add_f32 v[72:73], v[72:73], v[80:81]
    v_pk_add_f32 v[74:75], v[74:75], v[82:83]
    s_waitcnt lgkmcnt(2)
    v_pk_add_f32 v[88:89], v[88:89], v[92:93]
    v_pk_add_f32 v[90:91], v[90:91], v[94:95]
    v_pk_add_f32 v[72:73], v[72:73], v[88:89]
    v_pk_add_f32 v[74:75], v[74:75], v[90:91]
    s_waitcnt lgkmcnt(0)
    v_pk_add_f32 v[96:97], v[96:97], v[100:101]
    v_pk_add_f32 v[98:99], v[98:99], v[102:103]
    v_pk_add_f32 v[72:73], v[72:73], v[96:97]
    v_pk_add_f32 v[74:75], v[74:75], v[98:99]
    v_cvt_pk_bf16_f32 v12, v72, v73
    v_cvt_pk_bf16_f32 v13, v74, v75
    buffer_store_dwordx2 v[12:13], v108, s[40:43], s101 offen sc1
L_not1:
    s_waitcnt lgkmcnt(0)
    s_cmp_eq_u32 s39, 1
    s_cbranch_scc1 L_s_role
    s_endpgm
L_k_nopf:
    s_waitcnt vmcnt(3)
    s_bitcmp0_b32 s57, 22
    s_cbranch_scc1 L_sf_55
    s_waitcnt vmcnt(2)
    s_bitcmp0_b32 s58, 22
    s_cbranch_scc1 L_sf_55
    s_waitcnt vmcnt(1)
L_sf_55:
    buffer_load_dwordx4 v[128:131], v1, s[48:51], s97 offen offset:2048 nt
    v_min_u32 v39, 29, v0
    v_lshlrev_b32 v39, 2, v39
    buffer_load_dword v37, v39, s[44:47], 0 offen sc1
    s_waitcnt vmcnt(4)
    s_bitcmp0_b32 s57, 23
    s_cbranch_scc1 L_sf_56
    s_waitcnt vmcnt(3)
    s_bitcmp0_b32 s58, 23
    s_cbranch_scc1 L_sf_56
    s_waitcnt vmcnt(2)
L_sf_56:
    buffer_load_dwordx4 v[132:135], v1, s[48:51], s97 offen offset:3072 nt
    s_add_u32 s97, s97, 32768
    v_add_u32 v1, 4096, v1
    v_and_b32 v1, 0x7fff, v1
    s_waitcnt vmcnt(4)
    s_bitcmp0_b32 s57, 24
    s_cbranch_scc1 L_sf_57
    s_waitcnt vmcnt(3)
    s_bitcmp0_b32 s58, 24
    s_cbranch_scc1 L_sf_57
    s_waitcnt vmcnt(2)
L_sf_57:
    buffer_load_dwordx4 v[136:139], v1, s[48:51], s97 offen offset:0 nt
    s_waitcnt vmcnt(4)
    s_bitcmp0_b32 s57, 25
    s_cbranch_scc1 L_sf_58
    s_waitcnt vmcnt(3)
    s_bitcmp0_b32 s58, 25
    s_cbranch_scc1 L_sf_58
    s_waitcnt vmcnt(1)
L_sf_58:
    buffer_load_dwordx4 v[140:143], v1, s[48:51], s97 offen offset:1024 nt
    s_waitcnt vmcnt(4)
    s_bitcmp0_b32 s57, 26
    s_cbranch_scc1 L_sf_59
    s_waitcnt vmcnt(2)
    s_bitcmp0_b32 s58, 26
    s_cbranch_scc1 L_sf_59
    s_waitcnt vmcnt(1)
L_sf_59:
    buffer_load_dwordx4 v[144:147], v1, s[48:51], s97 offen offset:2048 nt
    s_waitcnt vmcnt(3)
    s_bitcmp0_b32 s57, 27
    s_cbranch_scc1 L_sf_60
    s_waitcnt vmcnt(2)
    s_bitcmp0_b32 s58, 27
    s_cbranch_scc1 L_sf_60
    s_waitcnt vmcnt(1)
L_sf_60:
    buffer_load_dwordx4 v[148:151], v1, s[48:51], s97 offen offset:3072 nt
    s_add_u32 s97, s97, 32768
    v_add_u32 v1, 4096, v1
    v_and_b32 v1, 0x7fff, v1
    v_cmp_eq_u32 vcc, 0, v37
    s_nop 0
    s_or_b32 s96, vcc_lo, vcc_hi
    buffer_load_dwordx4 v[4:7], v2, s[40:43], s98 offen sc1
    s_waitcnt vmcnt(4)
    s_bitcmp0_b32 s57, 28
    s_cbranch_scc1 L_sf_61
    s_waitcnt vmcnt(3)
    s_bitcmp0_b32 s58, 28
    s_cbranch_scc1 L_sf_61
    s_waitcnt vmcnt(2)
L_sf_61:
    buffer_load_dwordx4 v[152:155], v1, s[48:51], s97 offen offset:0 nt
    s_waitcnt vmcnt(4)
    s_bitcmp0_b32 s57, 29
    s_cbranch_scc1 L_sf_62
    s_waitcnt vmcnt(3)
    s_bitcmp0_b32 s58, 29
    s_cbranch_scc1 L_sf_62
    s_waitcnt vmcnt(2)
L_sf_62:
    buffer_load_dwordx4 v[156:159], v1, s[48:51], s97 offen offset:1024 nt
    s_waitcnt vmcnt(4)
    s_bitcmp0_b32 s57, 30
    s_cbranch_scc1 L_sf_63
    s_waitcnt vmcnt(3)
    s_bitcmp0_b32 s58, 30
    s_cbranch_scc1 L_sf_63
    s_waitcnt vmcnt(1)
L_sf_63:
    buffer_load_dwordx4 v[160:163], v1, s[48:51], s97 offen offset:2048 nt
    s_waitcnt vmcnt(4)
    s_bitcmp0_b32 s57, 31
    s_cbranch_scc1 L_sf_64
    s_waitcnt vmcnt(2)
    s_bitcmp0_b32 s58, 31
    s_cbranch_scc1 L_sf_64
    s_waitcnt vmcnt(1)
L_sf_64:
    buffer_load_dwordx4 v[164:167], v1, s[48:51], s97 offen offset:3072 nt
    s_mov_b32 s97, 0
    v_add_u32 v1, 4096, v1
    v_and_b32 v1, 0x7fff, v1
    v_add_u32 v1, 8192, v1
    v_and_b32 v1, 0x7fff, v1
    s_mov_b32 s97, 65536
    s_branch L_k_join
L_v_nopf:
    v_and_b32_dpp v24, v19, v20 row_newbcast:0 row_mask:0xf bank_mask:0xf
    v_and_b32_dpp v25, v19, v21 row_newbcast:0 row_mask:0xf bank_mask:0xf
    v_and_b32_dpp v26, v19, v22 row_newbcast:0 row_mask:0xf bank_mask:0xf
    v_and_b32_dpp v27, v19, v23 row_newbcast:0 row_mask:0xf bank_mask:0xf
    s_waitcnt vmcnt(3)
    s_bitcmp0_b32 s14, 0
    s_cbranch_scc1 L_sf_91
    s_waitcnt vmcnt(2)
    s_bitcmp0_b32 s15, 0
    s_cbranch_scc1 L_sf_91
    s_waitcnt vmcnt(1)
L_sf_91:
    buffer_load_dwordx4 v[40:43], v1, s[52:55], s97 offen offset:0 nt
    v_mfma_f32_16x16x32_bf16 v[32:35], v[24:27], v[152:155], v[32:35]
    v_and_b32_dpp v28, v19, v20 row_newbcast:8 row_mask:0xf bank_mask:0xf
    v_and_b32_dpp v29, v19, v21 row_newbcast:8 row_mask:0xf bank_mask:0xf
    v_and_b32_dpp v30, v19, v22 row_newbcast:8 row_mask:0xf bank_mask:0xf
    v_and_b32_dpp v31, v19, v23 row_newbcast:8 row_mask:0xf bank_mask:0xf
    s_waitcnt vmcnt(3)
    s_bitcmp0_b32 s14, 1
    s_cbranch_scc1 L_sf_92
    s_waitcnt vmcnt(2)
    s_bitcmp0_b32 s15, 1
    s_cbranch_scc1 L_sf_92
    s_waitcnt vmcnt(1)
L_sf_92:
    buffer_load_dwordx4 v[44:47], v1, s[52:55], s97 offen offset:1024 nt
    v_mfma_f32_16x16x32_bf16 v[32:35], v[28:31], v[156:159], v[32:35]
    v_and_b32_dpp v24, v19, v20 row_newbcast:4 row_mask:0xf bank_mask:0xf
    v_and_b32_dpp v25, v19, v21 row_newbcast:4 row_mask:0xf bank_mask:0xf
    v_and_b32_dpp v26, v19, v22 row_newbcast:4 row_mask:0xf bank_mask:0xf
    v_and_b32_dpp v27, v19, v23 row_newbcast:4 row_mask:0xf bank_mask:0xf
    s_waitcnt vmcnt(3)
    s_bitcmp0_b32 s14, 2
    s_cbranch_scc1 L_sf_93
    s_waitcnt vmcnt(2)
    s_bitcmp0_b32 s15, 2
    s_cbranch_scc1 L_sf_93
    s_waitcnt vmcnt(1)
L_sf_93:
    buffer_load_dwordx4 v[48:51], v1, s[52:55], s97 offen offset:2048 nt
    v_mfma_f32_16x16x32_bf16 v[32:35], v[24:27], v[160:163], v[32:35]
    v_and_b32_dpp v28, v19, v20 row_newbcast:12 row_mask:0xf bank_mask:0xf
    v_and_b32_dpp v29, v19, v21 row_newbcast:12 row_mask:0xf bank_mask:0xf
    v_and_b32_dpp v30, v19, v22 row_newbcast:12 row_mask:0xf bank_mask:0xf
    v_and_b32_dpp v31, v19, v23 row_newbcast:12 row_mask:0xf bank_mask:0xf
    s_waitcnt vmcnt(3)
    s_bitcmp0_b32 s14, 3
    s_cbranch_scc1 L_sf_94
    s_waitcnt vmcnt(2)
    s_bitcmp0_b32 s15, 3
    s_cbranch_scc1 L_sf_94
    s_waitcnt vmcnt(1)
L_sf_94:
    buffer_load_dwordx4 v[52:55], v1, s[52:55], s97 offen offset:3072 nt
    s_add_u32 s97, s97, 32768
    v_add_u32 v1, 4096, v1
    v_and_b32 v1, 0x7fff, v1
    v_mfma_f32_16x16x32_bf16 v[32:35], v[28:31], v[164:167], v[32:35]
    v_and_b32_dpp v24, v12, v20 row_newbcast:0 row_mask:0xf bank_mask:0xf
    v_and_b32_dpp v25, v12, v21 row_newbcast:0 row_mask:0xf bank_mask:0xf
    v_and_b32_dpp v26, v12, v22 row_newbcast:0 row_mask:0xf bank_mask:0xf
    v_and_b32_dpp v27, v12, v23 row_newbcast:0 row_mask:0xf bank_mask:0xf
    s_waitcnt vmcnt(3)
    s_bitcmp0_b32 s14, 4
    s_cbranch_scc1 L_sf_95
    s_waitcnt vmcnt(2)
    s_bitcmp0_b32 s15, 4
    s_cbranch_scc1 L_sf_95
    s_waitcnt vmcnt(1)
L_sf_95:
    buffer_load_dwordx4 v[56:59], v1, s[52:55], s97 offen offset:0 nt
    v_mfma_f32_16x16x32_bf16 v[32:35], v[24:27], v[40:43], v[32:35]
    v_and_b32_dpp v28, v12, v20 row_newbcast:8 row_mask:0xf bank_mask:0xf
    v_and_b32_dpp v29, v12, v21 row_newbcast:8 row_mask:0xf bank_mask:0xf
    v_and_b32_dpp v30, v12, v22 row_newbcast:8 row_mask:0xf bank_mask:0xf
    v_and_b32_dpp v31, v12, v23 row_newbcast:8 row_mask:0xf bank_mask:0xf
    s_waitcnt vmcnt(3)
    s_bitcmp0_b32 s14, 5
    s_cbranch_scc1 L_sf_96
    s_waitcnt vmcnt(2)
    s_bitcmp0_b32 s15, 5
    s_cbranch_scc1 L_sf_96
    s_waitcnt vmcnt(1)
L_sf_96:
    buffer_load_dwordx4 v[60:63], v1, s[52:55], s97 offen offset:1024 nt
    v_mfma_f32_16x16x32_bf16 v[32:35], v[28:31], v[44:47], v[32:35]
    v_and_b32_dpp v24, v12, v20 row_newbcast:4 row_mask:0xf bank_mask:0xf
    v_and_b32_dpp v25, v12, v21 row_newbcast:4 row_mask:0xf bank_mask:0xf
    v_and_b32_dpp v26, v12, v22 row_newbcast:4 row_mask:0xf bank_mask:0xf
    v_and_b32_dpp v27, v12, v23 row_newbcast:4 row_mask:0xf bank_mask:0xf
    s_waitcnt vmcnt(3)
    s_bitcmp0_b32 s14, 6
    s_cbranch_scc1 L_sf_97
    s_waitcnt vmcnt(2)
    s_bitcmp0_b32 s15, 6
    s_cbranch_scc1 L_sf_97
    s_waitcnt vmcnt(1)
L_sf_97:
    buffer_load_dwordx4 v[64:67], v1, s[52:55], s97 offen offset:2048 nt
    v_mfma_f32_16x16x32_bf16 v[32:35], v[24:27], v[48:51], v[32:35]
    v_and_b32_dpp v28, v12, v20 row_newbcast:12 row_mask:0xf bank_mask:0xf
    v_and_b32_dpp v29, v12, v21 row_newbcast:12 row_mask:0xf bank_mask:0xf
    v_and_b32_dpp v30, v12, v22 row_newbcast:12 row_mask:0xf bank_mask:0xf
    v_and_b32_dpp v31, v12, v23 row_newbcast:12 row_mask:0xf bank_mask:0xf
    s_waitcnt vmcnt(3)
    s_bitcmp0_b32 s14, 7
    s_cbranch_scc1 L_sf_98
    s_waitcnt vmcnt(2)
    s_bitcmp0_b32 s15, 7
    s_cbranch_scc1 L_sf_98
    s_waitcnt vmcnt(1)
L_sf_98:
    buffer_load_dwordx4 v[68:71], v1, s[52:55], s97 offen offset:3072 nt
    s_add_u32 s97, s97, 32768
    v_add_u32 v1, 4096, v1
    v_and_b32 v1, 0x7fff, v1
    v_mfma_f32_16x16x32_bf16 v[32:35], v[28:31], v[52:55], v[32:35]
    v_and_b32_dpp v24, v13, v20 row_newbcast:0 row_mask:0xf bank_mask:0xf
    v_and_b32_dpp v25, v13, v21 row_newbcast:0 row_mask:0xf bank_mask:0xf
    v_and_b32_dpp v26, v13, v22 row_newbcast:0 row_mask:0xf bank_mask:0xf
    v_and_b32_dpp v27, v13, v23 row_newbcast:0 row_mask:0xf bank_mask:0xf
    s_waitcnt vmcnt(3)
    s_nop 0
    v_mfma_f32_16x16x32_bf16 v[32:35], v[24:27], v[56:59], v[32:35]
    v_and_b32_dpp v28, v13, v20 row_newbcast:8 row_mask:0xf bank_mask:0xf
    v_and_b32_dpp v29, v13, v21 row_newbcast:8 row_mask:0xf bank_mask:0xf
    v_and_b32_dpp v30, v13, v22 row_newbcast:8 row_mask:0xf bank_mask:0xf
    v_and_b32_dpp v31, v13, v23 row_newbcast:8 row_mask:0xf bank_mask:0xf
    s_waitcnt vmcnt(2)
    s_nop 0
    v_mfma_f32_16x16x32_bf16 v[32:35], v[28:31], v[60:63], v[32:35]
    v_and_b32_dpp v24, v13, v20 row_newbcast:4 row_mask:0xf bank_mask:0xf
    v_and_b32_dpp v25, v13, v21 row_newbcast:4 row_mask:0xf bank_mask:0xf
    v_and_b32_dpp v26, v13, v22 row_newbcast:4 row_mask:0xf bank_mask:0xf
    v_and_b32_dpp v27, v13, v23 row_newbcast:4 row_mask:0xf bank_mask:0xf
    s_waitcnt vmcnt(1)
    s_nop 0
    v_mfma_f32_16x16x32_bf16 v[32:35], v[24:27], v[64:67], v[32:35]
    v_and_b32_dpp v28, v13, v20 row_newbcast:12 row_mask:0xf bank_mask:0xf
    v_and_b32_dpp v29, v13, v21 row_newbcast:12 row_mask:0xf bank_mask:0xf
    v_and_b32_dpp v30, v13, v22 row_newbcast:12 row_mask:0xf bank_mask:0xf
    v_and_b32_dpp v31, v13, v23 row_newbcast:12 row_mask:0xf bank_mask:0xf
    s_waitcnt vmcnt(0)
    s_nop 0
    v_mfma_f32_16x16x32_bf16 v[32:35], v[28:31], v[68:71], v[32:35]
    s_branch L_v_join
L_oslow:
    buffer_store_dword v32, v39, s[40:43], s98 offen sc1
    s_branch L_odone
L_qslow:
L_wy_100:
    buffer_load_dword v37, v39, s[44:47], 0 offen sc1
    s_waitcnt vmcnt(0)
    v_cmp_ne_u32 vcc, -1, v37
    s_cbranch_vccz L_wy_100e
    s_sleep 4
    s_sub_u32 s60, s60, 1
    s_cbranch_scc0 L_wy_100
    s_mov_b32 s60, 0
L_wy_100e:
L_qslow2:
L_poll_101:
    buffer_load_dwordx4 v[4:7], v2, s[40:43], s98 offen sc1
    s_waitcnt vmcnt(0)
    v_max3_u32 v38, v4, v5, v6
    v_max_u32 v38, v38, v7
    v_cmp_eq_u32 vcc, -1, v38
    s_cbranch_vccz L_poll_101e
    s_sleep 2
    s_sub_u32 s60, s60, 1
    s_cbranch_scc0 L_poll_101
    s_mov_b32 s60, 0
L_poll_101e:
    s_branch L_qok
L_mljob:
    s_lshl_b32 s96, s38, 3
    s_add_u32 s96, s96, s3
    s_lshl3_add_u32 s96, s96, s99
    buffer_store_dwordx2 v[8:9], v36, s[40:43], s96 offen sc1
    s_branch L_mldone
L_service:
    s_mov_b32 s59, 0
    v_mov_b32 v5, 0
    v_mov_b32 v105, 0
    v_mov_b32 v108, 0
    v_mov_b32 v160, 0
    v_mov_b32 v8, 162068
L_lw_102:
    ds_read_b32 v9, v8
    s_waitcnt lgkmcnt(0)
    v_cmp_gt_u32 vcc, 8, v9
    s_cbranch_vccz L_lw_102e
    s_sleep 8
    s_sub_u32 s60, s60, 1
    s_cbranch_scc0 L_lw_102
    s_mov_b32 s60, 0
L_lw_102e:
    v_and_b32 v2, 15, v0
    v_lshlrev_b32 v2, 3, v2
    v_add_u32 v3, 161920, v2
    ds_read_b64 v[8:9], v3
    s_lshl_b32 s99, s37, 5
    s_add_u32 s99, s99, s36
    s_lshl_b32 s99, s99, 7
    s_add_u32 s99, s99, 73728
    s_lshl_b32 s62, s38, 6
    s_add_u32 s62, s62, s99
    s_getreg_b32 s58, hwreg(HW_REG_XCC_ID, 0, 4)
    v_mov_b32 v10, s58
    s_lshl_b32 s98, s34, 5
    s_add_u32 s98, s98, s35
    s_lshl_b32 s63, s98, 2
    s_add_u32 s63, s63, 229376
    s_lshl_b32 s98, s98, 8
    s_add_u32 s98, s98, 90112
    v_lshlrev_b32 v39, 2, v0
    s_bfm_b64 exec, 8, 0
    s_waitcnt lgkmcnt(0)
    buffer_store_dwordx2 v[8:9], v2, s[40:43], s62 offen sc1
    s_mov_b64 exec, 1
    buffer_store_dword v10, v36, s[40:43], s63 offen sc1
    s_mov_b64 exec, -1
    v_mov_b32 v12, 162076
L_lw_103:
    ds_read_b32 v13, v12
    s_waitcnt lgkmcnt(0)
    v_cmp_gt_u32 vcc, 4, v13
    s_cbranch_vccz L_lw_103e
    s_sleep 4
    s_sub_u32 s60, s60, 1
    s_cbranch_scc0 L_lw_103
    s_mov_b32 s60, 0
L_lw_103e:
    v_and_b32 v11, 31, v0
    v_lshlrev_b32 v11, 2, v11
    s_lshl_b32 s63, s34, 7
    s_add_u32 s63, s63, 229376
    buffer_load_dword v12, v39, s[40:43], s98 offen sc1
L_poll_104:
    buffer_load_dwordx2 v[8:9], v2, s[40:43], s99 offen sc1
    buffer_load_dword v10, v11, s[40:43], s63 offen sc1
    s_waitcnt vmcnt(0)
    v_max3_u32 v38, v8, v9, v10
    v_cmp_eq_u32 vcc, -1, v38
    s_cbranch_vccz L_poll_104e
    s_sleep 16
    s_sub_u32 s60, s60, 1
    s_cbranch_scc0 L_poll_104
    s_mov_b32 s60, 0
L_poll_104e:
    v_mov_b32 v37, v8
    s_nop 1
    v_max_f32_dpp v37, v37, v37 quad_perm:[1,0,3,2] row_mask:0xf bank_mask:0xf
    s_nop 1
    v_max_f32_dpp v37, v37, v37 quad_perm:[2,3,0,1] row_mask:0xf bank_mask:0xf
    s_nop 1
    v_max_f32_dpp v37, v37, v37 row_ror:4 row_mask:0xf bank_mask:0xf
    s_nop 1
    v_max_f32_dpp v37, v37, v37 row_ror:8 row_mask:0xf bank_mask:0xf
    v_sub_f32 v8, v8, v37
    v_exp_f32 v8, v8
    s_nop 0
    v_mul_f32 v9, v8, v9
    s_nop 1
    v_add_f32_dpp v9, v9, v9 quad_perm:[1,0,3,2] row_mask:0xf bank_mask:0xf
    s_nop 1
    v_add_f32_dpp v9, v9, v9 quad_perm:[2,3,0,1] row_mask:0xf bank_mask:0xf
    s_nop 1
    v_add_f32_dpp v9, v9, v9 row_ror:4 row_mask:0xf bank_mask:0xf
    s_nop 1
    v_add_f32_dpp v9, v9, v9 row_ror:8 row_mask:0xf bank_mask:0xf
    s_getreg_b32 s62, hwreg(HW_REG_XCC_ID, 0, 4)
    v_cmp_ne_u32 vcc, s62, v10
    s_nop 0
    s_cmp_eq_u64 vcc, 0
    s_cselect_b32 s61, 1, 0
    v_rcp_f32 v9, v9
    v_lshrrev_b32 v3, 1, v2
    v_add_u32 v3, 161984, v3
    v_mul_f32 v8, v8, v9
    v_mov_b32 v10, 162072
    v_mov_b32 v11, s61
    ds_write_b32 v3, v8
    ds_write_b32 v10, v11
    s_mov_b32 s3, 1
    v_lshrrev_b32 v9, 4, v0
    v_lshl_add_u32 v8, v9, 2, v2
    s_lshl_b32 s96, s3, 9
    s_add_u32 s96, s96, 157824
    v_lshl_add_u32 v8, v8, 2, s96
    v_lshlrev_b32 v9, 3, v0
    v_add_u32 v9, 157824, v9
    v_mov_b32 v10, 162048
    v_mov_b32 v11, 1
    s_lshl_b32 s96, s38, 5
    s_add_u32 s96, s96, 161984
    v_mov_b32 v3, s96
    s_sub_u32 s62, 8, s39
    s_lshl_b32 s98, s34, 5
    s_add_u32 s98, s98, s35
    s_lshl_b32 s98, s98, 8
    s_add_u32 s98, s98, 90112
    v_lshlrev_b32 v39, 2, v0
    s_branch L_t0b
L_jobend:
    v_lshrrev_b32 v9, 4, v0
    v_lshl_add_u32 v9, v9, 2, v2
    v_lshlrev_b32 v9, 2, v9
    s_mov_b32 exec_hi, 0
    s_nop 1
    buffer_store_dwordx4 v[32:35], v9, s[40:43], s13 offen sc1
    s_endpgm
L_proxy:
    v_mov_b32 v5, 0
    v_mov_b32 v105, 0
    v_mov_b32 v108, 0
    v_mov_b32 v160, 0
    s_barrier
    s_waitcnt lgkmcnt(0)
    s_mov_b32 s40, s32
    s_mov_b32 s41, s33
    s_mov_b32 s42, 589824
    s_mov_b32 s43, 0x20000
    s_mov_b32 s44, s30
    s_mov_b32 s45, s31
    s_mov_b32 s46, 256
    s_mov_b32 s47, 0x20000
    s_sub_u32 s97, 7, s3
    s_mul_i32 s97, s97, 27
    s_cmp_eq_u32 s3, 5
    s_cselect_b32 s97, 32, s97
    s_add_u32 s97, s97, s35
    s_lshl_b32 s97, s97, 9
    s_add_u32 s97, s97, 196608
    v_and_b32 v2, 15, v0
    v_lshlrev_b32 v2, 3, v2
    v_bfe_u32 v20, v0, 4, 1
    v_lshl_add_u32 v20, v20, 2, v2
    v_lshlrev_b32 v20, 2, v20
    s_cmp_lg_u32 s3, 7
    s_cbranch_scc1 L_px6
    s_sub_u32 s96, 6, s59
    v_mov_b32 v8, 162068
L_lw_105:
    ds_read_b32 v9, v8
    s_waitcnt lgkmcnt(0)
    v_cmp_gt_u32 vcc, s96, v9
    s_cbranch_vccz L_lw_105e
    s_sleep 8
    s_sub_u32 s60, s60, 1
    s_cbranch_scc0 L_lw_105
    s_mov_b32 s60, 0
L_lw_105e:
    v_and_b32 v2, 15, v0
    v_lshlrev_b32 v2, 3, v2
    v_add_u32 v3, 161920, v2
    ds_read_b64 v[8:9], v3
    s_lshl_b32 s99, s37, 5
    s_add_u32 s99, s99, s36
    s_lshl_b32 s99, s99, 7
    s_add_u32 s99, s99, 73728
    s_lshl_b32 s62, s38, 6
    s_add_u32 s62, s62, s99
    s_getreg_b32 s58, hwreg(HW_REG_XCC_ID, 0, 4)
    v_mov_b32 v10, s58
    s_lshl_b32 s98, s34, 5
    s_add_u32 s98, s98, s35
    s_lshl_b32 s63, s98, 2
    s_add_u32 s63, s63, 229376
    s_lshl_b32 s98, s98, 8
    s_add_u32 s98, s98, 90112
    v_lshlrev_b32 v39, 2, v0
    s_bfm_b64 exec, s96, 0
    s_waitcnt lgkmcnt(0)
    buffer_store_dwordx2 v[8:9], v2, s[40:43], s62 offen sc1
    s_mov_b64 exec, 1
    buffer_store_dword v10, v36, s[40:43], s63 offen sc1
    s_mov_b64 exec, -1
    s_mov_b32 s100, 4
    s_lshl_b32 s63, s100, 8
    v_and_b32 v8, 15, v0
    v_lshl_add_u32 v8, v8, 4, s63
    v_lshrrev_b32 v9, 4, v0
    v_mul_u32_u24 v5, 1280, v9
    v_add_u32 v5, v5, v8
    v_mul_u32_u24 v4, 1296, v9
    v_add_u32 v4, v4, v8
    v_add_u32 v4, 81920, v4
    v_lshlrev_b32 v6, 1, v5
    v_add_u32 v6, 87104, v6
    s_lshl_b32 s62, s100, 3
    s_add_u32 s62, s62, 97344
    v_lshl_add_u32 v7, v9, 6, s62
    s_mov_b32 s48, s4
    s_mov_b32 s49, s5
    s_mov_b32 s50, 5120
    s_mov_b32 s51, 0x20000
    buffer_load_dwordx4 v[8:11], v5, s[48:51], 0 offen
    s_mov_b32 s62, 20480
    s_mov_b32 s63, 30720
L_poll_106:
    buffer_load_dwordx4 v[12:15], v5, s[40:43], s62 offen sc1
    buffer_load_dwordx4 v[16:19], v5, s[40:43], s63 offen sc1
    s_waitcnt vmcnt(0)
    v_max3_u32 v38, v12, v13, v14
    v_max3_u32 v38, v38, v15, v16
    v_max3_u32 v38, v38, v17, v18
    v_max_u32 v38, v38, v19
    v_cmp_eq_u32 vcc, -1, v38
    s_cbranch_vccz L_poll_106e
    s_sleep 32
    s_sub_u32 s60, s60, 1
    s_cbranch_scc0 L_poll_106
    s_mov_b32 s60, 0
L_poll_106e:
    v_lshlrev_b32 v40, 16, v8
    v_and_b32 v41, 0xffff0000, v8
    v_lshlrev_b32 v42, 16, v9
    v_and_b32 v43, 0xffff0000, v9
    v_lshlrev_b32 v44, 16, v10
    v_and_b32 v45, 0xffff0000, v10
    v_lshlrev_b32 v46, 16, v11
    v_and_b32 v47, 0xffff0000, v11
    v_lshlrev_b32 v48, 16, v12
    v_and_b32 v49, 0xffff0000, v12
    v_lshlrev_b32 v50, 16, v13
    v_and_b32 v51, 0xffff0000, v13
    v_lshlrev_b32 v52, 16, v14
    v_and_b32 v53, 0xffff0000, v14
    v_lshlrev_b32 v54, 16, v15
    v_and_b32 v55, 0xffff0000, v15
    v_lshlrev_b32 v56, 16, v16
    v_and_b32 v57, 0xffff0000, v16
    v_lshlrev_b32 v58, 16, v17
    v_and_b32 v59, 0xffff0000, v17
    v_lshlrev_b32 v60, 16, v18
    v_and_b32 v61, 0xffff0000, v18
    v_lshlrev_b32 v62, 16, v19
    v_and_b32 v63, 0xffff0000, v19
    v_mov_b32 v64, 0
    v_mov_b32 v65, 0
    v_mov_b32 v66, 0
    v_mov_b32 v67, 0
    v_mov_b32 v68, 0
    v_mov_b32 v69, 0
    v_mov_b32 v70, 0
    v_mov_b32 v71, 0
    s_or_b32 s96, s59, s39
    s_cbranch_scc0 L_nofrag_107
    v_mov_b32 v104, 162060
L_lw_108:
    ds_read_b32 v105, v104
    s_waitcnt lgkmcnt(0)
    v_cmp_gt_u32 vcc, 4, v105
    s_cbranch_vccz L_lw_108e
    s_sleep 2
    s_sub_u32 s60, s60, 1
    s_cbranch_scc0 L_lw_108
    s_mov_b32 s60, 0
L_lw_108e:
    s_cmp_eq_u32 s59, 0
    s_cbranch_scc1 L_nofrag_107
    v_lshrrev_b32 v109, 4, v0
    v_bfe_u32 v104, v0, 1, 1
    v_lshl_add_u32 v104, v109, 1, v104
    v_bfe_u32 v110, v0, 2, 2
    v_lshl_add_u32 v104, v104, 3, v110
    v_lshlrev_b32 v104, 7, v104
    v_and_b32 v110, 1, v0
    v_lshl_add_u32 v104, v110, 3, v104
    s_lshl_b32 s96, s3, 13
    s_add_u32 s96, s96, 81920
    v_add_u32 v104, s96, v104
    ds_read_b64_tr_b16 v[72:73], v104 offset:0
    ds_read_b64_tr_b16 v[74:75], v104 offset:512
    ds_read_b64_tr_b16 v[76:77], v104 offset:16
    ds_read_b64_tr_b16 v[78:79], v104 offset:528
    ds_read_b64_tr_b16 v[80:81], v104 offset:32
    ds_read_b64_tr_b16 v[82:83], v104 offset:544
    ds_read_b64_tr_b16 v[84:85], v104 offset:48
    ds_read_b64_tr_b16 v[86:87], v104 offset:560
    ds_read_b64_tr_b16 v[88:89], v104 offset:64
    ds_read_b64_tr_b16 v[90:91], v104 offset:576
    ds_read_b64_tr_b16 v[92:93], v104 offset:80
    ds_read_b64_tr_b16 v[94:95], v104 offset:592
    ds_read_b64_tr_b16 v[96:97], v104 offset:96
    ds_read_b64_tr_b16 v[98:99], v104 offset:608
    ds_read_b64_tr_b16 v[100:101], v104 offset:112
    ds_read_b64_tr_b16 v[102:103], v104 offset:624
    v_bfe_u32 v105, v0, 1, 3
    v_lshlrev_b32 v105, 8, v105
    v_lshl_add_u32 v105, v109, 5, v105
    v_lshl_add_u32 v105, v110, 4, v105
    v_mul_u32_u24 v106, 320, v109
    v_bfe_u32 v110, v0, 3, 1
    v_mul_u32_u24 v110, 160, v110
    v_add_u32 v106, v106, v110
    v_and_b32 v110, 7, v0
    v_lshl_add_u32 v107, v110, 4, v106
    v_add_u32 v107, 81920, v107
    v_lshl_add_u32 v106, v110, 2, v106
    v_add_u32 v106, s96, v106
    v_mul_u32_u24 v108, 1280, v109
    v_add_u32 v108, v108, v2
    s_lshr_b32 s96, s3, 1
    s_lshl_b32 s96, s96, 11
    s_and_b32 s100, s3, 1
    s_lshl_b32 s100, s100, 7
    s_add_u32 s100, s100, s96
    s_lshl_b32 s96, s34, 13
    s_add_u32 s100, s100, s96
    s_add_u32 s100, s100, 90112
    s_mul_i32 s101, s34, 5120
    s_lshl_b32 s96, s35, 7
    s_add_u32 s101, s101, s96
    s_add_u32 s101, s101, 152832
L_nofrag_107:
    v_mov_b32 v12, 162076
L_lw_109:
    ds_read_b32 v13, v12
    s_waitcnt lgkmcnt(0)
    v_cmp_gt_u32 vcc, 4, v13
    s_cbranch_vccz L_lw_109e
    s_sleep 4
    s_sub_u32 s60, s60, 1
    s_cbranch_scc0 L_lw_109
    s_mov_b32 s60, 0
L_lw_109e:
    v_and_b32 v11, 31, v0
    v_lshlrev_b32 v11, 2, v11
    s_lshl_b32 s63, s34, 7
    s_add_u32 s63, s63, 229376
    buffer_load_dword v12, v39, s[40:43], s98 offen sc1
L_poll_110:
    buffer_load_dwordx2 v[8:9], v2, s[40:43], s99 offen sc1
    buffer_load_dword v10, v11, s[40:43], s63 offen sc1
    buffer_load_dwordx4 v[32:35], v20, s[40:43], s97 offen sc1
    s_waitcnt vmcnt(0)
    v_max3_u32 v38, v8, v9, v10
    v_max3_u32 v38, v38, v32, v33
    v_max3_u32 v38, v38, v34, v35
    v_cmp_eq_u32 vcc, -1, v38
    s_cbranch_vccz L_poll_110e
    s_sleep 16
    s_sub_u32 s60, s60, 1
    s_cbranch_scc0 L_poll_110
    s_mov_b32 s60, 0
L_poll_110e:
    v_mov_b32 v37, v8
    s_nop 1
    v_max_f32_dpp v37, v37, v37 quad_perm:[1,0,3,2] row_mask:0xf bank_mask:0xf
    s_nop 1
    v_max_f32_dpp v37, v37, v37 quad_perm:[2,3,0,1] row_mask:0xf bank_mask:0xf
    s_nop 1
    v_max_f32_dpp v37, v37, v37 row_ror:4 row_mask:0xf bank_mask:0xf
    s_nop 1
    v_max_f32_dpp v37, v37, v37 row_ror:8 row_mask:0xf bank_mask:0xf
    v_sub_f32 v8, v8, v37
    v_exp_f32 v8, v8
    s_nop 0
    v_mul_f32 v9, v8, v9
    s_nop 1
    v_add_f32_dpp v9, v9, v9 quad_perm:[1,0,3,2] row_mask:0xf bank_mask:0xf
    s_nop 1
    v_add_f32_dpp v9, v9, v9 quad_perm:[2,3,0,1] row_mask:0xf bank_mask:0xf
    s_nop 1
    v_add_f32_dpp v9, v9, v9 row_ror:4 row_mask:0xf bank_mask:0xf
    s_nop 1
    v_add_f32_dpp v9, v9, v9 row_ror:8 row_mask:0xf bank_mask:0xf
    s_getreg_b32 s62, hwreg(HW_REG_XCC_ID, 0, 4)
    v_cmp_ne_u32 vcc, s62, v10
    s_nop 0
    s_cmp_eq_u64 vcc, 0
    s_cselect_b32 s61, 1, 0
    v_rcp_f32 v9, v9
    v_lshrrev_b32 v3, 1, v2
    v_add_u32 v3, 161984, v3
    v_mul_f32 v8, v8, v9
    v_mov_b32 v10, 162072
    v_mov_b32 v11, s61
    ds_write_b32 v3, v8
    ds_write_b32 v10, v11
    s_branch L_pxj
L_px6:
    s_or_b32 s96, s59, s39
    s_cbranch_scc0 L_nofrag_111
    v_mov_b32 v104, 162060
L_lw_112:
    ds_read_b32 v105, v104
    s_waitcnt lgkmcnt(0)
    v_cmp_gt_u32 vcc, 4, v105
    s_cbranch_vccz L_lw_112e
    s_sleep 2
    s_sub_u32 s60, s60, 1
    s_cbranch_scc0 L_lw_112
    s_mov_b32 s60, 0
L_lw_112e:
    s_cmp_eq_u32 s59, 0
    s_cbranch_scc1 L_nofrag_111
    v_lshrrev_b32 v109, 4, v0
    v_bfe_u32 v104, v0, 1, 1
    v_lshl_add_u32 v104, v109, 1, v104
    v_bfe_u32 v110, v0, 2, 2
    v_lshl_add_u32 v104, v104, 3, v110
    v_lshlrev_b32 v104, 7, v104
    v_and_b32 v110, 1, v0
    v_lshl_add_u32 v104, v110, 3, v104
    s_lshl_b32 s96, s3, 13
    s_add_u32 s96, s96, 81920
    v_add_u32 v104, s96, v104
    ds_read_b64_tr_b16 v[72:73], v104 offset:0
    ds_read_b64_tr_b16 v[74:75], v104 offset:512
    ds_read_b64_tr_b16 v[76:77], v104 offset:16
    ds_read_b64_tr_b16 v[78:79], v104 offset:528
    ds_read_b64_tr_b16 v[80:81], v104 offset:32
    ds_read_b64_tr_b16 v[82:83], v104 offset:544
    ds_read_b64_tr_b16 v[84:85], v104 offset:48
    ds_read_b64_tr_b16 v[86:87], v104 offset:560
    ds_read_b64_tr_b16 v[88:89], v104 offset:64
    ds_read_b64_tr_b16 v[90:91], v104 offset:576
    ds_read_b64_tr_b16 v[92:93], v104 offset:80
    ds_read_b64_tr_b16 v[94:95], v104 offset:592
    ds_read_b64_tr_b16 v[96:97], v104 offset:96
    ds_read_b64_tr_b16 v[98:99], v104 offset:608
    ds_read_b64_tr_b16 v[100:101], v104 offset:112
    ds_read_b64_tr_b16 v[102:103], v104 offset:624
    v_bfe_u32 v105, v0, 1, 3
    v_lshlrev_b32 v105, 8, v105
    v_lshl_add_u32 v105, v109, 5, v105
    v_lshl_add_u32 v105, v110, 4, v105
    v_mul_u32_u24 v106, 320, v109
    v_bfe_u32 v110, v0, 3, 1
    v_mul_u32_u24 v110, 160, v110
    v_add_u32 v106, v106, v110
    v_and_b32 v110, 7, v0
    v_lshl_add_u32 v107, v110, 4, v106
    v_add_u32 v107, 81920, v107
    v_lshl_add_u32 v106, v110, 2, v106
    v_add_u32 v106, s96, v106
    v_mul_u32_u24 v108, 1280, v109
    v_add_u32 v108, v108, v2
    s_lshr_b32 s96, s3, 1
    s_lshl_b32 s96, s96, 11
    s_and_b32 s100, s3, 1
    s_lshl_b32 s100, s100, 7
    s_add_u32 s100, s100, s96
    s_lshl_b32 s96, s34, 13
    s_add_u32 s100, s100, s96
    s_add_u32 s100, s100, 90112
    s_mul_i32 s101, s34, 5120
    s_lshl_b32 s96, s35, 7
    s_add_u32 s101, s101, s96
    s_add_u32 s101, s101, 152832
L_nofrag_111:
    v_mov_b32 v8, 162076
L_lw_113:
    ds_read_b32 v9, v8
    s_waitcnt lgkmcnt(0)
    v_cmp_gt_u32 vcc, 4, v9
    s_cbranch_vccz L_lw_113e
    s_sleep 16
    s_sub_u32 s60, s60, 1
    s_cbranch_scc0 L_lw_113
    s_mov_b32 s60, 0
L_lw_113e:
L_poll_114:
    buffer_load_dwordx4 v[32:35], v20, s[40:43], s97 offen sc1
    s_waitcnt vmcnt(0)
    v_max3_u32 v38, v32, v33, v34
    v_max_u32 v38, v38, v35
    v_cmp_eq_u32 vcc, -1, v38
    s_cbranch_vccz L_poll_114e
    s_sleep 16
    s_sub_u32 s60, s60, 1
    s_cbranch_scc0 L_poll_114
    s_mov_b32 s60, 0
L_poll_114e:
L_pxj:
    v_mov_b32 v8, 162048
L_lw_115:
    ds_read_b32 v9, v8
    s_waitcnt lgkmcnt(0)
    v_cmp_gt_u32 vcc, 3, v9
    s_cbranch_vccz L_lw_115e
    s_sleep 2
    s_sub_u32 s60, s60, 1
    s_cbranch_scc0 L_lw_115
    s_mov_b32 s60, 0
L_lw_115e:
    v_lshrrev_b32 v9, 4, v0
    v_lshl_add_u32 v8, v9, 2, v2
    s_lshl_b32 s96, s3, 9
    s_add_u32 s96, s96, 157824
    v_lshl_add_u32 v8, v8, 2, s96
    v_lshlrev_b32 v9, 3, v0
    v_add_u32 v9, 157824, v9
    v_mov_b32 v10, 162048
    v_mov_b32 v11, 1
    s_lshl_b32 s96, s38, 5
    s_add_u32 s96, s96, 161984
    v_mov_b32 v3, s96
    s_sub_u32 s62, 8, s39
    s_lshl_b32 s98, s34, 5
    s_add_u32 s98, s98, s35
    s_lshl_b32 s98, s98, 8
    s_add_u32 s98, s98, 90112
    v_lshlrev_b32 v39, 2, v0
    s_branch L_t0
L_s_role:
    s_cmp_eq_u32 s3, 7
    s_cbranch_scc1 L_t2gate
    s_cmp_gt_u32 s3, 3
    s_cbranch_scc1 L_fin_prep
    s_mov_b32 s48, s18
    s_mov_b32 s49, s19
    s_mov_b32 s50, 3456
    s_mov_b32 s51, 0x20000
    v_lshrrev_b32 v3, 4, v0
    v_bfe_u32 v1, v0, 2, 2
    v_and_b32 v2, 3, v0
    v_lshl_add_u32 v4, v3, 2, v1
    v_lshlrev_b32 v4, 1, v4
    s_lshl_b32 s62, s35, 7
    s_lshl_b32 s63, s3, 5
    s_add_u32 s62, s62, s63
    buffer_load_ushort v82, v4, s[48:51], s62 offen
    v_mov_b32 v72, 162064
L_lw_116:
    ds_read_b32 v73, v72
    s_waitcnt lgkmcnt(0)
    v_cmp_gt_u32 vcc, 4, v73
    s_cbranch_vccz L_lw_116e
    s_sleep 2
    s_sub_u32 s60, s60, 1
    s_cbranch_scc0 L_lw_116
    s_mov_b32 s60, 0
L_lw_116e:
    v_lshrrev_b32 v72, 4, v0
    v_lshlrev_b32 v72, 10, v72
    v_bfe_u32 v73, v0, 2, 2
    v_lshl_add_u32 v72, v73, 7, v72
    v_and_b32 v73, 3, v0
    v_lshl_add_u32 v72, v73, 3, v72
    v_bfe_u32 v73, v0, 3, 2
    v_lshl_add_u32 v72, v73, 5, v72
    v_xor_b32 v72, s63, v72
    v_add_u32 v73, 40960, v72
    v_and_b32 v5, 7, v0
    v_mul_u32_u24 v5, 1296, v5
    v_lshl_add_u32 v5, v3, 4, v5
    v_add_u32 v5, 147456, v5
    ds_read_b64_tr_b16 v[88:89], v72 offset:0
    ds_read_b64_tr_b16 v[90:91], v72 offset:512
    ds_read_b64_tr_b16 v[92:93], v72 offset:4096
    ds_read_b64_tr_b16 v[94:95], v72 offset:4608
    ds_read_b64_tr_b16 v[96:97], v72 offset:8192
    ds_read_b64_tr_b16 v[98:99], v72 offset:8704
    ds_read_b64_tr_b16 v[100:101], v72 offset:12288
    ds_read_b64_tr_b16 v[102:103], v72 offset:12800
    ds_read_b64_tr_b16 v[104:105], v72 offset:16384
    ds_read_b64_tr_b16 v[106:107], v72 offset:16896
    ds_read_b64_tr_b16 v[108:109], v72 offset:20480
    ds_read_b64_tr_b16 v[110:111], v72 offset:20992
    ds_read_b64_tr_b16 v[112:113], v72 offset:24576
    ds_read_b64_tr_b16 v[114:115], v72 offset:25088
    ds_read_b64_tr_b16 v[116:117], v72 offset:28672
    ds_read_b64_tr_b16 v[118:119], v72 offset:29184
    ds_read_b64_tr_b16 v[120:121], v72 offset:32768
    ds_read_b64_tr_b16 v[122:123], v72 offset:33280
    ds_read_b64_tr_b16 v[124:125], v72 offset:36864
    ds_read_b64_tr_b16 v[126:127], v72 offset:37376
    ds_read_b64_tr_b16 v[128:129], v73 offset:0
    ds_read_b64_tr_b16 v[130:131], v73 offset:512
    ds_read_b64_tr_b16 v[132:133], v73 offset:4096
    ds_read_b64_tr_b16 v[134:135], v73 offset:4608
    ds_read_b64_tr_b16 v[136:137], v73 offset:8192
    ds_read_b64_tr_b16 v[138:139], v73 offset:8704
    ds_read_b64_tr_b16 v[140:141], v73 offset:12288
    ds_read_b64_tr_b16 v[142:143], v73 offset:12800
    ds_read_b64_tr_b16 v[144:145], v73 offset:16384
    ds_read_b64_tr_b16 v[146:147], v73 offset:16896
    ds_read_b64_tr_b16 v[148:149], v73 offset:20480
    ds_read_b64_tr_b16 v[150:151], v73 offset:20992
    ds_read_b64_tr_b16 v[152:153], v73 offset:24576
    ds_read_b64_tr_b16 v[154:155], v73 offset:25088
    ds_read_b64_tr_b16 v[156:157], v73 offset:28672
    ds_read_b64_tr_b16 v[158:159], v73 offset:29184
    ds_read_b64_tr_b16 v[160:161], v73 offset:32768
    ds_read_b64_tr_b16 v[162:163], v73 offset:33280
    ds_read_b64_tr_b16 v[164:165], v73 offset:36864
    ds_read_b64_tr_b16 v[166:167], v73 offset:37376
    ds_read_b128 v[8:11], v5 offset:0
    ds_read_b128 v[12:15], v5 offset:64
    ds_read_b128 v[16:19], v5 offset:128
    ds_read_b128 v[20:23], v5 offset:192
    ds_read_b128 v[24:27], v5 offset:256
    ds_read_b128 v[28:31], v5 offset:320
    ds_read_b128 v[32:35], v5 offset:384
    ds_read_b128 v[36:39], v5 offset:448
    ds_read_b128 v[40:43], v5 offset:512
    ds_read_b128 v[44:47], v5 offset:576
    s_waitcnt lgkmcnt(9)
    v_mfma_f32_16x16x32_bf16 v[48:51], v[88:91], v[8:11], 0
    s_waitcnt lgkmcnt(8)
    v_mfma_f32_16x16x32_bf16 v[48:51], v[92:95], v[12:15], v[48:51]
    s_waitcnt lgkmcnt(7)
    v_mfma_f32_16x16x32_bf16 v[48:51], v[96:99], v[16:19], v[48:51]
    s_waitcnt lgkmcnt(6)
    v_mfma_f32_16x16x32_bf16 v[48:51], v[100:103], v[20:23], v[48:51]
    s_waitcnt lgkmcnt(5)
    v_mfma_f32_16x16x32_bf16 v[48:51], v[104:107], v[24:27], v[48:51]
    s_waitcnt lgkmcnt(4)
    v_mfma_f32_16x16x32_bf16 v[48:51], v[108:111], v[28:31], v[48:51]
    s_waitcnt lgkmcnt(3)
    v_mfma_f32_16x16x32_bf16 v[48:51], v[112:115], v[32:35], v[48:51]
    s_waitcnt lgkmcnt(2)
    v_mfma_f32_16x16x32_bf16 v[48:51], v[116:119], v[36:39], v[48:51]
    s_waitcnt lgkmcnt(1)
    v_mfma_f32_16x16x32_bf16 v[48:51], v[120:123], v[40:43], v[48:51]
    s_waitcnt lgkmcnt(0)
    v_mfma_f32_16x16x32_bf16 v[48:51], v[124:127], v[44:47], v[48:51]
    ds_read_b128 v[8:11], v5 offset:640
    ds_read_b128 v[12:15], v5 offset:704
    ds_read_b128 v[16:19], v5 offset:768
    ds_read_b128 v[20:23], v5 offset:832
    ds_read_b128 v[24:27], v5 offset:896
    ds_read_b128 v[28:31], v5 offset:960
    ds_read_b128 v[32:35], v5 offset:1024
    ds_read_b128 v[36:39], v5 offset:1088
    ds_read_b128 v[40:43], v5 offset:1152
    ds_read_b128 v[44:47], v5 offset:1216
    s_waitcnt lgkmcnt(9)
    v_mfma_f32_16x16x32_bf16 v[48:51], v[128:131], v[8:11], v[48:51]
    s_waitcnt lgkmcnt(8)
    v_mfma_f32_16x16x32_bf16 v[48:51], v[132:135], v[12:15], v[48:51]
    s_waitcnt lgkmcnt(7)
    v_mfma_f32_16x16x32_bf16 v[48:51], v[136:139], v[16:19], v[48:51]
    s_waitcnt lgkmcnt(6)
    v_mfma_f32_16x16x32_bf16 v[48:51], v[140:143], v[20:23], v[48:51]
    s_waitcnt lgkmcnt(5)
    v_mfma_f32_16x16x32_bf16 v[48:51], v[144:147], v[24:27], v[48:51]
    s_waitcnt lgkmcnt(4)
    v_mfma_f32_16x16x32_bf16 v[48:51], v[148:151], v[28:31], v[48:51]
    s_waitcnt lgkmcnt(3)
    v_mfma_f32_16x16x32_bf16 v[48:51], v[152:155], v[32:35], v[48:51]
    s_waitcnt lgkmcnt(2)
    v_mfma_f32_16x16x32_bf16 v[48:51], v[156:159], v[36:39], v[48:51]
    s_waitcnt lgkmcnt(1)
    v_mfma_f32_16x16x32_bf16 v[48:51], v[160:163], v[40:43], v[48:51]
    s_waitcnt lgkmcnt(0)
    v_mfma_f32_16x16x32_bf16 v[48:51], v[164:167], v[44:47], v[48:51]
    v_mul_u32_u24 v79, 1296, v2
    v_lshl_add_u32 v79, v1, 6, v79
    v_lshl_add_u32 v79, v3, 4, v79
    v_add_u32 v79, 81920, v79
    v_mul_u32_u24 v80, 144, v2
    v_add3_u32 v80, v80, v4, s63
    v_add_u32 v80, 97600, v80
    v_lshlrev_b32 v81, 6, v2
    v_add_u32 v81, 97344, v81
    v_mov_b32_dpp v84, v48 quad_perm:[0,1,2,3] row_mask:0xf bank_mask:0x1
    v_mov_b32_dpp v85, v48 row_ror:4 row_mask:0xf bank_mask:0x1
    v_mov_b32_dpp v84, v49 row_ror:4 row_mask:0xf bank_mask:0x2
    v_mov_b32_dpp v85, v49 quad_perm:[0,1,2,3] row_mask:0xf bank_mask:0x2
    v_mov_b32_dpp v84, v50 quad_perm:[0,1,2,3] row_mask:0xf bank_mask:0x4
    v_mov_b32_dpp v85, v50 row_ror:4 row_mask:0xf bank_mask:0x4
    v_mov_b32_dpp v84, v51 row_ror:4 row_mask:0xf bank_mask:0x8
    v_mov_b32_dpp v85, v51 quad_perm:[0,1,2,3] row_mask:0xf bank_mask:0x8
    s_mov_b32 s62, 0xbacccccd
    s_mov_b32 s63, 0xbdd2d3e8
    v_mov_b32 v86, 0xc0135761
    s_branch L_ffn1
L_fin_prep:
    s_mul_i32 s62, s35, 3
    s_add_u32 s62, s62, s3
    s_sub_u32 s62, s62, 4
    s_cmp_ge_u32 s62, 80
    s_cbranch_scc1 L_end
    s_lshl_b32 s96, s62, 7
    s_lshl_b32 s57, s62, 6
    s_mul_i32 s63, s62, 0xccd
    s_lshr_b32 s63, s63, 16
    s_mul_i32 s63, s63, 1280
    s_sub_u32 s63, s57, s63
    s_add_u32 s96, s96, 262144
    s_add_u32 s97, s96, 81920
    s_add_u32 s98, s96, 163840
    s_add_u32 s99, s96, 245760
    v_lshrrev_b32 v72, 3, v0
    v_mul_u32_u24 v72, 10240, v72
    v_and_b32 v1, 7, v0
    v_lshl_add_u32 v72, v1, 4, v72
    v_mov_b32 v100, 0
    v_mov_b32 v101, 0
    v_mov_b32 v102, 0
    v_mov_b32 v103, 0
    v_bfe_u32 v3, v0, 4, 1
    v_lshrrev_b32 v4, 5, v0
    v_lshl_add_u32 v3, v3, 1, v4
    v_lshl_add_u32 v73, v1, 2, v3
    v_lshlrev_b32 v73, 1, v73
    s_lshl_b32 s62, s57, 1
    s_add_u32 s62, s62, 87104
    v_lshl_add_u32 v74, v73, 1, s62
    s_mov_b32 s48, s22
    s_mov_b32 s49, s23
    s_mov_b32 s50, 1280
    s_mov_b32 s51, 0x20000
    s_mov_b32 s52, s28
    s_mov_b32 s53, s29
    s_mov_b32 s54, 5120
    s_mov_b32 s55, 0x20000
    buffer_load_dwordx4 v[88:91], v72, s[40:43], s96 offen sc1
    buffer_load_dwordx4 v[92:95], v72, s[40:43], s97 offen sc1
    buffer_load_dwordx4 v[96:99], v72, s[40:43], s98 offen sc1
    s_mov_b64 exec, 0xffffff
    buffer_load_dwordx4 v[100:103], v72, s[40:43], s99 offen sc1
    s_mov_b64 exec, -1
    buffer_load_ushort v75, v73, s[48:51], s63 offen
    v_and_b32 v77, 0xfffc, v73
    s_add_u32 s62, s57, 35840
    buffer_load_dword v76, v77, s[40:43], s62 offen sc1
    s_barrier
    s_waitcnt vmcnt(0)
    v_cmp_eq_u32 vcc, -1, v76
    s_cbranch_vccz L_gbok
L_poll_117:
    buffer_load_dword v76, v77, s[40:43], s62 offen sc1
    s_waitcnt vmcnt(0)
    v_cmp_eq_u32 vcc, -1, v76
    s_cbranch_vccz L_poll_117e
    s_sleep 2
    s_sub_u32 s60, s60, 1
    s_cbranch_scc0 L_poll_117
    s_mov_b32 s60, 0
L_poll_117e:
L_gbok:
    v_lshlrev_b32 v75, 16, v75
    v_and_b32 v77, 2, v73
    v_lshlrev_b32 v77, 3, v77
    v_lshrrev_b32 v76, v77, v76
    v_lshlrev_b32 v76, 16, v76
    s_barrier
    s_barrier
    ds_read_b32 v78, v74
    s_barrier
    s_mov_b64 s[4:5], -1
    s_mov_b64 s[6:7], -1
    s_mov_b64 s[8:9], -1
    s_mov_b64 s[10:11], 0xffffff
L_yg:
    s_mov_b64 exec, s[4:5]
    buffer_load_dwordx4 v[88:91], v72, s[40:43], s96 offen sc1
    s_mov_b64 exec, s[6:7]
    buffer_load_dwordx4 v[92:95], v72, s[40:43], s97 offen sc1
    s_mov_b64 exec, s[8:9]
    buffer_load_dwordx4 v[96:99], v72, s[40:43], s98 offen sc1
    s_mov_b64 exec, s[10:11]
    buffer_load_dwordx4 v[100:103], v72, s[40:43], s99 offen sc1
    s_mov_b64 exec, -1
    s_waitcnt vmcnt(3)
    v_max3_u32 v3, v88, v89, v90
    v_max_u32 v3, v3, v91
    v_cmp_eq_u32 s[4:5], -1, v3
    s_waitcnt vmcnt(2)
    v_max3_u32 v3, v92, v93, v94
    v_max_u32 v3, v3, v95
    v_cmp_eq_u32 s[6:7], -1, v3
    s_waitcnt vmcnt(1)
    v_max3_u32 v3, v96, v97, v98
    v_max_u32 v3, v3, v99
    v_cmp_eq_u32 s[8:9], -1, v3
    s_waitcnt vmcnt(0)
    v_max3_u32 v3, v100, v101, v102
    v_max_u32 v3, v3, v103
    v_cmp_eq_u32 s[10:11], -1, v3
    s_or_b64 s[16:17], s[4:5], s[6:7]
    s_or_b64 s[16:17], s[16:17], s[8:9]
    s_or_b64 s[16:17], s[16:17], s[10:11]
    s_cbranch_scc0 L_ygd
    s_sub_u32 s60, s60, 1
    s_cbranch_scc0 L_yg
L_ygd:
    v_pk_add_f32 v[88:89], v[88:89], v[92:93]
    v_pk_add_f32 v[90:91], v[90:91], v[94:95]
    v_pk_add_f32 v[96:97], v[96:97], v[100:101]
    v_pk_add_f32 v[98:99], v[98:99], v[102:103]
    v_pk_add_f32 v[88:89], v[88:89], v[96:97]
    v_pk_add_f32 v[90:91], v[90:91], v[98:99]
    s_nop 0
    v_permlane32_swap_b32 v88, v89
    v_permlane32_swap_b32 v90, v91
    v_add_f32 v88, v88, v89
    v_add_f32 v90, v90, v91
    s_nop 1
    v_permlane16_swap_b32 v88, v90
    v_add_f32 v88, v88, v90
    s_waitcnt lgkmcnt(0)
    s_nop 0
    v_add_f32_dpp v88, v88, v88 row_ror:8 row_mask:0xf bank_mask:0xf
    v_add_f32 v88, v88, v75
    v_fma_f32 v88, v88, v76, v78
    v_cvt_pk_bf16_f32 v88, v88, v88
    s_mov_b32 exec_lo, 0x00ff00ff
    s_mov_b32 exec_hi, 0x00ff00ff
    buffer_store_short v88, v73, s[52:55], s57 offen
    s_endpgm
L_t2gate:
    s_cmp_ge_u32 s35, 22
    s_cselect_b32 s62, 8, 0
    v_mov_b32 v8, 162052
L_lw_118:
    ds_read_b32 v9, v8
    s_waitcnt lgkmcnt(0)
    v_cmp_gt_u32 vcc, s62, v9
    s_cbranch_vccz L_lw_118e
    s_sleep 2
    s_sub_u32 s60, s60, 1
    s_cbranch_scc0 L_lw_118
    s_mov_b32 s60, 0
L_lw_118e:
    v_mov_b32 v8, 162048
L_lw_119:
    ds_read_b32 v9, v8
    s_waitcnt lgkmcnt(0)
    v_cmp_gt_u32 vcc, 8, v9
    s_cbranch_vccz L_lw_119e
    s_sleep 2
    s_sub_u32 s60, s60, 1
    s_cbranch_scc0 L_lw_119
    s_mov_b32 s60, 0
L_lw_119e:
    ds_read_b32 v9, v8 offset:24
    s_waitcnt lgkmcnt(0)
    v_readfirstlane_b32 s61, v9
    s_mov_b32 s58, 0x3f80
    s_mov_b32 s59, 0x3f800000
    s_mov_b32 s63, 0xff
L_pg:
    s_bitcmp0_b32 s63, 0
    s_cbranch_scc1 L_pgi0
    s_mov_b32 s62, 155648
    buffer_load_dwordx4 v[8:11], v5, s[40:43], s62 offen sc1
L_pgi0:
    s_bitcmp0_b32 s63, 1
    s_cbranch_scc1 L_pgi1
    s_mov_b32 s62, 160768
    buffer_load_dwordx4 v[12:15], v5, s[40:43], s62 offen sc1
L_pgi1:
    s_bitcmp0_b32 s63, 2
    s_cbranch_scc1 L_pgi2
    s_mov_b32 s62, 165888
    buffer_load_dwordx4 v[16:19], v5, s[40:43], s62 offen sc1
L_pgi2:
    s_bitcmp0_b32 s63, 3
    s_cbranch_scc1 L_pgi3
    s_mov_b32 s62, 171008
    buffer_load_dwordx4 v[20:23], v5, s[40:43], s62 offen sc1
L_pgi3:
    s_bitcmp0_b32 s63, 4
    s_cbranch_scc1 L_pgi4
    s_mov_b32 s62, 176128
    buffer_load_dwordx4 v[24:27], v5, s[40:43], s62 offen sc1
L_pgi4:
    s_bitcmp0_b32 s63, 5
    s_cbranch_scc1 L_pgi5
    s_mov_b32 s62, 181248
    buffer_load_dwordx4 v[28:31], v5, s[40:43], s62 offen sc1
L_pgi5:
    s_bitcmp0_b32 s63, 6
    s_cbranch_scc1 L_pgi6
    s_mov_b32 s62, 186368
    buffer_load_dwordx4 v[32:35], v5, s[40:43], s62 offen sc1
L_pgi6:
    s_bitcmp0_b32 s63, 7
    s_cbranch_scc1 L_pgi7
    s_mov_b32 s62, 191488
    buffer_load_dwordx4 v[36:39], v5, s[40:43], s62 offen sc1
L_pgi7:
    s_sub_u32 s60, s60, 1
    s_cselect_b32 s62, 0, -1
    s_cselect_b32 s60, 0, s60
    s_waitcnt vmcnt(0)
    s_bitcmp0_b32 s63, 0
    s_cbranch_scc1 L_pgc0
    v_max3_u32 v3, v8, v9, v10
    v_max_u32 v3, v3, v11
    v_and_b32 v3, s62, v3
    v_cmp_eq_u32 vcc, -1, v3
    s_cbranch_vccnz L_pgc0
    v_dot2c_f32_bf16 v64, s58, v8
    v_dot2c_f32_bf16 v65, s59, v8
    v_dot2c_f32_bf16 v66, s58, v9
    v_dot2c_f32_bf16 v67, s59, v9
    v_dot2c_f32_bf16 v68, s58, v10
    v_dot2c_f32_bf16 v69, s59, v10
    v_dot2c_f32_bf16 v70, s58, v11
    v_dot2c_f32_bf16 v71, s59, v11
    s_bitset0_b32 s63, 0
L_pgc0:
    s_bitcmp0_b32 s63, 1
    s_cbranch_scc1 L_pgc1
    v_max3_u32 v3, v12, v13, v14
    v_max_u32 v3, v3, v15
    v_and_b32 v3, s62, v3
    v_cmp_eq_u32 vcc, -1, v3
    s_cbranch_vccnz L_pgc1
    v_dot2c_f32_bf16 v64, s58, v12
    v_dot2c_f32_bf16 v65, s59, v12
    v_dot2c_f32_bf16 v66, s58, v13
    v_dot2c_f32_bf16 v67, s59, v13
    v_dot2c_f32_bf16 v68, s58, v14
    v_dot2c_f32_bf16 v69, s59, v14
    v_dot2c_f32_bf16 v70, s58, v15
    v_dot2c_f32_bf16 v71, s59, v15
    s_bitset0_b32 s63, 1
L_pgc1:
    s_bitcmp0_b32 s63, 2
    s_cbranch_scc1 L_pgc2
    v_max3_u32 v3, v16, v17, v18
    v_max_u32 v3, v3, v19
    v_and_b32 v3, s62, v3
    v_cmp_eq_u32 vcc, -1, v3
    s_cbranch_vccnz L_pgc2
    v_dot2c_f32_bf16 v64, s58, v16
    v_dot2c_f32_bf16 v65, s59, v16
    v_dot2c_f32_bf16 v66, s58, v17
    v_dot2c_f32_bf16 v67, s59, v17
    v_dot2c_f32_bf16 v68, s58, v18
    v_dot2c_f32_bf16 v69, s59, v18
    v_dot2c_f32_bf16 v70, s58, v19
    v_dot2c_f32_bf16 v71, s59, v19
    s_bitset0_b32 s63, 2
L_pgc2:
    s_bitcmp0_b32 s63, 3
    s_cbranch_scc1 L_pgc3
    v_max3_u32 v3, v20, v21, v22
    v_max_u32 v3, v3, v23
    v_and_b32 v3, s62, v3
    v_cmp_eq_u32 vcc, -1, v3
    s_cbranch_vccnz L_pgc3
    v_dot2c_f32_bf16 v64, s58, v20
    v_dot2c_f32_bf16 v65, s59, v20
    v_dot2c_f32_bf16 v66, s58, v21
    v_dot2c_f32_bf16 v67, s59, v21
    v_dot2c_f32_bf16 v68, s58, v22
    v_dot2c_f32_bf16 v69, s59, v22
    v_dot2c_f32_bf16 v70, s58, v23
    v_dot2c_f32_bf16 v71, s59, v23
    s_bitset0_b32 s63, 3
L_pgc3:
    s_bitcmp0_b32 s63, 4
    s_cbranch_scc1 L_pgc4
    v_max3_u32 v3, v24, v25, v26
    v_max_u32 v3, v3, v27
    v_and_b32 v3, s62, v3
    v_cmp_eq_u32 vcc, -1, v3
    s_cbranch_vccnz L_pgc4
    v_dot2c_f32_bf16 v64, s58, v24
    v_dot2c_f32_bf16 v65, s59, v24
    v_dot2c_f32_bf16 v66, s58, v25
    v_dot2c_f32_bf16 v67, s59, v25
    v_dot2c_f32_bf16 v68, s58, v26
    v_dot2c_f32_bf16 v69, s59, v26
    v_dot2c_f32_bf16 v70, s58, v27
    v_dot2c_f32_bf16 v71, s59, v27
    s_bitset0_b32 s63, 4
L_pgc4:
    s_bitcmp0_b32 s63, 5
    s_cbranch_scc1 L_pgc5
    v_max3_u32 v3, v28, v29, v30
    v_max_u32 v3, v3, v31
    v_and_b32 v3, s62, v3
    v_cmp_eq_u32 vcc, -1, v3
    s_cbranch_vccnz L_pgc5
    v_dot2c_f32_bf16 v64, s58, v28
    v_dot2c_f32_bf16 v65, s59, v28
    v_dot2c_f32_bf16 v66, s58, v29
    v_dot2c_f32_bf16 v67, s59, v29
    v_dot2c_f32_bf16 v68, s58, v30
    v_dot2c_f32_bf16 v69, s59, v30
    v_dot2c_f32_bf16 v70, s58, v31
    v_dot2c_f32_bf16 v71, s59, v31
    s_bitset0_b32 s63, 5
L_pgc5:
    s_bitcmp0_b32 s63, 6
    s_cbranch_scc1 L_pgc6
    v_max3_u32 v3, v32, v33, v34
    v_max_u32 v3, v3, v35
    v_and_b32 v3, s62, v3
    v_cmp_eq_u32 vcc, -1, v3
    s_cbranch_vccnz L_pgc6
    v_dot2c_f32_bf16 v64, s58, v32
    v_dot2c_f32_bf16 v65, s59, v32
    v_dot2c_f32_bf16 v66, s58, v33
    v_dot2c_f32_bf16 v67, s59, v33
    v_dot2c_f32_bf16 v68, s58, v34
    v_dot2c_f32_bf16 v69, s59, v34
    v_dot2c_f32_bf16 v70, s58, v35
    v_dot2c_f32_bf16 v71, s59, v35
    s_bitset0_b32 s63, 6
L_pgc6:
    s_bitcmp0_b32 s63, 7
    s_cbranch_scc1 L_pgc7
    v_max3_u32 v3, v36, v37, v38
    v_max_u32 v3, v3, v39
    v_and_b32 v3, s62, v3
    v_cmp_eq_u32 vcc, -1, v3
    s_cbranch_vccnz L_pgc7
    v_dot2c_f32_bf16 v64, s58, v36
    v_dot2c_f32_bf16 v65, s59, v36
    v_dot2c_f32_bf16 v66, s58, v37
    v_dot2c_f32_bf16 v67, s59, v37
    v_dot2c_f32_bf16 v68, s58, v38
    v_dot2c_f32_bf16 v69, s59, v38
    v_dot2c_f32_bf16 v70, s58, v39
    v_dot2c_f32_bf16 v71, s59, v39
    s_bitset0_b32 s63, 7
L_pgc7:
    s_bcnt1_i32_b32 s62, s63
    s_cbranch_scc0 L_pgd
    s_cmp_gt_u32 s62, 3
    s_cbranch_scc1 L_pg
    s_ff1_i32_b32 s96, s63
    s_bitset0_b32 s63, s96
    s_mul_i32 s96, s96, 5120
    s_add_u32 s96, s96, 155648
    s_cmp_eq_u32 s62, 1
    s_cbranch_scc1 L_pt1
    s_ff1_i32_b32 s97, s63
    s_bitset0_b32 s63, s97
    s_mul_i32 s97, s97, 5120
    s_add_u32 s97, s97, 155648
    s_cmp_eq_u32 s62, 2
    s_cbranch_scc1 L_pt2
    s_ff1_i32_b32 s98, s63
    s_bitset0_b32 s63, s98
    s_mul_i32 s98, s98, 5120
    s_add_u32 s98, s98, 155648
L_pt3:
L_ptl3:
    buffer_load_dwordx4 v[16:19], v5, s[40:43], s96 offen sc1
    buffer_load_dwordx4 v[20:23], v5, s[40:43], s97 offen sc1
    buffer_load_dwordx4 v[24:27], v5, s[40:43], s98 offen sc1
    s_waitcnt vmcnt(0)
    v_max3_u32 v3, v16, v17, v18
    v_max3_u32 v3, v3, v19, v20
    v_max3_u32 v3, v3, v21, v22
    v_max3_u32 v3, v3, v23, v24
    v_max3_u32 v3, v3, v25, v26
    v_max_u32 v3, v3, v27
    v_cmp_eq_u32 vcc, -1, v3
    s_cbranch_vccz L_pta3
    s_sub_u32 s60, s60, 1
    s_cbranch_scc0 L_ptl3
    s_mov_b32 s60, 0
    s_branch L_pta3
L_pt2:
L_ptl2:
    buffer_load_dwordx4 v[16:19], v5, s[40:43], s96 offen sc1
    buffer_load_dwordx4 v[20:23], v5, s[40:43], s97 offen sc1
    s_waitcnt vmcnt(0)
    v_max3_u32 v3, v16, v17, v18
    v_max3_u32 v3, v3, v19, v20
    v_max3_u32 v3, v3, v21, v22
    v_max_u32 v3, v3, v23
    v_cmp_eq_u32 vcc, -1, v3
    s_cbranch_vccz L_pta2
    s_sub_u32 s60, s60, 1
    s_cbranch_scc0 L_ptl2
    s_mov_b32 s60, 0
    s_branch L_pta2
L_pt1:
L_ptl1:
    buffer_load_dwordx4 v[16:19], v5, s[40:43], s96 offen sc1
    s_waitcnt vmcnt(0)
    v_max3_u32 v3, v16, v17, v18
    v_max_u32 v3, v3, v19
    v_cmp_eq_u32 vcc, -1, v3
    s_cbranch_vccz L_pta1
    s_sub_u32 s60, s60, 1
    s_cbranch_scc0 L_ptl1
    s_mov_b32 s60, 0
L_pta1:
    v_dot2c_f32_bf16 v64, s58, v16
    v_dot2c_f32_bf16 v65, s59, v16
    v_dot2c_f32_bf16 v66, s58, v17
    v_dot2c_f32_bf16 v67, s59, v17
    v_dot2c_f32_bf16 v68, s58, v18
    v_dot2c_f32_bf16 v69, s59, v18
    v_dot2c_f32_bf16 v70, s58, v19
    v_dot2c_f32_bf16 v71, s59, v19
L_pgd:
    v_pk_fma_f32 v[64:65], v[64:65], v[48:49], v[40:41]
    v_pk_fma_f32 v[66:67], v[66:67], v[50:51], v[42:43]
    v_pk_fma_f32 v[68:69], v[68:69], v[52:53], v[44:45]
    v_pk_fma_f32 v[70:71], v[70:71], v[54:55], v[46:47]
    v_pk_mul_f32 v[56:57], v[64:65], v[56:57]
    v_pk_mul_f32 v[58:59], v[66:67], v[58:59]
    v_pk_mul_f32 v[60:61], v[68:69], v[60:61]
    v_pk_mul_f32 v[62:63], v[70:71], v[62:63]
    v_cvt_pk_bf16_f32 v8, v56, v57
    v_cvt_pk_bf16_f32 v9, v58, v59
    v_cvt_pk_bf16_f32 v10, v60, v61
    v_cvt_pk_bf16_f32 v11, v62, v63
    ds_write_b128 v4, v[8:11]
    v_pk_add_f32 v[40:41], v[64:65], v[66:67]
    v_pk_add_f32 v[42:43], v[68:69], v[70:71]
    v_pk_mul_f32 v[44:45], v[64:65], v[64:65]
    v_pk_mul_f32 v[46:47], v[66:67], v[66:67]
    v_pk_add_f32 v[40:41], v[40:41], v[42:43]
    v_pk_fma_f32 v[44:45], v[68:69], v[68:69], v[44:45]
    v_pk_fma_f32 v[46:47], v[70:71], v[70:71], v[46:47]
    s_waitcnt lgkmcnt(0)
    s_barrier
    v_add_f32 v8, v40, v41
    v_pk_add_f32 v[44:45], v[44:45], v[46:47]
    v_add_f32 v9, v44, v45
    v_add_f32_dpp v8, v8, v8 quad_perm:[1,0,3,2] row_mask:0xf bank_mask:0xf
    s_nop 0
    v_add_f32_dpp v9, v9, v9 quad_perm:[1,0,3,2] row_mask:0xf bank_mask:0xf
    v_add_f32_dpp v8, v8, v8 quad_perm:[2,3,0,1] row_mask:0xf bank_mask:0xf
    s_nop 0
    v_add_f32_dpp v9, v9, v9 quad_perm:[2,3,0,1] row_mask:0xf bank_mask:0xf
    v_add_f32_dpp v8, v8, v8 row_ror:4 row_mask:0xf bank_mask:0xf
    s_nop 0
    v_add_f32_dpp v9, v9, v9 row_ror:4 row_mask:0xf bank_mask:0xf
    v_add_f32_dpp v8, v8, v8 row_ror:8 row_mask:0xf bank_mask:0xf
    s_nop 0
    v_add_f32_dpp v9, v9, v9 row_ror:8 row_mask:0xf bank_mask:0xf
    ds_write_b64 v7, v[8:9]
    s_waitcnt lgkmcnt(0)
    s_barrier
    ds_write_b128 v6, v[64:67]
    ds_write_b128 v6, v[68:71] offset:16
    s_waitcnt vmcnt(0) lgkmcnt(0)
    s_cmp_lg_u32 s3, 7
    s_cbranch_scc1 L_ffn2
    s_endpgm
L_pta3:
    v_dot2c_f32_bf16 v64, s58, v24
    v_dot2c_f32_bf16 v65, s59, v24
    v_dot2c_f32_bf16 v66, s58, v25
    v_dot2c_f32_bf16 v67, s59, v25
    v_dot2c_f32_bf16 v68, s58, v26
    v_dot2c_f32_bf16 v69, s59, v26
    v_dot2c_f32_bf16 v70, s58, v27
    v_dot2c_f32_bf16 v71, s59, v27
L_pta2:
    v_dot2c_f32_bf16 v64, s58, v20
    v_dot2c_f32_bf16 v65, s59, v20
    v_dot2c_f32_bf16 v66, s58, v21
    v_dot2c_f32_bf16 v67, s59, v21
    v_dot2c_f32_bf16 v68, s58, v22
    v_dot2c_f32_bf16 v69, s59, v22
    v_dot2c_f32_bf16 v70, s58, v23
    v_dot2c_f32_bf16 v71, s59, v23
    s_branch L_pta1
L_ffn1:
    s_barrier
    ds_read_b128 v[8:11], v79 offset:0
    ds_read_b128 v[12:15], v79 offset:256
    ds_read_b128 v[16:19], v79 offset:512
    ds_read_b128 v[20:23], v79 offset:768
    ds_read_b128 v[24:27], v79 offset:1024
    s_waitcnt vmcnt(0)
    v_lshlrev_b32 v82, 16, v82
    v_add_f32 v85, v85, v82
    s_waitcnt lgkmcnt(4)
    v_mfma_f32_16x16x32_bf16 v[32:35], v[88:91], v[8:11], 0
    v_mfma_f32_16x16x32_bf16 v[36:39], v[92:95], v[8:11], 0
    v_mfma_f32_16x16x32_bf16 v[40:43], v[96:99], v[8:11], 0
    v_mfma_f32_16x16x32_bf16 v[44:47], v[100:103], v[8:11], 0
    s_waitcnt lgkmcnt(3)
    v_mfma_f32_16x16x32_bf16 v[32:35], v[104:107], v[12:15], v[32:35]
    v_mfma_f32_16x16x32_bf16 v[36:39], v[108:111], v[12:15], v[36:39]
    v_mfma_f32_16x16x32_bf16 v[40:43], v[112:115], v[12:15], v[40:43]
    v_mfma_f32_16x16x32_bf16 v[44:47], v[116:119], v[12:15], v[44:47]
    s_waitcnt lgkmcnt(2)
    v_mfma_f32_16x16x32_bf16 v[32:35], v[120:123], v[16:19], v[32:35]
    v_mfma_f32_16x16x32_bf16 v[36:39], v[124:127], v[16:19], v[36:39]
    v_mfma_f32_16x16x32_bf16 v[40:43], v[128:131], v[16:19], v[40:43]
    v_mfma_f32_16x16x32_bf16 v[44:47], v[132:135], v[16:19], v[44:47]
    s_waitcnt lgkmcnt(1)
    s_barrier
    ds_read_b128 v[48:51], v81
    ds_read_b128 v[52:55], v81 offset:16
    ds_read_b64 v[56:57], v81 offset:32
    v_mfma_f32_16x16x32_bf16 v[32:35], v[136:139], v[20:23], v[32:35]
    v_mfma_f32_16x16x32_bf16 v[36:39], v[140:143], v[20:23], v[36:39]
    v_mfma_f32_16x16x32_bf16 v[40:43], v[144:147], v[20:23], v[40:43]
    v_mfma_f32_16x16x32_bf16 v[44:47], v[148:151], v[20:23], v[44:47]
    s_waitcnt lgkmcnt(3)
    v_mfma_f32_16x16x32_bf16 v[32:35], v[152:155], v[24:27], v[32:35]
    v_mfma_f32_16x16x32_bf16 v[36:39], v[156:159], v[24:27], v[36:39]
    s_waitcnt lgkmcnt(0)
    v_pk_add_f32 v[48:49], v[48:49], v[50:51]
    v_pk_add_f32 v[52:53], v[52:53], v[54:55]
    v_mfma_f32_16x16x32_bf16 v[40:43], v[160:163], v[24:27], v[40:43]
    v_pk_add_f32 v[48:49], v[48:49], v[56:57]
    v_pk_add_f32 v[48:49], v[48:49], v[52:53]
    v_mfma_f32_16x16x32_bf16 v[44:47], v[164:167], v[24:27], v[44:47]
    v_mul_f32 v48, s62, v48
    v_mul_f32 v49, s62, v49
    v_mul_f32 v7, v84, v48
    v_fma_f32 v49, -v48, v48, -v49
    v_max_f32 v49, 0, v49
    v_add_f32 v49, 0x3727c5ac, v49
    v_rsq_f32 v49, v49
    v_add_f32_dpp v5, v36, v7 row_ror:12 row_mask:0xf bank_mask:0x1
    v_add_f32_dpp v5, v41, v7 row_ror:12 row_mask:0xf bank_mask:0x2
    v_add_f32_dpp v5, v46, v7 row_ror:12 row_mask:0xf bank_mask:0x4
    v_add_f32_dpp v5, v35, v7 row_ror:12 row_mask:0xf bank_mask:0x8
    v_add_f32_dpp v4, v40, v32 row_ror:8 row_mask:0xf bank_mask:0x1
    v_add_f32_dpp v4, v45, v37 row_ror:8 row_mask:0xf bank_mask:0x2
    v_add_f32_dpp v4, v34, v42 row_ror:8 row_mask:0xf bank_mask:0x4
    v_add_f32_dpp v4, v39, v47 row_ror:8 row_mask:0xf bank_mask:0x8
    v_add_f32_dpp v6, v44, v5 row_ror:4 row_mask:0xf bank_mask:0x1
    v_add_f32_dpp v6, v33, v5 row_ror:4 row_mask:0xf bank_mask:0x2
    v_add_f32_dpp v6, v38, v5 row_ror:4 row_mask:0xf bank_mask:0x4
    v_add_f32_dpp v6, v43, v5 row_ror:4 row_mask:0xf bank_mask:0x8
    v_add_f32 v4, v4, v6
    v_fma_f32 v4, v4, v49, v85
    v_mul_f32 v5, v4, v4
    v_fma_f32 v5, v5, s63, v86
    v_mul_f32 v5, v5, v4
    v_exp_f32 v5, v5
    s_nop 0
    v_add_f32 v5, 1.0, v5
    v_rcp_f32 v5, v5
    s_nop 0
    v_mul_f32 v4, v4, v5
    v_cvt_pk_bf16_f32 v4, v4, v4
    ds_write_b16 v80, v4
    s_waitcnt lgkmcnt(0)
    s_barrier
    s_endpgm
L_h_t1:
    s_cmp_lg_u32 s3, 3
    s_cbranch_scc1 L_h_noclr
    s_sub_u32 s62, s56, 154
    s_cmp_lt_u32 s62, 30
    s_cbranch_scc0 L_h_noclr
    s_lshl_b32 s63, s62, 2
    s_mul_i32 s62, s62, 7168
    s_add_u32 s62, s62, 20480
    v_mov_b32 v4, -1
    v_mov_b32 v5, -1
    v_mov_b32 v6, -1
    v_mov_b32 v7, -1
    v_lshlrev_b32 v8, 4, v0
    buffer_store_dwordx4 v[4:7], v8, s[40:43], s62 offen offset:0 sc1
    buffer_store_dwordx4 v[4:7], v8, s[40:43], s62 offen offset:1024 sc1
    buffer_store_dwordx4 v[4:7], v8, s[40:43], s62 offen offset:2048 sc1
    buffer_store_dwordx4 v[4:7], v8, s[40:43], s62 offen offset:3072 sc1
    s_add_u32 s62, s62, 4096
    buffer_store_dwordx4 v[4:7], v8, s[40:43], s62 offen offset:0 sc1
    buffer_store_dwordx4 v[4:7], v8, s[40:43], s62 offen offset:1024 sc1
    buffer_store_dwordx4 v[4:7], v8, s[40:43], s62 offen offset:2048 sc1
    v_mov_b32 v8, s63
    s_waitcnt vmcnt(0)
    s_mov_b64 exec, 1
    buffer_store_dword v4, v8, s[44:47], 0 offen sc1
    s_mov_b64 exec, -1
L_h_noclr:
    v_lshrrev_b32 v1, 3, v0
    v_mul_u32_u24 v1, 1280, v1
    v_and_b32 v2, 7, v0
    v_lshl_add_u32 v1, v2, 4, v1
    s_lshl2_add_u32 s63, s34, s3
    s_mul_i32 s63, s63, 163840
    s_lshl_b32 s62, s35, 7
    s_add_u32 s63, s63, s62
    s_sub_u32 s63, s63, 2816
    s_lshl_b32 s62, s3, 14
    s_add_u32 s62, s62, 81920
    s_mov_b32 m0, s62
    s_mov_b32 s48, s12
    s_mov_b32 s49, s13
    s_mov_b32 s50, 5242880
    s_mov_b32 s51, 0x20000
    s_add_u32 s100, s39, 1
    s_mov_b32 s62, 8
L_dma_5:
    buffer_load_dwordx4 v1, s[48:51], s63 offen nt lds
    s_add_u32 m0, m0, 1024
    s_add_u32 s63, s63, 10240
    s_cmp_eq_u32 s100, 0
    s_cbranch_scc1 L_dma_5n0
    s_waitcnt vmcnt(4)
    s_cmp_eq_u32 s100, 2
    s_cbranch_scc1 L_dma_5n0
    s_waitcnt vmcnt(1)
L_dma_5n0:
    buffer_load_dwordx4 v1, s[48:51], s63 offen nt lds
    s_add_u32 m0, m0, 1024
    s_add_u32 s63, s63, 10240
    s_cmp_eq_u32 s100, 0
    s_cbranch_scc1 L_dma_5n1
    s_waitcnt vmcnt(4)
    s_cmp_eq_u32 s100, 2
    s_cbranch_scc1 L_dma_5n1
    s_waitcnt vmcnt(1)
L_dma_5n1:
    s_sub_u32 s62, s62, 1
    s_cmp_lg_u32 s62, 0
    s_cbranch_scc1 L_dma_5
    s_cmp_eq_u32 s39, 1
    s_cbranch_scc1 L_h_role
    s_waitcnt vmcnt(0)
    v_mov_b32 v4, 162060
    v_mov_b32 v5, 1
    s_mov_b64 exec, 1
    ds_add_u32 v4, v5
    s_mov_b64 exec, -1
    s_cmp_eq_u32 s3, 0
    s_cbranch_scc1 L_service
    s_endpgm
L_h_role:
    v_lshrrev_b32 v3, 4, v0
    v_and_b32 v2, 3, v0
    v_bfe_u32 v1, v0, 2, 2
    v_mul_u32_u24 v160, 2560, v2
    v_lshl_add_u32 v160, v1, 6, v160
    v_lshl_add_u32 v160, v3, 4, v160
    s_mul_i32 s57, s35, 10240
    s_mul_i32 s62, s3, 640
    s_add_u32 s57, s57, s62
    s_add_u32 s57, s57, 262144
    v_mov_b32 v4, -1
    v_mov_b32 v5, -1
    v_mov_b32 v6, -1
    v_mov_b32 v7, -1
    buffer_store_dwordx4 v[4:7], v160, s[40:43], s57 offen sc1
    buffer_store_dwordx4 v[4:7], v160, s[40:43], s57 offen offset:256 sc1
    s_mov_b32 exec_lo, 0x00ff00ff
    s_mov_b32 exec_hi, 0x00ff00ff
    buffer_store_dwordx4 v[4:7], v160, s[40:43], s57 offen offset:512 sc1
    s_mov_b64 exec, -1
    v_add_u32 v8, 0, v0
    v_mul_u32_u24 v10, 0xccd, v8
    v_lshrrev_b32 v10, 16, v10
    v_mul_u32_u24 v9, 20, v10
    v_sub_u32 v8, v8, v9
    v_mul_u32_u24 v10, 1280, v10
    v_lshl_add_u32 v10, v8, 4, v10
    v_add_u32 v8, 64, v0
    v_mul_u32_u24 v11, 0xccd, v8
    v_lshrrev_b32 v11, 16, v11
    v_mul_u32_u24 v9, 20, v11
    v_sub_u32 v8, v8, v9
    v_mul_u32_u24 v11, 1280, v11
    v_lshl_add_u32 v11, v8, 4, v11
    v_add_u32 v8, 128, v0
    v_mul_u32_u24 v12, 0xccd, v8
    v_lshrrev_b32 v12, 16, v12
    v_mul_u32_u24 v9, 20, v12
    v_sub_u32 v8, v8, v9
    v_mul_u32_u24 v12, 1280, v12
    v_lshl_add_u32 v12, v8, 4, v12
    v_add_u32 v8, 192, v0
    v_mul_u32_u24 v13, 0xccd, v8
    v_lshrrev_b32 v13, 16, v13
    v_mul_u32_u24 v9, 20, v13
    v_sub_u32 v8, v8, v9
    v_mul_u32_u24 v13, 1280, v13
    v_lshl_add_u32 v13, v8, 4, v13
    v_add_u32 v8, 256, v0
    v_mul_u32_u24 v14, 0xccd, v8
    v_lshrrev_b32 v14, 16, v14
    v_mul_u32_u24 v9, 20, v14
    v_sub_u32 v8, v8, v9
    v_mul_u32_u24 v14, 1280, v14
    v_lshl_add_u32 v14, v8, 4, v14
    s_waitcnt vmcnt(0)
    v_mov_b32 v8, 162060
    v_mov_b32 v9, 1
    s_mov_b64 exec, 1
    ds_add_u32 v8, v9
    s_mov_b64 exec, -1
    s_mov_b32 s48, s20
    s_mov_b32 s49, s21
    s_mov_b32 s50, 2211840
    s_mov_b32 s51, 0x20000
    s_mul_i32 s63, s35, 81920
    s_mul_i32 s62, s3, 320
    s_add_u32 s63, s63, s62
    s_mov_b32 m0, s101
    s_mov_b32 s62, 4
L_w2dma:
    buffer_load_dwordx4 v10, s[48:51], s63 offen nt lds
    s_add_u32 m0, m0, 1024
    s_waitcnt vmcnt(4)
    s_cmp_ge_u32 s35, 22
    s_cbranch_scc1 L_w2n0
    s_waitcnt vmcnt(2)
L_w2n0:
    buffer_load_dwordx4 v11, s[48:51], s63 offen nt lds
    s_add_u32 m0, m0, 1024
    s_waitcnt vmcnt(4)
    s_cmp_ge_u32 s35, 22
    s_cbranch_scc1 L_w2n1
    s_waitcnt vmcnt(2)
L_w2n1:
    buffer_load_dwordx4 v12, s[48:51], s63 offen nt lds
    s_add_u32 m0, m0, 1024
    s_waitcnt vmcnt(4)
    s_cmp_ge_u32 s35, 22
    s_cbranch_scc1 L_w2n2
    s_waitcnt vmcnt(2)
L_w2n2:
    buffer_load_dwordx4 v13, s[48:51], s63 offen nt lds
    s_add_u32 m0, m0, 1024
    s_waitcnt vmcnt(4)
    s_cmp_ge_u32 s35, 22
    s_cbranch_scc1 L_w2n3
    s_waitcnt vmcnt(2)
L_w2n3:
    buffer_load_dwordx4 v14, s[48:51], s63 offen nt lds
    s_add_u32 m0, m0, 1024
    s_waitcnt vmcnt(4)
    s_cmp_ge_u32 s35, 22
    s_cbranch_scc1 L_w2n4
    s_waitcnt vmcnt(2)
L_w2n4:
    s_add_u32 s63, s63, 20480
    s_sub_u32 s62, s62, 1
    s_cmp_lg_u32 s62, 0
    s_cbranch_scc1 L_w2dma
    v_lshl_add_u32 v8, v3, 3, v1
    v_mul_u32_u24 v8, 320, v8
    v_lshl_add_u32 v8, v2, 3, v8
    v_add_u32 v8, s101, v8
    s_waitcnt vmcnt(0)
    ds_read_b64_tr_b16 v[80:81], v8 offset:0
    ds_read_b64_tr_b16 v[82:83], v8 offset:1280
    ds_read_b64_tr_b16 v[84:85], v8 offset:10240
    ds_read_b64_tr_b16 v[86:87], v8 offset:11520
    ds_read_b64_tr_b16 v[88:89], v8 offset:32
    ds_read_b64_tr_b16 v[90:91], v8 offset:1312
    ds_read_b64_tr_b16 v[92:93], v8 offset:10272
    ds_read_b64_tr_b16 v[94:95], v8 offset:11552
    ds_read_b64_tr_b16 v[96:97], v8 offset:64
    ds_read_b64_tr_b16 v[98:99], v8 offset:1344
    ds_read_b64_tr_b16 v[100:101], v8 offset:10304
    ds_read_b64_tr_b16 v[102:103], v8 offset:11584
    ds_read_b64_tr_b16 v[104:105], v8 offset:96
    ds_read_b64_tr_b16 v[106:107], v8 offset:1376
    ds_read_b64_tr_b16 v[108:109], v8 offset:10336
    ds_read_b64_tr_b16 v[110:111], v8 offset:11616
    ds_read_b64_tr_b16 v[112:113], v8 offset:128
    ds_read_b64_tr_b16 v[114:115], v8 offset:1408
    ds_read_b64_tr_b16 v[116:117], v8 offset:10368
    ds_read_b64_tr_b16 v[118:119], v8 offset:11648
    ds_read_b64_tr_b16 v[120:121], v8 offset:160
    ds_read_b64_tr_b16 v[122:123], v8 offset:1440
    ds_read_b64_tr_b16 v[124:125], v8 offset:10400
    ds_read_b64_tr_b16 v[126:127], v8 offset:11680
    ds_read_b64_tr_b16 v[128:129], v8 offset:192
    ds_read_b64_tr_b16 v[130:131], v8 offset:1472
    ds_read_b64_tr_b16 v[132:133], v8 offset:10432
    ds_read_b64_tr_b16 v[134:135], v8 offset:11712
    ds_read_b64_tr_b16 v[136:137], v8 offset:224
    ds_read_b64_tr_b16 v[138:139], v8 offset:1504
    ds_read_b64_tr_b16 v[140:141], v8 offset:10464
    ds_read_b64_tr_b16 v[142:143], v8 offset:11744
    ds_read_b64_tr_b16 v[144:145], v8 offset:256
    ds_read_b64_tr_b16 v[146:147], v8 offset:1536
    ds_read_b64_tr_b16 v[148:149], v8 offset:10496
    ds_read_b64_tr_b16 v[150:151], v8 offset:11776
    ds_read_b64_tr_b16 v[152:153], v8 offset:288
    ds_read_b64_tr_b16 v[154:155], v8 offset:1568
    ds_read_b64_tr_b16 v[156:157], v8 offset:10528
    ds_read_b64_tr_b16 v[158:159], v8 offset:11808
    s_mov_b32 s48, s16
    s_mov_b32 s49, s17
    s_mov_b32 s50, 2211840
    s_mov_b32 s51, 0x20000
    s_lshl_b32 s98, s35, 7
    s_mov_b32 s99, 3456
    v_lshrrev_b32 v9, 3, v0
    v_mul_lo_u32 v10, v9, s99
    v_and_b32 v9, 2, v9
    v_xor_b32 v9, v9, v0
    v_and_b32 v9, 7, v9
    v_lshl_add_u32 v10, v9, 4, v10
    v_add_u32 v10, s98, v10
    v_xor_b32 v11, 64, v10
    s_mul_i32 s63, s3, 552960
    s_mov_b32 m0, s101
    s_waitcnt lgkmcnt(0)
    s_cmp_ge_u32 s35, 22
    s_cselect_b32 s100, 2, 1
    s_mov_b32 s62, 10
L_dma_6:
    buffer_load_dwordx4 v10, s[48:51], s63 offen nt lds
    s_add_u32 m0, m0, 1024
    s_add_u32 s63, s63, 27648
    s_cmp_eq_u32 s100, 0
    s_cbranch_scc1 L_dma_6n0
    s_waitcnt vmcnt(4)
    s_cmp_eq_u32 s100, 2
    s_cbranch_scc1 L_dma_6n0
    s_waitcnt vmcnt(2)
L_dma_6n0:
    buffer_load_dwordx4 v11, s[48:51], s63 offen nt lds
    s_add_u32 m0, m0, 1024
    s_add_u32 s63, s63, 27648
    s_cmp_eq_u32 s100, 0
    s_cbranch_scc1 L_dma_6n1
    s_waitcnt vmcnt(4)
    s_cmp_eq_u32 s100, 2
    s_cbranch_scc1 L_dma_6n1
    s_waitcnt vmcnt(2)
L_dma_6n1:
    s_sub_u32 s62, s62, 1
    s_cmp_lg_u32 s62, 0
    s_cbranch_scc1 L_dma_6
    v_mov_b32 v8, 162068
L_lw_7:
    ds_read_b32 v9, v8
    s_waitcnt lgkmcnt(0)
    v_cmp_gt_u32 vcc, 1, v9
    s_cbranch_vccz L_lw_7e
    s_sleep 8
    s_sub_u32 s60, s60, 1
    s_cbranch_scc0 L_lw_7
    s_mov_b32 s60, 0
L_lw_7e:
    s_cmp_lg_u32 s3, 3
    s_cbranch_scc1 L_h_nomo
    v_and_b32 v4, 15, v0
    v_lshlrev_b32 v4, 4, v4
    v_mul_u32_u24 v5, 1280, v3
    v_add_u32 v5, v5, v4
    v_mul_u32_u24 v6, 1296, v3
    v_add_u32 v6, v6, v4
    v_add_u32 v6, 147456, v6
    s_mov_b32 s62, 30720
    s_mov_b32 s63, 25600
L_poll_8:
    buffer_load_dwordx4 v[40:43], v5, s[40:43], s62 offen offset:0 sc1
    buffer_load_dwordx4 v[44:47], v5, s[40:43], s62 offen offset:256 sc1
    buffer_load_dwordx4 v[48:51], v5, s[40:43], s62 offen offset:512 sc1
    buffer_load_dwordx4 v[52:55], v5, s[40:43], s62 offen offset:768 sc1
    buffer_load_dwordx4 v[56:59], v5, s[40:43], s62 offen offset:1024 sc1
    buffer_load_dwordx4 v[60:63], v5, s[40:43], s63 offen offset:0 sc1
    buffer_load_dwordx4 v[64:67], v5, s[40:43], s63 offen offset:256 sc1
    buffer_load_dwordx4 v[68:71], v5, s[40:43], s63 offen offset:512 sc1
    buffer_load_dwordx4 v[72:75], v5, s[40:43], s63 offen offset:768 sc1
    buffer_load_dwordx4 v[76:79], v5, s[40:43], s63 offen offset:1024 sc1
    s_waitcnt vmcnt(0)
    v_max3_u32 v7, v40, v41, v42
    v_max3_u32 v7, v7, v43, v44
    v_max3_u32 v7, v7, v45, v46
    v_max3_u32 v7, v7, v47, v48
    v_max3_u32 v7, v7, v49, v50
    v_max3_u32 v7, v7, v51, v52
    v_max3_u32 v7, v7, v53, v54
    v_max3_u32 v7, v7, v55, v56
    v_max3_u32 v7, v7, v57, v58
    v_max3_u32 v7, v7, v59, v60
    v_max3_u32 v7, v7, v61, v62
    v_max3_u32 v7, v7, v63, v64
    v_max3_u32 v7, v7, v65, v66
    v_max3_u32 v7, v7, v67, v68
    v_max3_u32 v7, v7, v69, v70
    v_max3_u32 v7, v7, v71, v72
    v_max3_u32 v7, v7, v73, v74
    v_max3_u32 v7, v7, v75, v76
    v_max3_u32 v7, v7, v77, v78
    v_max_u32 v7, v7, v79
    v_cmp_eq_u32 vcc, -1, v7
    s_cbranch_vccz L_poll_8e
    s_sleep 8
    s_sub_u32 s60, s60, 1
    s_cbranch_scc0 L_poll_8
    s_mov_b32 s60, 0
L_poll_8e:
    ds_write_b128 v6, v[40:43] offset:0
    ds_write_b128 v6, v[44:47] offset:256
    ds_write_b128 v6, v[48:51] offset:512
    ds_write_b128 v6, v[52:55] offset:768
    ds_write_b128 v6, v[56:59] offset:1024
    ds_write_b128 v6, v[60:63] offset:5184
    ds_write_b128 v6, v[64:67] offset:5440
    ds_write_b128 v6, v[68:71] offset:5696
    ds_write_b128 v6, v[72:75] offset:5952
    ds_write_b128 v6, v[76:79] offset:6208
L_h_nomo:
    v_mul_u32_u24 v4, 144, v2
    v_lshl_add_u32 v4, v3, 4, v4
    v_add_u32 v161, 97600, v4
    s_mov_b32 s100, s3
    s_lshl_b32 s63, s100, 8
    v_and_b32 v8, 15, v0
    v_lshl_add_u32 v8, v8, 4, s63
    v_lshrrev_b32 v9, 4, v0
    v_mul_u32_u24 v5, 1280, v9
    v_add_u32 v5, v5, v8
    v_mul_u32_u24 v4, 1296, v9
    v_add_u32 v4, v4, v8
    v_add_u32 v4, 81920, v4
    v_lshlrev_b32 v6, 1, v5
    v_add_u32 v6, 87104, v6
    s_lshl_b32 s62, s100, 3
    s_add_u32 s62, s62, 97344
    v_lshl_add_u32 v7, v9, 6, s62
    s_mov_b32 s48, s4
    s_mov_b32 s49, s5
    s_mov_b32 s50, 5120
    s_mov_b32 s51, 0x20000
    buffer_load_dwordx4 v[8:11], v5, s[48:51], 0 offen
    s_mov_b32 s62, 20480
    s_mov_b32 s63, 30720
L_poll_9:
    buffer_load_dwordx4 v[12:15], v5, s[40:43], s62 offen sc1
    buffer_load_dwordx4 v[16:19], v5, s[40:43], s63 offen sc1
    s_waitcnt vmcnt(0)
    v_max3_u32 v38, v12, v13, v14
    v_max3_u32 v38, v38, v15, v16
    v_max3_u32 v38, v38, v17, v18
    v_max_u32 v38, v38, v19
    v_cmp_eq_u32 vcc, -1, v38
    s_cbranch_vccz L_poll_9e
    s_sleep 8
    s_sub_u32 s60, s60, 1
    s_cbranch_scc0 L_poll_9
    s_mov_b32 s60, 0
L_poll_9e:
    v_lshlrev_b32 v40, 16, v8
    v_and_b32 v41, 0xffff0000, v8
    v_lshlrev_b32 v42, 16, v9
    v_and_b32 v43, 0xffff0000, v9
    v_lshlrev_b32 v44, 16, v10
    v_and_b32 v45, 0xffff0000, v10
    v_lshlrev_b32 v46, 16, v11
    v_and_b32 v47, 0xffff0000, v11
    v_lshlrev_b32 v48, 16, v12
    v_and_b32 v49, 0xffff0000, v12
    v_lshlrev_b32 v50, 16, v13
    v_and_b32 v51, 0xffff0000, v13
    v_lshlrev_b32 v52, 16, v14
    v_and_b32 v53, 0xffff0000, v14
    v_lshlrev_b32 v54, 16, v15
    v_and_b32 v55, 0xffff0000, v15
    v_lshlrev_b32 v56, 16, v16
    v_and_b32 v57, 0xffff0000, v16
    v_lshlrev_b32 v58, 16, v17
    v_and_b32 v59, 0xffff0000, v17
    v_lshlrev_b32 v60, 16, v18
    v_and_b32 v61, 0xffff0000, v18
    v_lshlrev_b32 v62, 16, v19
    v_and_b32 v63, 0xffff0000, v19
    v_mov_b32 v64, 0
    v_mov_b32 v65, 0
    v_mov_b32 v66, 0
    v_mov_b32 v67, 0
    v_mov_b32 v68, 0
    v_mov_b32 v69, 0
    v_mov_b32 v70, 0
    v_mov_b32 v71, 0
    s_waitcnt vmcnt(0) lgkmcnt(0)
    v_mov_b32 v8, 162064
    v_mov_b32 v9, 1
    s_mov_b64 exec, 1
    ds_add_u32 v8, v9
    s_mov_b64 exec, -1
    s_branch L_t2gate
L_ffn2:
    s_barrier
    ds_read_b128 v[8:11], v161
    ds_read_b128 v[12:15], v161 offset:64
    s_cmp_eq_u32 s61, 1
    s_cbranch_scc0 L_f2slow
    s_waitcnt lgkmcnt(1)
    v_mfma_f32_16x16x32_bf16 v[16:19], v[80:83], v[8:11], 0
    v_mfma_f32_16x16x32_bf16 v[20:23], v[88:91], v[8:11], 0
    v_mfma_f32_16x16x32_bf16 v[24:27], v[96:99], v[8:11], 0
    v_mfma_f32_16x16x32_bf16 v[28:31], v[104:107], v[8:11], 0
    s_waitcnt lgkmcnt(0)
    v_mfma_f32_16x16x32_bf16 v[16:19], v[84:87], v[12:15], v[16:19]
    v_mfma_f32_16x16x32_bf16 v[20:23], v[92:95], v[12:15], v[20:23]
    v_mfma_f32_16x16x32_bf16 v[24:27], v[100:103], v[12:15], v[24:27]
    v_mfma_f32_16x16x32_bf16 v[28:31], v[108:111], v[12:15], v[28:31]
    v_mfma_f32_16x16x32_bf16 v[32:35], v[112:115], v[8:11], 0
    v_mfma_f32_16x16x32_bf16 v[36:39], v[120:123], v[8:11], 0
    v_mfma_f32_16x16x32_bf16 v[40:43], v[128:131], v[8:11], 0
    v_mfma_f32_16x16x32_bf16 v[44:47], v[136:139], v[8:11], 0
    v_mfma_f32_16x16x32_bf16 v[32:35], v[116:119], v[12:15], v[32:35]
    v_mfma_f32_16x16x32_bf16 v[36:39], v[124:127], v[12:15], v[36:39]
    v_mfma_f32_16x16x32_bf16 v[40:43], v[132:135], v[12:15], v[40:43]
    v_mfma_f32_16x16x32_bf16 v[44:47], v[140:143], v[12:15], v[44:47]
    v_mfma_f32_16x16x32_bf16 v[48:51], v[144:147], v[8:11], 0
    v_mov_b32_dpp v16, v20 quad_perm:[0,1,2,3] row_mask:0xf bank_mask:0x2
    v_mov_b32_dpp v17, v21 quad_perm:[0,1,2,3] row_mask:0xf bank_mask:0x2
    v_mov_b32_dpp v18, v22 quad_perm:[0,1,2,3] row_mask:0xf bank_mask:0x2
    v_mfma_f32_16x16x32_bf16 v[52:55], v[152:155], v[8:11], 0
    v_mov_b32_dpp v19, v23 quad_perm:[0,1,2,3] row_mask:0xf bank_mask:0x2
    v_mov_b32_dpp v16, v24 quad_perm:[0,1,2,3] row_mask:0xf bank_mask:0x4
    v_mov_b32_dpp v17, v25 quad_perm:[0,1,2,3] row_mask:0xf bank_mask:0x4
    v_mfma_f32_16x16x32_bf16 v[48:51], v[148:151], v[12:15], v[48:51]
    v_mov_b32_dpp v18, v26 quad_perm:[0,1,2,3] row_mask:0xf bank_mask:0x4
    v_mov_b32_dpp v19, v27 quad_perm:[0,1,2,3] row_mask:0xf bank_mask:0x4
    v_mov_b32_dpp v16, v28 quad_perm:[0,1,2,3] row_mask:0xf bank_mask:0x8
    v_mfma_f32_16x16x32_bf16 v[52:55], v[156:159], v[12:15], v[52:55]
    v_mov_b32_dpp v17, v29 quad_perm:[0,1,2,3] row_mask:0xf bank_mask:0x8
    v_mov_b32_dpp v18, v30 quad_perm:[0,1,2,3] row_mask:0xf bank_mask:0x8
    v_mov_b32_dpp v19, v31 quad_perm:[0,1,2,3] row_mask:0xf bank_mask:0x8
    buffer_store_dwordx4 v[16:19], v160, s[40:43], s57 offen
    v_mov_b32_dpp v32, v36 quad_perm:[0,1,2,3] row_mask:0xf bank_mask:0x2
    v_mov_b32_dpp v33, v37 quad_perm:[0,1,2,3] row_mask:0xf bank_mask:0x2
    v_mov_b32_dpp v34, v38 quad_perm:[0,1,2,3] row_mask:0xf bank_mask:0x2
    v_mov_b32_dpp v35, v39 quad_perm:[0,1,2,3] row_mask:0xf bank_mask:0x2
    v_mov_b32_dpp v32, v40 quad_perm:[0,1,2,3] row_mask:0xf bank_mask:0x4
    v_mov_b32_dpp v33, v41 quad_perm:[0,1,2,3] row_mask:0xf bank_mask:0x4
    v_mov_b32_dpp v34, v42 quad_perm:[0,1,2,3] row_mask:0xf bank_mask:0x4
    v_mov_b32_dpp v35, v43 quad_perm:[0,1,2,3] row_mask:0xf bank_mask:0x4
    v_mov_b32_dpp v32, v44 quad_perm:[0,1,2,3] row_mask:0xf bank_mask:0x8
    v_mov_b32_dpp v33, v45 quad_perm:[0,1,2,3] row_mask:0xf bank_mask:0x8
    v_mov_b32_dpp v34, v46 quad_perm:[0,1,2,3] row_mask:0xf bank_mask:0x8
    v_mov_b32_dpp v35, v47 quad_perm:[0,1,2,3] row_mask:0xf bank_mask:0x8
    buffer_store_dwordx4 v[32:35], v160, s[40:43], s57 offen offset:256
    v_mov_b32_dpp v48, v52 quad_perm:[0,1,2,3] row_mask:0xf bank_mask:0x2
    v_mov_b32_dpp v49, v53 quad_perm:[0,1,2,3] row_mask:0xf bank_mask:0x2
    v_mov_b32_dpp v50, v54 quad_perm:[0,1,2,3] row_mask:0xf bank_mask:0x2
    v_mov_b32_dpp v51, v55 quad_perm:[0,1,2,3] row_mask:0xf bank_mask:0x2
    s_mov_b32 exec_lo, 0x00ff00ff
    s_mov_b32 exec_hi, 0x00ff00ff
    buffer_store_dwordx4 v[48:51], v160, s[40:43], s57 offen offset:512
L_f2done:
    s_barrier
    s_endpgm
L_f2slow:
    s_waitcnt lgkmcnt(1)
    v_mfma_f32_16x16x32_bf16 v[16:19], v[80:83], v[8:11], 0
    v_mfma_f32_16x16x32_bf16 v[20:23], v[88:91], v[8:11], 0
    v_mfma_f32_16x16x32_bf16 v[24:27], v[96:99], v[8:11], 0
    v_mfma_f32_16x16x32_bf16 v[28:31], v[104:107], v[8:11], 0
    s_waitcnt lgkmcnt(0)
    v_mfma_f32_16x16x32_bf16 v[16:19], v[84:87], v[12:15], v[16:19]
    v_mfma_f32_16x16x32_bf16 v[20:23], v[92:95], v[12:15], v[20:23]
    v_mfma_f32_16x16x32_bf16 v[24:27], v[100:103], v[12:15], v[24:27]
    v_mfma_f32_16x16x32_bf16 v[28:31], v[108:111], v[12:15], v[28:31]
    v_mfma_f32_16x16x32_bf16 v[32:35], v[112:115], v[8:11], 0
    v_mfma_f32_16x16x32_bf16 v[36:39], v[120:123], v[8:11], 0
    v_mfma_f32_16x16x32_bf16 v[40:43], v[128:131], v[8:11], 0
    v_mfma_f32_16x16x32_bf16 v[44:47], v[136:139], v[8:11], 0
    v_mfma_f32_16x16x32_bf16 v[32:35], v[116:119], v[12:15], v[32:35]
    v_mfma_f32_16x16x32_bf16 v[36:39], v[124:127], v[12:15], v[36:39]
    v_mfma_f32_16x16x32_bf16 v[40:43], v[132:135], v[12:15], v[40:43]
    v_mfma_f32_16x16x32_bf16 v[44:47], v[140:143], v[12:15], v[44:47]
    v_mfma_f32_16x16x32_bf16 v[48:51], v[144:147], v[8:11], 0
    v_mov_b32_dpp v16, v20 quad_perm:[0,1,2,3] row_mask:0xf bank_mask:0x2
    v_mov_b32_dpp v17, v21 quad_perm:[0,1,2,3] row_mask:0xf bank_mask:0x2
    v_mov_b32_dpp v18, v22 quad_perm:[0,1,2,3] row_mask:0xf bank_mask:0x2
    v_mfma_f32_16x16x32_bf16 v[52:55], v[152:155], v[8:11], 0
    v_mov_b32_dpp v19, v23 quad_perm:[0,1,2,3] row_mask:0xf bank_mask:0x2
    v_mov_b32_dpp v16, v24 quad_perm:[0,1,2,3] row_mask:0xf bank_mask:0x4
    v_mov_b32_dpp v17, v25 quad_perm:[0,1,2,3] row_mask:0xf bank_mask:0x4
    v_mfma_f32_16x16x32_bf16 v[48:51], v[148:151], v[12:15], v[48:51]
    v_mov_b32_dpp v18, v26 quad_perm:[0,1,2,3] row_mask:0xf bank_mask:0x4
    v_mov_b32_dpp v19, v27 quad_perm:[0,1,2,3] row_mask:0xf bank_mask:0x4
    v_mov_b32_dpp v16, v28 quad_perm:[0,1,2,3] row_mask:0xf bank_mask:0x8
    v_mfma_f32_16x16x32_bf16 v[52:55], v[156:159], v[12:15], v[52:55]
    v_mov_b32_dpp v17, v29 quad_perm:[0,1,2,3] row_mask:0xf bank_mask:0x8
    v_mov_b32_dpp v18, v30 quad_perm:[0,1,2,3] row_mask:0xf bank_mask:0x8
    v_mov_b32_dpp v19, v31 quad_perm:[0,1,2,3] row_mask:0xf bank_mask:0x8
    buffer_store_dwordx4 v[16:19], v160, s[40:43], s57 offen sc1
    v_mov_b32_dpp v32, v36 quad_perm:[0,1,2,3] row_mask:0xf bank_mask:0x2
    v_mov_b32_dpp v33, v37 quad_perm:[0,1,2,3] row_mask:0xf bank_mask:0x2
    v_mov_b32_dpp v34, v38 quad_perm:[0,1,2,3] row_mask:0xf bank_mask:0x2
    v_mov_b32_dpp v35, v39 quad_perm:[0,1,2,3] row_mask:0xf bank_mask:0x2
    v_mov_b32_dpp v32, v40 quad_perm:[0,1,2,3] row_mask:0xf bank_mask:0x4
    v_mov_b32_dpp v33, v41 quad_perm:[0,1,2,3] row_mask:0xf bank_mask:0x4
    v_mov_b32_dpp v34, v42 quad_perm:[0,1,2,3] row_mask:0xf bank_mask:0x4
    v_mov_b32_dpp v35, v43 quad_perm:[0,1,2,3] row_mask:0xf bank_mask:0x4
    v_mov_b32_dpp v32, v44 quad_perm:[0,1,2,3] row_mask:0xf bank_mask:0x8
    v_mov_b32_dpp v33, v45 quad_perm:[0,1,2,3] row_mask:0xf bank_mask:0x8
    v_mov_b32_dpp v34, v46 quad_perm:[0,1,2,3] row_mask:0xf bank_mask:0x8
    v_mov_b32_dpp v35, v47 quad_perm:[0,1,2,3] row_mask:0xf bank_mask:0x8
    buffer_store_dwordx4 v[32:35], v160, s[40:43], s57 offen offset:256 sc1
    v_mov_b32_dpp v48, v52 quad_perm:[0,1,2,3] row_mask:0xf bank_mask:0x2
    v_mov_b32_dpp v49, v53 quad_perm:[0,1,2,3] row_mask:0xf bank_mask:0x2
    v_mov_b32_dpp v50, v54 quad_perm:[0,1,2,3] row_mask:0xf bank_mask:0x2
    v_mov_b32_dpp v51, v55 quad_perm:[0,1,2,3] row_mask:0xf bank_mask:0x2
    s_mov_b32 exec_lo, 0x00ff00ff
    s_mov_b32 exec_hi, 0x00ff00ff
    buffer_store_dwordx4 v[48:51], v160, s[40:43], s57 offen offset:512 sc1
    s_branch L_f2done
L_end:
    s_endpgm
L_codeend:
.section .rodata,"a"
.p2align 6
.amdhsa_kernel adaLN_cond__sliding_block_cached__dense_activation_gelu__decode_kernel
  .amdhsa_next_free_vgpr 168
  .amdhsa_next_free_sgpr 102
  .amdhsa_accum_offset 168
  .amdhsa_group_segment_fixed_size 0
  .amdhsa_kernarg_size 120
  .amdhsa_user_sgpr_count 2
  .amdhsa_user_sgpr_kernarg_segment_ptr 1
  .amdhsa_system_sgpr_workgroup_id_x 1
.end_amdhsa_kernel
```

```asm
; @launch grid=(256,1,1) block=(768,1,1) lds=162176
.amdgcn_target "amdgcn-amd-amdhsa--gfx950"
.text
.globl adaLN_cond__sliding_block_cached__dense_activation_gelu__decode_kernel
.p2align 8
.type adaLN_cond__sliding_block_cached__dense_activation_gelu__decode_kernel,@function
adaLN_cond__sliding_block_cached__dense_activation_gelu__decode_kernel:
    s_load_dwordx16 s[4:19], s[0:1], 0
    s_load_dwordx8 s[20:27], s[0:1], 64
    s_load_dwordx4 s[28:31], s[0:1], 96
    s_load_dwordx2 s[32:33], s[0:1], 112
    s_cmp_ge_u32 s2, 256
    s_cbranch_scc1 L_end
    v_lshrrev_b32 v1, 6, v0
    v_lshlrev_b32 v2, 4, v0
    v_readfirstlane_b32 s3, v1
    v_and_b32 v0, 63, v0
    s_and_b32 s34, s2, 7
    s_lshr_b32 s35, s2, 3
    s_cmp_lg_u32 s35, 21
    s_cbranch_scc1 L_nopf
    s_getpc_b64 s[48:49]
    s_and_b32 s48, s48, 0xffffff00
    s_mov_b32 s50, L_codeend-adaLN_cond__sliding_block_cached__dense_activation_gelu__decode_kernel
    s_mov_b32 s51, 0x20000
    s_mov_b32 s52, 12288
    buffer_load_dwordx4 v[152:155], v2, s[48:51], 0 offen
    buffer_load_dwordx4 v[156:159], v2, s[48:51], s52 offen
L_nopf:
    s_lshr_b32 s36, s35, 3
    s_lshl2_add_u32 s36, s34, s36
    s_bfe_u32 s37, s35, 0x20001
    s_and_b32 s38, s35, 1
    s_cmp_lt_u32 s35, 27
    s_cselect_b32 s39, 1, 0
    s_cmp_eq_u32 s34, 2
    s_cselect_b32 s39, s39, 0
    s_sub_u32 s62, s34, 3
    s_and_b32 s62, s62, 7
    s_mul_i32 s56, s35, 7
    s_add_u32 s56, s56, s62
    s_cmp_eq_u32 s62, 7
    s_cselect_b32 s56, 255, s56
    s_mov_b32 s60, 400000
    s_mov_b32 s61, 0
    v_mov_b32 v36, 0
    s_cmp_lt_u32 s3, 4
    s_cbranch_scc1 L_helpers
    s_sub_u32 s3, s3, 4
    s_cmp_ge_u32 s35, 22
    s_cselect_b32 s59, 1, 0
    s_add_u32 s62, s3, s59
    s_cmp_ge_u32 s62, 6
    s_cselect_b32 s62, s39, 0
    s_cmp_eq_u32 s62, 1
    s_cbranch_scc1 L_proxy
    s_cmp_eq_u32 s59, 1
    s_cselect_b32 s100, 0, 81920
    s_lshl_b32 s62, s3, 13
    s_add_u32 s100, s100, s62
    s_and_b32 s62, s39, s59
    s_cselect_b32 s100, -1, s100
    s_mov_b32 s101, 0
L_stream:
    s_lshl_b32 s62, s37, 5
    s_add_u32 s62, s62, s36
    s_lshl_b32 s63, s62, 21
    s_lshl_b32 s96, s38, 18
    s_add_u32 s63, s63, s96
    s_add_u32 s63, s63, 1572864
    v_lshlrev_b32 v1, 4, v0
    s_lshl_b32 s96, s3, 12
    v_add_u32 v1, s96, v1
    s_mov_b32 s97, 0
    s_mov_b32 s50, 262144
    s_mov_b32 s51, 0x20000
    s_waitcnt lgkmcnt(0)
    s_add_u32 s48, s6, s63
    s_addc_u32 s49, s7, 0
    buffer_load_dwordx4 v[40:43], v1, s[48:51], s97 offen offset:0 nt
    buffer_load_dwordx4 v[44:47], v1, s[48:51], s97 offen offset:1024 nt
    s_barrier
    s_branch L_stream2
L_helpers:
    s_cmp_lg_u32 s3, 0
    s_cbranch_scc1 L_noinit
    v_lshlrev_b32 v1, 2, v0
    v_add_u32 v1, 161920, v1
    ds_write_b32 v1, v36
L_noinit:
    s_waitcnt lgkmcnt(0)
    s_mov_b32 s40, s32
    s_mov_b32 s41, s33
    s_mov_b32 s42, 589824
    s_mov_b32 s43, 0x20000
    s_mov_b32 s44, s30
    s_mov_b32 s45, s31
    s_mov_b32 s46, 256
    s_mov_b32 s47, 0x20000
    s_lshl2_add_u32 s62, s35, s3
    s_cmp_eq_u32 s62, 87
    s_cbranch_scc1 L_touch
L_notp:
    s_mul_i32 s101, s3, 20480
    s_mov_b32 s96, s56
    s_cmp_lt_u32 s56, 40
    s_cbranch_scc0 L_nothalf
    s_cmp_lt_u32 s3, 2
    s_cbranch_scc1 L_unit
    s_add_u32 s62, s56, 20
    s_cmp_eq_u32 s3, 2
    s_cbranch_scc1 L_job
    s_lshr_b32 s62, s56, 1
    s_and_b32 s63, s56, 1
    s_mul_i32 s63, s63, 5120
    s_lshl_b32 s96, s62, 7
    s_add_u32 s63, s63, s96
    s_cmp_ge_u32 s62, 10
    s_cselect_b32 s62, 8960, 0
    s_add_u32 s63, s63, s62
    v_lshrrev_b32 v1, 4, v0
    v_mul_u32_u24 v1, 1280, v1
    v_and_b32 v2, 15, v0
    v_lshl_add_u32 v1, v2, 3, v1
    v_mov_b32 v4, -1
    v_mov_b32 v5, -1
    buffer_store_dwordx2 v[4:5], v1, s[40:43], s63 offen sc1
    s_lshl_b32 s62, s56, 1
    s_waitcnt vmcnt(0)
    s_mov_b64 exec, 1
    buffer_store_short v4, v36, s[44:47], s62 offen offset:128 sc1
    s_mov_b64 exec, -1
    s_barrier
    s_branch L_service
L_nothalf:
    s_cmp_lt_u32 s56, 104
    s_cbranch_scc1 L_unit
    s_sub_u32 s62, s56, 144
    s_cmp_lt_u32 s62, 10
    s_cbranch_scc0 L_nojob
    s_cmp_lt_u32 s3, 2
    s_cbranch_scc0 L_nojob
    s_mul_i32 s63, s3, 10
    s_add_u32 s62, s62, s63
L_job:
    s_cmp_lt_u32 s62, 59
    s_cbranch_scc0 L_end
    s_mov_b32 s100, s101
    s_lshl_b32 s101, s62, 9
    s_add_u32 s101, s101, 196608
    s_cmp_lt_u32 s62, 27
    s_cselect_b32 s63, 0, 27
    s_cselect_b32 s3, 7, 6
    s_cmp_lt_u32 s62, 54
    s_cselect_b32 s63, s63, 32
    s_cselect_b32 s3, s3, 5
    s_sub_u32 s35, s62, s63
    s_mov_b32 s34, 2
    s_lshr_b32 s36, s35, 3
    s_add_u32 s36, s36, 8
    s_bfe_u32 s37, s35, 0x20001
    s_and_b32 s38, s35, 1
    s_mov_b32 s59, 0
    s_branch L_stream
L_nojob:
    s_barrier
    s_cmp_ge_u32 s35, 22
    s_cbranch_scc1 L_h_t1
    s_cmp_eq_u32 s39, 1
    s_cbranch_scc1 L_h_role
    s_cmp_lt_u32 s96, 144
    s_cbranch_scc1 L_unit
    s_cmp_eq_u32 s3, 3
    s_cbranch_scc1 L_service
    s_endpgm
L_unit:
    v_lshrrev_b32 v3, 4, v0
    v_and_b32 v4, 3, v0
    v_bfe_u32 v7, v0, 2, 2
    v_lshlrev_b32 v64, 5, v7
    v_lshl_add_u32 v64, v3, 3, v64
    s_mov_b32 s14, s3
    s_mov_b32 s15, 3
    s_sub_u32 s62, s96, 40
    s_cmp_lt_u32 s62, 64
    s_cbranch_scc1 L_u_q
    s_mov_b32 s100, 1
    s_sub_u32 s96, s96, 84
    s_mov_b32 s12, 10240
    s_cmp_lt_u32 s56, 40
    s_cbranch_scc0 L_u_full
    s_mov_b32 s100, 0
    s_lshr_b32 s96, s56, 1
    s_and_b32 s62, s56, 1
    s_lshl1_add_u32 s14, s62, s14
    s_mov_b32 s15, 1
    s_cmp_ge_u32 s96, 10
    s_addc_u32 s62, s62, 0
    s_mul_i32 s12, s62, 5120
    s_add_u32 s12, s12, 0
L_u_full:
    s_mov_b32 s97, 0
    s_mov_b32 s99, 7680
    s_mov_b32 s48, s26
    s_mov_b32 s49, s27
    s_mov_b32 s50, 4915200
    s_mov_b32 s51, 0x20000
    s_mov_b32 s52, s24
    s_mov_b32 s53, s25
    s_mov_b32 s54, 5120
    s_mov_b32 s55, 0x20000
    v_and_b32 v6, 15, v0
    v_lshlrev_b32 v6, 4, v6
    v_mul_u32_u24 v5, 1280, v3
    v_add_u32 v5, v5, v6
    s_mul_i32 s62, s14, 320
    buffer_load_dwordx4 v[8:11], v5, s[52:55], s62 offen
    s_mov_b32 exec_lo, 0x000f000f
    s_mov_b32 exec_hi, 0x000f000f
    buffer_load_dwordx4 v[12:15], v5, s[52:55], s62 offen offset:256
    s_mov_b64 exec, -1
    s_lshl_b32 s98, s96, 7
    s_mul_i32 s13, s96, 0x199a
    s_lshr_b32 s13, s13, 16
    s_mul_i32 s63, s13, 3840
    s_add_u32 s57, s98, s63
    s_add_u32 s57, s57, s12
    v_mul_u32_u24 v5, 1280, v4
    v_add_u32 v64, v64, v5
    s_cmp_lg_u32 s13, 1
    s_cbranch_scc1 L_u_go
    s_mov_b32 s52, s4
    s_mov_b32 s53, s5
    s_mov_b32 s54, 5120
    s_mov_b32 s55, 0x20000
    v_lshrrev_b32 v6, 2, v0
    v_lshl_add_u32 v6, v6, 4, v5
    s_sub_u32 s62, s98, 1280
    buffer_load_dwordx4 v[16:19], v6, s[52:55], 0 offen offset:0
    buffer_load_dwordx4 v[20:23], v6, s[52:55], 0 offen offset:256
    buffer_load_dwordx4 v[24:27], v6, s[52:55], 0 offen offset:512
    buffer_load_dwordx4 v[28:31], v6, s[52:55], 0 offen offset:768
    buffer_load_dwordx4 v[32:35], v6, s[52:55], 0 offen offset:1024
    buffer_load_dwordx2 v[66:67], v64, s[52:55], s62 offen
    s_branch L_u_go
L_u_q:
    s_mov_b32 s97, 1
    s_mov_b32 s99, 8192
    s_mov_b32 s100, 0
    s_lshl_b32 s98, s62, 7
    s_add_u32 s57, s98, 40960
    v_lshl_add_u32 v64, v4, 13, v64
    s_mov_b32 s48, s10
    s_mov_b32 s49, s11
    s_mov_b32 s50, 5242880
    s_mov_b32 s51, 0x20000
L_u_go:
    v_lshrrev_b32 v6, 3, v0
    v_mul_lo_u32 v1, v6, s99
    v_and_b32 v6, 2, v6
    v_xor_b32 v6, v6, v0
    v_and_b32 v6, 7, v6
    v_lshl_add_u32 v1, v6, 4, v1
    v_add_u32 v1, s98, v1
    v_xor_b32 v2, 64, v1
    s_mul_i32 s63, s99, s14
    s_mul_i32 s63, s63, 160
    s_lshl_b32 s59, s99, 3
    s_mov_b32 m0, s101
    s_mov_b32 s62, 10
L_dma_1:
    buffer_load_dwordx4 v1, s[48:51], s63 offen nt lds
    s_add_u32 m0, m0, 1024
    s_add_u32 s63, s63, s59
    s_cmp_eq_u32 s100, 0
    s_cbranch_scc1 L_dma_1n0
    s_waitcnt vmcnt(3)
    s_cmp_eq_u32 s100, 2
    s_cbranch_scc1 L_dma_1n0
    s_waitcnt vmcnt(3)
L_dma_1n0:
    buffer_load_dwordx4 v2, s[48:51], s63 offen nt lds
    s_add_u32 m0, m0, 1024
    s_add_u32 s63, s63, s59
    s_cmp_eq_u32 s100, 0
    s_cbranch_scc1 L_dma_1n1
    s_waitcnt vmcnt(3)
    s_cmp_eq_u32 s100, 2
    s_cbranch_scc1 L_dma_1n1
    s_waitcnt vmcnt(3)
L_dma_1n1:
    s_sub_u32 s62, s62, 1
    s_cmp_lg_u32 s62, 0
    s_cbranch_scc1 L_dma_1
    v_min_u32 v65, 29, v0
    v_lshlrev_b32 v65, 2, v65
    s_cmp_lt_u32 s56, 104
    s_cselect_b32 s62, 32, 64
    v_min_u32 v6, 51, v0
    v_lshlrev_b32 v6, 2, v6
    v_cmp_le_u32 vcc, s62, v0
    s_nop 1
    v_cndmask_b32 v65, v65, v6, vcc
    v_mov_b32 v68, -1
    s_cmp_lt_u32 s56, 40
    s_cbranch_scc1 L_u_nofl
    buffer_load_dword v68, v65, s[44:47], 0 offen sc1
L_u_nofl:
    s_cmp_lt_u32 s56, 104
    s_cbranch_scc0 L_u_nob
    s_barrier
L_u_nob:
    v_lshrrev_b32 v60, 4, v0
    v_lshlrev_b32 v60, 10, v60
    v_bfe_u32 v6, v0, 2, 2
    v_lshl_add_u32 v60, v6, 7, v60
    v_and_b32 v6, 3, v0
    v_lshl_add_u32 v60, v6, 3, v60
    v_bfe_u32 v6, v0, 3, 2
    v_lshl_add_u32 v60, v6, 5, v60
    v_xor_b32 v61, 32, v60
    v_xor_b32 v62, 64, v60
    v_xor_b32 v63, 0x60, v60
    v_add_u32 v60, s101, v60
    v_add_u32 v61, s101, v61
    v_add_u32 v62, s101, v62
    v_add_u32 v63, s101, v63
    v_mov_b32 v56, 1.0
    v_mov_b32 v57, 1.0
    v_mov_b32 v58, 1.0
    v_mov_b32 v59, 1.0
    s_mov_b32 s58, 0
    s_cmp_eq_u32 s97, 1
    s_cbranch_scc1 L_u_q2
    s_cmp_eq_u32 s13, 4
    s_cselect_b32 s58, 1.0, 0
    s_cmp_lt_u32 s14, 2
    s_cselect_b32 s62, 1.0, 0
    s_cmp_eq_u32 s13, 1
    s_cselect_b32 s58, s62, s58
    s_cselect_b32 s56, 1, 0
    s_waitcnt vmcnt(20)
    s_mov_b32 s62, 0xbfb8aa3b
    v_lshlrev_b32 v40, 16, v8
    v_and_b32 v41, 0xffff0000, v8
    v_lshlrev_b32 v42, 16, v9
    v_and_b32 v43, 0xffff0000, v9
    v_lshlrev_b32 v44, 16, v10
    v_and_b32 v45, 0xffff0000, v10
    v_lshlrev_b32 v46, 16, v11
    v_and_b32 v47, 0xffff0000, v11
    v_mul_f32 v48, s62, v40
    v_mul_f32 v49, s62, v41
    v_mul_f32 v50, s62, v42
    v_mul_f32 v51, s62, v43
    v_mul_f32 v52, s62, v44
    v_mul_f32 v53, s62, v45
    v_mul_f32 v54, s62, v46
    v_mul_f32 v55, s62, v47
    v_exp_f32 v48, v48
    v_exp_f32 v49, v49
    v_exp_f32 v50, v50
    v_exp_f32 v51, v51
    v_exp_f32 v52, v52
    v_exp_f32 v53, v53
    v_exp_f32 v54, v54
    v_exp_f32 v55, v55
    v_add_f32 v48, 1.0, v48
    v_add_f32 v49, 1.0, v49
    v_add_f32 v50, 1.0, v50
    v_add_f32 v51, 1.0, v51
    v_add_f32 v52, 1.0, v52
    v_add_f32 v53, 1.0, v53
    v_add_f32 v54, 1.0, v54
    v_add_f32 v55, 1.0, v55
    v_rcp_f32 v48, v48
    v_rcp_f32 v49, v49
    v_rcp_f32 v50, v50
    v_rcp_f32 v51, v51
    v_rcp_f32 v52, v52
    v_rcp_f32 v53, v53
    v_rcp_f32 v54, v54
    v_rcp_f32 v55, v55
    v_mul_f32 v40, v40, v48
    v_mul_f32 v41, v41, v49
    v_mul_f32 v42, v42, v50
    v_mul_f32 v43, v43, v51
    v_mul_f32 v44, v44, v52
    v_mul_f32 v45, v45, v53
    v_mul_f32 v46, v46, v54
    v_mul_f32 v47, v47, v55
    v_cvt_pk_bf16_f32 v8, v40, v41
    v_cvt_pk_bf16_f32 v9, v42, v43
    v_cvt_pk_bf16_f32 v10, v44, v45
    v_cvt_pk_bf16_f32 v11, v46, v47
    v_lshlrev_b32 v40, 16, v12
    v_and_b32 v41, 0xffff0000, v12
    v_lshlrev_b32 v42, 16, v13
    v_and_b32 v43, 0xffff0000, v13
    v_lshlrev_b32 v44, 16, v14
    v_and_b32 v45, 0xffff0000, v14
    v_lshlrev_b32 v46, 16, v15
    v_and_b32 v47, 0xffff0000, v15
    v_mul_f32 v48, s62, v40
    v_mul_f32 v49, s62, v41
    v_mul_f32 v50, s62, v42
    v_mul_f32 v51, s62, v43
    v_mul_f32 v52, s62, v44
    v_mul_f32 v53, s62, v45
    v_mul_f32 v54, s62, v46
    v_mul_f32 v55, s62, v47
    v_exp_f32 v48, v48
    v_exp_f32 v49, v49
    v_exp_f32 v50, v50
    v_exp_f32 v51, v51
    v_exp_f32 v52, v52
    v_exp_f32 v53, v53
    v_exp_f32 v54, v54
    v_exp_f32 v55, v55
    v_add_f32 v48, 1.0, v48
    v_add_f32 v49, 1.0, v49
    v_add_f32 v50, 1.0, v50
    v_add_f32 v51, 1.0, v51
    v_add_f32 v52, 1.0, v52
    v_add_f32 v53, 1.0, v53
    v_add_f32 v54, 1.0, v54
    v_add_f32 v55, 1.0, v55
    v_rcp_f32 v48, v48
    v_rcp_f32 v49, v49
    v_rcp_f32 v50, v50
    v_rcp_f32 v51, v51
    v_rcp_f32 v52, v52
    v_rcp_f32 v53, v53
    v_rcp_f32 v54, v54
    v_rcp_f32 v55, v55
    v_mul_f32 v40, v40, v48
    v_mul_f32 v41, v41, v49
    v_mul_f32 v42, v42, v50
    v_mul_f32 v43, v43, v51
    v_mul_f32 v44, v44, v52
    v_mul_f32 v45, v45, v53
    v_mul_f32 v46, v46, v54
    v_mul_f32 v47, v47, v55
    v_cvt_pk_bf16_f32 v12, v40, v41
    v_cvt_pk_bf16_f32 v13, v42, v43
    v_cvt_pk_bf16_f32 v14, v44, v45
    v_cvt_pk_bf16_f32 v15, v46, v47
    s_mul_i32 s62, s3, 1344
    s_add_u32 s62, s62, 151552
    v_mul_u32_u24 v5, 336, v3
    v_and_b32 v6, 15, v0
    v_lshl_add_u32 v5, v6, 4, v5
    v_add_u32 v5, s62, v5
    ds_write_b128 v5, v[8:11]
    s_mov_b32 exec_lo, 0x000f000f
    s_mov_b32 exec_hi, 0x000f000f
    ds_write_b128 v5, v[12:15] offset:256
    s_mov_b64 exec, -1
    v_mul_u32_u24 v5, 336, v4
    v_lshl_add_u32 v5, v3, 4, v5
    v_add_u32 v5, s62, v5
    s_mov_b32 s59, 0x3e800000
    s_cmp_eq_u32 s56, 0
    s_cbranch_scc1 L_u_nost
    v_mov_b32 v40, 0
    v_mov_b32 v41, 0
    s_mov_b32 s62, 0x3f803f80
    v_dot2c_f32_bf16 v40, s62, v16
    v_dot2c_f32_bf16 v41, v16, v16
    v_dot2c_f32_bf16 v40, s62, v17
    v_dot2c_f32_bf16 v41, v17, v17
    v_dot2c_f32_bf16 v40, s62, v18
    v_dot2c_f32_bf16 v41, v18, v18
    v_dot2c_f32_bf16 v40, s62, v19
    v_dot2c_f32_bf16 v41, v19, v19
    v_dot2c_f32_bf16 v40, s62, v20
    v_dot2c_f32_bf16 v41, v20, v20
    v_dot2c_f32_bf16 v40, s62, v21
    v_dot2c_f32_bf16 v41, v21, v21
    v_dot2c_f32_bf16 v40, s62, v22
    v_dot2c_f32_bf16 v41, v22, v22
    v_dot2c_f32_bf16 v40, s62, v23
    v_dot2c_f32_bf16 v41, v23, v23
    v_dot2c_f32_bf16 v40, s62, v24
    v_dot2c_f32_bf16 v41, v24, v24
    v_dot2c_f32_bf16 v40, s62, v25
    v_dot2c_f32_bf16 v41, v25, v25
    v_dot2c_f32_bf16 v40, s62, v26
    v_dot2c_f32_bf16 v41, v26, v26
    v_dot2c_f32_bf16 v40, s62, v27
    v_dot2c_f32_bf16 v41, v27, v27
    v_dot2c_f32_bf16 v40, s62, v28
    v_dot2c_f32_bf16 v41, v28, v28
    v_dot2c_f32_bf16 v40, s62, v29
    v_dot2c_f32_bf16 v41, v29, v29
    v_dot2c_f32_bf16 v40, s62, v30
    v_dot2c_f32_bf16 v41, v30, v30
    v_dot2c_f32_bf16 v40, s62, v31
    v_dot2c_f32_bf16 v41, v31, v31
    v_dot2c_f32_bf16 v40, s62, v32
    v_dot2c_f32_bf16 v41, v32, v32
    v_dot2c_f32_bf16 v40, s62, v33
    v_dot2c_f32_bf16 v41, v33, v33
    v_dot2c_f32_bf16 v40, s62, v34
    v_dot2c_f32_bf16 v41, v34, v34
    v_dot2c_f32_bf16 v40, s62, v35
    v_dot2c_f32_bf16 v41, v35, v35
    s_nop 1
    v_add_f32_dpp v40, v40, v40 row_ror:4 row_mask:0xf bank_mask:0xf
    v_add_f32_dpp v41, v41, v41 row_ror:4 row_mask:0xf bank_mask:0xf
    s_nop 0
    v_add_f32_dpp v40, v40, v40 row_ror:8 row_mask:0xf bank_mask:0xf
    v_add_f32_dpp v41, v41, v41 row_ror:8 row_mask:0xf bank_mask:0xf
    v_mov_b32 v42, v40
    v_mov_b32 v43, v41
    s_nop 0
    v_permlane16_swap_b32 v40, v42
    v_permlane16_swap_b32 v41, v43
    v_add_f32 v40, v40, v42
    v_add_f32 v41, v41, v43
    v_mov_b32 v42, v40
    v_mov_b32 v43, v41
    s_nop 0
    v_permlane32_swap_b32 v40, v42
    v_permlane32_swap_b32 v41, v43
    v_add_f32 v40, v40, v42
    v_add_f32 v41, v41, v43
    s_mov_b32 s62, 0x3acccccd
    v_mul_f32 v40, s62, v40
    v_mul_f32 v41, s62, v41
    v_fma_f32 v41, -v40, v40, v41
    v_max_f32 v41, 0, v41
    v_add_f32 v41, 0x3727c5ac, v41
    v_rsq_f32 v41, v41
    v_lshlrev_b32 v56, 16, v66
    v_and_b32 v57, 0xffff0000, v66
    v_lshlrev_b32 v58, 16, v67
    v_and_b32 v59, 0xffff0000, v67
    v_sub_f32 v56, v56, v40
    v_sub_f32 v57, v57, v40
    v_sub_f32 v58, v58, v40
    v_sub_f32 v59, v59, v40
    v_mul_f32 v56, v56, v41
    v_mul_f32 v57, v57, v41
    v_mul_f32 v58, v58, v41
    v_mul_f32 v59, v59, v41
L_u_nost:
    ds_read_b128 v[8:11], v5 offset:0
    ds_read_b128 v[12:15], v5 offset:64
    ds_read_b128 v[16:19], v5 offset:128
    ds_read_b128 v[20:23], v5 offset:192
    ds_read_b128 v[24:27], v5 offset:256
    s_branch L_u_frag
L_u_q2:
    v_and_b32 v5, 15, v0
    v_mul_u32_u24 v5, 1280, v5
    v_lshl_add_u32 v5, v3, 4, v5
    s_mul_i32 s63, s3, 320
    s_add_u32 s63, s63, 0
    s_mov_b32 s59, 1.0
L_u_frag:
    s_waitcnt vmcnt(0)
    v_cmp_ne_u32 vcc, -1, v68
    s_cbranch_vccz L_u_yok
L_wy_2:
    buffer_load_dword v37, v65, s[44:47], 0 offen sc1
    s_waitcnt vmcnt(0)
    v_cmp_ne_u32 vcc, -1, v37
    s_cbranch_vccz L_wy_2e
    s_sleep 4
    s_sub_u32 s60, s60, 1
    s_cbranch_scc0 L_wy_2
    s_mov_b32 s60, 0
L_wy_2e:
L_u_yok:
    ds_read_b64_tr_b16 v[80:81], v60 offset:0
    ds_read_b64_tr_b16 v[82:83], v60 offset:512
    ds_read_b64_tr_b16 v[84:85], v61 offset:0
    ds_read_b64_tr_b16 v[86:87], v61 offset:512
    ds_read_b64_tr_b16 v[88:89], v62 offset:0
    ds_read_b64_tr_b16 v[90:91], v62 offset:512
    ds_read_b64_tr_b16 v[92:93], v63 offset:0
    ds_read_b64_tr_b16 v[94:95], v63 offset:512
    ds_read_b64_tr_b16 v[96:97], v60 offset:4096
    ds_read_b64_tr_b16 v[98:99], v60 offset:4608
    ds_read_b64_tr_b16 v[100:101], v61 offset:4096
    ds_read_b64_tr_b16 v[102:103], v61 offset:4608
    ds_read_b64_tr_b16 v[104:105], v62 offset:4096
    ds_read_b64_tr_b16 v[106:107], v62 offset:4608
    ds_read_b64_tr_b16 v[108:109], v63 offset:4096
    ds_read_b64_tr_b16 v[110:111], v63 offset:4608
    ds_read_b64_tr_b16 v[112:113], v60 offset:8192
    ds_read_b64_tr_b16 v[114:115], v60 offset:8704
    ds_read_b64_tr_b16 v[116:117], v61 offset:8192
    ds_read_b64_tr_b16 v[118:119], v61 offset:8704
    ds_read_b64_tr_b16 v[120:121], v62 offset:8192
    ds_read_b64_tr_b16 v[122:123], v62 offset:8704
    ds_read_b64_tr_b16 v[124:125], v63 offset:8192
    ds_read_b64_tr_b16 v[126:127], v63 offset:8704
    ds_read_b64_tr_b16 v[128:129], v60 offset:12288
    ds_read_b64_tr_b16 v[130:131], v60 offset:12800
    ds_read_b64_tr_b16 v[132:133], v61 offset:12288
    ds_read_b64_tr_b16 v[134:135], v61 offset:12800
    ds_read_b64_tr_b16 v[136:137], v62 offset:12288
    ds_read_b64_tr_b16 v[138:139], v62 offset:12800
    ds_read_b64_tr_b16 v[140:141], v63 offset:12288
    ds_read_b64_tr_b16 v[142:143], v63 offset:12800
    ds_read_b64_tr_b16 v[144:145], v60 offset:16384
    ds_read_b64_tr_b16 v[146:147], v60 offset:16896
    ds_read_b64_tr_b16 v[148:149], v61 offset:16384
    ds_read_b64_tr_b16 v[150:151], v61 offset:16896
    ds_read_b64_tr_b16 v[152:153], v62 offset:16384
    ds_read_b64_tr_b16 v[154:155], v62 offset:16896
    ds_read_b64_tr_b16 v[156:157], v63 offset:16384
    ds_read_b64_tr_b16 v[158:159], v63 offset:16896
    s_cmp_eq_u32 s97, 0
    s_cbranch_scc1 L_u_mm
    v_lshrrev_b32 v6, 2, v0
    v_mul_u32_u24 v6, 158, v6
    v_and_b32 v6, 0xfffc, v6
    v_and_b32 v7, 3, v0
    v_mul_u32_u24 v7, 5120, v7
    v_add_u32 v6, v6, v7
    s_mov_b64 exec, 0xfff
L_poll_3:
    buffer_load_dword v8, v6, s[40:43], s63 offen offset:3840 sc1
    s_waitcnt vmcnt(0)
    v_cmp_eq_u32 vcc, -1, v8
    s_cbranch_vccz L_poll_3e
    s_sleep 4
    s_sub_u32 s60, s60, 1
    s_cbranch_scc0 L_poll_3
    s_mov_b32 s60, 0
L_poll_3e:
    s_mov_b64 exec, -1
L_poll_4:
    buffer_load_dwordx4 v[8:11], v5, s[40:43], s63 offen offset:0 sc1
    buffer_load_dwordx4 v[12:15], v5, s[40:43], s63 offen offset:64 sc1
    buffer_load_dwordx4 v[16:19], v5, s[40:43], s63 offen offset:128 sc1
    buffer_load_dwordx4 v[20:23], v5, s[40:43], s63 offen offset:192 sc1
    buffer_load_dwordx4 v[24:27], v5, s[40:43], s63 offen offset:256 sc1
    s_waitcnt vmcnt(0)
    v_max3_u32 v37, v8, v9, v10
    v_max3_u32 v37, v37, v11, v12
    v_max3_u32 v37, v37, v13, v14
    v_max3_u32 v37, v37, v15, v16
    v_max3_u32 v37, v37, v17, v18
    v_max3_u32 v37, v37, v19, v20
    v_max3_u32 v37, v37, v21, v22
    v_max3_u32 v37, v37, v23, v24
    v_max3_u32 v37, v37, v25, v26
    v_max_u32 v37, v37, v27
    v_cmp_eq_u32 vcc, -1, v37
    s_cbranch_vccz L_poll_4e
    s_sleep 1
    s_sub_u32 s60, s60, 1
    s_cbranch_scc0 L_poll_4
    s_mov_b32 s60, 0
L_poll_4e:
L_u_got:
L_u_mm:
    s_waitcnt lgkmcnt(0)
    v_mfma_f32_16x16x32_bf16 v[40:43], v[80:83], v[8:11], 0
    v_mfma_f32_16x16x32_bf16 v[44:47], v[84:87], v[8:11], 0
    v_mfma_f32_16x16x32_bf16 v[48:51], v[88:91], v[8:11], 0
    v_mfma_f32_16x16x32_bf16 v[52:55], v[92:95], v[8:11], 0
    v_mfma_f32_16x16x32_bf16 v[40:43], v[96:99], v[12:15], v[40:43]
    v_mfma_f32_16x16x32_bf16 v[44:47], v[100:103], v[12:15], v[44:47]
    v_mfma_f32_16x16x32_bf16 v[48:51], v[104:107], v[12:15], v[48:51]
    v_mfma_f32_16x16x32_bf16 v[52:55], v[108:111], v[12:15], v[52:55]
    v_mfma_f32_16x16x32_bf16 v[40:43], v[112:115], v[16:19], v[40:43]
    v_mfma_f32_16x16x32_bf16 v[44:47], v[116:119], v[16:19], v[44:47]
    v_mfma_f32_16x16x32_bf16 v[48:51], v[120:123], v[16:19], v[48:51]
    v_mfma_f32_16x16x32_bf16 v[52:55], v[124:127], v[16:19], v[52:55]
    v_mfma_f32_16x16x32_bf16 v[40:43], v[128:131], v[20:23], v[40:43]
    v_mfma_f32_16x16x32_bf16 v[44:47], v[132:135], v[20:23], v[44:47]
    v_mfma_f32_16x16x32_bf16 v[48:51], v[136:139], v[20:23], v[48:51]
    v_mfma_f32_16x16x32_bf16 v[52:55], v[140:143], v[20:23], v[52:55]
    v_mfma_f32_16x16x32_bf16 v[40:43], v[144:147], v[24:27], v[40:43]
    v_mfma_f32_16x16x32_bf16 v[44:47], v[148:151], v[24:27], v[44:47]
    v_mfma_f32_16x16x32_bf16 v[48:51], v[152:155], v[24:27], v[48:51]
    v_mfma_f32_16x16x32_bf16 v[52:55], v[156:159], v[24:27], v[52:55]
    v_lshlrev_b32 v5, 4, v0
    v_add_u32 v5, 147456, v5
    s_lshl_b32 s62, s3, 10
    v_add_u32 v6, s62, v5
    v_mov_b32 v32, 162056
    v_mov_b32 v33, 1
    v_add_f32_dpp v40, v40, v40 row_ror:8 row_mask:0xf bank_mask:0xf
    v_add_f32_dpp v41, v41, v41 row_ror:8 row_mask:0xf bank_mask:0xf
    v_add_f32_dpp v42, v42, v42 row_ror:8 row_mask:0xf bank_mask:0xf
    v_add_f32_dpp v43, v43, v43 row_ror:8 row_mask:0xf bank_mask:0xf
    v_add_f32_dpp v44, v44, v44 row_ror:8 row_mask:0xf bank_mask:0xf
    v_add_f32_dpp v45, v45, v45 row_ror:8 row_mask:0xf bank_mask:0xf
    v_add_f32_dpp v46, v46, v46 row_ror:8 row_mask:0xf bank_mask:0xf
    v_add_f32_dpp v47, v47, v47 row_ror:8 row_mask:0xf bank_mask:0xf
    v_add_f32_dpp v48, v48, v48 row_ror:8 row_mask:0xf bank_mask:0xf
    v_add_f32_dpp v49, v49, v49 row_ror:8 row_mask:0xf bank_mask:0xf
    v_add_f32_dpp v50, v50, v50 row_ror:8 row_mask:0xf bank_mask:0xf
    v_add_f32_dpp v51, v51, v51 row_ror:8 row_mask:0xf bank_mask:0xf
    v_add_f32_dpp v52, v52, v52 row_ror:8 row_mask:0xf bank_mask:0xf
    v_add_f32_dpp v53, v53, v53 row_ror:8 row_mask:0xf bank_mask:0xf
    v_add_f32_dpp v54, v54, v54 row_ror:8 row_mask:0xf bank_mask:0xf
    v_add_f32_dpp v55, v55, v55 row_ror:8 row_mask:0xf bank_mask:0xf
    v_add_f32_dpp v28, v40, v40 row_ror:4 row_mask:0xf bank_mask:0x1
    v_add_f32_dpp v29, v41, v41 row_ror:4 row_mask:0xf bank_mask:0x1
    v_add_f32_dpp v30, v42, v42 row_ror:4 row_mask:0xf bank_mask:0x1
    v_add_f32_dpp v31, v43, v43 row_ror:4 row_mask:0xf bank_mask:0x1
    v_add_f32_dpp v28, v44, v44 row_ror:4 row_mask:0xf bank_mask:0x2
    v_add_f32_dpp v29, v45, v45 row_ror:4 row_mask:0xf bank_mask:0x2
    v_add_f32_dpp v30, v46, v46 row_ror:4 row_mask:0xf bank_mask:0x2
    v_add_f32_dpp v31, v47, v47 row_ror:4 row_mask:0xf bank_mask:0x2
    v_add_f32_dpp v28, v48, v48 row_ror:4 row_mask:0xf bank_mask:0x4
    v_add_f32_dpp v29, v49, v49 row_ror:4 row_mask:0xf bank_mask:0x4
    v_add_f32_dpp v30, v50, v50 row_ror:4 row_mask:0xf bank_mask:0x4
    v_add_f32_dpp v31, v51, v51 row_ror:4 row_mask:0xf bank_mask:0x4
    v_add_f32_dpp v28, v52, v52 row_ror:4 row_mask:0xf bank_mask:0x8
    v_add_f32_dpp v29, v53, v53 row_ror:4 row_mask:0xf bank_mask:0x8
    v_add_f32_dpp v30, v54, v54 row_ror:4 row_mask:0xf bank_mask:0x8
    v_add_f32_dpp v31, v55, v55 row_ror:4 row_mask:0xf bank_mask:0x8
    ds_write_b128 v6, v[28:31]
    s_mov_b64 exec, 1
    ds_add_rtn_u32 v34, v32, v33
    s_mov_b64 exec, -1
    ds_read_b128 v[8:11], v5
    ds_read_b128 v[12:15], v5 offset:1024
    ds_read_b128 v[16:19], v5 offset:2048
    ds_read_b128 v[20:23], v5 offset:3072
    s_waitcnt lgkmcnt(0)
    v_readfirstlane_b32 s62, v34
    v_mov_b32 v24, s58
    s_cmp_eq_u32 s62, s15
    s_cbranch_scc1 L_u_last
    s_cmp_eq_u32 s62, 1
    s_cbranch_scc1 L_service
    s_endpgm
L_u_last:
    v_add_f32 v8, v8, v12
    v_add_f32 v9, v9, v13
    v_add_f32 v10, v10, v14
    v_add_f32 v11, v11, v15
    s_cmp_eq_u32 s15, 1
    s_cbranch_scc1 L_u_two
    v_add_f32 v16, v16, v20
    v_add_f32 v17, v17, v21
    v_add_f32 v18, v18, v22
    v_add_f32 v19, v19, v23
    v_add_f32 v8, v8, v16
    v_add_f32 v9, v9, v17
    v_add_f32 v10, v10, v18
    v_add_f32 v11, v11, v19
L_u_two:
    v_fma_f32 v8, v8, s59, v24
    v_fma_f32 v9, v9, s59, v24
    v_fma_f32 v10, v10, s59, v24
    v_fma_f32 v11, v11, s59, v24
    v_mul_f32 v8, v8, v56
    v_mul_f32 v9, v9, v57
    v_mul_f32 v10, v10, v58
    v_mul_f32 v11, v11, v59
    v_cvt_pk_bf16_f32 v8, v8, v9
    v_cvt_pk_bf16_f32 v9, v10, v11
    buffer_store_dwordx2 v[8:9], v64, s[40:43], s57 offen sc1
    s_endpgm
L_touch:
    s_load_dword s0, s[32:33], 0
    s_load_dword s0, s[30:31], 0
    s_cmp_eq_u32 s39, 1
    s_cbranch_scc1 L_tpr
    s_mov_b32 s62, 16777216
    s_load_dword s0, s[8:9], s62
    s_mov_b32 s62, 83886080
    s_load_dword s0, s[8:9], s62
    s_mov_b32 s62, 150994944
    s_load_dword s0, s[8:9], s62
    s_mov_b32 s62, 218103808
    s_load_dword s0, s[8:9], s62
    s_branch L_tpv
L_tpr:
    s_load_dword s0, s[20:21], 0
    s_mov_b32 s62, 2211836
    s_load_dword s0, s[20:21], s62
    s_load_dword s0, s[16:17], 0
    s_mov_b32 s62, 2211836
    s_load_dword s0, s[16:17], s62
    s_load_dword s0, s[18:19], 0
    s_load_dword s0, s[22:23], 0
    s_load_dword s0, s[28:29], 0
    s_load_dword s0, s[4:5], 0
L_tpv:
    s_lshl_b32 s62, s34, 23
    s_load_dword s0, s[8:9], s62
    s_add_u32 s62, s62, 67108864
    s_load_dword s0, s[8:9], s62
    s_add_u32 s62, s62, 67108864
    s_load_dword s0, s[8:9], s62
    s_add_u32 s62, s62, 67108864
    s_load_dword s0, s[8:9], s62
    s_add_u32 s62, s62, 67108864
    s_branch L_notp
L_stream2:
    s_mov_b32 s12, s100
    s_mov_b32 s13, s101
    s_mov_b32 s40, s32
    s_mov_b32 s41, s33
    s_mov_b32 s42, 589824
    s_mov_b32 s43, 0x20000
    s_mov_b32 s44, s30
    s_mov_b32 s45, s31
    s_mov_b32 s46, 256
    s_mov_b32 s47, 0x20000
    s_bitcmp1_b32 s3, 0
    s_mov_b32 s57, 0xffffffff
    s_mov_b32 s58, 0xffff
    s_mov_b32 s14, 0xffffffff
    s_mov_b32 s15, 0x0
L_pm_10:
    s_cmp_lt_u32 s56, 104
    s_cbranch_scc0 L_pm_11
    s_bitcmp1_b32 s3, 0
    s_mov_b32 s57, 0xffff
    s_mov_b32 s58, 0x0
    s_mov_b32 s14, 0xffffffff
    s_mov_b32 s15, 0x0
L_pm_11:
    s_sub_u32 s96, s56, 43
    s_and_b32 s96, s96, 0xffffffc7
    s_cmp_eq_u32 s96, 0
    s_cbranch_scc0 L_pm_12
    s_bitcmp1_b32 s3, 0
    s_mov_b32 s57, 0x0
    s_mov_b32 s58, 0x0
    s_mov_b32 s14, 0x0
    s_mov_b32 s15, 0x0
L_pm_12:
    s_cmp_lt_u32 s56, 40
    s_cbranch_scc0 L_pm_13
    s_bitcmp1_b32 s3, 0
    s_mov_b32 s57, 0xffffffff
    s_mov_b32 s58, 0xf
    s_mov_b32 s14, 0xffffffff
    s_mov_b32 s15, 0x0
L_pm_13:
    s_cmp_eq_u32 s39, 1
    s_cbranch_scc0 L_pm_14
    s_bitcmp1_b32 s3, 0
    s_mov_b32 s57, 0xff0fff
    s_cselect_b32 s57, 0xff00ffff, s57
    s_mov_b32 s58, 0xfff
    s_mov_b32 s14, 0xff00ff
    s_cselect_b32 s14, 0xff00ff00, s14
    s_mov_b32 s15, 0x0
L_pm_14:
    s_cmp_lg_u32 s13, 0
    s_cbranch_scc0 L_pm_15
    s_bitcmp1_b32 s3, 0
    s_mov_b32 s57, 0x0
    s_mov_b32 s58, 0x0
    s_mov_b32 s14, 0x0
    s_mov_b32 s15, 0x0
L_pm_15:
    s_and_b32 s96, s39, s59
    s_cbranch_scc0 L_pm_16
    s_bitcmp1_b32 s3, 0
    s_mov_b32 s57, 0xffff
    s_mov_b32 s58, 0xffff
    s_mov_b32 s14, 0x0
    s_mov_b32 s15, 0x0
L_pm_16:
    s_add_u32 s52, s8, s63
    s_addc_u32 s53, s9, 0
    s_mov_b32 s54, 262144
    s_mov_b32 s55, 0x20000
    v_and_b32 v2, 15, v0
    v_lshrrev_b32 v3, 1, v2
    v_and_b32 v37, 1, v2
    v_lshlrev_b32 v37, 4, v37
    v_mov_b32 v38, 0xffff
    v_lshlrev_b32 v37, v37, v38
    v_cmp_eq_u32 vcc, 0, v3
    v_mov_b32 v32, 0
    s_nop 0
    v_cndmask_b32 v20, 0, v37, vcc
    v_cmp_eq_u32 vcc, 1, v3
    v_mov_b32 v33, 0
    s_nop 0
    v_cndmask_b32 v21, 0, v37, vcc
    v_cmp_eq_u32 vcc, 2, v3
    v_mov_b32 v34, 0
    s_nop 0
    v_cndmask_b32 v22, 0, v37, vcc
    v_cmp_eq_u32 vcc, 3, v3
    v_mov_b32 v35, 0
    s_nop 0
    v_cndmask_b32 v23, 0, v37, vcc
    v_lshlrev_b32 v2, 4, v2
    s_lshl_b32 s98, s62, 8
    s_add_u32 s98, s98, 40960
    s_lshl_b32 s99, s62, 7
    s_add_u32 s99, s99, 73728
    s_bitcmp0_b32 s57, 2
    s_cbranch_scc1 L_sf_17
    s_bitcmp0_b32 s58, 2
    s_cbranch_scc1 L_sf_17
    s_waitcnt vmcnt(1)
L_sf_17:
    buffer_load_dwordx4 v[48:51], v1, s[48:51], s97 offen offset:2048 nt
    s_bitcmp0_b32 s57, 3
    s_cbranch_scc1 L_sf_18
    s_waitcnt vmcnt(2)
    s_bitcmp0_b32 s58, 3
    s_cbranch_scc1 L_sf_18
    s_waitcnt vmcnt(1)
L_sf_18:
    buffer_load_dwordx4 v[52:55], v1, s[48:51], s97 offen offset:3072 nt
    s_add_u32 s97, s97, 32768
    v_add_u32 v1, 4096, v1
    v_and_b32 v1, 0x7fff, v1
    s_waitcnt vmcnt(3)
    s_bitcmp0_b32 s57, 4
    s_cbranch_scc1 L_sf_19
    s_waitcnt vmcnt(2)
    s_bitcmp0_b32 s58, 4
    s_cbranch_scc1 L_sf_19
    s_waitcnt vmcnt(1)
L_sf_19:
    buffer_load_dwordx4 v[56:59], v1, s[48:51], s97 offen offset:0 nt
    s_waitcnt vmcnt(3)
    s_bitcmp0_b32 s57, 5
    s_cbranch_scc1 L_sf_20
    s_waitcnt vmcnt(2)
    s_bitcmp0_b32 s58, 5
    s_cbranch_scc1 L_sf_20
    s_waitcnt vmcnt(1)
L_sf_20:
    buffer_load_dwordx4 v[60:63], v1, s[48:51], s97 offen offset:1024 nt
    s_waitcnt vmcnt(3)
    s_bitcmp0_b32 s57, 6
    s_cbranch_scc1 L_sf_21
    s_waitcnt vmcnt(2)
    s_bitcmp0_b32 s58, 6
    s_cbranch_scc1 L_sf_21
    s_waitcnt vmcnt(1)
L_sf_21:
    buffer_load_dwordx4 v[64:67], v1, s[48:51], s97 offen offset:2048 nt
    s_waitcnt vmcnt(3)
    s_bitcmp0_b32 s57, 7
    s_cbranch_scc1 L_sf_22
    s_waitcnt vmcnt(2)
    s_bitcmp0_b32 s58, 7
    s_cbranch_scc1 L_sf_22
    s_waitcnt vmcnt(1)
L_sf_22:
    buffer_load_dwordx4 v[68:71], v1, s[48:51], s97 offen offset:3072 nt
    s_add_u32 s97, s97, 32768
    v_add_u32 v1, 4096, v1
    v_and_b32 v1, 0x7fff, v1
    s_waitcnt vmcnt(3)
    s_bitcmp0_b32 s57, 8
    s_cbranch_scc1 L_sf_23
    s_waitcnt vmcnt(2)
    s_bitcmp0_b32 s58, 8
    s_cbranch_scc1 L_sf_23
    s_waitcnt vmcnt(1)
L_sf_23:
    buffer_load_dwordx4 v[72:75], v1, s[48:51], s97 offen offset:0 nt
    s_waitcnt vmcnt(3)
    s_bitcmp0_b32 s57, 9
    s_cbranch_scc1 L_sf_24
    s_waitcnt vmcnt(2)
    s_bitcmp0_b32 s58, 9
    s_cbranch_scc1 L_sf_24
    s_waitcnt vmcnt(1)
L_sf_24:
    buffer_load_dwordx4 v[76:79], v1, s[48:51], s97 offen offset:1024 nt
    s_waitcnt vmcnt(3)
    s_bitcmp0_b32 s57, 10
    s_cbranch_scc1 L_sf_25
    s_waitcnt vmcnt(2)
    s_bitcmp0_b32 s58, 10
    s_cbranch_scc1 L_sf_25
    s_waitcnt vmcnt(1)
L_sf_25:
    buffer_load_dwordx4 v[80:83], v1, s[48:51], s97 offen offset:2048 nt
    s_waitcnt vmcnt(3)
    s_bitcmp0_b32 s57, 11
    s_cbranch_scc1 L_sf_26
    s_waitcnt vmcnt(2)
    s_bitcmp0_b32 s58, 11
    s_cbranch_scc1 L_sf_26
    s_waitcnt vmcnt(1)
L_sf_26:
    buffer_load_dwordx4 v[84:87], v1, s[48:51], s97 offen offset:3072 nt
    s_add_u32 s97, s97, 32768
    v_add_u32 v1, 4096, v1
    v_and_b32 v1, 0x7fff, v1
    s_waitcnt vmcnt(3)
    s_bitcmp0_b32 s57, 12
    s_cbranch_scc1 L_sf_27
    s_waitcnt vmcnt(2)
    s_bitcmp0_b32 s58, 12
    s_cbranch_scc1 L_sf_27
    s_waitcnt vmcnt(1)
L_sf_27:
    buffer_load_dwordx4 v[88:91], v1, s[48:51], s97 offen offset:0 nt
    s_waitcnt vmcnt(3)
    s_bitcmp0_b32 s57, 13
    s_cbranch_scc1 L_sf_28
    s_waitcnt vmcnt(2)
    s_bitcmp0_b32 s58, 13
    s_cbranch_scc1 L_sf_28
    s_waitcnt vmcnt(1)
L_sf_28:
    buffer_load_dwordx4 v[92:95], v1, s[48:51], s97 offen offset:1024 nt
    s_waitcnt vmcnt(3)
    s_bitcmp0_b32 s57, 14
    s_cbranch_scc1 L_sf_29
    s_waitcnt vmcnt(2)
    s_bitcmp0_b32 s58, 14
    s_cbranch_scc1 L_sf_29
    s_waitcnt vmcnt(1)
L_sf_29:
    buffer_load_dwordx4 v[96:99], v1, s[48:51], s97 offen offset:2048 nt
    s_waitcnt vmcnt(3)
    s_bitcmp0_b32 s57, 15
    s_cbranch_scc1 L_sf_30
    s_waitcnt vmcnt(2)
    s_bitcmp0_b32 s58, 15
    s_cbranch_scc1 L_sf_30
    s_waitcnt vmcnt(1)
L_sf_30:
    buffer_load_dwordx4 v[100:103], v1, s[48:51], s97 offen offset:3072 nt
    s_add_u32 s97, s97, 32768
    v_add_u32 v1, 4096, v1
    v_and_b32 v1, 0x7fff, v1
    s_waitcnt vmcnt(3)
    s_bitcmp0_b32 s57, 16
    s_cbranch_scc1 L_sf_31
    s_waitcnt vmcnt(2)
    s_bitcmp0_b32 s58, 16
    s_cbranch_scc1 L_sf_31
    s_waitcnt vmcnt(1)
L_sf_31:
    buffer_load_dwordx4 v[104:107], v1, s[48:51], s97 offen offset:0 nt
    s_waitcnt vmcnt(3)
    s_bitcmp0_b32 s57, 17
    s_cbranch_scc1 L_sf_32
    s_waitcnt vmcnt(2)
    s_bitcmp0_b32 s58, 17
    s_cbranch_scc1 L_sf_32
    s_waitcnt vmcnt(1)
L_sf_32:
    buffer_load_dwordx4 v[108:111], v1, s[48:51], s97 offen offset:1024 nt
    s_waitcnt vmcnt(3)
    s_bitcmp0_b32 s57, 18
    s_cbranch_scc1 L_sf_33
    s_waitcnt vmcnt(2)
    s_bitcmp0_b32 s58, 18
    s_cbranch_scc1 L_sf_33
    s_waitcnt vmcnt(1)
L_sf_33:
    buffer_load_dwordx4 v[112:115], v1, s[48:51], s97 offen offset:2048 nt
    s_waitcnt vmcnt(3)
    s_bitcmp0_b32 s57, 19
    s_cbranch_scc1 L_sf_34
    s_waitcnt vmcnt(2)
    s_bitcmp0_b32 s58, 19
    s_cbranch_scc1 L_sf_34
    s_waitcnt vmcnt(1)
L_sf_34:
    buffer_load_dwordx4 v[116:119], v1, s[48:51], s97 offen offset:3072 nt
    s_add_u32 s97, s97, 32768
    v_add_u32 v1, 4096, v1
    v_and_b32 v1, 0x7fff, v1
    s_waitcnt vmcnt(3)
    s_bitcmp0_b32 s57, 20
    s_cbranch_scc1 L_sf_35
    s_waitcnt vmcnt(2)
    s_bitcmp0_b32 s58, 20
    s_cbranch_scc1 L_sf_35
    s_waitcnt vmcnt(1)
L_sf_35:
    buffer_load_dwordx4 v[120:123], v1, s[48:51], s97 offen offset:0 nt
    s_waitcnt vmcnt(3)
    s_bitcmp0_b32 s57, 21
    s_cbranch_scc1 L_sf_36
    s_waitcnt vmcnt(2)
    s_bitcmp0_b32 s58, 21
    s_cbranch_scc1 L_sf_36
    s_waitcnt vmcnt(1)
L_sf_36:
    buffer_load_dwordx4 v[124:127], v1, s[48:51], s97 offen offset:1024 nt
    s_cmp_eq_u32 s12, -1
    s_cbranch_scc1 L_k_nopf
    s_waitcnt vmcnt(3)
    s_bitcmp0_b32 s57, 22
    s_cbranch_scc1 L_sf_37
    s_waitcnt vmcnt(2)
    s_bitcmp0_b32 s58, 22
    s_cbranch_scc1 L_sf_37
    s_waitcnt vmcnt(1)
L_sf_37:
    buffer_load_dwordx4 v[128:131], v1, s[48:51], s97 offen offset:2048 nt
    s_waitcnt vmcnt(3)
    s_bitcmp0_b32 s57, 23
    s_cbranch_scc1 L_sf_38
    s_waitcnt vmcnt(2)
    s_bitcmp0_b32 s58, 23
    s_cbranch_scc1 L_sf_38
    s_waitcnt vmcnt(1)
L_sf_38:
    buffer_load_dwordx4 v[132:135], v1, s[48:51], s97 offen offset:3072 nt
    s_add_u32 s97, s97, 32768
    v_add_u32 v1, 4096, v1
    v_and_b32 v1, 0x7fff, v1
    s_waitcnt vmcnt(3)
    s_bitcmp0_b32 s57, 24
    s_cbranch_scc1 L_sf_39
    s_waitcnt vmcnt(2)
    s_bitcmp0_b32 s58, 24
    s_cbranch_scc1 L_sf_39
    s_waitcnt vmcnt(1)
L_sf_39:
    buffer_load_dwordx4 v[136:139], v1, s[48:51], s97 offen offset:0 nt
    s_waitcnt vmcnt(3)
    s_bitcmp0_b32 s57, 25
    s_cbranch_scc1 L_sf_40
    s_waitcnt vmcnt(2)
    s_bitcmp0_b32 s58, 25
    s_cbranch_scc1 L_sf_40
    s_waitcnt vmcnt(1)
L_sf_40:
    buffer_load_dwordx4 v[140:143], v1, s[48:51], s97 offen offset:1024 nt
    s_waitcnt vmcnt(3)
    s_bitcmp0_b32 s57, 26
    s_cbranch_scc1 L_sf_41
    s_waitcnt vmcnt(2)
    s_bitcmp0_b32 s58, 26
    s_cbranch_scc1 L_sf_41
    s_waitcnt vmcnt(1)
L_sf_41:
    buffer_load_dwordx4 v[144:147], v1, s[48:51], s97 offen offset:2048 nt
    s_waitcnt vmcnt(3)
    s_bitcmp0_b32 s57, 27
    s_cbranch_scc1 L_sf_42
    s_waitcnt vmcnt(2)
    s_bitcmp0_b32 s58, 27
    s_cbranch_scc1 L_sf_42
    s_waitcnt vmcnt(1)
L_sf_42:
    buffer_load_dwordx4 v[148:151], v1, s[48:51], s97 offen offset:3072 nt
    s_add_u32 s97, s97, 32768
    v_add_u32 v1, 4096, v1
    v_and_b32 v1, 0x7fff, v1
    s_waitcnt vmcnt(3)
    s_bitcmp0_b32 s57, 28
    s_cbranch_scc1 L_sf_43
    s_waitcnt vmcnt(2)
    s_bitcmp0_b32 s58, 28
    s_cbranch_scc1 L_sf_43
    s_waitcnt vmcnt(1)
L_sf_43:
    buffer_load_dwordx4 v[152:155], v1, s[48:51], s97 offen offset:0 nt
    s_waitcnt vmcnt(3)
    s_bitcmp0_b32 s57, 29
    s_cbranch_scc1 L_sf_44
    s_waitcnt vmcnt(2)
    s_bitcmp0_b32 s58, 29
    s_cbranch_scc1 L_sf_44
    s_waitcnt vmcnt(1)
L_sf_44:
    buffer_load_dwordx4 v[156:159], v1, s[48:51], s97 offen offset:1024 nt
    s_waitcnt vmcnt(3)
    s_bitcmp0_b32 s57, 30
    s_cbranch_scc1 L_sf_45
    s_waitcnt vmcnt(2)
    s_bitcmp0_b32 s58, 30
    s_cbranch_scc1 L_sf_45
    s_waitcnt vmcnt(1)
L_sf_45:
    buffer_load_dwordx4 v[160:163], v1, s[48:51], s97 offen offset:2048 nt
    v_min_u32 v39, 29, v0
    v_lshlrev_b32 v39, 2, v39
    buffer_load_dword v37, v39, s[44:47], 0 offen sc1
    s_waitcnt vmcnt(4)
    s_bitcmp0_b32 s57, 31
    s_cbranch_scc1 L_sf_46
    s_waitcnt vmcnt(3)
    s_bitcmp0_b32 s58, 31
    s_cbranch_scc1 L_sf_46
    s_waitcnt vmcnt(2)
L_sf_46:
    buffer_load_dwordx4 v[164:167], v1, s[48:51], s97 offen offset:3072 nt
    s_mov_b32 s97, 0
    v_add_u32 v1, 4096, v1
    v_and_b32 v1, 0x7fff, v1
    s_waitcnt vmcnt(4)
    s_bitcmp0_b32 s14, 0
    s_cbranch_scc1 L_sf_47
    s_waitcnt vmcnt(3)
    s_bitcmp0_b32 s15, 0
    s_cbranch_scc1 L_sf_47
    s_waitcnt vmcnt(2)
L_sf_47:
    s_add_u32 m0, s12, 0
    s_nop 0
    buffer_load_dwordx4 v1, s[52:55], s97 offen offset:0 nt lds
    s_waitcnt vmcnt(4)
    s_bitcmp0_b32 s14, 1
    s_cbranch_scc1 L_sf_48
    s_waitcnt vmcnt(3)
    s_bitcmp0_b32 s15, 1
    s_cbranch_scc1 L_sf_48
    s_waitcnt vmcnt(1)
L_sf_48:
    buffer_load_dwordx4 v1, s[52:55], s97 offen offset:1024 nt lds
    s_waitcnt vmcnt(4)
    s_bitcmp0_b32 s14, 2
    s_cbranch_scc1 L_sf_49
    s_waitcnt vmcnt(2)
    s_bitcmp0_b32 s15, 2
    s_cbranch_scc1 L_sf_49
    s_waitcnt vmcnt(1)
L_sf_49:
    buffer_load_dwordx4 v1, s[52:55], s97 offen offset:2048 nt lds
    s_waitcnt vmcnt(3)
    s_bitcmp0_b32 s14, 3
    s_cbranch_scc1 L_sf_50
    s_waitcnt vmcnt(2)
    s_bitcmp0_b32 s15, 3
    s_cbranch_scc1 L_sf_50
    s_waitcnt vmcnt(1)
L_sf_50:
    buffer_load_dwordx4 v1, s[52:55], s97 offen offset:3072 nt lds
    s_add_u32 s97, s97, 32768
    v_add_u32 v1, 4096, v1
    v_and_b32 v1, 0x7fff, v1
    v_cmp_eq_u32 vcc, 0, v37
    s_nop 0
    s_or_b32 s96, vcc_lo, vcc_hi
    buffer_load_dwordx4 v[4:7], v2, s[40:43], s98 offen sc1
    s_waitcnt vmcnt(4)
    s_bitcmp0_b32 s14, 4
    s_cbranch_scc1 L_sf_51
    s_waitcnt vmcnt(3)
    s_bitcmp0_b32 s15, 4
    s_cbranch_scc1 L_sf_51
    s_waitcnt vmcnt(2)
L_sf_51:
    s_add_u32 m0, s12, 4096
    s_nop 0
    buffer_load_dwordx4 v1, s[52:55], s97 offen offset:0 nt lds
    s_waitcnt vmcnt(4)
    s_bitcmp0_b32 s14, 5
    s_cbranch_scc1 L_sf_52
    s_waitcnt vmcnt(3)
    s_bitcmp0_b32 s15, 5
    s_cbranch_scc1 L_sf_52
    s_waitcnt vmcnt(2)
L_sf_52:
    buffer_load_dwordx4 v1, s[52:55], s97 offen offset:1024 nt lds
    s_waitcnt vmcnt(4)
    s_bitcmp0_b32 s14, 6
    s_cbranch_scc1 L_sf_53
    s_waitcnt vmcnt(3)
    s_bitcmp0_b32 s15, 6
    s_cbranch_scc1 L_sf_53
    s_waitcnt vmcnt(1)
L_sf_53:
    buffer_load_dwordx4 v1, s[52:55], s97 offen offset:2048 nt lds
    s_waitcnt vmcnt(4)
    s_bitcmp0_b32 s14, 7
    s_cbranch_scc1 L_sf_54
    s_waitcnt vmcnt(2)
    s_bitcmp0_b32 s15, 7
    s_cbranch_scc1 L_sf_54
    s_waitcnt vmcnt(1)
L_sf_54:
    buffer_load_dwordx4 v1, s[52:55], s97 offen offset:3072 nt lds
    s_add_u32 s97, s97, 32768
    v_add_u32 v1, 4096, v1
    v_and_b32 v1, 0x7fff, v1
L_k_join:
    s_waitcnt vmcnt(4)
    v_max3_u32 v38, v4, v5, v6
    v_max_u32 v38, v38, v7
    v_cmp_eq_u32 vcc, -1, v38
    s_cmp_lg_u32 s96, 0
    s_cbranch_scc1 L_qslow
    s_cbranch_vccnz L_qslow2
L_qok:
    v_dot2_f32_bf16 v8, v72, v4, 0
    v_dot2_f32_bf16 v9, v76, v4, 0
    v_dot2_f32_bf16 v10, v80, v4, 0
    v_dot2_f32_bf16 v11, v84, v4, 0
    v_dot2_f32_bf16 v24, v88, v4, 0
    v_dot2_f32_bf16 v25, v92, v4, 0
    v_dot2_f32_bf16 v26, v96, v4, 0
    v_dot2_f32_bf16 v27, v100, v4, 0
    v_dot2_f32_bf16 v8, v73, v5, v8
    v_dot2_f32_bf16 v9, v77, v5, v9
    v_dot2_f32_bf16 v10, v81, v5, v10
    v_dot2_f32_bf16 v11, v85, v5, v11
    v_dot2_f32_bf16 v24, v89, v5, v24
    v_dot2_f32_bf16 v25, v93, v5, v25
    v_dot2_f32_bf16 v26, v97, v5, v26
    v_dot2_f32_bf16 v27, v101, v5, v27
    v_dot2_f32_bf16 v8, v74, v6, v8
    v_dot2_f32_bf16 v9, v78, v6, v9
    v_dot2_f32_bf16 v10, v82, v6, v10
    v_dot2_f32_bf16 v11, v86, v6, v11
    v_dot2_f32_bf16 v24, v90, v6, v24
    v_dot2_f32_bf16 v25, v94, v6, v25
    v_dot2_f32_bf16 v26, v98, v6, v26
    v_dot2_f32_bf16 v27, v102, v6, v27
    v_dot2_f32_bf16 v8, v75, v7, v8
    v_dot2_f32_bf16 v9, v79, v7, v9
    v_dot2_f32_bf16 v10, v83, v7, v10
    v_dot2_f32_bf16 v11, v87, v7, v11
    v_dot2_f32_bf16 v24, v91, v7, v24
    v_dot2_f32_bf16 v25, v95, v7, v25
    v_dot2_f32_bf16 v26, v99, v7, v26
    v_dot2_f32_bf16 v27, v103, v7, v27
    v_add_f32_dpp v8, v8, v8 row_ror:8 row_mask:0xf bank_mask:0x3
    v_add_f32_dpp v10, v10, v10 row_ror:8 row_mask:0xf bank_mask:0x3
    v_add_f32_dpp v24, v24, v24 row_ror:8 row_mask:0xf bank_mask:0x3
    v_add_f32_dpp v26, v26, v26 row_ror:8 row_mask:0xf bank_mask:0x3
    v_add_f32_dpp v8, v9, v9 row_ror:8 row_mask:0xf bank_mask:0xc
    v_add_f32_dpp v10, v11, v11 row_ror:8 row_mask:0xf bank_mask:0xc
    v_add_f32_dpp v24, v25, v25 row_ror:8 row_mask:0xf bank_mask:0xc
    v_add_f32_dpp v26, v27, v27 row_ror:8 row_mask:0xf bank_mask:0xc
    v_add_f32_dpp v14, v8, v8 row_half_mirror row_mask:0xf bank_mask:0x5
    v_add_f32_dpp v15, v24, v24 row_half_mirror row_mask:0xf bank_mask:0x5
    v_add_f32_dpp v14, v10, v10 row_half_mirror row_mask:0xf bank_mask:0xa
    v_add_f32_dpp v15, v26, v26 row_half_mirror row_mask:0xf bank_mask:0xa
    s_nop 0
    v_add_f32_dpp v14, v14, v14 quad_perm:[1,0,3,2] row_mask:0xf bank_mask:0xf
    v_add_f32_dpp v15, v15, v15 quad_perm:[1,0,3,2] row_mask:0xf bank_mask:0xf
    s_nop 0
    v_add_f32_dpp v14, v14, v14 quad_perm:[2,3,0,1] row_mask:0xf bank_mask:0xf
    v_add_f32_dpp v15, v15, v15 quad_perm:[2,3,0,1] row_mask:0xf bank_mask:0xf
    s_waitcnt vmcnt(3)
    s_bitcmp0_b32 s14, 8
    s_cbranch_scc1 L_sf_65
    s_waitcnt vmcnt(2)
    s_bitcmp0_b32 s15, 8
    s_cbranch_scc1 L_sf_65
    s_waitcnt vmcnt(1)
L_sf_65:
    buffer_load_dwordx4 v[72:75], v1, s[52:55], s97 offen offset:0 nt
    v_dot2_f32_bf16 v8, v40, v4, 0
    v_dot2_f32_bf16 v9, v44, v4, 0
    v_dot2_f32_bf16 v10, v48, v4, 0
    v_dot2_f32_bf16 v11, v52, v4, 0
    v_dot2_f32_bf16 v24, v56, v4, 0
    v_dot2_f32_bf16 v25, v60, v4, 0
    v_dot2_f32_bf16 v26, v64, v4, 0
    v_dot2_f32_bf16 v27, v68, v4, 0
    v_dot2_f32_bf16 v28, v104, v4, 0
    v_dot2_f32_bf16 v29, v108, v4, 0
    v_dot2_f32_bf16 v30, v112, v4, 0
    v_dot2_f32_bf16 v31, v116, v4, 0
    v_dot2_f32_bf16 v8, v41, v5, v8
    v_dot2_f32_bf16 v9, v45, v5, v9
    v_dot2_f32_bf16 v10, v49, v5, v10
    v_dot2_f32_bf16 v11, v53, v5, v11
    v_dot2_f32_bf16 v24, v57, v5, v24
    v_dot2_f32_bf16 v25, v61, v5, v25
    v_dot2_f32_bf16 v26, v65, v5, v26
    v_dot2_f32_bf16 v27, v69, v5, v27
    v_dot2_f32_bf16 v28, v105, v5, v28
    v_dot2_f32_bf16 v29, v109, v5, v29
    v_dot2_f32_bf16 v30, v113, v5, v30
    v_dot2_f32_bf16 v31, v117, v5, v31
    v_dot2_f32_bf16 v8, v42, v6, v8
    v_dot2_f32_bf16 v9, v46, v6, v9
    v_dot2_f32_bf16 v10, v50, v6, v10
    v_dot2_f32_bf16 v11, v54, v6, v11
    v_dot2_f32_bf16 v24, v58, v6, v24
    v_dot2_f32_bf16 v25, v62, v6, v25
    v_dot2_f32_bf16 v26, v66, v6, v26
    v_dot2_f32_bf16 v27, v70, v6, v27
    v_dot2_f32_bf16 v28, v106, v6, v28
    v_dot2_f32_bf16 v29, v110, v6, v29
    v_dot2_f32_bf16 v30, v114, v6, v30
    v_dot2_f32_bf16 v31, v118, v6, v31
    v_dot2_f32_bf16 v8, v43, v7, v8
    v_dot2_f32_bf16 v9, v47, v7, v9
    v_dot2_f32_bf16 v10, v51, v7, v10
    v_dot2_f32_bf16 v11, v55, v7, v11
    v_dot2_f32_bf16 v24, v59, v7, v24
    v_dot2_f32_bf16 v25, v63, v7, v25
    v_dot2_f32_bf16 v26, v67, v7, v26
    v_dot2_f32_bf16 v27, v71, v7, v27
    v_dot2_f32_bf16 v28, v107, v7, v28
    v_dot2_f32_bf16 v29, v111, v7, v29
    v_dot2_f32_bf16 v30, v115, v7, v30
    v_dot2_f32_bf16 v31, v119, v7, v31
    v_add_f32_dpp v8, v8, v8 row_ror:8 row_mask:0xf bank_mask:0x3
    v_add_f32_dpp v10, v10, v10 row_ror:8 row_mask:0xf bank_mask:0x3
    v_add_f32_dpp v24, v24, v24 row_ror:8 row_mask:0xf bank_mask:0x3
    v_add_f32_dpp v26, v26, v26 row_ror:8 row_mask:0xf bank_mask:0x3
    v_add_f32_dpp v28, v28, v28 row_ror:8 row_mask:0xf bank_mask:0x3
    v_add_f32_dpp v30, v30, v30 row_ror:8 row_mask:0xf bank_mask:0x3
    v_add_f32_dpp v8, v9, v9 row_ror:8 row_mask:0xf bank_mask:0xc
    v_add_f32_dpp v10, v11, v11 row_ror:8 row_mask:0xf bank_mask:0xc
    v_add_f32_dpp v24, v25, v25 row_ror:8 row_mask:0xf bank_mask:0xc
    v_add_f32_dpp v26, v27, v27 row_ror:8 row_mask:0xf bank_mask:0xc
    v_add_f32_dpp v28, v29, v29 row_ror:8 row_mask:0xf bank_mask:0xc
    v_add_f32_dpp v30, v31, v31 row_ror:8 row_mask:0xf bank_mask:0xc
    v_add_f32_dpp v12, v8, v8 row_half_mirror row_mask:0xf bank_mask:0x5
    v_add_f32_dpp v13, v24, v24 row_half_mirror row_mask:0xf bank_mask:0x5
    v_add_f32_dpp v16, v28, v28 row_half_mirror row_mask:0xf bank_mask:0x5
    v_add_f32_dpp v12, v10, v10 row_half_mirror row_mask:0xf bank_mask:0xa
    v_add_f32_dpp v13, v26, v26 row_half_mirror row_mask:0xf bank_mask:0xa
    v_add_f32_dpp v16, v30, v30 row_half_mirror row_mask:0xf bank_mask:0xa
    v_add_f32_dpp v12, v12, v12 quad_perm:[1,0,3,2] row_mask:0xf bank_mask:0xf
    v_add_f32_dpp v13, v13, v13 quad_perm:[1,0,3,2] row_mask:0xf bank_mask:0xf
    v_add_f32_dpp v16, v16, v16 quad_perm:[1,0,3,2] row_mask:0xf bank_mask:0xf
    v_add_f32_dpp v12, v12, v12 quad_perm:[2,3,0,1] row_mask:0xf bank_mask:0xf
    v_add_f32_dpp v13, v13, v13 quad_perm:[2,3,0,1] row_mask:0xf bank_mask:0xf
    v_add_f32_dpp v16, v16, v16 quad_perm:[2,3,0,1] row_mask:0xf bank_mask:0xf
    s_waitcnt vmcnt(3)
    s_bitcmp0_b32 s14, 9
    s_cbranch_scc1 L_sf_66
    s_waitcnt vmcnt(2)
    s_bitcmp0_b32 s15, 9
    s_cbranch_scc1 L_sf_66
    s_waitcnt vmcnt(1)
L_sf_66:
    buffer_load_dwordx4 v[76:79], v1, s[52:55], s97 offen offset:1024 nt
    v_dot2_f32_bf16 v8, v120, v4, 0
    v_dot2_f32_bf16 v9, v124, v4, 0
    v_dot2_f32_bf16 v10, v128, v4, 0
    v_dot2_f32_bf16 v11, v132, v4, 0
    v_dot2_f32_bf16 v24, v136, v4, 0
    v_dot2_f32_bf16 v25, v140, v4, 0
    v_dot2_f32_bf16 v26, v144, v4, 0
    v_dot2_f32_bf16 v27, v148, v4, 0
    v_dot2_f32_bf16 v8, v121, v5, v8
    v_dot2_f32_bf16 v9, v125, v5, v9
    v_dot2_f32_bf16 v10, v129, v5, v10
    v_dot2_f32_bf16 v11, v133, v5, v11
    v_dot2_f32_bf16 v24, v137, v5, v24
    v_dot2_f32_bf16 v25, v141, v5, v25
    v_dot2_f32_bf16 v26, v145, v5, v26
    v_dot2_f32_bf16 v27, v149, v5, v27
    v_dot2_f32_bf16 v8, v122, v6, v8
    v_dot2_f32_bf16 v9, v126, v6, v9
    v_dot2_f32_bf16 v10, v130, v6, v10
    v_dot2_f32_bf16 v11, v134, v6, v11
    v_dot2_f32_bf16 v24, v138, v6, v24
    v_dot2_f32_bf16 v25, v142, v6, v25
    v_dot2_f32_bf16 v26, v146, v6, v26
    v_dot2_f32_bf16 v27, v150, v6, v27
    v_dot2_f32_bf16 v8, v123, v7, v8
    v_dot2_f32_bf16 v9, v127, v7, v9
    v_dot2_f32_bf16 v10, v131, v7, v10
    v_dot2_f32_bf16 v11, v135, v7, v11
    v_dot2_f32_bf16 v24, v139, v7, v24
    v_dot2_f32_bf16 v25, v143, v7, v25
    v_dot2_f32_bf16 v26, v147, v7, v26
    v_dot2_f32_bf16 v27, v151, v7, v27
    v_add_f32_dpp v8, v8, v8 row_ror:8 row_mask:0xf bank_mask:0x3
    v_add_f32_dpp v10, v10, v10 row_ror:8 row_mask:0xf bank_mask:0x3
    v_add_f32_dpp v24, v24, v24 row_ror:8 row_mask:0xf bank_mask:0x3
    v_add_f32_dpp v26, v26, v26 row_ror:8 row_mask:0xf bank_mask:0x3
    v_add_f32_dpp v8, v9, v9 row_ror:8 row_mask:0xf bank_mask:0xc
    v_add_f32_dpp v10, v11, v11 row_ror:8 row_mask:0xf bank_mask:0xc
    v_add_f32_dpp v24, v25, v25 row_ror:8 row_mask:0xf bank_mask:0xc
    v_add_f32_dpp v26, v27, v27 row_ror:8 row_mask:0xf bank_mask:0xc
    v_add_f32_dpp v17, v8, v8 row_half_mirror row_mask:0xf bank_mask:0x5
    v_add_f32_dpp v18, v24, v24 row_half_mirror row_mask:0xf bank_mask:0x5
    v_add_f32_dpp v17, v10, v10 row_half_mirror row_mask:0xf bank_mask:0xa
    v_add_f32_dpp v18, v26, v26 row_half_mirror row_mask:0xf bank_mask:0xa
    s_nop 0
    v_add_f32_dpp v17, v17, v17 quad_perm:[1,0,3,2] row_mask:0xf bank_mask:0xf
    v_add_f32_dpp v18, v18, v18 quad_perm:[1,0,3,2] row_mask:0xf bank_mask:0xf
    s_nop 0
    v_add_f32_dpp v17, v17, v17 quad_perm:[2,3,0,1] row_mask:0xf bank_mask:0xf
    v_add_f32_dpp v18, v18, v18 quad_perm:[2,3,0,1] row_mask:0xf bank_mask:0xf
    s_waitcnt vmcnt(3)
    s_bitcmp0_b32 s14, 10
    s_cbranch_scc1 L_sf_67
    s_waitcnt vmcnt(2)
    s_bitcmp0_b32 s15, 10
    s_cbranch_scc1 L_sf_67
    s_waitcnt vmcnt(1)
L_sf_67:
    buffer_load_dwordx4 v[80:83], v1, s[52:55], s97 offen offset:2048 nt
    s_waitcnt vmcnt(3)
    s_bitcmp0_b32 s14, 11
    s_cbranch_scc1 L_sf_68
    s_waitcnt vmcnt(2)
    s_bitcmp0_b32 s15, 11
    s_cbranch_scc1 L_sf_68
    s_waitcnt vmcnt(1)
L_sf_68:
    buffer_load_dwordx4 v[84:87], v1, s[52:55], s97 offen offset:3072 nt
    s_add_u32 s97, s97, 32768
    v_add_u32 v1, 4096, v1
    v_and_b32 v1, 0x7fff, v1
    s_cmp_eq_u32 s12, -1
    s_cbranch_scc1 L_nopfrd
    v_lshl_add_u32 v38, v0, 4, s12
    ds_read_b128 v[40:43], v38 offset:0
    ds_read_b128 v[44:47], v38 offset:1024
    ds_read_b128 v[48:51], v38 offset:2048
    ds_read_b128 v[52:55], v38 offset:3072
    ds_read_b128 v[56:59], v38 offset:4096
    ds_read_b128 v[60:63], v38 offset:5120
    ds_read_b128 v[64:67], v38 offset:6144
    ds_read_b128 v[68:71], v38 offset:7168
L_nopfrd:
    v_dot2_f32_bf16 v8, v152, v4, 0
    v_dot2_f32_bf16 v9, v156, v4, 0
    v_dot2_f32_bf16 v10, v160, v4, 0
    v_dot2_f32_bf16 v11, v164, v4, 0
    v_dot2_f32_bf16 v8, v153, v5, v8
    v_dot2_f32_bf16 v9, v157, v5, v9
    v_dot2_f32_bf16 v10, v161, v5, v10
    v_dot2_f32_bf16 v11, v165, v5, v11
    v_dot2_f32_bf16 v8, v154, v6, v8
    v_dot2_f32_bf16 v9, v158, v6, v9
    v_dot2_f32_bf16 v10, v162, v6, v10
    v_dot2_f32_bf16 v11, v166, v6, v11
    v_dot2_f32_bf16 v8, v155, v7, v8
    v_dot2_f32_bf16 v9, v159, v7, v9
    v_dot2_f32_bf16 v10, v163, v7, v10
    v_dot2_f32_bf16 v11, v167, v7, v11
    v_add_f32_dpp v8, v8, v8 row_ror:8 row_mask:0xf bank_mask:0x3
    s_nop 0
    v_add_f32_dpp v10, v10, v10 row_ror:8 row_mask:0xf bank_mask:0x3
    v_add_f32_dpp v8, v9, v9 row_ror:8 row_mask:0xf bank_mask:0xc
    v_add_f32_dpp v10, v11, v11 row_ror:8 row_mask:0xf bank_mask:0xc
    s_nop 0
    v_add_f32_dpp v19, v8, v8 row_half_mirror row_mask:0xf bank_mask:0x5
    v_add_f32_dpp v19, v10, v10 row_half_mirror row_mask:0xf bank_mask:0xa
    s_nop 1
    v_add_f32_dpp v19, v19, v19 quad_perm:[1,0,3,2] row_mask:0xf bank_mask:0xf
    s_nop 1
    v_add_f32_dpp v19, v19, v19 quad_perm:[2,3,0,1] row_mask:0xf bank_mask:0xf
    v_max3_f32 v3, v12, v13, v14
    v_max3_f32 v8, v15, v16, v17
    v_max3_f32 v3, v3, v18, v19
    v_max_f32 v3, v3, v8
    s_nop 1
    v_max_f32_dpp v3, v3, v3 row_ror:4 row_mask:0xf bank_mask:0xf
    s_nop 1
    v_max_f32_dpp v3, v3, v3 row_ror:8 row_mask:0xf bank_mask:0xf
    v_mov_b32 v8, v3
    s_nop 1
    v_permlane16_swap_b32 v3, v8
    v_max_f32 v3, v3, v8
    v_mov_b32 v8, v3
    s_nop 1
    v_permlane32_swap_b32 v3, v8
    v_max_f32 v3, v3, v8
    s_mov_b32 s96, 0x3e0293ee
    v_mul_f32 v8, s96, v3
    v_fma_f32 v12, v12, s96, -v8
    v_fma_f32 v13, v13, s96, -v8
    v_fma_f32 v14, v14, s96, -v8
    v_fma_f32 v15, v15, s96, -v8
    v_fma_f32 v16, v16, s96, -v8
    v_fma_f32 v17, v17, s96, -v8
    v_fma_f32 v18, v18, s96, -v8
    v_fma_f32 v19, v19, s96, -v8
    v_exp_f32 v12, v12
    v_exp_f32 v13, v13
    v_exp_f32 v14, v14
    v_exp_f32 v15, v15
    v_exp_f32 v16, v16
    v_exp_f32 v17, v17
    v_exp_f32 v18, v18
    v_exp_f32 v19, v19
    v_add_f32 v9, v12, v13
    v_add_f32 v10, v14, v15
    v_add_f32 v11, v16, v17
    v_add_f32 v3, v18, v19
    v_add_f32 v9, v9, v10
    v_add_f32 v3, v3, v11
    v_add_f32 v9, v9, v3
    v_cvt_pk_bf16_f32 v12, v12, v12
    v_cvt_pk_bf16_f32 v13, v13, v13
    v_cvt_pk_bf16_f32 v14, v14, v14
    v_cvt_pk_bf16_f32 v15, v15, v15
    v_cvt_pk_bf16_f32 v16, v16, v16
    v_cvt_pk_bf16_f32 v17, v17, v17
    v_cvt_pk_bf16_f32 v18, v18, v18
    v_cvt_pk_bf16_f32 v19, v19, v19
    v_add_f32_dpp v9, v9, v9 row_ror:4 row_mask:0xf bank_mask:0xf
    s_nop 1
    v_add_f32_dpp v9, v9, v9 row_ror:8 row_mask:0xf bank_mask:0xf
    v_mov_b32 v10, v9
    s_nop 1
    v_permlane16_swap_b32 v9, v10
    v_add_f32 v9, v9, v10
    v_mov_b32 v10, v9
    s_nop 1
    v_permlane32_swap_b32 v9, v10
    v_add_f32 v9, v9, v10
    s_mov_b64 exec, 1
    s_cmp_lg_u32 s13, 0
    s_cbranch_scc1 L_mljob
    s_lshl_b32 s96, s3, 3
    s_add_u32 s96, s96, 161920
    v_mov_b32 v10, s96
    v_mov_b32 v11, 162068
    v_mov_b32 v3, 1
    ds_write_b64 v10, v[8:9]
    ds_add_u32 v11, v3
L_mldone:
    s_mov_b64 exec, -1
    v_lshrrev_b32 v2, 1, v2
    v_and_b32_dpp v24, v14, v20 row_newbcast:0 row_mask:0xf bank_mask:0xf
    v_and_b32_dpp v25, v14, v21 row_newbcast:0 row_mask:0xf bank_mask:0xf
    v_and_b32_dpp v26, v14, v22 row_newbcast:0 row_mask:0xf bank_mask:0xf
    v_and_b32_dpp v27, v14, v23 row_newbcast:0 row_mask:0xf bank_mask:0xf
    s_waitcnt vmcnt(3)
    s_bitcmp0_b32 s14, 12
    s_cbranch_scc1 L_sf_69
    s_waitcnt vmcnt(2)
    s_bitcmp0_b32 s15, 12
    s_cbranch_scc1 L_sf_69
    s_waitcnt vmcnt(1)
L_sf_69:
    buffer_load_dwordx4 v[88:91], v1, s[52:55], s97 offen offset:0 nt
    v_mfma_f32_16x16x32_bf16 v[32:35], v[24:27], v[72:75], v[32:35]
    s_cmp_eq_u32 s12, -1
    s_cbranch_scc1 L_nopfpv8
    s_waitcnt lgkmcnt(0)
    v_and_b32_dpp v24, v12, v20 row_newbcast:0 row_mask:0xf bank_mask:0xf
    v_and_b32_dpp v25, v12, v21 row_newbcast:0 row_mask:0xf bank_mask:0xf
    v_and_b32_dpp v26, v12, v22 row_newbcast:0 row_mask:0xf bank_mask:0xf
    v_and_b32_dpp v27, v12, v23 row_newbcast:0 row_mask:0xf bank_mask:0xf
    s_nop 1
    v_mfma_f32_16x16x32_bf16 v[32:35], v[24:27], v[40:43], v[32:35]
    v_and_b32_dpp v28, v12, v20 row_newbcast:8 row_mask:0xf bank_mask:0xf
    v_and_b32_dpp v29, v12, v21 row_newbcast:8 row_mask:0xf bank_mask:0xf
    v_and_b32_dpp v30, v12, v22 row_newbcast:8 row_mask:0xf bank_mask:0xf
    v_and_b32_dpp v31, v12, v23 row_newbcast:8 row_mask:0xf bank_mask:0xf
    s_nop 1
    v_mfma_f32_16x16x32_bf16 v[32:35], v[28:31], v[44:47], v[32:35]
    v_and_b32_dpp v24, v12, v20 row_newbcast:4 row_mask:0xf bank_mask:0xf
    v_and_b32_dpp v25, v12, v21 row_newbcast:4 row_mask:0xf bank_mask:0xf
    v_and_b32_dpp v26, v12, v22 row_newbcast:4 row_mask:0xf bank_mask:0xf
    v_and_b32_dpp v27, v12, v23 row_newbcast:4 row_mask:0xf bank_mask:0xf
    s_nop 1
    v_mfma_f32_16x16x32_bf16 v[32:35], v[24:27], v[48:51], v[32:35]
    v_and_b32_dpp v28, v12, v20 row_newbcast:12 row_mask:0xf bank_mask:0xf
    v_and_b32_dpp v29, v12, v21 row_newbcast:12 row_mask:0xf bank_mask:0xf
    v_and_b32_dpp v30, v12, v22 row_newbcast:12 row_mask:0xf bank_mask:0xf
    v_and_b32_dpp v31, v12, v23 row_newbcast:12 row_mask:0xf bank_mask:0xf
    s_nop 1
    v_mfma_f32_16x16x32_bf16 v[32:35], v[28:31], v[52:55], v[32:35]
L_nopfpv8:
    v_and_b32_dpp v28, v14, v20 row_newbcast:8 row_mask:0xf bank_mask:0xf
    v_and_b32_dpp v29, v14, v21 row_newbcast:8 row_mask:0xf bank_mask:0xf
    v_and_b32_dpp v30, v14, v22 row_newbcast:8 row_mask:0xf bank_mask:0xf
    v_and_b32_dpp v31, v14, v23 row_newbcast:8 row_mask:0xf bank_mask:0xf
    s_waitcnt vmcnt(3)
    s_bitcmp0_b32 s14, 13
    s_cbranch_scc1 L_sf_70
    s_waitcnt vmcnt(2)
    s_bitcmp0_b32 s15, 13
    s_cbranch_scc1 L_sf_70
    s_waitcnt vmcnt(1)
L_sf_70:
    buffer_load_dwordx4 v[92:95], v1, s[52:55], s97 offen offset:1024 nt
    v_mfma_f32_16x16x32_bf16 v[32:35], v[28:31], v[76:79], v[32:35]
    s_cmp_eq_u32 s12, -1
    s_cbranch_scc1 L_nopfpv9
    s_waitcnt lgkmcnt(0)
    v_and_b32_dpp v24, v13, v20 row_newbcast:0 row_mask:0xf bank_mask:0xf
    v_and_b32_dpp v25, v13, v21 row_newbcast:0 row_mask:0xf bank_mask:0xf
    v_and_b32_dpp v26, v13, v22 row_newbcast:0 row_mask:0xf bank_mask:0xf
    v_and_b32_dpp v27, v13, v23 row_newbcast:0 row_mask:0xf bank_mask:0xf
    s_nop 1
    v_mfma_f32_16x16x32_bf16 v[32:35], v[24:27], v[56:59], v[32:35]
    v_and_b32_dpp v28, v13, v20 row_newbcast:8 row_mask:0xf bank_mask:0xf
    v_and_b32_dpp v29, v13, v21 row_newbcast:8 row_mask:0xf bank_mask:0xf
    v_and_b32_dpp v30, v13, v22 row_newbcast:8 row_mask:0xf bank_mask:0xf
    v_and_b32_dpp v31, v13, v23 row_newbcast:8 row_mask:0xf bank_mask:0xf
    s_nop 1
    v_mfma_f32_16x16x32_bf16 v[32:35], v[28:31], v[60:63], v[32:35]
    v_and_b32_dpp v24, v13, v20 row_newbcast:4 row_mask:0xf bank_mask:0xf
    v_and_b32_dpp v25, v13, v21 row_newbcast:4 row_mask:0xf bank_mask:0xf
    v_and_b32_dpp v26, v13, v22 row_newbcast:4 row_mask:0xf bank_mask:0xf
    v_and_b32_dpp v27, v13, v23 row_newbcast:4 row_mask:0xf bank_mask:0xf
    s_nop 1
    v_mfma_f32_16x16x32_bf16 v[32:35], v[24:27], v[64:67], v[32:35]
    v_and_b32_dpp v28, v13, v20 row_newbcast:12 row_mask:0xf bank_mask:0xf
    v_and_b32_dpp v29, v13, v21 row_newbcast:12 row_mask:0xf bank_mask:0xf
    v_and_b32_dpp v30, v13, v22 row_newbcast:12 row_mask:0xf bank_mask:0xf
    v_and_b32_dpp v31, v13, v23 row_newbcast:12 row_mask:0xf bank_mask:0xf
    s_nop 1
    v_mfma_f32_16x16x32_bf16 v[32:35], v[28:31], v[68:71], v[32:35]
L_nopfpv9:
    v_and_b32_dpp v24, v14, v20 row_newbcast:4 row_mask:0xf bank_mask:0xf
    v_and_b32_dpp v25, v14, v21 row_newbcast:4 row_mask:0xf bank_mask:0xf
    v_and_b32_dpp v26, v14, v22 row_newbcast:4 row_mask:0xf bank_mask:0xf
    v_and_b32_dpp v27, v14, v23 row_newbcast:4 row_mask:0xf bank_mask:0xf
    s_waitcnt vmcnt(3)
    s_bitcmp0_b32 s14, 14
    s_cbranch_scc1 L_sf_71
    s_waitcnt vmcnt(2)
    s_bitcmp0_b32 s15, 14
    s_cbranch_scc1 L_sf_71
    s_waitcnt vmcnt(1)
L_sf_71:
    buffer_load_dwordx4 v[96:99], v1, s[52:55], s97 offen offset:2048 nt
    v_mfma_f32_16x16x32_bf16 v[32:35], v[24:27], v[80:83], v[32:35]
    v_and_b32_dpp v28, v14, v20 row_newbcast:12 row_mask:0xf bank_mask:0xf
    v_and_b32_dpp v29, v14, v21 row_newbcast:12 row_mask:0xf bank_mask:0xf
    v_and_b32_dpp v30, v14, v22 row_newbcast:12 row_mask:0xf bank_mask:0xf
    v_and_b32_dpp v31, v14, v23 row_newbcast:12 row_mask:0xf bank_mask:0xf
    s_waitcnt vmcnt(3)
    s_bitcmp0_b32 s14, 15
    s_cbranch_scc1 L_sf_72
    s_waitcnt vmcnt(2)
    s_bitcmp0_b32 s15, 15
    s_cbranch_scc1 L_sf_72
    s_waitcnt vmcnt(1)
L_sf_72:
    buffer_load_dwordx4 v[100:103], v1, s[52:55], s97 offen offset:3072 nt
    s_add_u32 s97, s97, 32768
    v_add_u32 v1, 4096, v1
    v_and_b32 v1, 0x7fff, v1
    v_mfma_f32_16x16x32_bf16 v[32:35], v[28:31], v[84:87], v[32:35]
    v_and_b32_dpp v24, v15, v20 row_newbcast:0 row_mask:0xf bank_mask:0xf
    v_and_b32_dpp v25, v15, v21 row_newbcast:0 row_mask:0xf bank_mask:0xf
    v_and_b32_dpp v26, v15, v22 row_newbcast:0 row_mask:0xf bank_mask:0xf
    v_and_b32_dpp v27, v15, v23 row_newbcast:0 row_mask:0xf bank_mask:0xf
    s_waitcnt vmcnt(3)
    s_bitcmp0_b32 s14, 16
    s_cbranch_scc1 L_sf_73
    s_waitcnt vmcnt(2)
    s_bitcmp0_b32 s15, 16
    s_cbranch_scc1 L_sf_73
    s_waitcnt vmcnt(1)
L_sf_73:
    buffer_load_dwordx4 v[104:107], v1, s[52:55], s97 offen offset:0 nt
    v_mfma_f32_16x16x32_bf16 v[32:35], v[24:27], v[88:91], v[32:35]
    v_and_b32_dpp v28, v15, v20 row_newbcast:8 row_mask:0xf bank_mask:0xf
    v_and_b32_dpp v29, v15, v21 row_newbcast:8 row_mask:0xf bank_mask:0xf
    v_and_b32_dpp v30, v15, v22 row_newbcast:8 row_mask:0xf bank_mask:0xf
    v_and_b32_dpp v31, v15, v23 row_newbcast:8 row_mask:0xf bank_mask:0xf
    s_waitcnt vmcnt(3)
    s_bitcmp0_b32 s14, 17
    s_cbranch_scc1 L_sf_74
    s_waitcnt vmcnt(2)
    s_bitcmp0_b32 s15, 17
    s_cbranch_scc1 L_sf_74
    s_waitcnt vmcnt(1)
L_sf_74:
    buffer_load_dwordx4 v[108:111], v1, s[52:55], s97 offen offset:1024 nt
    v_mfma_f32_16x16x32_bf16 v[32:35], v[28:31], v[92:95], v[32:35]
    v_and_b32_dpp v24, v15, v20 row_newbcast:4 row_mask:0xf bank_mask:0xf
    v_and_b32_dpp v25, v15, v21 row_newbcast:4 row_mask:0xf bank_mask:0xf
    v_and_b32_dpp v26, v15, v22 row_newbcast:4 row_mask:0xf bank_mask:0xf
    v_and_b32_dpp v27, v15, v23 row_newbcast:4 row_mask:0xf bank_mask:0xf
    s_waitcnt vmcnt(3)
    s_bitcmp0_b32 s14, 18
    s_cbranch_scc1 L_sf_75
    s_waitcnt vmcnt(2)
    s_bitcmp0_b32 s15, 18
    s_cbranch_scc1 L_sf_75
    s_waitcnt vmcnt(1)
L_sf_75:
    buffer_load_dwordx4 v[112:115], v1, s[52:55], s97 offen offset:2048 nt
    v_mfma_f32_16x16x32_bf16 v[32:35], v[24:27], v[96:99], v[32:35]
    v_and_b32_dpp v28, v15, v20 row_newbcast:12 row_mask:0xf bank_mask:0xf
    v_and_b32_dpp v29, v15, v21 row_newbcast:12 row_mask:0xf bank_mask:0xf
    v_and_b32_dpp v30, v15, v22 row_newbcast:12 row_mask:0xf bank_mask:0xf
    v_and_b32_dpp v31, v15, v23 row_newbcast:12 row_mask:0xf bank_mask:0xf
    s_waitcnt vmcnt(3)
    s_bitcmp0_b32 s14, 19
    s_cbranch_scc1 L_sf_76
    s_waitcnt vmcnt(2)
    s_bitcmp0_b32 s15, 19
    s_cbranch_scc1 L_sf_76
    s_waitcnt vmcnt(1)
L_sf_76:
    buffer_load_dwordx4 v[116:119], v1, s[52:55], s97 offen offset:3072 nt
    s_add_u32 s97, s97, 32768
    v_add_u32 v1, 4096, v1
    v_and_b32 v1, 0x7fff, v1
    v_mfma_f32_16x16x32_bf16 v[32:35], v[28:31], v[100:103], v[32:35]
    v_and_b32_dpp v24, v16, v20 row_newbcast:0 row_mask:0xf bank_mask:0xf
    v_and_b32_dpp v25, v16, v21 row_newbcast:0 row_mask:0xf bank_mask:0xf
    v_and_b32_dpp v26, v16, v22 row_newbcast:0 row_mask:0xf bank_mask:0xf
    v_and_b32_dpp v27, v16, v23 row_newbcast:0 row_mask:0xf bank_mask:0xf
    s_waitcnt vmcnt(3)
    s_bitcmp0_b32 s14, 20
    s_cbranch_scc1 L_sf_77
    s_waitcnt vmcnt(2)
    s_bitcmp0_b32 s15, 20
    s_cbranch_scc1 L_sf_77
    s_waitcnt vmcnt(1)
L_sf_77:
    buffer_load_dwordx4 v[120:123], v1, s[52:55], s97 offen offset:0 nt
    v_mfma_f32_16x16x32_bf16 v[32:35], v[24:27], v[104:107], v[32:35]
    v_and_b32_dpp v28, v16, v20 row_newbcast:8 row_mask:0xf bank_mask:0xf
    v_and_b32_dpp v29, v16, v21 row_newbcast:8 row_mask:0xf bank_mask:0xf
    v_and_b32_dpp v30, v16, v22 row_newbcast:8 row_mask:0xf bank_mask:0xf
    v_and_b32_dpp v31, v16, v23 row_newbcast:8 row_mask:0xf bank_mask:0xf
    s_waitcnt vmcnt(3)
    s_bitcmp0_b32 s14, 21
    s_cbranch_scc1 L_sf_78
    s_waitcnt vmcnt(2)
    s_bitcmp0_b32 s15, 21
    s_cbranch_scc1 L_sf_78
    s_waitcnt vmcnt(1)
L_sf_78:
    buffer_load_dwordx4 v[124:127], v1, s[52:55], s97 offen offset:1024 nt
    v_mfma_f32_16x16x32_bf16 v[32:35], v[28:31], v[108:111], v[32:35]
    v_and_b32_dpp v24, v16, v20 row_newbcast:4 row_mask:0xf bank_mask:0xf
    v_and_b32_dpp v25, v16, v21 row_newbcast:4 row_mask:0xf bank_mask:0xf
    v_and_b32_dpp v26, v16, v22 row_newbcast:4 row_mask:0xf bank_mask:0xf
    v_and_b32_dpp v27, v16, v23 row_newbcast:4 row_mask:0xf bank_mask:0xf
    s_waitcnt vmcnt(3)
    s_bitcmp0_b32 s14, 22
    s_cbranch_scc1 L_sf_79
    s_waitcnt vmcnt(2)
    s_bitcmp0_b32 s15, 22
    s_cbranch_scc1 L_sf_79
    s_waitcnt vmcnt(1)
L_sf_79:
    buffer_load_dwordx4 v[128:131], v1, s[52:55], s97 offen offset:2048 nt
    v_mfma_f32_16x16x32_bf16 v[32:35], v[24:27], v[112:115], v[32:35]
    v_and_b32_dpp v28, v16, v20 row_newbcast:12 row_mask:0xf bank_mask:0xf
    v_and_b32_dpp v29, v16, v21 row_newbcast:12 row_mask:0xf bank_mask:0xf
    v_and_b32_dpp v30, v16, v22 row_newbcast:12 row_mask:0xf bank_mask:0xf
    v_and_b32_dpp v31, v16, v23 row_newbcast:12 row_mask:0xf bank_mask:0xf
    s_waitcnt vmcnt(3)
    s_bitcmp0_b32 s14, 23
    s_cbranch_scc1 L_sf_80
    s_waitcnt vmcnt(2)
    s_bitcmp0_b32 s15, 23
    s_cbranch_scc1 L_sf_80
    s_waitcnt vmcnt(1)
L_sf_80:
    buffer_load_dwordx4 v[132:135], v1, s[52:55], s97 offen offset:3072 nt
    s_add_u32 s97, s97, 32768
    v_add_u32 v1, 4096, v1
    v_and_b32 v1, 0x7fff, v1
    v_mfma_f32_16x16x32_bf16 v[32:35], v[28:31], v[116:119], v[32:35]
    v_and_b32_dpp v24, v17, v20 row_newbcast:0 row_mask:0xf bank_mask:0xf
    v_and_b32_dpp v25, v17, v21 row_newbcast:0 row_mask:0xf bank_mask:0xf
    v_and_b32_dpp v26, v17, v22 row_newbcast:0 row_mask:0xf bank_mask:0xf
    v_and_b32_dpp v27, v17, v23 row_newbcast:0 row_mask:0xf bank_mask:0xf
    s_waitcnt vmcnt(3)
    s_bitcmp0_b32 s14, 24
    s_cbranch_scc1 L_sf_81
    s_waitcnt vmcnt(2)
    s_bitcmp0_b32 s15, 24
    s_cbranch_scc1 L_sf_81
    s_waitcnt vmcnt(1)
L_sf_81:
    buffer_load_dwordx4 v[136:139], v1, s[52:55], s97 offen offset:0 nt
    v_mfma_f32_16x16x32_bf16 v[32:35], v[24:27], v[120:123], v[32:35]
    s_or_b32 s96, s59, s39
    s_cbranch_scc0 L_nofrag_82
    v_mov_b32 v104, 162060
L_lw_83:
    ds_read_b32 v105, v104
    s_waitcnt lgkmcnt(0)
    v_cmp_gt_u32 vcc, 4, v105
    s_cbranch_vccz L_lw_83e
    s_sleep 2
    s_sub_u32 s60, s60, 1
    s_cbranch_scc0 L_lw_83
    s_mov_b32 s60, 0
L_lw_83e:
    s_cmp_eq_u32 s59, 0
    s_cbranch_scc1 L_nofrag_82
    v_lshrrev_b32 v109, 4, v0
    v_bfe_u32 v104, v0, 1, 1
    v_lshl_add_u32 v104, v109, 1, v104
    v_bfe_u32 v110, v0, 2, 2
    v_lshl_add_u32 v104, v104, 3, v110
    v_lshlrev_b32 v104, 7, v104
    v_and_b32 v110, 1, v0
    v_lshl_add_u32 v104, v110, 3, v104
    s_lshl_b32 s96, s3, 13
    s_add_u32 s96, s96, 81920
    v_add_u32 v104, s96, v104
    ds_read_b64_tr_b16 v[72:73], v104 offset:0
    ds_read_b64_tr_b16 v[74:75], v104 offset:512
    ds_read_b64_tr_b16 v[76:77], v104 offset:16
    ds_read_b64_tr_b16 v[78:79], v104 offset:528
    ds_read_b64_tr_b16 v[80:81], v104 offset:32
    ds_read_b64_tr_b16 v[82:83], v104 offset:544
    ds_read_b64_tr_b16 v[84:85], v104 offset:48
    ds_read_b64_tr_b16 v[86:87], v104 offset:560
    ds_read_b64_tr_b16 v[88:89], v104 offset:64
    ds_read_b64_tr_b16 v[90:91], v104 offset:576
    ds_read_b64_tr_b16 v[92:93], v104 offset:80
    ds_read_b64_tr_b16 v[94:95], v104 offset:592
    ds_read_b64_tr_b16 v[96:97], v104 offset:96
    ds_read_b64_tr_b16 v[98:99], v104 offset:608
    ds_read_b64_tr_b16 v[100:101], v104 offset:112
    ds_read_b64_tr_b16 v[102:103], v104 offset:624
    v_bfe_u32 v105, v0, 1, 3
    v_lshlrev_b32 v105, 8, v105
    v_lshl_add_u32 v105, v109, 5, v105
    v_lshl_add_u32 v105, v110, 4, v105
    v_mul_u32_u24 v106, 320, v109
    v_bfe_u32 v110, v0, 3, 1
    v_mul_u32_u24 v110, 160, v110
    v_add_u32 v106, v106, v110
    v_and_b32 v110, 7, v0
    v_lshl_add_u32 v107, v110, 4, v106
    v_add_u32 v107, 81920, v107
    v_lshl_add_u32 v106, v110, 2, v106
    v_add_u32 v106, s96, v106
    v_mul_u32_u24 v108, 1280, v109
    v_add_u32 v108, v108, v2
    s_lshr_b32 s96, s3, 1
    s_lshl_b32 s96, s96, 11
    s_and_b32 s100, s3, 1
    s_lshl_b32 s100, s100, 7
    s_add_u32 s100, s100, s96
    s_lshl_b32 s96, s34, 13
    s_add_u32 s100, s100, s96
    s_add_u32 s100, s100, 90112
    s_mul_i32 s101, s34, 5120
    s_lshl_b32 s96, s35, 7
    s_add_u32 s101, s101, s96
    s_add_u32 s101, s101, 152832
L_nofrag_82:
    v_mov_b32 v10, 162076
    v_mov_b32 v11, 1
    s_mov_b64 exec, 1
    ds_add_u32 v10, v11
    s_mov_b64 exec, -1
    v_and_b32_dpp v28, v17, v20 row_newbcast:8 row_mask:0xf bank_mask:0xf
    v_and_b32_dpp v29, v17, v21 row_newbcast:8 row_mask:0xf bank_mask:0xf
    v_and_b32_dpp v30, v17, v22 row_newbcast:8 row_mask:0xf bank_mask:0xf
    v_and_b32_dpp v31, v17, v23 row_newbcast:8 row_mask:0xf bank_mask:0xf
    s_waitcnt vmcnt(3)
    s_bitcmp0_b32 s14, 25
    s_cbranch_scc1 L_sf_84
    s_waitcnt vmcnt(2)
    s_bitcmp0_b32 s15, 25
    s_cbranch_scc1 L_sf_84
    s_waitcnt vmcnt(1)
L_sf_84:
    buffer_load_dwordx4 v[140:143], v1, s[52:55], s97 offen offset:1024 nt
    v_mfma_f32_16x16x32_bf16 v[32:35], v[28:31], v[124:127], v[32:35]
    v_and_b32_dpp v24, v17, v20 row_newbcast:4 row_mask:0xf bank_mask:0xf
    v_and_b32_dpp v25, v17, v21 row_newbcast:4 row_mask:0xf bank_mask:0xf
    v_and_b32_dpp v26, v17, v22 row_newbcast:4 row_mask:0xf bank_mask:0xf
    v_and_b32_dpp v27, v17, v23 row_newbcast:4 row_mask:0xf bank_mask:0xf
    s_waitcnt vmcnt(3)
    s_bitcmp0_b32 s14, 26
    s_cbranch_scc1 L_sf_85
    s_waitcnt vmcnt(2)
    s_bitcmp0_b32 s15, 26
    s_cbranch_scc1 L_sf_85
    s_waitcnt vmcnt(1)
L_sf_85:
    buffer_load_dwordx4 v[144:147], v1, s[52:55], s97 offen offset:2048 nt
    v_mfma_f32_16x16x32_bf16 v[32:35], v[24:27], v[128:131], v[32:35]
    v_and_b32_dpp v28, v17, v20 row_newbcast:12 row_mask:0xf bank_mask:0xf
    v_and_b32_dpp v29, v17, v21 row_newbcast:12 row_mask:0xf bank_mask:0xf
    v_and_b32_dpp v30, v17, v22 row_newbcast:12 row_mask:0xf bank_mask:0xf
    v_and_b32_dpp v31, v17, v23 row_newbcast:12 row_mask:0xf bank_mask:0xf
    s_waitcnt vmcnt(3)
    s_bitcmp0_b32 s14, 27
    s_cbranch_scc1 L_sf_86
    s_waitcnt vmcnt(2)
    s_bitcmp0_b32 s15, 27
    s_cbranch_scc1 L_sf_86
    s_waitcnt vmcnt(1)
L_sf_86:
    buffer_load_dwordx4 v[148:151], v1, s[52:55], s97 offen offset:3072 nt
    s_add_u32 s97, s97, 32768
    v_add_u32 v1, 4096, v1
    v_and_b32 v1, 0x7fff, v1
    v_mfma_f32_16x16x32_bf16 v[32:35], v[28:31], v[132:135], v[32:35]
    v_and_b32_dpp v24, v18, v20 row_newbcast:0 row_mask:0xf bank_mask:0xf
    v_and_b32_dpp v25, v18, v21 row_newbcast:0 row_mask:0xf bank_mask:0xf
    v_and_b32_dpp v26, v18, v22 row_newbcast:0 row_mask:0xf bank_mask:0xf
    v_and_b32_dpp v27, v18, v23 row_newbcast:0 row_mask:0xf bank_mask:0xf
    s_waitcnt vmcnt(3)
    s_bitcmp0_b32 s14, 28
    s_cbranch_scc1 L_sf_87
    s_waitcnt vmcnt(2)
    s_bitcmp0_b32 s15, 28
    s_cbranch_scc1 L_sf_87
    s_waitcnt vmcnt(1)
L_sf_87:
    buffer_load_dwordx4 v[152:155], v1, s[52:55], s97 offen offset:0 nt
    v_mfma_f32_16x16x32_bf16 v[32:35], v[24:27], v[136:139], v[32:35]
    v_and_b32_dpp v28, v18, v20 row_newbcast:8 row_mask:0xf bank_mask:0xf
    v_and_b32_dpp v29, v18, v21 row_newbcast:8 row_mask:0xf bank_mask:0xf
    v_and_b32_dpp v30, v18, v22 row_newbcast:8 row_mask:0xf bank_mask:0xf
    v_and_b32_dpp v31, v18, v23 row_newbcast:8 row_mask:0xf bank_mask:0xf
    s_waitcnt vmcnt(3)
    s_bitcmp0_b32 s14, 29
    s_cbranch_scc1 L_sf_88
    s_waitcnt vmcnt(2)
    s_bitcmp0_b32 s15, 29
    s_cbranch_scc1 L_sf_88
    s_waitcnt vmcnt(1)
L_sf_88:
    buffer_load_dwordx4 v[156:159], v1, s[52:55], s97 offen offset:1024 nt
    v_mfma_f32_16x16x32_bf16 v[32:35], v[28:31], v[140:143], v[32:35]
    v_and_b32_dpp v24, v18, v20 row_newbcast:4 row_mask:0xf bank_mask:0xf
    v_and_b32_dpp v25, v18, v21 row_newbcast:4 row_mask:0xf bank_mask:0xf
    v_and_b32_dpp v26, v18, v22 row_newbcast:4 row_mask:0xf bank_mask:0xf
    v_and_b32_dpp v27, v18, v23 row_newbcast:4 row_mask:0xf bank_mask:0xf
    s_waitcnt vmcnt(3)
    s_bitcmp0_b32 s14, 30
    s_cbranch_scc1 L_sf_89
    s_waitcnt vmcnt(2)
    s_bitcmp0_b32 s15, 30
    s_cbranch_scc1 L_sf_89
    s_waitcnt vmcnt(1)
L_sf_89:
    buffer_load_dwordx4 v[160:163], v1, s[52:55], s97 offen offset:2048 nt
    v_mfma_f32_16x16x32_bf16 v[32:35], v[24:27], v[144:147], v[32:35]
    v_lshrrev_b32 v9, 4, v0
    v_lshl_add_u32 v8, v9, 2, v2
    s_lshl_b32 s96, s3, 9
    s_add_u32 s96, s96, 157824
    v_lshl_add_u32 v8, v8, 2, s96
    v_lshlrev_b32 v9, 3, v0
    v_add_u32 v9, 157824, v9
    v_mov_b32 v10, 162048
    v_mov_b32 v11, 1
    s_lshl_b32 s96, s38, 5
    s_add_u32 s96, s96, 161984
    v_mov_b32 v3, s96
    s_sub_u32 s62, 8, s39
    s_lshl_b32 s98, s34, 5
    s_add_u32 s98, s98, s35
    s_lshl_b32 s98, s98, 8
    s_add_u32 s98, s98, 90112
    v_lshlrev_b32 v39, 2, v0
    v_and_b32_dpp v28, v18, v20 row_newbcast:12 row_mask:0xf bank_mask:0xf
    v_and_b32_dpp v29, v18, v21 row_newbcast:12 row_mask:0xf bank_mask:0xf
    v_and_b32_dpp v30, v18, v22 row_newbcast:12 row_mask:0xf bank_mask:0xf
    v_and_b32_dpp v31, v18, v23 row_newbcast:12 row_mask:0xf bank_mask:0xf
    s_waitcnt vmcnt(3)
    s_bitcmp0_b32 s14, 31
    s_cbranch_scc1 L_sf_90
    s_waitcnt vmcnt(2)
    s_bitcmp0_b32 s15, 31
    s_cbranch_scc1 L_sf_90
    s_waitcnt vmcnt(1)
L_sf_90:
    buffer_load_dwordx4 v[164:167], v1, s[52:55], s97 offen offset:3072 nt
    s_mov_b32 s97, 0
    v_add_u32 v1, 4096, v1
    v_and_b32 v1, 0x7fff, v1
    v_mfma_f32_16x16x32_bf16 v[32:35], v[28:31], v[148:151], v[32:35]
    s_cmp_eq_u32 s12, -1
    s_cbranch_scc1 L_v_nopf
    v_and_b32_dpp v24, v19, v20 row_newbcast:0 row_mask:0xf bank_mask:0xf
    v_and_b32_dpp v25, v19, v21 row_newbcast:0 row_mask:0xf bank_mask:0xf
    v_and_b32_dpp v26, v19, v22 row_newbcast:0 row_mask:0xf bank_mask:0xf
    v_and_b32_dpp v27, v19, v23 row_newbcast:0 row_mask:0xf bank_mask:0xf
    s_waitcnt vmcnt(3)
    s_nop 0
    v_mfma_f32_16x16x32_bf16 v[32:35], v[24:27], v[152:155], v[32:35]
    v_and_b32_dpp v28, v19, v20 row_newbcast:8 row_mask:0xf bank_mask:0xf
    v_and_b32_dpp v29, v19, v21 row_newbcast:8 row_mask:0xf bank_mask:0xf
    v_and_b32_dpp v30, v19, v22 row_newbcast:8 row_mask:0xf bank_mask:0xf
    v_and_b32_dpp v31, v19, v23 row_newbcast:8 row_mask:0xf bank_mask:0xf
    s_waitcnt vmcnt(2)
    s_nop 0
    v_mfma_f32_16x16x32_bf16 v[32:35], v[28:31], v[156:159], v[32:35]
    v_and_b32_dpp v24, v19, v20 row_newbcast:4 row_mask:0xf bank_mask:0xf
    v_and_b32_dpp v25, v19, v21 row_newbcast:4 row_mask:0xf bank_mask:0xf
    v_and_b32_dpp v26, v19, v22 row_newbcast:4 row_mask:0xf bank_mask:0xf
    v_and_b32_dpp v27, v19, v23 row_newbcast:4 row_mask:0xf bank_mask:0xf
    s_waitcnt vmcnt(1)
    s_nop 0
    v_mfma_f32_16x16x32_bf16 v[32:35], v[24:27], v[160:163], v[32:35]
    v_and_b32_dpp v28, v19, v20 row_newbcast:12 row_mask:0xf bank_mask:0xf
    v_and_b32_dpp v29, v19, v21 row_newbcast:12 row_mask:0xf bank_mask:0xf
    v_and_b32_dpp v30, v19, v22 row_newbcast:12 row_mask:0xf bank_mask:0xf
    v_and_b32_dpp v31, v19, v23 row_newbcast:12 row_mask:0xf bank_mask:0xf
    s_waitcnt vmcnt(0)
    s_nop 0
    v_mfma_f32_16x16x32_bf16 v[32:35], v[28:31], v[164:167], v[32:35]
L_v_join:
    s_cmp_lg_u32 s13, 0
    s_cbranch_scc1 L_jobend
L_t0:
    s_mov_b32 exec_hi, 0
    s_nop 4
    ds_write_b128 v8, v[32:35]
L_t0b:
    s_mov_b64 exec, 1
    ds_add_rtn_u32 v37, v10, v11
    s_mov_b64 exec, -1
    ds_read_b32 v38, v10 offset:24
    ds_read_b128 v[24:27], v3
    ds_read_b128 v[28:31], v3 offset:16
    ds_read_b64 v[144:145], v9 offset:0
    ds_read_b64 v[146:147], v9 offset:512
    ds_read_b64 v[148:149], v9 offset:1024
    ds_read_b64 v[150:151], v9 offset:1536
    ds_read_b64 v[152:153], v9 offset:2048
    ds_read_b64 v[154:155], v9 offset:2560
    ds_read_b64 v[156:157], v9 offset:3072
    ds_read_b64 v[158:159], v9 offset:3584
    s_waitcnt lgkmcnt(10)
    v_readfirstlane_b32 s96, v37
    v_readfirstlane_b32 s61, v38
    s_cmp_lg_u32 s96, s62
    s_cbranch_scc1 L_nopub
    s_waitcnt lgkmcnt(6)
    v_pk_mul_f32 v[144:145], v[144:145], v[24:25] op_sel:[0,0] op_sel_hi:[1,0]
    v_pk_mul_f32 v[146:147], v[146:147], v[24:25] op_sel:[0,1] op_sel_hi:[1,1]
    s_waitcnt lgkmcnt(4)
    v_pk_fma_f32 v[144:145], v[148:149], v[26:27], v[144:145] op_sel:[0,0,0] op_sel_hi:[1,0,1]
    v_pk_fma_f32 v[146:147], v[150:151], v[26:27], v[146:147] op_sel:[0,1,0] op_sel_hi:[1,1,1]
    s_waitcnt lgkmcnt(2)
    v_pk_fma_f32 v[144:145], v[152:153], v[28:29], v[144:145] op_sel:[0,0,0] op_sel_hi:[1,0,1]
    v_pk_fma_f32 v[146:147], v[154:155], v[28:29], v[146:147] op_sel:[0,1,0] op_sel_hi:[1,1,1]
    s_waitcnt lgkmcnt(0)
    v_pk_fma_f32 v[144:145], v[156:157], v[30:31], v[144:145] op_sel:[0,0,0] op_sel_hi:[1,0,1]
    v_pk_fma_f32 v[146:147], v[158:159], v[30:31], v[146:147] op_sel:[0,1,0] op_sel_hi:[1,1,1]
    s_cmp_eq_u32 s61, 1
    v_pk_add_f32 v[144:145], v[144:145], v[146:147]
    v_cvt_pk_bf16_f32 v32, v144, v145
    s_cbranch_scc0 L_oslow
    buffer_store_dword v32, v39, s[40:43], s98 offen
L_odone:
L_nopub:
    s_cmp_eq_u32 s59, 0
    s_cbranch_scc1 L_not1
L_poll_99:
    buffer_load_dwordx4 v[16:19], v105, s[40:43], s100 offen sc1
    s_waitcnt vmcnt(0)
    v_max3_u32 v38, v16, v17, v18
    v_max_u32 v38, v38, v19
    v_cmp_eq_u32 vcc, -1, v38
    s_cbranch_vccz L_poll_99e
    s_sub_u32 s60, s60, 1
    s_cbranch_scc0 L_poll_99
    s_mov_b32 s60, 0
L_poll_99e:
    v_mfma_f32_16x16x32_bf16 v[112:115], v[16:19], v[72:75], 0
    v_mfma_f32_16x16x32_bf16 v[128:131], v[16:19], v[88:91], 0
    v_mfma_f32_16x16x32_bf16 v[116:119], v[16:19], v[76:79], 0
    v_mfma_f32_16x16x32_bf16 v[132:135], v[16:19], v[92:95], 0
    v_mfma_f32_16x16x32_bf16 v[120:123], v[16:19], v[80:83], 0
    v_mfma_f32_16x16x32_bf16 v[136:139], v[16:19], v[96:99], 0
    v_mfma_f32_16x16x32_bf16 v[124:127], v[16:19], v[84:87], 0
    v_mfma_f32_16x16x32_bf16 v[140:143], v[16:19], v[100:103], 0
    s_nop 0
    v_pk_add_f32 v[112:113], v[112:113], v[114:115]
    v_pk_add_f32 v[128:129], v[128:129], v[130:131]
    v_pk_add_f32 v[116:117], v[116:117], v[118:119]
    v_pk_add_f32 v[132:133], v[132:133], v[134:135]
    v_add_f32_dpp v12, v113, v112 row_ror:8 row_mask:0xf bank_mask:0x3
    v_add_f32_dpp v12, v128, v129 row_ror:8 row_mask:0xf bank_mask:0xc
    ds_write_b32 v106, v12 offset:0
    v_pk_add_f32 v[120:121], v[120:121], v[122:123]
    v_pk_add_f32 v[136:137], v[136:137], v[138:139]
    v_add_f32_dpp v13, v117, v116 row_ror:8 row_mask:0xf bank_mask:0x3
    v_add_f32_dpp v13, v132, v133 row_ror:8 row_mask:0xf bank_mask:0xc
    ds_write_b32 v106, v13 offset:32
    v_pk_add_f32 v[124:125], v[124:125], v[126:127]
    v_pk_add_f32 v[140:141], v[140:141], v[142:143]
    v_add_f32_dpp v14, v121, v120 row_ror:8 row_mask:0xf bank_mask:0x3
    v_add_f32_dpp v14, v136, v137 row_ror:8 row_mask:0xf bank_mask:0xc
    ds_write_b32 v106, v14 offset:64
    v_add_f32_dpp v15, v125, v124 row_ror:8 row_mask:0xf bank_mask:0x3
    v_add_f32_dpp v15, v140, v141 row_ror:8 row_mask:0xf bank_mask:0xc
    ds_write_b32 v106, v15 offset:96
    s_mov_b64 exec, 1
    ds_add_rtn_u32 v37, v10, v11 offset:4
    s_mov_b64 exec, -1
    ds_read_b128 v[72:75], v107 offset:0
    ds_read_b128 v[76:79], v107 offset:8192
    ds_read_b128 v[80:83], v107 offset:16384
    ds_read_b128 v[84:87], v107 offset:24576
    ds_read_b128 v[88:91], v107 offset:32768
    ds_read_b128 v[92:95], v107 offset:40960
    ds_read_b128 v[96:99], v107 offset:49152
    ds_read_b128 v[100:103], v107 offset:57344
    s_waitcnt lgkmcnt(8)
    v_readfirstlane_b32 s96, v37
    s_nop 0
    s_cmp_lg_u32 s96, 7
    s_cbranch_scc1 L_not1
    s_waitcnt lgkmcnt(6)
    v_pk_add_f32 v[72:73], v[72:73], v[76:77]
    v_pk_add_f32 v[74:75], v[74:75], v[78:79]
    s_waitcnt lgkmcnt(4)
    v_pk_add_f32 v[80:81], v[80:81], v[84:85]
    v_pk_add_f32 v[82:83], v[82:83], v[86:87]
    v_pk_add_f32 v[72:73], v[72:73], v[80:81]
    v_pk_add_f32 v[74:75], v[74:75], v[82:83]
    s_waitcnt lgkmcnt(2)
    v_pk_add_f32 v[88:89], v[88:89], v[92:93]
    v_pk_add_f32 v[90:91], v[90:91], v[94:95]
    v_pk_add_f32 v[72:73], v[72:73], v[88:89]
    v_pk_add_f32 v[74:75], v[74:75], v[90:91]
    s_waitcnt lgkmcnt(0)
    v_pk_add_f32 v[96:97], v[96:97], v[100:101]
    v_pk_add_f32 v[98:99], v[98:99], v[102:103]
    v_pk_add_f32 v[72:73], v[72:73], v[96:97]
    v_pk_add_f32 v[74:75], v[74:75], v[98:99]
    v_cvt_pk_bf16_f32 v12, v72, v73
    v_cvt_pk_bf16_f32 v13, v74, v75
    buffer_store_dwordx2 v[12:13], v108, s[40:43], s101 offen sc1
L_not1:
    s_waitcnt lgkmcnt(0)
    s_cmp_eq_u32 s39, 1
    s_cbranch_scc1 L_s_role
    s_endpgm
L_k_nopf:
    s_waitcnt vmcnt(3)
    s_bitcmp0_b32 s57, 22
    s_cbranch_scc1 L_sf_55
    s_waitcnt vmcnt(2)
    s_bitcmp0_b32 s58, 22
    s_cbranch_scc1 L_sf_55
    s_waitcnt vmcnt(1)
L_sf_55:
    buffer_load_dwordx4 v[128:131], v1, s[48:51], s97 offen offset:2048 nt
    v_min_u32 v39, 29, v0
    v_lshlrev_b32 v39, 2, v39
    buffer_load_dword v37, v39, s[44:47], 0 offen sc1
    s_waitcnt vmcnt(4)
    s_bitcmp0_b32 s57, 23
    s_cbranch_scc1 L_sf_56
    s_waitcnt vmcnt(3)
    s_bitcmp0_b32 s58, 23
    s_cbranch_scc1 L_sf_56
    s_waitcnt vmcnt(2)
L_sf_56:
    buffer_load_dwordx4 v[132:135], v1, s[48:51], s97 offen offset:3072 nt
    s_add_u32 s97, s97, 32768
    v_add_u32 v1, 4096, v1
    v_and_b32 v1, 0x7fff, v1
    s_waitcnt vmcnt(4)
    s_bitcmp0_b32 s57, 24
    s_cbranch_scc1 L_sf_57
    s_waitcnt vmcnt(3)
    s_bitcmp0_b32 s58, 24
    s_cbranch_scc1 L_sf_57
    s_waitcnt vmcnt(2)
L_sf_57:
    buffer_load_dwordx4 v[136:139], v1, s[48:51], s97 offen offset:0 nt
    s_waitcnt vmcnt(4)
    s_bitcmp0_b32 s57, 25
    s_cbranch_scc1 L_sf_58
    s_waitcnt vmcnt(3)
    s_bitcmp0_b32 s58, 25
    s_cbranch_scc1 L_sf_58
    s_waitcnt vmcnt(1)
L_sf_58:
    buffer_load_dwordx4 v[140:143], v1, s[48:51], s97 offen offset:1024 nt
    s_waitcnt vmcnt(4)
    s_bitcmp0_b32 s57, 26
    s_cbranch_scc1 L_sf_59
    s_waitcnt vmcnt(2)
    s_bitcmp0_b32 s58, 26
    s_cbranch_scc1 L_sf_59
    s_waitcnt vmcnt(1)
L_sf_59:
    buffer_load_dwordx4 v[144:147], v1, s[48:51], s97 offen offset:2048 nt
    s_waitcnt vmcnt(3)
    s_bitcmp0_b32 s57, 27
    s_cbranch_scc1 L_sf_60
    s_waitcnt vmcnt(2)
    s_bitcmp0_b32 s58, 27
    s_cbranch_scc1 L_sf_60
    s_waitcnt vmcnt(1)
L_sf_60:
    buffer_load_dwordx4 v[148:151], v1, s[48:51], s97 offen offset:3072 nt
    s_add_u32 s97, s97, 32768
    v_add_u32 v1, 4096, v1
    v_and_b32 v1, 0x7fff, v1
    v_cmp_eq_u32 vcc, 0, v37
    s_nop 0
    s_or_b32 s96, vcc_lo, vcc_hi
    buffer_load_dwordx4 v[4:7], v2, s[40:43], s98 offen sc1
    s_waitcnt vmcnt(4)
    s_bitcmp0_b32 s57, 28
    s_cbranch_scc1 L_sf_61
    s_waitcnt vmcnt(3)
    s_bitcmp0_b32 s58, 28
    s_cbranch_scc1 L_sf_61
    s_waitcnt vmcnt(2)
L_sf_61:
    buffer_load_dwordx4 v[152:155], v1, s[48:51], s97 offen offset:0 nt
    s_waitcnt vmcnt(4)
    s_bitcmp0_b32 s57, 29
    s_cbranch_scc1 L_sf_62
    s_waitcnt vmcnt(3)
    s_bitcmp0_b32 s58, 29
    s_cbranch_scc1 L_sf_62
    s_waitcnt vmcnt(2)
L_sf_62:
    buffer_load_dwordx4 v[156:159], v1, s[48:51], s97 offen offset:1024 nt
    s_waitcnt vmcnt(4)
    s_bitcmp0_b32 s57, 30
    s_cbranch_scc1 L_sf_63
    s_waitcnt vmcnt(3)
    s_bitcmp0_b32 s58, 30
    s_cbranch_scc1 L_sf_63
    s_waitcnt vmcnt(1)
L_sf_63:
    buffer_load_dwordx4 v[160:163], v1, s[48:51], s97 offen offset:2048 nt
    s_waitcnt vmcnt(4)
    s_bitcmp0_b32 s57, 31
    s_cbranch_scc1 L_sf_64
    s_waitcnt vmcnt(2)
    s_bitcmp0_b32 s58, 31
    s_cbranch_scc1 L_sf_64
    s_waitcnt vmcnt(1)
L_sf_64:
    buffer_load_dwordx4 v[164:167], v1, s[48:51], s97 offen offset:3072 nt
    s_mov_b32 s97, 0
    v_add_u32 v1, 4096, v1
    v_and_b32 v1, 0x7fff, v1
    v_add_u32 v1, 8192, v1
    v_and_b32 v1, 0x7fff, v1
    s_mov_b32 s97, 65536
    s_branch L_k_join
L_v_nopf:
    v_and_b32_dpp v24, v19, v20 row_newbcast:0 row_mask:0xf bank_mask:0xf
    v_and_b32_dpp v25, v19, v21 row_newbcast:0 row_mask:0xf bank_mask:0xf
    v_and_b32_dpp v26, v19, v22 row_newbcast:0 row_mask:0xf bank_mask:0xf
    v_and_b32_dpp v27, v19, v23 row_newbcast:0 row_mask:0xf bank_mask:0xf
    s_waitcnt vmcnt(3)
    s_bitcmp0_b32 s14, 0
    s_cbranch_scc1 L_sf_91
    s_waitcnt vmcnt(2)
    s_bitcmp0_b32 s15, 0
    s_cbranch_scc1 L_sf_91
    s_waitcnt vmcnt(1)
L_sf_91:
    buffer_load_dwordx4 v[40:43], v1, s[52:55], s97 offen offset:0 nt
    v_mfma_f32_16x16x32_bf16 v[32:35], v[24:27], v[152:155], v[32:35]
    v_and_b32_dpp v28, v19, v20 row_newbcast:8 row_mask:0xf bank_mask:0xf
    v_and_b32_dpp v29, v19, v21 row_newbcast:8 row_mask:0xf bank_mask:0xf
    v_and_b32_dpp v30, v19, v22 row_newbcast:8 row_mask:0xf bank_mask:0xf
    v_and_b32_dpp v31, v19, v23 row_newbcast:8 row_mask:0xf bank_mask:0xf
    s_waitcnt vmcnt(3)
    s_bitcmp0_b32 s14, 1
    s_cbranch_scc1 L_sf_92
    s_waitcnt vmcnt(2)
    s_bitcmp0_b32 s15, 1
    s_cbranch_scc1 L_sf_92
    s_waitcnt vmcnt(1)
L_sf_92:
    buffer_load_dwordx4 v[44:47], v1, s[52:55], s97 offen offset:1024 nt
    v_mfma_f32_16x16x32_bf16 v[32:35], v[28:31], v[156:159], v[32:35]
    v_and_b32_dpp v24, v19, v20 row_newbcast:4 row_mask:0xf bank_mask:0xf
    v_and_b32_dpp v25, v19, v21 row_newbcast:4 row_mask:0xf bank_mask:0xf
    v_and_b32_dpp v26, v19, v22 row_newbcast:4 row_mask:0xf bank_mask:0xf
    v_and_b32_dpp v27, v19, v23 row_newbcast:4 row_mask:0xf bank_mask:0xf
    s_waitcnt vmcnt(3)
    s_bitcmp0_b32 s14, 2
    s_cbranch_scc1 L_sf_93
    s_waitcnt vmcnt(2)
    s_bitcmp0_b32 s15, 2
    s_cbranch_scc1 L_sf_93
    s_waitcnt vmcnt(1)
L_sf_93:
    buffer_load_dwordx4 v[48:51], v1, s[52:55], s97 offen offset:2048 nt
    v_mfma_f32_16x16x32_bf16 v[32:35], v[24:27], v[160:163], v[32:35]
    v_and_b32_dpp v28, v19, v20 row_newbcast:12 row_mask:0xf bank_mask:0xf
    v_and_b32_dpp v29, v19, v21 row_newbcast:12 row_mask:0xf bank_mask:0xf
    v_and_b32_dpp v30, v19, v22 row_newbcast:12 row_mask:0xf bank_mask:0xf
    v_and_b32_dpp v31, v19, v23 row_newbcast:12 row_mask:0xf bank_mask:0xf
    s_waitcnt vmcnt(3)
    s_bitcmp0_b32 s14, 3
    s_cbranch_scc1 L_sf_94
    s_waitcnt vmcnt(2)
    s_bitcmp0_b32 s15, 3
    s_cbranch_scc1 L_sf_94
    s_waitcnt vmcnt(1)
L_sf_94:
    buffer_load_dwordx4 v[52:55], v1, s[52:55], s97 offen offset:3072 nt
    s_add_u32 s97, s97, 32768
    v_add_u32 v1, 4096, v1
    v_and_b32 v1, 0x7fff, v1
    v_mfma_f32_16x16x32_bf16 v[32:35], v[28:31], v[164:167], v[32:35]
    v_and_b32_dpp v24, v12, v20 row_newbcast:0 row_mask:0xf bank_mask:0xf
    v_and_b32_dpp v25, v12, v21 row_newbcast:0 row_mask:0xf bank_mask:0xf
    v_and_b32_dpp v26, v12, v22 row_newbcast:0 row_mask:0xf bank_mask:0xf
    v_and_b32_dpp v27, v12, v23 row_newbcast:0 row_mask:0xf bank_mask:0xf
    s_waitcnt vmcnt(3)
    s_bitcmp0_b32 s14, 4
    s_cbranch_scc1 L_sf_95
    s_waitcnt vmcnt(2)
    s_bitcmp0_b32 s15, 4
    s_cbranch_scc1 L_sf_95
    s_waitcnt vmcnt(1)
L_sf_95:
    buffer_load_dwordx4 v[56:59], v1, s[52:55], s97 offen offset:0 nt
    v_mfma_f32_16x16x32_bf16 v[32:35], v[24:27], v[40:43], v[32:35]
    v_and_b32_dpp v28, v12, v20 row_newbcast:8 row_mask:0xf bank_mask:0xf
    v_and_b32_dpp v29, v12, v21 row_newbcast:8 row_mask:0xf bank_mask:0xf
    v_and_b32_dpp v30, v12, v22 row_newbcast:8 row_mask:0xf bank_mask:0xf
    v_and_b32_dpp v31, v12, v23 row_newbcast:8 row_mask:0xf bank_mask:0xf
    s_waitcnt vmcnt(3)
    s_bitcmp0_b32 s14, 5
    s_cbranch_scc1 L_sf_96
    s_waitcnt vmcnt(2)
    s_bitcmp0_b32 s15, 5
    s_cbranch_scc1 L_sf_96
    s_waitcnt vmcnt(1)
L_sf_96:
    buffer_load_dwordx4 v[60:63], v1, s[52:55], s97 offen offset:1024 nt
    v_mfma_f32_16x16x32_bf16 v[32:35], v[28:31], v[44:47], v[32:35]
    v_and_b32_dpp v24, v12, v20 row_newbcast:4 row_mask:0xf bank_mask:0xf
    v_and_b32_dpp v25, v12, v21 row_newbcast:4 row_mask:0xf bank_mask:0xf
    v_and_b32_dpp v26, v12, v22 row_newbcast:4 row_mask:0xf bank_mask:0xf
    v_and_b32_dpp v27, v12, v23 row_newbcast:4 row_mask:0xf bank_mask:0xf
    s_waitcnt vmcnt(3)
    s_bitcmp0_b32 s14, 6
    s_cbranch_scc1 L_sf_97
    s_waitcnt vmcnt(2)
    s_bitcmp0_b32 s15, 6
    s_cbranch_scc1 L_sf_97
    s_waitcnt vmcnt(1)
L_sf_97:
    buffer_load_dwordx4 v[64:67], v1, s[52:55], s97 offen offset:2048 nt
    v_mfma_f32_16x16x32_bf16 v[32:35], v[24:27], v[48:51], v[32:35]
    v_and_b32_dpp v28, v12, v20 row_newbcast:12 row_mask:0xf bank_mask:0xf
    v_and_b32_dpp v29, v12, v21 row_newbcast:12 row_mask:0xf bank_mask:0xf
    v_and_b32_dpp v30, v12, v22 row_newbcast:12 row_mask:0xf bank_mask:0xf
    v_and_b32_dpp v31, v12, v23 row_newbcast:12 row_mask:0xf bank_mask:0xf
    s_waitcnt vmcnt(3)
    s_bitcmp0_b32 s14, 7
    s_cbranch_scc1 L_sf_98
    s_waitcnt vmcnt(2)
    s_bitcmp0_b32 s15, 7
    s_cbranch_scc1 L_sf_98
    s_waitcnt vmcnt(1)
L_sf_98:
    buffer_load_dwordx4 v[68:71], v1, s[52:55], s97 offen offset:3072 nt
    s_add_u32 s97, s97, 32768
    v_add_u32 v1, 4096, v1
    v_and_b32 v1, 0x7fff, v1
    v_mfma_f32_16x16x32_bf16 v[32:35], v[28:31], v[52:55], v[32:35]
    v_and_b32_dpp v24, v13, v20 row_newbcast:0 row_mask:0xf bank_mask:0xf
    v_and_b32_dpp v25, v13, v21 row_newbcast:0 row_mask:0xf bank_mask:0xf
    v_and_b32_dpp v26, v13, v22 row_newbcast:0 row_mask:0xf bank_mask:0xf
    v_and_b32_dpp v27, v13, v23 row_newbcast:0 row_mask:0xf bank_mask:0xf
    s_waitcnt vmcnt(3)
    s_nop 0
    v_mfma_f32_16x16x32_bf16 v[32:35], v[24:27], v[56:59], v[32:35]
    v_and_b32_dpp v28, v13, v20 row_newbcast:8 row_mask:0xf bank_mask:0xf
    v_and_b32_dpp v29, v13, v21 row_newbcast:8 row_mask:0xf bank_mask:0xf
    v_and_b32_dpp v30, v13, v22 row_newbcast:8 row_mask:0xf bank_mask:0xf
    v_and_b32_dpp v31, v13, v23 row_newbcast:8 row_mask:0xf bank_mask:0xf
    s_waitcnt vmcnt(2)
    s_nop 0
    v_mfma_f32_16x16x32_bf16 v[32:35], v[28:31], v[60:63], v[32:35]
    v_and_b32_dpp v24, v13, v20 row_newbcast:4 row_mask:0xf bank_mask:0xf
    v_and_b32_dpp v25, v13, v21 row_newbcast:4 row_mask:0xf bank_mask:0xf
    v_and_b32_dpp v26, v13, v22 row_newbcast:4 row_mask:0xf bank_mask:0xf
    v_and_b32_dpp v27, v13, v23 row_newbcast:4 row_mask:0xf bank_mask:0xf
    s_waitcnt vmcnt(1)
    s_nop 0
    v_mfma_f32_16x16x32_bf16 v[32:35], v[24:27], v[64:67], v[32:35]
    v_and_b32_dpp v28, v13, v20 row_newbcast:12 row_mask:0xf bank_mask:0xf
    v_and_b32_dpp v29, v13, v21 row_newbcast:12 row_mask:0xf bank_mask:0xf
    v_and_b32_dpp v30, v13, v22 row_newbcast:12 row_mask:0xf bank_mask:0xf
    v_and_b32_dpp v31, v13, v23 row_newbcast:12 row_mask:0xf bank_mask:0xf
    s_waitcnt vmcnt(0)
    s_nop 0
    v_mfma_f32_16x16x32_bf16 v[32:35], v[28:31], v[68:71], v[32:35]
    s_branch L_v_join
L_oslow:
    buffer_store_dword v32, v39, s[40:43], s98 offen sc1
    s_branch L_odone
L_qslow:
L_wy_100:
    buffer_load_dword v37, v39, s[44:47], 0 offen sc1
    s_waitcnt vmcnt(0)
    v_cmp_ne_u32 vcc, -1, v37
    s_cbranch_vccz L_wy_100e
    s_sleep 4
    s_sub_u32 s60, s60, 1
    s_cbranch_scc0 L_wy_100
    s_mov_b32 s60, 0
L_wy_100e:
L_qslow2:
L_poll_101:
    buffer_load_dwordx4 v[4:7], v2, s[40:43], s98 offen sc1
    s_waitcnt vmcnt(0)
    v_max3_u32 v38, v4, v5, v6
    v_max_u32 v38, v38, v7
    v_cmp_eq_u32 vcc, -1, v38
    s_cbranch_vccz L_poll_101e
    s_sleep 2
    s_sub_u32 s60, s60, 1
    s_cbranch_scc0 L_poll_101
    s_mov_b32 s60, 0
L_poll_101e:
    s_branch L_qok
L_mljob:
    s_lshl_b32 s96, s38, 3
    s_add_u32 s96, s96, s3
    s_lshl3_add_u32 s96, s96, s99
    buffer_store_dwordx2 v[8:9], v36, s[40:43], s96 offen sc1
    s_branch L_mldone
L_service:
    s_mov_b32 s59, 0
    v_mov_b32 v5, 0
    v_mov_b32 v105, 0
    v_mov_b32 v108, 0
    v_mov_b32 v160, 0
    v_mov_b32 v8, 162068
L_lw_102:
    ds_read_b32 v9, v8
    s_waitcnt lgkmcnt(0)
    v_cmp_gt_u32 vcc, 8, v9
    s_cbranch_vccz L_lw_102e
    s_sleep 8
    s_sub_u32 s60, s60, 1
    s_cbranch_scc0 L_lw_102
    s_mov_b32 s60, 0
L_lw_102e:
    v_and_b32 v2, 15, v0
    v_lshlrev_b32 v2, 3, v2
    v_add_u32 v3, 161920, v2
    ds_read_b64 v[8:9], v3
    s_lshl_b32 s99, s37, 5
    s_add_u32 s99, s99, s36
    s_lshl_b32 s99, s99, 7
    s_add_u32 s99, s99, 73728
    s_lshl_b32 s62, s38, 6
    s_add_u32 s62, s62, s99
    s_getreg_b32 s58, hwreg(HW_REG_XCC_ID, 0, 4)
    v_mov_b32 v10, s58
    s_lshl_b32 s98, s34, 5
    s_add_u32 s98, s98, s35
    s_lshl_b32 s63, s98, 2
    s_add_u32 s63, s63, 229376
    s_lshl_b32 s98, s98, 8
    s_add_u32 s98, s98, 90112
    v_lshlrev_b32 v39, 2, v0
    s_bfm_b64 exec, 8, 0
    s_waitcnt lgkmcnt(0)
    buffer_store_dwordx2 v[8:9], v2, s[40:43], s62 offen sc1
    s_mov_b64 exec, 1
    buffer_store_dword v10, v36, s[40:43], s63 offen sc1
    s_mov_b64 exec, -1
    v_mov_b32 v12, 162076
L_lw_103:
    ds_read_b32 v13, v12
    s_waitcnt lgkmcnt(0)
    v_cmp_gt_u32 vcc, 4, v13
    s_cbranch_vccz L_lw_103e
    s_sleep 4
    s_sub_u32 s60, s60, 1
    s_cbranch_scc0 L_lw_103
    s_mov_b32 s60, 0
L_lw_103e:
    v_and_b32 v11, 31, v0
    v_lshlrev_b32 v11, 2, v11
    s_lshl_b32 s63, s34, 7
    s_add_u32 s63, s63, 229376
    buffer_load_dword v12, v39, s[40:43], s98 offen sc1
L_poll_104:
    buffer_load_dwordx2 v[8:9], v2, s[40:43], s99 offen sc1
    buffer_load_dword v10, v11, s[40:43], s63 offen sc1
    s_waitcnt vmcnt(0)
    v_max3_u32 v38, v8, v9, v10
    v_cmp_eq_u32 vcc, -1, v38
    s_cbranch_vccz L_poll_104e
    s_sleep 16
    s_sub_u32 s60, s60, 1
    s_cbranch_scc0 L_poll_104
    s_mov_b32 s60, 0
L_poll_104e:
    v_mov_b32 v37, v8
    s_nop 1
    v_max_f32_dpp v37, v37, v37 quad_perm:[1,0,3,2] row_mask:0xf bank_mask:0xf
    s_nop 1
    v_max_f32_dpp v37, v37, v37 quad_perm:[2,3,0,1] row_mask:0xf bank_mask:0xf
    s_nop 1
    v_max_f32_dpp v37, v37, v37 row_ror:4 row_mask:0xf bank_mask:0xf
    s_nop 1
    v_max_f32_dpp v37, v37, v37 row_ror:8 row_mask:0xf bank_mask:0xf
    v_sub_f32 v8, v8, v37
    v_exp_f32 v8, v8
    s_nop 0
    v_mul_f32 v9, v8, v9
    s_nop 1
    v_add_f32_dpp v9, v9, v9 quad_perm:[1,0,3,2] row_mask:0xf bank_mask:0xf
    s_nop 1
    v_add_f32_dpp v9, v9, v9 quad_perm:[2,3,0,1] row_mask:0xf bank_mask:0xf
    s_nop 1
    v_add_f32_dpp v9, v9, v9 row_ror:4 row_mask:0xf bank_mask:0xf
    s_nop 1
    v_add_f32_dpp v9, v9, v9 row_ror:8 row_mask:0xf bank_mask:0xf
    s_getreg_b32 s62, hwreg(HW_REG_XCC_ID, 0, 4)
    v_cmp_ne_u32 vcc, s62, v10
    s_nop 0
    s_cmp_eq_u64 vcc, 0
    s_cselect_b32 s61, 1, 0
    v_rcp_f32 v9, v9
    v_lshrrev_b32 v3, 1, v2
    v_add_u32 v3, 161984, v3
    v_mul_f32 v8, v8, v9
    v_mov_b32 v10, 162072
    v_mov_b32 v11, s61
    ds_write_b32 v3, v8
    ds_write_b32 v10, v11
    s_mov_b32 s3, 1
    v_lshrrev_b32 v9, 4, v0
    v_lshl_add_u32 v8, v9, 2, v2
    s_lshl_b32 s96, s3, 9
    s_add_u32 s96, s96, 157824
    v_lshl_add_u32 v8, v8, 2, s96
    v_lshlrev_b32 v9, 3, v0
    v_add_u32 v9, 157824, v9
    v_mov_b32 v10, 162048
    v_mov_b32 v11, 1
    s_lshl_b32 s96, s38, 5
    s_add_u32 s96, s96, 161984
    v_mov_b32 v3, s96
    s_sub_u32 s62, 8, s39
    s_lshl_b32 s98, s34, 5
    s_add_u32 s98, s98, s35
    s_lshl_b32 s98, s98, 8
    s_add_u32 s98, s98, 90112
    v_lshlrev_b32 v39, 2, v0
    s_branch L_t0b
L_jobend:
    v_lshrrev_b32 v9, 4, v0
    v_lshl_add_u32 v9, v9, 2, v2
    v_lshlrev_b32 v9, 2, v9
    s_mov_b32 exec_hi, 0
    s_nop 1
    buffer_store_dwordx4 v[32:35], v9, s[40:43], s13 offen sc1
    s_endpgm
L_proxy:
    v_mov_b32 v5, 0
    v_mov_b32 v105, 0
    v_mov_b32 v108, 0
    v_mov_b32 v160, 0
    s_barrier
    s_waitcnt lgkmcnt(0)
    s_mov_b32 s40, s32
    s_mov_b32 s41, s33
    s_mov_b32 s42, 589824
    s_mov_b32 s43, 0x20000
    s_mov_b32 s44, s30
    s_mov_b32 s45, s31
    s_mov_b32 s46, 256
    s_mov_b32 s47, 0x20000
    s_sub_u32 s97, 7, s3
    s_mul_i32 s97, s97, 27
    s_cmp_eq_u32 s3, 5
    s_cselect_b32 s97, 32, s97
    s_add_u32 s97, s97, s35
    s_lshl_b32 s97, s97, 9
    s_add_u32 s97, s97, 196608
    v_and_b32 v2, 15, v0
    v_lshlrev_b32 v2, 3, v2
    v_bfe_u32 v20, v0, 4, 1
    v_lshl_add_u32 v20, v20, 2, v2
    v_lshlrev_b32 v20, 2, v20
    s_cmp_lg_u32 s3, 7
    s_cbranch_scc1 L_px6
    s_sub_u32 s96, 6, s59
    v_mov_b32 v8, 162068
L_lw_105:
    ds_read_b32 v9, v8
    s_waitcnt lgkmcnt(0)
    v_cmp_gt_u32 vcc, s96, v9
    s_cbranch_vccz L_lw_105e
    s_sleep 8
    s_sub_u32 s60, s60, 1
    s_cbranch_scc0 L_lw_105
    s_mov_b32 s60, 0
L_lw_105e:
    v_and_b32 v2, 15, v0
    v_lshlrev_b32 v2, 3, v2
    v_add_u32 v3, 161920, v2
    ds_read_b64 v[8:9], v3
    s_lshl_b32 s99, s37, 5
    s_add_u32 s99, s99, s36
    s_lshl_b32 s99, s99, 7
    s_add_u32 s99, s99, 73728
    s_lshl_b32 s62, s38, 6
    s_add_u32 s62, s62, s99
    s_getreg_b32 s58, hwreg(HW_REG_XCC_ID, 0, 4)
    v_mov_b32 v10, s58
    s_lshl_b32 s98, s34, 5
    s_add_u32 s98, s98, s35
    s_lshl_b32 s63, s98, 2
    s_add_u32 s63, s63, 229376
    s_lshl_b32 s98, s98, 8
    s_add_u32 s98, s98, 90112
    v_lshlrev_b32 v39, 2, v0
    s_bfm_b64 exec, s96, 0
    s_waitcnt lgkmcnt(0)
    buffer_store_dwordx2 v[8:9], v2, s[40:43], s62 offen sc1
    s_mov_b64 exec, 1
    buffer_store_dword v10, v36, s[40:43], s63 offen sc1
    s_mov_b64 exec, -1
    s_mov_b32 s100, 4
    s_lshl_b32 s63, s100, 8
    v_and_b32 v8, 15, v0
    v_lshl_add_u32 v8, v8, 4, s63
    v_lshrrev_b32 v9, 4, v0
    v_mul_u32_u24 v5, 1280, v9
    v_add_u32 v5, v5, v8
    v_mul_u32_u24 v4, 1296, v9
    v_add_u32 v4, v4, v8
    v_add_u32 v4, 81920, v4
    v_lshlrev_b32 v6, 1, v5
    v_add_u32 v6, 87104, v6
    s_lshl_b32 s62, s100, 3
    s_add_u32 s62, s62, 97344
    v_lshl_add_u32 v7, v9, 6, s62
    s_mov_b32 s48, s4
    s_mov_b32 s49, s5
    s_mov_b32 s50, 5120
    s_mov_b32 s51, 0x20000
    buffer_load_dwordx4 v[8:11], v5, s[48:51], 0 offen
    s_mov_b32 s62, 20480
    s_mov_b32 s63, 30720
L_poll_106:
    buffer_load_dwordx4 v[12:15], v5, s[40:43], s62 offen sc1
    buffer_load_dwordx4 v[16:19], v5, s[40:43], s63 offen sc1
    s_waitcnt vmcnt(0)
    v_max3_u32 v38, v12, v13, v14
    v_max3_u32 v38, v38, v15, v16
    v_max3_u32 v38, v38, v17, v18
    v_max_u32 v38, v38, v19
    v_cmp_eq_u32 vcc, -1, v38
    s_cbranch_vccz L_poll_106e
    s_sleep 32
    s_sub_u32 s60, s60, 1
    s_cbranch_scc0 L_poll_106
    s_mov_b32 s60, 0
L_poll_106e:
    v_lshlrev_b32 v40, 16, v8
    v_and_b32 v41, 0xffff0000, v8
    v_lshlrev_b32 v42, 16, v9
    v_and_b32 v43, 0xffff0000, v9
    v_lshlrev_b32 v44, 16, v10
    v_and_b32 v45, 0xffff0000, v10
    v_lshlrev_b32 v46, 16, v11
    v_and_b32 v47, 0xffff0000, v11
    v_lshlrev_b32 v48, 16, v12
    v_and_b32 v49, 0xffff0000, v12
    v_lshlrev_b32 v50, 16, v13
    v_and_b32 v51, 0xffff0000, v13
    v_lshlrev_b32 v52, 16, v14
    v_and_b32 v53, 0xffff0000, v14
    v_lshlrev_b32 v54, 16, v15
    v_and_b32 v55, 0xffff0000, v15
    v_lshlrev_b32 v56, 16, v16
    v_and_b32 v57, 0xffff0000, v16
    v_lshlrev_b32 v58, 16, v17
    v_and_b32 v59, 0xffff0000, v17
    v_lshlrev_b32 v60, 16, v18
    v_and_b32 v61, 0xffff0000, v18
    v_lshlrev_b32 v62, 16, v19
    v_and_b32 v63, 0xffff0000, v19
    v_mov_b32 v64, 0
    v_mov_b32 v65, 0
    v_mov_b32 v66, 0
    v_mov_b32 v67, 0
    v_mov_b32 v68, 0
    v_mov_b32 v69, 0
    v_mov_b32 v70, 0
    v_mov_b32 v71, 0
    s_or_b32 s96, s59, s39
    s_cbranch_scc0 L_nofrag_107
    v_mov_b32 v104, 162060
L_lw_108:
    ds_read_b32 v105, v104
    s_waitcnt lgkmcnt(0)
    v_cmp_gt_u32 vcc, 4, v105
    s_cbranch_vccz L_lw_108e
    s_sleep 2
    s_sub_u32 s60, s60, 1
    s_cbranch_scc0 L_lw_108
    s_mov_b32 s60, 0
L_lw_108e:
    s_cmp_eq_u32 s59, 0
    s_cbranch_scc1 L_nofrag_107
    v_lshrrev_b32 v109, 4, v0
    v_bfe_u32 v104, v0, 1, 1
    v_lshl_add_u32 v104, v109, 1, v104
    v_bfe_u32 v110, v0, 2, 2
    v_lshl_add_u32 v104, v104, 3, v110
    v_lshlrev_b32 v104, 7, v104
    v_and_b32 v110, 1, v0
    v_lshl_add_u32 v104, v110, 3, v104
    s_lshl_b32 s96, s3, 13
    s_add_u32 s96, s96, 81920
    v_add_u32 v104, s96, v104
    ds_read_b64_tr_b16 v[72:73], v104 offset:0
    ds_read_b64_tr_b16 v[74:75], v104 offset:512
    ds_read_b64_tr_b16 v[76:77], v104 offset:16
    ds_read_b64_tr_b16 v[78:79], v104 offset:528
    ds_read_b64_tr_b16 v[80:81], v104 offset:32
    ds_read_b64_tr_b16 v[82:83], v104 offset:544
    ds_read_b64_tr_b16 v[84:85], v104 offset:48
    ds_read_b64_tr_b16 v[86:87], v104 offset:560
    ds_read_b64_tr_b16 v[88:89], v104 offset:64
    ds_read_b64_tr_b16 v[90:91], v104 offset:576
    ds_read_b64_tr_b16 v[92:93], v104 offset:80
    ds_read_b64_tr_b16 v[94:95], v104 offset:592
    ds_read_b64_tr_b16 v[96:97], v104 offset:96
    ds_read_b64_tr_b16 v[98:99], v104 offset:608
    ds_read_b64_tr_b16 v[100:101], v104 offset:112
    ds_read_b64_tr_b16 v[102:103], v104 offset:624
    v_bfe_u32 v105, v0, 1, 3
    v_lshlrev_b32 v105, 8, v105
    v_lshl_add_u32 v105, v109, 5, v105
    v_lshl_add_u32 v105, v110, 4, v105
    v_mul_u32_u24 v106, 320, v109
    v_bfe_u32 v110, v0, 3, 1
    v_mul_u32_u24 v110, 160, v110
    v_add_u32 v106, v106, v110
    v_and_b32 v110, 7, v0
    v_lshl_add_u32 v107, v110, 4, v106
    v_add_u32 v107, 81920, v107
    v_lshl_add_u32 v106, v110, 2, v106
    v_add_u32 v106, s96, v106
    v_mul_u32_u24 v108, 1280, v109
    v_add_u32 v108, v108, v2
    s_lshr_b32 s96, s3, 1
    s_lshl_b32 s96, s96, 11
    s_and_b32 s100, s3, 1
    s_lshl_b32 s100, s100, 7
    s_add_u32 s100, s100, s96
    s_lshl_b32 s96, s34, 13
    s_add_u32 s100, s100, s96
    s_add_u32 s100, s100, 90112
    s_mul_i32 s101, s34, 5120
    s_lshl_b32 s96, s35, 7
    s_add_u32 s101, s101, s96
    s_add_u32 s101, s101, 152832
L_nofrag_107:
    v_mov_b32 v12, 162076
L_lw_109:
    ds_read_b32 v13, v12
    s_waitcnt lgkmcnt(0)
    v_cmp_gt_u32 vcc, 4, v13
    s_cbranch_vccz L_lw_109e
    s_sleep 4
    s_sub_u32 s60, s60, 1
    s_cbranch_scc0 L_lw_109
    s_mov_b32 s60, 0
L_lw_109e:
    v_and_b32 v11, 31, v0
    v_lshlrev_b32 v11, 2, v11
    s_lshl_b32 s63, s34, 7
    s_add_u32 s63, s63, 229376
    buffer_load_dword v12, v39, s[40:43], s98 offen sc1
L_poll_110:
    buffer_load_dwordx2 v[8:9], v2, s[40:43], s99 offen sc1
    buffer_load_dword v10, v11, s[40:43], s63 offen sc1
    buffer_load_dwordx4 v[32:35], v20, s[40:43], s97 offen sc1
    s_waitcnt vmcnt(0)
    v_max3_u32 v38, v8, v9, v10
    v_max3_u32 v38, v38, v32, v33
    v_max3_u32 v38, v38, v34, v35
    v_cmp_eq_u32 vcc, -1, v38
    s_cbranch_vccz L_poll_110e
    s_sleep 16
    s_sub_u32 s60, s60, 1
    s_cbranch_scc0 L_poll_110
    s_mov_b32 s60, 0
L_poll_110e:
    v_mov_b32 v37, v8
    s_nop 1
    v_max_f32_dpp v37, v37, v37 quad_perm:[1,0,3,2] row_mask:0xf bank_mask:0xf
    s_nop 1
    v_max_f32_dpp v37, v37, v37 quad_perm:[2,3,0,1] row_mask:0xf bank_mask:0xf
    s_nop 1
    v_max_f32_dpp v37, v37, v37 row_ror:4 row_mask:0xf bank_mask:0xf
    s_nop 1
    v_max_f32_dpp v37, v37, v37 row_ror:8 row_mask:0xf bank_mask:0xf
    v_sub_f32 v8, v8, v37
    v_exp_f32 v8, v8
    s_nop 0
    v_mul_f32 v9, v8, v9
    s_nop 1
    v_add_f32_dpp v9, v9, v9 quad_perm:[1,0,3,2] row_mask:0xf bank_mask:0xf
    s_nop 1
    v_add_f32_dpp v9, v9, v9 quad_perm:[2,3,0,1] row_mask:0xf bank_mask:0xf
    s_nop 1
    v_add_f32_dpp v9, v9, v9 row_ror:4 row_mask:0xf bank_mask:0xf
    s_nop 1
    v_add_f32_dpp v9, v9, v9 row_ror:8 row_mask:0xf bank_mask:0xf
    s_getreg_b32 s62, hwreg(HW_REG_XCC_ID, 0, 4)
    v_cmp_ne_u32 vcc, s62, v10
    s_nop 0
    s_cmp_eq_u64 vcc, 0
    s_cselect_b32 s61, 1, 0
    v_rcp_f32 v9, v9
    v_lshrrev_b32 v3, 1, v2
    v_add_u32 v3, 161984, v3
    v_mul_f32 v8, v8, v9
    v_mov_b32 v10, 162072
    v_mov_b32 v11, s61
    ds_write_b32 v3, v8
    ds_write_b32 v10, v11
    s_branch L_pxj
L_px6:
    s_or_b32 s96, s59, s39
    s_cbranch_scc0 L_nofrag_111
    v_mov_b32 v104, 162060
L_lw_112:
    ds_read_b32 v105, v104
    s_waitcnt lgkmcnt(0)
    v_cmp_gt_u32 vcc, 4, v105
    s_cbranch_vccz L_lw_112e
    s_sleep 2
    s_sub_u32 s60, s60, 1
    s_cbranch_scc0 L_lw_112
    s_mov_b32 s60, 0
L_lw_112e:
    s_cmp_eq_u32 s59, 0
    s_cbranch_scc1 L_nofrag_111
    v_lshrrev_b32 v109, 4, v0
    v_bfe_u32 v104, v0, 1, 1
    v_lshl_add_u32 v104, v109, 1, v104
    v_bfe_u32 v110, v0, 2, 2
    v_lshl_add_u32 v104, v104, 3, v110
    v_lshlrev_b32 v104, 7, v104
    v_and_b32 v110, 1, v0
    v_lshl_add_u32 v104, v110, 3, v104
    s_lshl_b32 s96, s3, 13
    s_add_u32 s96, s96, 81920
    v_add_u32 v104, s96, v104
    ds_read_b64_tr_b16 v[72:73], v104 offset:0
    ds_read_b64_tr_b16 v[74:75], v104 offset:512
    ds_read_b64_tr_b16 v[76:77], v104 offset:16
    ds_read_b64_tr_b16 v[78:79], v104 offset:528
    ds_read_b64_tr_b16 v[80:81], v104 offset:32
    ds_read_b64_tr_b16 v[82:83], v104 offset:544
    ds_read_b64_tr_b16 v[84:85], v104 offset:48
    ds_read_b64_tr_b16 v[86:87], v104 offset:560
    ds_read_b64_tr_b16 v[88:89], v104 offset:64
    ds_read_b64_tr_b16 v[90:91], v104 offset:576
    ds_read_b64_tr_b16 v[92:93], v104 offset:80
    ds_read_b64_tr_b16 v[94:95], v104 offset:592
    ds_read_b64_tr_b16 v[96:97], v104 offset:96
    ds_read_b64_tr_b16 v[98:99], v104 offset:608
    ds_read_b64_tr_b16 v[100:101], v104 offset:112
    ds_read_b64_tr_b16 v[102:103], v104 offset:624
    v_bfe_u32 v105, v0, 1, 3
    v_lshlrev_b32 v105, 8, v105
    v_lshl_add_u32 v105, v109, 5, v105
    v_lshl_add_u32 v105, v110, 4, v105
    v_mul_u32_u24 v106, 320, v109
    v_bfe_u32 v110, v0, 3, 1
    v_mul_u32_u24 v110, 160, v110
    v_add_u32 v106, v106, v110
    v_and_b32 v110, 7, v0
    v_lshl_add_u32 v107, v110, 4, v106
    v_add_u32 v107, 81920, v107
    v_lshl_add_u32 v106, v110, 2, v106
    v_add_u32 v106, s96, v106
    v_mul_u32_u24 v108, 1280, v109
    v_add_u32 v108, v108, v2
    s_lshr_b32 s96, s3, 1
    s_lshl_b32 s96, s96, 11
    s_and_b32 s100, s3, 1
    s_lshl_b32 s100, s100, 7
    s_add_u32 s100, s100, s96
    s_lshl_b32 s96, s34, 13
    s_add_u32 s100, s100, s96
    s_add_u32 s100, s100, 90112
    s_mul_i32 s101, s34, 5120
    s_lshl_b32 s96, s35, 7
    s_add_u32 s101, s101, s96
    s_add_u32 s101, s101, 152832
L_nofrag_111:
    v_mov_b32 v8, 162076
L_lw_113:
    ds_read_b32 v9, v8
    s_waitcnt lgkmcnt(0)
    v_cmp_gt_u32 vcc, 4, v9
    s_cbranch_vccz L_lw_113e
    s_sleep 16
    s_sub_u32 s60, s60, 1
    s_cbranch_scc0 L_lw_113
    s_mov_b32 s60, 0
L_lw_113e:
L_poll_114:
    buffer_load_dwordx4 v[32:35], v20, s[40:43], s97 offen sc1
    s_waitcnt vmcnt(0)
    v_max3_u32 v38, v32, v33, v34
    v_max_u32 v38, v38, v35
    v_cmp_eq_u32 vcc, -1, v38
    s_cbranch_vccz L_poll_114e
    s_sleep 16
    s_sub_u32 s60, s60, 1
    s_cbranch_scc0 L_poll_114
    s_mov_b32 s60, 0
L_poll_114e:
L_pxj:
    v_mov_b32 v8, 162048
L_lw_115:
    ds_read_b32 v9, v8
    s_waitcnt lgkmcnt(0)
    v_cmp_gt_u32 vcc, 3, v9
    s_cbranch_vccz L_lw_115e
    s_sleep 2
    s_sub_u32 s60, s60, 1
    s_cbranch_scc0 L_lw_115
    s_mov_b32 s60, 0
L_lw_115e:
    v_lshrrev_b32 v9, 4, v0
    v_lshl_add_u32 v8, v9, 2, v2
    s_lshl_b32 s96, s3, 9
    s_add_u32 s96, s96, 157824
    v_lshl_add_u32 v8, v8, 2, s96
    v_lshlrev_b32 v9, 3, v0
    v_add_u32 v9, 157824, v9
    v_mov_b32 v10, 162048
    v_mov_b32 v11, 1
    s_lshl_b32 s96, s38, 5
    s_add_u32 s96, s96, 161984
    v_mov_b32 v3, s96
    s_sub_u32 s62, 8, s39
    s_lshl_b32 s98, s34, 5
    s_add_u32 s98, s98, s35
    s_lshl_b32 s98, s98, 8
    s_add_u32 s98, s98, 90112
    v_lshlrev_b32 v39, 2, v0
    s_branch L_t0
L_s_role:
    s_cmp_eq_u32 s3, 7
    s_cbranch_scc1 L_t2gate
    s_cmp_gt_u32 s3, 3
    s_cbranch_scc1 L_fin_prep
    s_mov_b32 s48, s18
    s_mov_b32 s49, s19
    s_mov_b32 s50, 3456
    s_mov_b32 s51, 0x20000
    v_lshrrev_b32 v3, 4, v0
    v_bfe_u32 v1, v0, 2, 2
    v_and_b32 v2, 3, v0
    v_lshl_add_u32 v4, v3, 2, v1
    v_lshlrev_b32 v4, 1, v4
    s_lshl_b32 s62, s35, 7
    s_lshl_b32 s63, s3, 5
    s_add_u32 s62, s62, s63
    buffer_load_ushort v82, v4, s[48:51], s62 offen
    v_mov_b32 v72, 162064
L_lw_116:
    ds_read_b32 v73, v72
    s_waitcnt lgkmcnt(0)
    v_cmp_gt_u32 vcc, 4, v73
    s_cbranch_vccz L_lw_116e
    s_sleep 2
    s_sub_u32 s60, s60, 1
    s_cbranch_scc0 L_lw_116
    s_mov_b32 s60, 0
L_lw_116e:
    v_lshrrev_b32 v72, 4, v0
    v_lshlrev_b32 v72, 10, v72
    v_bfe_u32 v73, v0, 2, 2
    v_lshl_add_u32 v72, v73, 7, v72
    v_and_b32 v73, 3, v0
    v_lshl_add_u32 v72, v73, 3, v72
    v_bfe_u32 v73, v0, 3, 2
    v_lshl_add_u32 v72, v73, 5, v72
    v_xor_b32 v72, s63, v72
    v_add_u32 v73, 40960, v72
    v_and_b32 v5, 7, v0
    v_mul_u32_u24 v5, 1296, v5
    v_lshl_add_u32 v5, v3, 4, v5
    v_add_u32 v5, 147456, v5
    ds_read_b64_tr_b16 v[88:89], v72 offset:0
    ds_read_b64_tr_b16 v[90:91], v72 offset:512
    ds_read_b64_tr_b16 v[92:93], v72 offset:4096
    ds_read_b64_tr_b16 v[94:95], v72 offset:4608
    ds_read_b64_tr_b16 v[96:97], v72 offset:8192
    ds_read_b64_tr_b16 v[98:99], v72 offset:8704
    ds_read_b64_tr_b16 v[100:101], v72 offset:12288
    ds_read_b64_tr_b16 v[102:103], v72 offset:12800
    ds_read_b64_tr_b16 v[104:105], v72 offset:16384
    ds_read_b64_tr_b16 v[106:107], v72 offset:16896
    ds_read_b64_tr_b16 v[108:109], v72 offset:20480
    ds_read_b64_tr_b16 v[110:111], v72 offset:20992
    ds_read_b64_tr_b16 v[112:113], v72 offset:24576
    ds_read_b64_tr_b16 v[114:115], v72 offset:25088
    ds_read_b64_tr_b16 v[116:117], v72 offset:28672
    ds_read_b64_tr_b16 v[118:119], v72 offset:29184
    ds_read_b64_tr_b16 v[120:121], v72 offset:32768
    ds_read_b64_tr_b16 v[122:123], v72 offset:33280
    ds_read_b64_tr_b16 v[124:125], v72 offset:36864
    ds_read_b64_tr_b16 v[126:127], v72 offset:37376
    ds_read_b64_tr_b16 v[128:129], v73 offset:0
    ds_read_b64_tr_b16 v[130:131], v73 offset:512
    ds_read_b64_tr_b16 v[132:133], v73 offset:4096
    ds_read_b64_tr_b16 v[134:135], v73 offset:4608
    ds_read_b64_tr_b16 v[136:137], v73 offset:8192
    ds_read_b64_tr_b16 v[138:139], v73 offset:8704
    ds_read_b64_tr_b16 v[140:141], v73 offset:12288
    ds_read_b64_tr_b16 v[142:143], v73 offset:12800
    ds_read_b64_tr_b16 v[144:145], v73 offset:16384
    ds_read_b64_tr_b16 v[146:147], v73 offset:16896
    ds_read_b64_tr_b16 v[148:149], v73 offset:20480
    ds_read_b64_tr_b16 v[150:151], v73 offset:20992
    ds_read_b64_tr_b16 v[152:153], v73 offset:24576
    ds_read_b64_tr_b16 v[154:155], v73 offset:25088
    ds_read_b64_tr_b16 v[156:157], v73 offset:28672
    ds_read_b64_tr_b16 v[158:159], v73 offset:29184
    ds_read_b64_tr_b16 v[160:161], v73 offset:32768
    ds_read_b64_tr_b16 v[162:163], v73 offset:33280
    ds_read_b64_tr_b16 v[164:165], v73 offset:36864
    ds_read_b64_tr_b16 v[166:167], v73 offset:37376
    ds_read_b128 v[8:11], v5 offset:0
    ds_read_b128 v[12:15], v5 offset:64
    ds_read_b128 v[16:19], v5 offset:128
    ds_read_b128 v[20:23], v5 offset:192
    ds_read_b128 v[24:27], v5 offset:256
    ds_read_b128 v[28:31], v5 offset:320
    ds_read_b128 v[32:35], v5 offset:384
    ds_read_b128 v[36:39], v5 offset:448
    ds_read_b128 v[40:43], v5 offset:512
    ds_read_b128 v[44:47], v5 offset:576
    s_waitcnt lgkmcnt(9)
    v_mfma_f32_16x16x32_bf16 v[48:51], v[88:91], v[8:11], 0
    s_waitcnt lgkmcnt(8)
    v_mfma_f32_16x16x32_bf16 v[48:51], v[92:95], v[12:15], v[48:51]
    s_waitcnt lgkmcnt(7)
    v_mfma_f32_16x16x32_bf16 v[48:51], v[96:99], v[16:19], v[48:51]
    s_waitcnt lgkmcnt(6)
    v_mfma_f32_16x16x32_bf16 v[48:51], v[100:103], v[20:23], v[48:51]
    s_waitcnt lgkmcnt(5)
    v_mfma_f32_16x16x32_bf16 v[48:51], v[104:107], v[24:27], v[48:51]
    s_waitcnt lgkmcnt(4)
    v_mfma_f32_16x16x32_bf16 v[48:51], v[108:111], v[28:31], v[48:51]
    s_waitcnt lgkmcnt(3)
    v_mfma_f32_16x16x32_bf16 v[48:51], v[112:115], v[32:35], v[48:51]
    s_waitcnt lgkmcnt(2)
    v_mfma_f32_16x16x32_bf16 v[48:51], v[116:119], v[36:39], v[48:51]
    s_waitcnt lgkmcnt(1)
    v_mfma_f32_16x16x32_bf16 v[48:51], v[120:123], v[40:43], v[48:51]
    s_waitcnt lgkmcnt(0)
    v_mfma_f32_16x16x32_bf16 v[48:51], v[124:127], v[44:47], v[48:51]
    ds_read_b128 v[8:11], v5 offset:640
    ds_read_b128 v[12:15], v5 offset:704
    ds_read_b128 v[16:19], v5 offset:768
    ds_read_b128 v[20:23], v5 offset:832
    ds_read_b128 v[24:27], v5 offset:896
    ds_read_b128 v[28:31], v5 offset:960
    ds_read_b128 v[32:35], v5 offset:1024
    ds_read_b128 v[36:39], v5 offset:1088
    ds_read_b128 v[40:43], v5 offset:1152
    ds_read_b128 v[44:47], v5 offset:1216
    s_waitcnt lgkmcnt(9)
    v_mfma_f32_16x16x32_bf16 v[48:51], v[128:131], v[8:11], v[48:51]
    s_waitcnt lgkmcnt(8)
    v_mfma_f32_16x16x32_bf16 v[48:51], v[132:135], v[12:15], v[48:51]
    s_waitcnt lgkmcnt(7)
    v_mfma_f32_16x16x32_bf16 v[48:51], v[136:139], v[16:19], v[48:51]
    s_waitcnt lgkmcnt(6)
    v_mfma_f32_16x16x32_bf16 v[48:51], v[140:143], v[20:23], v[48:51]
    s_waitcnt lgkmcnt(5)
    v_mfma_f32_16x16x32_bf16 v[48:51], v[144:147], v[24:27], v[48:51]
    s_waitcnt lgkmcnt(4)
    v_mfma_f32_16x16x32_bf16 v[48:51], v[148:151], v[28:31], v[48:51]
    s_waitcnt lgkmcnt(3)
    v_mfma_f32_16x16x32_bf16 v[48:51], v[152:155], v[32:35], v[48:51]
    s_waitcnt lgkmcnt(2)
    v_mfma_f32_16x16x32_bf16 v[48:51], v[156:159], v[36:39], v[48:51]
    s_waitcnt lgkmcnt(1)
    v_mfma_f32_16x16x32_bf16 v[48:51], v[160:163], v[40:43], v[48:51]
    s_waitcnt lgkmcnt(0)
    v_mfma_f32_16x16x32_bf16 v[48:51], v[164:167], v[44:47], v[48:51]
    v_mul_u32_u24 v79, 1296, v2
    v_lshl_add_u32 v79, v1, 6, v79
    v_lshl_add_u32 v79, v3, 4, v79
    v_add_u32 v79, 81920, v79
    v_mul_u32_u24 v80, 144, v2
    v_add3_u32 v80, v80, v4, s63
    v_add_u32 v80, 97600, v80
    v_lshlrev_b32 v81, 6, v2
    v_add_u32 v81, 97344, v81
    v_mov_b32_dpp v84, v48 quad_perm:[0,1,2,3] row_mask:0xf bank_mask:0x1
    v_mov_b32_dpp v85, v48 row_ror:4 row_mask:0xf bank_mask:0x1
    v_mov_b32_dpp v84, v49 row_ror:4 row_mask:0xf bank_mask:0x2
    v_mov_b32_dpp v85, v49 quad_perm:[0,1,2,3] row_mask:0xf bank_mask:0x2
    v_mov_b32_dpp v84, v50 quad_perm:[0,1,2,3] row_mask:0xf bank_mask:0x4
    v_mov_b32_dpp v85, v50 row_ror:4 row_mask:0xf bank_mask:0x4
    v_mov_b32_dpp v84, v51 row_ror:4 row_mask:0xf bank_mask:0x8
    v_mov_b32_dpp v85, v51 quad_perm:[0,1,2,3] row_mask:0xf bank_mask:0x8
    s_mov_b32 s62, 0xbacccccd
    s_mov_b32 s63, 0xbdd2d3e8
    v_mov_b32 v86, 0xc0135761
    s_branch L_ffn1
L_fin_prep:
    s_mul_i32 s62, s35, 3
    s_add_u32 s62, s62, s3
    s_sub_u32 s62, s62, 4
    s_cmp_ge_u32 s62, 80
    s_cbranch_scc1 L_end
    s_lshl_b32 s96, s62, 7
    s_lshl_b32 s57, s62, 6
    s_mul_i32 s63, s62, 0xccd
    s_lshr_b32 s63, s63, 16
    s_mul_i32 s63, s63, 1280
    s_sub_u32 s63, s57, s63
    s_add_u32 s96, s96, 262144
    s_add_u32 s97, s96, 81920
    s_add_u32 s98, s96, 163840
    s_add_u32 s99, s96, 245760
    v_lshrrev_b32 v72, 3, v0
    v_mul_u32_u24 v72, 10240, v72
    v_and_b32 v1, 7, v0
    v_lshl_add_u32 v72, v1, 4, v72
    v_mov_b32 v100, 0
    v_mov_b32 v101, 0
    v_mov_b32 v102, 0
    v_mov_b32 v103, 0
    v_bfe_u32 v3, v0, 4, 1
    v_lshrrev_b32 v4, 5, v0
    v_lshl_add_u32 v3, v3, 1, v4
    v_lshl_add_u32 v73, v1, 2, v3
    v_lshlrev_b32 v73, 1, v73
    s_lshl_b32 s62, s57, 1
    s_add_u32 s62, s62, 87104
    v_lshl_add_u32 v74, v73, 1, s62
    s_mov_b32 s48, s22
    s_mov_b32 s49, s23
    s_mov_b32 s50, 1280
    s_mov_b32 s51, 0x20000
    s_mov_b32 s52, s28
    s_mov_b32 s53, s29
    s_mov_b32 s54, 5120
    s_mov_b32 s55, 0x20000
    buffer_load_dwordx4 v[88:91], v72, s[40:43], s96 offen sc1
    buffer_load_dwordx4 v[92:95], v72, s[40:43], s97 offen sc1
    buffer_load_dwordx4 v[96:99], v72, s[40:43], s98 offen sc1
    s_mov_b64 exec, 0xffffff
    buffer_load_dwordx4 v[100:103], v72, s[40:43], s99 offen sc1
    s_mov_b64 exec, -1
    buffer_load_ushort v75, v73, s[48:51], s63 offen
    v_and_b32 v77, 0xfffc, v73
    s_add_u32 s62, s57, 35840
    buffer_load_dword v76, v77, s[40:43], s62 offen sc1
    s_barrier
    s_waitcnt vmcnt(0)
    v_cmp_eq_u32 vcc, -1, v76
    s_cbranch_vccz L_gbok
L_poll_117:
    buffer_load_dword v76, v77, s[40:43], s62 offen sc1
    s_waitcnt vmcnt(0)
    v_cmp_eq_u32 vcc, -1, v76
    s_cbranch_vccz L_poll_117e
    s_sleep 2
    s_sub_u32 s60, s60, 1
    s_cbranch_scc0 L_poll_117
    s_mov_b32 s60, 0
L_poll_117e:
L_gbok:
    v_lshlrev_b32 v75, 16, v75
    v_and_b32 v77, 2, v73
    v_lshlrev_b32 v77, 3, v77
    v_lshrrev_b32 v76, v77, v76
    v_lshlrev_b32 v76, 16, v76
    s_barrier
    s_barrier
    ds_read_b32 v78, v74
    s_barrier
    s_mov_b64 s[4:5], -1
    s_mov_b64 s[6:7], -1
    s_mov_b64 s[8:9], -1
    s_mov_b64 s[10:11], 0xffffff
L_yg:
    s_mov_b64 exec, s[4:5]
    buffer_load_dwordx4 v[88:91], v72, s[40:43], s96 offen sc1
    s_mov_b64 exec, s[6:7]
    buffer_load_dwordx4 v[92:95], v72, s[40:43], s97 offen sc1
    s_mov_b64 exec, s[8:9]
    buffer_load_dwordx4 v[96:99], v72, s[40:43], s98 offen sc1
    s_mov_b64 exec, s[10:11]
    buffer_load_dwordx4 v[100:103], v72, s[40:43], s99 offen sc1
    s_mov_b64 exec, -1
    s_waitcnt vmcnt(3)
    v_max3_u32 v3, v88, v89, v90
    v_max_u32 v3, v3, v91
    v_cmp_eq_u32 s[4:5], -1, v3
    s_waitcnt vmcnt(2)
    v_max3_u32 v3, v92, v93, v94
    v_max_u32 v3, v3, v95
    v_cmp_eq_u32 s[6:7], -1, v3
    s_waitcnt vmcnt(1)
    v_max3_u32 v3, v96, v97, v98
    v_max_u32 v3, v3, v99
    v_cmp_eq_u32 s[8:9], -1, v3
    s_waitcnt vmcnt(0)
    v_max3_u32 v3, v100, v101, v102
    v_max_u32 v3, v3, v103
    v_cmp_eq_u32 s[10:11], -1, v3
    s_or_b64 s[16:17], s[4:5], s[6:7]
    s_or_b64 s[16:17], s[16:17], s[8:9]
    s_or_b64 s[16:17], s[16:17], s[10:11]
    s_cbranch_scc0 L_ygd
    s_sub_u32 s60, s60, 1
    s_cbranch_scc0 L_yg
L_ygd:
    v_pk_add_f32 v[88:89], v[88:89], v[92:93]
    v_pk_add_f32 v[90:91], v[90:91], v[94:95]
    v_pk_add_f32 v[96:97], v[96:97], v[100:101]
    v_pk_add_f32 v[98:99], v[98:99], v[102:103]
    v_pk_add_f32 v[88:89], v[88:89], v[96:97]
    v_pk_add_f32 v[90:91], v[90:91], v[98:99]
    s_nop 0
    v_permlane32_swap_b32 v88, v89
    v_permlane32_swap_b32 v90, v91
    v_add_f32 v88, v88, v89
    v_add_f32 v90, v90, v91
    s_nop 1
    v_permlane16_swap_b32 v88, v90
    v_add_f32 v88, v88, v90
    s_waitcnt lgkmcnt(0)
    s_nop 0
    v_add_f32_dpp v88, v88, v88 row_ror:8 row_mask:0xf bank_mask:0xf
    v_add_f32 v88, v88, v75
    v_fma_f32 v88, v88, v76, v78
    v_cvt_pk_bf16_f32 v88, v88, v88
    s_mov_b32 exec_lo, 0x00ff00ff
    s_mov_b32 exec_hi, 0x00ff00ff
    buffer_store_short v88, v73, s[52:55], s57 offen
    s_endpgm
L_t2gate:
    s_cmp_ge_u32 s35, 22
    s_cselect_b32 s62, 8, 0
    v_mov_b32 v8, 162052
L_lw_118:
    ds_read_b32 v9, v8
    s_waitcnt lgkmcnt(0)
    v_cmp_gt_u32 vcc, s62, v9
    s_cbranch_vccz L_lw_118e
    s_sleep 2
    s_sub_u32 s60, s60, 1
    s_cbranch_scc0 L_lw_118
    s_mov_b32 s60, 0
L_lw_118e:
    v_mov_b32 v8, 162048
L_lw_119:
    ds_read_b32 v9, v8
    s_waitcnt lgkmcnt(0)
    v_cmp_gt_u32 vcc, 8, v9
    s_cbranch_vccz L_lw_119e
    s_sleep 2
    s_sub_u32 s60, s60, 1
    s_cbranch_scc0 L_lw_119
    s_mov_b32 s60, 0
L_lw_119e:
    ds_read_b32 v9, v8 offset:24
    s_waitcnt lgkmcnt(0)
    v_readfirstlane_b32 s61, v9
    s_mov_b32 s58, 0x3f80
    s_mov_b32 s59, 0x3f800000
    s_mov_b32 s63, 0xff
L_pg:
    s_bitcmp0_b32 s63, 0
    s_cbranch_scc1 L_pgi0
    s_mov_b32 s62, 155648
    buffer_load_dwordx4 v[8:11], v5, s[40:43], s62 offen sc1
L_pgi0:
    s_bitcmp0_b32 s63, 1
    s_cbranch_scc1 L_pgi1
    s_mov_b32 s62, 160768
    buffer_load_dwordx4 v[12:15], v5, s[40:43], s62 offen sc1
L_pgi1:
    s_bitcmp0_b32 s63, 2
    s_cbranch_scc1 L_pgi2
    s_mov_b32 s62, 165888
    buffer_load_dwordx4 v[16:19], v5, s[40:43], s62 offen sc1
L_pgi2:
    s_bitcmp0_b32 s63, 3
    s_cbranch_scc1 L_pgi3
    s_mov_b32 s62, 171008
    buffer_load_dwordx4 v[20:23], v5, s[40:43], s62 offen sc1
L_pgi3:
    s_bitcmp0_b32 s63, 4
    s_cbranch_scc1 L_pgi4
    s_mov_b32 s62, 176128
    buffer_load_dwordx4 v[24:27], v5, s[40:43], s62 offen sc1
L_pgi4:
    s_bitcmp0_b32 s63, 5
    s_cbranch_scc1 L_pgi5
    s_mov_b32 s62, 181248
    buffer_load_dwordx4 v[28:31], v5, s[40:43], s62 offen sc1
L_pgi5:
    s_bitcmp0_b32 s63, 6
    s_cbranch_scc1 L_pgi6
    s_mov_b32 s62, 186368
    buffer_load_dwordx4 v[32:35], v5, s[40:43], s62 offen sc1
L_pgi6:
    s_bitcmp0_b32 s63, 7
    s_cbranch_scc1 L_pgi7
    s_mov_b32 s62, 191488
    buffer_load_dwordx4 v[36:39], v5, s[40:43], s62 offen sc1
L_pgi7:
    s_sub_u32 s60, s60, 1
    s_cselect_b32 s62, 0, -1
    s_cselect_b32 s60, 0, s60
    s_waitcnt vmcnt(0)
    s_bitcmp0_b32 s63, 0
    s_cbranch_scc1 L_pgc0
    v_max3_u32 v3, v8, v9, v10
    v_max_u32 v3, v3, v11
    v_and_b32 v3, s62, v3
    v_cmp_eq_u32 vcc, -1, v3
    s_cbranch_vccnz L_pgc0
    v_dot2c_f32_bf16 v64, s58, v8
    v_dot2c_f32_bf16 v65, s59, v8
    v_dot2c_f32_bf16 v66, s58, v9
    v_dot2c_f32_bf16 v67, s59, v9
    v_dot2c_f32_bf16 v68, s58, v10
    v_dot2c_f32_bf16 v69, s59, v10
    v_dot2c_f32_bf16 v70, s58, v11
    v_dot2c_f32_bf16 v71, s59, v11
    s_bitset0_b32 s63, 0
L_pgc0:
    s_bitcmp0_b32 s63, 1
    s_cbranch_scc1 L_pgc1
    v_max3_u32 v3, v12, v13, v14
    v_max_u32 v3, v3, v15
    v_and_b32 v3, s62, v3
    v_cmp_eq_u32 vcc, -1, v3
    s_cbranch_vccnz L_pgc1
    v_dot2c_f32_bf16 v64, s58, v12
    v_dot2c_f32_bf16 v65, s59, v12
    v_dot2c_f32_bf16 v66, s58, v13
    v_dot2c_f32_bf16 v67, s59, v13
    v_dot2c_f32_bf16 v68, s58, v14
    v_dot2c_f32_bf16 v69, s59, v14
    v_dot2c_f32_bf16 v70, s58, v15
    v_dot2c_f32_bf16 v71, s59, v15
    s_bitset0_b32 s63, 1
L_pgc1:
    s_bitcmp0_b32 s63, 2
    s_cbranch_scc1 L_pgc2
    v_max3_u32 v3, v16, v17, v18
    v_max_u32 v3, v3, v19
    v_and_b32 v3, s62, v3
    v_cmp_eq_u32 vcc, -1, v3
    s_cbranch_vccnz L_pgc2
    v_dot2c_f32_bf16 v64, s58, v16
    v_dot2c_f32_bf16 v65, s59, v16
    v_dot2c_f32_bf16 v66, s58, v17
    v_dot2c_f32_bf16 v67, s59, v17
    v_dot2c_f32_bf16 v68, s58, v18
    v_dot2c_f32_bf16 v69, s59, v18
    v_dot2c_f32_bf16 v70, s58, v19
    v_dot2c_f32_bf16 v71, s59, v19
    s_bitset0_b32 s63, 2
L_pgc2:
    s_bitcmp0_b32 s63, 3
    s_cbranch_scc1 L_pgc3
    v_max3_u32 v3, v20, v21, v22
    v_max_u32 v3, v3, v23
    v_and_b32 v3, s62, v3
    v_cmp_eq_u32 vcc, -1, v3
    s_cbranch_vccnz L_pgc3
    v_dot2c_f32_bf16 v64, s58, v20
    v_dot2c_f32_bf16 v65, s59, v20
    v_dot2c_f32_bf16 v66, s58, v21
    v_dot2c_f32_bf16 v67, s59, v21
    v_dot2c_f32_bf16 v68, s58, v22
    v_dot2c_f32_bf16 v69, s59, v22
    v_dot2c_f32_bf16 v70, s58, v23
    v_dot2c_f32_bf16 v71, s59, v23
    s_bitset0_b32 s63, 3
L_pgc3:
    s_bitcmp0_b32 s63, 4
    s_cbranch_scc1 L_pgc4
    v_max3_u32 v3, v24, v25, v26
    v_max_u32 v3, v3, v27
    v_and_b32 v3, s62, v3
    v_cmp_eq_u32 vcc, -1, v3
    s_cbranch_vccnz L_pgc4
    v_dot2c_f32_bf16 v64, s58, v24
    v_dot2c_f32_bf16 v65, s59, v24
    v_dot2c_f32_bf16 v66, s58, v25
    v_dot2c_f32_bf16 v67, s59, v25
    v_dot2c_f32_bf16 v68, s58, v26
    v_dot2c_f32_bf16 v69, s59, v26
    v_dot2c_f32_bf16 v70, s58, v27
    v_dot2c_f32_bf16 v71, s59, v27
    s_bitset0_b32 s63, 4
L_pgc4:
    s_bitcmp0_b32 s63, 5
    s_cbranch_scc1 L_pgc5
    v_max3_u32 v3, v28, v29, v30
    v_max_u32 v3, v3, v31
    v_and_b32 v3, s62, v3
    v_cmp_eq_u32 vcc, -1, v3
    s_cbranch_vccnz L_pgc5
    v_dot2c_f32_bf16 v64, s58, v28
    v_dot2c_f32_bf16 v65, s59, v28
    v_dot2c_f32_bf16 v66, s58, v29
    v_dot2c_f32_bf16 v67, s59, v29
    v_dot2c_f32_bf16 v68, s58, v30
    v_dot2c_f32_bf16 v69, s59, v30
    v_dot2c_f32_bf16 v70, s58, v31
    v_dot2c_f32_bf16 v71, s59, v31
    s_bitset0_b32 s63, 5
L_pgc5:
    s_bitcmp0_b32 s63, 6
    s_cbranch_scc1 L_pgc6
    v_max3_u32 v3, v32, v33, v34
    v_max_u32 v3, v3, v35
    v_and_b32 v3, s62, v3
    v_cmp_eq_u32 vcc, -1, v3
    s_cbranch_vccnz L_pgc6
    v_dot2c_f32_bf16 v64, s58, v32
    v_dot2c_f32_bf16 v65, s59, v32
    v_dot2c_f32_bf16 v66, s58, v33
    v_dot2c_f32_bf16 v67, s59, v33
    v_dot2c_f32_bf16 v68, s58, v34
    v_dot2c_f32_bf16 v69, s59, v34
    v_dot2c_f32_bf16 v70, s58, v35
    v_dot2c_f32_bf16 v71, s59, v35
    s_bitset0_b32 s63, 6
L_pgc6:
    s_bitcmp0_b32 s63, 7
    s_cbranch_scc1 L_pgc7
    v_max3_u32 v3, v36, v37, v38
    v_max_u32 v3, v3, v39
    v_and_b32 v3, s62, v3
    v_cmp_eq_u32 vcc, -1, v3
    s_cbranch_vccnz L_pgc7
    v_dot2c_f32_bf16 v64, s58, v36
    v_dot2c_f32_bf16 v65, s59, v36
    v_dot2c_f32_bf16 v66, s58, v37
    v_dot2c_f32_bf16 v67, s59, v37
    v_dot2c_f32_bf16 v68, s58, v38
    v_dot2c_f32_bf16 v69, s59, v38
    v_dot2c_f32_bf16 v70, s58, v39
    v_dot2c_f32_bf16 v71, s59, v39
    s_bitset0_b32 s63, 7
L_pgc7:
    s_bcnt1_i32_b32 s62, s63
    s_cbranch_scc0 L_pgd
    s_cmp_gt_u32 s62, 3
    s_cbranch_scc1 L_pg
    s_ff1_i32_b32 s96, s63
    s_bitset0_b32 s63, s96
    s_mul_i32 s96, s96, 5120
    s_add_u32 s96, s96, 155648
    s_cmp_eq_u32 s62, 1
    s_cbranch_scc1 L_pt1
    s_ff1_i32_b32 s97, s63
    s_bitset0_b32 s63, s97
    s_mul_i32 s97, s97, 5120
    s_add_u32 s97, s97, 155648
    s_cmp_eq_u32 s62, 2
    s_cbranch_scc1 L_pt2
    s_ff1_i32_b32 s98, s63
    s_bitset0_b32 s63, s98
    s_mul_i32 s98, s98, 5120
    s_add_u32 s98, s98, 155648
L_pt3:
L_ptl3:
    buffer_load_dwordx4 v[16:19], v5, s[40:43], s96 offen sc1
    buffer_load_dwordx4 v[20:23], v5, s[40:43], s97 offen sc1
    buffer_load_dwordx4 v[24:27], v5, s[40:43], s98 offen sc1
    s_waitcnt vmcnt(0)
    v_max3_u32 v3, v16, v17, v18
    v_max3_u32 v3, v3, v19, v20
    v_max3_u32 v3, v3, v21, v22
    v_max3_u32 v3, v3, v23, v24
    v_max3_u32 v3, v3, v25, v26
    v_max_u32 v3, v3, v27
    v_cmp_eq_u32 vcc, -1, v3
    s_cbranch_vccz L_pta3
    s_sub_u32 s60, s60, 1
    s_cbranch_scc0 L_ptl3
    s_mov_b32 s60, 0
    s_branch L_pta3
L_pt2:
L_ptl2:
    buffer_load_dwordx4 v[16:19], v5, s[40:43], s96 offen sc1
    buffer_load_dwordx4 v[20:23], v5, s[40:43], s97 offen sc1
    s_waitcnt vmcnt(0)
    v_max3_u32 v3, v16, v17, v18
    v_max3_u32 v3, v3, v19, v20
    v_max3_u32 v3, v3, v21, v22
    v_max_u32 v3, v3, v23
    v_cmp_eq_u32 vcc, -1, v3
    s_cbranch_vccz L_pta2
    s_sub_u32 s60, s60, 1
    s_cbranch_scc0 L_ptl2
    s_mov_b32 s60, 0
    s_branch L_pta2
L_pt1:
L_ptl1:
    buffer_load_dwordx4 v[16:19], v5, s[40:43], s96 offen sc1
    s_waitcnt vmcnt(0)
    v_max3_u32 v3, v16, v17, v18
    v_max_u32 v3, v3, v19
    v_cmp_eq_u32 vcc, -1, v3
    s_cbranch_vccz L_pta1
    s_sub_u32 s60, s60, 1
    s_cbranch_scc0 L_ptl1
    s_mov_b32 s60, 0
L_pta1:
    v_dot2c_f32_bf16 v64, s58, v16
    v_dot2c_f32_bf16 v65, s59, v16
    v_dot2c_f32_bf16 v66, s58, v17
    v_dot2c_f32_bf16 v67, s59, v17
    v_dot2c_f32_bf16 v68, s58, v18
    v_dot2c_f32_bf16 v69, s59, v18
    v_dot2c_f32_bf16 v70, s58, v19
    v_dot2c_f32_bf16 v71, s59, v19
L_pgd:
    v_pk_fma_f32 v[64:65], v[64:65], v[48:49], v[40:41]
    v_pk_fma_f32 v[66:67], v[66:67], v[50:51], v[42:43]
    v_pk_fma_f32 v[68:69], v[68:69], v[52:53], v[44:45]
    v_pk_fma_f32 v[70:71], v[70:71], v[54:55], v[46:47]
    v_pk_mul_f32 v[56:57], v[64:65], v[56:57]
    v_pk_mul_f32 v[58:59], v[66:67], v[58:59]
    v_pk_mul_f32 v[60:61], v[68:69], v[60:61]
    v_pk_mul_f32 v[62:63], v[70:71], v[62:63]
    v_cvt_pk_bf16_f32 v8, v56, v57
    v_cvt_pk_bf16_f32 v9, v58, v59
    v_cvt_pk_bf16_f32 v10, v60, v61
    v_cvt_pk_bf16_f32 v11, v62, v63
    ds_write_b128 v4, v[8:11]
    v_pk_add_f32 v[40:41], v[64:65], v[66:67]
    v_pk_add_f32 v[42:43], v[68:69], v[70:71]
    v_pk_mul_f32 v[44:45], v[64:65], v[64:65]
    v_pk_mul_f32 v[46:47], v[66:67], v[66:67]
    v_pk_add_f32 v[40:41], v[40:41], v[42:43]
    v_pk_fma_f32 v[44:45], v[68:69], v[68:69], v[44:45]
    v_pk_fma_f32 v[46:47], v[70:71], v[70:71], v[46:47]
    s_waitcnt lgkmcnt(0)
    s_barrier
    v_add_f32 v8, v40, v41
    v_pk_add_f32 v[44:45], v[44:45], v[46:47]
    v_add_f32 v9, v44, v45
    v_add_f32_dpp v8, v8, v8 quad_perm:[1,0,3,2] row_mask:0xf bank_mask:0xf
    s_nop 0
    v_add_f32_dpp v9, v9, v9 quad_perm:[1,0,3,2] row_mask:0xf bank_mask:0xf
    v_add_f32_dpp v8, v8, v8 quad_perm:[2,3,0,1] row_mask:0xf bank_mask:0xf
    s_nop 0
    v_add_f32_dpp v9, v9, v9 quad_perm:[2,3,0,1] row_mask:0xf bank_mask:0xf
    v_add_f32_dpp v8, v8, v8 row_ror:4 row_mask:0xf bank_mask:0xf
    s_nop 0
    v_add_f32_dpp v9, v9, v9 row_ror:4 row_mask:0xf bank_mask:0xf
    v_add_f32_dpp v8, v8, v8 row_ror:8 row_mask:0xf bank_mask:0xf
    s_nop 0
    v_add_f32_dpp v9, v9, v9 row_ror:8 row_mask:0xf bank_mask:0xf
    ds_write_b64 v7, v[8:9]
    s_waitcnt lgkmcnt(0)
    s_barrier
    ds_write_b128 v6, v[64:67]
    ds_write_b128 v6, v[68:71] offset:16
    s_waitcnt vmcnt(0) lgkmcnt(0)
    s_cmp_lg_u32 s3, 7
    s_cbranch_scc1 L_ffn2
    s_endpgm
L_pta3:
    v_dot2c_f32_bf16 v64, s58, v24
    v_dot2c_f32_bf16 v65, s59, v24
    v_dot2c_f32_bf16 v66, s58, v25
    v_dot2c_f32_bf16 v67, s59, v25
    v_dot2c_f32_bf16 v68, s58, v26
    v_dot2c_f32_bf16 v69, s59, v26
    v_dot2c_f32_bf16 v70, s58, v27
    v_dot2c_f32_bf16 v71, s59, v27
L_pta2:
    v_dot2c_f32_bf16 v64, s58, v20
    v_dot2c_f32_bf16 v65, s59, v20
    v_dot2c_f32_bf16 v66, s58, v21
    v_dot2c_f32_bf16 v67, s59, v21
    v_dot2c_f32_bf16 v68, s58, v22
    v_dot2c_f32_bf16 v69, s59, v22
    v_dot2c_f32_bf16 v70, s58, v23
    v_dot2c_f32_bf16 v71, s59, v23
    s_branch L_pta1
L_ffn1:
    s_barrier
    ds_read_b128 v[8:11], v79 offset:0
    ds_read_b128 v[12:15], v79 offset:256
    ds_read_b128 v[16:19], v79 offset:512
    ds_read_b128 v[20:23], v79 offset:768
    ds_read_b128 v[24:27], v79 offset:1024
    s_waitcnt vmcnt(0)
    v_lshlrev_b32 v82, 16, v82
    v_add_f32 v85, v85, v82
    s_waitcnt lgkmcnt(4)
    v_mfma_f32_16x16x32_bf16 v[32:35], v[88:91], v[8:11], 0
    v_mfma_f32_16x16x32_bf16 v[36:39], v[92:95], v[8:11], 0
    v_mfma_f32_16x16x32_bf16 v[40:43], v[96:99], v[8:11], 0
    v_mfma_f32_16x16x32_bf16 v[44:47], v[100:103], v[8:11], 0
    s_waitcnt lgkmcnt(3)
    v_mfma_f32_16x16x32_bf16 v[32:35], v[104:107], v[12:15], v[32:35]
    v_mfma_f32_16x16x32_bf16 v[36:39], v[108:111], v[12:15], v[36:39]
    v_mfma_f32_16x16x32_bf16 v[40:43], v[112:115], v[12:15], v[40:43]
    v_mfma_f32_16x16x32_bf16 v[44:47], v[116:119], v[12:15], v[44:47]
    s_waitcnt lgkmcnt(2)
    v_mfma_f32_16x16x32_bf16 v[32:35], v[120:123], v[16:19], v[32:35]
    v_mfma_f32_16x16x32_bf16 v[36:39], v[124:127], v[16:19], v[36:39]
    v_mfma_f32_16x16x32_bf16 v[40:43], v[128:131], v[16:19], v[40:43]
    v_mfma_f32_16x16x32_bf16 v[44:47], v[132:135], v[16:19], v[44:47]
    s_waitcnt lgkmcnt(1)
    s_barrier
    ds_read_b128 v[48:51], v81
    ds_read_b128 v[52:55], v81 offset:16
    ds_read_b64 v[56:57], v81 offset:32
    v_mfma_f32_16x16x32_bf16 v[32:35], v[136:139], v[20:23], v[32:35]
    v_mfma_f32_16x16x32_bf16 v[36:39], v[140:143], v[20:23], v[36:39]
    v_mfma_f32_16x16x32_bf16 v[40:43], v[144:147], v[20:23], v[40:43]
    v_mfma_f32_16x16x32_bf16 v[44:47], v[148:151], v[20:23], v[44:47]
    s_waitcnt lgkmcnt(3)
    v_mfma_f32_16x16x32_bf16 v[32:35], v[152:155], v[24:27], v[32:35]
    v_mfma_f32_16x16x32_bf16 v[36:39], v[156:159], v[24:27], v[36:39]
    s_waitcnt lgkmcnt(0)
    v_pk_add_f32 v[48:49], v[48:49], v[50:51]
    v_pk_add_f32 v[52:53], v[52:53], v[54:55]
    v_mfma_f32_16x16x32_bf16 v[40:43], v[160:163], v[24:27], v[40:43]
    v_pk_add_f32 v[48:49], v[48:49], v[56:57]
    v_pk_add_f32 v[48:49], v[48:49], v[52:53]
    v_mfma_f32_16x16x32_bf16 v[44:47], v[164:167], v[24:27], v[44:47]
    v_mul_f32 v48, s62, v48
    v_mul_f32 v49, s62, v49
    v_mul_f32 v7, v84, v48
    v_fma_f32 v49, -v48, v48, -v49
    v_max_f32 v49, 0, v49
    v_add_f32 v49, 0x3727c5ac, v49
    v_rsq_f32 v49, v49
    v_add_f32_dpp v5, v36, v7 row_ror:12 row_mask:0xf bank_mask:0x1
    v_add_f32_dpp v5, v41, v7 row_ror:12 row_mask:0xf bank_mask:0x2
    v_add_f32_dpp v5, v46, v7 row_ror:12 row_mask:0xf bank_mask:0x4
    v_add_f32_dpp v5, v35, v7 row_ror:12 row_mask:0xf bank_mask:0x8
    v_add_f32_dpp v4, v40, v32 row_ror:8 row_mask:0xf bank_mask:0x1
    v_add_f32_dpp v4, v45, v37 row_ror:8 row_mask:0xf bank_mask:0x2
    v_add_f32_dpp v4, v34, v42 row_ror:8 row_mask:0xf bank_mask:0x4
    v_add_f32_dpp v4, v39, v47 row_ror:8 row_mask:0xf bank_mask:0x8
    v_add_f32_dpp v6, v44, v5 row_ror:4 row_mask:0xf bank_mask:0x1
    v_add_f32_dpp v6, v33, v5 row_ror:4 row_mask:0xf bank_mask:0x2
    v_add_f32_dpp v6, v38, v5 row_ror:4 row_mask:0xf bank_mask:0x4
    v_add_f32_dpp v6, v43, v5 row_ror:4 row_mask:0xf bank_mask:0x8
    v_add_f32 v4, v4, v6
    v_fma_f32 v4, v4, v49, v85
    v_mul_f32 v5, v4, v4
    v_fma_f32 v5, v5, s63, v86
    v_mul_f32 v5, v5, v4
    v_exp_f32 v5, v5
    s_nop 0
    v_add_f32 v5, 1.0, v5
    v_rcp_f32 v5, v5
    s_nop 0
    v_mul_f32 v4, v4, v5
    v_cvt_pk_bf16_f32 v4, v4, v4
    ds_write_b16 v80, v4
    s_waitcnt lgkmcnt(0)
    s_barrier
    s_endpgm
L_h_t1:
    s_cmp_lg_u32 s3, 3
    s_cbranch_scc1 L_h_noclr
    s_sub_u32 s62, s56, 154
    s_cmp_lt_u32 s62, 30
    s_cbranch_scc0 L_h_noclr
    s_lshl_b32 s63, s62, 2
    s_mul_i32 s62, s62, 7168
    s_add_u32 s62, s62, 20480
    v_mov_b32 v4, -1
    v_mov_b32 v5, -1
    v_mov_b32 v6, -1
    v_mov_b32 v7, -1
    v_lshlrev_b32 v8, 4, v0
    buffer_store_dwordx4 v[4:7], v8, s[40:43], s62 offen offset:0 sc1
    buffer_store_dwordx4 v[4:7], v8, s[40:43], s62 offen offset:1024 sc1
    buffer_store_dwordx4 v[4:7], v8, s[40:43], s62 offen offset:2048 sc1
    buffer_store_dwordx4 v[4:7], v8, s[40:43], s62 offen offset:3072 sc1
    s_add_u32 s62, s62, 4096
    buffer_store_dwordx4 v[4:7], v8, s[40:43], s62 offen offset:0 sc1
    buffer_store_dwordx4 v[4:7], v8, s[40:43], s62 offen offset:1024 sc1
    buffer_store_dwordx4 v[4:7], v8, s[40:43], s62 offen offset:2048 sc1
    v_mov_b32 v8, s63
    s_waitcnt vmcnt(0)
    s_mov_b64 exec, 1
    buffer_store_dword v4, v8, s[44:47], 0 offen sc1
    s_mov_b64 exec, -1
L_h_noclr:
    v_lshrrev_b32 v1, 3, v0
    v_mul_u32_u24 v1, 1280, v1
    v_and_b32 v2, 7, v0
    v_lshl_add_u32 v1, v2, 4, v1
    s_lshl2_add_u32 s63, s34, s3
    s_mul_i32 s63, s63, 163840
    s_lshl_b32 s62, s35, 7
    s_add_u32 s63, s63, s62
    s_sub_u32 s63, s63, 2816
    s_lshl_b32 s62, s3, 14
    s_add_u32 s62, s62, 81920
    s_mov_b32 m0, s62
    s_mov_b32 s48, s12
    s_mov_b32 s49, s13
    s_mov_b32 s50, 5242880
    s_mov_b32 s51, 0x20000
    s_add_u32 s100, s39, 1
    s_mov_b32 s62, 8
L_dma_5:
    buffer_load_dwordx4 v1, s[48:51], s63 offen nt lds
    s_add_u32 m0, m0, 1024
    s_add_u32 s63, s63, 10240
    s_cmp_eq_u32 s100, 0
    s_cbranch_scc1 L_dma_5n0
    s_waitcnt vmcnt(7)
    s_cmp_eq_u32 s100, 2
    s_cbranch_scc1 L_dma_5n0
    s_waitcnt vmcnt(3)
L_dma_5n0:
    buffer_load_dwordx4 v1, s[48:51], s63 offen nt lds
    s_add_u32 m0, m0, 1024
    s_add_u32 s63, s63, 10240
    s_cmp_eq_u32 s100, 0
    s_cbranch_scc1 L_dma_5n1
    s_waitcnt vmcnt(7)
    s_cmp_eq_u32 s100, 2
    s_cbranch_scc1 L_dma_5n1
    s_waitcnt vmcnt(3)
L_dma_5n1:
    s_sub_u32 s62, s62, 1
    s_cmp_lg_u32 s62, 0
    s_cbranch_scc1 L_dma_5
    s_cmp_eq_u32 s39, 1
    s_cbranch_scc1 L_h_role
    s_waitcnt vmcnt(0)
    v_mov_b32 v4, 162060
    v_mov_b32 v5, 1
    s_mov_b64 exec, 1
    ds_add_u32 v4, v5
    s_mov_b64 exec, -1
    s_cmp_eq_u32 s3, 0
    s_cbranch_scc1 L_service
    s_endpgm
L_h_role:
    v_lshrrev_b32 v3, 4, v0
    v_and_b32 v2, 3, v0
    v_bfe_u32 v1, v0, 2, 2
    v_mul_u32_u24 v160, 2560, v2
    v_lshl_add_u32 v160, v1, 6, v160
    v_lshl_add_u32 v160, v3, 4, v160
    s_mul_i32 s57, s35, 10240
    s_mul_i32 s62, s3, 640
    s_add_u32 s57, s57, s62
    s_add_u32 s57, s57, 262144
    v_mov_b32 v4, -1
    v_mov_b32 v5, -1
    v_mov_b32 v6, -1
    v_mov_b32 v7, -1
    buffer_store_dwordx4 v[4:7], v160, s[40:43], s57 offen sc1
    buffer_store_dwordx4 v[4:7], v160, s[40:43], s57 offen offset:256 sc1
    s_mov_b32 exec_lo, 0x00ff00ff
    s_mov_b32 exec_hi, 0x00ff00ff
    buffer_store_dwordx4 v[4:7], v160, s[40:43], s57 offen offset:512 sc1
    s_mov_b64 exec, -1
    v_add_u32 v8, 0, v0
    v_mul_u32_u24 v10, 0xccd, v8
    v_lshrrev_b32 v10, 16, v10
    v_mul_u32_u24 v9, 20, v10
    v_sub_u32 v8, v8, v9
    v_mul_u32_u24 v10, 1280, v10
    v_lshl_add_u32 v10, v8, 4, v10
    v_add_u32 v8, 64, v0
    v_mul_u32_u24 v11, 0xccd, v8
    v_lshrrev_b32 v11, 16, v11
    v_mul_u32_u24 v9, 20, v11
    v_sub_u32 v8, v8, v9
    v_mul_u32_u24 v11, 1280, v11
    v_lshl_add_u32 v11, v8, 4, v11
    v_add_u32 v8, 128, v0
    v_mul_u32_u24 v12, 0xccd, v8
    v_lshrrev_b32 v12, 16, v12
    v_mul_u32_u24 v9, 20, v12
    v_sub_u32 v8, v8, v9
    v_mul_u32_u24 v12, 1280, v12
    v_lshl_add_u32 v12, v8, 4, v12
    v_add_u32 v8, 192, v0
    v_mul_u32_u24 v13, 0xccd, v8
    v_lshrrev_b32 v13, 16, v13
    v_mul_u32_u24 v9, 20, v13
    v_sub_u32 v8, v8, v9
    v_mul_u32_u24 v13, 1280, v13
    v_lshl_add_u32 v13, v8, 4, v13
    v_add_u32 v8, 256, v0
    v_mul_u32_u24 v14, 0xccd, v8
    v_lshrrev_b32 v14, 16, v14
    v_mul_u32_u24 v9, 20, v14
    v_sub_u32 v8, v8, v9
    v_mul_u32_u24 v14, 1280, v14
    v_lshl_add_u32 v14, v8, 4, v14
    s_waitcnt vmcnt(0)
    v_mov_b32 v8, 162060
    v_mov_b32 v9, 1
    s_mov_b64 exec, 1
    ds_add_u32 v8, v9
    s_mov_b64 exec, -1
    s_mov_b32 s48, s20
    s_mov_b32 s49, s21
    s_mov_b32 s50, 2211840
    s_mov_b32 s51, 0x20000
    s_mul_i32 s63, s35, 81920
    s_mul_i32 s62, s3, 320
    s_add_u32 s63, s63, s62
    s_mov_b32 m0, s101
    s_mov_b32 s62, 4
L_w2dma:
    buffer_load_dwordx4 v10, s[48:51], s63 offen nt lds
    s_add_u32 m0, m0, 1024
    s_waitcnt vmcnt(7)
    s_cmp_ge_u32 s35, 22
    s_cbranch_scc1 L_w2n0
    s_waitcnt vmcnt(7)
L_w2n0:
    buffer_load_dwordx4 v11, s[48:51], s63 offen nt lds
    s_add_u32 m0, m0, 1024
    s_waitcnt vmcnt(7)
    s_cmp_ge_u32 s35, 22
    s_cbranch_scc1 L_w2n1
    s_waitcnt vmcnt(7)
L_w2n1:
    buffer_load_dwordx4 v12, s[48:51], s63 offen nt lds
    s_add_u32 m0, m0, 1024
    s_waitcnt vmcnt(7)
    s_cmp_ge_u32 s35, 22
    s_cbranch_scc1 L_w2n2
    s_waitcnt vmcnt(7)
L_w2n2:
    buffer_load_dwordx4 v13, s[48:51], s63 offen nt lds
    s_add_u32 m0, m0, 1024
    s_waitcnt vmcnt(7)
    s_cmp_ge_u32 s35, 22
    s_cbranch_scc1 L_w2n3
    s_waitcnt vmcnt(7)
L_w2n3:
    buffer_load_dwordx4 v14, s[48:51], s63 offen nt lds
    s_add_u32 m0, m0, 1024
    s_waitcnt vmcnt(7)
    s_cmp_ge_u32 s35, 22
    s_cbranch_scc1 L_w2n4
    s_waitcnt vmcnt(7)
L_w2n4:
    s_add_u32 s63, s63, 20480
    s_sub_u32 s62, s62, 1
    s_cmp_lg_u32 s62, 0
    s_cbranch_scc1 L_w2dma
    v_lshl_add_u32 v8, v3, 3, v1
    v_mul_u32_u24 v8, 320, v8
    v_lshl_add_u32 v8, v2, 3, v8
    v_add_u32 v8, s101, v8
    s_waitcnt vmcnt(0)
    ds_read_b64_tr_b16 v[80:81], v8 offset:0
    ds_read_b64_tr_b16 v[82:83], v8 offset:1280
    ds_read_b64_tr_b16 v[84:85], v8 offset:10240
    ds_read_b64_tr_b16 v[86:87], v8 offset:11520
    ds_read_b64_tr_b16 v[88:89], v8 offset:32
    ds_read_b64_tr_b16 v[90:91], v8 offset:1312
    ds_read_b64_tr_b16 v[92:93], v8 offset:10272
    ds_read_b64_tr_b16 v[94:95], v8 offset:11552
    ds_read_b64_tr_b16 v[96:97], v8 offset:64
    ds_read_b64_tr_b16 v[98:99], v8 offset:1344
    ds_read_b64_tr_b16 v[100:101], v8 offset:10304
    ds_read_b64_tr_b16 v[102:103], v8 offset:11584
    ds_read_b64_tr_b16 v[104:105], v8 offset:96
    ds_read_b64_tr_b16 v[106:107], v8 offset:1376
    ds_read_b64_tr_b16 v[108:109], v8 offset:10336
    ds_read_b64_tr_b16 v[110:111], v8 offset:11616
    ds_read_b64_tr_b16 v[112:113], v8 offset:128
    ds_read_b64_tr_b16 v[114:115], v8 offset:1408
    ds_read_b64_tr_b16 v[116:117], v8 offset:10368
    ds_read_b64_tr_b16 v[118:119], v8 offset:11648
    ds_read_b64_tr_b16 v[120:121], v8 offset:160
    ds_read_b64_tr_b16 v[122:123], v8 offset:1440
    ds_read_b64_tr_b16 v[124:125], v8 offset:10400
    ds_read_b64_tr_b16 v[126:127], v8 offset:11680
    ds_read_b64_tr_b16 v[128:129], v8 offset:192
    ds_read_b64_tr_b16 v[130:131], v8 offset:1472
    ds_read_b64_tr_b16 v[132:133], v8 offset:10432
    ds_read_b64_tr_b16 v[134:135], v8 offset:11712
    ds_read_b64_tr_b16 v[136:137], v8 offset:224
    ds_read_b64_tr_b16 v[138:139], v8 offset:1504
    ds_read_b64_tr_b16 v[140:141], v8 offset:10464
    ds_read_b64_tr_b16 v[142:143], v8 offset:11744
    ds_read_b64_tr_b16 v[144:145], v8 offset:256
    ds_read_b64_tr_b16 v[146:147], v8 offset:1536
    ds_read_b64_tr_b16 v[148:149], v8 offset:10496
    ds_read_b64_tr_b16 v[150:151], v8 offset:11776
    ds_read_b64_tr_b16 v[152:153], v8 offset:288
    ds_read_b64_tr_b16 v[154:155], v8 offset:1568
    ds_read_b64_tr_b16 v[156:157], v8 offset:10528
    ds_read_b64_tr_b16 v[158:159], v8 offset:11808
    s_mov_b32 s48, s16
    s_mov_b32 s49, s17
    s_mov_b32 s50, 2211840
    s_mov_b32 s51, 0x20000
    s_lshl_b32 s98, s35, 7
    s_mov_b32 s99, 3456
    v_lshrrev_b32 v9, 3, v0
    v_mul_lo_u32 v10, v9, s99
    v_and_b32 v9, 2, v9
    v_xor_b32 v9, v9, v0
    v_and_b32 v9, 7, v9
    v_lshl_add_u32 v10, v9, 4, v10
    v_add_u32 v10, s98, v10
    v_xor_b32 v11, 64, v10
    s_mul_i32 s63, s3, 552960
    s_mov_b32 m0, s101
    s_waitcnt lgkmcnt(0)
    s_cmp_ge_u32 s35, 22
    s_cselect_b32 s100, 2, 1
    s_mov_b32 s62, 10
L_dma_6:
    buffer_load_dwordx4 v10, s[48:51], s63 offen nt lds
    s_add_u32 m0, m0, 1024
    s_add_u32 s63, s63, 27648
    s_cmp_eq_u32 s100, 0
    s_cbranch_scc1 L_dma_6n0
    s_waitcnt vmcnt(7)
    s_cmp_eq_u32 s100, 2
    s_cbranch_scc1 L_dma_6n0
    s_waitcnt vmcnt(7)
L_dma_6n0:
    buffer_load_dwordx4 v11, s[48:51], s63 offen nt lds
    s_add_u32 m0, m0, 1024
    s_add_u32 s63, s63, 27648
    s_cmp_eq_u32 s100, 0
    s_cbranch_scc1 L_dma_6n1
    s_waitcnt vmcnt(7)
    s_cmp_eq_u32 s100, 2
    s_cbranch_scc1 L_dma_6n1
    s_waitcnt vmcnt(7)
L_dma_6n1:
    s_sub_u32 s62, s62, 1
    s_cmp_lg_u32 s62, 0
    s_cbranch_scc1 L_dma_6
    v_mov_b32 v8, 162068
L_lw_7:
    ds_read_b32 v9, v8
    s_waitcnt lgkmcnt(0)
    v_cmp_gt_u32 vcc, 1, v9
    s_cbranch_vccz L_lw_7e
    s_sleep 8
    s_sub_u32 s60, s60, 1
    s_cbranch_scc0 L_lw_7
    s_mov_b32 s60, 0
L_lw_7e:
    s_cmp_lg_u32 s3, 3
    s_cbranch_scc1 L_h_nomo
    v_and_b32 v4, 15, v0
    v_lshlrev_b32 v4, 4, v4
    v_mul_u32_u24 v5, 1280, v3
    v_add_u32 v5, v5, v4
    v_mul_u32_u24 v6, 1296, v3
    v_add_u32 v6, v6, v4
    v_add_u32 v6, 147456, v6
    s_mov_b32 s62, 30720
    s_mov_b32 s63, 25600
L_poll_8:
    buffer_load_dwordx4 v[40:43], v5, s[40:43], s62 offen offset:0 sc1
    buffer_load_dwordx4 v[44:47], v5, s[40:43], s62 offen offset:256 sc1
    buffer_load_dwordx4 v[48:51], v5, s[40:43], s62 offen offset:512 sc1
    buffer_load_dwordx4 v[52:55], v5, s[40:43], s62 offen offset:768 sc1
    buffer_load_dwordx4 v[56:59], v5, s[40:43], s62 offen offset:1024 sc1
    buffer_load_dwordx4 v[60:63], v5, s[40:43], s63 offen offset:0 sc1
    buffer_load_dwordx4 v[64:67], v5, s[40:43], s63 offen offset:256 sc1
    buffer_load_dwordx4 v[68:71], v5, s[40:43], s63 offen offset:512 sc1
    buffer_load_dwordx4 v[72:75], v5, s[40:43], s63 offen offset:768 sc1
    buffer_load_dwordx4 v[76:79], v5, s[40:43], s63 offen offset:1024 sc1
    s_waitcnt vmcnt(0)
    v_max3_u32 v7, v40, v41, v42
    v_max3_u32 v7, v7, v43, v44
    v_max3_u32 v7, v7, v45, v46
    v_max3_u32 v7, v7, v47, v48
    v_max3_u32 v7, v7, v49, v50
    v_max3_u32 v7, v7, v51, v52
    v_max3_u32 v7, v7, v53, v54
    v_max3_u32 v7, v7, v55, v56
    v_max3_u32 v7, v7, v57, v58
    v_max3_u32 v7, v7, v59, v60
    v_max3_u32 v7, v7, v61, v62
    v_max3_u32 v7, v7, v63, v64
    v_max3_u32 v7, v7, v65, v66
    v_max3_u32 v7, v7, v67, v68
    v_max3_u32 v7, v7, v69, v70
    v_max3_u32 v7, v7, v71, v72
    v_max3_u32 v7, v7, v73, v74
    v_max3_u32 v7, v7, v75, v76
    v_max3_u32 v7, v7, v77, v78
    v_max_u32 v7, v7, v79
    v_cmp_eq_u32 vcc, -1, v7
    s_cbranch_vccz L_poll_8e
    s_sleep 8
    s_sub_u32 s60, s60, 1
    s_cbranch_scc0 L_poll_8
    s_mov_b32 s60, 0
L_poll_8e:
    ds_write_b128 v6, v[40:43] offset:0
    ds_write_b128 v6, v[44:47] offset:256
    ds_write_b128 v6, v[48:51] offset:512
    ds_write_b128 v6, v[52:55] offset:768
    ds_write_b128 v6, v[56:59] offset:1024
    ds_write_b128 v6, v[60:63] offset:5184
    ds_write_b128 v6, v[64:67] offset:5440
    ds_write_b128 v6, v[68:71] offset:5696
    ds_write_b128 v6, v[72:75] offset:5952
    ds_write_b128 v6, v[76:79] offset:6208
L_h_nomo:
    v_mul_u32_u24 v4, 144, v2
    v_lshl_add_u32 v4, v3, 4, v4
    v_add_u32 v161, 97600, v4
    s_mov_b32 s100, s3
    s_lshl_b32 s63, s100, 8
    v_and_b32 v8, 15, v0
    v_lshl_add_u32 v8, v8, 4, s63
    v_lshrrev_b32 v9, 4, v0
    v_mul_u32_u24 v5, 1280, v9
    v_add_u32 v5, v5, v8
    v_mul_u32_u24 v4, 1296, v9
    v_add_u32 v4, v4, v8
    v_add_u32 v4, 81920, v4
    v_lshlrev_b32 v6, 1, v5
    v_add_u32 v6, 87104, v6
    s_lshl_b32 s62, s100, 3
    s_add_u32 s62, s62, 97344
    v_lshl_add_u32 v7, v9, 6, s62
    s_mov_b32 s48, s4
    s_mov_b32 s49, s5
    s_mov_b32 s50, 5120
    s_mov_b32 s51, 0x20000
    buffer_load_dwordx4 v[8:11], v5, s[48:51], 0 offen
    s_mov_b32 s62, 20480
    s_mov_b32 s63, 30720
L_poll_9:
    buffer_load_dwordx4 v[12:15], v5, s[40:43], s62 offen sc1
    buffer_load_dwordx4 v[16:19], v5, s[40:43], s63 offen sc1
    s_waitcnt vmcnt(0)
    v_max3_u32 v38, v12, v13, v14
    v_max3_u32 v38, v38, v15, v16
    v_max3_u32 v38, v38, v17, v18
    v_max_u32 v38, v38, v19
    v_cmp_eq_u32 vcc, -1, v38
    s_cbranch_vccz L_poll_9e
    s_sleep 8
    s_sub_u32 s60, s60, 1
    s_cbranch_scc0 L_poll_9
    s_mov_b32 s60, 0
L_poll_9e:
    v_lshlrev_b32 v40, 16, v8
    v_and_b32 v41, 0xffff0000, v8
    v_lshlrev_b32 v42, 16, v9
    v_and_b32 v43, 0xffff0000, v9
    v_lshlrev_b32 v44, 16, v10
    v_and_b32 v45, 0xffff0000, v10
    v_lshlrev_b32 v46, 16, v11
    v_and_b32 v47, 0xffff0000, v11
    v_lshlrev_b32 v48, 16, v12
    v_and_b32 v49, 0xffff0000, v12
    v_lshlrev_b32 v50, 16, v13
    v_and_b32 v51, 0xffff0000, v13
    v_lshlrev_b32 v52, 16, v14
    v_and_b32 v53, 0xffff0000, v14
    v_lshlrev_b32 v54, 16, v15
    v_and_b32 v55, 0xffff0000, v15
    v_lshlrev_b32 v56, 16, v16
    v_and_b32 v57, 0xffff0000, v16
    v_lshlrev_b32 v58, 16, v17
    v_and_b32 v59, 0xffff0000, v17
    v_lshlrev_b32 v60, 16, v18
    v_and_b32 v61, 0xffff0000, v18
    v_lshlrev_b32 v62, 16, v19
    v_and_b32 v63, 0xffff0000, v19
    v_mov_b32 v64, 0
    v_mov_b32 v65, 0
    v_mov_b32 v66, 0
    v_mov_b32 v67, 0
    v_mov_b32 v68, 0
    v_mov_b32 v69, 0
    v_mov_b32 v70, 0
    v_mov_b32 v71, 0
    s_waitcnt vmcnt(0) lgkmcnt(0)
    v_mov_b32 v8, 162064
    v_mov_b32 v9, 1
    s_mov_b64 exec, 1
    ds_add_u32 v8, v9
    s_mov_b64 exec, -1
    s_branch L_t2gate
L_ffn2:
    s_barrier
    ds_read_b128 v[8:11], v161
    ds_read_b128 v[12:15], v161 offset:64
    s_cmp_eq_u32 s61, 1
    s_cbranch_scc0 L_f2slow
    s_waitcnt lgkmcnt(1)
    v_mfma_f32_16x16x32_bf16 v[16:19], v[80:83], v[8:11], 0
    v_mfma_f32_16x16x32_bf16 v[20:23], v[88:91], v[8:11], 0
    v_mfma_f32_16x16x32_bf16 v[24:27], v[96:99], v[8:11], 0
    v_mfma_f32_16x16x32_bf16 v[28:31], v[104:107], v[8:11], 0
    s_waitcnt lgkmcnt(0)
    v_mfma_f32_16x16x32_bf16 v[16:19], v[84:87], v[12:15], v[16:19]
    v_mfma_f32_16x16x32_bf16 v[20:23], v[92:95], v[12:15], v[20:23]
    v_mfma_f32_16x16x32_bf16 v[24:27], v[100:103], v[12:15], v[24:27]
    v_mfma_f32_16x16x32_bf16 v[28:31], v[108:111], v[12:15], v[28:31]
    v_mfma_f32_16x16x32_bf16 v[32:35], v[112:115], v[8:11], 0
    v_mfma_f32_16x16x32_bf16 v[36:39], v[120:123], v[8:11], 0
    v_mfma_f32_16x16x32_bf16 v[40:43], v[128:131], v[8:11], 0
    v_mfma_f32_16x16x32_bf16 v[44:47], v[136:139], v[8:11], 0
    v_mfma_f32_16x16x32_bf16 v[32:35], v[116:119], v[12:15], v[32:35]
    v_mfma_f32_16x16x32_bf16 v[36:39], v[124:127], v[12:15], v[36:39]
    v_mfma_f32_16x16x32_bf16 v[40:43], v[132:135], v[12:15], v[40:43]
    v_mfma_f32_16x16x32_bf16 v[44:47], v[140:143], v[12:15], v[44:47]
    v_mfma_f32_16x16x32_bf16 v[48:51], v[144:147], v[8:11], 0
    v_mov_b32_dpp v16, v20 quad_perm:[0,1,2,3] row_mask:0xf bank_mask:0x2
    v_mov_b32_dpp v17, v21 quad_perm:[0,1,2,3] row_mask:0xf bank_mask:0x2
    v_mov_b32_dpp v18, v22 quad_perm:[0,1,2,3] row_mask:0xf bank_mask:0x2
    v_mfma_f32_16x16x32_bf16 v[52:55], v[152:155], v[8:11], 0
    v_mov_b32_dpp v19, v23 quad_perm:[0,1,2,3] row_mask:0xf bank_mask:0x2
    v_mov_b32_dpp v16, v24 quad_perm:[0,1,2,3] row_mask:0xf bank_mask:0x4
    v_mov_b32_dpp v17, v25 quad_perm:[0,1,2,3] row_mask:0xf bank_mask:0x4
    v_mfma_f32_16x16x32_bf16 v[48:51], v[148:151], v[12:15], v[48:51]
    v_mov_b32_dpp v18, v26 quad_perm:[0,1,2,3] row_mask:0xf bank_mask:0x4
    v_mov_b32_dpp v19, v27 quad_perm:[0,1,2,3] row_mask:0xf bank_mask:0x4
    v_mov_b32_dpp v16, v28 quad_perm:[0,1,2,3] row_mask:0xf bank_mask:0x8
    v_mfma_f32_16x16x32_bf16 v[52:55], v[156:159], v[12:15], v[52:55]
    v_mov_b32_dpp v17, v29 quad_perm:[0,1,2,3] row_mask:0xf bank_mask:0x8
    v_mov_b32_dpp v18, v30 quad_perm:[0,1,2,3] row_mask:0xf bank_mask:0x8
    v_mov_b32_dpp v19, v31 quad_perm:[0,1,2,3] row_mask:0xf bank_mask:0x8
    buffer_store_dwordx4 v[16:19], v160, s[40:43], s57 offen
    v_mov_b32_dpp v32, v36 quad_perm:[0,1,2,3] row_mask:0xf bank_mask:0x2
    v_mov_b32_dpp v33, v37 quad_perm:[0,1,2,3] row_mask:0xf bank_mask:0x2
    v_mov_b32_dpp v34, v38 quad_perm:[0,1,2,3] row_mask:0xf bank_mask:0x2
    v_mov_b32_dpp v35, v39 quad_perm:[0,1,2,3] row_mask:0xf bank_mask:0x2
    v_mov_b32_dpp v32, v40 quad_perm:[0,1,2,3] row_mask:0xf bank_mask:0x4
    v_mov_b32_dpp v33, v41 quad_perm:[0,1,2,3] row_mask:0xf bank_mask:0x4
    v_mov_b32_dpp v34, v42 quad_perm:[0,1,2,3] row_mask:0xf bank_mask:0x4
    v_mov_b32_dpp v35, v43 quad_perm:[0,1,2,3] row_mask:0xf bank_mask:0x4
    v_mov_b32_dpp v32, v44 quad_perm:[0,1,2,3] row_mask:0xf bank_mask:0x8
    v_mov_b32_dpp v33, v45 quad_perm:[0,1,2,3] row_mask:0xf bank_mask:0x8
    v_mov_b32_dpp v34, v46 quad_perm:[0,1,2,3] row_mask:0xf bank_mask:0x8
    v_mov_b32_dpp v35, v47 quad_perm:[0,1,2,3] row_mask:0xf bank_mask:0x8
    buffer_store_dwordx4 v[32:35], v160, s[40:43], s57 offen offset:256
    v_mov_b32_dpp v48, v52 quad_perm:[0,1,2,3] row_mask:0xf bank_mask:0x2
    v_mov_b32_dpp v49, v53 quad_perm:[0,1,2,3] row_mask:0xf bank_mask:0x2
    v_mov_b32_dpp v50, v54 quad_perm:[0,1,2,3] row_mask:0xf bank_mask:0x2
    v_mov_b32_dpp v51, v55 quad_perm:[0,1,2,3] row_mask:0xf bank_mask:0x2
    s_mov_b32 exec_lo, 0x00ff00ff
    s_mov_b32 exec_hi, 0x00ff00ff
    buffer_store_dwordx4 v[48:51], v160, s[40:43], s57 offen offset:512
L_f2done:
    s_barrier
    s_endpgm
L_f2slow:
    s_waitcnt lgkmcnt(1)
    v_mfma_f32_16x16x32_bf16 v[16:19], v[80:83], v[8:11], 0
    v_mfma_f32_16x16x32_bf16 v[20:23], v[88:91], v[8:11], 0
    v_mfma_f32_16x16x32_bf16 v[24:27], v[96:99], v[8:11], 0
    v_mfma_f32_16x16x32_bf16 v[28:31], v[104:107], v[8:11], 0
    s_waitcnt lgkmcnt(0)
    v_mfma_f32_16x16x32_bf16 v[16:19], v[84:87], v[12:15], v[16:19]
    v_mfma_f32_16x16x32_bf16 v[20:23], v[92:95], v[12:15], v[20:23]
    v_mfma_f32_16x16x32_bf16 v[24:27], v[100:103], v[12:15], v[24:27]
    v_mfma_f32_16x16x32_bf16 v[28:31], v[108:111], v[12:15], v[28:31]
    v_mfma_f32_16x16x32_bf16 v[32:35], v[112:115], v[8:11], 0
    v_mfma_f32_16x16x32_bf16 v[36:39], v[120:123], v[8:11], 0
    v_mfma_f32_16x16x32_bf16 v[40:43], v[128:131], v[8:11], 0
    v_mfma_f32_16x16x32_bf16 v[44:47], v[136:139], v[8:11], 0
    v_mfma_f32_16x16x32_bf16 v[32:35], v[116:119], v[12:15], v[32:35]
    v_mfma_f32_16x16x32_bf16 v[36:39], v[124:127], v[12:15], v[36:39]
    v_mfma_f32_16x16x32_bf16 v[40:43], v[132:135], v[12:15], v[40:43]
    v_mfma_f32_16x16x32_bf16 v[44:47], v[140:143], v[12:15], v[44:47]
    v_mfma_f32_16x16x32_bf16 v[48:51], v[144:147], v[8:11], 0
    v_mov_b32_dpp v16, v20 quad_perm:[0,1,2,3] row_mask:0xf bank_mask:0x2
    v_mov_b32_dpp v17, v21 quad_perm:[0,1,2,3] row_mask:0xf bank_mask:0x2
    v_mov_b32_dpp v18, v22 quad_perm:[0,1,2,3] row_mask:0xf bank_mask:0x2
    v_mfma_f32_16x16x32_bf16 v[52:55], v[152:155], v[8:11], 0
    v_mov_b32_dpp v19, v23 quad_perm:[0,1,2,3] row_mask:0xf bank_mask:0x2
    v_mov_b32_dpp v16, v24 quad_perm:[0,1,2,3] row_mask:0xf bank_mask:0x4
    v_mov_b32_dpp v17, v25 quad_perm:[0,1,2,3] row_mask:0xf bank_mask:0x4
    v_mfma_f32_16x16x32_bf16 v[48:51], v[148:151], v[12:15], v[48:51]
    v_mov_b32_dpp v18, v26 quad_perm:[0,1,2,3] row_mask:0xf bank_mask:0x4
    v_mov_b32_dpp v19, v27 quad_perm:[0,1,2,3] row_mask:0xf bank_mask:0x4
    v_mov_b32_dpp v16, v28 quad_perm:[0,1,2,3] row_mask:0xf bank_mask:0x8
    v_mfma_f32_16x16x32_bf16 v[52:55], v[156:159], v[12:15], v[52:55]
    v_mov_b32_dpp v17, v29 quad_perm:[0,1,2,3] row_mask:0xf bank_mask:0x8
    v_mov_b32_dpp v18, v30 quad_perm:[0,1,2,3] row_mask:0xf bank_mask:0x8
    v_mov_b32_dpp v19, v31 quad_perm:[0,1,2,3] row_mask:0xf bank_mask:0x8
    buffer_store_dwordx4 v[16:19], v160, s[40:43], s57 offen sc1
    v_mov_b32_dpp v32, v36 quad_perm:[0,1,2,3] row_mask:0xf bank_mask:0x2
    v_mov_b32_dpp v33, v37 quad_perm:[0,1,2,3] row_mask:0xf bank_mask:0x2
    v_mov_b32_dpp v34, v38 quad_perm:[0,1,2,3] row_mask:0xf bank_mask:0x2
    v_mov_b32_dpp v35, v39 quad_perm:[0,1,2,3] row_mask:0xf bank_mask:0x2
    v_mov_b32_dpp v32, v40 quad_perm:[0,1,2,3] row_mask:0xf bank_mask:0x4
    v_mov_b32_dpp v33, v41 quad_perm:[0,1,2,3] row_mask:0xf bank_mask:0x4
    v_mov_b32_dpp v34, v42 quad_perm:[0,1,2,3] row_mask:0xf bank_mask:0x4
    v_mov_b32_dpp v35, v43 quad_perm:[0,1,2,3] row_mask:0xf bank_mask:0x4
    v_mov_b32_dpp v32, v44 quad_perm:[0,1,2,3] row_mask:0xf bank_mask:0x8
    v_mov_b32_dpp v33, v45 quad_perm:[0,1,2,3] row_mask:0xf bank_mask:0x8
    v_mov_b32_dpp v34, v46 quad_perm:[0,1,2,3] row_mask:0xf bank_mask:0x8
    v_mov_b32_dpp v35, v47 quad_perm:[0,1,2,3] row_mask:0xf bank_mask:0x8
    buffer_store_dwordx4 v[32:35], v160, s[40:43], s57 offen offset:256 sc1
    v_mov_b32_dpp v48, v52 quad_perm:[0,1,2,3] row_mask:0xf bank_mask:0x2
    v_mov_b32_dpp v49, v53 quad_perm:[0,1,2,3] row_mask:0xf bank_mask:0x2
    v_mov_b32_dpp v50, v54 quad_perm:[0,1,2,3] row_mask:0xf bank_mask:0x2
    v_mov_b32_dpp v51, v55 quad_perm:[0,1,2,3] row_mask:0xf bank_mask:0x2
    s_mov_b32 exec_lo, 0x00ff00ff
    s_mov_b32 exec_hi, 0x00ff00ff
    buffer_store_dwordx4 v[48:51], v160, s[40:43], s57 offen offset:512 sc1
    s_branch L_f2done
L_end:
    s_endpgm
L_codeend:
.section .rodata,"a"
.p2align 6
.amdhsa_kernel adaLN_cond__sliding_block_cached__dense_activation_gelu__decode_kernel
  .amdhsa_next_free_vgpr 168
  .amdhsa_next_free_sgpr 102
  .amdhsa_accum_offset 168
  .amdhsa_group_segment_fixed_size 0
  .amdhsa_kernarg_size 120
  .amdhsa_user_sgpr_count 2
  .amdhsa_user_sgpr_kernarg_segment_ptr 1
  .amdhsa_system_sgpr_workgroup_id_x 1
.end_amdhsa_kernel
```

```asm
; @launch grid=(256,1,1) block=(768,1,1) lds=162176
.amdgcn_target "amdgcn-amd-amdhsa--gfx950"
.text
.globl adaLN_cond__sliding_block_cached__dense_activation_gelu__decode_kernel
.p2align 8
.type adaLN_cond__sliding_block_cached__dense_activation_gelu__decode_kernel,@function
adaLN_cond__sliding_block_cached__dense_activation_gelu__decode_kernel:
    s_load_dwordx16 s[4:19], s[0:1], 0
    s_load_dwordx8 s[20:27], s[0:1], 64
    s_load_dwordx4 s[28:31], s[0:1], 96
    s_load_dwordx2 s[32:33], s[0:1], 112
    s_cmp_ge_u32 s2, 256
    s_cbranch_scc1 L_end
    v_lshrrev_b32 v1, 6, v0
    v_lshlrev_b32 v2, 4, v0
    v_readfirstlane_b32 s3, v1
    v_and_b32 v0, 63, v0
    s_and_b32 s34, s2, 7
    s_lshr_b32 s35, s2, 3
    s_cmp_lg_u32 s35, 21
    s_cbranch_scc1 L_nopf
    s_getpc_b64 s[48:49]
    s_and_b32 s48, s48, 0xffffff00
    s_mov_b32 s50, L_codeend-adaLN_cond__sliding_block_cached__dense_activation_gelu__decode_kernel
    s_mov_b32 s51, 0x20000
    s_mov_b32 s52, 12288
    buffer_load_dwordx4 v[152:155], v2, s[48:51], 0 offen
    buffer_load_dwordx4 v[156:159], v2, s[48:51], s52 offen
L_nopf:
    s_lshr_b32 s36, s35, 3
    s_lshl2_add_u32 s36, s34, s36
    s_bfe_u32 s37, s35, 0x20001
    s_and_b32 s38, s35, 1
    s_cmp_lt_u32 s35, 27
    s_cselect_b32 s39, 1, 0
    s_cmp_eq_u32 s34, 2
    s_cselect_b32 s39, s39, 0
    s_sub_u32 s62, s34, 3
    s_and_b32 s62, s62, 7
    s_mul_i32 s56, s35, 7
    s_add_u32 s56, s56, s62
    s_cmp_eq_u32 s62, 7
    s_cselect_b32 s56, 255, s56
    s_mov_b32 s60, 400000
    s_mov_b32 s61, 0
    v_mov_b32 v36, 0
    s_cmp_lt_u32 s3, 4
    s_cbranch_scc1 L_helpers
    s_sub_u32 s3, s3, 4
    s_cmp_ge_u32 s35, 22
    s_cselect_b32 s59, 1, 0
    s_add_u32 s62, s3, s59
    s_cmp_ge_u32 s62, 6
    s_cselect_b32 s62, s39, 0
    s_cmp_eq_u32 s62, 1
    s_cbranch_scc1 L_proxy
    s_cmp_eq_u32 s59, 1
    s_cselect_b32 s100, 0, 81920
    s_lshl_b32 s62, s3, 13
    s_add_u32 s100, s100, s62
    s_and_b32 s62, s39, s59
    s_cselect_b32 s100, -1, s100
    s_mov_b32 s101, 0
L_stream:
    s_lshl_b32 s62, s37, 5
    s_add_u32 s62, s62, s36
    s_lshl_b32 s63, s62, 21
    s_lshl_b32 s96, s38, 18
    s_add_u32 s63, s63, s96
    s_add_u32 s63, s63, 1572864
    v_lshlrev_b32 v1, 4, v0
    s_lshl_b32 s96, s3, 12
    v_add_u32 v1, s96, v1
    s_mov_b32 s97, 0
    s_mov_b32 s50, 262144
    s_mov_b32 s51, 0x20000
    s_waitcnt lgkmcnt(0)
    s_add_u32 s48, s6, s63
    s_addc_u32 s49, s7, 0
    s_cmp_lt_u32 s56, 40
    s_cbranch_scc0 L_nob0
    s_barrier
L_nob0:
    buffer_load_dwordx4 v[40:43], v1, s[48:51], s97 offen offset:0 nt
    buffer_load_dwordx4 v[44:47], v1, s[48:51], s97 offen offset:1024 nt
    s_cmp_lt_u32 s56, 40
    s_cbranch_scc1 L_stream2
    s_barrier
    s_branch L_stream2
L_helpers:
    s_cmp_lg_u32 s3, 0
    s_cbranch_scc1 L_noinit
    v_lshlrev_b32 v1, 2, v0
    v_add_u32 v1, 161920, v1
    ds_write_b32 v1, v36
L_noinit:
    s_waitcnt lgkmcnt(0)
    s_mov_b32 s40, s32
    s_mov_b32 s41, s33
    s_mov_b32 s42, 589824
    s_mov_b32 s43, 0x20000
    s_mov_b32 s44, s30
    s_mov_b32 s45, s31
    s_mov_b32 s46, 256
    s_mov_b32 s47, 0x20000
    s_lshl2_add_u32 s62, s35, s3
    s_cmp_eq_u32 s62, 87
    s_cbranch_scc1 L_touch
L_notp:
    s_mul_i32 s101, s3, 20480
    s_mov_b32 s96, s56
    s_cmp_lt_u32 s56, 40
    s_cbranch_scc0 L_nothalf
    s_cmp_lt_u32 s3, 2
    s_cbranch_scc1 L_unit
    s_add_u32 s62, s56, 20
    s_cmp_eq_u32 s3, 2
    s_cbranch_scc1 L_job
    s_lshr_b32 s62, s56, 1
    s_and_b32 s63, s56, 1
    s_mul_i32 s63, s63, 5120
    s_lshl_b32 s96, s62, 7
    s_add_u32 s63, s63, s96
    s_cmp_ge_u32 s62, 10
    s_cselect_b32 s62, 8960, 0
    s_add_u32 s63, s63, s62
    v_lshrrev_b32 v1, 4, v0
    v_mul_u32_u24 v1, 1280, v1
    v_and_b32 v2, 15, v0
    v_lshl_add_u32 v1, v2, 3, v1
    v_mov_b32 v4, -1
    v_mov_b32 v5, -1
    buffer_store_dwordx2 v[4:5], v1, s[40:43], s63 offen sc1
    s_lshl_b32 s62, s56, 1
    s_waitcnt vmcnt(0)
    s_mov_b64 exec, 1
    buffer_store_short v4, v36, s[44:47], s62 offen offset:128 sc1
    s_mov_b64 exec, -1
    s_barrier
    s_branch L_service
L_nothalf:
    s_cmp_lt_u32 s56, 104
    s_cbranch_scc1 L_unit
    s_sub_u32 s62, s56, 144
    s_cmp_lt_u32 s62, 10
    s_cbranch_scc0 L_nojob
    s_cmp_lt_u32 s3, 2
    s_cbranch_scc0 L_nojob
    s_mul_i32 s63, s3, 10
    s_add_u32 s62, s62, s63
L_job:
    s_cmp_lt_u32 s62, 59
    s_cbranch_scc0 L_end
    s_mov_b32 s100, s101
    s_lshl_b32 s101, s62, 9
    s_add_u32 s101, s101, 196608
    s_cmp_lt_u32 s62, 27
    s_cselect_b32 s63, 0, 27
    s_cselect_b32 s3, 7, 6
    s_cmp_lt_u32 s62, 54
    s_cselect_b32 s63, s63, 32
    s_cselect_b32 s3, s3, 5
    s_sub_u32 s35, s62, s63
    s_mov_b32 s34, 2
    s_lshr_b32 s36, s35, 3
    s_add_u32 s36, s36, 8
    s_bfe_u32 s37, s35, 0x20001
    s_and_b32 s38, s35, 1
    s_mov_b32 s59, 0
    s_branch L_stream
L_nojob:
    s_barrier
    s_cmp_ge_u32 s35, 22
    s_cbranch_scc1 L_h_t1
    s_cmp_eq_u32 s39, 1
    s_cbranch_scc1 L_h_role
    s_cmp_lt_u32 s96, 144
    s_cbranch_scc1 L_unit
    s_cmp_eq_u32 s3, 3
    s_cbranch_scc1 L_service
    s_endpgm
L_unit:
    v_lshrrev_b32 v3, 4, v0
    v_and_b32 v4, 3, v0
    v_bfe_u32 v7, v0, 2, 2
    v_lshlrev_b32 v64, 5, v7
    v_lshl_add_u32 v64, v3, 3, v64
    s_mov_b32 s14, s3
    s_mov_b32 s15, 3
    s_sub_u32 s62, s96, 40
    s_cmp_lt_u32 s62, 64
    s_cbranch_scc1 L_u_q
    s_mov_b32 s100, 1
    s_sub_u32 s96, s96, 84
    s_mov_b32 s12, 10240
    s_cmp_lt_u32 s56, 40
    s_cbranch_scc0 L_u_full
    s_mov_b32 s100, 0
    s_lshr_b32 s96, s56, 1
    s_and_b32 s62, s56, 1
    s_lshl1_add_u32 s14, s62, s14
    s_mov_b32 s15, 1
    s_cmp_ge_u32 s96, 10
    s_addc_u32 s62, s62, 0
    s_mul_i32 s12, s62, 5120
    s_add_u32 s12, s12, 0
L_u_full:
    s_mov_b32 s97, 0
    s_mov_b32 s99, 7680
    s_mov_b32 s48, s26
    s_mov_b32 s49, s27
    s_mov_b32 s50, 4915200
    s_mov_b32 s51, 0x20000
    s_mov_b32 s52, s24
    s_mov_b32 s53, s25
    s_mov_b32 s54, 5120
    s_mov_b32 s55, 0x20000
    v_and_b32 v6, 15, v0
    v_lshlrev_b32 v6, 4, v6
    v_mul_u32_u24 v5, 1280, v3
    v_add_u32 v5, v5, v6
    s_mul_i32 s62, s14, 320
    buffer_load_dwordx4 v[8:11], v5, s[52:55], s62 offen
    s_mov_b32 exec_lo, 0x000f000f
    s_mov_b32 exec_hi, 0x000f000f
    buffer_load_dwordx4 v[12:15], v5, s[52:55], s62 offen offset:256
    s_mov_b64 exec, -1
    s_lshl_b32 s98, s96, 7
    s_mul_i32 s13, s96, 0x199a
    s_lshr_b32 s13, s13, 16
    s_mul_i32 s63, s13, 3840
    s_add_u32 s57, s98, s63
    s_add_u32 s57, s57, s12
    v_mul_u32_u24 v5, 1280, v4
    v_add_u32 v64, v64, v5
    s_cmp_lg_u32 s13, 1
    s_cbranch_scc1 L_u_go
    s_mov_b32 s52, s4
    s_mov_b32 s53, s5
    s_mov_b32 s54, 5120
    s_mov_b32 s55, 0x20000
    v_lshrrev_b32 v6, 2, v0
    v_lshl_add_u32 v6, v6, 4, v5
    s_sub_u32 s62, s98, 1280
    buffer_load_dwordx4 v[16:19], v6, s[52:55], 0 offen offset:0
    buffer_load_dwordx4 v[20:23], v6, s[52:55], 0 offen offset:256
    buffer_load_dwordx4 v[24:27], v6, s[52:55], 0 offen offset:512
    buffer_load_dwordx4 v[28:31], v6, s[52:55], 0 offen offset:768
    buffer_load_dwordx4 v[32:35], v6, s[52:55], 0 offen offset:1024
    buffer_load_dwordx2 v[66:67], v64, s[52:55], s62 offen
    s_branch L_u_go
L_u_q:
    s_mov_b32 s97, 1
    s_mov_b32 s99, 8192
    s_mov_b32 s100, 0
    s_lshl_b32 s98, s62, 7
    s_add_u32 s57, s98, 40960
    v_lshl_add_u32 v64, v4, 13, v64
    s_mov_b32 s48, s10
    s_mov_b32 s49, s11
    s_mov_b32 s50, 5242880
    s_mov_b32 s51, 0x20000
L_u_go:
    v_lshrrev_b32 v6, 3, v0
    v_mul_lo_u32 v1, v6, s99
    v_and_b32 v6, 2, v6
    v_xor_b32 v6, v6, v0
    v_and_b32 v6, 7, v6
    v_lshl_add_u32 v1, v6, 4, v1
    v_add_u32 v1, s98, v1
    v_xor_b32 v2, 64, v1
    s_mul_i32 s63, s99, s14
    s_mul_i32 s63, s63, 160
    s_lshl_b32 s59, s99, 3
    s_mov_b32 m0, s101
    s_mov_b32 s62, 10
L_dma_1:
    buffer_load_dwordx4 v1, s[48:51], s63 offen nt lds
    s_add_u32 m0, m0, 1024
    s_add_u32 s63, s63, s59
    s_cmp_eq_u32 s100, 0
    s_cbranch_scc1 L_dma_1n0
    s_waitcnt vmcnt(3)
    s_cmp_eq_u32 s100, 2
    s_cbranch_scc1 L_dma_1n0
    s_waitcnt vmcnt(3)
L_dma_1n0:
    buffer_load_dwordx4 v2, s[48:51], s63 offen nt lds
    s_add_u32 m0, m0, 1024
    s_add_u32 s63, s63, s59
    s_cmp_eq_u32 s100, 0
    s_cbranch_scc1 L_dma_1n1
    s_waitcnt vmcnt(3)
    s_cmp_eq_u32 s100, 2
    s_cbranch_scc1 L_dma_1n1
    s_waitcnt vmcnt(3)
L_dma_1n1:
    s_sub_u32 s62, s62, 1
    s_cmp_lg_u32 s62, 0
    s_cbranch_scc1 L_dma_1
    v_min_u32 v65, 29, v0
    v_lshlrev_b32 v65, 2, v65
    s_cmp_lt_u32 s56, 104
    s_cselect_b32 s62, 32, 64
    v_min_u32 v6, 51, v0
    v_lshlrev_b32 v6, 2, v6
    v_cmp_le_u32 vcc, s62, v0
    s_nop 1
    v_cndmask_b32 v65, v65, v6, vcc
    v_mov_b32 v68, -1
    s_cmp_lt_u32 s56, 40
    s_cbranch_scc1 L_u_nofl
    buffer_load_dword v68, v65, s[44:47], 0 offen sc1
L_u_nofl:
    s_cmp_lt_u32 s56, 104
    s_cbranch_scc0 L_u_nob
    s_barrier
L_u_nob:
    v_lshrrev_b32 v60, 4, v0
    v_lshlrev_b32 v60, 10, v60
    v_bfe_u32 v6, v0, 2, 2
    v_lshl_add_u32 v60, v6, 7, v60
    v_and_b32 v6, 3, v0
    v_lshl_add_u32 v60, v6, 3, v60
    v_bfe_u32 v6, v0, 3, 2
    v_lshl_add_u32 v60, v6, 5, v60
    v_xor_b32 v61, 32, v60
    v_xor_b32 v62, 64, v60
    v_xor_b32 v63, 0x60, v60
    v_add_u32 v60, s101, v60
    v_add_u32 v61, s101, v61
    v_add_u32 v62, s101, v62
    v_add_u32 v63, s101, v63
    v_mov_b32 v56, 1.0
    v_mov_b32 v57, 1.0
    v_mov_b32 v58, 1.0
    v_mov_b32 v59, 1.0
    s_mov_b32 s58, 0
    s_cmp_eq_u32 s97, 1
    s_cbranch_scc1 L_u_q2
    s_cmp_eq_u32 s13, 4
    s_cselect_b32 s58, 1.0, 0
    s_cmp_lt_u32 s14, 2
    s_cselect_b32 s62, 1.0, 0
    s_cmp_eq_u32 s13, 1
    s_cselect_b32 s58, s62, s58
    s_cselect_b32 s56, 1, 0
    s_waitcnt vmcnt(20)
    s_mov_b32 s62, 0xbfb8aa3b
    v_lshlrev_b32 v40, 16, v8
    v_and_b32 v41, 0xffff0000, v8
    v_lshlrev_b32 v42, 16, v9
    v_and_b32 v43, 0xffff0000, v9
    v_lshlrev_b32 v44, 16, v10
    v_and_b32 v45, 0xffff0000, v10
    v_lshlrev_b32 v46, 16, v11
    v_and_b32 v47, 0xffff0000, v11
    v_mul_f32 v48, s62, v40
    v_mul_f32 v49, s62, v41
    v_mul_f32 v50, s62, v42
    v_mul_f32 v51, s62, v43
    v_mul_f32 v52, s62, v44
    v_mul_f32 v53, s62, v45
    v_mul_f32 v54, s62, v46
    v_mul_f32 v55, s62, v47
    v_exp_f32 v48, v48
    v_exp_f32 v49, v49
    v_exp_f32 v50, v50
    v_exp_f32 v51, v51
    v_exp_f32 v52, v52
    v_exp_f32 v53, v53
    v_exp_f32 v54, v54
    v_exp_f32 v55, v55
    v_add_f32 v48, 1.0, v48
    v_add_f32 v49, 1.0, v49
    v_add_f32 v50, 1.0, v50
    v_add_f32 v51, 1.0, v51
    v_add_f32 v52, 1.0, v52
    v_add_f32 v53, 1.0, v53
    v_add_f32 v54, 1.0, v54
    v_add_f32 v55, 1.0, v55
    v_rcp_f32 v48, v48
    v_rcp_f32 v49, v49
    v_rcp_f32 v50, v50
    v_rcp_f32 v51, v51
    v_rcp_f32 v52, v52
    v_rcp_f32 v53, v53
    v_rcp_f32 v54, v54
    v_rcp_f32 v55, v55
    v_mul_f32 v40, v40, v48
    v_mul_f32 v41, v41, v49
    v_mul_f32 v42, v42, v50
    v_mul_f32 v43, v43, v51
    v_mul_f32 v44, v44, v52
    v_mul_f32 v45, v45, v53
    v_mul_f32 v46, v46, v54
    v_mul_f32 v47, v47, v55
    v_cvt_pk_bf16_f32 v8, v40, v41
    v_cvt_pk_bf16_f32 v9, v42, v43
    v_cvt_pk_bf16_f32 v10, v44, v45
    v_cvt_pk_bf16_f32 v11, v46, v47
    v_lshlrev_b32 v40, 16, v12
    v_and_b32 v41, 0xffff0000, v12
    v_lshlrev_b32 v42, 16, v13
    v_and_b32 v43, 0xffff0000, v13
    v_lshlrev_b32 v44, 16, v14
    v_and_b32 v45, 0xffff0000, v14
    v_lshlrev_b32 v46, 16, v15
    v_and_b32 v47, 0xffff0000, v15
    v_mul_f32 v48, s62, v40
    v_mul_f32 v49, s62, v41
    v_mul_f32 v50, s62, v42
    v_mul_f32 v51, s62, v43
    v_mul_f32 v52, s62, v44
    v_mul_f32 v53, s62, v45
    v_mul_f32 v54, s62, v46
    v_mul_f32 v55, s62, v47
    v_exp_f32 v48, v48
    v_exp_f32 v49, v49
    v_exp_f32 v50, v50
    v_exp_f32 v51, v51
    v_exp_f32 v52, v52
    v_exp_f32 v53, v53
    v_exp_f32 v54, v54
    v_exp_f32 v55, v55
    v_add_f32 v48, 1.0, v48
    v_add_f32 v49, 1.0, v49
    v_add_f32 v50, 1.0, v50
    v_add_f32 v51, 1.0, v51
    v_add_f32 v52, 1.0, v52
    v_add_f32 v53, 1.0, v53
    v_add_f32 v54, 1.0, v54
    v_add_f32 v55, 1.0, v55
    v_rcp_f32 v48, v48
    v_rcp_f32 v49, v49
    v_rcp_f32 v50, v50
    v_rcp_f32 v51, v51
    v_rcp_f32 v52, v52
    v_rcp_f32 v53, v53
    v_rcp_f32 v54, v54
    v_rcp_f32 v55, v55
    v_mul_f32 v40, v40, v48
    v_mul_f32 v41, v41, v49
    v_mul_f32 v42, v42, v50
    v_mul_f32 v43, v43, v51
    v_mul_f32 v44, v44, v52
    v_mul_f32 v45, v45, v53
    v_mul_f32 v46, v46, v54
    v_mul_f32 v47, v47, v55
    v_cvt_pk_bf16_f32 v12, v40, v41
    v_cvt_pk_bf16_f32 v13, v42, v43
    v_cvt_pk_bf16_f32 v14, v44, v45
    v_cvt_pk_bf16_f32 v15, v46, v47
    s_mul_i32 s62, s3, 1344
    s_add_u32 s62, s62, 151552
    v_mul_u32_u24 v5, 336, v3
    v_and_b32 v6, 15, v0
    v_lshl_add_u32 v5, v6, 4, v5
    v_add_u32 v5, s62, v5
    ds_write_b128 v5, v[8:11]
    s_mov_b32 exec_lo, 0x000f000f
    s_mov_b32 exec_hi, 0x000f000f
    ds_write_b128 v5, v[12:15] offset:256
    s_mov_b64 exec, -1
    v_mul_u32_u24 v5, 336, v4
    v_lshl_add_u32 v5, v3, 4, v5
    v_add_u32 v5, s62, v5
    s_mov_b32 s59, 0x3e800000
    s_cmp_eq_u32 s56, 0
    s_cbranch_scc1 L_u_nost
    v_mov_b32 v40, 0
    v_mov_b32 v41, 0
    s_mov_b32 s62, 0x3f803f80
    v_dot2c_f32_bf16 v40, s62, v16
    v_dot2c_f32_bf16 v41, v16, v16
    v_dot2c_f32_bf16 v40, s62, v17
    v_dot2c_f32_bf16 v41, v17, v17
    v_dot2c_f32_bf16 v40, s62, v18
    v_dot2c_f32_bf16 v41, v18, v18
    v_dot2c_f32_bf16 v40, s62, v19
    v_dot2c_f32_bf16 v41, v19, v19
    v_dot2c_f32_bf16 v40, s62, v20
    v_dot2c_f32_bf16 v41, v20, v20
    v_dot2c_f32_bf16 v40, s62, v21
    v_dot2c_f32_bf16 v41, v21, v21
    v_dot2c_f32_bf16 v40, s62, v22
    v_dot2c_f32_bf16 v41, v22, v22
    v_dot2c_f32_bf16 v40, s62, v23
    v_dot2c_f32_bf16 v41, v23, v23
    v_dot2c_f32_bf16 v40, s62, v24
    v_dot2c_f32_bf16 v41, v24, v24
    v_dot2c_f32_bf16 v40, s62, v25
    v_dot2c_f32_bf16 v41, v25, v25
    v_dot2c_f32_bf16 v40, s62, v26
    v_dot2c_f32_bf16 v41, v26, v26
    v_dot2c_f32_bf16 v40, s62, v27
    v_dot2c_f32_bf16 v41, v27, v27
    v_dot2c_f32_bf16 v40, s62, v28
    v_dot2c_f32_bf16 v41, v28, v28
    v_dot2c_f32_bf16 v40, s62, v29
    v_dot2c_f32_bf16 v41, v29, v29
    v_dot2c_f32_bf16 v40, s62, v30
    v_dot2c_f32_bf16 v41, v30, v30
    v_dot2c_f32_bf16 v40, s62, v31
    v_dot2c_f32_bf16 v41, v31, v31
    v_dot2c_f32_bf16 v40, s62, v32
    v_dot2c_f32_bf16 v41, v32, v32
    v_dot2c_f32_bf16 v40, s62, v33
    v_dot2c_f32_bf16 v41, v33, v33
    v_dot2c_f32_bf16 v40, s62, v34
    v_dot2c_f32_bf16 v41, v34, v34
    v_dot2c_f32_bf16 v40, s62, v35
    v_dot2c_f32_bf16 v41, v35, v35
    s_nop 1
    v_add_f32_dpp v40, v40, v40 row_ror:4 row_mask:0xf bank_mask:0xf
    v_add_f32_dpp v41, v41, v41 row_ror:4 row_mask:0xf bank_mask:0xf
    s_nop 0
    v_add_f32_dpp v40, v40, v40 row_ror:8 row_mask:0xf bank_mask:0xf
    v_add_f32_dpp v41, v41, v41 row_ror:8 row_mask:0xf bank_mask:0xf
    v_mov_b32 v42, v40
    v_mov_b32 v43, v41
    s_nop 0
    v_permlane16_swap_b32 v40, v42
    v_permlane16_swap_b32 v41, v43
    v_add_f32 v40, v40, v42
    v_add_f32 v41, v41, v43
    v_mov_b32 v42, v40
    v_mov_b32 v43, v41
    s_nop 0
    v_permlane32_swap_b32 v40, v42
    v_permlane32_swap_b32 v41, v43
    v_add_f32 v40, v40, v42
    v_add_f32 v41, v41, v43
    s_mov_b32 s62, 0x3acccccd
    v_mul_f32 v40, s62, v40
    v_mul_f32 v41, s62, v41
    v_fma_f32 v41, -v40, v40, v41
    v_max_f32 v41, 0, v41
    v_add_f32 v41, 0x3727c5ac, v41
    v_rsq_f32 v41, v41
    v_lshlrev_b32 v56, 16, v66
    v_and_b32 v57, 0xffff0000, v66
    v_lshlrev_b32 v58, 16, v67
    v_and_b32 v59, 0xffff0000, v67
    v_sub_f32 v56, v56, v40
    v_sub_f32 v57, v57, v40
    v_sub_f32 v58, v58, v40
    v_sub_f32 v59, v59, v40
    v_mul_f32 v56, v56, v41
    v_mul_f32 v57, v57, v41
    v_mul_f32 v58, v58, v41
    v_mul_f32 v59, v59, v41
L_u_nost:
    ds_read_b128 v[8:11], v5 offset:0
    ds_read_b128 v[12:15], v5 offset:64
    ds_read_b128 v[16:19], v5 offset:128
    ds_read_b128 v[20:23], v5 offset:192
    ds_read_b128 v[24:27], v5 offset:256
    s_branch L_u_frag
L_u_q2:
    v_and_b32 v5, 15, v0
    v_mul_u32_u24 v5, 1280, v5
    v_lshl_add_u32 v5, v3, 4, v5
    s_mul_i32 s63, s3, 320
    s_add_u32 s63, s63, 0
    s_mov_b32 s59, 1.0
L_u_frag:
    s_waitcnt vmcnt(0)
    v_cmp_ne_u32 vcc, -1, v68
    s_cbranch_vccz L_u_yok
L_wy_2:
    buffer_load_dword v37, v65, s[44:47], 0 offen sc1
    s_waitcnt vmcnt(0)
    v_cmp_ne_u32 vcc, -1, v37
    s_cbranch_vccz L_wy_2e
    s_sleep 4
    s_sub_u32 s60, s60, 1
    s_cbranch_scc0 L_wy_2
    s_mov_b32 s60, 0
L_wy_2e:
L_u_yok:
    ds_read_b64_tr_b16 v[80:81], v60 offset:0
    ds_read_b64_tr_b16 v[82:83], v60 offset:512
    ds_read_b64_tr_b16 v[84:85], v61 offset:0
    ds_read_b64_tr_b16 v[86:87], v61 offset:512
    ds_read_b64_tr_b16 v[88:89], v62 offset:0
    ds_read_b64_tr_b16 v[90:91], v62 offset:512
    ds_read_b64_tr_b16 v[92:93], v63 offset:0
    ds_read_b64_tr_b16 v[94:95], v63 offset:512
    ds_read_b64_tr_b16 v[96:97], v60 offset:4096
    ds_read_b64_tr_b16 v[98:99], v60 offset:4608
    ds_read_b64_tr_b16 v[100:101], v61 offset:4096
    ds_read_b64_tr_b16 v[102:103], v61 offset:4608
    ds_read_b64_tr_b16 v[104:105], v62 offset:4096
    ds_read_b64_tr_b16 v[106:107], v62 offset:4608
    ds_read_b64_tr_b16 v[108:109], v63 offset:4096
    ds_read_b64_tr_b16 v[110:111], v63 offset:4608
    ds_read_b64_tr_b16 v[112:113], v60 offset:8192
    ds_read_b64_tr_b16 v[114:115], v60 offset:8704
    ds_read_b64_tr_b16 v[116:117], v61 offset:8192
    ds_read_b64_tr_b16 v[118:119], v61 offset:8704
    ds_read_b64_tr_b16 v[120:121], v62 offset:8192
    ds_read_b64_tr_b16 v[122:123], v62 offset:8704
    ds_read_b64_tr_b16 v[124:125], v63 offset:8192
    ds_read_b64_tr_b16 v[126:127], v63 offset:8704
    ds_read_b64_tr_b16 v[128:129], v60 offset:12288
    ds_read_b64_tr_b16 v[130:131], v60 offset:12800
    ds_read_b64_tr_b16 v[132:133], v61 offset:12288
    ds_read_b64_tr_b16 v[134:135], v61 offset:12800
    ds_read_b64_tr_b16 v[136:137], v62 offset:12288
    ds_read_b64_tr_b16 v[138:139], v62 offset:12800
    ds_read_b64_tr_b16 v[140:141], v63 offset:12288
    ds_read_b64_tr_b16 v[142:143], v63 offset:12800
    ds_read_b64_tr_b16 v[144:145], v60 offset:16384
    ds_read_b64_tr_b16 v[146:147], v60 offset:16896
    ds_read_b64_tr_b16 v[148:149], v61 offset:16384
    ds_read_b64_tr_b16 v[150:151], v61 offset:16896
    ds_read_b64_tr_b16 v[152:153], v62 offset:16384
    ds_read_b64_tr_b16 v[154:155], v62 offset:16896
    ds_read_b64_tr_b16 v[156:157], v63 offset:16384
    ds_read_b64_tr_b16 v[158:159], v63 offset:16896
    s_cmp_eq_u32 s97, 0
    s_cbranch_scc1 L_u_mm
    v_lshrrev_b32 v6, 2, v0
    v_mul_u32_u24 v6, 158, v6
    v_and_b32 v6, 0xfffc, v6
    v_and_b32 v7, 3, v0
    v_mul_u32_u24 v7, 5120, v7
    v_add_u32 v6, v6, v7
    s_mov_b64 exec, 0xfff
    s_branch L_poll_3
L_poll_3s:
    s_sleep 4
L_poll_3:
    buffer_load_dword v8, v6, s[40:43], s63 offen offset:3840 sc1
    s_sub_u32 s60, s60, 1
    s_cbranch_scc1 L_poll_3t
    s_waitcnt vmcnt(0)
    v_cmp_eq_u32 vcc, -1, v8
    s_cbranch_vccnz L_poll_3s
L_poll_3e:
    s_mov_b64 exec, -1
    s_branch L_poll_4
L_poll_4s:
    s_sleep 1
L_poll_4:
    buffer_load_dwordx4 v[8:11], v5, s[40:43], s63 offen offset:0 sc1
    buffer_load_dwordx4 v[12:15], v5, s[40:43], s63 offen offset:64 sc1
    buffer_load_dwordx4 v[16:19], v5, s[40:43], s63 offen offset:128 sc1
    buffer_load_dwordx4 v[20:23], v5, s[40:43], s63 offen offset:192 sc1
    buffer_load_dwordx4 v[24:27], v5, s[40:43], s63 offen offset:256 sc1
    s_sub_u32 s60, s60, 1
    s_cbranch_scc1 L_poll_4t
    s_waitcnt vmcnt(0)
    v_max3_u32 v37, v8, v9, v10
    v_max3_u32 v37, v37, v11, v12
    v_max3_u32 v37, v37, v13, v14
    v_max3_u32 v37, v37, v15, v16
    v_max3_u32 v37, v37, v17, v18
    v_max3_u32 v37, v37, v19, v20
    v_max3_u32 v37, v37, v21, v22
    v_max3_u32 v37, v37, v23, v24
    v_max3_u32 v37, v37, v25, v26
    v_max_u32 v37, v37, v27
    v_cmp_eq_u32 vcc, -1, v37
    s_cbranch_vccnz L_poll_4s
L_poll_4e:
L_u_got:
L_u_mm:
    s_waitcnt lgkmcnt(0)
    v_mfma_f32_16x16x32_bf16 v[40:43], v[80:83], v[8:11], 0
    v_mfma_f32_16x16x32_bf16 v[44:47], v[84:87], v[8:11], 0
    v_mfma_f32_16x16x32_bf16 v[48:51], v[88:91], v[8:11], 0
    v_mfma_f32_16x16x32_bf16 v[52:55], v[92:95], v[8:11], 0
    v_mfma_f32_16x16x32_bf16 v[40:43], v[96:99], v[12:15], v[40:43]
    v_mfma_f32_16x16x32_bf16 v[44:47], v[100:103], v[12:15], v[44:47]
    v_mfma_f32_16x16x32_bf16 v[48:51], v[104:107], v[12:15], v[48:51]
    v_mfma_f32_16x16x32_bf16 v[52:55], v[108:111], v[12:15], v[52:55]
    v_mfma_f32_16x16x32_bf16 v[40:43], v[112:115], v[16:19], v[40:43]
    v_mfma_f32_16x16x32_bf16 v[44:47], v[116:119], v[16:19], v[44:47]
    v_mfma_f32_16x16x32_bf16 v[48:51], v[120:123], v[16:19], v[48:51]
    v_mfma_f32_16x16x32_bf16 v[52:55], v[124:127], v[16:19], v[52:55]
    v_mfma_f32_16x16x32_bf16 v[40:43], v[128:131], v[20:23], v[40:43]
    v_mfma_f32_16x16x32_bf16 v[44:47], v[132:135], v[20:23], v[44:47]
    v_mfma_f32_16x16x32_bf16 v[48:51], v[136:139], v[20:23], v[48:51]
    v_mfma_f32_16x16x32_bf16 v[52:55], v[140:143], v[20:23], v[52:55]
    v_mfma_f32_16x16x32_bf16 v[40:43], v[144:147], v[24:27], v[40:43]
    v_mfma_f32_16x16x32_bf16 v[44:47], v[148:151], v[24:27], v[44:47]
    v_mfma_f32_16x16x32_bf16 v[48:51], v[152:155], v[24:27], v[48:51]
    v_mfma_f32_16x16x32_bf16 v[52:55], v[156:159], v[24:27], v[52:55]
    v_lshlrev_b32 v5, 4, v0
    v_add_u32 v5, 147456, v5
    s_lshl_b32 s62, s3, 10
    v_add_u32 v6, s62, v5
    v_mov_b32 v32, 162056
    v_mov_b32 v33, 1
    v_add_f32_dpp v40, v40, v40 row_ror:8 row_mask:0xf bank_mask:0xf
    v_add_f32_dpp v41, v41, v41 row_ror:8 row_mask:0xf bank_mask:0xf
    v_add_f32_dpp v42, v42, v42 row_ror:8 row_mask:0xf bank_mask:0xf
    v_add_f32_dpp v43, v43, v43 row_ror:8 row_mask:0xf bank_mask:0xf
    v_add_f32_dpp v44, v44, v44 row_ror:8 row_mask:0xf bank_mask:0xf
    v_add_f32_dpp v45, v45, v45 row_ror:8 row_mask:0xf bank_mask:0xf
    v_add_f32_dpp v46, v46, v46 row_ror:8 row_mask:0xf bank_mask:0xf
    v_add_f32_dpp v47, v47, v47 row_ror:8 row_mask:0xf bank_mask:0xf
    v_add_f32_dpp v48, v48, v48 row_ror:8 row_mask:0xf bank_mask:0xf
    v_add_f32_dpp v49, v49, v49 row_ror:8 row_mask:0xf bank_mask:0xf
    v_add_f32_dpp v50, v50, v50 row_ror:8 row_mask:0xf bank_mask:0xf
    v_add_f32_dpp v51, v51, v51 row_ror:8 row_mask:0xf bank_mask:0xf
    v_add_f32_dpp v52, v52, v52 row_ror:8 row_mask:0xf bank_mask:0xf
    v_add_f32_dpp v53, v53, v53 row_ror:8 row_mask:0xf bank_mask:0xf
    v_add_f32_dpp v54, v54, v54 row_ror:8 row_mask:0xf bank_mask:0xf
    v_add_f32_dpp v55, v55, v55 row_ror:8 row_mask:0xf bank_mask:0xf
    v_add_f32_dpp v28, v40, v40 row_ror:4 row_mask:0xf bank_mask:0x1
    v_add_f32_dpp v29, v41, v41 row_ror:4 row_mask:0xf bank_mask:0x1
    v_add_f32_dpp v30, v42, v42 row_ror:4 row_mask:0xf bank_mask:0x1
    v_add_f32_dpp v31, v43, v43 row_ror:4 row_mask:0xf bank_mask:0x1
    v_add_f32_dpp v28, v44, v44 row_ror:4 row_mask:0xf bank_mask:0x2
    v_add_f32_dpp v29, v45, v45 row_ror:4 row_mask:0xf bank_mask:0x2
    v_add_f32_dpp v30, v46, v46 row_ror:4 row_mask:0xf bank_mask:0x2
    v_add_f32_dpp v31, v47, v47 row_ror:4 row_mask:0xf bank_mask:0x2
    v_add_f32_dpp v28, v48, v48 row_ror:4 row_mask:0xf bank_mask:0x4
    v_add_f32_dpp v29, v49, v49 row_ror:4 row_mask:0xf bank_mask:0x4
    v_add_f32_dpp v30, v50, v50 row_ror:4 row_mask:0xf bank_mask:0x4
    v_add_f32_dpp v31, v51, v51 row_ror:4 row_mask:0xf bank_mask:0x4
    v_add_f32_dpp v28, v52, v52 row_ror:4 row_mask:0xf bank_mask:0x8
    v_add_f32_dpp v29, v53, v53 row_ror:4 row_mask:0xf bank_mask:0x8
    v_add_f32_dpp v30, v54, v54 row_ror:4 row_mask:0xf bank_mask:0x8
    v_add_f32_dpp v31, v55, v55 row_ror:4 row_mask:0xf bank_mask:0x8
    ds_write_b128 v6, v[28:31]
    s_mov_b64 exec, 1
    ds_add_rtn_u32 v34, v32, v33
    s_mov_b64 exec, -1
    ds_read_b128 v[8:11], v5
    ds_read_b128 v[12:15], v5 offset:1024
    ds_read_b128 v[16:19], v5 offset:2048
    ds_read_b128 v[20:23], v5 offset:3072
    s_waitcnt lgkmcnt(0)
    v_readfirstlane_b32 s62, v34
    v_mov_b32 v24, s58
    s_cmp_eq_u32 s62, s15
    s_cbranch_scc1 L_u_last
    s_cmp_eq_u32 s62, 1
    s_cbranch_scc1 L_service
    s_endpgm
L_u_last:
    v_add_f32 v8, v8, v12
    v_add_f32 v9, v9, v13
    v_add_f32 v10, v10, v14
    v_add_f32 v11, v11, v15
    s_cmp_eq_u32 s15, 1
    s_cbranch_scc1 L_u_two
    v_add_f32 v16, v16, v20
    v_add_f32 v17, v17, v21
    v_add_f32 v18, v18, v22
    v_add_f32 v19, v19, v23
    v_add_f32 v8, v8, v16
    v_add_f32 v9, v9, v17
    v_add_f32 v10, v10, v18
    v_add_f32 v11, v11, v19
L_u_two:
    v_fma_f32 v8, v8, s59, v24
    v_fma_f32 v9, v9, s59, v24
    v_fma_f32 v10, v10, s59, v24
    v_fma_f32 v11, v11, s59, v24
    v_mul_f32 v8, v8, v56
    v_mul_f32 v9, v9, v57
    v_mul_f32 v10, v10, v58
    v_mul_f32 v11, v11, v59
    v_cvt_pk_bf16_f32 v8, v8, v9
    v_cvt_pk_bf16_f32 v9, v10, v11
    buffer_store_dwordx2 v[8:9], v64, s[40:43], s57 offen sc1
    s_endpgm
L_touch:
    s_load_dword s0, s[32:33], 0
    s_load_dword s0, s[30:31], 0
    s_cmp_eq_u32 s39, 1
    s_cbranch_scc1 L_tpr
    s_mov_b32 s62, 16777216
    s_load_dword s0, s[8:9], s62
    s_mov_b32 s62, 83886080
    s_load_dword s0, s[8:9], s62
    s_mov_b32 s62, 150994944
    s_load_dword s0, s[8:9], s62
    s_mov_b32 s62, 218103808
    s_load_dword s0, s[8:9], s62
    s_branch L_tpv
L_tpr:
    s_load_dword s0, s[20:21], 0
    s_mov_b32 s62, 2211836
    s_load_dword s0, s[20:21], s62
    s_load_dword s0, s[16:17], 0
    s_mov_b32 s62, 2211836
    s_load_dword s0, s[16:17], s62
    s_load_dword s0, s[18:19], 0
    s_load_dword s0, s[22:23], 0
    s_load_dword s0, s[28:29], 0
    s_load_dword s0, s[4:5], 0
L_tpv:
    s_lshl_b32 s62, s34, 23
    s_load_dword s0, s[8:9], s62
    s_add_u32 s62, s62, 67108864
    s_load_dword s0, s[8:9], s62
    s_add_u32 s62, s62, 67108864
    s_load_dword s0, s[8:9], s62
    s_add_u32 s62, s62, 67108864
    s_load_dword s0, s[8:9], s62
    s_add_u32 s62, s62, 67108864
    s_branch L_notp
L_stream2:
    s_mov_b32 s12, s100
    s_mov_b32 s13, s101
    s_mov_b32 s40, s32
    s_mov_b32 s41, s33
    s_mov_b32 s42, 589824
    s_mov_b32 s43, 0x20000
    s_mov_b32 s44, s30
    s_mov_b32 s45, s31
    s_mov_b32 s46, 256
    s_mov_b32 s47, 0x20000
    s_bitcmp1_b32 s3, 0
    s_mov_b32 s57, 0xffffffff
    s_mov_b32 s58, 0xffff
    s_mov_b32 s14, 0xffffffff
    s_mov_b32 s15, 0x0
L_pm_10:
    s_cmp_lt_u32 s56, 104
    s_cbranch_scc0 L_pm_11
    s_bitcmp1_b32 s3, 0
    s_mov_b32 s57, 0xffff
    s_mov_b32 s58, 0x0
    s_mov_b32 s14, 0xffffffff
    s_mov_b32 s15, 0x0
L_pm_11:
    s_sub_u32 s96, s56, 43
    s_and_b32 s96, s96, 0xffffffc7
    s_cmp_eq_u32 s96, 0
    s_cbranch_scc0 L_pm_12
    s_bitcmp1_b32 s3, 0
    s_mov_b32 s57, 0x0
    s_mov_b32 s58, 0x0
    s_mov_b32 s14, 0x0
    s_mov_b32 s15, 0x0
L_pm_12:
    s_cmp_lt_u32 s56, 40
    s_cbranch_scc0 L_pm_13
    s_bitcmp1_b32 s3, 0
    s_mov_b32 s57, 0xffffffff
    s_mov_b32 s58, 0xf
    s_mov_b32 s14, 0xffffffff
    s_mov_b32 s15, 0x0
L_pm_13:
    s_cmp_eq_u32 s39, 1
    s_cbranch_scc0 L_pm_14
    s_bitcmp1_b32 s3, 0
    s_mov_b32 s57, 0xff0fff
    s_cselect_b32 s57, 0xff00ffff, s57
    s_mov_b32 s58, 0xfff
    s_mov_b32 s14, 0xff00ff
    s_cselect_b32 s14, 0xff00ff00, s14
    s_mov_b32 s15, 0x0
L_pm_14:
    s_cmp_lg_u32 s13, 0
    s_cbranch_scc0 L_pm_15
    s_bitcmp1_b32 s3, 0
    s_mov_b32 s57, 0xffffffff
    s_mov_b32 s58, 0x0
    s_mov_b32 s14, 0x0
    s_mov_b32 s15, 0x0
L_pm_15:
    s_and_b32 s96, s39, s59
    s_cbranch_scc0 L_pm_16
    s_bitcmp1_b32 s3, 0
    s_mov_b32 s57, 0xffff
    s_mov_b32 s58, 0xffff
    s_mov_b32 s14, 0x0
    s_mov_b32 s15, 0x0
L_pm_16:
    s_add_u32 s52, s8, s63
    s_addc_u32 s53, s9, 0
    s_mov_b32 s54, 262144
    s_mov_b32 s55, 0x20000
    v_and_b32 v2, 15, v0
    v_lshrrev_b32 v3, 1, v2
    v_and_b32 v37, 1, v2
    v_lshlrev_b32 v37, 4, v37
    v_mov_b32 v38, 0xffff
    v_lshlrev_b32 v37, v37, v38
    v_cmp_eq_u32 vcc, 0, v3
    v_mov_b32 v32, 0
    s_nop 0
    v_cndmask_b32 v20, 0, v37, vcc
    v_cmp_eq_u32 vcc, 1, v3
    v_mov_b32 v33, 0
    s_nop 0
    v_cndmask_b32 v21, 0, v37, vcc
    v_cmp_eq_u32 vcc, 2, v3
    v_mov_b32 v34, 0
    s_nop 0
    v_cndmask_b32 v22, 0, v37, vcc
    v_cmp_eq_u32 vcc, 3, v3
    v_mov_b32 v35, 0
    s_nop 0
    v_cndmask_b32 v23, 0, v37, vcc
    v_lshlrev_b32 v2, 4, v2
    s_lshl_b32 s98, s62, 8
    s_add_u32 s98, s98, 40960
    s_lshl_b32 s99, s62, 7
    s_add_u32 s99, s99, 73728
    s_bitcmp0_b32 s57, 2
    s_cbranch_scc1 L_sf_17
    s_bitcmp0_b32 s58, 2
    s_cbranch_scc1 L_sf_17
    s_waitcnt vmcnt(1)
L_sf_17:
    buffer_load_dwordx4 v[48:51], v1, s[48:51], s97 offen offset:2048 nt
    s_bitcmp0_b32 s57, 3
    s_cbranch_scc1 L_sf_18
    s_waitcnt vmcnt(2)
    s_bitcmp0_b32 s58, 3
    s_cbranch_scc1 L_sf_18
    s_waitcnt vmcnt(1)
L_sf_18:
    buffer_load_dwordx4 v[52:55], v1, s[48:51], s97 offen offset:3072 nt
    s_add_u32 s97, s97, 32768
    v_add_u32 v1, 4096, v1
    v_and_b32 v1, 0x7fff, v1
    s_waitcnt vmcnt(3)
    s_bitcmp0_b32 s57, 4
    s_cbranch_scc1 L_sf_19
    s_waitcnt vmcnt(2)
    s_bitcmp0_b32 s58, 4
    s_cbranch_scc1 L_sf_19
    s_waitcnt vmcnt(1)
L_sf_19:
    buffer_load_dwordx4 v[56:59], v1, s[48:51], s97 offen offset:0 nt
    s_waitcnt vmcnt(3)
    s_bitcmp0_b32 s57, 5
    s_cbranch_scc1 L_sf_20
    s_waitcnt vmcnt(2)
    s_bitcmp0_b32 s58, 5
    s_cbranch_scc1 L_sf_20
    s_waitcnt vmcnt(1)
L_sf_20:
    buffer_load_dwordx4 v[60:63], v1, s[48:51], s97 offen offset:1024 nt
    s_waitcnt vmcnt(3)
    s_bitcmp0_b32 s57, 6
    s_cbranch_scc1 L_sf_21
    s_waitcnt vmcnt(2)
    s_bitcmp0_b32 s58, 6
    s_cbranch_scc1 L_sf_21
    s_waitcnt vmcnt(1)
L_sf_21:
    buffer_load_dwordx4 v[64:67], v1, s[48:51], s97 offen offset:2048 nt
    s_waitcnt vmcnt(3)
    s_bitcmp0_b32 s57, 7
    s_cbranch_scc1 L_sf_22
    s_waitcnt vmcnt(2)
    s_bitcmp0_b32 s58, 7
    s_cbranch_scc1 L_sf_22
    s_waitcnt vmcnt(1)
L_sf_22:
    buffer_load_dwordx4 v[68:71], v1, s[48:51], s97 offen offset:3072 nt
    s_add_u32 s97, s97, 32768
    v_add_u32 v1, 4096, v1
    v_and_b32 v1, 0x7fff, v1
    s_waitcnt vmcnt(3)
    s_bitcmp0_b32 s57, 8
    s_cbranch_scc1 L_sf_23
    s_waitcnt vmcnt(2)
    s_bitcmp0_b32 s58, 8
    s_cbranch_scc1 L_sf_23
    s_waitcnt vmcnt(1)
L_sf_23:
    buffer_load_dwordx4 v[72:75], v1, s[48:51], s97 offen offset:0 nt
    s_waitcnt vmcnt(3)
    s_bitcmp0_b32 s57, 9
    s_cbranch_scc1 L_sf_24
    s_waitcnt vmcnt(2)
    s_bitcmp0_b32 s58, 9
    s_cbranch_scc1 L_sf_24
    s_waitcnt vmcnt(1)
L_sf_24:
    buffer_load_dwordx4 v[76:79], v1, s[48:51], s97 offen offset:1024 nt
    s_waitcnt vmcnt(3)
    s_bitcmp0_b32 s57, 10
    s_cbranch_scc1 L_sf_25
    s_waitcnt vmcnt(2)
    s_bitcmp0_b32 s58, 10
    s_cbranch_scc1 L_sf_25
    s_waitcnt vmcnt(1)
L_sf_25:
    buffer_load_dwordx4 v[80:83], v1, s[48:51], s97 offen offset:2048 nt
    s_waitcnt vmcnt(3)
    s_bitcmp0_b32 s57, 11
    s_cbranch_scc1 L_sf_26
    s_waitcnt vmcnt(2)
    s_bitcmp0_b32 s58, 11
    s_cbranch_scc1 L_sf_26
    s_waitcnt vmcnt(1)
L_sf_26:
    buffer_load_dwordx4 v[84:87], v1, s[48:51], s97 offen offset:3072 nt
    s_add_u32 s97, s97, 32768
    v_add_u32 v1, 4096, v1
    v_and_b32 v1, 0x7fff, v1
    s_waitcnt vmcnt(3)
    s_bitcmp0_b32 s57, 12
    s_cbranch_scc1 L_sf_27
    s_waitcnt vmcnt(2)
    s_bitcmp0_b32 s58, 12
    s_cbranch_scc1 L_sf_27
    s_waitcnt vmcnt(1)
L_sf_27:
    buffer_load_dwordx4 v[88:91], v1, s[48:51], s97 offen offset:0 nt
    s_waitcnt vmcnt(3)
    s_bitcmp0_b32 s57, 13
    s_cbranch_scc1 L_sf_28
    s_waitcnt vmcnt(2)
    s_bitcmp0_b32 s58, 13
    s_cbranch_scc1 L_sf_28
    s_waitcnt vmcnt(1)
L_sf_28:
    buffer_load_dwordx4 v[92:95], v1, s[48:51], s97 offen offset:1024 nt
    s_waitcnt vmcnt(3)
    s_bitcmp0_b32 s57, 14
    s_cbranch_scc1 L_sf_29
    s_waitcnt vmcnt(2)
    s_bitcmp0_b32 s58, 14
    s_cbranch_scc1 L_sf_29
    s_waitcnt vmcnt(1)
L_sf_29:
    buffer_load_dwordx4 v[96:99], v1, s[48:51], s97 offen offset:2048 nt
    s_waitcnt vmcnt(3)
    s_bitcmp0_b32 s57, 15
    s_cbranch_scc1 L_sf_30
    s_waitcnt vmcnt(2)
    s_bitcmp0_b32 s58, 15
    s_cbranch_scc1 L_sf_30
    s_waitcnt vmcnt(1)
L_sf_30:
    buffer_load_dwordx4 v[100:103], v1, s[48:51], s97 offen offset:3072 nt
    s_add_u32 s97, s97, 32768
    v_add_u32 v1, 4096, v1
    v_and_b32 v1, 0x7fff, v1
    s_waitcnt vmcnt(3)
    s_bitcmp0_b32 s57, 16
    s_cbranch_scc1 L_sf_31
    s_waitcnt vmcnt(2)
    s_bitcmp0_b32 s58, 16
    s_cbranch_scc1 L_sf_31
    s_waitcnt vmcnt(1)
L_sf_31:
    buffer_load_dwordx4 v[104:107], v1, s[48:51], s97 offen offset:0 nt
    s_waitcnt vmcnt(3)
    s_bitcmp0_b32 s57, 17
    s_cbranch_scc1 L_sf_32
    s_waitcnt vmcnt(2)
    s_bitcmp0_b32 s58, 17
    s_cbranch_scc1 L_sf_32
    s_waitcnt vmcnt(1)
L_sf_32:
    buffer_load_dwordx4 v[108:111], v1, s[48:51], s97 offen offset:1024 nt
    s_waitcnt vmcnt(3)
    s_bitcmp0_b32 s57, 18
    s_cbranch_scc1 L_sf_33
    s_waitcnt vmcnt(2)
    s_bitcmp0_b32 s58, 18
    s_cbranch_scc1 L_sf_33
    s_waitcnt vmcnt(1)
L_sf_33:
    buffer_load_dwordx4 v[112:115], v1, s[48:51], s97 offen offset:2048 nt
    s_waitcnt vmcnt(3)
    s_bitcmp0_b32 s57, 19
    s_cbranch_scc1 L_sf_34
    s_waitcnt vmcnt(2)
    s_bitcmp0_b32 s58, 19
    s_cbranch_scc1 L_sf_34
    s_waitcnt vmcnt(1)
L_sf_34:
    buffer_load_dwordx4 v[116:119], v1, s[48:51], s97 offen offset:3072 nt
    s_add_u32 s97, s97, 32768
    v_add_u32 v1, 4096, v1
    v_and_b32 v1, 0x7fff, v1
    s_waitcnt vmcnt(3)
    s_bitcmp0_b32 s57, 20
    s_cbranch_scc1 L_sf_35
    s_waitcnt vmcnt(2)
    s_bitcmp0_b32 s58, 20
    s_cbranch_scc1 L_sf_35
    s_waitcnt vmcnt(1)
L_sf_35:
    buffer_load_dwordx4 v[120:123], v1, s[48:51], s97 offen offset:0 nt
    s_waitcnt vmcnt(3)
    s_bitcmp0_b32 s57, 21
    s_cbranch_scc1 L_sf_36
    s_waitcnt vmcnt(2)
    s_bitcmp0_b32 s58, 21
    s_cbranch_scc1 L_sf_36
    s_waitcnt vmcnt(1)
L_sf_36:
    buffer_load_dwordx4 v[124:127], v1, s[48:51], s97 offen offset:1024 nt
    s_cmp_eq_u32 s12, -1
    s_cbranch_scc1 L_k_nopf
    s_waitcnt vmcnt(3)
    s_bitcmp0_b32 s57, 22
    s_cbranch_scc1 L_sf_37
    s_waitcnt vmcnt(2)
    s_bitcmp0_b32 s58, 22
    s_cbranch_scc1 L_sf_37
    s_waitcnt vmcnt(1)
L_sf_37:
    buffer_load_dwordx4 v[128:131], v1, s[48:51], s97 offen offset:2048 nt
    s_waitcnt vmcnt(3)
    s_bitcmp0_b32 s57, 23
    s_cbranch_scc1 L_sf_38
    s_waitcnt vmcnt(2)
    s_bitcmp0_b32 s58, 23
    s_cbranch_scc1 L_sf_38
    s_waitcnt vmcnt(1)
L_sf_38:
    buffer_load_dwordx4 v[132:135], v1, s[48:51], s97 offen offset:3072 nt
    s_add_u32 s97, s97, 32768
    v_add_u32 v1, 4096, v1
    v_and_b32 v1, 0x7fff, v1
    s_waitcnt vmcnt(3)
    s_bitcmp0_b32 s57, 24
    s_cbranch_scc1 L_sf_39
    s_waitcnt vmcnt(2)
    s_bitcmp0_b32 s58, 24
    s_cbranch_scc1 L_sf_39
    s_waitcnt vmcnt(1)
L_sf_39:
    buffer_load_dwordx4 v[136:139], v1, s[48:51], s97 offen offset:0 nt
    s_waitcnt vmcnt(3)
    s_bitcmp0_b32 s57, 25
    s_cbranch_scc1 L_sf_40
    s_waitcnt vmcnt(2)
    s_bitcmp0_b32 s58, 25
    s_cbranch_scc1 L_sf_40
    s_waitcnt vmcnt(1)
L_sf_40:
    buffer_load_dwordx4 v[140:143], v1, s[48:51], s97 offen offset:1024 nt
    s_waitcnt vmcnt(3)
    s_bitcmp0_b32 s57, 26
    s_cbranch_scc1 L_sf_41
    s_waitcnt vmcnt(2)
    s_bitcmp0_b32 s58, 26
    s_cbranch_scc1 L_sf_41
    s_waitcnt vmcnt(1)
L_sf_41:
    buffer_load_dwordx4 v[144:147], v1, s[48:51], s97 offen offset:2048 nt
    s_waitcnt vmcnt(3)
    s_bitcmp0_b32 s57, 27
    s_cbranch_scc1 L_sf_42
    s_waitcnt vmcnt(2)
    s_bitcmp0_b32 s58, 27
    s_cbranch_scc1 L_sf_42
    s_waitcnt vmcnt(1)
L_sf_42:
    buffer_load_dwordx4 v[148:151], v1, s[48:51], s97 offen offset:3072 nt
    s_add_u32 s97, s97, 32768
    v_add_u32 v1, 4096, v1
    v_and_b32 v1, 0x7fff, v1
    s_waitcnt vmcnt(3)
    s_bitcmp0_b32 s57, 28
    s_cbranch_scc1 L_sf_43
    s_waitcnt vmcnt(2)
    s_bitcmp0_b32 s58, 28
    s_cbranch_scc1 L_sf_43
    s_waitcnt vmcnt(1)
L_sf_43:
    buffer_load_dwordx4 v[152:155], v1, s[48:51], s97 offen offset:0 nt
    s_waitcnt vmcnt(3)
    s_bitcmp0_b32 s57, 29
    s_cbranch_scc1 L_sf_44
    s_waitcnt vmcnt(2)
    s_bitcmp0_b32 s58, 29
    s_cbranch_scc1 L_sf_44
    s_waitcnt vmcnt(1)
L_sf_44:
    buffer_load_dwordx4 v[156:159], v1, s[48:51], s97 offen offset:1024 nt
    s_waitcnt vmcnt(3)
    s_bitcmp0_b32 s57, 30
    s_cbranch_scc1 L_sf_45
    s_waitcnt vmcnt(2)
    s_bitcmp0_b32 s58, 30
    s_cbranch_scc1 L_sf_45
    s_waitcnt vmcnt(1)
L_sf_45:
    buffer_load_dwordx4 v[160:163], v1, s[48:51], s97 offen offset:2048 nt
    v_min_u32 v39, 29, v0
    v_lshlrev_b32 v39, 2, v39
    buffer_load_dword v37, v39, s[44:47], 0 offen sc1
    s_waitcnt vmcnt(4)
    s_bitcmp0_b32 s57, 31
    s_cbranch_scc1 L_sf_46
    s_waitcnt vmcnt(3)
    s_bitcmp0_b32 s58, 31
    s_cbranch_scc1 L_sf_46
    s_waitcnt vmcnt(2)
L_sf_46:
    buffer_load_dwordx4 v[164:167], v1, s[48:51], s97 offen offset:3072 nt
    s_mov_b32 s97, 0
    v_add_u32 v1, 4096, v1
    v_and_b32 v1, 0x7fff, v1
    s_waitcnt vmcnt(4)
    s_bitcmp0_b32 s14, 0
    s_cbranch_scc1 L_sf_47
    s_waitcnt vmcnt(3)
    s_bitcmp0_b32 s15, 0
    s_cbranch_scc1 L_sf_47
    s_waitcnt vmcnt(2)
L_sf_47:
    s_add_u32 m0, s12, 0
    s_nop 0
    buffer_load_dwordx4 v1, s[52:55], s97 offen offset:0 nt lds
    s_waitcnt vmcnt(4)
    s_bitcmp0_b32 s14, 1
    s_cbranch_scc1 L_sf_48
    s_waitcnt vmcnt(3)
    s_bitcmp0_b32 s15, 1
    s_cbranch_scc1 L_sf_48
    s_waitcnt vmcnt(1)
L_sf_48:
    buffer_load_dwordx4 v1, s[52:55], s97 offen offset:1024 nt lds
    s_waitcnt vmcnt(4)
    s_bitcmp0_b32 s14, 2
    s_cbranch_scc1 L_sf_49
    s_waitcnt vmcnt(2)
    s_bitcmp0_b32 s15, 2
    s_cbranch_scc1 L_sf_49
    s_waitcnt vmcnt(1)
L_sf_49:
    buffer_load_dwordx4 v1, s[52:55], s97 offen offset:2048 nt lds
    s_waitcnt vmcnt(3)
    s_bitcmp0_b32 s14, 3
    s_cbranch_scc1 L_sf_50
    s_waitcnt vmcnt(2)
    s_bitcmp0_b32 s15, 3
    s_cbranch_scc1 L_sf_50
    s_waitcnt vmcnt(1)
L_sf_50:
    buffer_load_dwordx4 v1, s[52:55], s97 offen offset:3072 nt lds
    s_add_u32 s97, s97, 32768
    v_add_u32 v1, 4096, v1
    v_and_b32 v1, 0x7fff, v1
    v_cmp_eq_u32 vcc, 0, v37
    s_nop 0
    s_or_b32 s96, vcc_lo, vcc_hi
    buffer_load_dwordx4 v[4:7], v2, s[40:43], s98 offen sc1
    s_waitcnt vmcnt(4)
    s_bitcmp0_b32 s14, 4
    s_cbranch_scc1 L_sf_51
    s_waitcnt vmcnt(3)
    s_bitcmp0_b32 s15, 4
    s_cbranch_scc1 L_sf_51
    s_waitcnt vmcnt(2)
L_sf_51:
    s_add_u32 m0, s12, 4096
    s_nop 0
    buffer_load_dwordx4 v1, s[52:55], s97 offen offset:0 nt lds
    s_waitcnt vmcnt(4)
    s_bitcmp0_b32 s14, 5
    s_cbranch_scc1 L_sf_52
    s_waitcnt vmcnt(3)
    s_bitcmp0_b32 s15, 5
    s_cbranch_scc1 L_sf_52
    s_waitcnt vmcnt(2)
L_sf_52:
    buffer_load_dwordx4 v1, s[52:55], s97 offen offset:1024 nt lds
    s_waitcnt vmcnt(4)
    s_bitcmp0_b32 s14, 6
    s_cbranch_scc1 L_sf_53
    s_waitcnt vmcnt(3)
    s_bitcmp0_b32 s15, 6
    s_cbranch_scc1 L_sf_53
    s_waitcnt vmcnt(1)
L_sf_53:
    buffer_load_dwordx4 v1, s[52:55], s97 offen offset:2048 nt lds
    s_waitcnt vmcnt(4)
    s_bitcmp0_b32 s14, 7
    s_cbranch_scc1 L_sf_54
    s_waitcnt vmcnt(2)
    s_bitcmp0_b32 s15, 7
    s_cbranch_scc1 L_sf_54
    s_waitcnt vmcnt(1)
L_sf_54:
    buffer_load_dwordx4 v1, s[52:55], s97 offen offset:3072 nt lds
    s_add_u32 s97, s97, 32768
    v_add_u32 v1, 4096, v1
    v_and_b32 v1, 0x7fff, v1
L_k_join:
    s_waitcnt vmcnt(4)
    v_max3_u32 v38, v4, v5, v6
    v_max_u32 v38, v38, v7
    v_cmp_eq_u32 vcc, -1, v38
    s_cmp_lg_u32 s96, 0
    s_cbranch_scc1 L_qslow
    s_cbranch_vccnz L_qslow2
L_qok:
    v_dot2_f32_bf16 v8, v72, v4, 0
    v_dot2_f32_bf16 v9, v76, v4, 0
    v_dot2_f32_bf16 v10, v80, v4, 0
    v_dot2_f32_bf16 v11, v84, v4, 0
    v_dot2_f32_bf16 v24, v88, v4, 0
    v_dot2_f32_bf16 v25, v92, v4, 0
    v_dot2_f32_bf16 v26, v96, v4, 0
    v_dot2_f32_bf16 v27, v100, v4, 0
    v_dot2_f32_bf16 v8, v73, v5, v8
    v_dot2_f32_bf16 v9, v77, v5, v9
    v_dot2_f32_bf16 v10, v81, v5, v10
    v_dot2_f32_bf16 v11, v85, v5, v11
    v_dot2_f32_bf16 v24, v89, v5, v24
    v_dot2_f32_bf16 v25, v93, v5, v25
    v_dot2_f32_bf16 v26, v97, v5, v26
    v_dot2_f32_bf16 v27, v101, v5, v27
    v_dot2_f32_bf16 v8, v74, v6, v8
    v_dot2_f32_bf16 v9, v78, v6, v9
    v_dot2_f32_bf16 v10, v82, v6, v10
    v_dot2_f32_bf16 v11, v86, v6, v11
    v_dot2_f32_bf16 v24, v90, v6, v24
    v_dot2_f32_bf16 v25, v94, v6, v25
    v_dot2_f32_bf16 v26, v98, v6, v26
    v_dot2_f32_bf16 v27, v102, v6, v27
    v_dot2_f32_bf16 v8, v75, v7, v8
    v_dot2_f32_bf16 v9, v79, v7, v9
    v_dot2_f32_bf16 v10, v83, v7, v10
    v_dot2_f32_bf16 v11, v87, v7, v11
    v_dot2_f32_bf16 v24, v91, v7, v24
    v_dot2_f32_bf16 v25, v95, v7, v25
    v_dot2_f32_bf16 v26, v99, v7, v26
    v_dot2_f32_bf16 v27, v103, v7, v27
    v_add_f32_dpp v8, v8, v8 row_ror:8 row_mask:0xf bank_mask:0x3
    v_add_f32_dpp v10, v10, v10 row_ror:8 row_mask:0xf bank_mask:0x3
    v_add_f32_dpp v24, v24, v24 row_ror:8 row_mask:0xf bank_mask:0x3
    v_add_f32_dpp v26, v26, v26 row_ror:8 row_mask:0xf bank_mask:0x3
    v_add_f32_dpp v8, v9, v9 row_ror:8 row_mask:0xf bank_mask:0xc
    v_add_f32_dpp v10, v11, v11 row_ror:8 row_mask:0xf bank_mask:0xc
    v_add_f32_dpp v24, v25, v25 row_ror:8 row_mask:0xf bank_mask:0xc
    v_add_f32_dpp v26, v27, v27 row_ror:8 row_mask:0xf bank_mask:0xc
    v_add_f32_dpp v14, v8, v8 row_half_mirror row_mask:0xf bank_mask:0x5
    v_add_f32_dpp v15, v24, v24 row_half_mirror row_mask:0xf bank_mask:0x5
    v_add_f32_dpp v14, v10, v10 row_half_mirror row_mask:0xf bank_mask:0xa
    v_add_f32_dpp v15, v26, v26 row_half_mirror row_mask:0xf bank_mask:0xa
    s_nop 0
    v_add_f32_dpp v14, v14, v14 quad_perm:[1,0,3,2] row_mask:0xf bank_mask:0xf
    v_add_f32_dpp v15, v15, v15 quad_perm:[1,0,3,2] row_mask:0xf bank_mask:0xf
    s_nop 0
    v_add_f32_dpp v14, v14, v14 quad_perm:[2,3,0,1] row_mask:0xf bank_mask:0xf
    v_add_f32_dpp v15, v15, v15 quad_perm:[2,3,0,1] row_mask:0xf bank_mask:0xf
    s_waitcnt vmcnt(3)
    s_bitcmp0_b32 s14, 8
    s_cbranch_scc1 L_sf_65
    s_waitcnt vmcnt(2)
    s_bitcmp0_b32 s15, 8
    s_cbranch_scc1 L_sf_65
    s_waitcnt vmcnt(1)
L_sf_65:
    buffer_load_dwordx4 v[72:75], v1, s[52:55], s97 offen offset:0 nt
    v_dot2_f32_bf16 v8, v40, v4, 0
    v_dot2_f32_bf16 v9, v44, v4, 0
    v_dot2_f32_bf16 v10, v48, v4, 0
    v_dot2_f32_bf16 v11, v52, v4, 0
    v_dot2_f32_bf16 v24, v56, v4, 0
    v_dot2_f32_bf16 v25, v60, v4, 0
    v_dot2_f32_bf16 v26, v64, v4, 0
    v_dot2_f32_bf16 v27, v68, v4, 0
    v_dot2_f32_bf16 v28, v104, v4, 0
    v_dot2_f32_bf16 v29, v108, v4, 0
    v_dot2_f32_bf16 v30, v112, v4, 0
    v_dot2_f32_bf16 v31, v116, v4, 0
    v_dot2_f32_bf16 v8, v41, v5, v8
    v_dot2_f32_bf16 v9, v45, v5, v9
    v_dot2_f32_bf16 v10, v49, v5, v10
    v_dot2_f32_bf16 v11, v53, v5, v11
    v_dot2_f32_bf16 v24, v57, v5, v24
    v_dot2_f32_bf16 v25, v61, v5, v25
    v_dot2_f32_bf16 v26, v65, v5, v26
    v_dot2_f32_bf16 v27, v69, v5, v27
    v_dot2_f32_bf16 v28, v105, v5, v28
    v_dot2_f32_bf16 v29, v109, v5, v29
    v_dot2_f32_bf16 v30, v113, v5, v30
    v_dot2_f32_bf16 v31, v117, v5, v31
    v_dot2_f32_bf16 v8, v42, v6, v8
    v_dot2_f32_bf16 v9, v46, v6, v9
    v_dot2_f32_bf16 v10, v50, v6, v10
    v_dot2_f32_bf16 v11, v54, v6, v11
    v_dot2_f32_bf16 v24, v58, v6, v24
    v_dot2_f32_bf16 v25, v62, v6, v25
    v_dot2_f32_bf16 v26, v66, v6, v26
    v_dot2_f32_bf16 v27, v70, v6, v27
    v_dot2_f32_bf16 v28, v106, v6, v28
    v_dot2_f32_bf16 v29, v110, v6, v29
    v_dot2_f32_bf16 v30, v114, v6, v30
    v_dot2_f32_bf16 v31, v118, v6, v31
    v_dot2_f32_bf16 v8, v43, v7, v8
    v_dot2_f32_bf16 v9, v47, v7, v9
    v_dot2_f32_bf16 v10, v51, v7, v10
    v_dot2_f32_bf16 v11, v55, v7, v11
    v_dot2_f32_bf16 v24, v59, v7, v24
    v_dot2_f32_bf16 v25, v63, v7, v25
    v_dot2_f32_bf16 v26, v67, v7, v26
    v_dot2_f32_bf16 v27, v71, v7, v27
    v_dot2_f32_bf16 v28, v107, v7, v28
    v_dot2_f32_bf16 v29, v111, v7, v29
    v_dot2_f32_bf16 v30, v115, v7, v30
    v_dot2_f32_bf16 v31, v119, v7, v31
    v_add_f32_dpp v8, v8, v8 row_ror:8 row_mask:0xf bank_mask:0x3
    v_add_f32_dpp v10, v10, v10 row_ror:8 row_mask:0xf bank_mask:0x3
    v_add_f32_dpp v24, v24, v24 row_ror:8 row_mask:0xf bank_mask:0x3
    v_add_f32_dpp v26, v26, v26 row_ror:8 row_mask:0xf bank_mask:0x3
    v_add_f32_dpp v28, v28, v28 row_ror:8 row_mask:0xf bank_mask:0x3
    v_add_f32_dpp v30, v30, v30 row_ror:8 row_mask:0xf bank_mask:0x3
    v_add_f32_dpp v8, v9, v9 row_ror:8 row_mask:0xf bank_mask:0xc
    v_add_f32_dpp v10, v11, v11 row_ror:8 row_mask:0xf bank_mask:0xc
    v_add_f32_dpp v24, v25, v25 row_ror:8 row_mask:0xf bank_mask:0xc
    v_add_f32_dpp v26, v27, v27 row_ror:8 row_mask:0xf bank_mask:0xc
    v_add_f32_dpp v28, v29, v29 row_ror:8 row_mask:0xf bank_mask:0xc
    v_add_f32_dpp v30, v31, v31 row_ror:8 row_mask:0xf bank_mask:0xc
    v_add_f32_dpp v12, v8, v8 row_half_mirror row_mask:0xf bank_mask:0x5
    v_add_f32_dpp v13, v24, v24 row_half_mirror row_mask:0xf bank_mask:0x5
    v_add_f32_dpp v16, v28, v28 row_half_mirror row_mask:0xf bank_mask:0x5
    v_add_f32_dpp v12, v10, v10 row_half_mirror row_mask:0xf bank_mask:0xa
    v_add_f32_dpp v13, v26, v26 row_half_mirror row_mask:0xf bank_mask:0xa
    v_add_f32_dpp v16, v30, v30 row_half_mirror row_mask:0xf bank_mask:0xa
    v_add_f32_dpp v12, v12, v12 quad_perm:[1,0,3,2] row_mask:0xf bank_mask:0xf
    v_add_f32_dpp v13, v13, v13 quad_perm:[1,0,3,2] row_mask:0xf bank_mask:0xf
    v_add_f32_dpp v16, v16, v16 quad_perm:[1,0,3,2] row_mask:0xf bank_mask:0xf
    v_add_f32_dpp v12, v12, v12 quad_perm:[2,3,0,1] row_mask:0xf bank_mask:0xf
    v_add_f32_dpp v13, v13, v13 quad_perm:[2,3,0,1] row_mask:0xf bank_mask:0xf
    v_add_f32_dpp v16, v16, v16 quad_perm:[2,3,0,1] row_mask:0xf bank_mask:0xf
    s_waitcnt vmcnt(3)
    s_bitcmp0_b32 s14, 9
    s_cbranch_scc1 L_sf_66
    s_waitcnt vmcnt(2)
    s_bitcmp0_b32 s15, 9
    s_cbranch_scc1 L_sf_66
    s_waitcnt vmcnt(1)
L_sf_66:
    buffer_load_dwordx4 v[76:79], v1, s[52:55], s97 offen offset:1024 nt
    v_dot2_f32_bf16 v8, v120, v4, 0
    v_dot2_f32_bf16 v9, v124, v4, 0
    v_dot2_f32_bf16 v10, v128, v4, 0
    v_dot2_f32_bf16 v11, v132, v4, 0
    v_dot2_f32_bf16 v24, v136, v4, 0
    v_dot2_f32_bf16 v25, v140, v4, 0
    v_dot2_f32_bf16 v26, v144, v4, 0
    v_dot2_f32_bf16 v27, v148, v4, 0
    v_dot2_f32_bf16 v8, v121, v5, v8
    v_dot2_f32_bf16 v9, v125, v5, v9
    v_dot2_f32_bf16 v10, v129, v5, v10
    v_dot2_f32_bf16 v11, v133, v5, v11
    v_dot2_f32_bf16 v24, v137, v5, v24
    v_dot2_f32_bf16 v25, v141, v5, v25
    v_dot2_f32_bf16 v26, v145, v5, v26
    v_dot2_f32_bf16 v27, v149, v5, v27
    v_dot2_f32_bf16 v8, v122, v6, v8
    v_dot2_f32_bf16 v9, v126, v6, v9
    v_dot2_f32_bf16 v10, v130, v6, v10
    v_dot2_f32_bf16 v11, v134, v6, v11
    v_dot2_f32_bf16 v24, v138, v6, v24
    v_dot2_f32_bf16 v25, v142, v6, v25
    v_dot2_f32_bf16 v26, v146, v6, v26
    v_dot2_f32_bf16 v27, v150, v6, v27
    v_dot2_f32_bf16 v8, v123, v7, v8
    v_dot2_f32_bf16 v9, v127, v7, v9
    v_dot2_f32_bf16 v10, v131, v7, v10
    v_dot2_f32_bf16 v11, v135, v7, v11
    v_dot2_f32_bf16 v24, v139, v7, v24
    v_dot2_f32_bf16 v25, v143, v7, v25
    v_dot2_f32_bf16 v26, v147, v7, v26
    v_dot2_f32_bf16 v27, v151, v7, v27
    v_add_f32_dpp v8, v8, v8 row_ror:8 row_mask:0xf bank_mask:0x3
    v_add_f32_dpp v10, v10, v10 row_ror:8 row_mask:0xf bank_mask:0x3
    v_add_f32_dpp v24, v24, v24 row_ror:8 row_mask:0xf bank_mask:0x3
    v_add_f32_dpp v26, v26, v26 row_ror:8 row_mask:0xf bank_mask:0x3
    v_add_f32_dpp v8, v9, v9 row_ror:8 row_mask:0xf bank_mask:0xc
    v_add_f32_dpp v10, v11, v11 row_ror:8 row_mask:0xf bank_mask:0xc
    v_add_f32_dpp v24, v25, v25 row_ror:8 row_mask:0xf bank_mask:0xc
    v_add_f32_dpp v26, v27, v27 row_ror:8 row_mask:0xf bank_mask:0xc
    v_add_f32_dpp v17, v8, v8 row_half_mirror row_mask:0xf bank_mask:0x5
    v_add_f32_dpp v18, v24, v24 row_half_mirror row_mask:0xf bank_mask:0x5
    v_add_f32_dpp v17, v10, v10 row_half_mirror row_mask:0xf bank_mask:0xa
    v_add_f32_dpp v18, v26, v26 row_half_mirror row_mask:0xf bank_mask:0xa
    s_nop 0
    v_add_f32_dpp v17, v17, v17 quad_perm:[1,0,3,2] row_mask:0xf bank_mask:0xf
    v_add_f32_dpp v18, v18, v18 quad_perm:[1,0,3,2] row_mask:0xf bank_mask:0xf
    s_nop 0
    v_add_f32_dpp v17, v17, v17 quad_perm:[2,3,0,1] row_mask:0xf bank_mask:0xf
    v_add_f32_dpp v18, v18, v18 quad_perm:[2,3,0,1] row_mask:0xf bank_mask:0xf
    s_waitcnt vmcnt(3)
    s_bitcmp0_b32 s14, 10
    s_cbranch_scc1 L_sf_67
    s_waitcnt vmcnt(2)
    s_bitcmp0_b32 s15, 10
    s_cbranch_scc1 L_sf_67
    s_waitcnt vmcnt(1)
L_sf_67:
    buffer_load_dwordx4 v[80:83], v1, s[52:55], s97 offen offset:2048 nt
    s_waitcnt vmcnt(3)
    s_bitcmp0_b32 s14, 11
    s_cbranch_scc1 L_sf_68
    s_waitcnt vmcnt(2)
    s_bitcmp0_b32 s15, 11
    s_cbranch_scc1 L_sf_68
    s_waitcnt vmcnt(1)
L_sf_68:
    buffer_load_dwordx4 v[84:87], v1, s[52:55], s97 offen offset:3072 nt
    s_add_u32 s97, s97, 32768
    v_add_u32 v1, 4096, v1
    v_and_b32 v1, 0x7fff, v1
    s_cmp_eq_u32 s12, -1
    s_cbranch_scc1 L_nopfrd
    v_lshl_add_u32 v38, v0, 4, s12
    ds_read_b128 v[40:43], v38 offset:0
    ds_read_b128 v[44:47], v38 offset:1024
    ds_read_b128 v[48:51], v38 offset:2048
    ds_read_b128 v[52:55], v38 offset:3072
    ds_read_b128 v[56:59], v38 offset:4096
    ds_read_b128 v[60:63], v38 offset:5120
    ds_read_b128 v[64:67], v38 offset:6144
    ds_read_b128 v[68:71], v38 offset:7168
L_nopfrd:
    v_dot2_f32_bf16 v8, v152, v4, 0
    v_dot2_f32_bf16 v9, v156, v4, 0
    v_dot2_f32_bf16 v10, v160, v4, 0
    v_dot2_f32_bf16 v11, v164, v4, 0
    v_dot2_f32_bf16 v8, v153, v5, v8
    v_dot2_f32_bf16 v9, v157, v5, v9
    v_dot2_f32_bf16 v10, v161, v5, v10
    v_dot2_f32_bf16 v11, v165, v5, v11
    v_dot2_f32_bf16 v8, v154, v6, v8
    v_dot2_f32_bf16 v9, v158, v6, v9
    v_dot2_f32_bf16 v10, v162, v6, v10
    v_dot2_f32_bf16 v11, v166, v6, v11
    v_dot2_f32_bf16 v8, v155, v7, v8
    v_dot2_f32_bf16 v9, v159, v7, v9
    v_dot2_f32_bf16 v10, v163, v7, v10
    v_dot2_f32_bf16 v11, v167, v7, v11
    v_add_f32_dpp v8, v8, v8 row_ror:8 row_mask:0xf bank_mask:0x3
    s_nop 0
    v_add_f32_dpp v10, v10, v10 row_ror:8 row_mask:0xf bank_mask:0x3
    v_add_f32_dpp v8, v9, v9 row_ror:8 row_mask:0xf bank_mask:0xc
    v_add_f32_dpp v10, v11, v11 row_ror:8 row_mask:0xf bank_mask:0xc
    s_nop 0
    v_add_f32_dpp v19, v8, v8 row_half_mirror row_mask:0xf bank_mask:0x5
    v_add_f32_dpp v19, v10, v10 row_half_mirror row_mask:0xf bank_mask:0xa
    s_nop 1
    v_add_f32_dpp v19, v19, v19 quad_perm:[1,0,3,2] row_mask:0xf bank_mask:0xf
    s_nop 1
    v_add_f32_dpp v19, v19, v19 quad_perm:[2,3,0,1] row_mask:0xf bank_mask:0xf
    v_max3_f32 v3, v12, v13, v14
    v_max3_f32 v8, v15, v16, v17
    v_max3_f32 v3, v3, v18, v19
    v_max_f32 v3, v3, v8
    s_nop 1
    v_max_f32_dpp v3, v3, v3 row_ror:4 row_mask:0xf bank_mask:0xf
    s_nop 1
    v_max_f32_dpp v3, v3, v3 row_ror:8 row_mask:0xf bank_mask:0xf
    v_mov_b32 v8, v3
    s_nop 1
    v_permlane16_swap_b32 v3, v8
    v_max_f32 v3, v3, v8
    v_mov_b32 v8, v3
    s_nop 1
    v_permlane32_swap_b32 v3, v8
    v_max_f32 v3, v3, v8
    s_mov_b32 s96, 0x3e0293ee
    v_mul_f32 v8, s96, v3
    v_fma_f32 v12, v12, s96, -v8
    v_fma_f32 v13, v13, s96, -v8
    v_fma_f32 v14, v14, s96, -v8
    v_fma_f32 v15, v15, s96, -v8
    v_fma_f32 v16, v16, s96, -v8
    v_fma_f32 v17, v17, s96, -v8
    v_fma_f32 v18, v18, s96, -v8
    v_fma_f32 v19, v19, s96, -v8
    v_exp_f32 v12, v12
    v_exp_f32 v13, v13
    v_exp_f32 v14, v14
    v_exp_f32 v15, v15
    v_exp_f32 v16, v16
    v_exp_f32 v17, v17
    v_exp_f32 v18, v18
    v_exp_f32 v19, v19
    v_add_f32 v9, v12, v13
    v_add_f32 v10, v14, v15
    v_add_f32 v11, v16, v17
    v_add_f32 v3, v18, v19
    v_add_f32 v9, v9, v10
    v_add_f32 v3, v3, v11
    v_add_f32 v9, v9, v3
    v_cvt_pk_bf16_f32 v12, v12, v12
    v_cvt_pk_bf16_f32 v13, v13, v13
    v_cvt_pk_bf16_f32 v14, v14, v14
    v_cvt_pk_bf16_f32 v15, v15, v15
    v_cvt_pk_bf16_f32 v16, v16, v16
    v_cvt_pk_bf16_f32 v17, v17, v17
    v_cvt_pk_bf16_f32 v18, v18, v18
    v_cvt_pk_bf16_f32 v19, v19, v19
    v_add_f32_dpp v9, v9, v9 row_ror:4 row_mask:0xf bank_mask:0xf
    s_nop 1
    v_add_f32_dpp v9, v9, v9 row_ror:8 row_mask:0xf bank_mask:0xf
    v_mov_b32 v10, v9
    s_nop 1
    v_permlane16_swap_b32 v9, v10
    v_add_f32 v9, v9, v10
    v_mov_b32 v10, v9
    s_nop 1
    v_permlane32_swap_b32 v9, v10
    v_add_f32 v9, v9, v10
    s_mov_b64 exec, 1
    s_cmp_lg_u32 s13, 0
    s_cbranch_scc1 L_mljob
    s_lshl_b32 s96, s3, 3
    s_add_u32 s96, s96, 161920
    v_mov_b32 v10, s96
    v_mov_b32 v11, 162068
    v_mov_b32 v3, 1
    ds_write_b64 v10, v[8:9]
    ds_add_u32 v11, v3
L_mldone:
    s_mov_b64 exec, -1
    v_lshrrev_b32 v2, 1, v2
    v_and_b32_dpp v24, v14, v20 row_newbcast:0 row_mask:0xf bank_mask:0xf
    v_and_b32_dpp v25, v14, v21 row_newbcast:0 row_mask:0xf bank_mask:0xf
    v_and_b32_dpp v26, v14, v22 row_newbcast:0 row_mask:0xf bank_mask:0xf
    v_and_b32_dpp v27, v14, v23 row_newbcast:0 row_mask:0xf bank_mask:0xf
    s_waitcnt vmcnt(3)
    s_bitcmp0_b32 s14, 12
    s_cbranch_scc1 L_sf_69
    s_waitcnt vmcnt(2)
    s_bitcmp0_b32 s15, 12
    s_cbranch_scc1 L_sf_69
    s_waitcnt vmcnt(1)
L_sf_69:
    buffer_load_dwordx4 v[88:91], v1, s[52:55], s97 offen offset:0 nt
    v_mfma_f32_16x16x32_bf16 v[32:35], v[24:27], v[72:75], v[32:35]
    s_cmp_eq_u32 s12, -1
    s_cbranch_scc1 L_nopfpv8
    s_waitcnt lgkmcnt(0)
    v_and_b32_dpp v24, v12, v20 row_newbcast:0 row_mask:0xf bank_mask:0xf
    v_and_b32_dpp v25, v12, v21 row_newbcast:0 row_mask:0xf bank_mask:0xf
    v_and_b32_dpp v26, v12, v22 row_newbcast:0 row_mask:0xf bank_mask:0xf
    v_and_b32_dpp v27, v12, v23 row_newbcast:0 row_mask:0xf bank_mask:0xf
    s_nop 1
    v_mfma_f32_16x16x32_bf16 v[32:35], v[24:27], v[40:43], v[32:35]
    v_and_b32_dpp v28, v12, v20 row_newbcast:8 row_mask:0xf bank_mask:0xf
    v_and_b32_dpp v29, v12, v21 row_newbcast:8 row_mask:0xf bank_mask:0xf
    v_and_b32_dpp v30, v12, v22 row_newbcast:8 row_mask:0xf bank_mask:0xf
    v_and_b32_dpp v31, v12, v23 row_newbcast:8 row_mask:0xf bank_mask:0xf
    s_nop 1
    v_mfma_f32_16x16x32_bf16 v[32:35], v[28:31], v[44:47], v[32:35]
    v_and_b32_dpp v24, v12, v20 row_newbcast:4 row_mask:0xf bank_mask:0xf
    v_and_b32_dpp v25, v12, v21 row_newbcast:4 row_mask:0xf bank_mask:0xf
    v_and_b32_dpp v26, v12, v22 row_newbcast:4 row_mask:0xf bank_mask:0xf
    v_and_b32_dpp v27, v12, v23 row_newbcast:4 row_mask:0xf bank_mask:0xf
    s_nop 1
    v_mfma_f32_16x16x32_bf16 v[32:35], v[24:27], v[48:51], v[32:35]
    v_and_b32_dpp v28, v12, v20 row_newbcast:12 row_mask:0xf bank_mask:0xf
    v_and_b32_dpp v29, v12, v21 row_newbcast:12 row_mask:0xf bank_mask:0xf
    v_and_b32_dpp v30, v12, v22 row_newbcast:12 row_mask:0xf bank_mask:0xf
    v_and_b32_dpp v31, v12, v23 row_newbcast:12 row_mask:0xf bank_mask:0xf
    s_nop 1
    v_mfma_f32_16x16x32_bf16 v[32:35], v[28:31], v[52:55], v[32:35]
L_nopfpv8:
    v_and_b32_dpp v28, v14, v20 row_newbcast:8 row_mask:0xf bank_mask:0xf
    v_and_b32_dpp v29, v14, v21 row_newbcast:8 row_mask:0xf bank_mask:0xf
    v_and_b32_dpp v30, v14, v22 row_newbcast:8 row_mask:0xf bank_mask:0xf
    v_and_b32_dpp v31, v14, v23 row_newbcast:8 row_mask:0xf bank_mask:0xf
    s_waitcnt vmcnt(3)
    s_bitcmp0_b32 s14, 13
    s_cbranch_scc1 L_sf_70
    s_waitcnt vmcnt(2)
    s_bitcmp0_b32 s15, 13
    s_cbranch_scc1 L_sf_70
    s_waitcnt vmcnt(1)
L_sf_70:
    buffer_load_dwordx4 v[92:95], v1, s[52:55], s97 offen offset:1024 nt
    v_mfma_f32_16x16x32_bf16 v[32:35], v[28:31], v[76:79], v[32:35]
    s_cmp_eq_u32 s12, -1
    s_cbranch_scc1 L_nopfpv9
    s_waitcnt lgkmcnt(0)
    v_and_b32_dpp v24, v13, v20 row_newbcast:0 row_mask:0xf bank_mask:0xf
    v_and_b32_dpp v25, v13, v21 row_newbcast:0 row_mask:0xf bank_mask:0xf
    v_and_b32_dpp v26, v13, v22 row_newbcast:0 row_mask:0xf bank_mask:0xf
    v_and_b32_dpp v27, v13, v23 row_newbcast:0 row_mask:0xf bank_mask:0xf
    s_nop 1
    v_mfma_f32_16x16x32_bf16 v[32:35], v[24:27], v[56:59], v[32:35]
    v_and_b32_dpp v28, v13, v20 row_newbcast:8 row_mask:0xf bank_mask:0xf
    v_and_b32_dpp v29, v13, v21 row_newbcast:8 row_mask:0xf bank_mask:0xf
    v_and_b32_dpp v30, v13, v22 row_newbcast:8 row_mask:0xf bank_mask:0xf
    v_and_b32_dpp v31, v13, v23 row_newbcast:8 row_mask:0xf bank_mask:0xf
    s_nop 1
    v_mfma_f32_16x16x32_bf16 v[32:35], v[28:31], v[60:63], v[32:35]
    v_and_b32_dpp v24, v13, v20 row_newbcast:4 row_mask:0xf bank_mask:0xf
    v_and_b32_dpp v25, v13, v21 row_newbcast:4 row_mask:0xf bank_mask:0xf
    v_and_b32_dpp v26, v13, v22 row_newbcast:4 row_mask:0xf bank_mask:0xf
    v_and_b32_dpp v27, v13, v23 row_newbcast:4 row_mask:0xf bank_mask:0xf
    s_nop 1
    v_mfma_f32_16x16x32_bf16 v[32:35], v[24:27], v[64:67], v[32:35]
    v_and_b32_dpp v28, v13, v20 row_newbcast:12 row_mask:0xf bank_mask:0xf
    v_and_b32_dpp v29, v13, v21 row_newbcast:12 row_mask:0xf bank_mask:0xf
    v_and_b32_dpp v30, v13, v22 row_newbcast:12 row_mask:0xf bank_mask:0xf
    v_and_b32_dpp v31, v13, v23 row_newbcast:12 row_mask:0xf bank_mask:0xf
    s_nop 1
    v_mfma_f32_16x16x32_bf16 v[32:35], v[28:31], v[68:71], v[32:35]
L_nopfpv9:
    v_and_b32_dpp v24, v14, v20 row_newbcast:4 row_mask:0xf bank_mask:0xf
    v_and_b32_dpp v25, v14, v21 row_newbcast:4 row_mask:0xf bank_mask:0xf
    v_and_b32_dpp v26, v14, v22 row_newbcast:4 row_mask:0xf bank_mask:0xf
    v_and_b32_dpp v27, v14, v23 row_newbcast:4 row_mask:0xf bank_mask:0xf
    s_waitcnt vmcnt(3)
    s_bitcmp0_b32 s14, 14
    s_cbranch_scc1 L_sf_71
    s_waitcnt vmcnt(2)
    s_bitcmp0_b32 s15, 14
    s_cbranch_scc1 L_sf_71
    s_waitcnt vmcnt(1)
L_sf_71:
    buffer_load_dwordx4 v[96:99], v1, s[52:55], s97 offen offset:2048 nt
    v_mfma_f32_16x16x32_bf16 v[32:35], v[24:27], v[80:83], v[32:35]
    v_and_b32_dpp v28, v14, v20 row_newbcast:12 row_mask:0xf bank_mask:0xf
    v_and_b32_dpp v29, v14, v21 row_newbcast:12 row_mask:0xf bank_mask:0xf
    v_and_b32_dpp v30, v14, v22 row_newbcast:12 row_mask:0xf bank_mask:0xf
    v_and_b32_dpp v31, v14, v23 row_newbcast:12 row_mask:0xf bank_mask:0xf
    s_waitcnt vmcnt(3)
    s_bitcmp0_b32 s14, 15
    s_cbranch_scc1 L_sf_72
    s_waitcnt vmcnt(2)
    s_bitcmp0_b32 s15, 15
    s_cbranch_scc1 L_sf_72
    s_waitcnt vmcnt(1)
L_sf_72:
    buffer_load_dwordx4 v[100:103], v1, s[52:55], s97 offen offset:3072 nt
    s_add_u32 s97, s97, 32768
    v_add_u32 v1, 4096, v1
    v_and_b32 v1, 0x7fff, v1
    v_mfma_f32_16x16x32_bf16 v[32:35], v[28:31], v[84:87], v[32:35]
    v_and_b32_dpp v24, v15, v20 row_newbcast:0 row_mask:0xf bank_mask:0xf
    v_and_b32_dpp v25, v15, v21 row_newbcast:0 row_mask:0xf bank_mask:0xf
    v_and_b32_dpp v26, v15, v22 row_newbcast:0 row_mask:0xf bank_mask:0xf
    v_and_b32_dpp v27, v15, v23 row_newbcast:0 row_mask:0xf bank_mask:0xf
    s_waitcnt vmcnt(3)
    s_bitcmp0_b32 s14, 16
    s_cbranch_scc1 L_sf_73
    s_waitcnt vmcnt(2)
    s_bitcmp0_b32 s15, 16
    s_cbranch_scc1 L_sf_73
    s_waitcnt vmcnt(1)
L_sf_73:
    buffer_load_dwordx4 v[104:107], v1, s[52:55], s97 offen offset:0 nt
    v_mfma_f32_16x16x32_bf16 v[32:35], v[24:27], v[88:91], v[32:35]
    v_and_b32_dpp v28, v15, v20 row_newbcast:8 row_mask:0xf bank_mask:0xf
    v_and_b32_dpp v29, v15, v21 row_newbcast:8 row_mask:0xf bank_mask:0xf
    v_and_b32_dpp v30, v15, v22 row_newbcast:8 row_mask:0xf bank_mask:0xf
    v_and_b32_dpp v31, v15, v23 row_newbcast:8 row_mask:0xf bank_mask:0xf
    s_waitcnt vmcnt(3)
    s_bitcmp0_b32 s14, 17
    s_cbranch_scc1 L_sf_74
    s_waitcnt vmcnt(2)
    s_bitcmp0_b32 s15, 17
    s_cbranch_scc1 L_sf_74
    s_waitcnt vmcnt(1)
L_sf_74:
    buffer_load_dwordx4 v[108:111], v1, s[52:55], s97 offen offset:1024 nt
    v_mfma_f32_16x16x32_bf16 v[32:35], v[28:31], v[92:95], v[32:35]
    v_and_b32_dpp v24, v15, v20 row_newbcast:4 row_mask:0xf bank_mask:0xf
    v_and_b32_dpp v25, v15, v21 row_newbcast:4 row_mask:0xf bank_mask:0xf
    v_and_b32_dpp v26, v15, v22 row_newbcast:4 row_mask:0xf bank_mask:0xf
    v_and_b32_dpp v27, v15, v23 row_newbcast:4 row_mask:0xf bank_mask:0xf
    s_waitcnt vmcnt(3)
    s_bitcmp0_b32 s14, 18
    s_cbranch_scc1 L_sf_75
    s_waitcnt vmcnt(2)
    s_bitcmp0_b32 s15, 18
    s_cbranch_scc1 L_sf_75
    s_waitcnt vmcnt(1)
L_sf_75:
    buffer_load_dwordx4 v[112:115], v1, s[52:55], s97 offen offset:2048 nt
    v_mfma_f32_16x16x32_bf16 v[32:35], v[24:27], v[96:99], v[32:35]
    v_and_b32_dpp v28, v15, v20 row_newbcast:12 row_mask:0xf bank_mask:0xf
    v_and_b32_dpp v29, v15, v21 row_newbcast:12 row_mask:0xf bank_mask:0xf
    v_and_b32_dpp v30, v15, v22 row_newbcast:12 row_mask:0xf bank_mask:0xf
    v_and_b32_dpp v31, v15, v23 row_newbcast:12 row_mask:0xf bank_mask:0xf
    s_waitcnt vmcnt(3)
    s_bitcmp0_b32 s14, 19
    s_cbranch_scc1 L_sf_76
    s_waitcnt vmcnt(2)
    s_bitcmp0_b32 s15, 19
    s_cbranch_scc1 L_sf_76
    s_waitcnt vmcnt(1)
L_sf_76:
    buffer_load_dwordx4 v[116:119], v1, s[52:55], s97 offen offset:3072 nt
    s_add_u32 s97, s97, 32768
    v_add_u32 v1, 4096, v1
    v_and_b32 v1, 0x7fff, v1
    v_mfma_f32_16x16x32_bf16 v[32:35], v[28:31], v[100:103], v[32:35]
    v_and_b32_dpp v24, v16, v20 row_newbcast:0 row_mask:0xf bank_mask:0xf
    v_and_b32_dpp v25, v16, v21 row_newbcast:0 row_mask:0xf bank_mask:0xf
    v_and_b32_dpp v26, v16, v22 row_newbcast:0 row_mask:0xf bank_mask:0xf
    v_and_b32_dpp v27, v16, v23 row_newbcast:0 row_mask:0xf bank_mask:0xf
    s_waitcnt vmcnt(3)
    s_bitcmp0_b32 s14, 20
    s_cbranch_scc1 L_sf_77
    s_waitcnt vmcnt(2)
    s_bitcmp0_b32 s15, 20
    s_cbranch_scc1 L_sf_77
    s_waitcnt vmcnt(1)
L_sf_77:
    buffer_load_dwordx4 v[120:123], v1, s[52:55], s97 offen offset:0 nt
    v_mfma_f32_16x16x32_bf16 v[32:35], v[24:27], v[104:107], v[32:35]
    v_and_b32_dpp v28, v16, v20 row_newbcast:8 row_mask:0xf bank_mask:0xf
    v_and_b32_dpp v29, v16, v21 row_newbcast:8 row_mask:0xf bank_mask:0xf
    v_and_b32_dpp v30, v16, v22 row_newbcast:8 row_mask:0xf bank_mask:0xf
    v_and_b32_dpp v31, v16, v23 row_newbcast:8 row_mask:0xf bank_mask:0xf
    s_waitcnt vmcnt(3)
    s_bitcmp0_b32 s14, 21
    s_cbranch_scc1 L_sf_78
    s_waitcnt vmcnt(2)
    s_bitcmp0_b32 s15, 21
    s_cbranch_scc1 L_sf_78
    s_waitcnt vmcnt(1)
L_sf_78:
    buffer_load_dwordx4 v[124:127], v1, s[52:55], s97 offen offset:1024 nt
    v_mfma_f32_16x16x32_bf16 v[32:35], v[28:31], v[108:111], v[32:35]
    v_and_b32_dpp v24, v16, v20 row_newbcast:4 row_mask:0xf bank_mask:0xf
    v_and_b32_dpp v25, v16, v21 row_newbcast:4 row_mask:0xf bank_mask:0xf
    v_and_b32_dpp v26, v16, v22 row_newbcast:4 row_mask:0xf bank_mask:0xf
    v_and_b32_dpp v27, v16, v23 row_newbcast:4 row_mask:0xf bank_mask:0xf
    s_waitcnt vmcnt(3)
    s_bitcmp0_b32 s14, 22
    s_cbranch_scc1 L_sf_79
    s_waitcnt vmcnt(2)
    s_bitcmp0_b32 s15, 22
    s_cbranch_scc1 L_sf_79
    s_waitcnt vmcnt(1)
L_sf_79:
    buffer_load_dwordx4 v[128:131], v1, s[52:55], s97 offen offset:2048 nt
    v_mfma_f32_16x16x32_bf16 v[32:35], v[24:27], v[112:115], v[32:35]
    v_and_b32_dpp v28, v16, v20 row_newbcast:12 row_mask:0xf bank_mask:0xf
    v_and_b32_dpp v29, v16, v21 row_newbcast:12 row_mask:0xf bank_mask:0xf
    v_and_b32_dpp v30, v16, v22 row_newbcast:12 row_mask:0xf bank_mask:0xf
    v_and_b32_dpp v31, v16, v23 row_newbcast:12 row_mask:0xf bank_mask:0xf
    s_waitcnt vmcnt(3)
    s_bitcmp0_b32 s14, 23
    s_cbranch_scc1 L_sf_80
    s_waitcnt vmcnt(2)
    s_bitcmp0_b32 s15, 23
    s_cbranch_scc1 L_sf_80
    s_waitcnt vmcnt(1)
L_sf_80:
    buffer_load_dwordx4 v[132:135], v1, s[52:55], s97 offen offset:3072 nt
    s_add_u32 s97, s97, 32768
    v_add_u32 v1, 4096, v1
    v_and_b32 v1, 0x7fff, v1
    v_mfma_f32_16x16x32_bf16 v[32:35], v[28:31], v[116:119], v[32:35]
    v_and_b32_dpp v24, v17, v20 row_newbcast:0 row_mask:0xf bank_mask:0xf
    v_and_b32_dpp v25, v17, v21 row_newbcast:0 row_mask:0xf bank_mask:0xf
    v_and_b32_dpp v26, v17, v22 row_newbcast:0 row_mask:0xf bank_mask:0xf
    v_and_b32_dpp v27, v17, v23 row_newbcast:0 row_mask:0xf bank_mask:0xf
    s_waitcnt vmcnt(3)
    s_bitcmp0_b32 s14, 24
    s_cbranch_scc1 L_sf_81
    s_waitcnt vmcnt(2)
    s_bitcmp0_b32 s15, 24
    s_cbranch_scc1 L_sf_81
    s_waitcnt vmcnt(1)
L_sf_81:
    buffer_load_dwordx4 v[136:139], v1, s[52:55], s97 offen offset:0 nt
    v_mfma_f32_16x16x32_bf16 v[32:35], v[24:27], v[120:123], v[32:35]
    s_or_b32 s96, s59, s39
    s_cbranch_scc0 L_nofrag_82
    v_mov_b32 v104, 162060
L_lw_83:
    ds_read_b32 v105, v104
    s_waitcnt lgkmcnt(0)
    v_cmp_gt_u32 vcc, 4, v105
    s_cbranch_vccz L_lw_83e
    s_sleep 2
    s_sub_u32 s60, s60, 1
    s_cbranch_scc0 L_lw_83
    s_mov_b32 s60, 0
L_lw_83e:
    s_cmp_eq_u32 s59, 0
    s_cbranch_scc1 L_nofrag_82
    v_lshrrev_b32 v109, 4, v0
    v_bfe_u32 v104, v0, 1, 1
    v_lshl_add_u32 v104, v109, 1, v104
    v_bfe_u32 v110, v0, 2, 2
    v_lshl_add_u32 v104, v104, 3, v110
    v_lshlrev_b32 v104, 7, v104
    v_and_b32 v110, 1, v0
    v_lshl_add_u32 v104, v110, 3, v104
    s_lshr_b32 s63, s3, 1
    s_and_b32 s62, s3, 1
    s_lshl_b32 s96, s63, 14
    s_lshl_b32 s100, s62, 6
    s_add_u32 s100, s100, 81920
    s_add_u32 s96, s96, s100
    v_add_u32 v104, s96, v104
    ds_read_b64_tr_b16 v[72:73], v104 offset:0
    ds_read_b64_tr_b16 v[74:75], v104 offset:512
    ds_read_b64_tr_b16 v[76:77], v104 offset:16
    ds_read_b64_tr_b16 v[78:79], v104 offset:528
    ds_read_b64_tr_b16 v[80:81], v104 offset:32
    ds_read_b64_tr_b16 v[82:83], v104 offset:544
    ds_read_b64_tr_b16 v[84:85], v104 offset:48
    ds_read_b64_tr_b16 v[86:87], v104 offset:560
    ds_read_b64_tr_b16 v[88:89], v104 offset:8192
    ds_read_b64_tr_b16 v[90:91], v104 offset:8704
    ds_read_b64_tr_b16 v[92:93], v104 offset:8208
    ds_read_b64_tr_b16 v[94:95], v104 offset:8720
    ds_read_b64_tr_b16 v[96:97], v104 offset:8224
    ds_read_b64_tr_b16 v[98:99], v104 offset:8736
    ds_read_b64_tr_b16 v[100:101], v104 offset:8240
    ds_read_b64_tr_b16 v[102:103], v104 offset:8752
    v_bfe_u32 v105, v0, 1, 3
    v_lshlrev_b32 v105, 8, v105
    v_lshl_add_u32 v105, v109, 5, v105
    v_lshl_add_u32 v105, v110, 4, v105
    v_lshrrev_b32 v106, 3, v0
    v_lshlrev_b32 v106, 7, v106
    v_and_b32 v110, 7, v0
    v_lshl_add_u32 v107, v110, 3, v106
    v_add_u32 v107, s100, v107
    v_lshl_add_u32 v106, v110, 2, v106
    v_add_u32 v106, s96, v106
    v_lshlrev_b32 v108, 2, v0
    s_lshl_b32 s96, s62, 2
    s_add_u32 s96, s96, 162088
    v_mov_b32 v109, s96
    s_lshl_b32 s100, s63, 11
    s_lshl_b32 s96, s34, 13
    s_add_u32 s100, s100, s96
    s_add_u32 s100, s100, 90112
    s_mul_i32 s101, s34, 5120
    s_lshl_b32 s96, s35, 9
    s_add_u32 s101, s101, s96
    s_lshl_b32 s96, s62, 8
    s_add_u32 s101, s101, s96
    s_add_u32 s101, s101, 144384
L_nofrag_82:
    v_mov_b32 v10, 162076
    v_mov_b32 v11, 1
    s_mov_b64 exec, 1
    ds_add_u32 v10, v11
    s_mov_b64 exec, -1
    v_and_b32_dpp v28, v17, v20 row_newbcast:8 row_mask:0xf bank_mask:0xf
    v_and_b32_dpp v29, v17, v21 row_newbcast:8 row_mask:0xf bank_mask:0xf
    v_and_b32_dpp v30, v17, v22 row_newbcast:8 row_mask:0xf bank_mask:0xf
    v_and_b32_dpp v31, v17, v23 row_newbcast:8 row_mask:0xf bank_mask:0xf
    s_waitcnt vmcnt(3)
    s_bitcmp0_b32 s14, 25
    s_cbranch_scc1 L_sf_84
    s_waitcnt vmcnt(2)
    s_bitcmp0_b32 s15, 25
    s_cbranch_scc1 L_sf_84
    s_waitcnt vmcnt(1)
L_sf_84:
    buffer_load_dwordx4 v[140:143], v1, s[52:55], s97 offen offset:1024 nt
    v_mfma_f32_16x16x32_bf16 v[32:35], v[28:31], v[124:127], v[32:35]
    v_and_b32_dpp v24, v17, v20 row_newbcast:4 row_mask:0xf bank_mask:0xf
    v_and_b32_dpp v25, v17, v21 row_newbcast:4 row_mask:0xf bank_mask:0xf
    v_and_b32_dpp v26, v17, v22 row_newbcast:4 row_mask:0xf bank_mask:0xf
    v_and_b32_dpp v27, v17, v23 row_newbcast:4 row_mask:0xf bank_mask:0xf
    s_waitcnt vmcnt(3)
    s_bitcmp0_b32 s14, 26
    s_cbranch_scc1 L_sf_85
    s_waitcnt vmcnt(2)
    s_bitcmp0_b32 s15, 26
    s_cbranch_scc1 L_sf_85
    s_waitcnt vmcnt(1)
L_sf_85:
    buffer_load_dwordx4 v[144:147], v1, s[52:55], s97 offen offset:2048 nt
    v_mfma_f32_16x16x32_bf16 v[32:35], v[24:27], v[128:131], v[32:35]
    v_and_b32_dpp v28, v17, v20 row_newbcast:12 row_mask:0xf bank_mask:0xf
    v_and_b32_dpp v29, v17, v21 row_newbcast:12 row_mask:0xf bank_mask:0xf
    v_and_b32_dpp v30, v17, v22 row_newbcast:12 row_mask:0xf bank_mask:0xf
    v_and_b32_dpp v31, v17, v23 row_newbcast:12 row_mask:0xf bank_mask:0xf
    s_waitcnt vmcnt(3)
    s_bitcmp0_b32 s14, 27
    s_cbranch_scc1 L_sf_86
    s_waitcnt vmcnt(2)
    s_bitcmp0_b32 s15, 27
    s_cbranch_scc1 L_sf_86
    s_waitcnt vmcnt(1)
L_sf_86:
    buffer_load_dwordx4 v[148:151], v1, s[52:55], s97 offen offset:3072 nt
    s_add_u32 s97, s97, 32768
    v_add_u32 v1, 4096, v1
    v_and_b32 v1, 0x7fff, v1
    v_mfma_f32_16x16x32_bf16 v[32:35], v[28:31], v[132:135], v[32:35]
    v_and_b32_dpp v24, v18, v20 row_newbcast:0 row_mask:0xf bank_mask:0xf
    v_and_b32_dpp v25, v18, v21 row_newbcast:0 row_mask:0xf bank_mask:0xf
    v_and_b32_dpp v26, v18, v22 row_newbcast:0 row_mask:0xf bank_mask:0xf
    v_and_b32_dpp v27, v18, v23 row_newbcast:0 row_mask:0xf bank_mask:0xf
    s_waitcnt vmcnt(3)
    s_bitcmp0_b32 s14, 28
    s_cbranch_scc1 L_sf_87
    s_waitcnt vmcnt(2)
    s_bitcmp0_b32 s15, 28
    s_cbranch_scc1 L_sf_87
    s_waitcnt vmcnt(1)
L_sf_87:
    buffer_load_dwordx4 v[152:155], v1, s[52:55], s97 offen offset:0 nt
    v_mfma_f32_16x16x32_bf16 v[32:35], v[24:27], v[136:139], v[32:35]
    v_and_b32_dpp v28, v18, v20 row_newbcast:8 row_mask:0xf bank_mask:0xf
    v_and_b32_dpp v29, v18, v21 row_newbcast:8 row_mask:0xf bank_mask:0xf
    v_and_b32_dpp v30, v18, v22 row_newbcast:8 row_mask:0xf bank_mask:0xf
    v_and_b32_dpp v31, v18, v23 row_newbcast:8 row_mask:0xf bank_mask:0xf
    s_waitcnt vmcnt(3)
    s_bitcmp0_b32 s14, 29
    s_cbranch_scc1 L_sf_88
    s_waitcnt vmcnt(2)
    s_bitcmp0_b32 s15, 29
    s_cbranch_scc1 L_sf_88
    s_waitcnt vmcnt(1)
L_sf_88:
    buffer_load_dwordx4 v[156:159], v1, s[52:55], s97 offen offset:1024 nt
    v_mfma_f32_16x16x32_bf16 v[32:35], v[28:31], v[140:143], v[32:35]
    v_and_b32_dpp v24, v18, v20 row_newbcast:4 row_mask:0xf bank_mask:0xf
    v_and_b32_dpp v25, v18, v21 row_newbcast:4 row_mask:0xf bank_mask:0xf
    v_and_b32_dpp v26, v18, v22 row_newbcast:4 row_mask:0xf bank_mask:0xf
    v_and_b32_dpp v27, v18, v23 row_newbcast:4 row_mask:0xf bank_mask:0xf
    s_waitcnt vmcnt(3)
    s_bitcmp0_b32 s14, 30
    s_cbranch_scc1 L_sf_89
    s_waitcnt vmcnt(2)
    s_bitcmp0_b32 s15, 30
    s_cbranch_scc1 L_sf_89
    s_waitcnt vmcnt(1)
L_sf_89:
    buffer_load_dwordx4 v[160:163], v1, s[52:55], s97 offen offset:2048 nt
    v_mfma_f32_16x16x32_bf16 v[32:35], v[24:27], v[144:147], v[32:35]
    v_lshrrev_b32 v9, 4, v0
    v_lshl_add_u32 v8, v9, 2, v2
    s_lshl_b32 s96, s3, 9
    s_add_u32 s96, s96, 157824
    v_lshl_add_u32 v8, v8, 2, s96
    v_lshlrev_b32 v9, 3, v0
    v_add_u32 v9, 157824, v9
    v_mov_b32 v10, 162048
    v_mov_b32 v11, 1
    s_lshl_b32 s96, s38, 5
    s_add_u32 s96, s96, 161984
    v_mov_b32 v3, s96
    s_sub_u32 s62, 8, s39
    s_lshl_b32 s98, s34, 5
    s_add_u32 s98, s98, s35
    s_lshl_b32 s98, s98, 8
    s_add_u32 s98, s98, 90112
    v_lshlrev_b32 v39, 2, v0
    v_and_b32_dpp v28, v18, v20 row_newbcast:12 row_mask:0xf bank_mask:0xf
    v_and_b32_dpp v29, v18, v21 row_newbcast:12 row_mask:0xf bank_mask:0xf
    v_and_b32_dpp v30, v18, v22 row_newbcast:12 row_mask:0xf bank_mask:0xf
    v_and_b32_dpp v31, v18, v23 row_newbcast:12 row_mask:0xf bank_mask:0xf
    s_waitcnt vmcnt(3)
    s_bitcmp0_b32 s14, 31
    s_cbranch_scc1 L_sf_90
    s_waitcnt vmcnt(2)
    s_bitcmp0_b32 s15, 31
    s_cbranch_scc1 L_sf_90
    s_waitcnt vmcnt(1)
L_sf_90:
    buffer_load_dwordx4 v[164:167], v1, s[52:55], s97 offen offset:3072 nt
    s_mov_b32 s97, 0
    v_add_u32 v1, 4096, v1
    v_and_b32 v1, 0x7fff, v1
    v_mfma_f32_16x16x32_bf16 v[32:35], v[28:31], v[148:151], v[32:35]
    s_cmp_eq_u32 s12, -1
    s_cbranch_scc1 L_v_nopf
    v_and_b32_dpp v24, v19, v20 row_newbcast:0 row_mask:0xf bank_mask:0xf
    v_and_b32_dpp v25, v19, v21 row_newbcast:0 row_mask:0xf bank_mask:0xf
    v_and_b32_dpp v26, v19, v22 row_newbcast:0 row_mask:0xf bank_mask:0xf
    v_and_b32_dpp v27, v19, v23 row_newbcast:0 row_mask:0xf bank_mask:0xf
    s_waitcnt vmcnt(3)
    s_nop 0
    v_mfma_f32_16x16x32_bf16 v[32:35], v[24:27], v[152:155], v[32:35]
    v_and_b32_dpp v28, v19, v20 row_newbcast:8 row_mask:0xf bank_mask:0xf
    v_and_b32_dpp v29, v19, v21 row_newbcast:8 row_mask:0xf bank_mask:0xf
    v_and_b32_dpp v30, v19, v22 row_newbcast:8 row_mask:0xf bank_mask:0xf
    v_and_b32_dpp v31, v19, v23 row_newbcast:8 row_mask:0xf bank_mask:0xf
    s_waitcnt vmcnt(2)
    s_nop 0
    v_mfma_f32_16x16x32_bf16 v[32:35], v[28:31], v[156:159], v[32:35]
    v_and_b32_dpp v24, v19, v20 row_newbcast:4 row_mask:0xf bank_mask:0xf
    v_and_b32_dpp v25, v19, v21 row_newbcast:4 row_mask:0xf bank_mask:0xf
    v_and_b32_dpp v26, v19, v22 row_newbcast:4 row_mask:0xf bank_mask:0xf
    v_and_b32_dpp v27, v19, v23 row_newbcast:4 row_mask:0xf bank_mask:0xf
    s_waitcnt vmcnt(1)
    s_nop 0
    v_mfma_f32_16x16x32_bf16 v[32:35], v[24:27], v[160:163], v[32:35]
    v_and_b32_dpp v28, v19, v20 row_newbcast:12 row_mask:0xf bank_mask:0xf
    v_and_b32_dpp v29, v19, v21 row_newbcast:12 row_mask:0xf bank_mask:0xf
    v_and_b32_dpp v30, v19, v22 row_newbcast:12 row_mask:0xf bank_mask:0xf
    v_and_b32_dpp v31, v19, v23 row_newbcast:12 row_mask:0xf bank_mask:0xf
    s_waitcnt vmcnt(0)
    s_nop 0
    v_mfma_f32_16x16x32_bf16 v[32:35], v[28:31], v[164:167], v[32:35]
L_v_join:
    s_cmp_lg_u32 s13, 0
    s_cbranch_scc1 L_jobend
L_t0:
    s_mov_b32 exec_hi, 0
    s_nop 4
    ds_write_b128 v8, v[32:35]
L_t0b:
    s_mov_b64 exec, 1
    ds_add_rtn_u32 v37, v10, v11
    s_mov_b64 exec, -1
    ds_read_b32 v38, v10 offset:24
    ds_read_b128 v[24:27], v3
    ds_read_b128 v[28:31], v3 offset:16
    ds_read_b64 v[144:145], v9 offset:0
    ds_read_b64 v[146:147], v9 offset:512
    ds_read_b64 v[148:149], v9 offset:1024
    ds_read_b64 v[150:151], v9 offset:1536
    ds_read_b64 v[152:153], v9 offset:2048
    ds_read_b64 v[154:155], v9 offset:2560
    ds_read_b64 v[156:157], v9 offset:3072
    ds_read_b64 v[158:159], v9 offset:3584
    s_waitcnt lgkmcnt(10)
    v_readfirstlane_b32 s96, v37
    v_readfirstlane_b32 s61, v38
    s_cmp_lg_u32 s96, s62
    s_cbranch_scc1 L_nopub
    s_waitcnt lgkmcnt(6)
    v_pk_mul_f32 v[144:145], v[144:145], v[24:25] op_sel:[0,0] op_sel_hi:[1,0]
    v_pk_mul_f32 v[146:147], v[146:147], v[24:25] op_sel:[0,1] op_sel_hi:[1,1]
    s_waitcnt lgkmcnt(4)
    v_pk_fma_f32 v[144:145], v[148:149], v[26:27], v[144:145] op_sel:[0,0,0] op_sel_hi:[1,0,1]
    v_pk_fma_f32 v[146:147], v[150:151], v[26:27], v[146:147] op_sel:[0,1,0] op_sel_hi:[1,1,1]
    s_waitcnt lgkmcnt(2)
    v_pk_fma_f32 v[144:145], v[152:153], v[28:29], v[144:145] op_sel:[0,0,0] op_sel_hi:[1,0,1]
    v_pk_fma_f32 v[146:147], v[154:155], v[28:29], v[146:147] op_sel:[0,1,0] op_sel_hi:[1,1,1]
    s_waitcnt lgkmcnt(0)
    v_pk_fma_f32 v[144:145], v[156:157], v[30:31], v[144:145] op_sel:[0,0,0] op_sel_hi:[1,0,1]
    v_pk_fma_f32 v[146:147], v[158:159], v[30:31], v[146:147] op_sel:[0,1,0] op_sel_hi:[1,1,1]
    s_cmp_eq_u32 s61, 1
    v_pk_add_f32 v[144:145], v[144:145], v[146:147]
    v_cvt_pk_bf16_f32 v32, v144, v145
    s_cbranch_scc0 L_oslow
    buffer_store_dword v32, v39, s[40:43], s98 offen
L_odone:
L_nopub:
    s_cmp_eq_u32 s59, 0
    s_cbranch_scc1 L_not1
L_poll_99:
    buffer_load_dwordx4 v[16:19], v105, s[40:43], s100 offen sc1
    buffer_load_dwordx4 v[20:23], v105, s[40:43], s100 offen offset:128 sc1
    s_sub_u32 s60, s60, 1
    s_cbranch_scc1 L_poll_99t
    s_waitcnt vmcnt(0)
    v_max3_u32 v38, v16, v17, v18
    v_max3_u32 v38, v38, v19, v20
    v_max3_u32 v38, v38, v21, v22
    v_max_u32 v38, v38, v23
    v_cmp_eq_u32 vcc, -1, v38
    s_cbranch_vccnz L_poll_99
L_poll_99e:
    v_mfma_f32_16x16x32_bf16 v[112:115], v[16:19], v[72:75], 0
    v_mfma_f32_16x16x32_bf16 v[120:123], v[16:19], v[80:83], 0
    v_mfma_f32_16x16x32_bf16 v[116:119], v[16:19], v[76:79], 0
    v_mfma_f32_16x16x32_bf16 v[124:127], v[16:19], v[84:87], 0
    v_mfma_f32_16x16x32_bf16 v[112:115], v[20:23], v[88:91], v[112:115]
    v_mfma_f32_16x16x32_bf16 v[120:123], v[20:23], v[96:99], v[120:123]
    v_mfma_f32_16x16x32_bf16 v[116:119], v[20:23], v[92:95], v[116:119]
    v_mfma_f32_16x16x32_bf16 v[124:127], v[20:23], v[100:103], v[124:127]
    s_nop 4
    v_pk_add_f32 v[112:113], v[112:113], v[114:115]
    v_pk_add_f32 v[120:121], v[120:121], v[122:123]
    v_pk_add_f32 v[116:117], v[116:117], v[118:119]
    v_pk_add_f32 v[124:125], v[124:125], v[126:127]
    v_add_f32_dpp v12, v113, v112 row_ror:8 row_mask:0xf bank_mask:0x3
    v_add_f32_dpp v12, v120, v121 row_ror:8 row_mask:0xf bank_mask:0xc
    v_add_f32_dpp v13, v117, v116 row_ror:8 row_mask:0xf bank_mask:0x3
    v_add_f32_dpp v13, v124, v125 row_ror:8 row_mask:0xf bank_mask:0xc
    ds_write2_b32 v106, v12, v13 offset0:0 offset1:8
    s_mov_b64 exec, 1
    ds_add_rtn_u32 v37, v109, v11
    s_mov_b64 exec, -1
    ds_read_b64 v[72:73], v107 offset:0
    ds_read_b64 v[74:75], v107 offset:16384
    ds_read_b64 v[76:77], v107 offset:32768
    ds_read_b64 v[78:79], v107 offset:49152
    s_waitcnt lgkmcnt(4)
    v_readfirstlane_b32 s96, v37
    s_waitcnt lgkmcnt(2)
    v_pk_add_f32 v[72:73], v[72:73], v[74:75]
    s_cmp_lg_u32 s96, 3
    s_cbranch_scc1 L_not1
    s_waitcnt lgkmcnt(0)
    v_pk_add_f32 v[76:77], v[76:77], v[78:79]
    v_pk_add_f32 v[72:73], v[72:73], v[76:77]
    v_cvt_pk_bf16_f32 v12, v72, v73
    buffer_store_dword v12, v108, s[40:43], s101 offen sc1
L_not1:
    s_waitcnt lgkmcnt(0)
    s_cmp_eq_u32 s39, 1
    s_cbranch_scc1 L_s_role
    s_endpgm
L_k_nopf:
    s_waitcnt vmcnt(3)
    s_bitcmp0_b32 s57, 22
    s_cbranch_scc1 L_sf_55
    s_waitcnt vmcnt(2)
    s_bitcmp0_b32 s58, 22
    s_cbranch_scc1 L_sf_55
    s_waitcnt vmcnt(1)
L_sf_55:
    buffer_load_dwordx4 v[128:131], v1, s[48:51], s97 offen offset:2048 nt
    v_min_u32 v39, 29, v0
    v_lshlrev_b32 v39, 2, v39
    buffer_load_dword v37, v39, s[44:47], 0 offen sc1
    s_waitcnt vmcnt(4)
    s_bitcmp0_b32 s57, 23
    s_cbranch_scc1 L_sf_56
    s_waitcnt vmcnt(3)
    s_bitcmp0_b32 s58, 23
    s_cbranch_scc1 L_sf_56
    s_waitcnt vmcnt(2)
L_sf_56:
    buffer_load_dwordx4 v[132:135], v1, s[48:51], s97 offen offset:3072 nt
    s_add_u32 s97, s97, 32768
    v_add_u32 v1, 4096, v1
    v_and_b32 v1, 0x7fff, v1
    s_waitcnt vmcnt(4)
    s_bitcmp0_b32 s57, 24
    s_cbranch_scc1 L_sf_57
    s_waitcnt vmcnt(3)
    s_bitcmp0_b32 s58, 24
    s_cbranch_scc1 L_sf_57
    s_waitcnt vmcnt(2)
L_sf_57:
    buffer_load_dwordx4 v[136:139], v1, s[48:51], s97 offen offset:0 nt
    s_waitcnt vmcnt(4)
    s_bitcmp0_b32 s57, 25
    s_cbranch_scc1 L_sf_58
    s_waitcnt vmcnt(3)
    s_bitcmp0_b32 s58, 25
    s_cbranch_scc1 L_sf_58
    s_waitcnt vmcnt(1)
L_sf_58:
    buffer_load_dwordx4 v[140:143], v1, s[48:51], s97 offen offset:1024 nt
    s_waitcnt vmcnt(4)
    s_bitcmp0_b32 s57, 26
    s_cbranch_scc1 L_sf_59
    s_waitcnt vmcnt(2)
    s_bitcmp0_b32 s58, 26
    s_cbranch_scc1 L_sf_59
    s_waitcnt vmcnt(1)
L_sf_59:
    buffer_load_dwordx4 v[144:147], v1, s[48:51], s97 offen offset:2048 nt
    s_waitcnt vmcnt(3)
    s_bitcmp0_b32 s57, 27
    s_cbranch_scc1 L_sf_60
    s_waitcnt vmcnt(2)
    s_bitcmp0_b32 s58, 27
    s_cbranch_scc1 L_sf_60
    s_waitcnt vmcnt(1)
L_sf_60:
    buffer_load_dwordx4 v[148:151], v1, s[48:51], s97 offen offset:3072 nt
    s_add_u32 s97, s97, 32768
    v_add_u32 v1, 4096, v1
    v_and_b32 v1, 0x7fff, v1
    v_cmp_eq_u32 vcc, 0, v37
    s_nop 0
    s_or_b32 s96, vcc_lo, vcc_hi
    buffer_load_dwordx4 v[4:7], v2, s[40:43], s98 offen sc1
    s_waitcnt vmcnt(4)
    s_bitcmp0_b32 s57, 28
    s_cbranch_scc1 L_sf_61
    s_waitcnt vmcnt(3)
    s_bitcmp0_b32 s58, 28
    s_cbranch_scc1 L_sf_61
    s_waitcnt vmcnt(2)
L_sf_61:
    buffer_load_dwordx4 v[152:155], v1, s[48:51], s97 offen offset:0 nt
    s_waitcnt vmcnt(4)
    s_bitcmp0_b32 s57, 29
    s_cbranch_scc1 L_sf_62
    s_waitcnt vmcnt(3)
    s_bitcmp0_b32 s58, 29
    s_cbranch_scc1 L_sf_62
    s_waitcnt vmcnt(2)
L_sf_62:
    buffer_load_dwordx4 v[156:159], v1, s[48:51], s97 offen offset:1024 nt
    s_waitcnt vmcnt(4)
    s_bitcmp0_b32 s57, 30
    s_cbranch_scc1 L_sf_63
    s_waitcnt vmcnt(3)
    s_bitcmp0_b32 s58, 30
    s_cbranch_scc1 L_sf_63
    s_waitcnt vmcnt(1)
L_sf_63:
    buffer_load_dwordx4 v[160:163], v1, s[48:51], s97 offen offset:2048 nt
    s_waitcnt vmcnt(4)
    s_bitcmp0_b32 s57, 31
    s_cbranch_scc1 L_sf_64
    s_waitcnt vmcnt(2)
    s_bitcmp0_b32 s58, 31
    s_cbranch_scc1 L_sf_64
    s_waitcnt vmcnt(1)
L_sf_64:
    buffer_load_dwordx4 v[164:167], v1, s[48:51], s97 offen offset:3072 nt
    s_mov_b32 s97, 0
    v_add_u32 v1, 4096, v1
    v_and_b32 v1, 0x7fff, v1
    v_add_u32 v1, 8192, v1
    v_and_b32 v1, 0x7fff, v1
    s_mov_b32 s97, 65536
    s_branch L_k_join
L_v_nopf:
    v_and_b32_dpp v24, v19, v20 row_newbcast:0 row_mask:0xf bank_mask:0xf
    v_and_b32_dpp v25, v19, v21 row_newbcast:0 row_mask:0xf bank_mask:0xf
    v_and_b32_dpp v26, v19, v22 row_newbcast:0 row_mask:0xf bank_mask:0xf
    v_and_b32_dpp v27, v19, v23 row_newbcast:0 row_mask:0xf bank_mask:0xf
    s_waitcnt vmcnt(3)
    s_bitcmp0_b32 s14, 0
    s_cbranch_scc1 L_sf_91
    s_waitcnt vmcnt(2)
    s_bitcmp0_b32 s15, 0
    s_cbranch_scc1 L_sf_91
    s_waitcnt vmcnt(1)
L_sf_91:
    buffer_load_dwordx4 v[40:43], v1, s[52:55], s97 offen offset:0 nt
    v_mfma_f32_16x16x32_bf16 v[32:35], v[24:27], v[152:155], v[32:35]
    v_and_b32_dpp v28, v19, v20 row_newbcast:8 row_mask:0xf bank_mask:0xf
    v_and_b32_dpp v29, v19, v21 row_newbcast:8 row_mask:0xf bank_mask:0xf
    v_and_b32_dpp v30, v19, v22 row_newbcast:8 row_mask:0xf bank_mask:0xf
    v_and_b32_dpp v31, v19, v23 row_newbcast:8 row_mask:0xf bank_mask:0xf
    s_waitcnt vmcnt(3)
    s_bitcmp0_b32 s14, 1
    s_cbranch_scc1 L_sf_92
    s_waitcnt vmcnt(2)
    s_bitcmp0_b32 s15, 1
    s_cbranch_scc1 L_sf_92
    s_waitcnt vmcnt(1)
L_sf_92:
    buffer_load_dwordx4 v[44:47], v1, s[52:55], s97 offen offset:1024 nt
    v_mfma_f32_16x16x32_bf16 v[32:35], v[28:31], v[156:159], v[32:35]
    v_and_b32_dpp v24, v19, v20 row_newbcast:4 row_mask:0xf bank_mask:0xf
    v_and_b32_dpp v25, v19, v21 row_newbcast:4 row_mask:0xf bank_mask:0xf
    v_and_b32_dpp v26, v19, v22 row_newbcast:4 row_mask:0xf bank_mask:0xf
    v_and_b32_dpp v27, v19, v23 row_newbcast:4 row_mask:0xf bank_mask:0xf
    s_waitcnt vmcnt(3)
    s_bitcmp0_b32 s14, 2
    s_cbranch_scc1 L_sf_93
    s_waitcnt vmcnt(2)
    s_bitcmp0_b32 s15, 2
    s_cbranch_scc1 L_sf_93
    s_waitcnt vmcnt(1)
L_sf_93:
    buffer_load_dwordx4 v[48:51], v1, s[52:55], s97 offen offset:2048 nt
    v_mfma_f32_16x16x32_bf16 v[32:35], v[24:27], v[160:163], v[32:35]
    v_and_b32_dpp v28, v19, v20 row_newbcast:12 row_mask:0xf bank_mask:0xf
    v_and_b32_dpp v29, v19, v21 row_newbcast:12 row_mask:0xf bank_mask:0xf
    v_and_b32_dpp v30, v19, v22 row_newbcast:12 row_mask:0xf bank_mask:0xf
    v_and_b32_dpp v31, v19, v23 row_newbcast:12 row_mask:0xf bank_mask:0xf
    s_waitcnt vmcnt(3)
    s_bitcmp0_b32 s14, 3
    s_cbranch_scc1 L_sf_94
    s_waitcnt vmcnt(2)
    s_bitcmp0_b32 s15, 3
    s_cbranch_scc1 L_sf_94
    s_waitcnt vmcnt(1)
L_sf_94:
    buffer_load_dwordx4 v[52:55], v1, s[52:55], s97 offen offset:3072 nt
    s_add_u32 s97, s97, 32768
    v_add_u32 v1, 4096, v1
    v_and_b32 v1, 0x7fff, v1
    v_mfma_f32_16x16x32_bf16 v[32:35], v[28:31], v[164:167], v[32:35]
    v_and_b32_dpp v24, v12, v20 row_newbcast:0 row_mask:0xf bank_mask:0xf
    v_and_b32_dpp v25, v12, v21 row_newbcast:0 row_mask:0xf bank_mask:0xf
    v_and_b32_dpp v26, v12, v22 row_newbcast:0 row_mask:0xf bank_mask:0xf
    v_and_b32_dpp v27, v12, v23 row_newbcast:0 row_mask:0xf bank_mask:0xf
    s_waitcnt vmcnt(3)
    s_bitcmp0_b32 s14, 4
    s_cbranch_scc1 L_sf_95
    s_waitcnt vmcnt(2)
    s_bitcmp0_b32 s15, 4
    s_cbranch_scc1 L_sf_95
    s_waitcnt vmcnt(1)
L_sf_95:
    buffer_load_dwordx4 v[56:59], v1, s[52:55], s97 offen offset:0 nt
    v_mfma_f32_16x16x32_bf16 v[32:35], v[24:27], v[40:43], v[32:35]
    v_and_b32_dpp v28, v12, v20 row_newbcast:8 row_mask:0xf bank_mask:0xf
    v_and_b32_dpp v29, v12, v21 row_newbcast:8 row_mask:0xf bank_mask:0xf
    v_and_b32_dpp v30, v12, v22 row_newbcast:8 row_mask:0xf bank_mask:0xf
    v_and_b32_dpp v31, v12, v23 row_newbcast:8 row_mask:0xf bank_mask:0xf
    s_waitcnt vmcnt(3)
    s_bitcmp0_b32 s14, 5
    s_cbranch_scc1 L_sf_96
    s_waitcnt vmcnt(2)
    s_bitcmp0_b32 s15, 5
    s_cbranch_scc1 L_sf_96
    s_waitcnt vmcnt(1)
L_sf_96:
    buffer_load_dwordx4 v[60:63], v1, s[52:55], s97 offen offset:1024 nt
    v_mfma_f32_16x16x32_bf16 v[32:35], v[28:31], v[44:47], v[32:35]
    v_and_b32_dpp v24, v12, v20 row_newbcast:4 row_mask:0xf bank_mask:0xf
    v_and_b32_dpp v25, v12, v21 row_newbcast:4 row_mask:0xf bank_mask:0xf
    v_and_b32_dpp v26, v12, v22 row_newbcast:4 row_mask:0xf bank_mask:0xf
    v_and_b32_dpp v27, v12, v23 row_newbcast:4 row_mask:0xf bank_mask:0xf
    s_waitcnt vmcnt(3)
    s_bitcmp0_b32 s14, 6
    s_cbranch_scc1 L_sf_97
    s_waitcnt vmcnt(2)
    s_bitcmp0_b32 s15, 6
    s_cbranch_scc1 L_sf_97
    s_waitcnt vmcnt(1)
L_sf_97:
    buffer_load_dwordx4 v[64:67], v1, s[52:55], s97 offen offset:2048 nt
    v_mfma_f32_16x16x32_bf16 v[32:35], v[24:27], v[48:51], v[32:35]
    v_and_b32_dpp v28, v12, v20 row_newbcast:12 row_mask:0xf bank_mask:0xf
    v_and_b32_dpp v29, v12, v21 row_newbcast:12 row_mask:0xf bank_mask:0xf
    v_and_b32_dpp v30, v12, v22 row_newbcast:12 row_mask:0xf bank_mask:0xf
    v_and_b32_dpp v31, v12, v23 row_newbcast:12 row_mask:0xf bank_mask:0xf
    s_waitcnt vmcnt(3)
    s_bitcmp0_b32 s14, 7
    s_cbranch_scc1 L_sf_98
    s_waitcnt vmcnt(2)
    s_bitcmp0_b32 s15, 7
    s_cbranch_scc1 L_sf_98
    s_waitcnt vmcnt(1)
L_sf_98:
    buffer_load_dwordx4 v[68:71], v1, s[52:55], s97 offen offset:3072 nt
    s_add_u32 s97, s97, 32768
    v_add_u32 v1, 4096, v1
    v_and_b32 v1, 0x7fff, v1
    v_mfma_f32_16x16x32_bf16 v[32:35], v[28:31], v[52:55], v[32:35]
    v_and_b32_dpp v24, v13, v20 row_newbcast:0 row_mask:0xf bank_mask:0xf
    v_and_b32_dpp v25, v13, v21 row_newbcast:0 row_mask:0xf bank_mask:0xf
    v_and_b32_dpp v26, v13, v22 row_newbcast:0 row_mask:0xf bank_mask:0xf
    v_and_b32_dpp v27, v13, v23 row_newbcast:0 row_mask:0xf bank_mask:0xf
    s_waitcnt vmcnt(3)
    s_nop 0
    v_mfma_f32_16x16x32_bf16 v[32:35], v[24:27], v[56:59], v[32:35]
    v_and_b32_dpp v28, v13, v20 row_newbcast:8 row_mask:0xf bank_mask:0xf
    v_and_b32_dpp v29, v13, v21 row_newbcast:8 row_mask:0xf bank_mask:0xf
    v_and_b32_dpp v30, v13, v22 row_newbcast:8 row_mask:0xf bank_mask:0xf
    v_and_b32_dpp v31, v13, v23 row_newbcast:8 row_mask:0xf bank_mask:0xf
    s_waitcnt vmcnt(2)
    s_nop 0
    v_mfma_f32_16x16x32_bf16 v[32:35], v[28:31], v[60:63], v[32:35]
    v_and_b32_dpp v24, v13, v20 row_newbcast:4 row_mask:0xf bank_mask:0xf
    v_and_b32_dpp v25, v13, v21 row_newbcast:4 row_mask:0xf bank_mask:0xf
    v_and_b32_dpp v26, v13, v22 row_newbcast:4 row_mask:0xf bank_mask:0xf
    v_and_b32_dpp v27, v13, v23 row_newbcast:4 row_mask:0xf bank_mask:0xf
    s_waitcnt vmcnt(1)
    s_nop 0
    v_mfma_f32_16x16x32_bf16 v[32:35], v[24:27], v[64:67], v[32:35]
    v_and_b32_dpp v28, v13, v20 row_newbcast:12 row_mask:0xf bank_mask:0xf
    v_and_b32_dpp v29, v13, v21 row_newbcast:12 row_mask:0xf bank_mask:0xf
    v_and_b32_dpp v30, v13, v22 row_newbcast:12 row_mask:0xf bank_mask:0xf
    v_and_b32_dpp v31, v13, v23 row_newbcast:12 row_mask:0xf bank_mask:0xf
    s_waitcnt vmcnt(0)
    s_nop 0
    v_mfma_f32_16x16x32_bf16 v[32:35], v[28:31], v[68:71], v[32:35]
    s_branch L_v_join
L_oslow:
    buffer_store_dword v32, v39, s[40:43], s98 offen sc1
    s_branch L_odone
L_qslow:
L_wy_100:
    buffer_load_dword v37, v39, s[44:47], 0 offen sc1
    s_waitcnt vmcnt(0)
    v_cmp_ne_u32 vcc, -1, v37
    s_cbranch_vccz L_wy_100e
    s_sleep 4
    s_sub_u32 s60, s60, 1
    s_cbranch_scc0 L_wy_100
    s_mov_b32 s60, 0
L_wy_100e:
L_qslow2:
    s_branch L_poll_101
L_poll_101s:
    s_sleep 2
L_poll_101:
    buffer_load_dwordx4 v[4:7], v2, s[40:43], s98 offen sc1
    s_sub_u32 s60, s60, 1
    s_cbranch_scc1 L_poll_101t
    s_waitcnt vmcnt(0)
    v_max3_u32 v38, v4, v5, v6
    v_max_u32 v38, v38, v7
    v_cmp_eq_u32 vcc, -1, v38
    s_cbranch_vccnz L_poll_101s
L_poll_101e:
    s_branch L_qok
L_mljob:
    s_lshl_b32 s96, s38, 3
    s_add_u32 s96, s96, s3
    s_lshl3_add_u32 s96, s96, s99
    buffer_store_dwordx2 v[8:9], v36, s[40:43], s96 offen sc1
    s_branch L_mldone
L_service:
    s_mov_b32 s59, 0
    v_mov_b32 v5, 0
    v_mov_b32 v105, 0
    v_mov_b32 v108, 0
    v_mov_b32 v160, 0
    v_mov_b32 v8, 162068
L_lw_102:
    ds_read_b32 v9, v8
    s_waitcnt lgkmcnt(0)
    v_cmp_gt_u32 vcc, 8, v9
    s_cbranch_vccz L_lw_102e
    s_sleep 8
    s_sub_u32 s60, s60, 1
    s_cbranch_scc0 L_lw_102
    s_mov_b32 s60, 0
L_lw_102e:
    v_and_b32 v2, 15, v0
    v_lshlrev_b32 v2, 3, v2
    v_add_u32 v3, 161920, v2
    ds_read_b64 v[8:9], v3
    s_lshl_b32 s99, s37, 5
    s_add_u32 s99, s99, s36
    s_lshl_b32 s99, s99, 7
    s_add_u32 s99, s99, 73728
    s_lshl_b32 s62, s38, 6
    s_add_u32 s62, s62, s99
    s_getreg_b32 s58, hwreg(HW_REG_XCC_ID, 0, 4)
    v_mov_b32 v10, s58
    s_lshl_b32 s98, s34, 5
    s_add_u32 s98, s98, s35
    s_lshl_b32 s63, s98, 2
    s_add_u32 s63, s63, 229376
    s_lshl_b32 s98, s98, 8
    s_add_u32 s98, s98, 90112
    v_lshlrev_b32 v39, 2, v0
    s_bfm_b64 exec, 8, 0
    s_waitcnt lgkmcnt(0)
    buffer_store_dwordx2 v[8:9], v2, s[40:43], s62 offen sc1
    s_mov_b64 exec, 1
    buffer_store_dword v10, v36, s[40:43], s63 offen sc1
    s_mov_b64 exec, -1
    v_mov_b32 v12, 162076
L_lw_103:
    ds_read_b32 v13, v12
    s_waitcnt lgkmcnt(0)
    v_cmp_gt_u32 vcc, 4, v13
    s_cbranch_vccz L_lw_103e
    s_sleep 4
    s_sub_u32 s60, s60, 1
    s_cbranch_scc0 L_lw_103
    s_mov_b32 s60, 0
L_lw_103e:
    v_and_b32 v11, 31, v0
    v_lshlrev_b32 v11, 2, v11
    s_lshl_b32 s63, s34, 7
    s_add_u32 s63, s63, 229376
    buffer_load_dword v12, v39, s[40:43], s98 offen sc1
    s_branch L_poll_104
L_poll_104s:
    s_sleep 16
L_poll_104:
    buffer_load_dwordx2 v[8:9], v2, s[40:43], s99 offen sc1
    buffer_load_dword v10, v11, s[40:43], s63 offen sc1
    s_sub_u32 s60, s60, 1
    s_cbranch_scc1 L_poll_104t
    s_waitcnt vmcnt(0)
    v_max3_u32 v38, v8, v9, v10
    v_cmp_eq_u32 vcc, -1, v38
    s_cbranch_vccnz L_poll_104s
L_poll_104e:
    v_mov_b32 v37, v8
    s_nop 1
    v_max_f32_dpp v37, v37, v37 quad_perm:[1,0,3,2] row_mask:0xf bank_mask:0xf
    s_nop 1
    v_max_f32_dpp v37, v37, v37 quad_perm:[2,3,0,1] row_mask:0xf bank_mask:0xf
    s_nop 1
    v_max_f32_dpp v37, v37, v37 row_ror:4 row_mask:0xf bank_mask:0xf
    s_nop 1
    v_max_f32_dpp v37, v37, v37 row_ror:8 row_mask:0xf bank_mask:0xf
    v_sub_f32 v8, v8, v37
    v_exp_f32 v8, v8
    s_nop 0
    v_mul_f32 v9, v8, v9
    s_nop 1
    v_add_f32_dpp v9, v9, v9 quad_perm:[1,0,3,2] row_mask:0xf bank_mask:0xf
    s_nop 1
    v_add_f32_dpp v9, v9, v9 quad_perm:[2,3,0,1] row_mask:0xf bank_mask:0xf
    s_nop 1
    v_add_f32_dpp v9, v9, v9 row_ror:4 row_mask:0xf bank_mask:0xf
    s_nop 1
    v_add_f32_dpp v9, v9, v9 row_ror:8 row_mask:0xf bank_mask:0xf
    s_getreg_b32 s62, hwreg(HW_REG_XCC_ID, 0, 4)
    v_cmp_ne_u32 vcc, s62, v10
    s_nop 0
    s_cmp_eq_u64 vcc, 0
    s_cselect_b32 s61, 1, 0
    v_rcp_f32 v9, v9
    v_lshrrev_b32 v3, 1, v2
    v_add_u32 v3, 161984, v3
    v_mul_f32 v8, v8, v9
    v_mov_b32 v10, 162072
    v_mov_b32 v11, s61
    ds_write_b32 v3, v8
    ds_write_b32 v10, v11
    s_mov_b32 s3, 1
    v_lshrrev_b32 v9, 4, v0
    v_lshl_add_u32 v8, v9, 2, v2
    s_lshl_b32 s96, s3, 9
    s_add_u32 s96, s96, 157824
    v_lshl_add_u32 v8, v8, 2, s96
    v_lshlrev_b32 v9, 3, v0
    v_add_u32 v9, 157824, v9
    v_mov_b32 v10, 162048
    v_mov_b32 v11, 1
    s_lshl_b32 s96, s38, 5
    s_add_u32 s96, s96, 161984
    v_mov_b32 v3, s96
    s_sub_u32 s62, 8, s39
    s_lshl_b32 s98, s34, 5
    s_add_u32 s98, s98, s35
    s_lshl_b32 s98, s98, 8
    s_add_u32 s98, s98, 90112
    v_lshlrev_b32 v39, 2, v0
    s_branch L_t0b
L_jobend:
    v_lshrrev_b32 v9, 4, v0
    v_lshl_add_u32 v9, v9, 2, v2
    v_lshlrev_b32 v9, 2, v9
    s_mov_b32 exec_hi, 0
    s_nop 1
    buffer_store_dwordx4 v[32:35], v9, s[40:43], s13 offen sc1
    s_endpgm
L_proxy:
    v_mov_b32 v5, 0
    v_mov_b32 v105, 0
    v_mov_b32 v108, 0
    v_mov_b32 v160, 0
    s_barrier
    s_waitcnt lgkmcnt(0)
    s_mov_b32 s40, s32
    s_mov_b32 s41, s33
    s_mov_b32 s42, 589824
    s_mov_b32 s43, 0x20000
    s_mov_b32 s44, s30
    s_mov_b32 s45, s31
    s_mov_b32 s46, 256
    s_mov_b32 s47, 0x20000
    s_sub_u32 s97, 7, s3
    s_mul_i32 s97, s97, 27
    s_cmp_eq_u32 s3, 5
    s_cselect_b32 s97, 32, s97
    s_add_u32 s97, s97, s35
    s_lshl_b32 s97, s97, 9
    s_add_u32 s97, s97, 196608
    v_and_b32 v2, 15, v0
    v_lshlrev_b32 v2, 3, v2
    v_bfe_u32 v20, v0, 4, 1
    v_lshl_add_u32 v20, v20, 2, v2
    v_lshlrev_b32 v20, 2, v20
    s_cmp_lg_u32 s3, 7
    s_cbranch_scc1 L_px6
    s_sub_u32 s96, 6, s59
    v_mov_b32 v8, 162068
L_lw_105:
    ds_read_b32 v9, v8
    s_waitcnt lgkmcnt(0)
    v_cmp_gt_u32 vcc, s96, v9
    s_cbranch_vccz L_lw_105e
    s_sleep 8
    s_sub_u32 s60, s60, 1
    s_cbranch_scc0 L_lw_105
    s_mov_b32 s60, 0
L_lw_105e:
    v_and_b32 v2, 15, v0
    v_lshlrev_b32 v2, 3, v2
    v_add_u32 v3, 161920, v2
    ds_read_b64 v[8:9], v3
    s_lshl_b32 s99, s37, 5
    s_add_u32 s99, s99, s36
    s_lshl_b32 s99, s99, 7
    s_add_u32 s99, s99, 73728
    s_lshl_b32 s62, s38, 6
    s_add_u32 s62, s62, s99
    s_getreg_b32 s58, hwreg(HW_REG_XCC_ID, 0, 4)
    v_mov_b32 v10, s58
    s_lshl_b32 s98, s34, 5
    s_add_u32 s98, s98, s35
    s_lshl_b32 s63, s98, 2
    s_add_u32 s63, s63, 229376
    s_lshl_b32 s98, s98, 8
    s_add_u32 s98, s98, 90112
    v_lshlrev_b32 v39, 2, v0
    s_bfm_b64 exec, s96, 0
    s_waitcnt lgkmcnt(0)
    buffer_store_dwordx2 v[8:9], v2, s[40:43], s62 offen sc1
    s_mov_b64 exec, 1
    buffer_store_dword v10, v36, s[40:43], s63 offen sc1
    s_mov_b64 exec, -1
    s_mov_b32 s100, 4
    s_lshl_b32 s63, s100, 8
    v_and_b32 v8, 15, v0
    v_lshl_add_u32 v8, v8, 4, s63
    v_lshrrev_b32 v9, 4, v0
    v_mul_u32_u24 v5, 1280, v9
    v_add_u32 v5, v5, v8
    v_mul_u32_u24 v4, 1296, v9
    v_add_u32 v4, v4, v8
    v_add_u32 v4, 81920, v4
    v_lshlrev_b32 v6, 1, v5
    v_add_u32 v6, 87104, v6
    s_lshl_b32 s62, s100, 3
    s_add_u32 s62, s62, 97344
    v_lshl_add_u32 v7, v9, 6, s62
    s_mov_b32 s48, s4
    s_mov_b32 s49, s5
    s_mov_b32 s50, 5120
    s_mov_b32 s51, 0x20000
    buffer_load_dwordx4 v[8:11], v5, s[48:51], 0 offen
    s_mov_b32 s62, 20480
    s_mov_b32 s63, 30720
    s_branch L_poll_106
L_poll_106s:
    s_sleep 32
L_poll_106:
    buffer_load_dwordx4 v[12:15], v5, s[40:43], s62 offen sc1
    buffer_load_dwordx4 v[16:19], v5, s[40:43], s63 offen sc1
    s_sub_u32 s60, s60, 1
    s_cbranch_scc1 L_poll_106t
    s_waitcnt vmcnt(0)
    v_max3_u32 v38, v12, v13, v14
    v_max3_u32 v38, v38, v15, v16
    v_max3_u32 v38, v38, v17, v18
    v_max_u32 v38, v38, v19
    v_cmp_eq_u32 vcc, -1, v38
    s_cbranch_vccnz L_poll_106s
L_poll_106e:
    v_lshlrev_b32 v40, 16, v8
    v_and_b32 v41, 0xffff0000, v8
    v_lshlrev_b32 v42, 16, v9
    v_and_b32 v43, 0xffff0000, v9
    v_lshlrev_b32 v44, 16, v10
    v_and_b32 v45, 0xffff0000, v10
    v_lshlrev_b32 v46, 16, v11
    v_and_b32 v47, 0xffff0000, v11
    v_lshlrev_b32 v48, 16, v12
    v_and_b32 v49, 0xffff0000, v12
    v_lshlrev_b32 v50, 16, v13
    v_and_b32 v51, 0xffff0000, v13
    v_lshlrev_b32 v52, 16, v14
    v_and_b32 v53, 0xffff0000, v14
    v_lshlrev_b32 v54, 16, v15
    v_and_b32 v55, 0xffff0000, v15
    v_lshlrev_b32 v56, 16, v16
    v_and_b32 v57, 0xffff0000, v16
    v_lshlrev_b32 v58, 16, v17
    v_and_b32 v59, 0xffff0000, v17
    v_lshlrev_b32 v60, 16, v18
    v_and_b32 v61, 0xffff0000, v18
    v_lshlrev_b32 v62, 16, v19
    v_and_b32 v63, 0xffff0000, v19
    v_mov_b32 v64, 0
    v_mov_b32 v65, 0
    v_mov_b32 v66, 0
    v_mov_b32 v67, 0
    v_mov_b32 v68, 0
    v_mov_b32 v69, 0
    v_mov_b32 v70, 0
    v_mov_b32 v71, 0
    v_bfe_u32 v5, v0, 2, 2
    v_lshlrev_b32 v5, 8, v5
    v_lshrrev_b32 v8, 4, v0
    v_lshl_add_u32 v5, v8, 6, v5
    v_and_b32 v8, 3, v0
    v_lshl_add_u32 v5, v8, 4, v5
    s_lshl_b32 s63, s100, 10
    v_add_u32 v5, s63, v5
    s_or_b32 s96, s59, s39
    s_cbranch_scc0 L_nofrag_107
    v_mov_b32 v104, 162060
L_lw_108:
    ds_read_b32 v105, v104
    s_waitcnt lgkmcnt(0)
    v_cmp_gt_u32 vcc, 4, v105
    s_cbranch_vccz L_lw_108e
    s_sleep 2
    s_sub_u32 s60, s60, 1
    s_cbranch_scc0 L_lw_108
    s_mov_b32 s60, 0
L_lw_108e:
    s_cmp_eq_u32 s59, 0
    s_cbranch_scc1 L_nofrag_107
    v_lshrrev_b32 v109, 4, v0
    v_bfe_u32 v104, v0, 1, 1
    v_lshl_add_u32 v104, v109, 1, v104
    v_bfe_u32 v110, v0, 2, 2
    v_lshl_add_u32 v104, v104, 3, v110
    v_lshlrev_b32 v104, 7, v104
    v_and_b32 v110, 1, v0
    v_lshl_add_u32 v104, v110, 3, v104
    s_lshr_b32 s63, s3, 1
    s_and_b32 s62, s3, 1
    s_lshl_b32 s96, s63, 14
    s_lshl_b32 s100, s62, 6
    s_add_u32 s100, s100, 81920
    s_add_u32 s96, s96, s100
    v_add_u32 v104, s96, v104
    ds_read_b64_tr_b16 v[72:73], v104 offset:0
    ds_read_b64_tr_b16 v[74:75], v104 offset:512
    ds_read_b64_tr_b16 v[76:77], v104 offset:16
    ds_read_b64_tr_b16 v[78:79], v104 offset:528
    ds_read_b64_tr_b16 v[80:81], v104 offset:32
    ds_read_b64_tr_b16 v[82:83], v104 offset:544
    ds_read_b64_tr_b16 v[84:85], v104 offset:48
    ds_read_b64_tr_b16 v[86:87], v104 offset:560
    ds_read_b64_tr_b16 v[88:89], v104 offset:8192
    ds_read_b64_tr_b16 v[90:91], v104 offset:8704
    ds_read_b64_tr_b16 v[92:93], v104 offset:8208
    ds_read_b64_tr_b16 v[94:95], v104 offset:8720
    ds_read_b64_tr_b16 v[96:97], v104 offset:8224
    ds_read_b64_tr_b16 v[98:99], v104 offset:8736
    ds_read_b64_tr_b16 v[100:101], v104 offset:8240
    ds_read_b64_tr_b16 v[102:103], v104 offset:8752
    v_bfe_u32 v105, v0, 1, 3
    v_lshlrev_b32 v105, 8, v105
    v_lshl_add_u32 v105, v109, 5, v105
    v_lshl_add_u32 v105, v110, 4, v105
    v_lshrrev_b32 v106, 3, v0
    v_lshlrev_b32 v106, 7, v106
    v_and_b32 v110, 7, v0
    v_lshl_add_u32 v107, v110, 3, v106
    v_add_u32 v107, s100, v107
    v_lshl_add_u32 v106, v110, 2, v106
    v_add_u32 v106, s96, v106
    v_lshlrev_b32 v108, 2, v0
    s_lshl_b32 s96, s62, 2
    s_add_u32 s96, s96, 162088
    v_mov_b32 v109, s96
    s_lshl_b32 s100, s63, 11
    s_lshl_b32 s96, s34, 13
    s_add_u32 s100, s100, s96
    s_add_u32 s100, s100, 90112
    s_mul_i32 s101, s34, 5120
    s_lshl_b32 s96, s35, 9
    s_add_u32 s101, s101, s96
    s_lshl_b32 s96, s62, 8
    s_add_u32 s101, s101, s96
    s_add_u32 s101, s101, 144384
L_nofrag_107:
    v_mov_b32 v12, 162076
L_lw_109:
    ds_read_b32 v13, v12
    s_waitcnt lgkmcnt(0)
    v_cmp_gt_u32 vcc, 4, v13
    s_cbranch_vccz L_lw_109e
    s_sleep 4
    s_sub_u32 s60, s60, 1
    s_cbranch_scc0 L_lw_109
    s_mov_b32 s60, 0
L_lw_109e:
    v_and_b32 v11, 31, v0
    v_lshlrev_b32 v11, 2, v11
    s_lshl_b32 s63, s34, 7
    s_add_u32 s63, s63, 229376
    buffer_load_dword v12, v39, s[40:43], s98 offen sc1
    s_branch L_poll_110
L_poll_110s:
    s_sleep 16
L_poll_110:
    buffer_load_dwordx2 v[8:9], v2, s[40:43], s99 offen sc1
    buffer_load_dword v10, v11, s[40:43], s63 offen sc1
    buffer_load_dwordx4 v[32:35], v20, s[40:43], s97 offen sc1
    s_sub_u32 s60, s60, 1
    s_cbranch_scc1 L_poll_110t
    s_waitcnt vmcnt(0)
    v_max3_u32 v38, v8, v9, v10
    v_max3_u32 v38, v38, v32, v33
    v_max3_u32 v38, v38, v34, v35
    v_cmp_eq_u32 vcc, -1, v38
    s_cbranch_vccnz L_poll_110s
L_poll_110e:
    v_mov_b32 v37, v8
    s_nop 1
    v_max_f32_dpp v37, v37, v37 quad_perm:[1,0,3,2] row_mask:0xf bank_mask:0xf
    s_nop 1
    v_max_f32_dpp v37, v37, v37 quad_perm:[2,3,0,1] row_mask:0xf bank_mask:0xf
    s_nop 1
    v_max_f32_dpp v37, v37, v37 row_ror:4 row_mask:0xf bank_mask:0xf
    s_nop 1
    v_max_f32_dpp v37, v37, v37 row_ror:8 row_mask:0xf bank_mask:0xf
    v_sub_f32 v8, v8, v37
    v_exp_f32 v8, v8
    s_nop 0
    v_mul_f32 v9, v8, v9
    s_nop 1
    v_add_f32_dpp v9, v9, v9 quad_perm:[1,0,3,2] row_mask:0xf bank_mask:0xf
    s_nop 1
    v_add_f32_dpp v9, v9, v9 quad_perm:[2,3,0,1] row_mask:0xf bank_mask:0xf
    s_nop 1
    v_add_f32_dpp v9, v9, v9 row_ror:4 row_mask:0xf bank_mask:0xf
    s_nop 1
    v_add_f32_dpp v9, v9, v9 row_ror:8 row_mask:0xf bank_mask:0xf
    s_getreg_b32 s62, hwreg(HW_REG_XCC_ID, 0, 4)
    v_cmp_ne_u32 vcc, s62, v10
    s_nop 0
    s_cmp_eq_u64 vcc, 0
    s_cselect_b32 s61, 1, 0
    v_rcp_f32 v9, v9
    v_lshrrev_b32 v3, 1, v2
    v_add_u32 v3, 161984, v3
    v_mul_f32 v8, v8, v9
    v_mov_b32 v10, 162072
    v_mov_b32 v11, s61
    ds_write_b32 v3, v8
    ds_write_b32 v10, v11
    s_branch L_pxj
L_px6:
    s_or_b32 s96, s59, s39
    s_cbranch_scc0 L_nofrag_111
    v_mov_b32 v104, 162060
L_lw_112:
    ds_read_b32 v105, v104
    s_waitcnt lgkmcnt(0)
    v_cmp_gt_u32 vcc, 4, v105
    s_cbranch_vccz L_lw_112e
    s_sleep 2
    s_sub_u32 s60, s60, 1
    s_cbranch_scc0 L_lw_112
    s_mov_b32 s60, 0
L_lw_112e:
    s_cmp_eq_u32 s59, 0
    s_cbranch_scc1 L_nofrag_111
    v_lshrrev_b32 v109, 4, v0
    v_bfe_u32 v104, v0, 1, 1
    v_lshl_add_u32 v104, v109, 1, v104
    v_bfe_u32 v110, v0, 2, 2
    v_lshl_add_u32 v104, v104, 3, v110
    v_lshlrev_b32 v104, 7, v104
    v_and_b32 v110, 1, v0
    v_lshl_add_u32 v104, v110, 3, v104
    s_lshr_b32 s63, s3, 1
    s_and_b32 s62, s3, 1
    s_lshl_b32 s96, s63, 14
    s_lshl_b32 s100, s62, 6
    s_add_u32 s100, s100, 81920
    s_add_u32 s96, s96, s100
    v_add_u32 v104, s96, v104
    ds_read_b64_tr_b16 v[72:73], v104 offset:0
    ds_read_b64_tr_b16 v[74:75], v104 offset:512
    ds_read_b64_tr_b16 v[76:77], v104 offset:16
    ds_read_b64_tr_b16 v[78:79], v104 offset:528
    ds_read_b64_tr_b16 v[80:81], v104 offset:32
    ds_read_b64_tr_b16 v[82:83], v104 offset:544
    ds_read_b64_tr_b16 v[84:85], v104 offset:48
    ds_read_b64_tr_b16 v[86:87], v104 offset:560
    ds_read_b64_tr_b16 v[88:89], v104 offset:8192
    ds_read_b64_tr_b16 v[90:91], v104 offset:8704
    ds_read_b64_tr_b16 v[92:93], v104 offset:8208
    ds_read_b64_tr_b16 v[94:95], v104 offset:8720
    ds_read_b64_tr_b16 v[96:97], v104 offset:8224
    ds_read_b64_tr_b16 v[98:99], v104 offset:8736
    ds_read_b64_tr_b16 v[100:101], v104 offset:8240
    ds_read_b64_tr_b16 v[102:103], v104 offset:8752
    v_bfe_u32 v105, v0, 1, 3
    v_lshlrev_b32 v105, 8, v105
    v_lshl_add_u32 v105, v109, 5, v105
    v_lshl_add_u32 v105, v110, 4, v105
    v_lshrrev_b32 v106, 3, v0
    v_lshlrev_b32 v106, 7, v106
    v_and_b32 v110, 7, v0
    v_lshl_add_u32 v107, v110, 3, v106
    v_add_u32 v107, s100, v107
    v_lshl_add_u32 v106, v110, 2, v106
    v_add_u32 v106, s96, v106
    v_lshlrev_b32 v108, 2, v0
    s_lshl_b32 s96, s62, 2
    s_add_u32 s96, s96, 162088
    v_mov_b32 v109, s96
    s_lshl_b32 s100, s63, 11
    s_lshl_b32 s96, s34, 13
    s_add_u32 s100, s100, s96
    s_add_u32 s100, s100, 90112
    s_mul_i32 s101, s34, 5120
    s_lshl_b32 s96, s35, 9
    s_add_u32 s101, s101, s96
    s_lshl_b32 s96, s62, 8
    s_add_u32 s101, s101, s96
    s_add_u32 s101, s101, 144384
L_nofrag_111:
    v_mov_b32 v8, 162076
L_lw_113:
    ds_read_b32 v9, v8
    s_waitcnt lgkmcnt(0)
    v_cmp_gt_u32 vcc, 4, v9
    s_cbranch_vccz L_lw_113e
    s_sleep 16
    s_sub_u32 s60, s60, 1
    s_cbranch_scc0 L_lw_113
    s_mov_b32 s60, 0
L_lw_113e:
    s_branch L_poll_114
L_poll_114s:
    s_sleep 16
L_poll_114:
    buffer_load_dwordx4 v[32:35], v20, s[40:43], s97 offen sc1
    s_sub_u32 s60, s60, 1
    s_cbranch_scc1 L_poll_114t
    s_waitcnt vmcnt(0)
    v_max3_u32 v38, v32, v33, v34
    v_max_u32 v38, v38, v35
    v_cmp_eq_u32 vcc, -1, v38
    s_cbranch_vccnz L_poll_114s
L_poll_114e:
L_pxj:
    v_mov_b32 v8, 162048
L_lw_115:
    ds_read_b32 v9, v8
    s_waitcnt lgkmcnt(0)
    v_cmp_gt_u32 vcc, 3, v9
    s_cbranch_vccz L_lw_115e
    s_sleep 2
    s_sub_u32 s60, s60, 1
    s_cbranch_scc0 L_lw_115
    s_mov_b32 s60, 0
L_lw_115e:
    v_lshrrev_b32 v9, 4, v0
    v_lshl_add_u32 v8, v9, 2, v2
    s_lshl_b32 s96, s3, 9
    s_add_u32 s96, s96, 157824
    v_lshl_add_u32 v8, v8, 2, s96
    v_lshlrev_b32 v9, 3, v0
    v_add_u32 v9, 157824, v9
    v_mov_b32 v10, 162048
    v_mov_b32 v11, 1
    s_lshl_b32 s96, s38, 5
    s_add_u32 s96, s96, 161984
    v_mov_b32 v3, s96
    s_sub_u32 s62, 8, s39
    s_lshl_b32 s98, s34, 5
    s_add_u32 s98, s98, s35
    s_lshl_b32 s98, s98, 8
    s_add_u32 s98, s98, 90112
    v_lshlrev_b32 v39, 2, v0
    s_branch L_t0
L_s_role:
    s_cmp_eq_u32 s3, 7
    s_cbranch_scc1 L_t2gate
    s_cmp_gt_u32 s3, 3
    s_cbranch_scc1 L_fin_prep
    s_mov_b32 s48, s18
    s_mov_b32 s49, s19
    s_mov_b32 s50, 3456
    s_mov_b32 s51, 0x20000
    v_lshrrev_b32 v3, 4, v0
    v_bfe_u32 v1, v0, 2, 2
    v_and_b32 v2, 3, v0
    v_lshl_add_u32 v4, v3, 2, v1
    v_lshlrev_b32 v4, 1, v4
    s_lshl_b32 s62, s35, 7
    s_lshl_b32 s63, s3, 5
    s_add_u32 s62, s62, s63
    buffer_load_ushort v82, v4, s[48:51], s62 offen
    v_mov_b32 v72, 162064
L_lw_116:
    ds_read_b32 v73, v72
    s_waitcnt lgkmcnt(0)
    v_cmp_gt_u32 vcc, 4, v73
    s_cbranch_vccz L_lw_116e
    s_sleep 2
    s_sub_u32 s60, s60, 1
    s_cbranch_scc0 L_lw_116
    s_mov_b32 s60, 0
L_lw_116e:
    v_lshrrev_b32 v72, 4, v0
    v_lshlrev_b32 v72, 10, v72
    v_bfe_u32 v73, v0, 2, 2
    v_lshl_add_u32 v72, v73, 7, v72
    v_and_b32 v73, 3, v0
    v_lshl_add_u32 v72, v73, 3, v72
    v_bfe_u32 v73, v0, 3, 2
    v_lshl_add_u32 v72, v73, 5, v72
    v_xor_b32 v72, s63, v72
    v_add_u32 v73, 40960, v72
    v_and_b32 v5, 7, v0
    v_mul_u32_u24 v5, 1296, v5
    v_lshl_add_u32 v5, v3, 4, v5
    v_add_u32 v5, 147456, v5
    ds_read_b64_tr_b16 v[88:89], v72 offset:0
    ds_read_b64_tr_b16 v[90:91], v72 offset:512
    ds_read_b64_tr_b16 v[92:93], v72 offset:4096
    ds_read_b64_tr_b16 v[94:95], v72 offset:4608
    ds_read_b64_tr_b16 v[96:97], v72 offset:8192
    ds_read_b64_tr_b16 v[98:99], v72 offset:8704
    ds_read_b64_tr_b16 v[100:101], v72 offset:12288
    ds_read_b64_tr_b16 v[102:103], v72 offset:12800
    ds_read_b64_tr_b16 v[104:105], v72 offset:16384
    ds_read_b64_tr_b16 v[106:107], v72 offset:16896
    ds_read_b64_tr_b16 v[108:109], v72 offset:20480
    ds_read_b64_tr_b16 v[110:111], v72 offset:20992
    ds_read_b64_tr_b16 v[112:113], v72 offset:24576
    ds_read_b64_tr_b16 v[114:115], v72 offset:25088
    ds_read_b64_tr_b16 v[116:117], v72 offset:28672
    ds_read_b64_tr_b16 v[118:119], v72 offset:29184
    ds_read_b64_tr_b16 v[120:121], v72 offset:32768
    ds_read_b64_tr_b16 v[122:123], v72 offset:33280
    ds_read_b64_tr_b16 v[124:125], v72 offset:36864
    ds_read_b64_tr_b16 v[126:127], v72 offset:37376
    ds_read_b64_tr_b16 v[128:129], v73 offset:0
    ds_read_b64_tr_b16 v[130:131], v73 offset:512
    ds_read_b64_tr_b16 v[132:133], v73 offset:4096
    ds_read_b64_tr_b16 v[134:135], v73 offset:4608
    ds_read_b64_tr_b16 v[136:137], v73 offset:8192
    ds_read_b64_tr_b16 v[138:139], v73 offset:8704
    ds_read_b64_tr_b16 v[140:141], v73 offset:12288
    ds_read_b64_tr_b16 v[142:143], v73 offset:12800
    ds_read_b64_tr_b16 v[144:145], v73 offset:16384
    ds_read_b64_tr_b16 v[146:147], v73 offset:16896
    ds_read_b64_tr_b16 v[148:149], v73 offset:20480
    ds_read_b64_tr_b16 v[150:151], v73 offset:20992
    ds_read_b64_tr_b16 v[152:153], v73 offset:24576
    ds_read_b64_tr_b16 v[154:155], v73 offset:25088
    ds_read_b64_tr_b16 v[156:157], v73 offset:28672
    ds_read_b64_tr_b16 v[158:159], v73 offset:29184
    ds_read_b64_tr_b16 v[160:161], v73 offset:32768
    ds_read_b64_tr_b16 v[162:163], v73 offset:33280
    ds_read_b64_tr_b16 v[164:165], v73 offset:36864
    ds_read_b64_tr_b16 v[166:167], v73 offset:37376
    ds_read_b128 v[8:11], v5 offset:0
    ds_read_b128 v[12:15], v5 offset:64
    ds_read_b128 v[16:19], v5 offset:128
    ds_read_b128 v[20:23], v5 offset:192
    ds_read_b128 v[24:27], v5 offset:256
    ds_read_b128 v[28:31], v5 offset:320
    ds_read_b128 v[32:35], v5 offset:384
    ds_read_b128 v[36:39], v5 offset:448
    ds_read_b128 v[40:43], v5 offset:512
    ds_read_b128 v[44:47], v5 offset:576
    s_waitcnt lgkmcnt(9)
    v_mfma_f32_16x16x32_bf16 v[48:51], v[88:91], v[8:11], 0
    s_waitcnt lgkmcnt(8)
    v_mfma_f32_16x16x32_bf16 v[48:51], v[92:95], v[12:15], v[48:51]
    s_waitcnt lgkmcnt(7)
    v_mfma_f32_16x16x32_bf16 v[48:51], v[96:99], v[16:19], v[48:51]
    s_waitcnt lgkmcnt(6)
    v_mfma_f32_16x16x32_bf16 v[48:51], v[100:103], v[20:23], v[48:51]
    s_waitcnt lgkmcnt(5)
    v_mfma_f32_16x16x32_bf16 v[48:51], v[104:107], v[24:27], v[48:51]
    s_waitcnt lgkmcnt(4)
    v_mfma_f32_16x16x32_bf16 v[48:51], v[108:111], v[28:31], v[48:51]
    s_waitcnt lgkmcnt(3)
    v_mfma_f32_16x16x32_bf16 v[48:51], v[112:115], v[32:35], v[48:51]
    s_waitcnt lgkmcnt(2)
    v_mfma_f32_16x16x32_bf16 v[48:51], v[116:119], v[36:39], v[48:51]
    s_waitcnt lgkmcnt(1)
    v_mfma_f32_16x16x32_bf16 v[48:51], v[120:123], v[40:43], v[48:51]
    s_waitcnt lgkmcnt(0)
    v_mfma_f32_16x16x32_bf16 v[48:51], v[124:127], v[44:47], v[48:51]
    ds_read_b128 v[8:11], v5 offset:640
    ds_read_b128 v[12:15], v5 offset:704
    ds_read_b128 v[16:19], v5 offset:768
    ds_read_b128 v[20:23], v5 offset:832
    ds_read_b128 v[24:27], v5 offset:896
    ds_read_b128 v[28:31], v5 offset:960
    ds_read_b128 v[32:35], v5 offset:1024
    ds_read_b128 v[36:39], v5 offset:1088
    ds_read_b128 v[40:43], v5 offset:1152
    ds_read_b128 v[44:47], v5 offset:1216
    s_waitcnt lgkmcnt(9)
    v_mfma_f32_16x16x32_bf16 v[48:51], v[128:131], v[8:11], v[48:51]
    s_waitcnt lgkmcnt(8)
    v_mfma_f32_16x16x32_bf16 v[48:51], v[132:135], v[12:15], v[48:51]
    s_waitcnt lgkmcnt(7)
    v_mfma_f32_16x16x32_bf16 v[48:51], v[136:139], v[16:19], v[48:51]
    s_waitcnt lgkmcnt(6)
    v_mfma_f32_16x16x32_bf16 v[48:51], v[140:143], v[20:23], v[48:51]
    s_waitcnt lgkmcnt(5)
    v_mfma_f32_16x16x32_bf16 v[48:51], v[144:147], v[24:27], v[48:51]
    s_waitcnt lgkmcnt(4)
    v_mfma_f32_16x16x32_bf16 v[48:51], v[148:151], v[28:31], v[48:51]
    s_waitcnt lgkmcnt(3)
    v_mfma_f32_16x16x32_bf16 v[48:51], v[152:155], v[32:35], v[48:51]
    s_waitcnt lgkmcnt(2)
    v_mfma_f32_16x16x32_bf16 v[48:51], v[156:159], v[36:39], v[48:51]
    s_waitcnt lgkmcnt(1)
    v_mfma_f32_16x16x32_bf16 v[48:51], v[160:163], v[40:43], v[48:51]
    s_waitcnt lgkmcnt(0)
    v_mfma_f32_16x16x32_bf16 v[48:51], v[164:167], v[44:47], v[48:51]
    v_mul_u32_u24 v79, 1296, v2
    v_lshl_add_u32 v79, v1, 6, v79
    v_lshl_add_u32 v79, v3, 4, v79
    v_add_u32 v79, 81920, v79
    v_mul_u32_u24 v80, 144, v2
    v_add3_u32 v80, v80, v4, s63
    v_add_u32 v80, 97600, v80
    v_lshlrev_b32 v81, 6, v2
    v_add_u32 v81, 97344, v81
    v_mov_b32_dpp v84, v48 quad_perm:[0,1,2,3] row_mask:0xf bank_mask:0x1
    v_mov_b32_dpp v85, v48 row_ror:4 row_mask:0xf bank_mask:0x1
    v_mov_b32_dpp v84, v49 row_ror:4 row_mask:0xf bank_mask:0x2
    v_mov_b32_dpp v85, v49 quad_perm:[0,1,2,3] row_mask:0xf bank_mask:0x2
    v_mov_b32_dpp v84, v50 quad_perm:[0,1,2,3] row_mask:0xf bank_mask:0x4
    v_mov_b32_dpp v85, v50 row_ror:4 row_mask:0xf bank_mask:0x4
    v_mov_b32_dpp v84, v51 row_ror:4 row_mask:0xf bank_mask:0x8
    v_mov_b32_dpp v85, v51 quad_perm:[0,1,2,3] row_mask:0xf bank_mask:0x8
    s_mov_b32 s62, 0xbacccccd
    s_mov_b32 s63, 0xbdd2d3e8
    v_mov_b32 v86, 0xc0135761
    s_branch L_ffn1
L_fin_prep:
    s_mul_i32 s62, s35, 3
    s_add_u32 s62, s62, s3
    s_sub_u32 s62, s62, 4
    s_cmp_ge_u32 s62, 80
    s_cbranch_scc1 L_end
    s_lshl_b32 s96, s62, 7
    s_lshl_b32 s57, s62, 6
    s_mul_i32 s63, s62, 0xccd
    s_lshr_b32 s63, s63, 16
    s_mul_i32 s63, s63, 1280
    s_sub_u32 s63, s57, s63
    s_add_u32 s96, s96, 262144
    s_add_u32 s97, s96, 81920
    s_add_u32 s98, s96, 163840
    s_add_u32 s99, s96, 245760
    v_lshrrev_b32 v72, 3, v0
    v_mul_u32_u24 v72, 10240, v72
    v_and_b32 v1, 7, v0
    v_lshl_add_u32 v72, v1, 4, v72
    v_mov_b32 v100, 0
    v_mov_b32 v101, 0
    v_mov_b32 v102, 0
    v_mov_b32 v103, 0
    v_bfe_u32 v3, v0, 4, 1
    v_lshrrev_b32 v4, 5, v0
    v_lshl_add_u32 v3, v3, 1, v4
    v_lshl_add_u32 v73, v1, 2, v3
    v_lshlrev_b32 v73, 1, v73
    s_lshl_b32 s62, s57, 1
    s_add_u32 s62, s62, 87104
    v_lshl_add_u32 v74, v73, 1, s62
    s_mov_b32 s48, s22
    s_mov_b32 s49, s23
    s_mov_b32 s50, 1280
    s_mov_b32 s51, 0x20000
    s_mov_b32 s52, s28
    s_mov_b32 s53, s29
    s_mov_b32 s54, 5120
    s_mov_b32 s55, 0x20000
    buffer_load_dwordx4 v[88:91], v72, s[40:43], s96 offen sc1
    buffer_load_dwordx4 v[92:95], v72, s[40:43], s97 offen sc1
    buffer_load_dwordx4 v[96:99], v72, s[40:43], s98 offen sc1
    s_mov_b64 exec, 0xffffff
    buffer_load_dwordx4 v[100:103], v72, s[40:43], s99 offen sc1
    s_mov_b64 exec, -1
    buffer_load_ushort v75, v73, s[48:51], s63 offen
    v_and_b32 v77, 0xfffc, v73
    s_add_u32 s62, s57, 35840
    buffer_load_dword v76, v77, s[40:43], s62 offen sc1
    s_barrier
    s_waitcnt vmcnt(0)
    v_cmp_eq_u32 vcc, -1, v76
    s_cbranch_vccz L_gbok
    s_branch L_poll_117
L_poll_117s:
    s_sleep 2
L_poll_117:
    buffer_load_dword v76, v77, s[40:43], s62 offen sc1
    s_sub_u32 s60, s60, 1
    s_cbranch_scc1 L_poll_117t
    s_waitcnt vmcnt(0)
    v_cmp_eq_u32 vcc, -1, v76
    s_cbranch_vccnz L_poll_117s
L_poll_117e:
L_gbok:
    v_lshlrev_b32 v75, 16, v75
    v_and_b32 v77, 2, v73
    v_lshlrev_b32 v77, 3, v77
    v_lshrrev_b32 v76, v77, v76
    v_lshlrev_b32 v76, 16, v76
    s_barrier
    s_barrier
    ds_read_b32 v78, v74
    s_barrier
    s_mov_b64 s[4:5], -1
    s_mov_b64 s[6:7], -1
    s_mov_b64 s[8:9], -1
    s_mov_b64 s[10:11], 0xffffff
L_yg:
    s_mov_b64 exec, s[4:5]
    buffer_load_dwordx4 v[88:91], v72, s[40:43], s96 offen sc1
    s_mov_b64 exec, s[6:7]
    buffer_load_dwordx4 v[92:95], v72, s[40:43], s97 offen sc1
    s_mov_b64 exec, s[8:9]
    buffer_load_dwordx4 v[96:99], v72, s[40:43], s98 offen sc1
    s_mov_b64 exec, s[10:11]
    buffer_load_dwordx4 v[100:103], v72, s[40:43], s99 offen sc1
    s_mov_b64 exec, -1
    s_sub_u32 s60, s60, 1
    s_cbranch_scc1 L_ygt
    s_waitcnt vmcnt(3)
    v_max3_u32 v3, v88, v89, v90
    v_max_u32 v3, v3, v91
    v_cmp_eq_u32 s[4:5], -1, v3
    s_waitcnt vmcnt(2)
    v_max3_u32 v3, v92, v93, v94
    v_max_u32 v3, v3, v95
    v_cmp_eq_u32 s[6:7], -1, v3
    s_waitcnt vmcnt(1)
    v_max3_u32 v3, v96, v97, v98
    v_max_u32 v3, v3, v99
    v_cmp_eq_u32 s[8:9], -1, v3
    s_waitcnt vmcnt(0)
    v_max3_u32 v3, v100, v101, v102
    v_max_u32 v3, v3, v103
    v_cmp_eq_u32 s[10:11], -1, v3
    s_or_b64 s[16:17], s[4:5], s[6:7]
    s_or_b64 s[16:17], s[16:17], s[8:9]
    s_or_b64 s[16:17], s[16:17], s[10:11]
    s_cbranch_scc1 L_yg
L_ygd:
    v_pk_add_f32 v[88:89], v[88:89], v[92:93]
    v_pk_add_f32 v[90:91], v[90:91], v[94:95]
    v_pk_add_f32 v[96:97], v[96:97], v[100:101]
    v_pk_add_f32 v[98:99], v[98:99], v[102:103]
    v_pk_add_f32 v[88:89], v[88:89], v[96:97]
    v_pk_add_f32 v[90:91], v[90:91], v[98:99]
    s_nop 0
    v_permlane32_swap_b32 v88, v89
    v_permlane32_swap_b32 v90, v91
    v_add_f32 v88, v88, v89
    v_add_f32 v90, v90, v91
    s_nop 1
    v_permlane16_swap_b32 v88, v90
    v_add_f32 v88, v88, v90
    s_waitcnt lgkmcnt(0)
    s_nop 0
    v_add_f32_dpp v88, v88, v88 row_ror:8 row_mask:0xf bank_mask:0xf
    v_add_f32 v88, v88, v75
    v_fma_f32 v88, v88, v76, v78
    v_cvt_pk_bf16_f32 v88, v88, v88
    s_mov_b32 exec_lo, 0x00ff00ff
    s_mov_b32 exec_hi, 0x00ff00ff
    buffer_store_short v88, v73, s[52:55], s57 offen
    s_endpgm
L_t2gate:
    s_cmp_ge_u32 s35, 22
    s_cselect_b32 s62, 4, 0
    v_mov_b32 v8, 162088
L_lw_118:
    ds_read_b32 v9, v8
    s_waitcnt lgkmcnt(0)
    v_cmp_gt_u32 vcc, s62, v9
    s_cbranch_vccz L_lw_118e
    s_sleep 2
    s_sub_u32 s60, s60, 1
    s_cbranch_scc0 L_lw_118
    s_mov_b32 s60, 0
L_lw_118e:
    v_mov_b32 v8, 162048
L_lw_119:
    ds_read_b32 v9, v8
    s_waitcnt lgkmcnt(0)
    v_cmp_gt_u32 vcc, 8, v9
    s_cbranch_vccz L_lw_119e
    s_sleep 2
    s_sub_u32 s60, s60, 1
    s_cbranch_scc0 L_lw_119
    s_mov_b32 s60, 0
L_lw_119e:
    ds_read_b32 v9, v8 offset:24
    s_waitcnt lgkmcnt(0)
    v_readfirstlane_b32 s61, v9
    s_mov_b32 s58, 0x3f80
    s_mov_b32 s59, 0x3f800000
    s_mov_b32 s63, 0xff
L_pg:
    s_bitcmp0_b32 s63, 0
    s_cbranch_scc1 L_pgi0
    s_mov_b32 s62, 155648
    buffer_load_dwordx4 v[8:11], v5, s[40:43], s62 offen sc1
L_pgi0:
    s_bitcmp0_b32 s63, 1
    s_cbranch_scc1 L_pgi1
    s_mov_b32 s62, 160768
    buffer_load_dwordx4 v[12:15], v5, s[40:43], s62 offen sc1
L_pgi1:
    s_bitcmp0_b32 s63, 2
    s_cbranch_scc1 L_pgi2
    s_mov_b32 s62, 165888
    buffer_load_dwordx4 v[16:19], v5, s[40:43], s62 offen sc1
L_pgi2:
    s_bitcmp0_b32 s63, 3
    s_cbranch_scc1 L_pgi3
    s_mov_b32 s62, 171008
    buffer_load_dwordx4 v[20:23], v5, s[40:43], s62 offen sc1
L_pgi3:
    s_bitcmp0_b32 s63, 4
    s_cbranch_scc1 L_pgi4
    s_mov_b32 s62, 176128
    buffer_load_dwordx4 v[24:27], v5, s[40:43], s62 offen sc1
L_pgi4:
    s_bitcmp0_b32 s63, 5
    s_cbranch_scc1 L_pgi5
    s_mov_b32 s62, 181248
    buffer_load_dwordx4 v[28:31], v5, s[40:43], s62 offen sc1
L_pgi5:
    s_bitcmp0_b32 s63, 6
    s_cbranch_scc1 L_pgi6
    s_mov_b32 s62, 186368
    buffer_load_dwordx4 v[32:35], v5, s[40:43], s62 offen sc1
L_pgi6:
    s_bitcmp0_b32 s63, 7
    s_cbranch_scc1 L_pgi7
    s_mov_b32 s62, 191488
    buffer_load_dwordx4 v[36:39], v5, s[40:43], s62 offen sc1
L_pgi7:
    s_sub_u32 s60, s60, 1
    s_cselect_b32 s62, 0, -1
    s_cselect_b32 s60, 0, s60
    s_waitcnt vmcnt(0)
    s_bitcmp0_b32 s63, 0
    s_cbranch_scc1 L_pgc0
    v_max3_u32 v3, v8, v9, v10
    v_max_u32 v3, v3, v11
    v_and_b32 v3, s62, v3
    v_cmp_eq_u32 vcc, -1, v3
    s_cbranch_vccnz L_pgc0
    v_dot2c_f32_bf16 v64, s58, v8
    v_dot2c_f32_bf16 v65, s59, v8
    v_dot2c_f32_bf16 v66, s58, v9
    v_dot2c_f32_bf16 v67, s59, v9
    v_dot2c_f32_bf16 v68, s58, v10
    v_dot2c_f32_bf16 v69, s59, v10
    v_dot2c_f32_bf16 v70, s58, v11
    v_dot2c_f32_bf16 v71, s59, v11
    s_bitset0_b32 s63, 0
L_pgc0:
    s_bitcmp0_b32 s63, 1
    s_cbranch_scc1 L_pgc1
    v_max3_u32 v3, v12, v13, v14
    v_max_u32 v3, v3, v15
    v_and_b32 v3, s62, v3
    v_cmp_eq_u32 vcc, -1, v3
    s_cbranch_vccnz L_pgc1
    v_dot2c_f32_bf16 v64, s58, v12
    v_dot2c_f32_bf16 v65, s59, v12
    v_dot2c_f32_bf16 v66, s58, v13
    v_dot2c_f32_bf16 v67, s59, v13
    v_dot2c_f32_bf16 v68, s58, v14
    v_dot2c_f32_bf16 v69, s59, v14
    v_dot2c_f32_bf16 v70, s58, v15
    v_dot2c_f32_bf16 v71, s59, v15
    s_bitset0_b32 s63, 1
L_pgc1:
    s_bitcmp0_b32 s63, 2
    s_cbranch_scc1 L_pgc2
    v_max3_u32 v3, v16, v17, v18
    v_max_u32 v3, v3, v19
    v_and_b32 v3, s62, v3
    v_cmp_eq_u32 vcc, -1, v3
    s_cbranch_vccnz L_pgc2
    v_dot2c_f32_bf16 v64, s58, v16
    v_dot2c_f32_bf16 v65, s59, v16
    v_dot2c_f32_bf16 v66, s58, v17
    v_dot2c_f32_bf16 v67, s59, v17
    v_dot2c_f32_bf16 v68, s58, v18
    v_dot2c_f32_bf16 v69, s59, v18
    v_dot2c_f32_bf16 v70, s58, v19
    v_dot2c_f32_bf16 v71, s59, v19
    s_bitset0_b32 s63, 2
L_pgc2:
    s_bitcmp0_b32 s63, 3
    s_cbranch_scc1 L_pgc3
    v_max3_u32 v3, v20, v21, v22
    v_max_u32 v3, v3, v23
    v_and_b32 v3, s62, v3
    v_cmp_eq_u32 vcc, -1, v3
    s_cbranch_vccnz L_pgc3
    v_dot2c_f32_bf16 v64, s58, v20
    v_dot2c_f32_bf16 v65, s59, v20
    v_dot2c_f32_bf16 v66, s58, v21
    v_dot2c_f32_bf16 v67, s59, v21
    v_dot2c_f32_bf16 v68, s58, v22
    v_dot2c_f32_bf16 v69, s59, v22
    v_dot2c_f32_bf16 v70, s58, v23
    v_dot2c_f32_bf16 v71, s59, v23
    s_bitset0_b32 s63, 3
L_pgc3:
    s_bitcmp0_b32 s63, 4
    s_cbranch_scc1 L_pgc4
    v_max3_u32 v3, v24, v25, v26
    v_max_u32 v3, v3, v27
    v_and_b32 v3, s62, v3
    v_cmp_eq_u32 vcc, -1, v3
    s_cbranch_vccnz L_pgc4
    v_dot2c_f32_bf16 v64, s58, v24
    v_dot2c_f32_bf16 v65, s59, v24
    v_dot2c_f32_bf16 v66, s58, v25
    v_dot2c_f32_bf16 v67, s59, v25
    v_dot2c_f32_bf16 v68, s58, v26
    v_dot2c_f32_bf16 v69, s59, v26
    v_dot2c_f32_bf16 v70, s58, v27
    v_dot2c_f32_bf16 v71, s59, v27
    s_bitset0_b32 s63, 4
L_pgc4:
    s_bitcmp0_b32 s63, 5
    s_cbranch_scc1 L_pgc5
    v_max3_u32 v3, v28, v29, v30
    v_max_u32 v3, v3, v31
    v_and_b32 v3, s62, v3
    v_cmp_eq_u32 vcc, -1, v3
    s_cbranch_vccnz L_pgc5
    v_dot2c_f32_bf16 v64, s58, v28
    v_dot2c_f32_bf16 v65, s59, v28
    v_dot2c_f32_bf16 v66, s58, v29
    v_dot2c_f32_bf16 v67, s59, v29
    v_dot2c_f32_bf16 v68, s58, v30
    v_dot2c_f32_bf16 v69, s59, v30
    v_dot2c_f32_bf16 v70, s58, v31
    v_dot2c_f32_bf16 v71, s59, v31
    s_bitset0_b32 s63, 5
L_pgc5:
    s_bitcmp0_b32 s63, 6
    s_cbranch_scc1 L_pgc6
    v_max3_u32 v3, v32, v33, v34
    v_max_u32 v3, v3, v35
    v_and_b32 v3, s62, v3
    v_cmp_eq_u32 vcc, -1, v3
    s_cbranch_vccnz L_pgc6
    v_dot2c_f32_bf16 v64, s58, v32
    v_dot2c_f32_bf16 v65, s59, v32
    v_dot2c_f32_bf16 v66, s58, v33
    v_dot2c_f32_bf16 v67, s59, v33
    v_dot2c_f32_bf16 v68, s58, v34
    v_dot2c_f32_bf16 v69, s59, v34
    v_dot2c_f32_bf16 v70, s58, v35
    v_dot2c_f32_bf16 v71, s59, v35
    s_bitset0_b32 s63, 6
L_pgc6:
    s_bitcmp0_b32 s63, 7
    s_cbranch_scc1 L_pgc7
    v_max3_u32 v3, v36, v37, v38
    v_max_u32 v3, v3, v39
    v_and_b32 v3, s62, v3
    v_cmp_eq_u32 vcc, -1, v3
    s_cbranch_vccnz L_pgc7
    v_dot2c_f32_bf16 v64, s58, v36
    v_dot2c_f32_bf16 v65, s59, v36
    v_dot2c_f32_bf16 v66, s58, v37
    v_dot2c_f32_bf16 v67, s59, v37
    v_dot2c_f32_bf16 v68, s58, v38
    v_dot2c_f32_bf16 v69, s59, v38
    v_dot2c_f32_bf16 v70, s58, v39
    v_dot2c_f32_bf16 v71, s59, v39
    s_bitset0_b32 s63, 7
L_pgc7:
    s_bcnt1_i32_b32 s62, s63
    s_cbranch_scc0 L_pgd
    s_cmp_gt_u32 s62, 3
    s_cbranch_scc1 L_pg
    s_ff1_i32_b32 s96, s63
    s_bitset0_b32 s63, s96
    s_mul_i32 s96, s96, 5120
    s_add_u32 s96, s96, 155648
    s_cmp_eq_u32 s62, 1
    s_cbranch_scc1 L_pt1
    s_ff1_i32_b32 s97, s63
    s_bitset0_b32 s63, s97
    s_mul_i32 s97, s97, 5120
    s_add_u32 s97, s97, 155648
    s_cmp_eq_u32 s62, 2
    s_cbranch_scc1 L_pt2
    s_ff1_i32_b32 s98, s63
    s_bitset0_b32 s63, s98
    s_mul_i32 s98, s98, 5120
    s_add_u32 s98, s98, 155648
L_pt3:
L_poll_120:
    buffer_load_dwordx4 v[16:19], v5, s[40:43], s96 offen sc1
    buffer_load_dwordx4 v[20:23], v5, s[40:43], s97 offen sc1
    buffer_load_dwordx4 v[24:27], v5, s[40:43], s98 offen sc1
    s_sub_u32 s60, s60, 1
    s_cbranch_scc1 L_poll_120t
    s_waitcnt vmcnt(0)
    v_max3_u32 v3, v16, v17, v18
    v_max3_u32 v3, v3, v19, v20
    v_max3_u32 v3, v3, v21, v22
    v_max3_u32 v3, v3, v23, v24
    v_max3_u32 v3, v3, v25, v26
    v_max_u32 v3, v3, v27
    v_cmp_eq_u32 vcc, -1, v3
    s_cbranch_vccnz L_poll_120
L_poll_120e:
    v_dot2c_f32_bf16 v64, s58, v16
    v_dot2c_f32_bf16 v65, s59, v16
    v_dot2c_f32_bf16 v66, s58, v17
    v_dot2c_f32_bf16 v67, s59, v17
    v_dot2c_f32_bf16 v68, s58, v18
    v_dot2c_f32_bf16 v69, s59, v18
    v_dot2c_f32_bf16 v70, s58, v19
    v_dot2c_f32_bf16 v71, s59, v19
    v_dot2c_f32_bf16 v64, s58, v20
    v_dot2c_f32_bf16 v65, s59, v20
    v_dot2c_f32_bf16 v66, s58, v21
    v_dot2c_f32_bf16 v67, s59, v21
    v_dot2c_f32_bf16 v68, s58, v22
    v_dot2c_f32_bf16 v69, s59, v22
    v_dot2c_f32_bf16 v70, s58, v23
    v_dot2c_f32_bf16 v71, s59, v23
    v_dot2c_f32_bf16 v64, s58, v24
    v_dot2c_f32_bf16 v65, s59, v24
    v_dot2c_f32_bf16 v66, s58, v25
    v_dot2c_f32_bf16 v67, s59, v25
    v_dot2c_f32_bf16 v68, s58, v26
    v_dot2c_f32_bf16 v69, s59, v26
    v_dot2c_f32_bf16 v70, s58, v27
    v_dot2c_f32_bf16 v71, s59, v27
    s_branch L_pgd
L_pt2:
L_poll_121:
    buffer_load_dwordx4 v[16:19], v5, s[40:43], s96 offen sc1
    buffer_load_dwordx4 v[20:23], v5, s[40:43], s97 offen sc1
    s_sub_u32 s60, s60, 1
    s_cbranch_scc1 L_poll_121t
    s_waitcnt vmcnt(0)
    v_max3_u32 v3, v16, v17, v18
    v_max3_u32 v3, v3, v19, v20
    v_max3_u32 v3, v3, v21, v22
    v_max_u32 v3, v3, v23
    v_cmp_eq_u32 vcc, -1, v3
    s_cbranch_vccnz L_poll_121
L_poll_121e:
    v_dot2c_f32_bf16 v64, s58, v16
    v_dot2c_f32_bf16 v65, s59, v16
    v_dot2c_f32_bf16 v66, s58, v17
    v_dot2c_f32_bf16 v67, s59, v17
    v_dot2c_f32_bf16 v68, s58, v18
    v_dot2c_f32_bf16 v69, s59, v18
    v_dot2c_f32_bf16 v70, s58, v19
    v_dot2c_f32_bf16 v71, s59, v19
    v_dot2c_f32_bf16 v64, s58, v20
    v_dot2c_f32_bf16 v65, s59, v20
    v_dot2c_f32_bf16 v66, s58, v21
    v_dot2c_f32_bf16 v67, s59, v21
    v_dot2c_f32_bf16 v68, s58, v22
    v_dot2c_f32_bf16 v69, s59, v22
    v_dot2c_f32_bf16 v70, s58, v23
    v_dot2c_f32_bf16 v71, s59, v23
    s_branch L_pgd
L_pt1:
L_poll_122:
    buffer_load_dwordx4 v[16:19], v5, s[40:43], s96 offen sc1
    s_sub_u32 s60, s60, 1
    s_cbranch_scc1 L_poll_122t
    s_waitcnt vmcnt(0)
    v_max3_u32 v3, v16, v17, v18
    v_max_u32 v3, v3, v19
    v_cmp_eq_u32 vcc, -1, v3
    s_cbranch_vccnz L_poll_122
L_poll_122e:
    v_dot2c_f32_bf16 v64, s58, v16
    v_dot2c_f32_bf16 v65, s59, v16
    v_dot2c_f32_bf16 v66, s58, v17
    v_dot2c_f32_bf16 v67, s59, v17
    v_dot2c_f32_bf16 v68, s58, v18
    v_dot2c_f32_bf16 v69, s59, v18
    v_dot2c_f32_bf16 v70, s58, v19
    v_dot2c_f32_bf16 v71, s59, v19
L_pgd:
    v_pk_fma_f32 v[64:65], v[64:65], v[48:49], v[40:41]
    v_pk_fma_f32 v[66:67], v[66:67], v[50:51], v[42:43]
    v_pk_fma_f32 v[68:69], v[68:69], v[52:53], v[44:45]
    v_pk_fma_f32 v[70:71], v[70:71], v[54:55], v[46:47]
    v_pk_mul_f32 v[56:57], v[64:65], v[56:57]
    v_pk_mul_f32 v[58:59], v[66:67], v[58:59]
    v_pk_mul_f32 v[60:61], v[68:69], v[60:61]
    v_pk_mul_f32 v[62:63], v[70:71], v[62:63]
    v_cvt_pk_bf16_f32 v8, v56, v57
    v_cvt_pk_bf16_f32 v9, v58, v59
    v_cvt_pk_bf16_f32 v10, v60, v61
    v_cvt_pk_bf16_f32 v11, v62, v63
    ds_write_b128 v4, v[8:11]
    v_pk_add_f32 v[40:41], v[64:65], v[66:67]
    v_pk_add_f32 v[42:43], v[68:69], v[70:71]
    v_pk_mul_f32 v[44:45], v[64:65], v[64:65]
    v_pk_mul_f32 v[46:47], v[66:67], v[66:67]
    v_pk_add_f32 v[40:41], v[40:41], v[42:43]
    v_pk_fma_f32 v[44:45], v[68:69], v[68:69], v[44:45]
    v_pk_fma_f32 v[46:47], v[70:71], v[70:71], v[46:47]
    s_waitcnt lgkmcnt(0)
    s_barrier
    v_add_f32 v8, v40, v41
    v_pk_add_f32 v[44:45], v[44:45], v[46:47]
    v_add_f32 v9, v44, v45
    v_add_f32_dpp v8, v8, v8 quad_perm:[1,0,3,2] row_mask:0xf bank_mask:0xf
    s_nop 0
    v_add_f32_dpp v9, v9, v9 quad_perm:[1,0,3,2] row_mask:0xf bank_mask:0xf
    v_add_f32_dpp v8, v8, v8 quad_perm:[2,3,0,1] row_mask:0xf bank_mask:0xf
    s_nop 0
    v_add_f32_dpp v9, v9, v9 quad_perm:[2,3,0,1] row_mask:0xf bank_mask:0xf
    v_add_f32_dpp v8, v8, v8 row_ror:4 row_mask:0xf bank_mask:0xf
    s_nop 0
    v_add_f32_dpp v9, v9, v9 row_ror:4 row_mask:0xf bank_mask:0xf
    v_add_f32_dpp v8, v8, v8 row_ror:8 row_mask:0xf bank_mask:0xf
    s_nop 0
    v_add_f32_dpp v9, v9, v9 row_ror:8 row_mask:0xf bank_mask:0xf
    ds_write_b64 v7, v[8:9]
    s_waitcnt lgkmcnt(0)
    s_barrier
    ds_write_b128 v6, v[64:67]
    ds_write_b128 v6, v[68:71] offset:16
    s_waitcnt vmcnt(0) lgkmcnt(0)
    s_cmp_lg_u32 s3, 7
    s_cbranch_scc1 L_ffn2
    s_endpgm
L_ffn1:
    s_barrier
    ds_read_b128 v[8:11], v79 offset:0
    ds_read_b128 v[12:15], v79 offset:256
    ds_read_b128 v[16:19], v79 offset:512
    ds_read_b128 v[20:23], v79 offset:768
    ds_read_b128 v[24:27], v79 offset:1024
    s_waitcnt vmcnt(0)
    v_lshlrev_b32 v82, 16, v82
    v_add_f32 v85, v85, v82
    s_waitcnt lgkmcnt(4)
    v_mfma_f32_16x16x32_bf16 v[32:35], v[88:91], v[8:11], 0
    v_mfma_f32_16x16x32_bf16 v[36:39], v[92:95], v[8:11], 0
    v_mfma_f32_16x16x32_bf16 v[40:43], v[96:99], v[8:11], 0
    v_mfma_f32_16x16x32_bf16 v[44:47], v[100:103], v[8:11], 0
    s_waitcnt lgkmcnt(3)
    v_mfma_f32_16x16x32_bf16 v[32:35], v[104:107], v[12:15], v[32:35]
    v_mfma_f32_16x16x32_bf16 v[36:39], v[108:111], v[12:15], v[36:39]
    v_mfma_f32_16x16x32_bf16 v[40:43], v[112:115], v[12:15], v[40:43]
    v_mfma_f32_16x16x32_bf16 v[44:47], v[116:119], v[12:15], v[44:47]
    s_waitcnt lgkmcnt(2)
    v_mfma_f32_16x16x32_bf16 v[32:35], v[120:123], v[16:19], v[32:35]
    v_mfma_f32_16x16x32_bf16 v[36:39], v[124:127], v[16:19], v[36:39]
    v_mfma_f32_16x16x32_bf16 v[40:43], v[128:131], v[16:19], v[40:43]
    v_mfma_f32_16x16x32_bf16 v[44:47], v[132:135], v[16:19], v[44:47]
    s_waitcnt lgkmcnt(1)
    s_barrier
    ds_read_b128 v[48:51], v81
    ds_read_b128 v[52:55], v81 offset:16
    ds_read_b64 v[56:57], v81 offset:32
    v_mfma_f32_16x16x32_bf16 v[32:35], v[136:139], v[20:23], v[32:35]
    v_mfma_f32_16x16x32_bf16 v[36:39], v[140:143], v[20:23], v[36:39]
    v_mfma_f32_16x16x32_bf16 v[40:43], v[144:147], v[20:23], v[40:43]
    v_mfma_f32_16x16x32_bf16 v[44:47], v[148:151], v[20:23], v[44:47]
    s_waitcnt lgkmcnt(3)
    v_mfma_f32_16x16x32_bf16 v[32:35], v[152:155], v[24:27], v[32:35]
    v_mfma_f32_16x16x32_bf16 v[36:39], v[156:159], v[24:27], v[36:39]
    s_waitcnt lgkmcnt(0)
    v_pk_add_f32 v[48:49], v[48:49], v[50:51]
    v_pk_add_f32 v[52:53], v[52:53], v[54:55]
    v_mfma_f32_16x16x32_bf16 v[40:43], v[160:163], v[24:27], v[40:43]
    v_pk_add_f32 v[48:49], v[48:49], v[56:57]
    v_pk_add_f32 v[48:49], v[48:49], v[52:53]
    v_mfma_f32_16x16x32_bf16 v[44:47], v[164:167], v[24:27], v[44:47]
    v_mul_f32 v48, s62, v48
    v_mul_f32 v49, s62, v49
    v_mul_f32 v7, v84, v48
    v_fma_f32 v49, -v48, v48, -v49
    v_max_f32 v49, 0, v49
    v_add_f32 v49, 0x3727c5ac, v49
    v_rsq_f32 v49, v49
    v_add_f32_dpp v5, v36, v7 row_ror:12 row_mask:0xf bank_mask:0x1
    v_add_f32_dpp v5, v41, v7 row_ror:12 row_mask:0xf bank_mask:0x2
    v_add_f32_dpp v5, v46, v7 row_ror:12 row_mask:0xf bank_mask:0x4
    v_add_f32_dpp v5, v35, v7 row_ror:12 row_mask:0xf bank_mask:0x8
    v_add_f32_dpp v4, v40, v32 row_ror:8 row_mask:0xf bank_mask:0x1
    v_add_f32_dpp v4, v45, v37 row_ror:8 row_mask:0xf bank_mask:0x2
    v_add_f32_dpp v4, v34, v42 row_ror:8 row_mask:0xf bank_mask:0x4
    v_add_f32_dpp v4, v39, v47 row_ror:8 row_mask:0xf bank_mask:0x8
    v_add_f32_dpp v6, v44, v5 row_ror:4 row_mask:0xf bank_mask:0x1
    v_add_f32_dpp v6, v33, v5 row_ror:4 row_mask:0xf bank_mask:0x2
    v_add_f32_dpp v6, v38, v5 row_ror:4 row_mask:0xf bank_mask:0x4
    v_add_f32_dpp v6, v43, v5 row_ror:4 row_mask:0xf bank_mask:0x8
    v_add_f32 v4, v4, v6
    v_fma_f32 v4, v4, v49, v85
    v_mul_f32 v5, v4, v4
    v_fma_f32 v5, v5, s63, v86
    v_mul_f32 v5, v5, v4
    v_exp_f32 v5, v5
    s_nop 0
    v_add_f32 v5, 1.0, v5
    v_rcp_f32 v5, v5
    s_nop 0
    v_mul_f32 v4, v4, v5
    v_cvt_pk_bf16_f32 v4, v4, v4
    ds_write_b16 v80, v4
    s_waitcnt lgkmcnt(0)
    s_barrier
    s_endpgm
L_h_t1:
    s_cmp_lg_u32 s3, 3
    s_cbranch_scc1 L_h_noclr
    s_sub_u32 s62, s56, 154
    s_cmp_lt_u32 s62, 30
    s_cbranch_scc0 L_h_noclr
    s_lshl_b32 s63, s62, 2
    s_mul_i32 s62, s62, 7168
    s_add_u32 s62, s62, 20480
    v_mov_b32 v4, -1
    v_mov_b32 v5, -1
    v_mov_b32 v6, -1
    v_mov_b32 v7, -1
    v_lshlrev_b32 v8, 4, v0
    buffer_store_dwordx4 v[4:7], v8, s[40:43], s62 offen offset:0 sc1
    buffer_store_dwordx4 v[4:7], v8, s[40:43], s62 offen offset:1024 sc1
    buffer_store_dwordx4 v[4:7], v8, s[40:43], s62 offen offset:2048 sc1
    buffer_store_dwordx4 v[4:7], v8, s[40:43], s62 offen offset:3072 sc1
    s_add_u32 s62, s62, 4096
    buffer_store_dwordx4 v[4:7], v8, s[40:43], s62 offen offset:0 sc1
    buffer_store_dwordx4 v[4:7], v8, s[40:43], s62 offen offset:1024 sc1
    buffer_store_dwordx4 v[4:7], v8, s[40:43], s62 offen offset:2048 sc1
    v_mov_b32 v8, s63
    s_waitcnt vmcnt(0)
    s_mov_b64 exec, 1
    buffer_store_dword v4, v8, s[44:47], 0 offen sc1
    s_mov_b64 exec, -1
L_h_noclr:
    v_lshrrev_b32 v1, 3, v0
    v_mul_u32_u24 v1, 1280, v1
    v_and_b32 v2, 7, v0
    v_lshl_add_u32 v1, v2, 4, v1
    s_lshl2_add_u32 s63, s34, s3
    s_mul_i32 s63, s63, 163840
    s_lshl_b32 s62, s35, 7
    s_add_u32 s63, s63, s62
    s_sub_u32 s63, s63, 2816
    s_lshl_b32 s62, s3, 14
    s_add_u32 s62, s62, 81920
    s_mov_b32 m0, s62
    s_mov_b32 s48, s12
    s_mov_b32 s49, s13
    s_mov_b32 s50, 5242880
    s_mov_b32 s51, 0x20000
    s_add_u32 s100, s39, 1
    s_mov_b32 s62, 8
L_dma_5:
    buffer_load_dwordx4 v1, s[48:51], s63 offen nt lds
    s_add_u32 m0, m0, 1024
    s_add_u32 s63, s63, 10240
    s_cmp_eq_u32 s100, 0
    s_cbranch_scc1 L_dma_5n0
    s_waitcnt vmcnt(7)
    s_cmp_eq_u32 s100, 2
    s_cbranch_scc1 L_dma_5n0
    s_waitcnt vmcnt(3)
L_dma_5n0:
    buffer_load_dwordx4 v1, s[48:51], s63 offen nt lds
    s_add_u32 m0, m0, 1024
    s_add_u32 s63, s63, 10240
    s_cmp_eq_u32 s100, 0
    s_cbranch_scc1 L_dma_5n1
    s_waitcnt vmcnt(7)
    s_cmp_eq_u32 s100, 2
    s_cbranch_scc1 L_dma_5n1
    s_waitcnt vmcnt(3)
L_dma_5n1:
    s_sub_u32 s62, s62, 1
    s_cmp_lg_u32 s62, 0
    s_cbranch_scc1 L_dma_5
    s_cmp_eq_u32 s39, 1
    s_cbranch_scc1 L_h_role
    s_waitcnt vmcnt(0)
    v_mov_b32 v4, 162060
    v_mov_b32 v5, 1
    s_mov_b64 exec, 1
    ds_add_u32 v4, v5
    s_mov_b64 exec, -1
    s_cmp_eq_u32 s3, 0
    s_cbranch_scc1 L_service
    s_endpgm
L_h_role:
    v_lshrrev_b32 v3, 4, v0
    v_and_b32 v2, 3, v0
    v_bfe_u32 v1, v0, 2, 2
    v_mul_u32_u24 v160, 2560, v2
    v_lshl_add_u32 v160, v1, 6, v160
    v_lshl_add_u32 v160, v3, 4, v160
    s_mul_i32 s57, s35, 10240
    s_mul_i32 s62, s3, 640
    s_add_u32 s57, s57, s62
    s_add_u32 s57, s57, 262144
    v_mov_b32 v4, -1
    v_mov_b32 v5, -1
    v_mov_b32 v6, -1
    v_mov_b32 v7, -1
    buffer_store_dwordx4 v[4:7], v160, s[40:43], s57 offen sc1
    buffer_store_dwordx4 v[4:7], v160, s[40:43], s57 offen offset:256 sc1
    s_mov_b32 exec_lo, 0x00ff00ff
    s_mov_b32 exec_hi, 0x00ff00ff
    buffer_store_dwordx4 v[4:7], v160, s[40:43], s57 offen offset:512 sc1
    s_mov_b64 exec, -1
    v_add_u32 v8, 0, v0
    v_mul_u32_u24 v10, 0xccd, v8
    v_lshrrev_b32 v10, 16, v10
    v_mul_u32_u24 v9, 20, v10
    v_sub_u32 v8, v8, v9
    v_mul_u32_u24 v10, 1280, v10
    v_lshl_add_u32 v10, v8, 4, v10
    v_add_u32 v8, 64, v0
    v_mul_u32_u24 v11, 0xccd, v8
    v_lshrrev_b32 v11, 16, v11
    v_mul_u32_u24 v9, 20, v11
    v_sub_u32 v8, v8, v9
    v_mul_u32_u24 v11, 1280, v11
    v_lshl_add_u32 v11, v8, 4, v11
    v_add_u32 v8, 128, v0
    v_mul_u32_u24 v12, 0xccd, v8
    v_lshrrev_b32 v12, 16, v12
    v_mul_u32_u24 v9, 20, v12
    v_sub_u32 v8, v8, v9
    v_mul_u32_u24 v12, 1280, v12
    v_lshl_add_u32 v12, v8, 4, v12
    v_add_u32 v8, 192, v0
    v_mul_u32_u24 v13, 0xccd, v8
    v_lshrrev_b32 v13, 16, v13
    v_mul_u32_u24 v9, 20, v13
    v_sub_u32 v8, v8, v9
    v_mul_u32_u24 v13, 1280, v13
    v_lshl_add_u32 v13, v8, 4, v13
    v_add_u32 v8, 256, v0
    v_mul_u32_u24 v14, 0xccd, v8
    v_lshrrev_b32 v14, 16, v14
    v_mul_u32_u24 v9, 20, v14
    v_sub_u32 v8, v8, v9
    v_mul_u32_u24 v14, 1280, v14
    v_lshl_add_u32 v14, v8, 4, v14
    s_waitcnt vmcnt(0)
    v_mov_b32 v8, 162060
    v_mov_b32 v9, 1
    s_mov_b64 exec, 1
    ds_add_u32 v8, v9
    s_mov_b64 exec, -1
    s_mov_b32 s48, s20
    s_mov_b32 s49, s21
    s_mov_b32 s50, 2211840
    s_mov_b32 s51, 0x20000
    s_mul_i32 s63, s35, 81920
    s_mul_i32 s62, s3, 320
    s_add_u32 s63, s63, s62
    s_mov_b32 m0, s101
    s_mov_b32 s62, 4
L_w2dma:
    buffer_load_dwordx4 v10, s[48:51], s63 offen nt lds
    s_add_u32 m0, m0, 1024
    s_waitcnt vmcnt(7)
    s_cmp_ge_u32 s35, 22
    s_cbranch_scc1 L_w2n0
    s_waitcnt vmcnt(7)
L_w2n0:
    buffer_load_dwordx4 v11, s[48:51], s63 offen nt lds
    s_add_u32 m0, m0, 1024
    s_waitcnt vmcnt(7)
    s_cmp_ge_u32 s35, 22
    s_cbranch_scc1 L_w2n1
    s_waitcnt vmcnt(7)
L_w2n1:
    buffer_load_dwordx4 v12, s[48:51], s63 offen nt lds
    s_add_u32 m0, m0, 1024
    s_waitcnt vmcnt(7)
    s_cmp_ge_u32 s35, 22
    s_cbranch_scc1 L_w2n2
    s_waitcnt vmcnt(7)
L_w2n2:
    buffer_load_dwordx4 v13, s[48:51], s63 offen nt lds
    s_add_u32 m0, m0, 1024
    s_waitcnt vmcnt(7)
    s_cmp_ge_u32 s35, 22
    s_cbranch_scc1 L_w2n3
    s_waitcnt vmcnt(7)
L_w2n3:
    buffer_load_dwordx4 v14, s[48:51], s63 offen nt lds
    s_add_u32 m0, m0, 1024
    s_waitcnt vmcnt(7)
    s_cmp_ge_u32 s35, 22
    s_cbranch_scc1 L_w2n4
    s_waitcnt vmcnt(7)
L_w2n4:
    s_add_u32 s63, s63, 20480
    s_sub_u32 s62, s62, 1
    s_cmp_lg_u32 s62, 0
    s_cbranch_scc1 L_w2dma
    v_lshl_add_u32 v8, v3, 3, v1
    v_mul_u32_u24 v8, 320, v8
    v_lshl_add_u32 v8, v2, 3, v8
    v_add_u32 v8, s101, v8
    s_waitcnt vmcnt(0)
    ds_read_b64_tr_b16 v[80:81], v8 offset:0
    ds_read_b64_tr_b16 v[82:83], v8 offset:1280
    ds_read_b64_tr_b16 v[84:85], v8 offset:10240
    ds_read_b64_tr_b16 v[86:87], v8 offset:11520
    ds_read_b64_tr_b16 v[88:89], v8 offset:32
    ds_read_b64_tr_b16 v[90:91], v8 offset:1312
    ds_read_b64_tr_b16 v[92:93], v8 offset:10272
    ds_read_b64_tr_b16 v[94:95], v8 offset:11552
    ds_read_b64_tr_b16 v[96:97], v8 offset:64
    ds_read_b64_tr_b16 v[98:99], v8 offset:1344
    ds_read_b64_tr_b16 v[100:101], v8 offset:10304
    ds_read_b64_tr_b16 v[102:103], v8 offset:11584
    ds_read_b64_tr_b16 v[104:105], v8 offset:96
    ds_read_b64_tr_b16 v[106:107], v8 offset:1376
    ds_read_b64_tr_b16 v[108:109], v8 offset:10336
    ds_read_b64_tr_b16 v[110:111], v8 offset:11616
    ds_read_b64_tr_b16 v[112:113], v8 offset:128
    ds_read_b64_tr_b16 v[114:115], v8 offset:1408
    ds_read_b64_tr_b16 v[116:117], v8 offset:10368
    ds_read_b64_tr_b16 v[118:119], v8 offset:11648
    ds_read_b64_tr_b16 v[120:121], v8 offset:160
    ds_read_b64_tr_b16 v[122:123], v8 offset:1440
    ds_read_b64_tr_b16 v[124:125], v8 offset:10400
    ds_read_b64_tr_b16 v[126:127], v8 offset:11680
    ds_read_b64_tr_b16 v[128:129], v8 offset:192
    ds_read_b64_tr_b16 v[130:131], v8 offset:1472
    ds_read_b64_tr_b16 v[132:133], v8 offset:10432
    ds_read_b64_tr_b16 v[134:135], v8 offset:11712
    ds_read_b64_tr_b16 v[136:137], v8 offset:224
    ds_read_b64_tr_b16 v[138:139], v8 offset:1504
    ds_read_b64_tr_b16 v[140:141], v8 offset:10464
    ds_read_b64_tr_b16 v[142:143], v8 offset:11744
    ds_read_b64_tr_b16 v[144:145], v8 offset:256
    ds_read_b64_tr_b16 v[146:147], v8 offset:1536
    ds_read_b64_tr_b16 v[148:149], v8 offset:10496
    ds_read_b64_tr_b16 v[150:151], v8 offset:11776
    ds_read_b64_tr_b16 v[152:153], v8 offset:288
    ds_read_b64_tr_b16 v[154:155], v8 offset:1568
    ds_read_b64_tr_b16 v[156:157], v8 offset:10528
    ds_read_b64_tr_b16 v[158:159], v8 offset:11808
    s_mov_b32 s48, s16
    s_mov_b32 s49, s17
    s_mov_b32 s50, 2211840
    s_mov_b32 s51, 0x20000
    s_lshl_b32 s98, s35, 7
    s_mov_b32 s99, 3456
    v_lshrrev_b32 v9, 3, v0
    v_mul_lo_u32 v10, v9, s99
    v_and_b32 v9, 2, v9
    v_xor_b32 v9, v9, v0
    v_and_b32 v9, 7, v9
    v_lshl_add_u32 v10, v9, 4, v10
    v_add_u32 v10, s98, v10
    v_xor_b32 v11, 64, v10
    s_mul_i32 s63, s3, 552960
    s_mov_b32 m0, s101
    s_waitcnt lgkmcnt(0)
    s_cmp_ge_u32 s35, 22
    s_cselect_b32 s100, 2, 1
    s_mov_b32 s62, 10
L_dma_6:
    buffer_load_dwordx4 v10, s[48:51], s63 offen nt lds
    s_add_u32 m0, m0, 1024
    s_add_u32 s63, s63, 27648
    s_cmp_eq_u32 s100, 0
    s_cbranch_scc1 L_dma_6n0
    s_waitcnt vmcnt(7)
    s_cmp_eq_u32 s100, 2
    s_cbranch_scc1 L_dma_6n0
    s_waitcnt vmcnt(7)
L_dma_6n0:
    buffer_load_dwordx4 v11, s[48:51], s63 offen nt lds
    s_add_u32 m0, m0, 1024
    s_add_u32 s63, s63, 27648
    s_cmp_eq_u32 s100, 0
    s_cbranch_scc1 L_dma_6n1
    s_waitcnt vmcnt(7)
    s_cmp_eq_u32 s100, 2
    s_cbranch_scc1 L_dma_6n1
    s_waitcnt vmcnt(7)
L_dma_6n1:
    s_sub_u32 s62, s62, 1
    s_cmp_lg_u32 s62, 0
    s_cbranch_scc1 L_dma_6
    v_mov_b32 v8, 162068
L_lw_7:
    ds_read_b32 v9, v8
    s_waitcnt lgkmcnt(0)
    v_cmp_gt_u32 vcc, 1, v9
    s_cbranch_vccz L_lw_7e
    s_sleep 8
    s_sub_u32 s60, s60, 1
    s_cbranch_scc0 L_lw_7
    s_mov_b32 s60, 0
L_lw_7e:
    s_cmp_lg_u32 s3, 3
    s_cbranch_scc1 L_h_nomo
    v_and_b32 v4, 15, v0
    v_lshlrev_b32 v4, 4, v4
    v_mul_u32_u24 v5, 1280, v3
    v_add_u32 v5, v5, v4
    v_mul_u32_u24 v6, 1296, v3
    v_add_u32 v6, v6, v4
    v_add_u32 v6, 147456, v6
    s_mov_b32 s62, 30720
    s_mov_b32 s63, 25600
    s_branch L_poll_8
L_poll_8s:
    s_sleep 8
L_poll_8:
    buffer_load_dwordx4 v[40:43], v5, s[40:43], s62 offen offset:0 sc1
    buffer_load_dwordx4 v[44:47], v5, s[40:43], s62 offen offset:256 sc1
    buffer_load_dwordx4 v[48:51], v5, s[40:43], s62 offen offset:512 sc1
    buffer_load_dwordx4 v[52:55], v5, s[40:43], s62 offen offset:768 sc1
    buffer_load_dwordx4 v[56:59], v5, s[40:43], s62 offen offset:1024 sc1
    buffer_load_dwordx4 v[60:63], v5, s[40:43], s63 offen offset:0 sc1
    buffer_load_dwordx4 v[64:67], v5, s[40:43], s63 offen offset:256 sc1
    buffer_load_dwordx4 v[68:71], v5, s[40:43], s63 offen offset:512 sc1
    buffer_load_dwordx4 v[72:75], v5, s[40:43], s63 offen offset:768 sc1
    buffer_load_dwordx4 v[76:79], v5, s[40:43], s63 offen offset:1024 sc1
    s_sub_u32 s60, s60, 1
    s_cbranch_scc1 L_poll_8t
    s_waitcnt vmcnt(0)
    v_max3_u32 v7, v40, v41, v42
    v_max3_u32 v7, v7, v43, v44
    v_max3_u32 v7, v7, v45, v46
    v_max3_u32 v7, v7, v47, v48
    v_max3_u32 v7, v7, v49, v50
    v_max3_u32 v7, v7, v51, v52
    v_max3_u32 v7, v7, v53, v54
    v_max3_u32 v7, v7, v55, v56
    v_max3_u32 v7, v7, v57, v58
    v_max3_u32 v7, v7, v59, v60
    v_max3_u32 v7, v7, v61, v62
    v_max3_u32 v7, v7, v63, v64
    v_max3_u32 v7, v7, v65, v66
    v_max3_u32 v7, v7, v67, v68
    v_max3_u32 v7, v7, v69, v70
    v_max3_u32 v7, v7, v71, v72
    v_max3_u32 v7, v7, v73, v74
    v_max3_u32 v7, v7, v75, v76
    v_max3_u32 v7, v7, v77, v78
    v_max_u32 v7, v7, v79
    v_cmp_eq_u32 vcc, -1, v7
    s_cbranch_vccnz L_poll_8s
L_poll_8e:
    ds_write_b128 v6, v[40:43] offset:0
    ds_write_b128 v6, v[44:47] offset:256
    ds_write_b128 v6, v[48:51] offset:512
    ds_write_b128 v6, v[52:55] offset:768
    ds_write_b128 v6, v[56:59] offset:1024
    ds_write_b128 v6, v[60:63] offset:5184
    ds_write_b128 v6, v[64:67] offset:5440
    ds_write_b128 v6, v[68:71] offset:5696
    ds_write_b128 v6, v[72:75] offset:5952
    ds_write_b128 v6, v[76:79] offset:6208
L_h_nomo:
    v_mul_u32_u24 v4, 144, v2
    v_lshl_add_u32 v4, v3, 4, v4
    v_add_u32 v161, 97600, v4
    s_mov_b32 s100, s3
    s_lshl_b32 s63, s100, 8
    v_and_b32 v8, 15, v0
    v_lshl_add_u32 v8, v8, 4, s63
    v_lshrrev_b32 v9, 4, v0
    v_mul_u32_u24 v5, 1280, v9
    v_add_u32 v5, v5, v8
    v_mul_u32_u24 v4, 1296, v9
    v_add_u32 v4, v4, v8
    v_add_u32 v4, 81920, v4
    v_lshlrev_b32 v6, 1, v5
    v_add_u32 v6, 87104, v6
    s_lshl_b32 s62, s100, 3
    s_add_u32 s62, s62, 97344
    v_lshl_add_u32 v7, v9, 6, s62
    s_mov_b32 s48, s4
    s_mov_b32 s49, s5
    s_mov_b32 s50, 5120
    s_mov_b32 s51, 0x20000
    buffer_load_dwordx4 v[8:11], v5, s[48:51], 0 offen
    s_mov_b32 s62, 20480
    s_mov_b32 s63, 30720
    s_branch L_poll_9
L_poll_9s:
    s_sleep 8
L_poll_9:
    buffer_load_dwordx4 v[12:15], v5, s[40:43], s62 offen sc1
    buffer_load_dwordx4 v[16:19], v5, s[40:43], s63 offen sc1
    s_sub_u32 s60, s60, 1
    s_cbranch_scc1 L_poll_9t
    s_waitcnt vmcnt(0)
    v_max3_u32 v38, v12, v13, v14
    v_max3_u32 v38, v38, v15, v16
    v_max3_u32 v38, v38, v17, v18
    v_max_u32 v38, v38, v19
    v_cmp_eq_u32 vcc, -1, v38
    s_cbranch_vccnz L_poll_9s
L_poll_9e:
    v_lshlrev_b32 v40, 16, v8
    v_and_b32 v41, 0xffff0000, v8
    v_lshlrev_b32 v42, 16, v9
    v_and_b32 v43, 0xffff0000, v9
    v_lshlrev_b32 v44, 16, v10
    v_and_b32 v45, 0xffff0000, v10
    v_lshlrev_b32 v46, 16, v11
    v_and_b32 v47, 0xffff0000, v11
    v_lshlrev_b32 v48, 16, v12
    v_and_b32 v49, 0xffff0000, v12
    v_lshlrev_b32 v50, 16, v13
    v_and_b32 v51, 0xffff0000, v13
    v_lshlrev_b32 v52, 16, v14
    v_and_b32 v53, 0xffff0000, v14
    v_lshlrev_b32 v54, 16, v15
    v_and_b32 v55, 0xffff0000, v15
    v_lshlrev_b32 v56, 16, v16
    v_and_b32 v57, 0xffff0000, v16
    v_lshlrev_b32 v58, 16, v17
    v_and_b32 v59, 0xffff0000, v17
    v_lshlrev_b32 v60, 16, v18
    v_and_b32 v61, 0xffff0000, v18
    v_lshlrev_b32 v62, 16, v19
    v_and_b32 v63, 0xffff0000, v19
    v_mov_b32 v64, 0
    v_mov_b32 v65, 0
    v_mov_b32 v66, 0
    v_mov_b32 v67, 0
    v_mov_b32 v68, 0
    v_mov_b32 v69, 0
    v_mov_b32 v70, 0
    v_mov_b32 v71, 0
    v_bfe_u32 v5, v0, 2, 2
    v_lshlrev_b32 v5, 8, v5
    v_lshrrev_b32 v8, 4, v0
    v_lshl_add_u32 v5, v8, 6, v5
    v_and_b32 v8, 3, v0
    v_lshl_add_u32 v5, v8, 4, v5
    s_lshl_b32 s63, s100, 10
    v_add_u32 v5, s63, v5
    s_waitcnt vmcnt(0) lgkmcnt(0)
    v_mov_b32 v8, 162064
    v_mov_b32 v9, 1
    s_mov_b64 exec, 1
    ds_add_u32 v8, v9
    s_mov_b64 exec, -1
    s_branch L_t2gate
L_ffn2:
    s_barrier
    ds_read_b128 v[8:11], v161
    ds_read_b128 v[12:15], v161 offset:64
    s_cmp_eq_u32 s61, 1
    s_cbranch_scc0 L_f2slow
    s_waitcnt lgkmcnt(1)
    v_mfma_f32_16x16x32_bf16 v[16:19], v[80:83], v[8:11], 0
    v_mfma_f32_16x16x32_bf16 v[20:23], v[88:91], v[8:11], 0
    v_mfma_f32_16x16x32_bf16 v[24:27], v[96:99], v[8:11], 0
    v_mfma_f32_16x16x32_bf16 v[28:31], v[104:107], v[8:11], 0
    s_waitcnt lgkmcnt(0)
    v_mfma_f32_16x16x32_bf16 v[16:19], v[84:87], v[12:15], v[16:19]
    v_mfma_f32_16x16x32_bf16 v[20:23], v[92:95], v[12:15], v[20:23]
    v_mfma_f32_16x16x32_bf16 v[24:27], v[100:103], v[12:15], v[24:27]
    v_mfma_f32_16x16x32_bf16 v[28:31], v[108:111], v[12:15], v[28:31]
    v_mfma_f32_16x16x32_bf16 v[32:35], v[112:115], v[8:11], 0
    v_mfma_f32_16x16x32_bf16 v[36:39], v[120:123], v[8:11], 0
    v_mfma_f32_16x16x32_bf16 v[40:43], v[128:131], v[8:11], 0
    v_mfma_f32_16x16x32_bf16 v[44:47], v[136:139], v[8:11], 0
    v_mfma_f32_16x16x32_bf16 v[32:35], v[116:119], v[12:15], v[32:35]
    v_mfma_f32_16x16x32_bf16 v[36:39], v[124:127], v[12:15], v[36:39]
    v_mfma_f32_16x16x32_bf16 v[40:43], v[132:135], v[12:15], v[40:43]
    v_mfma_f32_16x16x32_bf16 v[44:47], v[140:143], v[12:15], v[44:47]
    v_mfma_f32_16x16x32_bf16 v[48:51], v[144:147], v[8:11], 0
    v_mov_b32_dpp v16, v20 quad_perm:[0,1,2,3] row_mask:0xf bank_mask:0x2
    v_mov_b32_dpp v17, v21 quad_perm:[0,1,2,3] row_mask:0xf bank_mask:0x2
    v_mov_b32_dpp v18, v22 quad_perm:[0,1,2,3] row_mask:0xf bank_mask:0x2
    v_mfma_f32_16x16x32_bf16 v[52:55], v[152:155], v[8:11], 0
    v_mov_b32_dpp v19, v23 quad_perm:[0,1,2,3] row_mask:0xf bank_mask:0x2
    v_mov_b32_dpp v16, v24 quad_perm:[0,1,2,3] row_mask:0xf bank_mask:0x4
    v_mov_b32_dpp v17, v25 quad_perm:[0,1,2,3] row_mask:0xf bank_mask:0x4
    v_mfma_f32_16x16x32_bf16 v[48:51], v[148:151], v[12:15], v[48:51]
    v_mov_b32_dpp v18, v26 quad_perm:[0,1,2,3] row_mask:0xf bank_mask:0x4
    v_mov_b32_dpp v19, v27 quad_perm:[0,1,2,3] row_mask:0xf bank_mask:0x4
    v_mov_b32_dpp v16, v28 quad_perm:[0,1,2,3] row_mask:0xf bank_mask:0x8
    v_mfma_f32_16x16x32_bf16 v[52:55], v[156:159], v[12:15], v[52:55]
    v_mov_b32_dpp v17, v29 quad_perm:[0,1,2,3] row_mask:0xf bank_mask:0x8
    v_mov_b32_dpp v18, v30 quad_perm:[0,1,2,3] row_mask:0xf bank_mask:0x8
    v_mov_b32_dpp v19, v31 quad_perm:[0,1,2,3] row_mask:0xf bank_mask:0x8
    buffer_store_dwordx4 v[16:19], v160, s[40:43], s57 offen
    v_mov_b32_dpp v32, v36 quad_perm:[0,1,2,3] row_mask:0xf bank_mask:0x2
    v_mov_b32_dpp v33, v37 quad_perm:[0,1,2,3] row_mask:0xf bank_mask:0x2
    v_mov_b32_dpp v34, v38 quad_perm:[0,1,2,3] row_mask:0xf bank_mask:0x2
    v_mov_b32_dpp v35, v39 quad_perm:[0,1,2,3] row_mask:0xf bank_mask:0x2
    v_mov_b32_dpp v32, v40 quad_perm:[0,1,2,3] row_mask:0xf bank_mask:0x4
    v_mov_b32_dpp v33, v41 quad_perm:[0,1,2,3] row_mask:0xf bank_mask:0x4
    v_mov_b32_dpp v34, v42 quad_perm:[0,1,2,3] row_mask:0xf bank_mask:0x4
    v_mov_b32_dpp v35, v43 quad_perm:[0,1,2,3] row_mask:0xf bank_mask:0x4
    v_mov_b32_dpp v32, v44 quad_perm:[0,1,2,3] row_mask:0xf bank_mask:0x8
    v_mov_b32_dpp v33, v45 quad_perm:[0,1,2,3] row_mask:0xf bank_mask:0x8
    v_mov_b32_dpp v34, v46 quad_perm:[0,1,2,3] row_mask:0xf bank_mask:0x8
    v_mov_b32_dpp v35, v47 quad_perm:[0,1,2,3] row_mask:0xf bank_mask:0x8
    buffer_store_dwordx4 v[32:35], v160, s[40:43], s57 offen offset:256
    v_mov_b32_dpp v48, v52 quad_perm:[0,1,2,3] row_mask:0xf bank_mask:0x2
    v_mov_b32_dpp v49, v53 quad_perm:[0,1,2,3] row_mask:0xf bank_mask:0x2
    v_mov_b32_dpp v50, v54 quad_perm:[0,1,2,3] row_mask:0xf bank_mask:0x2
    v_mov_b32_dpp v51, v55 quad_perm:[0,1,2,3] row_mask:0xf bank_mask:0x2
    s_mov_b32 exec_lo, 0x00ff00ff
    s_mov_b32 exec_hi, 0x00ff00ff
    buffer_store_dwordx4 v[48:51], v160, s[40:43], s57 offen offset:512
L_f2done:
    s_barrier
    s_endpgm
L_f2slow:
    s_waitcnt lgkmcnt(1)
    v_mfma_f32_16x16x32_bf16 v[16:19], v[80:83], v[8:11], 0
    v_mfma_f32_16x16x32_bf16 v[20:23], v[88:91], v[8:11], 0
    v_mfma_f32_16x16x32_bf16 v[24:27], v[96:99], v[8:11], 0
    v_mfma_f32_16x16x32_bf16 v[28:31], v[104:107], v[8:11], 0
    s_waitcnt lgkmcnt(0)
    v_mfma_f32_16x16x32_bf16 v[16:19], v[84:87], v[12:15], v[16:19]
    v_mfma_f32_16x16x32_bf16 v[20:23], v[92:95], v[12:15], v[20:23]
    v_mfma_f32_16x16x32_bf16 v[24:27], v[100:103], v[12:15], v[24:27]
    v_mfma_f32_16x16x32_bf16 v[28:31], v[108:111], v[12:15], v[28:31]
    v_mfma_f32_16x16x32_bf16 v[32:35], v[112:115], v[8:11], 0
    v_mfma_f32_16x16x32_bf16 v[36:39], v[120:123], v[8:11], 0
    v_mfma_f32_16x16x32_bf16 v[40:43], v[128:131], v[8:11], 0
    v_mfma_f32_16x16x32_bf16 v[44:47], v[136:139], v[8:11], 0
    v_mfma_f32_16x16x32_bf16 v[32:35], v[116:119], v[12:15], v[32:35]
    v_mfma_f32_16x16x32_bf16 v[36:39], v[124:127], v[12:15], v[36:39]
    v_mfma_f32_16x16x32_bf16 v[40:43], v[132:135], v[12:15], v[40:43]
    v_mfma_f32_16x16x32_bf16 v[44:47], v[140:143], v[12:15], v[44:47]
    v_mfma_f32_16x16x32_bf16 v[48:51], v[144:147], v[8:11], 0
    v_mov_b32_dpp v16, v20 quad_perm:[0,1,2,3] row_mask:0xf bank_mask:0x2
    v_mov_b32_dpp v17, v21 quad_perm:[0,1,2,3] row_mask:0xf bank_mask:0x2
    v_mov_b32_dpp v18, v22 quad_perm:[0,1,2,3] row_mask:0xf bank_mask:0x2
    v_mfma_f32_16x16x32_bf16 v[52:55], v[152:155], v[8:11], 0
    v_mov_b32_dpp v19, v23 quad_perm:[0,1,2,3] row_mask:0xf bank_mask:0x2
    v_mov_b32_dpp v16, v24 quad_perm:[0,1,2,3] row_mask:0xf bank_mask:0x4
    v_mov_b32_dpp v17, v25 quad_perm:[0,1,2,3] row_mask:0xf bank_mask:0x4
    v_mfma_f32_16x16x32_bf16 v[48:51], v[148:151], v[12:15], v[48:51]
    v_mov_b32_dpp v18, v26 quad_perm:[0,1,2,3] row_mask:0xf bank_mask:0x4
    v_mov_b32_dpp v19, v27 quad_perm:[0,1,2,3] row_mask:0xf bank_mask:0x4
    v_mov_b32_dpp v16, v28 quad_perm:[0,1,2,3] row_mask:0xf bank_mask:0x8
    v_mfma_f32_16x16x32_bf16 v[52:55], v[156:159], v[12:15], v[52:55]
    v_mov_b32_dpp v17, v29 quad_perm:[0,1,2,3] row_mask:0xf bank_mask:0x8
    v_mov_b32_dpp v18, v30 quad_perm:[0,1,2,3] row_mask:0xf bank_mask:0x8
    v_mov_b32_dpp v19, v31 quad_perm:[0,1,2,3] row_mask:0xf bank_mask:0x8
    buffer_store_dwordx4 v[16:19], v160, s[40:43], s57 offen sc1
    v_mov_b32_dpp v32, v36 quad_perm:[0,1,2,3] row_mask:0xf bank_mask:0x2
    v_mov_b32_dpp v33, v37 quad_perm:[0,1,2,3] row_mask:0xf bank_mask:0x2
    v_mov_b32_dpp v34, v38 quad_perm:[0,1,2,3] row_mask:0xf bank_mask:0x2
    v_mov_b32_dpp v35, v39 quad_perm:[0,1,2,3] row_mask:0xf bank_mask:0x2
    v_mov_b32_dpp v32, v40 quad_perm:[0,1,2,3] row_mask:0xf bank_mask:0x4
    v_mov_b32_dpp v33, v41 quad_perm:[0,1,2,3] row_mask:0xf bank_mask:0x4
    v_mov_b32_dpp v34, v42 quad_perm:[0,1,2,3] row_mask:0xf bank_mask:0x4
    v_mov_b32_dpp v35, v43 quad_perm:[0,1,2,3] row_mask:0xf bank_mask:0x4
    v_mov_b32_dpp v32, v44 quad_perm:[0,1,2,3] row_mask:0xf bank_mask:0x8
    v_mov_b32_dpp v33, v45 quad_perm:[0,1,2,3] row_mask:0xf bank_mask:0x8
    v_mov_b32_dpp v34, v46 quad_perm:[0,1,2,3] row_mask:0xf bank_mask:0x8
    v_mov_b32_dpp v35, v47 quad_perm:[0,1,2,3] row_mask:0xf bank_mask:0x8
    buffer_store_dwordx4 v[32:35], v160, s[40:43], s57 offen offset:256 sc1
    v_mov_b32_dpp v48, v52 quad_perm:[0,1,2,3] row_mask:0xf bank_mask:0x2
    v_mov_b32_dpp v49, v53 quad_perm:[0,1,2,3] row_mask:0xf bank_mask:0x2
    v_mov_b32_dpp v50, v54 quad_perm:[0,1,2,3] row_mask:0xf bank_mask:0x2
    v_mov_b32_dpp v51, v55 quad_perm:[0,1,2,3] row_mask:0xf bank_mask:0x2
    s_mov_b32 exec_lo, 0x00ff00ff
    s_mov_b32 exec_hi, 0x00ff00ff
    buffer_store_dwordx4 v[48:51], v160, s[40:43], s57 offen offset:512 sc1
    s_branch L_f2done
L_poll_3t:
    s_mov_b32 s60, 0
    s_waitcnt vmcnt(0)
    s_branch L_poll_3e
L_poll_4t:
    s_mov_b32 s60, 0
    s_waitcnt vmcnt(0)
    s_branch L_poll_4e
L_poll_8t:
    s_mov_b32 s60, 0
    s_waitcnt vmcnt(0)
    s_branch L_poll_8e
L_poll_9t:
    s_mov_b32 s60, 0
    s_waitcnt vmcnt(0)
    s_branch L_poll_9e
L_poll_99t:
    s_mov_b32 s60, 0
    s_waitcnt vmcnt(0)
    s_branch L_poll_99e
L_poll_101t:
    s_mov_b32 s60, 0
    s_waitcnt vmcnt(0)
    s_branch L_poll_101e
L_poll_104t:
    s_mov_b32 s60, 0
    s_waitcnt vmcnt(0)
    s_branch L_poll_104e
L_poll_106t:
    s_mov_b32 s60, 0
    s_waitcnt vmcnt(0)
    s_branch L_poll_106e
L_poll_110t:
    s_mov_b32 s60, 0
    s_waitcnt vmcnt(0)
    s_branch L_poll_110e
L_poll_114t:
    s_mov_b32 s60, 0
    s_waitcnt vmcnt(0)
    s_branch L_poll_114e
L_poll_117t:
    s_mov_b32 s60, 0
    s_waitcnt vmcnt(0)
    s_branch L_poll_117e
L_ygt:
    s_waitcnt vmcnt(0)
    s_branch L_ygd
L_poll_120t:
    s_mov_b32 s60, 0
    s_waitcnt vmcnt(0)
    s_branch L_poll_120e
L_poll_121t:
    s_mov_b32 s60, 0
    s_waitcnt vmcnt(0)
    s_branch L_poll_121e
L_poll_122t:
    s_mov_b32 s60, 0
    s_waitcnt vmcnt(0)
    s_branch L_poll_122e
L_end:
    s_endpgm
L_codeend:
.section .rodata,"a"
.p2align 6
.amdhsa_kernel adaLN_cond__sliding_block_cached__dense_activation_gelu__decode_kernel
  .amdhsa_next_free_vgpr 168
  .amdhsa_next_free_sgpr 102
  .amdhsa_accum_offset 168
  .amdhsa_group_segment_fixed_size 0
  .amdhsa_kernarg_size 120
  .amdhsa_user_sgpr_count 2
  .amdhsa_user_sgpr_kernarg_segment_ptr 1
  .amdhsa_system_sgpr_workgroup_id_x 1
.end_amdhsa_kernel
```

```asm
; @launch grid=(256,1,1) block=(768,1,1) lds=162176
.amdgcn_target "amdgcn-amd-amdhsa--gfx950"
.text
.globl adaLN_cond__sliding_block_cached__dense_activation_gelu__decode_kernel
.p2align 8
.type adaLN_cond__sliding_block_cached__dense_activation_gelu__decode_kernel,@function
adaLN_cond__sliding_block_cached__dense_activation_gelu__decode_kernel:
    s_load_dwordx16 s[4:19], s[0:1], 0
    s_load_dwordx8 s[20:27], s[0:1], 64
    s_load_dwordx4 s[28:31], s[0:1], 96
    s_load_dwordx2 s[32:33], s[0:1], 112
    s_cmp_ge_u32 s2, 256
    s_cbranch_scc1 L_end
    v_lshrrev_b32 v1, 6, v0
    v_lshlrev_b32 v2, 4, v0
    v_readfirstlane_b32 s3, v1
    v_and_b32 v0, 63, v0
    s_and_b32 s34, s2, 7
    s_lshr_b32 s35, s2, 3
    s_cmp_lg_u32 s35, 21
    s_cbranch_scc1 L_nopf
    s_getpc_b64 s[48:49]
    s_and_b32 s48, s48, 0xffffff00
    s_mov_b32 s50, L_codeend-adaLN_cond__sliding_block_cached__dense_activation_gelu__decode_kernel
    s_mov_b32 s51, 0x20000
    s_mov_b32 s52, 12288
    buffer_load_dwordx4 v[152:155], v2, s[48:51], 0 offen
    buffer_load_dwordx4 v[156:159], v2, s[48:51], s52 offen
L_nopf:
    s_lshr_b32 s36, s35, 3
    s_lshl2_add_u32 s36, s34, s36
    s_bfe_u32 s37, s35, 0x20001
    s_and_b32 s38, s35, 1
    s_cmp_lt_u32 s35, 27
    s_cselect_b32 s39, 1, 0
    s_cmp_eq_u32 s34, 2
    s_cselect_b32 s39, s39, 0
    s_sub_u32 s62, s34, 3
    s_and_b32 s62, s62, 7
    s_mul_i32 s56, s35, 7
    s_add_u32 s56, s56, s62
    s_cmp_eq_u32 s62, 7
    s_cselect_b32 s56, 255, s56
    s_mov_b32 s60, 400000
    s_mov_b32 s61, 0
    v_mov_b32 v36, 0
    s_cmp_lt_u32 s3, 4
    s_cbranch_scc1 L_helpers
    s_sub_u32 s3, s3, 4
    s_cmp_ge_u32 s35, 22
    s_cselect_b32 s59, 1, 0
    s_add_u32 s62, s3, s59
    s_cmp_ge_u32 s62, 6
    s_cselect_b32 s62, s39, 0
    s_cmp_eq_u32 s62, 1
    s_cbranch_scc1 L_proxy
    s_cmp_eq_u32 s59, 1
    s_cselect_b32 s100, 0, 81920
    s_lshl_b32 s62, s3, 13
    s_add_u32 s100, s100, s62
    s_and_b32 s62, s39, s59
    s_cselect_b32 s100, -1, s100
    s_mov_b32 s101, 0
L_stream:
    s_lshl_b32 s62, s37, 5
    s_add_u32 s62, s62, s36
    s_lshl_b32 s63, s62, 21
    s_lshl_b32 s96, s38, 18
    s_add_u32 s63, s63, s96
    s_add_u32 s63, s63, 1572864
    v_lshlrev_b32 v1, 4, v0
    s_lshl_b32 s96, s3, 12
    v_add_u32 v1, s96, v1
    s_mov_b32 s97, 0
    s_mov_b32 s50, 262144
    s_mov_b32 s51, 0x20000
    s_waitcnt lgkmcnt(0)
    s_add_u32 s48, s6, s63
    s_addc_u32 s49, s7, 0
    s_cmp_lt_u32 s56, 40
    s_cbranch_scc0 L_nob0
    s_barrier
L_nob0:
    buffer_load_dwordx4 v[40:43], v1, s[48:51], s97 offen offset:0 nt
    buffer_load_dwordx4 v[44:47], v1, s[48:51], s97 offen offset:1024 nt
    s_cmp_lt_u32 s56, 40
    s_cbranch_scc1 L_stream2
    s_barrier
    s_branch L_stream2
L_helpers:
    s_cmp_lg_u32 s3, 0
    s_cbranch_scc1 L_noinit
    v_lshlrev_b32 v1, 2, v0
    v_add_u32 v1, 161920, v1
    ds_write_b32 v1, v36
L_noinit:
    s_waitcnt lgkmcnt(0)
    s_mov_b32 s40, s32
    s_mov_b32 s41, s33
    s_mov_b32 s42, 589824
    s_mov_b32 s43, 0x20000
    s_mov_b32 s44, s30
    s_mov_b32 s45, s31
    s_mov_b32 s46, 256
    s_mov_b32 s47, 0x20000
    s_lshl2_add_u32 s62, s35, s3
    s_cmp_eq_u32 s62, 87
    s_cbranch_scc1 L_touch
L_notp:
    s_mul_i32 s101, s3, 20480
    s_mov_b32 s96, s56
    s_cmp_lt_u32 s56, 40
    s_cbranch_scc0 L_nothalf
    s_cmp_lt_u32 s3, 2
    s_cbranch_scc1 L_unit
    s_add_u32 s62, s56, 20
    s_cmp_eq_u32 s3, 2
    s_cbranch_scc1 L_job
    s_lshr_b32 s62, s56, 1
    s_and_b32 s63, s56, 1
    s_mul_i32 s63, s63, 5120
    s_lshl_b32 s96, s62, 7
    s_add_u32 s63, s63, s96
    s_cmp_ge_u32 s62, 10
    s_cselect_b32 s62, 8960, 0
    s_add_u32 s63, s63, s62
    v_lshrrev_b32 v1, 4, v0
    v_mul_u32_u24 v1, 1280, v1
    v_and_b32 v2, 15, v0
    v_lshl_add_u32 v1, v2, 3, v1
    v_mov_b32 v4, -1
    v_mov_b32 v5, -1
    buffer_store_dwordx2 v[4:5], v1, s[40:43], s63 offen sc1
    s_lshl_b32 s62, s56, 1
    s_waitcnt vmcnt(0)
    s_mov_b64 exec, 1
    buffer_store_short v4, v36, s[44:47], s62 offen offset:128 sc1
    s_mov_b64 exec, -1
    s_barrier
    s_branch L_service
L_nothalf:
    s_cmp_lt_u32 s56, 104
    s_cbranch_scc1 L_unit
    s_sub_u32 s62, s56, 144
    s_cmp_lt_u32 s62, 10
    s_cbranch_scc0 L_nojob
    s_cmp_lt_u32 s3, 2
    s_cbranch_scc0 L_nojob
    s_mul_i32 s63, s3, 10
    s_add_u32 s62, s62, s63
L_job:
    s_cmp_lt_u32 s62, 59
    s_cbranch_scc0 L_end
    s_mov_b32 s100, s101
    s_lshl_b32 s101, s62, 9
    s_add_u32 s101, s101, 196608
    s_cmp_lt_u32 s62, 27
    s_cselect_b32 s63, 0, 27
    s_cselect_b32 s3, 7, 6
    s_cmp_lt_u32 s62, 54
    s_cselect_b32 s63, s63, 32
    s_cselect_b32 s3, s3, 5
    s_sub_u32 s35, s62, s63
    s_mov_b32 s34, 2
    s_lshr_b32 s36, s35, 3
    s_add_u32 s36, s36, 8
    s_bfe_u32 s37, s35, 0x20001
    s_and_b32 s38, s35, 1
    s_mov_b32 s59, 0
    s_branch L_stream
L_nojob:
    s_barrier
    s_cmp_ge_u32 s35, 22
    s_cbranch_scc1 L_h_t1
    s_cmp_eq_u32 s39, 1
    s_cbranch_scc1 L_h_role
    s_cmp_lt_u32 s96, 144
    s_cbranch_scc1 L_unit
    s_cmp_eq_u32 s3, 3
    s_cbranch_scc1 L_service
    s_endpgm
L_unit:
    v_lshrrev_b32 v3, 4, v0
    v_and_b32 v4, 3, v0
    v_bfe_u32 v7, v0, 2, 2
    v_lshlrev_b32 v64, 5, v7
    v_lshl_add_u32 v64, v3, 3, v64
    s_mov_b32 s14, s3
    s_mov_b32 s15, 3
    s_sub_u32 s62, s96, 40
    s_cmp_lt_u32 s62, 64
    s_cbranch_scc1 L_u_q
    s_mov_b32 s100, 1
    s_sub_u32 s96, s96, 84
    s_mov_b32 s12, 10240
    s_cmp_lt_u32 s56, 40
    s_cbranch_scc0 L_u_full
    s_mov_b32 s100, 0
    s_lshr_b32 s96, s56, 1
    s_and_b32 s62, s56, 1
    s_lshl1_add_u32 s14, s62, s14
    s_mov_b32 s15, 1
    s_cmp_ge_u32 s96, 10
    s_addc_u32 s62, s62, 0
    s_mul_i32 s12, s62, 5120
    s_add_u32 s12, s12, 0
L_u_full:
    s_mov_b32 s97, 0
    s_mov_b32 s99, 7680
    s_mov_b32 s48, s26
    s_mov_b32 s49, s27
    s_mov_b32 s50, 4915200
    s_mov_b32 s51, 0x20000
    s_mov_b32 s52, s24
    s_mov_b32 s53, s25
    s_mov_b32 s54, 5120
    s_mov_b32 s55, 0x20000
    v_and_b32 v6, 15, v0
    v_lshlrev_b32 v6, 4, v6
    v_mul_u32_u24 v5, 1280, v3
    v_add_u32 v5, v5, v6
    s_mul_i32 s62, s14, 320
    buffer_load_dwordx4 v[8:11], v5, s[52:55], s62 offen
    s_mov_b32 exec_lo, 0x000f000f
    s_mov_b32 exec_hi, 0x000f000f
    buffer_load_dwordx4 v[12:15], v5, s[52:55], s62 offen offset:256
    s_mov_b64 exec, -1
    s_lshl_b32 s98, s96, 7
    s_mul_i32 s13, s96, 0x199a
    s_lshr_b32 s13, s13, 16
    s_mul_i32 s63, s13, 3840
    s_add_u32 s57, s98, s63
    s_add_u32 s57, s57, s12
    v_mul_u32_u24 v5, 1280, v4
    v_add_u32 v64, v64, v5
    s_cmp_lg_u32 s13, 1
    s_cbranch_scc1 L_u_go
    s_mov_b32 s52, s4
    s_mov_b32 s53, s5
    s_mov_b32 s54, 5120
    s_mov_b32 s55, 0x20000
    v_lshrrev_b32 v6, 2, v0
    v_lshl_add_u32 v6, v6, 4, v5
    s_sub_u32 s62, s98, 1280
    buffer_load_dwordx4 v[16:19], v6, s[52:55], 0 offen offset:0
    buffer_load_dwordx4 v[20:23], v6, s[52:55], 0 offen offset:256
    buffer_load_dwordx4 v[24:27], v6, s[52:55], 0 offen offset:512
    buffer_load_dwordx4 v[28:31], v6, s[52:55], 0 offen offset:768
    buffer_load_dwordx4 v[32:35], v6, s[52:55], 0 offen offset:1024
    buffer_load_dwordx2 v[66:67], v64, s[52:55], s62 offen
    s_branch L_u_go
L_u_q:
    s_mov_b32 s97, 1
    s_mov_b32 s99, 8192
    s_mov_b32 s100, 0
    s_lshl_b32 s98, s62, 7
    s_add_u32 s57, s98, 40960
    v_lshl_add_u32 v64, v4, 13, v64
    s_mov_b32 s48, s10
    s_mov_b32 s49, s11
    s_mov_b32 s50, 5242880
    s_mov_b32 s51, 0x20000
L_u_go:
    v_lshrrev_b32 v6, 3, v0
    v_mul_lo_u32 v1, v6, s99
    v_and_b32 v6, 2, v6
    v_xor_b32 v6, v6, v0
    v_and_b32 v6, 7, v6
    v_lshl_add_u32 v1, v6, 4, v1
    v_add_u32 v1, s98, v1
    v_xor_b32 v2, 64, v1
    s_mul_i32 s63, s99, s14
    s_mul_i32 s63, s63, 160
    s_lshl_b32 s59, s99, 3
    s_mov_b32 m0, s101
    s_mov_b32 s62, 10
L_dma_1:
    buffer_load_dwordx4 v1, s[48:51], s63 offen nt lds
    s_add_u32 m0, m0, 1024
    s_add_u32 s63, s63, s59
    s_cmp_eq_u32 s100, 0
    s_cbranch_scc1 L_dma_1n0
    s_waitcnt vmcnt(3)
    s_cmp_eq_u32 s100, 2
    s_cbranch_scc1 L_dma_1n0
    s_waitcnt vmcnt(3)
L_dma_1n0:
    buffer_load_dwordx4 v2, s[48:51], s63 offen nt lds
    s_add_u32 m0, m0, 1024
    s_add_u32 s63, s63, s59
    s_cmp_eq_u32 s100, 0
    s_cbranch_scc1 L_dma_1n1
    s_waitcnt vmcnt(3)
    s_cmp_eq_u32 s100, 2
    s_cbranch_scc1 L_dma_1n1
    s_waitcnt vmcnt(3)
L_dma_1n1:
    s_sub_u32 s62, s62, 1
    s_cmp_lg_u32 s62, 0
    s_cbranch_scc1 L_dma_1
    v_min_u32 v65, 29, v0
    v_lshlrev_b32 v65, 2, v65
    s_cmp_lt_u32 s56, 104
    s_cselect_b32 s62, 32, 64
    v_min_u32 v6, 51, v0
    v_lshlrev_b32 v6, 2, v6
    v_cmp_le_u32 vcc, s62, v0
    s_nop 1
    v_cndmask_b32 v65, v65, v6, vcc
    v_mov_b32 v68, -1
    s_cmp_lt_u32 s56, 40
    s_cbranch_scc1 L_u_nofl
    buffer_load_dword v68, v65, s[44:47], 0 offen sc1
L_u_nofl:
    s_cmp_lt_u32 s56, 104
    s_cbranch_scc0 L_u_nob
    s_barrier
L_u_nob:
    v_lshrrev_b32 v60, 4, v0
    v_lshlrev_b32 v60, 10, v60
    v_bfe_u32 v6, v0, 2, 2
    v_lshl_add_u32 v60, v6, 7, v60
    v_and_b32 v6, 3, v0
    v_lshl_add_u32 v60, v6, 3, v60
    v_bfe_u32 v6, v0, 3, 2
    v_lshl_add_u32 v60, v6, 5, v60
    v_xor_b32 v61, 32, v60
    v_xor_b32 v62, 64, v60
    v_xor_b32 v63, 0x60, v60
    v_add_u32 v60, s101, v60
    v_add_u32 v61, s101, v61
    v_add_u32 v62, s101, v62
    v_add_u32 v63, s101, v63
    v_mov_b32 v56, 1.0
    v_mov_b32 v57, 1.0
    v_mov_b32 v58, 1.0
    v_mov_b32 v59, 1.0
    s_mov_b32 s58, 0
    s_cmp_eq_u32 s97, 1
    s_cbranch_scc1 L_u_q2
    s_cmp_eq_u32 s13, 4
    s_cselect_b32 s58, 1.0, 0
    s_cmp_lt_u32 s14, 2
    s_cselect_b32 s62, 1.0, 0
    s_cmp_eq_u32 s13, 1
    s_cselect_b32 s58, s62, s58
    s_cselect_b32 s56, 1, 0
    s_waitcnt vmcnt(20)
    s_mov_b32 s62, 0xbfb8aa3b
    v_lshlrev_b32 v40, 16, v8
    v_and_b32 v41, 0xffff0000, v8
    v_lshlrev_b32 v42, 16, v9
    v_and_b32 v43, 0xffff0000, v9
    v_lshlrev_b32 v44, 16, v10
    v_and_b32 v45, 0xffff0000, v10
    v_lshlrev_b32 v46, 16, v11
    v_and_b32 v47, 0xffff0000, v11
    v_mul_f32 v48, s62, v40
    v_mul_f32 v49, s62, v41
    v_mul_f32 v50, s62, v42
    v_mul_f32 v51, s62, v43
    v_mul_f32 v52, s62, v44
    v_mul_f32 v53, s62, v45
    v_mul_f32 v54, s62, v46
    v_mul_f32 v55, s62, v47
    v_exp_f32 v48, v48
    v_exp_f32 v49, v49
    v_exp_f32 v50, v50
    v_exp_f32 v51, v51
    v_exp_f32 v52, v52
    v_exp_f32 v53, v53
    v_exp_f32 v54, v54
    v_exp_f32 v55, v55
    v_add_f32 v48, 1.0, v48
    v_add_f32 v49, 1.0, v49
    v_add_f32 v50, 1.0, v50
    v_add_f32 v51, 1.0, v51
    v_add_f32 v52, 1.0, v52
    v_add_f32 v53, 1.0, v53
    v_add_f32 v54, 1.0, v54
    v_add_f32 v55, 1.0, v55
    v_rcp_f32 v48, v48
    v_rcp_f32 v49, v49
    v_rcp_f32 v50, v50
    v_rcp_f32 v51, v51
    v_rcp_f32 v52, v52
    v_rcp_f32 v53, v53
    v_rcp_f32 v54, v54
    v_rcp_f32 v55, v55
    v_mul_f32 v40, v40, v48
    v_mul_f32 v41, v41, v49
    v_mul_f32 v42, v42, v50
    v_mul_f32 v43, v43, v51
    v_mul_f32 v44, v44, v52
    v_mul_f32 v45, v45, v53
    v_mul_f32 v46, v46, v54
    v_mul_f32 v47, v47, v55
    v_cvt_pk_bf16_f32 v8, v40, v41
    v_cvt_pk_bf16_f32 v9, v42, v43
    v_cvt_pk_bf16_f32 v10, v44, v45
    v_cvt_pk_bf16_f32 v11, v46, v47
    v_lshlrev_b32 v40, 16, v12
    v_and_b32 v41, 0xffff0000, v12
    v_lshlrev_b32 v42, 16, v13
    v_and_b32 v43, 0xffff0000, v13
    v_lshlrev_b32 v44, 16, v14
    v_and_b32 v45, 0xffff0000, v14
    v_lshlrev_b32 v46, 16, v15
    v_and_b32 v47, 0xffff0000, v15
    v_mul_f32 v48, s62, v40
    v_mul_f32 v49, s62, v41
    v_mul_f32 v50, s62, v42
    v_mul_f32 v51, s62, v43
    v_mul_f32 v52, s62, v44
    v_mul_f32 v53, s62, v45
    v_mul_f32 v54, s62, v46
    v_mul_f32 v55, s62, v47
    v_exp_f32 v48, v48
    v_exp_f32 v49, v49
    v_exp_f32 v50, v50
    v_exp_f32 v51, v51
    v_exp_f32 v52, v52
    v_exp_f32 v53, v53
    v_exp_f32 v54, v54
    v_exp_f32 v55, v55
    v_add_f32 v48, 1.0, v48
    v_add_f32 v49, 1.0, v49
    v_add_f32 v50, 1.0, v50
    v_add_f32 v51, 1.0, v51
    v_add_f32 v52, 1.0, v52
    v_add_f32 v53, 1.0, v53
    v_add_f32 v54, 1.0, v54
    v_add_f32 v55, 1.0, v55
    v_rcp_f32 v48, v48
    v_rcp_f32 v49, v49
    v_rcp_f32 v50, v50
    v_rcp_f32 v51, v51
    v_rcp_f32 v52, v52
    v_rcp_f32 v53, v53
    v_rcp_f32 v54, v54
    v_rcp_f32 v55, v55
    v_mul_f32 v40, v40, v48
    v_mul_f32 v41, v41, v49
    v_mul_f32 v42, v42, v50
    v_mul_f32 v43, v43, v51
    v_mul_f32 v44, v44, v52
    v_mul_f32 v45, v45, v53
    v_mul_f32 v46, v46, v54
    v_mul_f32 v47, v47, v55
    v_cvt_pk_bf16_f32 v12, v40, v41
    v_cvt_pk_bf16_f32 v13, v42, v43
    v_cvt_pk_bf16_f32 v14, v44, v45
    v_cvt_pk_bf16_f32 v15, v46, v47
    s_mul_i32 s62, s3, 1344
    s_add_u32 s62, s62, 151552
    v_mul_u32_u24 v5, 336, v3
    v_and_b32 v6, 15, v0
    v_lshl_add_u32 v5, v6, 4, v5
    v_add_u32 v5, s62, v5
    ds_write_b128 v5, v[8:11]
    s_mov_b32 exec_lo, 0x000f000f
    s_mov_b32 exec_hi, 0x000f000f
    ds_write_b128 v5, v[12:15] offset:256
    s_mov_b64 exec, -1
    v_mul_u32_u24 v5, 336, v4
    v_lshl_add_u32 v5, v3, 4, v5
    v_add_u32 v5, s62, v5
    s_mov_b32 s59, 0x3e800000
    s_cmp_eq_u32 s56, 0
    s_cbranch_scc1 L_u_nost
    v_mov_b32 v40, 0
    v_mov_b32 v41, 0
    s_mov_b32 s62, 0x3f803f80
    v_dot2c_f32_bf16 v40, s62, v16
    v_dot2c_f32_bf16 v41, v16, v16
    v_dot2c_f32_bf16 v40, s62, v17
    v_dot2c_f32_bf16 v41, v17, v17
    v_dot2c_f32_bf16 v40, s62, v18
    v_dot2c_f32_bf16 v41, v18, v18
    v_dot2c_f32_bf16 v40, s62, v19
    v_dot2c_f32_bf16 v41, v19, v19
    v_dot2c_f32_bf16 v40, s62, v20
    v_dot2c_f32_bf16 v41, v20, v20
    v_dot2c_f32_bf16 v40, s62, v21
    v_dot2c_f32_bf16 v41, v21, v21
    v_dot2c_f32_bf16 v40, s62, v22
    v_dot2c_f32_bf16 v41, v22, v22
    v_dot2c_f32_bf16 v40, s62, v23
    v_dot2c_f32_bf16 v41, v23, v23
    v_dot2c_f32_bf16 v40, s62, v24
    v_dot2c_f32_bf16 v41, v24, v24
    v_dot2c_f32_bf16 v40, s62, v25
    v_dot2c_f32_bf16 v41, v25, v25
    v_dot2c_f32_bf16 v40, s62, v26
    v_dot2c_f32_bf16 v41, v26, v26
    v_dot2c_f32_bf16 v40, s62, v27
    v_dot2c_f32_bf16 v41, v27, v27
    v_dot2c_f32_bf16 v40, s62, v28
    v_dot2c_f32_bf16 v41, v28, v28
    v_dot2c_f32_bf16 v40, s62, v29
    v_dot2c_f32_bf16 v41, v29, v29
    v_dot2c_f32_bf16 v40, s62, v30
    v_dot2c_f32_bf16 v41, v30, v30
    v_dot2c_f32_bf16 v40, s62, v31
    v_dot2c_f32_bf16 v41, v31, v31
    v_dot2c_f32_bf16 v40, s62, v32
    v_dot2c_f32_bf16 v41, v32, v32
    v_dot2c_f32_bf16 v40, s62, v33
    v_dot2c_f32_bf16 v41, v33, v33
    v_dot2c_f32_bf16 v40, s62, v34
    v_dot2c_f32_bf16 v41, v34, v34
    v_dot2c_f32_bf16 v40, s62, v35
    v_dot2c_f32_bf16 v41, v35, v35
    s_nop 1
    v_add_f32_dpp v40, v40, v40 row_ror:4 row_mask:0xf bank_mask:0xf
    v_add_f32_dpp v41, v41, v41 row_ror:4 row_mask:0xf bank_mask:0xf
    s_nop 0
    v_add_f32_dpp v40, v40, v40 row_ror:8 row_mask:0xf bank_mask:0xf
    v_add_f32_dpp v41, v41, v41 row_ror:8 row_mask:0xf bank_mask:0xf
    v_mov_b32 v42, v40
    v_mov_b32 v43, v41
    s_nop 0
    v_permlane16_swap_b32 v40, v42
    v_permlane16_swap_b32 v41, v43
    v_add_f32 v40, v40, v42
    v_add_f32 v41, v41, v43
    v_mov_b32 v42, v40
    v_mov_b32 v43, v41
    s_nop 0
    v_permlane32_swap_b32 v40, v42
    v_permlane32_swap_b32 v41, v43
    v_add_f32 v40, v40, v42
    v_add_f32 v41, v41, v43
    s_mov_b32 s62, 0x3acccccd
    v_mul_f32 v40, s62, v40
    v_mul_f32 v41, s62, v41
    v_fma_f32 v41, -v40, v40, v41
    v_max_f32 v41, 0, v41
    v_add_f32 v41, 0x3727c5ac, v41
    v_rsq_f32 v41, v41
    v_lshlrev_b32 v56, 16, v66
    v_and_b32 v57, 0xffff0000, v66
    v_lshlrev_b32 v58, 16, v67
    v_and_b32 v59, 0xffff0000, v67
    v_sub_f32 v56, v56, v40
    v_sub_f32 v57, v57, v40
    v_sub_f32 v58, v58, v40
    v_sub_f32 v59, v59, v40
    v_mul_f32 v56, v56, v41
    v_mul_f32 v57, v57, v41
    v_mul_f32 v58, v58, v41
    v_mul_f32 v59, v59, v41
L_u_nost:
    ds_read_b128 v[8:11], v5 offset:0
    ds_read_b128 v[12:15], v5 offset:64
    ds_read_b128 v[16:19], v5 offset:128
    ds_read_b128 v[20:23], v5 offset:192
    ds_read_b128 v[24:27], v5 offset:256
    s_branch L_u_frag
L_u_q2:
    v_and_b32 v5, 15, v0
    v_mul_u32_u24 v5, 1280, v5
    v_lshl_add_u32 v5, v3, 4, v5
    s_mul_i32 s63, s3, 320
    s_add_u32 s63, s63, 0
    s_mov_b32 s59, 1.0
L_u_frag:
    s_waitcnt vmcnt(0)
    v_cmp_ne_u32 vcc, -1, v68
    s_cbranch_vccz L_u_yok
L_wy_2:
    buffer_load_dword v37, v65, s[44:47], 0 offen sc1
    s_waitcnt vmcnt(0)
    v_cmp_ne_u32 vcc, -1, v37
    s_cbranch_vccz L_wy_2e
    s_sleep 4
    s_sub_u32 s60, s60, 1
    s_cbranch_scc0 L_wy_2
    s_mov_b32 s60, 0
L_wy_2e:
L_u_yok:
    ds_read_b64_tr_b16 v[80:81], v60 offset:0
    ds_read_b64_tr_b16 v[82:83], v60 offset:512
    ds_read_b64_tr_b16 v[84:85], v61 offset:0
    ds_read_b64_tr_b16 v[86:87], v61 offset:512
    ds_read_b64_tr_b16 v[88:89], v62 offset:0
    ds_read_b64_tr_b16 v[90:91], v62 offset:512
    ds_read_b64_tr_b16 v[92:93], v63 offset:0
    ds_read_b64_tr_b16 v[94:95], v63 offset:512
    ds_read_b64_tr_b16 v[96:97], v60 offset:4096
    ds_read_b64_tr_b16 v[98:99], v60 offset:4608
    ds_read_b64_tr_b16 v[100:101], v61 offset:4096
    ds_read_b64_tr_b16 v[102:103], v61 offset:4608
    ds_read_b64_tr_b16 v[104:105], v62 offset:4096
    ds_read_b64_tr_b16 v[106:107], v62 offset:4608
    ds_read_b64_tr_b16 v[108:109], v63 offset:4096
    ds_read_b64_tr_b16 v[110:111], v63 offset:4608
    ds_read_b64_tr_b16 v[112:113], v60 offset:8192
    ds_read_b64_tr_b16 v[114:115], v60 offset:8704
    ds_read_b64_tr_b16 v[116:117], v61 offset:8192
    ds_read_b64_tr_b16 v[118:119], v61 offset:8704
    ds_read_b64_tr_b16 v[120:121], v62 offset:8192
    ds_read_b64_tr_b16 v[122:123], v62 offset:8704
    ds_read_b64_tr_b16 v[124:125], v63 offset:8192
    ds_read_b64_tr_b16 v[126:127], v63 offset:8704
    ds_read_b64_tr_b16 v[128:129], v60 offset:12288
    ds_read_b64_tr_b16 v[130:131], v60 offset:12800
    ds_read_b64_tr_b16 v[132:133], v61 offset:12288
    ds_read_b64_tr_b16 v[134:135], v61 offset:12800
    ds_read_b64_tr_b16 v[136:137], v62 offset:12288
    ds_read_b64_tr_b16 v[138:139], v62 offset:12800
    ds_read_b64_tr_b16 v[140:141], v63 offset:12288
    ds_read_b64_tr_b16 v[142:143], v63 offset:12800
    ds_read_b64_tr_b16 v[144:145], v60 offset:16384
    ds_read_b64_tr_b16 v[146:147], v60 offset:16896
    ds_read_b64_tr_b16 v[148:149], v61 offset:16384
    ds_read_b64_tr_b16 v[150:151], v61 offset:16896
    ds_read_b64_tr_b16 v[152:153], v62 offset:16384
    ds_read_b64_tr_b16 v[154:155], v62 offset:16896
    ds_read_b64_tr_b16 v[156:157], v63 offset:16384
    ds_read_b64_tr_b16 v[158:159], v63 offset:16896
    s_cmp_eq_u32 s97, 0
    s_cbranch_scc1 L_u_mm
    v_lshrrev_b32 v6, 2, v0
    v_mul_u32_u24 v6, 158, v6
    v_and_b32 v6, 0xfffc, v6
    v_and_b32 v7, 3, v0
    v_mul_u32_u24 v7, 5120, v7
    v_add_u32 v6, v6, v7
    s_mov_b64 exec, 0xfff
    s_branch L_poll_3
L_poll_3s:
    s_sleep 4
L_poll_3:
    buffer_load_dword v8, v6, s[40:43], s63 offen offset:3840 sc1
    s_sub_u32 s60, s60, 1
    s_cbranch_scc1 L_poll_3t
    s_waitcnt vmcnt(0)
    v_cmp_eq_u32 vcc, -1, v8
    s_cbranch_vccnz L_poll_3s
L_poll_3e:
    s_mov_b64 exec, -1
    s_branch L_poll_4
L_poll_4s:
    s_sleep 1
L_poll_4:
    buffer_load_dwordx4 v[8:11], v5, s[40:43], s63 offen offset:0 sc1
    buffer_load_dwordx4 v[12:15], v5, s[40:43], s63 offen offset:64 sc1
    buffer_load_dwordx4 v[16:19], v5, s[40:43], s63 offen offset:128 sc1
    buffer_load_dwordx4 v[20:23], v5, s[40:43], s63 offen offset:192 sc1
    buffer_load_dwordx4 v[24:27], v5, s[40:43], s63 offen offset:256 sc1
    s_sub_u32 s60, s60, 1
    s_cbranch_scc1 L_poll_4t
    s_waitcnt vmcnt(0)
    v_max3_u32 v37, v8, v9, v10
    v_max3_u32 v37, v37, v11, v12
    v_max3_u32 v37, v37, v13, v14
    v_max3_u32 v37, v37, v15, v16
    v_max3_u32 v37, v37, v17, v18
    v_max3_u32 v37, v37, v19, v20
    v_max3_u32 v37, v37, v21, v22
    v_max3_u32 v37, v37, v23, v24
    v_max3_u32 v37, v37, v25, v26
    v_max_u32 v37, v37, v27
    v_cmp_eq_u32 vcc, -1, v37
    s_cbranch_vccnz L_poll_4s
L_poll_4e:
L_u_got:
L_u_mm:
    s_waitcnt lgkmcnt(0)
    v_mfma_f32_16x16x32_bf16 v[40:43], v[80:83], v[8:11], 0
    v_mfma_f32_16x16x32_bf16 v[44:47], v[84:87], v[8:11], 0
    v_mfma_f32_16x16x32_bf16 v[48:51], v[88:91], v[8:11], 0
    v_mfma_f32_16x16x32_bf16 v[52:55], v[92:95], v[8:11], 0
    v_mfma_f32_16x16x32_bf16 v[40:43], v[96:99], v[12:15], v[40:43]
    v_mfma_f32_16x16x32_bf16 v[44:47], v[100:103], v[12:15], v[44:47]
    v_mfma_f32_16x16x32_bf16 v[48:51], v[104:107], v[12:15], v[48:51]
    v_mfma_f32_16x16x32_bf16 v[52:55], v[108:111], v[12:15], v[52:55]
    v_mfma_f32_16x16x32_bf16 v[40:43], v[112:115], v[16:19], v[40:43]
    v_mfma_f32_16x16x32_bf16 v[44:47], v[116:119], v[16:19], v[44:47]
    v_mfma_f32_16x16x32_bf16 v[48:51], v[120:123], v[16:19], v[48:51]
    v_mfma_f32_16x16x32_bf16 v[52:55], v[124:127], v[16:19], v[52:55]
    v_mfma_f32_16x16x32_bf16 v[40:43], v[128:131], v[20:23], v[40:43]
    v_mfma_f32_16x16x32_bf16 v[44:47], v[132:135], v[20:23], v[44:47]
    v_mfma_f32_16x16x32_bf16 v[48:51], v[136:139], v[20:23], v[48:51]
    v_mfma_f32_16x16x32_bf16 v[52:55], v[140:143], v[20:23], v[52:55]
    v_mfma_f32_16x16x32_bf16 v[40:43], v[144:147], v[24:27], v[40:43]
    v_mfma_f32_16x16x32_bf16 v[44:47], v[148:151], v[24:27], v[44:47]
    v_mfma_f32_16x16x32_bf16 v[48:51], v[152:155], v[24:27], v[48:51]
    v_mfma_f32_16x16x32_bf16 v[52:55], v[156:159], v[24:27], v[52:55]
    v_lshlrev_b32 v5, 4, v0
    v_add_u32 v5, 147456, v5
    s_lshl_b32 s62, s3, 10
    v_add_u32 v6, s62, v5
    v_mov_b32 v32, 162056
    v_mov_b32 v33, 1
    v_add_f32_dpp v40, v40, v40 row_ror:8 row_mask:0xf bank_mask:0xf
    v_add_f32_dpp v41, v41, v41 row_ror:8 row_mask:0xf bank_mask:0xf
    v_add_f32_dpp v42, v42, v42 row_ror:8 row_mask:0xf bank_mask:0xf
    v_add_f32_dpp v43, v43, v43 row_ror:8 row_mask:0xf bank_mask:0xf
    v_add_f32_dpp v44, v44, v44 row_ror:8 row_mask:0xf bank_mask:0xf
    v_add_f32_dpp v45, v45, v45 row_ror:8 row_mask:0xf bank_mask:0xf
    v_add_f32_dpp v46, v46, v46 row_ror:8 row_mask:0xf bank_mask:0xf
    v_add_f32_dpp v47, v47, v47 row_ror:8 row_mask:0xf bank_mask:0xf
    v_add_f32_dpp v48, v48, v48 row_ror:8 row_mask:0xf bank_mask:0xf
    v_add_f32_dpp v49, v49, v49 row_ror:8 row_mask:0xf bank_mask:0xf
    v_add_f32_dpp v50, v50, v50 row_ror:8 row_mask:0xf bank_mask:0xf
    v_add_f32_dpp v51, v51, v51 row_ror:8 row_mask:0xf bank_mask:0xf
    v_add_f32_dpp v52, v52, v52 row_ror:8 row_mask:0xf bank_mask:0xf
    v_add_f32_dpp v53, v53, v53 row_ror:8 row_mask:0xf bank_mask:0xf
    v_add_f32_dpp v54, v54, v54 row_ror:8 row_mask:0xf bank_mask:0xf
    v_add_f32_dpp v55, v55, v55 row_ror:8 row_mask:0xf bank_mask:0xf
    v_add_f32_dpp v28, v40, v40 row_ror:4 row_mask:0xf bank_mask:0x1
    v_add_f32_dpp v29, v41, v41 row_ror:4 row_mask:0xf bank_mask:0x1
    v_add_f32_dpp v30, v42, v42 row_ror:4 row_mask:0xf bank_mask:0x1
    v_add_f32_dpp v31, v43, v43 row_ror:4 row_mask:0xf bank_mask:0x1
    v_add_f32_dpp v28, v44, v44 row_ror:4 row_mask:0xf bank_mask:0x2
    v_add_f32_dpp v29, v45, v45 row_ror:4 row_mask:0xf bank_mask:0x2
    v_add_f32_dpp v30, v46, v46 row_ror:4 row_mask:0xf bank_mask:0x2
    v_add_f32_dpp v31, v47, v47 row_ror:4 row_mask:0xf bank_mask:0x2
    v_add_f32_dpp v28, v48, v48 row_ror:4 row_mask:0xf bank_mask:0x4
    v_add_f32_dpp v29, v49, v49 row_ror:4 row_mask:0xf bank_mask:0x4
    v_add_f32_dpp v30, v50, v50 row_ror:4 row_mask:0xf bank_mask:0x4
    v_add_f32_dpp v31, v51, v51 row_ror:4 row_mask:0xf bank_mask:0x4
    v_add_f32_dpp v28, v52, v52 row_ror:4 row_mask:0xf bank_mask:0x8
    v_add_f32_dpp v29, v53, v53 row_ror:4 row_mask:0xf bank_mask:0x8
    v_add_f32_dpp v30, v54, v54 row_ror:4 row_mask:0xf bank_mask:0x8
    v_add_f32_dpp v31, v55, v55 row_ror:4 row_mask:0xf bank_mask:0x8
    ds_write_b128 v6, v[28:31]
    s_mov_b64 exec, 1
    ds_add_rtn_u32 v34, v32, v33
    s_mov_b64 exec, -1
    ds_read_b128 v[8:11], v5
    ds_read_b128 v[12:15], v5 offset:1024
    ds_read_b128 v[16:19], v5 offset:2048
    ds_read_b128 v[20:23], v5 offset:3072
    s_waitcnt lgkmcnt(0)
    v_readfirstlane_b32 s62, v34
    v_mov_b32 v24, s58
    s_cmp_eq_u32 s62, s15
    s_cbranch_scc1 L_u_last
    s_cmp_eq_u32 s62, 1
    s_cbranch_scc1 L_service
    s_endpgm
L_u_last:
    v_add_f32 v8, v8, v12
    v_add_f32 v9, v9, v13
    v_add_f32 v10, v10, v14
    v_add_f32 v11, v11, v15
    s_cmp_eq_u32 s15, 1
    s_cbranch_scc1 L_u_two
    v_add_f32 v16, v16, v20
    v_add_f32 v17, v17, v21
    v_add_f32 v18, v18, v22
    v_add_f32 v19, v19, v23
    v_add_f32 v8, v8, v16
    v_add_f32 v9, v9, v17
    v_add_f32 v10, v10, v18
    v_add_f32 v11, v11, v19
L_u_two:
    v_fma_f32 v8, v8, s59, v24
    v_fma_f32 v9, v9, s59, v24
    v_fma_f32 v10, v10, s59, v24
    v_fma_f32 v11, v11, s59, v24
    v_mul_f32 v8, v8, v56
    v_mul_f32 v9, v9, v57
    v_mul_f32 v10, v10, v58
    v_mul_f32 v11, v11, v59
    v_cvt_pk_bf16_f32 v8, v8, v9
    v_cvt_pk_bf16_f32 v9, v10, v11
    buffer_store_dwordx2 v[8:9], v64, s[40:43], s57 offen sc1
    s_endpgm
L_touch:
    s_load_dword s0, s[32:33], 0
    s_load_dword s0, s[30:31], 0
    s_cmp_eq_u32 s39, 1
    s_cbranch_scc1 L_tpr
    s_mov_b32 s62, 16777216
    s_load_dword s0, s[8:9], s62
    s_mov_b32 s62, 83886080
    s_load_dword s0, s[8:9], s62
    s_mov_b32 s62, 150994944
    s_load_dword s0, s[8:9], s62
    s_mov_b32 s62, 218103808
    s_load_dword s0, s[8:9], s62
    s_branch L_tpv
L_tpr:
    s_load_dword s0, s[20:21], 0
    s_mov_b32 s62, 2211836
    s_load_dword s0, s[20:21], s62
    s_load_dword s0, s[16:17], 0
    s_mov_b32 s62, 2211836
    s_load_dword s0, s[16:17], s62
    s_load_dword s0, s[18:19], 0
    s_load_dword s0, s[22:23], 0
    s_load_dword s0, s[28:29], 0
    s_load_dword s0, s[4:5], 0
L_tpv:
    s_lshl_b32 s62, s34, 23
    s_load_dword s0, s[8:9], s62
    s_add_u32 s62, s62, 67108864
    s_load_dword s0, s[8:9], s62
    s_add_u32 s62, s62, 67108864
    s_load_dword s0, s[8:9], s62
    s_add_u32 s62, s62, 67108864
    s_load_dword s0, s[8:9], s62
    s_add_u32 s62, s62, 67108864
    s_branch L_notp
L_stream2:
    s_mov_b32 s12, s100
    s_mov_b32 s13, s101
    s_mov_b32 s40, s32
    s_mov_b32 s41, s33
    s_mov_b32 s42, 589824
    s_mov_b32 s43, 0x20000
    s_mov_b32 s44, s30
    s_mov_b32 s45, s31
    s_mov_b32 s46, 256
    s_mov_b32 s47, 0x20000
    s_bitcmp1_b32 s3, 0
    s_mov_b32 s57, 0xffffffff
    s_mov_b32 s58, 0xffff
    s_mov_b32 s14, 0xffffffff
    s_mov_b32 s15, 0x0
L_pm_10:
    s_cmp_lt_u32 s56, 104
    s_cbranch_scc0 L_pm_11
    s_bitcmp1_b32 s3, 0
    s_mov_b32 s57, 0xffff
    s_mov_b32 s58, 0x0
    s_mov_b32 s14, 0xffffffff
    s_mov_b32 s15, 0x0
L_pm_11:
    s_sub_u32 s96, s56, 43
    s_and_b32 s96, s96, 0xffffffc7
    s_cmp_eq_u32 s96, 0
    s_cbranch_scc0 L_pm_12
    s_bitcmp1_b32 s3, 0
    s_mov_b32 s57, 0x0
    s_mov_b32 s58, 0x0
    s_mov_b32 s14, 0x0
    s_mov_b32 s15, 0x0
L_pm_12:
    s_cmp_lt_u32 s56, 40
    s_cbranch_scc0 L_pm_13
    s_bitcmp1_b32 s3, 0
    s_mov_b32 s57, 0xffffffff
    s_mov_b32 s58, 0xf
    s_mov_b32 s14, 0xffffffff
    s_mov_b32 s15, 0x0
L_pm_13:
    s_cmp_eq_u32 s39, 1
    s_cbranch_scc0 L_pm_14
    s_bitcmp1_b32 s3, 0
    s_mov_b32 s57, 0xff0fff
    s_cselect_b32 s57, 0xff00ffff, s57
    s_mov_b32 s58, 0xfff
    s_mov_b32 s14, 0xff00ff
    s_cselect_b32 s14, 0xff00ff00, s14
    s_mov_b32 s15, 0x0
L_pm_14:
    s_cmp_lg_u32 s13, 0
    s_cbranch_scc0 L_pm_15
    s_bitcmp1_b32 s3, 0
    s_mov_b32 s57, 0xffffffff
    s_mov_b32 s58, 0x0
    s_mov_b32 s14, 0x0
    s_mov_b32 s15, 0x0
L_pm_15:
    s_and_b32 s96, s39, s59
    s_cbranch_scc0 L_pm_16
    s_bitcmp1_b32 s3, 0
    s_mov_b32 s57, 0xffff
    s_mov_b32 s58, 0xffff
    s_mov_b32 s14, 0x0
    s_mov_b32 s15, 0x0
L_pm_16:
    s_add_u32 s52, s8, s63
    s_addc_u32 s53, s9, 0
    s_mov_b32 s54, 262144
    s_mov_b32 s55, 0x20000
    v_and_b32 v2, 15, v0
    v_lshrrev_b32 v3, 1, v2
    v_and_b32 v37, 1, v2
    v_lshlrev_b32 v37, 4, v37
    v_mov_b32 v38, 0xffff
    v_lshlrev_b32 v37, v37, v38
    v_cmp_eq_u32 vcc, 0, v3
    v_mov_b32 v32, 0
    s_nop 0
    v_cndmask_b32 v20, 0, v37, vcc
    v_cmp_eq_u32 vcc, 1, v3
    v_mov_b32 v33, 0
    s_nop 0
    v_cndmask_b32 v21, 0, v37, vcc
    v_cmp_eq_u32 vcc, 2, v3
    v_mov_b32 v34, 0
    s_nop 0
    v_cndmask_b32 v22, 0, v37, vcc
    v_cmp_eq_u32 vcc, 3, v3
    v_mov_b32 v35, 0
    s_nop 0
    v_cndmask_b32 v23, 0, v37, vcc
    v_lshlrev_b32 v2, 4, v2
    s_lshl_b32 s98, s62, 8
    s_add_u32 s98, s98, 40960
    s_lshl_b32 s99, s62, 7
    s_add_u32 s99, s99, 73728
    s_bitcmp0_b32 s57, 2
    s_cbranch_scc1 L_sf_17
    s_bitcmp0_b32 s58, 2
    s_cbranch_scc1 L_sf_17
    s_waitcnt vmcnt(1)
L_sf_17:
    buffer_load_dwordx4 v[48:51], v1, s[48:51], s97 offen offset:2048 nt
    s_bitcmp0_b32 s57, 3
    s_cbranch_scc1 L_sf_18
    s_waitcnt vmcnt(2)
    s_bitcmp0_b32 s58, 3
    s_cbranch_scc1 L_sf_18
    s_waitcnt vmcnt(1)
L_sf_18:
    buffer_load_dwordx4 v[52:55], v1, s[48:51], s97 offen offset:3072 nt
    s_add_u32 s97, s97, 32768
    v_add_u32 v1, 4096, v1
    v_and_b32 v1, 0x7fff, v1
    s_waitcnt vmcnt(3)
    s_bitcmp0_b32 s57, 4
    s_cbranch_scc1 L_sf_19
    s_waitcnt vmcnt(2)
    s_bitcmp0_b32 s58, 4
    s_cbranch_scc1 L_sf_19
    s_waitcnt vmcnt(1)
L_sf_19:
    buffer_load_dwordx4 v[56:59], v1, s[48:51], s97 offen offset:0 nt
    s_waitcnt vmcnt(3)
    s_bitcmp0_b32 s57, 5
    s_cbranch_scc1 L_sf_20
    s_waitcnt vmcnt(2)
    s_bitcmp0_b32 s58, 5
    s_cbranch_scc1 L_sf_20
    s_waitcnt vmcnt(1)
L_sf_20:
    buffer_load_dwordx4 v[60:63], v1, s[48:51], s97 offen offset:1024 nt
    s_waitcnt vmcnt(3)
    s_bitcmp0_b32 s57, 6
    s_cbranch_scc1 L_sf_21
    s_waitcnt vmcnt(2)
    s_bitcmp0_b32 s58, 6
    s_cbranch_scc1 L_sf_21
    s_waitcnt vmcnt(1)
L_sf_21:
    buffer_load_dwordx4 v[64:67], v1, s[48:51], s97 offen offset:2048 nt
    s_waitcnt vmcnt(3)
    s_bitcmp0_b32 s57, 7
    s_cbranch_scc1 L_sf_22
    s_waitcnt vmcnt(2)
    s_bitcmp0_b32 s58, 7
    s_cbranch_scc1 L_sf_22
    s_waitcnt vmcnt(1)
L_sf_22:
    buffer_load_dwordx4 v[68:71], v1, s[48:51], s97 offen offset:3072 nt
    s_add_u32 s97, s97, 32768
    v_add_u32 v1, 4096, v1
    v_and_b32 v1, 0x7fff, v1
    s_waitcnt vmcnt(3)
    s_bitcmp0_b32 s57, 8
    s_cbranch_scc1 L_sf_23
    s_waitcnt vmcnt(2)
    s_bitcmp0_b32 s58, 8
    s_cbranch_scc1 L_sf_23
    s_waitcnt vmcnt(1)
L_sf_23:
    buffer_load_dwordx4 v[72:75], v1, s[48:51], s97 offen offset:0 nt
    s_waitcnt vmcnt(3)
    s_bitcmp0_b32 s57, 9
    s_cbranch_scc1 L_sf_24
    s_waitcnt vmcnt(2)
    s_bitcmp0_b32 s58, 9
    s_cbranch_scc1 L_sf_24
    s_waitcnt vmcnt(1)
L_sf_24:
    buffer_load_dwordx4 v[76:79], v1, s[48:51], s97 offen offset:1024 nt
    s_waitcnt vmcnt(3)
    s_bitcmp0_b32 s57, 10
    s_cbranch_scc1 L_sf_25
    s_waitcnt vmcnt(2)
    s_bitcmp0_b32 s58, 10
    s_cbranch_scc1 L_sf_25
    s_waitcnt vmcnt(1)
L_sf_25:
    buffer_load_dwordx4 v[80:83], v1, s[48:51], s97 offen offset:2048 nt
    s_waitcnt vmcnt(3)
    s_bitcmp0_b32 s57, 11
    s_cbranch_scc1 L_sf_26
    s_waitcnt vmcnt(2)
    s_bitcmp0_b32 s58, 11
    s_cbranch_scc1 L_sf_26
    s_waitcnt vmcnt(1)
L_sf_26:
    buffer_load_dwordx4 v[84:87], v1, s[48:51], s97 offen offset:3072 nt
    s_add_u32 s97, s97, 32768
    v_add_u32 v1, 4096, v1
    v_and_b32 v1, 0x7fff, v1
    s_waitcnt vmcnt(3)
    s_bitcmp0_b32 s57, 12
    s_cbranch_scc1 L_sf_27
    s_waitcnt vmcnt(2)
    s_bitcmp0_b32 s58, 12
    s_cbranch_scc1 L_sf_27
    s_waitcnt vmcnt(1)
L_sf_27:
    buffer_load_dwordx4 v[88:91], v1, s[48:51], s97 offen offset:0 nt
    s_waitcnt vmcnt(3)
    s_bitcmp0_b32 s57, 13
    s_cbranch_scc1 L_sf_28
    s_waitcnt vmcnt(2)
    s_bitcmp0_b32 s58, 13
    s_cbranch_scc1 L_sf_28
    s_waitcnt vmcnt(1)
L_sf_28:
    buffer_load_dwordx4 v[92:95], v1, s[48:51], s97 offen offset:1024 nt
    s_waitcnt vmcnt(3)
    s_bitcmp0_b32 s57, 14
    s_cbranch_scc1 L_sf_29
    s_waitcnt vmcnt(2)
    s_bitcmp0_b32 s58, 14
    s_cbranch_scc1 L_sf_29
    s_waitcnt vmcnt(1)
L_sf_29:
    buffer_load_dwordx4 v[96:99], v1, s[48:51], s97 offen offset:2048 nt
    s_waitcnt vmcnt(3)
    s_bitcmp0_b32 s57, 15
    s_cbranch_scc1 L_sf_30
    s_waitcnt vmcnt(2)
    s_bitcmp0_b32 s58, 15
    s_cbranch_scc1 L_sf_30
    s_waitcnt vmcnt(1)
L_sf_30:
    buffer_load_dwordx4 v[100:103], v1, s[48:51], s97 offen offset:3072 nt
    s_add_u32 s97, s97, 32768
    v_add_u32 v1, 4096, v1
    v_and_b32 v1, 0x7fff, v1
    s_waitcnt vmcnt(3)
    s_bitcmp0_b32 s57, 16
    s_cbranch_scc1 L_sf_31
    s_waitcnt vmcnt(2)
    s_bitcmp0_b32 s58, 16
    s_cbranch_scc1 L_sf_31
    s_waitcnt vmcnt(1)
L_sf_31:
    buffer_load_dwordx4 v[104:107], v1, s[48:51], s97 offen offset:0 nt
    s_waitcnt vmcnt(3)
    s_bitcmp0_b32 s57, 17
    s_cbranch_scc1 L_sf_32
    s_waitcnt vmcnt(2)
    s_bitcmp0_b32 s58, 17
    s_cbranch_scc1 L_sf_32
    s_waitcnt vmcnt(1)
L_sf_32:
    buffer_load_dwordx4 v[108:111], v1, s[48:51], s97 offen offset:1024 nt
    s_waitcnt vmcnt(3)
    s_bitcmp0_b32 s57, 18
    s_cbranch_scc1 L_sf_33
    s_waitcnt vmcnt(2)
    s_bitcmp0_b32 s58, 18
    s_cbranch_scc1 L_sf_33
    s_waitcnt vmcnt(1)
L_sf_33:
    buffer_load_dwordx4 v[112:115], v1, s[48:51], s97 offen offset:2048 nt
    s_waitcnt vmcnt(3)
    s_bitcmp0_b32 s57, 19
    s_cbranch_scc1 L_sf_34
    s_waitcnt vmcnt(2)
    s_bitcmp0_b32 s58, 19
    s_cbranch_scc1 L_sf_34
    s_waitcnt vmcnt(1)
L_sf_34:
    buffer_load_dwordx4 v[116:119], v1, s[48:51], s97 offen offset:3072 nt
    s_add_u32 s97, s97, 32768
    v_add_u32 v1, 4096, v1
    v_and_b32 v1, 0x7fff, v1
    s_waitcnt vmcnt(3)
    s_bitcmp0_b32 s57, 20
    s_cbranch_scc1 L_sf_35
    s_waitcnt vmcnt(2)
    s_bitcmp0_b32 s58, 20
    s_cbranch_scc1 L_sf_35
    s_waitcnt vmcnt(1)
L_sf_35:
    buffer_load_dwordx4 v[120:123], v1, s[48:51], s97 offen offset:0 nt
    s_waitcnt vmcnt(3)
    s_bitcmp0_b32 s57, 21
    s_cbranch_scc1 L_sf_36
    s_waitcnt vmcnt(2)
    s_bitcmp0_b32 s58, 21
    s_cbranch_scc1 L_sf_36
    s_waitcnt vmcnt(1)
L_sf_36:
    buffer_load_dwordx4 v[124:127], v1, s[48:51], s97 offen offset:1024 nt
    s_cmp_eq_u32 s12, -1
    s_cbranch_scc1 L_k_nopf
    s_waitcnt vmcnt(3)
    s_bitcmp0_b32 s57, 22
    s_cbranch_scc1 L_sf_37
    s_waitcnt vmcnt(2)
    s_bitcmp0_b32 s58, 22
    s_cbranch_scc1 L_sf_37
    s_waitcnt vmcnt(1)
L_sf_37:
    buffer_load_dwordx4 v[128:131], v1, s[48:51], s97 offen offset:2048 nt
    s_waitcnt vmcnt(3)
    s_bitcmp0_b32 s57, 23
    s_cbranch_scc1 L_sf_38
    s_waitcnt vmcnt(2)
    s_bitcmp0_b32 s58, 23
    s_cbranch_scc1 L_sf_38
    s_waitcnt vmcnt(1)
L_sf_38:
    buffer_load_dwordx4 v[132:135], v1, s[48:51], s97 offen offset:3072 nt
    s_add_u32 s97, s97, 32768
    v_add_u32 v1, 4096, v1
    v_and_b32 v1, 0x7fff, v1
    s_waitcnt vmcnt(3)
    s_bitcmp0_b32 s57, 24
    s_cbranch_scc1 L_sf_39
    s_waitcnt vmcnt(2)
    s_bitcmp0_b32 s58, 24
    s_cbranch_scc1 L_sf_39
    s_waitcnt vmcnt(1)
L_sf_39:
    buffer_load_dwordx4 v[136:139], v1, s[48:51], s97 offen offset:0 nt
    s_waitcnt vmcnt(3)
    s_bitcmp0_b32 s57, 25
    s_cbranch_scc1 L_sf_40
    s_waitcnt vmcnt(2)
    s_bitcmp0_b32 s58, 25
    s_cbranch_scc1 L_sf_40
    s_waitcnt vmcnt(1)
L_sf_40:
    buffer_load_dwordx4 v[140:143], v1, s[48:51], s97 offen offset:1024 nt
    s_waitcnt vmcnt(3)
    s_bitcmp0_b32 s57, 26
    s_cbranch_scc1 L_sf_41
    s_waitcnt vmcnt(2)
    s_bitcmp0_b32 s58, 26
    s_cbranch_scc1 L_sf_41
    s_waitcnt vmcnt(1)
L_sf_41:
    buffer_load_dwordx4 v[144:147], v1, s[48:51], s97 offen offset:2048 nt
    s_waitcnt vmcnt(3)
    s_bitcmp0_b32 s57, 27
    s_cbranch_scc1 L_sf_42
    s_waitcnt vmcnt(2)
    s_bitcmp0_b32 s58, 27
    s_cbranch_scc1 L_sf_42
    s_waitcnt vmcnt(1)
L_sf_42:
    buffer_load_dwordx4 v[148:151], v1, s[48:51], s97 offen offset:3072 nt
    s_add_u32 s97, s97, 32768
    v_add_u32 v1, 4096, v1
    v_and_b32 v1, 0x7fff, v1
    s_waitcnt vmcnt(3)
    s_bitcmp0_b32 s57, 28
    s_cbranch_scc1 L_sf_43
    s_waitcnt vmcnt(2)
    s_bitcmp0_b32 s58, 28
    s_cbranch_scc1 L_sf_43
    s_waitcnt vmcnt(1)
L_sf_43:
    buffer_load_dwordx4 v[152:155], v1, s[48:51], s97 offen offset:0 nt
    s_waitcnt vmcnt(3)
    s_bitcmp0_b32 s57, 29
    s_cbranch_scc1 L_sf_44
    s_waitcnt vmcnt(2)
    s_bitcmp0_b32 s58, 29
    s_cbranch_scc1 L_sf_44
    s_waitcnt vmcnt(1)
L_sf_44:
    buffer_load_dwordx4 v[156:159], v1, s[48:51], s97 offen offset:1024 nt
    s_waitcnt vmcnt(3)
    s_bitcmp0_b32 s57, 30
    s_cbranch_scc1 L_sf_45
    s_waitcnt vmcnt(2)
    s_bitcmp0_b32 s58, 30
    s_cbranch_scc1 L_sf_45
    s_waitcnt vmcnt(1)
L_sf_45:
    buffer_load_dwordx4 v[160:163], v1, s[48:51], s97 offen offset:2048 nt
    v_min_u32 v39, 29, v0
    v_lshlrev_b32 v39, 2, v39
    buffer_load_dword v37, v39, s[44:47], 0 offen sc1
    s_waitcnt vmcnt(4)
    s_bitcmp0_b32 s57, 31
    s_cbranch_scc1 L_sf_46
    s_waitcnt vmcnt(3)
    s_bitcmp0_b32 s58, 31
    s_cbranch_scc1 L_sf_46
    s_waitcnt vmcnt(2)
L_sf_46:
    buffer_load_dwordx4 v[164:167], v1, s[48:51], s97 offen offset:3072 nt
    s_mov_b32 s97, 0
    v_add_u32 v1, 4096, v1
    v_and_b32 v1, 0x7fff, v1
    s_waitcnt vmcnt(4)
    s_bitcmp0_b32 s14, 0
    s_cbranch_scc1 L_sf_47
    s_waitcnt vmcnt(3)
    s_bitcmp0_b32 s15, 0
    s_cbranch_scc1 L_sf_47
    s_waitcnt vmcnt(2)
L_sf_47:
    s_add_u32 m0, s12, 0
    s_nop 0
    buffer_load_dwordx4 v1, s[52:55], s97 offen offset:0 nt lds
    s_waitcnt vmcnt(4)
    s_bitcmp0_b32 s14, 1
    s_cbranch_scc1 L_sf_48
    s_waitcnt vmcnt(3)
    s_bitcmp0_b32 s15, 1
    s_cbranch_scc1 L_sf_48
    s_waitcnt vmcnt(1)
L_sf_48:
    buffer_load_dwordx4 v1, s[52:55], s97 offen offset:1024 nt lds
    s_waitcnt vmcnt(4)
    s_bitcmp0_b32 s14, 2
    s_cbranch_scc1 L_sf_49
    s_waitcnt vmcnt(2)
    s_bitcmp0_b32 s15, 2
    s_cbranch_scc1 L_sf_49
    s_waitcnt vmcnt(1)
L_sf_49:
    buffer_load_dwordx4 v1, s[52:55], s97 offen offset:2048 nt lds
    s_waitcnt vmcnt(3)
    s_bitcmp0_b32 s14, 3
    s_cbranch_scc1 L_sf_50
    s_waitcnt vmcnt(2)
    s_bitcmp0_b32 s15, 3
    s_cbranch_scc1 L_sf_50
    s_waitcnt vmcnt(1)
L_sf_50:
    buffer_load_dwordx4 v1, s[52:55], s97 offen offset:3072 nt lds
    s_add_u32 s97, s97, 32768
    v_add_u32 v1, 4096, v1
    v_and_b32 v1, 0x7fff, v1
    v_cmp_eq_u32 vcc, 0, v37
    s_nop 0
    s_or_b32 s96, vcc_lo, vcc_hi
    buffer_load_dwordx4 v[4:7], v2, s[40:43], s98 offen sc1
    s_waitcnt vmcnt(4)
    s_bitcmp0_b32 s14, 4
    s_cbranch_scc1 L_sf_51
    s_waitcnt vmcnt(3)
    s_bitcmp0_b32 s15, 4
    s_cbranch_scc1 L_sf_51
    s_waitcnt vmcnt(2)
L_sf_51:
    s_add_u32 m0, s12, 4096
    s_nop 0
    buffer_load_dwordx4 v1, s[52:55], s97 offen offset:0 nt lds
    s_waitcnt vmcnt(4)
    s_bitcmp0_b32 s14, 5
    s_cbranch_scc1 L_sf_52
    s_waitcnt vmcnt(3)
    s_bitcmp0_b32 s15, 5
    s_cbranch_scc1 L_sf_52
    s_waitcnt vmcnt(2)
L_sf_52:
    buffer_load_dwordx4 v1, s[52:55], s97 offen offset:1024 nt lds
    s_waitcnt vmcnt(4)
    s_bitcmp0_b32 s14, 6
    s_cbranch_scc1 L_sf_53
    s_waitcnt vmcnt(3)
    s_bitcmp0_b32 s15, 6
    s_cbranch_scc1 L_sf_53
    s_waitcnt vmcnt(1)
L_sf_53:
    buffer_load_dwordx4 v1, s[52:55], s97 offen offset:2048 nt lds
    s_waitcnt vmcnt(4)
    s_bitcmp0_b32 s14, 7
    s_cbranch_scc1 L_sf_54
    s_waitcnt vmcnt(2)
    s_bitcmp0_b32 s15, 7
    s_cbranch_scc1 L_sf_54
    s_waitcnt vmcnt(1)
L_sf_54:
    buffer_load_dwordx4 v1, s[52:55], s97 offen offset:3072 nt lds
    s_add_u32 s97, s97, 32768
    v_add_u32 v1, 4096, v1
    v_and_b32 v1, 0x7fff, v1
L_k_join:
    s_waitcnt vmcnt(4)
    v_max3_u32 v38, v4, v5, v6
    v_max_u32 v38, v38, v7
    v_cmp_eq_u32 vcc, -1, v38
    s_cmp_lg_u32 s96, 0
    s_cbranch_scc1 L_qslow
    s_cbranch_vccnz L_qslow2
L_qok:
    v_dot2_f32_bf16 v8, v72, v4, 0
    v_dot2_f32_bf16 v9, v76, v4, 0
    v_dot2_f32_bf16 v10, v80, v4, 0
    v_dot2_f32_bf16 v11, v84, v4, 0
    v_dot2_f32_bf16 v24, v88, v4, 0
    v_dot2_f32_bf16 v25, v92, v4, 0
    v_dot2_f32_bf16 v26, v96, v4, 0
    v_dot2_f32_bf16 v27, v100, v4, 0
    v_dot2_f32_bf16 v8, v73, v5, v8
    v_dot2_f32_bf16 v9, v77, v5, v9
    v_dot2_f32_bf16 v10, v81, v5, v10
    v_dot2_f32_bf16 v11, v85, v5, v11
    v_dot2_f32_bf16 v24, v89, v5, v24
    v_dot2_f32_bf16 v25, v93, v5, v25
    v_dot2_f32_bf16 v26, v97, v5, v26
    v_dot2_f32_bf16 v27, v101, v5, v27
    v_dot2_f32_bf16 v8, v74, v6, v8
    v_dot2_f32_bf16 v9, v78, v6, v9
    v_dot2_f32_bf16 v10, v82, v6, v10
    v_dot2_f32_bf16 v11, v86, v6, v11
    v_dot2_f32_bf16 v24, v90, v6, v24
    v_dot2_f32_bf16 v25, v94, v6, v25
    v_dot2_f32_bf16 v26, v98, v6, v26
    v_dot2_f32_bf16 v27, v102, v6, v27
    v_dot2_f32_bf16 v8, v75, v7, v8
    v_dot2_f32_bf16 v9, v79, v7, v9
    v_dot2_f32_bf16 v10, v83, v7, v10
    v_dot2_f32_bf16 v11, v87, v7, v11
    v_dot2_f32_bf16 v24, v91, v7, v24
    v_dot2_f32_bf16 v25, v95, v7, v25
    v_dot2_f32_bf16 v26, v99, v7, v26
    v_dot2_f32_bf16 v27, v103, v7, v27
    v_add_f32_dpp v8, v8, v8 row_ror:8 row_mask:0xf bank_mask:0x3
    v_add_f32_dpp v10, v10, v10 row_ror:8 row_mask:0xf bank_mask:0x3
    v_add_f32_dpp v24, v24, v24 row_ror:8 row_mask:0xf bank_mask:0x3
    v_add_f32_dpp v26, v26, v26 row_ror:8 row_mask:0xf bank_mask:0x3
    v_add_f32_dpp v8, v9, v9 row_ror:8 row_mask:0xf bank_mask:0xc
    v_add_f32_dpp v10, v11, v11 row_ror:8 row_mask:0xf bank_mask:0xc
    v_add_f32_dpp v24, v25, v25 row_ror:8 row_mask:0xf bank_mask:0xc
    v_add_f32_dpp v26, v27, v27 row_ror:8 row_mask:0xf bank_mask:0xc
    v_add_f32_dpp v14, v8, v8 row_half_mirror row_mask:0xf bank_mask:0x5
    v_add_f32_dpp v15, v24, v24 row_half_mirror row_mask:0xf bank_mask:0x5
    v_add_f32_dpp v14, v10, v10 row_half_mirror row_mask:0xf bank_mask:0xa
    v_add_f32_dpp v15, v26, v26 row_half_mirror row_mask:0xf bank_mask:0xa
    s_nop 0
    v_add_f32_dpp v14, v14, v14 quad_perm:[1,0,3,2] row_mask:0xf bank_mask:0xf
    v_add_f32_dpp v15, v15, v15 quad_perm:[1,0,3,2] row_mask:0xf bank_mask:0xf
    s_nop 0
    v_add_f32_dpp v14, v14, v14 quad_perm:[2,3,0,1] row_mask:0xf bank_mask:0xf
    v_add_f32_dpp v15, v15, v15 quad_perm:[2,3,0,1] row_mask:0xf bank_mask:0xf
    s_waitcnt vmcnt(3)
    s_bitcmp0_b32 s14, 8
    s_cbranch_scc1 L_sf_65
    s_waitcnt vmcnt(2)
    s_bitcmp0_b32 s15, 8
    s_cbranch_scc1 L_sf_65
    s_waitcnt vmcnt(1)
L_sf_65:
    buffer_load_dwordx4 v[72:75], v1, s[52:55], s97 offen offset:0 nt
    v_dot2_f32_bf16 v8, v40, v4, 0
    v_dot2_f32_bf16 v9, v44, v4, 0
    v_dot2_f32_bf16 v10, v48, v4, 0
    v_dot2_f32_bf16 v11, v52, v4, 0
    v_dot2_f32_bf16 v24, v56, v4, 0
    v_dot2_f32_bf16 v25, v60, v4, 0
    v_dot2_f32_bf16 v26, v64, v4, 0
    v_dot2_f32_bf16 v27, v68, v4, 0
    v_dot2_f32_bf16 v28, v104, v4, 0
    v_dot2_f32_bf16 v29, v108, v4, 0
    v_dot2_f32_bf16 v30, v112, v4, 0
    v_dot2_f32_bf16 v31, v116, v4, 0
    v_dot2_f32_bf16 v8, v41, v5, v8
    v_dot2_f32_bf16 v9, v45, v5, v9
    v_dot2_f32_bf16 v10, v49, v5, v10
    v_dot2_f32_bf16 v11, v53, v5, v11
    v_dot2_f32_bf16 v24, v57, v5, v24
    v_dot2_f32_bf16 v25, v61, v5, v25
    v_dot2_f32_bf16 v26, v65, v5, v26
    v_dot2_f32_bf16 v27, v69, v5, v27
    v_dot2_f32_bf16 v28, v105, v5, v28
    v_dot2_f32_bf16 v29, v109, v5, v29
    v_dot2_f32_bf16 v30, v113, v5, v30
    v_dot2_f32_bf16 v31, v117, v5, v31
    v_dot2_f32_bf16 v8, v42, v6, v8
    v_dot2_f32_bf16 v9, v46, v6, v9
    v_dot2_f32_bf16 v10, v50, v6, v10
    v_dot2_f32_bf16 v11, v54, v6, v11
    v_dot2_f32_bf16 v24, v58, v6, v24
    v_dot2_f32_bf16 v25, v62, v6, v25
    v_dot2_f32_bf16 v26, v66, v6, v26
    v_dot2_f32_bf16 v27, v70, v6, v27
    v_dot2_f32_bf16 v28, v106, v6, v28
    v_dot2_f32_bf16 v29, v110, v6, v29
    v_dot2_f32_bf16 v30, v114, v6, v30
    v_dot2_f32_bf16 v31, v118, v6, v31
    v_dot2_f32_bf16 v8, v43, v7, v8
    v_dot2_f32_bf16 v9, v47, v7, v9
    v_dot2_f32_bf16 v10, v51, v7, v10
    v_dot2_f32_bf16 v11, v55, v7, v11
    v_dot2_f32_bf16 v24, v59, v7, v24
    v_dot2_f32_bf16 v25, v63, v7, v25
    v_dot2_f32_bf16 v26, v67, v7, v26
    v_dot2_f32_bf16 v27, v71, v7, v27
    v_dot2_f32_bf16 v28, v107, v7, v28
    v_dot2_f32_bf16 v29, v111, v7, v29
    v_dot2_f32_bf16 v30, v115, v7, v30
    v_dot2_f32_bf16 v31, v119, v7, v31
    v_add_f32_dpp v8, v8, v8 row_ror:8 row_mask:0xf bank_mask:0x3
    v_add_f32_dpp v10, v10, v10 row_ror:8 row_mask:0xf bank_mask:0x3
    v_add_f32_dpp v24, v24, v24 row_ror:8 row_mask:0xf bank_mask:0x3
    v_add_f32_dpp v26, v26, v26 row_ror:8 row_mask:0xf bank_mask:0x3
    v_add_f32_dpp v28, v28, v28 row_ror:8 row_mask:0xf bank_mask:0x3
    v_add_f32_dpp v30, v30, v30 row_ror:8 row_mask:0xf bank_mask:0x3
    v_add_f32_dpp v8, v9, v9 row_ror:8 row_mask:0xf bank_mask:0xc
    v_add_f32_dpp v10, v11, v11 row_ror:8 row_mask:0xf bank_mask:0xc
    v_add_f32_dpp v24, v25, v25 row_ror:8 row_mask:0xf bank_mask:0xc
    v_add_f32_dpp v26, v27, v27 row_ror:8 row_mask:0xf bank_mask:0xc
    v_add_f32_dpp v28, v29, v29 row_ror:8 row_mask:0xf bank_mask:0xc
    v_add_f32_dpp v30, v31, v31 row_ror:8 row_mask:0xf bank_mask:0xc
    v_add_f32_dpp v12, v8, v8 row_half_mirror row_mask:0xf bank_mask:0x5
    v_add_f32_dpp v13, v24, v24 row_half_mirror row_mask:0xf bank_mask:0x5
    v_add_f32_dpp v16, v28, v28 row_half_mirror row_mask:0xf bank_mask:0x5
    v_add_f32_dpp v12, v10, v10 row_half_mirror row_mask:0xf bank_mask:0xa
    v_add_f32_dpp v13, v26, v26 row_half_mirror row_mask:0xf bank_mask:0xa
    v_add_f32_dpp v16, v30, v30 row_half_mirror row_mask:0xf bank_mask:0xa
    v_add_f32_dpp v12, v12, v12 quad_perm:[1,0,3,2] row_mask:0xf bank_mask:0xf
    v_add_f32_dpp v13, v13, v13 quad_perm:[1,0,3,2] row_mask:0xf bank_mask:0xf
    v_add_f32_dpp v16, v16, v16 quad_perm:[1,0,3,2] row_mask:0xf bank_mask:0xf
    v_add_f32_dpp v12, v12, v12 quad_perm:[2,3,0,1] row_mask:0xf bank_mask:0xf
    v_add_f32_dpp v13, v13, v13 quad_perm:[2,3,0,1] row_mask:0xf bank_mask:0xf
    v_add_f32_dpp v16, v16, v16 quad_perm:[2,3,0,1] row_mask:0xf bank_mask:0xf
    s_waitcnt vmcnt(3)
    s_bitcmp0_b32 s14, 9
    s_cbranch_scc1 L_sf_66
    s_waitcnt vmcnt(2)
    s_bitcmp0_b32 s15, 9
    s_cbranch_scc1 L_sf_66
    s_waitcnt vmcnt(1)
L_sf_66:
    buffer_load_dwordx4 v[76:79], v1, s[52:55], s97 offen offset:1024 nt
    v_dot2_f32_bf16 v8, v120, v4, 0
    v_dot2_f32_bf16 v9, v124, v4, 0
    v_dot2_f32_bf16 v10, v128, v4, 0
    v_dot2_f32_bf16 v11, v132, v4, 0
    v_dot2_f32_bf16 v24, v136, v4, 0
    v_dot2_f32_bf16 v25, v140, v4, 0
    v_dot2_f32_bf16 v26, v144, v4, 0
    v_dot2_f32_bf16 v27, v148, v4, 0
    v_dot2_f32_bf16 v8, v121, v5, v8
    v_dot2_f32_bf16 v9, v125, v5, v9
    v_dot2_f32_bf16 v10, v129, v5, v10
    v_dot2_f32_bf16 v11, v133, v5, v11
    v_dot2_f32_bf16 v24, v137, v5, v24
    v_dot2_f32_bf16 v25, v141, v5, v25
    v_dot2_f32_bf16 v26, v145, v5, v26
    v_dot2_f32_bf16 v27, v149, v5, v27
    v_dot2_f32_bf16 v8, v122, v6, v8
    v_dot2_f32_bf16 v9, v126, v6, v9
    v_dot2_f32_bf16 v10, v130, v6, v10
    v_dot2_f32_bf16 v11, v134, v6, v11
    v_dot2_f32_bf16 v24, v138, v6, v24
    v_dot2_f32_bf16 v25, v142, v6, v25
    v_dot2_f32_bf16 v26, v146, v6, v26
    v_dot2_f32_bf16 v27, v150, v6, v27
    v_dot2_f32_bf16 v8, v123, v7, v8
    v_dot2_f32_bf16 v9, v127, v7, v9
    v_dot2_f32_bf16 v10, v131, v7, v10
    v_dot2_f32_bf16 v11, v135, v7, v11
    v_dot2_f32_bf16 v24, v139, v7, v24
    v_dot2_f32_bf16 v25, v143, v7, v25
    v_dot2_f32_bf16 v26, v147, v7, v26
    v_dot2_f32_bf16 v27, v151, v7, v27
    v_add_f32_dpp v8, v8, v8 row_ror:8 row_mask:0xf bank_mask:0x3
    v_add_f32_dpp v10, v10, v10 row_ror:8 row_mask:0xf bank_mask:0x3
    v_add_f32_dpp v24, v24, v24 row_ror:8 row_mask:0xf bank_mask:0x3
    v_add_f32_dpp v26, v26, v26 row_ror:8 row_mask:0xf bank_mask:0x3
    v_add_f32_dpp v8, v9, v9 row_ror:8 row_mask:0xf bank_mask:0xc
    v_add_f32_dpp v10, v11, v11 row_ror:8 row_mask:0xf bank_mask:0xc
    v_add_f32_dpp v24, v25, v25 row_ror:8 row_mask:0xf bank_mask:0xc
    v_add_f32_dpp v26, v27, v27 row_ror:8 row_mask:0xf bank_mask:0xc
    v_add_f32_dpp v17, v8, v8 row_half_mirror row_mask:0xf bank_mask:0x5
    v_add_f32_dpp v18, v24, v24 row_half_mirror row_mask:0xf bank_mask:0x5
    v_add_f32_dpp v17, v10, v10 row_half_mirror row_mask:0xf bank_mask:0xa
    v_add_f32_dpp v18, v26, v26 row_half_mirror row_mask:0xf bank_mask:0xa
    s_nop 0
    v_add_f32_dpp v17, v17, v17 quad_perm:[1,0,3,2] row_mask:0xf bank_mask:0xf
    v_add_f32_dpp v18, v18, v18 quad_perm:[1,0,3,2] row_mask:0xf bank_mask:0xf
    s_nop 0
    v_add_f32_dpp v17, v17, v17 quad_perm:[2,3,0,1] row_mask:0xf bank_mask:0xf
    v_add_f32_dpp v18, v18, v18 quad_perm:[2,3,0,1] row_mask:0xf bank_mask:0xf
    s_waitcnt vmcnt(3)
    s_bitcmp0_b32 s14, 10
    s_cbranch_scc1 L_sf_67
    s_waitcnt vmcnt(2)
    s_bitcmp0_b32 s15, 10
    s_cbranch_scc1 L_sf_67
    s_waitcnt vmcnt(1)
L_sf_67:
    buffer_load_dwordx4 v[80:83], v1, s[52:55], s97 offen offset:2048 nt
    s_waitcnt vmcnt(3)
    s_bitcmp0_b32 s14, 11
    s_cbranch_scc1 L_sf_68
    s_waitcnt vmcnt(2)
    s_bitcmp0_b32 s15, 11
    s_cbranch_scc1 L_sf_68
    s_waitcnt vmcnt(1)
L_sf_68:
    buffer_load_dwordx4 v[84:87], v1, s[52:55], s97 offen offset:3072 nt
    s_add_u32 s97, s97, 32768
    v_add_u32 v1, 4096, v1
    v_and_b32 v1, 0x7fff, v1
    s_cmp_eq_u32 s12, -1
    s_cbranch_scc1 L_nopfrd
    v_lshl_add_u32 v38, v0, 4, s12
    ds_read_b128 v[40:43], v38 offset:0
    ds_read_b128 v[44:47], v38 offset:1024
    ds_read_b128 v[48:51], v38 offset:2048
    ds_read_b128 v[52:55], v38 offset:3072
    ds_read_b128 v[56:59], v38 offset:4096
    ds_read_b128 v[60:63], v38 offset:5120
    ds_read_b128 v[64:67], v38 offset:6144
    ds_read_b128 v[68:71], v38 offset:7168
L_nopfrd:
    v_dot2_f32_bf16 v8, v152, v4, 0
    v_dot2_f32_bf16 v9, v156, v4, 0
    v_dot2_f32_bf16 v10, v160, v4, 0
    v_dot2_f32_bf16 v11, v164, v4, 0
    v_dot2_f32_bf16 v8, v153, v5, v8
    v_dot2_f32_bf16 v9, v157, v5, v9
    v_dot2_f32_bf16 v10, v161, v5, v10
    v_dot2_f32_bf16 v11, v165, v5, v11
    v_dot2_f32_bf16 v8, v154, v6, v8
    v_dot2_f32_bf16 v9, v158, v6, v9
    v_dot2_f32_bf16 v10, v162, v6, v10
    v_dot2_f32_bf16 v11, v166, v6, v11
    v_dot2_f32_bf16 v8, v155, v7, v8
    v_dot2_f32_bf16 v9, v159, v7, v9
    v_dot2_f32_bf16 v10, v163, v7, v10
    v_dot2_f32_bf16 v11, v167, v7, v11
    v_add_f32_dpp v8, v8, v8 row_ror:8 row_mask:0xf bank_mask:0x3
    s_nop 0
    v_add_f32_dpp v10, v10, v10 row_ror:8 row_mask:0xf bank_mask:0x3
    v_add_f32_dpp v8, v9, v9 row_ror:8 row_mask:0xf bank_mask:0xc
    v_add_f32_dpp v10, v11, v11 row_ror:8 row_mask:0xf bank_mask:0xc
    s_nop 0
    v_add_f32_dpp v19, v8, v8 row_half_mirror row_mask:0xf bank_mask:0x5
    v_add_f32_dpp v19, v10, v10 row_half_mirror row_mask:0xf bank_mask:0xa
    s_nop 1
    v_add_f32_dpp v19, v19, v19 quad_perm:[1,0,3,2] row_mask:0xf bank_mask:0xf
    s_nop 1
    v_add_f32_dpp v19, v19, v19 quad_perm:[2,3,0,1] row_mask:0xf bank_mask:0xf
    v_max3_f32 v3, v12, v13, v14
    v_max3_f32 v8, v15, v16, v17
    v_max3_f32 v3, v3, v18, v19
    v_max_f32 v3, v3, v8
    s_nop 1
    v_max_f32_dpp v3, v3, v3 row_ror:4 row_mask:0xf bank_mask:0xf
    s_nop 1
    v_max_f32_dpp v3, v3, v3 row_ror:8 row_mask:0xf bank_mask:0xf
    v_mov_b32 v8, v3
    s_nop 1
    v_permlane16_swap_b32 v3, v8
    v_max_f32 v3, v3, v8
    v_mov_b32 v8, v3
    s_nop 1
    v_permlane32_swap_b32 v3, v8
    v_max_f32 v3, v3, v8
    s_mov_b32 s96, 0x3e0293ee
    v_mul_f32 v8, s96, v3
    v_fma_f32 v12, v12, s96, -v8
    v_fma_f32 v13, v13, s96, -v8
    v_fma_f32 v14, v14, s96, -v8
    v_fma_f32 v15, v15, s96, -v8
    v_fma_f32 v16, v16, s96, -v8
    v_fma_f32 v17, v17, s96, -v8
    v_fma_f32 v18, v18, s96, -v8
    v_fma_f32 v19, v19, s96, -v8
    v_exp_f32 v12, v12
    v_exp_f32 v13, v13
    v_exp_f32 v14, v14
    v_exp_f32 v15, v15
    v_exp_f32 v16, v16
    v_exp_f32 v17, v17
    v_exp_f32 v18, v18
    v_exp_f32 v19, v19
    v_add_f32 v9, v12, v13
    v_add_f32 v10, v14, v15
    v_add_f32 v11, v16, v17
    v_add_f32 v3, v18, v19
    v_add_f32 v9, v9, v10
    v_add_f32 v3, v3, v11
    v_add_f32 v9, v9, v3
    v_cvt_pk_bf16_f32 v12, v12, v12
    v_cvt_pk_bf16_f32 v13, v13, v13
    v_cvt_pk_bf16_f32 v14, v14, v14
    v_cvt_pk_bf16_f32 v15, v15, v15
    v_cvt_pk_bf16_f32 v16, v16, v16
    v_cvt_pk_bf16_f32 v17, v17, v17
    v_cvt_pk_bf16_f32 v18, v18, v18
    v_cvt_pk_bf16_f32 v19, v19, v19
    v_add_f32_dpp v9, v9, v9 row_ror:4 row_mask:0xf bank_mask:0xf
    s_nop 1
    v_add_f32_dpp v9, v9, v9 row_ror:8 row_mask:0xf bank_mask:0xf
    v_mov_b32 v10, v9
    s_nop 1
    v_permlane16_swap_b32 v9, v10
    v_add_f32 v9, v9, v10
    v_mov_b32 v10, v9
    s_nop 1
    v_permlane32_swap_b32 v9, v10
    v_add_f32 v9, v9, v10
    s_mov_b64 exec, 1
    s_cmp_lg_u32 s13, 0
    s_cbranch_scc1 L_mljob
    s_lshl_b32 s96, s3, 3
    s_add_u32 s96, s96, 161920
    v_mov_b32 v10, s96
    v_mov_b32 v11, 162068
    v_mov_b32 v3, 1
    ds_write_b64 v10, v[8:9]
    ds_add_u32 v11, v3
L_mldone:
    s_mov_b64 exec, -1
    v_lshrrev_b32 v2, 1, v2
    v_and_b32_dpp v24, v14, v20 row_newbcast:0 row_mask:0xf bank_mask:0xf
    v_and_b32_dpp v25, v14, v21 row_newbcast:0 row_mask:0xf bank_mask:0xf
    v_and_b32_dpp v26, v14, v22 row_newbcast:0 row_mask:0xf bank_mask:0xf
    v_and_b32_dpp v27, v14, v23 row_newbcast:0 row_mask:0xf bank_mask:0xf
    s_waitcnt vmcnt(3)
    s_bitcmp0_b32 s14, 12
    s_cbranch_scc1 L_sf_69
    s_waitcnt vmcnt(2)
    s_bitcmp0_b32 s15, 12
    s_cbranch_scc1 L_sf_69
    s_waitcnt vmcnt(1)
L_sf_69:
    buffer_load_dwordx4 v[88:91], v1, s[52:55], s97 offen offset:0 nt
    v_mfma_f32_16x16x32_bf16 v[32:35], v[24:27], v[72:75], v[32:35]
    s_cmp_eq_u32 s12, -1
    s_cbranch_scc1 L_nopfpv8
    s_waitcnt lgkmcnt(0)
    v_and_b32_dpp v24, v12, v20 row_newbcast:0 row_mask:0xf bank_mask:0xf
    v_and_b32_dpp v25, v12, v21 row_newbcast:0 row_mask:0xf bank_mask:0xf
    v_and_b32_dpp v26, v12, v22 row_newbcast:0 row_mask:0xf bank_mask:0xf
    v_and_b32_dpp v27, v12, v23 row_newbcast:0 row_mask:0xf bank_mask:0xf
    s_nop 1
    v_mfma_f32_16x16x32_bf16 v[32:35], v[24:27], v[40:43], v[32:35]
    v_and_b32_dpp v28, v12, v20 row_newbcast:8 row_mask:0xf bank_mask:0xf
    v_and_b32_dpp v29, v12, v21 row_newbcast:8 row_mask:0xf bank_mask:0xf
    v_and_b32_dpp v30, v12, v22 row_newbcast:8 row_mask:0xf bank_mask:0xf
    v_and_b32_dpp v31, v12, v23 row_newbcast:8 row_mask:0xf bank_mask:0xf
    s_nop 1
    v_mfma_f32_16x16x32_bf16 v[32:35], v[28:31], v[44:47], v[32:35]
    v_and_b32_dpp v24, v12, v20 row_newbcast:4 row_mask:0xf bank_mask:0xf
    v_and_b32_dpp v25, v12, v21 row_newbcast:4 row_mask:0xf bank_mask:0xf
    v_and_b32_dpp v26, v12, v22 row_newbcast:4 row_mask:0xf bank_mask:0xf
    v_and_b32_dpp v27, v12, v23 row_newbcast:4 row_mask:0xf bank_mask:0xf
    s_nop 1
    v_mfma_f32_16x16x32_bf16 v[32:35], v[24:27], v[48:51], v[32:35]
    v_and_b32_dpp v28, v12, v20 row_newbcast:12 row_mask:0xf bank_mask:0xf
    v_and_b32_dpp v29, v12, v21 row_newbcast:12 row_mask:0xf bank_mask:0xf
    v_and_b32_dpp v30, v12, v22 row_newbcast:12 row_mask:0xf bank_mask:0xf
    v_and_b32_dpp v31, v12, v23 row_newbcast:12 row_mask:0xf bank_mask:0xf
    s_nop 1
    v_mfma_f32_16x16x32_bf16 v[32:35], v[28:31], v[52:55], v[32:35]
L_nopfpv8:
    v_and_b32_dpp v28, v14, v20 row_newbcast:8 row_mask:0xf bank_mask:0xf
    v_and_b32_dpp v29, v14, v21 row_newbcast:8 row_mask:0xf bank_mask:0xf
    v_and_b32_dpp v30, v14, v22 row_newbcast:8 row_mask:0xf bank_mask:0xf
    v_and_b32_dpp v31, v14, v23 row_newbcast:8 row_mask:0xf bank_mask:0xf
    s_waitcnt vmcnt(3)
    s_bitcmp0_b32 s14, 13
    s_cbranch_scc1 L_sf_70
    s_waitcnt vmcnt(2)
    s_bitcmp0_b32 s15, 13
    s_cbranch_scc1 L_sf_70
    s_waitcnt vmcnt(1)
L_sf_70:
    buffer_load_dwordx4 v[92:95], v1, s[52:55], s97 offen offset:1024 nt
    v_mfma_f32_16x16x32_bf16 v[32:35], v[28:31], v[76:79], v[32:35]
    s_cmp_eq_u32 s12, -1
    s_cbranch_scc1 L_nopfpv9
    s_waitcnt lgkmcnt(0)
    v_and_b32_dpp v24, v13, v20 row_newbcast:0 row_mask:0xf bank_mask:0xf
    v_and_b32_dpp v25, v13, v21 row_newbcast:0 row_mask:0xf bank_mask:0xf
    v_and_b32_dpp v26, v13, v22 row_newbcast:0 row_mask:0xf bank_mask:0xf
    v_and_b32_dpp v27, v13, v23 row_newbcast:0 row_mask:0xf bank_mask:0xf
    s_nop 1
    v_mfma_f32_16x16x32_bf16 v[32:35], v[24:27], v[56:59], v[32:35]
    v_and_b32_dpp v28, v13, v20 row_newbcast:8 row_mask:0xf bank_mask:0xf
    v_and_b32_dpp v29, v13, v21 row_newbcast:8 row_mask:0xf bank_mask:0xf
    v_and_b32_dpp v30, v13, v22 row_newbcast:8 row_mask:0xf bank_mask:0xf
    v_and_b32_dpp v31, v13, v23 row_newbcast:8 row_mask:0xf bank_mask:0xf
    s_nop 1
    v_mfma_f32_16x16x32_bf16 v[32:35], v[28:31], v[60:63], v[32:35]
    v_and_b32_dpp v24, v13, v20 row_newbcast:4 row_mask:0xf bank_mask:0xf
    v_and_b32_dpp v25, v13, v21 row_newbcast:4 row_mask:0xf bank_mask:0xf
    v_and_b32_dpp v26, v13, v22 row_newbcast:4 row_mask:0xf bank_mask:0xf
    v_and_b32_dpp v27, v13, v23 row_newbcast:4 row_mask:0xf bank_mask:0xf
    s_nop 1
    v_mfma_f32_16x16x32_bf16 v[32:35], v[24:27], v[64:67], v[32:35]
    v_and_b32_dpp v28, v13, v20 row_newbcast:12 row_mask:0xf bank_mask:0xf
    v_and_b32_dpp v29, v13, v21 row_newbcast:12 row_mask:0xf bank_mask:0xf
    v_and_b32_dpp v30, v13, v22 row_newbcast:12 row_mask:0xf bank_mask:0xf
    v_and_b32_dpp v31, v13, v23 row_newbcast:12 row_mask:0xf bank_mask:0xf
    s_nop 1
    v_mfma_f32_16x16x32_bf16 v[32:35], v[28:31], v[68:71], v[32:35]
L_nopfpv9:
    v_and_b32_dpp v24, v14, v20 row_newbcast:4 row_mask:0xf bank_mask:0xf
    v_and_b32_dpp v25, v14, v21 row_newbcast:4 row_mask:0xf bank_mask:0xf
    v_and_b32_dpp v26, v14, v22 row_newbcast:4 row_mask:0xf bank_mask:0xf
    v_and_b32_dpp v27, v14, v23 row_newbcast:4 row_mask:0xf bank_mask:0xf
    s_waitcnt vmcnt(3)
    s_bitcmp0_b32 s14, 14
    s_cbranch_scc1 L_sf_71
    s_waitcnt vmcnt(2)
    s_bitcmp0_b32 s15, 14
    s_cbranch_scc1 L_sf_71
    s_waitcnt vmcnt(1)
L_sf_71:
    buffer_load_dwordx4 v[96:99], v1, s[52:55], s97 offen offset:2048 nt
    v_mfma_f32_16x16x32_bf16 v[32:35], v[24:27], v[80:83], v[32:35]
    v_and_b32_dpp v28, v14, v20 row_newbcast:12 row_mask:0xf bank_mask:0xf
    v_and_b32_dpp v29, v14, v21 row_newbcast:12 row_mask:0xf bank_mask:0xf
    v_and_b32_dpp v30, v14, v22 row_newbcast:12 row_mask:0xf bank_mask:0xf
    v_and_b32_dpp v31, v14, v23 row_newbcast:12 row_mask:0xf bank_mask:0xf
    s_waitcnt vmcnt(3)
    s_bitcmp0_b32 s14, 15
    s_cbranch_scc1 L_sf_72
    s_waitcnt vmcnt(2)
    s_bitcmp0_b32 s15, 15
    s_cbranch_scc1 L_sf_72
    s_waitcnt vmcnt(1)
L_sf_72:
    buffer_load_dwordx4 v[100:103], v1, s[52:55], s97 offen offset:3072 nt
    s_add_u32 s97, s97, 32768
    v_add_u32 v1, 4096, v1
    v_and_b32 v1, 0x7fff, v1
    v_mfma_f32_16x16x32_bf16 v[32:35], v[28:31], v[84:87], v[32:35]
    v_and_b32_dpp v24, v15, v20 row_newbcast:0 row_mask:0xf bank_mask:0xf
    v_and_b32_dpp v25, v15, v21 row_newbcast:0 row_mask:0xf bank_mask:0xf
    v_and_b32_dpp v26, v15, v22 row_newbcast:0 row_mask:0xf bank_mask:0xf
    v_and_b32_dpp v27, v15, v23 row_newbcast:0 row_mask:0xf bank_mask:0xf
    s_waitcnt vmcnt(3)
    s_bitcmp0_b32 s14, 16
    s_cbranch_scc1 L_sf_73
    s_waitcnt vmcnt(2)
    s_bitcmp0_b32 s15, 16
    s_cbranch_scc1 L_sf_73
    s_waitcnt vmcnt(1)
L_sf_73:
    buffer_load_dwordx4 v[104:107], v1, s[52:55], s97 offen offset:0 nt
    v_mfma_f32_16x16x32_bf16 v[32:35], v[24:27], v[88:91], v[32:35]
    v_and_b32_dpp v28, v15, v20 row_newbcast:8 row_mask:0xf bank_mask:0xf
    v_and_b32_dpp v29, v15, v21 row_newbcast:8 row_mask:0xf bank_mask:0xf
    v_and_b32_dpp v30, v15, v22 row_newbcast:8 row_mask:0xf bank_mask:0xf
    v_and_b32_dpp v31, v15, v23 row_newbcast:8 row_mask:0xf bank_mask:0xf
    s_waitcnt vmcnt(3)
    s_bitcmp0_b32 s14, 17
    s_cbranch_scc1 L_sf_74
    s_waitcnt vmcnt(2)
    s_bitcmp0_b32 s15, 17
    s_cbranch_scc1 L_sf_74
    s_waitcnt vmcnt(1)
L_sf_74:
    buffer_load_dwordx4 v[108:111], v1, s[52:55], s97 offen offset:1024 nt
    v_mfma_f32_16x16x32_bf16 v[32:35], v[28:31], v[92:95], v[32:35]
    v_and_b32_dpp v24, v15, v20 row_newbcast:4 row_mask:0xf bank_mask:0xf
    v_and_b32_dpp v25, v15, v21 row_newbcast:4 row_mask:0xf bank_mask:0xf
    v_and_b32_dpp v26, v15, v22 row_newbcast:4 row_mask:0xf bank_mask:0xf
    v_and_b32_dpp v27, v15, v23 row_newbcast:4 row_mask:0xf bank_mask:0xf
    s_waitcnt vmcnt(3)
    s_bitcmp0_b32 s14, 18
    s_cbranch_scc1 L_sf_75
    s_waitcnt vmcnt(2)
    s_bitcmp0_b32 s15, 18
    s_cbranch_scc1 L_sf_75
    s_waitcnt vmcnt(1)
L_sf_75:
    buffer_load_dwordx4 v[112:115], v1, s[52:55], s97 offen offset:2048 nt
    v_mfma_f32_16x16x32_bf16 v[32:35], v[24:27], v[96:99], v[32:35]
    v_and_b32_dpp v28, v15, v20 row_newbcast:12 row_mask:0xf bank_mask:0xf
    v_and_b32_dpp v29, v15, v21 row_newbcast:12 row_mask:0xf bank_mask:0xf
    v_and_b32_dpp v30, v15, v22 row_newbcast:12 row_mask:0xf bank_mask:0xf
    v_and_b32_dpp v31, v15, v23 row_newbcast:12 row_mask:0xf bank_mask:0xf
    s_waitcnt vmcnt(3)
    s_bitcmp0_b32 s14, 19
    s_cbranch_scc1 L_sf_76
    s_waitcnt vmcnt(2)
    s_bitcmp0_b32 s15, 19
    s_cbranch_scc1 L_sf_76
    s_waitcnt vmcnt(1)
L_sf_76:
    buffer_load_dwordx4 v[116:119], v1, s[52:55], s97 offen offset:3072 nt
    s_add_u32 s97, s97, 32768
    v_add_u32 v1, 4096, v1
    v_and_b32 v1, 0x7fff, v1
    v_mfma_f32_16x16x32_bf16 v[32:35], v[28:31], v[100:103], v[32:35]
    v_and_b32_dpp v24, v16, v20 row_newbcast:0 row_mask:0xf bank_mask:0xf
    v_and_b32_dpp v25, v16, v21 row_newbcast:0 row_mask:0xf bank_mask:0xf
    v_and_b32_dpp v26, v16, v22 row_newbcast:0 row_mask:0xf bank_mask:0xf
    v_and_b32_dpp v27, v16, v23 row_newbcast:0 row_mask:0xf bank_mask:0xf
    s_waitcnt vmcnt(3)
    s_bitcmp0_b32 s14, 20
    s_cbranch_scc1 L_sf_77
    s_waitcnt vmcnt(2)
    s_bitcmp0_b32 s15, 20
    s_cbranch_scc1 L_sf_77
    s_waitcnt vmcnt(1)
L_sf_77:
    buffer_load_dwordx4 v[120:123], v1, s[52:55], s97 offen offset:0 nt
    v_mfma_f32_16x16x32_bf16 v[32:35], v[24:27], v[104:107], v[32:35]
    v_and_b32_dpp v28, v16, v20 row_newbcast:8 row_mask:0xf bank_mask:0xf
    v_and_b32_dpp v29, v16, v21 row_newbcast:8 row_mask:0xf bank_mask:0xf
    v_and_b32_dpp v30, v16, v22 row_newbcast:8 row_mask:0xf bank_mask:0xf
    v_and_b32_dpp v31, v16, v23 row_newbcast:8 row_mask:0xf bank_mask:0xf
    s_waitcnt vmcnt(3)
    s_bitcmp0_b32 s14, 21
    s_cbranch_scc1 L_sf_78
    s_waitcnt vmcnt(2)
    s_bitcmp0_b32 s15, 21
    s_cbranch_scc1 L_sf_78
    s_waitcnt vmcnt(1)
L_sf_78:
    buffer_load_dwordx4 v[124:127], v1, s[52:55], s97 offen offset:1024 nt
    v_mfma_f32_16x16x32_bf16 v[32:35], v[28:31], v[108:111], v[32:35]
    v_and_b32_dpp v24, v16, v20 row_newbcast:4 row_mask:0xf bank_mask:0xf
    v_and_b32_dpp v25, v16, v21 row_newbcast:4 row_mask:0xf bank_mask:0xf
    v_and_b32_dpp v26, v16, v22 row_newbcast:4 row_mask:0xf bank_mask:0xf
    v_and_b32_dpp v27, v16, v23 row_newbcast:4 row_mask:0xf bank_mask:0xf
    s_waitcnt vmcnt(3)
    s_bitcmp0_b32 s14, 22
    s_cbranch_scc1 L_sf_79
    s_waitcnt vmcnt(2)
    s_bitcmp0_b32 s15, 22
    s_cbranch_scc1 L_sf_79
    s_waitcnt vmcnt(1)
L_sf_79:
    buffer_load_dwordx4 v[128:131], v1, s[52:55], s97 offen offset:2048 nt
    v_mfma_f32_16x16x32_bf16 v[32:35], v[24:27], v[112:115], v[32:35]
    v_and_b32_dpp v28, v16, v20 row_newbcast:12 row_mask:0xf bank_mask:0xf
    v_and_b32_dpp v29, v16, v21 row_newbcast:12 row_mask:0xf bank_mask:0xf
    v_and_b32_dpp v30, v16, v22 row_newbcast:12 row_mask:0xf bank_mask:0xf
    v_and_b32_dpp v31, v16, v23 row_newbcast:12 row_mask:0xf bank_mask:0xf
    s_waitcnt vmcnt(3)
    s_bitcmp0_b32 s14, 23
    s_cbranch_scc1 L_sf_80
    s_waitcnt vmcnt(2)
    s_bitcmp0_b32 s15, 23
    s_cbranch_scc1 L_sf_80
    s_waitcnt vmcnt(1)
L_sf_80:
    buffer_load_dwordx4 v[132:135], v1, s[52:55], s97 offen offset:3072 nt
    s_add_u32 s97, s97, 32768
    v_add_u32 v1, 4096, v1
    v_and_b32 v1, 0x7fff, v1
    v_mfma_f32_16x16x32_bf16 v[32:35], v[28:31], v[116:119], v[32:35]
    v_and_b32_dpp v24, v17, v20 row_newbcast:0 row_mask:0xf bank_mask:0xf
    v_and_b32_dpp v25, v17, v21 row_newbcast:0 row_mask:0xf bank_mask:0xf
    v_and_b32_dpp v26, v17, v22 row_newbcast:0 row_mask:0xf bank_mask:0xf
    v_and_b32_dpp v27, v17, v23 row_newbcast:0 row_mask:0xf bank_mask:0xf
    s_waitcnt vmcnt(3)
    s_bitcmp0_b32 s14, 24
    s_cbranch_scc1 L_sf_81
    s_waitcnt vmcnt(2)
    s_bitcmp0_b32 s15, 24
    s_cbranch_scc1 L_sf_81
    s_waitcnt vmcnt(1)
L_sf_81:
    buffer_load_dwordx4 v[136:139], v1, s[52:55], s97 offen offset:0 nt
    v_mfma_f32_16x16x32_bf16 v[32:35], v[24:27], v[120:123], v[32:35]
    s_or_b32 s96, s59, s39
    s_cbranch_scc0 L_nofrag_82
    v_mov_b32 v104, 162060
L_lw_83:
    ds_read_b32 v105, v104
    s_waitcnt lgkmcnt(0)
    v_cmp_gt_u32 vcc, 4, v105
    s_cbranch_vccz L_lw_83e
    s_sleep 2
    s_sub_u32 s60, s60, 1
    s_cbranch_scc0 L_lw_83
    s_mov_b32 s60, 0
L_lw_83e:
    s_cmp_eq_u32 s59, 0
    s_cbranch_scc1 L_nofrag_82
    v_lshrrev_b32 v109, 4, v0
    v_bfe_u32 v104, v0, 1, 1
    v_lshl_add_u32 v104, v109, 1, v104
    v_bfe_u32 v110, v0, 2, 2
    v_lshl_add_u32 v104, v104, 3, v110
    v_lshlrev_b32 v104, 7, v104
    v_and_b32 v110, 1, v0
    v_lshl_add_u32 v104, v110, 3, v104
    s_lshr_b32 s63, s3, 1
    s_and_b32 s62, s3, 1
    s_lshl_b32 s96, s63, 14
    s_lshl_b32 s100, s62, 6
    s_add_u32 s100, s100, 81920
    s_add_u32 s96, s96, s100
    v_add_u32 v104, s96, v104
    ds_read_b64_tr_b16 v[72:73], v104 offset:0
    ds_read_b64_tr_b16 v[74:75], v104 offset:512
    ds_read_b64_tr_b16 v[76:77], v104 offset:16
    ds_read_b64_tr_b16 v[78:79], v104 offset:528
    ds_read_b64_tr_b16 v[80:81], v104 offset:32
    ds_read_b64_tr_b16 v[82:83], v104 offset:544
    ds_read_b64_tr_b16 v[84:85], v104 offset:48
    ds_read_b64_tr_b16 v[86:87], v104 offset:560
    ds_read_b64_tr_b16 v[88:89], v104 offset:8192
    ds_read_b64_tr_b16 v[90:91], v104 offset:8704
    ds_read_b64_tr_b16 v[92:93], v104 offset:8208
    ds_read_b64_tr_b16 v[94:95], v104 offset:8720
    ds_read_b64_tr_b16 v[96:97], v104 offset:8224
    ds_read_b64_tr_b16 v[98:99], v104 offset:8736
    ds_read_b64_tr_b16 v[100:101], v104 offset:8240
    ds_read_b64_tr_b16 v[102:103], v104 offset:8752
    v_bfe_u32 v105, v0, 1, 3
    v_lshlrev_b32 v105, 8, v105
    v_lshl_add_u32 v105, v109, 5, v105
    v_lshl_add_u32 v105, v110, 4, v105
    v_lshrrev_b32 v106, 3, v0
    v_lshlrev_b32 v106, 7, v106
    v_and_b32 v110, 7, v0
    v_lshl_add_u32 v107, v110, 3, v106
    v_add_u32 v107, s100, v107
    v_lshl_add_u32 v106, v110, 2, v106
    v_add_u32 v106, s96, v106
    v_lshlrev_b32 v108, 2, v0
    s_lshl_b32 s96, s62, 2
    s_add_u32 s96, s96, 162088
    v_mov_b32 v109, s96
    s_lshl_b32 s100, s63, 11
    s_lshl_b32 s96, s34, 13
    s_add_u32 s100, s100, s96
    s_add_u32 s100, s100, 90112
    s_mul_i32 s101, s34, 5120
    s_lshl_b32 s96, s35, 9
    s_add_u32 s101, s101, s96
    s_lshl_b32 s96, s62, 8
    s_add_u32 s101, s101, s96
    s_add_u32 s101, s101, 144384
L_nofrag_82:
    v_mov_b32 v10, 162076
    v_mov_b32 v11, 1
    s_mov_b64 exec, 1
    ds_add_u32 v10, v11
    s_mov_b64 exec, -1
    v_and_b32_dpp v28, v17, v20 row_newbcast:8 row_mask:0xf bank_mask:0xf
    v_and_b32_dpp v29, v17, v21 row_newbcast:8 row_mask:0xf bank_mask:0xf
    v_and_b32_dpp v30, v17, v22 row_newbcast:8 row_mask:0xf bank_mask:0xf
    v_and_b32_dpp v31, v17, v23 row_newbcast:8 row_mask:0xf bank_mask:0xf
    s_waitcnt vmcnt(3)
    s_bitcmp0_b32 s14, 25
    s_cbranch_scc1 L_sf_84
    s_waitcnt vmcnt(2)
    s_bitcmp0_b32 s15, 25
    s_cbranch_scc1 L_sf_84
    s_waitcnt vmcnt(1)
L_sf_84:
    buffer_load_dwordx4 v[140:143], v1, s[52:55], s97 offen offset:1024 nt
    v_mfma_f32_16x16x32_bf16 v[32:35], v[28:31], v[124:127], v[32:35]
    v_and_b32_dpp v24, v17, v20 row_newbcast:4 row_mask:0xf bank_mask:0xf
    v_and_b32_dpp v25, v17, v21 row_newbcast:4 row_mask:0xf bank_mask:0xf
    v_and_b32_dpp v26, v17, v22 row_newbcast:4 row_mask:0xf bank_mask:0xf
    v_and_b32_dpp v27, v17, v23 row_newbcast:4 row_mask:0xf bank_mask:0xf
    s_waitcnt vmcnt(3)
    s_bitcmp0_b32 s14, 26
    s_cbranch_scc1 L_sf_85
    s_waitcnt vmcnt(2)
    s_bitcmp0_b32 s15, 26
    s_cbranch_scc1 L_sf_85
    s_waitcnt vmcnt(1)
L_sf_85:
    buffer_load_dwordx4 v[144:147], v1, s[52:55], s97 offen offset:2048 nt
    v_mfma_f32_16x16x32_bf16 v[32:35], v[24:27], v[128:131], v[32:35]
    v_and_b32_dpp v28, v17, v20 row_newbcast:12 row_mask:0xf bank_mask:0xf
    v_and_b32_dpp v29, v17, v21 row_newbcast:12 row_mask:0xf bank_mask:0xf
    v_and_b32_dpp v30, v17, v22 row_newbcast:12 row_mask:0xf bank_mask:0xf
    v_and_b32_dpp v31, v17, v23 row_newbcast:12 row_mask:0xf bank_mask:0xf
    s_waitcnt vmcnt(3)
    s_bitcmp0_b32 s14, 27
    s_cbranch_scc1 L_sf_86
    s_waitcnt vmcnt(2)
    s_bitcmp0_b32 s15, 27
    s_cbranch_scc1 L_sf_86
    s_waitcnt vmcnt(1)
L_sf_86:
    buffer_load_dwordx4 v[148:151], v1, s[52:55], s97 offen offset:3072 nt
    s_add_u32 s97, s97, 32768
    v_add_u32 v1, 4096, v1
    v_and_b32 v1, 0x7fff, v1
    v_mfma_f32_16x16x32_bf16 v[32:35], v[28:31], v[132:135], v[32:35]
    v_and_b32_dpp v24, v18, v20 row_newbcast:0 row_mask:0xf bank_mask:0xf
    v_and_b32_dpp v25, v18, v21 row_newbcast:0 row_mask:0xf bank_mask:0xf
    v_and_b32_dpp v26, v18, v22 row_newbcast:0 row_mask:0xf bank_mask:0xf
    v_and_b32_dpp v27, v18, v23 row_newbcast:0 row_mask:0xf bank_mask:0xf
    s_waitcnt vmcnt(3)
    s_bitcmp0_b32 s14, 28
    s_cbranch_scc1 L_sf_87
    s_waitcnt vmcnt(2)
    s_bitcmp0_b32 s15, 28
    s_cbranch_scc1 L_sf_87
    s_waitcnt vmcnt(1)
L_sf_87:
    buffer_load_dwordx4 v[152:155], v1, s[52:55], s97 offen offset:0 nt
    v_mfma_f32_16x16x32_bf16 v[32:35], v[24:27], v[136:139], v[32:35]
    v_and_b32_dpp v28, v18, v20 row_newbcast:8 row_mask:0xf bank_mask:0xf
    v_and_b32_dpp v29, v18, v21 row_newbcast:8 row_mask:0xf bank_mask:0xf
    v_and_b32_dpp v30, v18, v22 row_newbcast:8 row_mask:0xf bank_mask:0xf
    v_and_b32_dpp v31, v18, v23 row_newbcast:8 row_mask:0xf bank_mask:0xf
    s_waitcnt vmcnt(3)
    s_bitcmp0_b32 s14, 29
    s_cbranch_scc1 L_sf_88
    s_waitcnt vmcnt(2)
    s_bitcmp0_b32 s15, 29
    s_cbranch_scc1 L_sf_88
    s_waitcnt vmcnt(1)
L_sf_88:
    buffer_load_dwordx4 v[156:159], v1, s[52:55], s97 offen offset:1024 nt
    v_mfma_f32_16x16x32_bf16 v[32:35], v[28:31], v[140:143], v[32:35]
    v_and_b32_dpp v24, v18, v20 row_newbcast:4 row_mask:0xf bank_mask:0xf
    v_and_b32_dpp v25, v18, v21 row_newbcast:4 row_mask:0xf bank_mask:0xf
    v_and_b32_dpp v26, v18, v22 row_newbcast:4 row_mask:0xf bank_mask:0xf
    v_and_b32_dpp v27, v18, v23 row_newbcast:4 row_mask:0xf bank_mask:0xf
    s_waitcnt vmcnt(3)
    s_bitcmp0_b32 s14, 30
    s_cbranch_scc1 L_sf_89
    s_waitcnt vmcnt(2)
    s_bitcmp0_b32 s15, 30
    s_cbranch_scc1 L_sf_89
    s_waitcnt vmcnt(1)
L_sf_89:
    buffer_load_dwordx4 v[160:163], v1, s[52:55], s97 offen offset:2048 nt
    v_mfma_f32_16x16x32_bf16 v[32:35], v[24:27], v[144:147], v[32:35]
    v_lshrrev_b32 v9, 4, v0
    v_lshl_add_u32 v8, v9, 2, v2
    s_lshl_b32 s96, s3, 9
    s_add_u32 s96, s96, 157824
    v_lshl_add_u32 v8, v8, 2, s96
    v_lshlrev_b32 v9, 3, v0
    v_add_u32 v9, 157824, v9
    v_mov_b32 v10, 162048
    v_mov_b32 v11, 1
    s_lshl_b32 s96, s38, 5
    s_add_u32 s96, s96, 161984
    v_mov_b32 v3, s96
    s_sub_u32 s62, 8, s39
    s_lshl_b32 s98, s34, 5
    s_add_u32 s98, s98, s35
    s_lshl_b32 s98, s98, 8
    s_add_u32 s98, s98, 90112
    v_lshlrev_b32 v39, 2, v0
    v_and_b32_dpp v28, v18, v20 row_newbcast:12 row_mask:0xf bank_mask:0xf
    v_and_b32_dpp v29, v18, v21 row_newbcast:12 row_mask:0xf bank_mask:0xf
    v_and_b32_dpp v30, v18, v22 row_newbcast:12 row_mask:0xf bank_mask:0xf
    v_and_b32_dpp v31, v18, v23 row_newbcast:12 row_mask:0xf bank_mask:0xf
    s_waitcnt vmcnt(3)
    s_bitcmp0_b32 s14, 31
    s_cbranch_scc1 L_sf_90
    s_waitcnt vmcnt(2)
    s_bitcmp0_b32 s15, 31
    s_cbranch_scc1 L_sf_90
    s_waitcnt vmcnt(1)
L_sf_90:
    buffer_load_dwordx4 v[164:167], v1, s[52:55], s97 offen offset:3072 nt
    s_mov_b32 s97, 0
    v_add_u32 v1, 4096, v1
    v_and_b32 v1, 0x7fff, v1
    v_mfma_f32_16x16x32_bf16 v[32:35], v[28:31], v[148:151], v[32:35]
    s_cmp_eq_u32 s12, -1
    s_cbranch_scc1 L_v_nopf
    v_and_b32_dpp v24, v19, v20 row_newbcast:0 row_mask:0xf bank_mask:0xf
    v_and_b32_dpp v25, v19, v21 row_newbcast:0 row_mask:0xf bank_mask:0xf
    v_and_b32_dpp v26, v19, v22 row_newbcast:0 row_mask:0xf bank_mask:0xf
    v_and_b32_dpp v27, v19, v23 row_newbcast:0 row_mask:0xf bank_mask:0xf
    s_waitcnt vmcnt(3)
    s_nop 0
    v_mfma_f32_16x16x32_bf16 v[32:35], v[24:27], v[152:155], v[32:35]
    v_and_b32_dpp v28, v19, v20 row_newbcast:8 row_mask:0xf bank_mask:0xf
    v_and_b32_dpp v29, v19, v21 row_newbcast:8 row_mask:0xf bank_mask:0xf
    v_and_b32_dpp v30, v19, v22 row_newbcast:8 row_mask:0xf bank_mask:0xf
    v_and_b32_dpp v31, v19, v23 row_newbcast:8 row_mask:0xf bank_mask:0xf
    s_waitcnt vmcnt(2)
    s_nop 0
    v_mfma_f32_16x16x32_bf16 v[32:35], v[28:31], v[156:159], v[32:35]
    v_and_b32_dpp v24, v19, v20 row_newbcast:4 row_mask:0xf bank_mask:0xf
    v_and_b32_dpp v25, v19, v21 row_newbcast:4 row_mask:0xf bank_mask:0xf
    v_and_b32_dpp v26, v19, v22 row_newbcast:4 row_mask:0xf bank_mask:0xf
    v_and_b32_dpp v27, v19, v23 row_newbcast:4 row_mask:0xf bank_mask:0xf
    s_waitcnt vmcnt(1)
    s_nop 0
    v_mfma_f32_16x16x32_bf16 v[32:35], v[24:27], v[160:163], v[32:35]
    v_and_b32_dpp v28, v19, v20 row_newbcast:12 row_mask:0xf bank_mask:0xf
    v_and_b32_dpp v29, v19, v21 row_newbcast:12 row_mask:0xf bank_mask:0xf
    v_and_b32_dpp v30, v19, v22 row_newbcast:12 row_mask:0xf bank_mask:0xf
    v_and_b32_dpp v31, v19, v23 row_newbcast:12 row_mask:0xf bank_mask:0xf
    s_waitcnt vmcnt(0)
    s_nop 0
    v_mfma_f32_16x16x32_bf16 v[32:35], v[28:31], v[164:167], v[32:35]
L_v_join:
    s_cmp_lg_u32 s13, 0
    s_cbranch_scc1 L_jobend
L_t0:
    s_mov_b32 exec_hi, 0
    s_nop 4
    ds_write_b128 v8, v[32:35]
L_t0b:
    s_mov_b64 exec, 1
    ds_add_rtn_u32 v37, v10, v11
    s_mov_b64 exec, -1
    ds_read_b32 v38, v10 offset:24
    ds_read_b128 v[24:27], v3
    ds_read_b128 v[28:31], v3 offset:16
    ds_read_b64 v[144:145], v9 offset:0
    ds_read_b64 v[146:147], v9 offset:512
    ds_read_b64 v[148:149], v9 offset:1024
    ds_read_b64 v[150:151], v9 offset:1536
    ds_read_b64 v[152:153], v9 offset:2048
    ds_read_b64 v[154:155], v9 offset:2560
    ds_read_b64 v[156:157], v9 offset:3072
    ds_read_b64 v[158:159], v9 offset:3584
    s_waitcnt lgkmcnt(10)
    v_readfirstlane_b32 s96, v37
    v_readfirstlane_b32 s61, v38
    s_cmp_lg_u32 s96, s62
    s_cbranch_scc1 L_nopub
    s_waitcnt lgkmcnt(6)
    v_pk_mul_f32 v[144:145], v[144:145], v[24:25] op_sel:[0,0] op_sel_hi:[1,0]
    v_pk_mul_f32 v[146:147], v[146:147], v[24:25] op_sel:[0,1] op_sel_hi:[1,1]
    s_waitcnt lgkmcnt(4)
    v_pk_fma_f32 v[144:145], v[148:149], v[26:27], v[144:145] op_sel:[0,0,0] op_sel_hi:[1,0,1]
    v_pk_fma_f32 v[146:147], v[150:151], v[26:27], v[146:147] op_sel:[0,1,0] op_sel_hi:[1,1,1]
    s_waitcnt lgkmcnt(2)
    v_pk_fma_f32 v[144:145], v[152:153], v[28:29], v[144:145] op_sel:[0,0,0] op_sel_hi:[1,0,1]
    v_pk_fma_f32 v[146:147], v[154:155], v[28:29], v[146:147] op_sel:[0,1,0] op_sel_hi:[1,1,1]
    s_waitcnt lgkmcnt(0)
    v_pk_fma_f32 v[144:145], v[156:157], v[30:31], v[144:145] op_sel:[0,0,0] op_sel_hi:[1,0,1]
    v_pk_fma_f32 v[146:147], v[158:159], v[30:31], v[146:147] op_sel:[0,1,0] op_sel_hi:[1,1,1]
    s_cmp_eq_u32 s61, 1
    v_pk_add_f32 v[144:145], v[144:145], v[146:147]
    v_cvt_pk_bf16_f32 v32, v144, v145
    s_cbranch_scc0 L_oslow
    buffer_store_dword v32, v39, s[40:43], s98 offen
L_odone:
L_nopub:
    s_cmp_eq_u32 s59, 0
    s_cbranch_scc1 L_not1
L_poll_99:
    buffer_load_dwordx4 v[16:19], v105, s[40:43], s100 offen sc1
    buffer_load_dwordx4 v[20:23], v105, s[40:43], s100 offen offset:128 sc1
    s_sub_u32 s60, s60, 1
    s_cbranch_scc1 L_poll_99t
    s_waitcnt vmcnt(0)
    v_max3_u32 v38, v16, v17, v18
    v_max3_u32 v38, v38, v19, v20
    v_max3_u32 v38, v38, v21, v22
    v_max_u32 v38, v38, v23
    v_cmp_eq_u32 vcc, -1, v38
    s_cbranch_vccnz L_poll_99
L_poll_99e:
    v_mfma_f32_16x16x32_bf16 v[112:115], v[16:19], v[72:75], 0
    v_mfma_f32_16x16x32_bf16 v[120:123], v[16:19], v[80:83], 0
    v_mfma_f32_16x16x32_bf16 v[116:119], v[16:19], v[76:79], 0
    v_mfma_f32_16x16x32_bf16 v[124:127], v[16:19], v[84:87], 0
    v_mfma_f32_16x16x32_bf16 v[112:115], v[20:23], v[88:91], v[112:115]
    v_mfma_f32_16x16x32_bf16 v[120:123], v[20:23], v[96:99], v[120:123]
    v_mfma_f32_16x16x32_bf16 v[116:119], v[20:23], v[92:95], v[116:119]
    v_mfma_f32_16x16x32_bf16 v[124:127], v[20:23], v[100:103], v[124:127]
    s_nop 4
    v_pk_add_f32 v[112:113], v[112:113], v[114:115]
    v_pk_add_f32 v[120:121], v[120:121], v[122:123]
    v_pk_add_f32 v[116:117], v[116:117], v[118:119]
    v_pk_add_f32 v[124:125], v[124:125], v[126:127]
    v_add_f32_dpp v12, v113, v112 row_ror:8 row_mask:0xf bank_mask:0x3
    v_add_f32_dpp v12, v120, v121 row_ror:8 row_mask:0xf bank_mask:0xc
    v_add_f32_dpp v13, v117, v116 row_ror:8 row_mask:0xf bank_mask:0x3
    v_add_f32_dpp v13, v124, v125 row_ror:8 row_mask:0xf bank_mask:0xc
    ds_write2_b32 v106, v12, v13 offset0:0 offset1:8
    s_mov_b64 exec, 1
    ds_add_rtn_u32 v37, v109, v11
    s_mov_b64 exec, -1
    ds_read_b64 v[72:73], v107 offset:0
    ds_read_b64 v[74:75], v107 offset:16384
    ds_read_b64 v[76:77], v107 offset:32768
    ds_read_b64 v[78:79], v107 offset:49152
    s_waitcnt lgkmcnt(4)
    v_readfirstlane_b32 s96, v37
    s_waitcnt lgkmcnt(2)
    v_pk_add_f32 v[72:73], v[72:73], v[74:75]
    s_cmp_lg_u32 s96, 3
    s_cbranch_scc1 L_not1
    s_waitcnt lgkmcnt(0)
    v_pk_add_f32 v[76:77], v[76:77], v[78:79]
    v_pk_add_f32 v[72:73], v[72:73], v[76:77]
    v_cvt_pk_bf16_f32 v12, v72, v73
    buffer_store_dword v12, v108, s[40:43], s101 offen sc1
L_not1:
    s_waitcnt lgkmcnt(0)
    s_cmp_eq_u32 s39, 1
    s_cbranch_scc1 L_s_role
    s_endpgm
L_k_nopf:
    s_waitcnt vmcnt(3)
    s_bitcmp0_b32 s57, 22
    s_cbranch_scc1 L_sf_55
    s_waitcnt vmcnt(2)
    s_bitcmp0_b32 s58, 22
    s_cbranch_scc1 L_sf_55
    s_waitcnt vmcnt(1)
L_sf_55:
    buffer_load_dwordx4 v[128:131], v1, s[48:51], s97 offen offset:2048 nt
    v_min_u32 v39, 29, v0
    v_lshlrev_b32 v39, 2, v39
    buffer_load_dword v37, v39, s[44:47], 0 offen sc1
    s_waitcnt vmcnt(4)
    s_bitcmp0_b32 s57, 23
    s_cbranch_scc1 L_sf_56
    s_waitcnt vmcnt(3)
    s_bitcmp0_b32 s58, 23
    s_cbranch_scc1 L_sf_56
    s_waitcnt vmcnt(2)
L_sf_56:
    buffer_load_dwordx4 v[132:135], v1, s[48:51], s97 offen offset:3072 nt
    s_add_u32 s97, s97, 32768
    v_add_u32 v1, 4096, v1
    v_and_b32 v1, 0x7fff, v1
    s_waitcnt vmcnt(4)
    s_bitcmp0_b32 s57, 24
    s_cbranch_scc1 L_sf_57
    s_waitcnt vmcnt(3)
    s_bitcmp0_b32 s58, 24
    s_cbranch_scc1 L_sf_57
    s_waitcnt vmcnt(2)
L_sf_57:
    buffer_load_dwordx4 v[136:139], v1, s[48:51], s97 offen offset:0 nt
    s_waitcnt vmcnt(4)
    s_bitcmp0_b32 s57, 25
    s_cbranch_scc1 L_sf_58
    s_waitcnt vmcnt(3)
    s_bitcmp0_b32 s58, 25
    s_cbranch_scc1 L_sf_58
    s_waitcnt vmcnt(1)
L_sf_58:
    buffer_load_dwordx4 v[140:143], v1, s[48:51], s97 offen offset:1024 nt
    s_waitcnt vmcnt(4)
    s_bitcmp0_b32 s57, 26
    s_cbranch_scc1 L_sf_59
    s_waitcnt vmcnt(2)
    s_bitcmp0_b32 s58, 26
    s_cbranch_scc1 L_sf_59
    s_waitcnt vmcnt(1)
L_sf_59:
    buffer_load_dwordx4 v[144:147], v1, s[48:51], s97 offen offset:2048 nt
    s_waitcnt vmcnt(3)
    s_bitcmp0_b32 s57, 27
    s_cbranch_scc1 L_sf_60
    s_waitcnt vmcnt(2)
    s_bitcmp0_b32 s58, 27
    s_cbranch_scc1 L_sf_60
    s_waitcnt vmcnt(1)
L_sf_60:
    buffer_load_dwordx4 v[148:151], v1, s[48:51], s97 offen offset:3072 nt
    s_add_u32 s97, s97, 32768
    v_add_u32 v1, 4096, v1
    v_and_b32 v1, 0x7fff, v1
    v_cmp_eq_u32 vcc, 0, v37
    s_nop 0
    s_or_b32 s96, vcc_lo, vcc_hi
    buffer_load_dwordx4 v[4:7], v2, s[40:43], s98 offen sc1
    s_waitcnt vmcnt(4)
    s_bitcmp0_b32 s57, 28
    s_cbranch_scc1 L_sf_61
    s_waitcnt vmcnt(3)
    s_bitcmp0_b32 s58, 28
    s_cbranch_scc1 L_sf_61
    s_waitcnt vmcnt(2)
L_sf_61:
    buffer_load_dwordx4 v[152:155], v1, s[48:51], s97 offen offset:0 nt
    s_waitcnt vmcnt(4)
    s_bitcmp0_b32 s57, 29
    s_cbranch_scc1 L_sf_62
    s_waitcnt vmcnt(3)
    s_bitcmp0_b32 s58, 29
    s_cbranch_scc1 L_sf_62
    s_waitcnt vmcnt(2)
L_sf_62:
    buffer_load_dwordx4 v[156:159], v1, s[48:51], s97 offen offset:1024 nt
    s_waitcnt vmcnt(4)
    s_bitcmp0_b32 s57, 30
    s_cbranch_scc1 L_sf_63
    s_waitcnt vmcnt(3)
    s_bitcmp0_b32 s58, 30
    s_cbranch_scc1 L_sf_63
    s_waitcnt vmcnt(1)
L_sf_63:
    buffer_load_dwordx4 v[160:163], v1, s[48:51], s97 offen offset:2048 nt
    s_waitcnt vmcnt(4)
    s_bitcmp0_b32 s57, 31
    s_cbranch_scc1 L_sf_64
    s_waitcnt vmcnt(2)
    s_bitcmp0_b32 s58, 31
    s_cbranch_scc1 L_sf_64
    s_waitcnt vmcnt(1)
L_sf_64:
    buffer_load_dwordx4 v[164:167], v1, s[48:51], s97 offen offset:3072 nt
    s_mov_b32 s97, 0
    v_add_u32 v1, 4096, v1
    v_and_b32 v1, 0x7fff, v1
    v_add_u32 v1, 8192, v1
    v_and_b32 v1, 0x7fff, v1
    s_mov_b32 s97, 65536
    s_branch L_k_join
L_v_nopf:
    v_and_b32_dpp v24, v19, v20 row_newbcast:0 row_mask:0xf bank_mask:0xf
    v_and_b32_dpp v25, v19, v21 row_newbcast:0 row_mask:0xf bank_mask:0xf
    v_and_b32_dpp v26, v19, v22 row_newbcast:0 row_mask:0xf bank_mask:0xf
    v_and_b32_dpp v27, v19, v23 row_newbcast:0 row_mask:0xf bank_mask:0xf
    s_waitcnt vmcnt(3)
    s_bitcmp0_b32 s14, 0
    s_cbranch_scc1 L_sf_91
    s_waitcnt vmcnt(2)
    s_bitcmp0_b32 s15, 0
    s_cbranch_scc1 L_sf_91
    s_waitcnt vmcnt(1)
L_sf_91:
    buffer_load_dwordx4 v[40:43], v1, s[52:55], s97 offen offset:0 nt
    v_mfma_f32_16x16x32_bf16 v[32:35], v[24:27], v[152:155], v[32:35]
    v_and_b32_dpp v28, v19, v20 row_newbcast:8 row_mask:0xf bank_mask:0xf
    v_and_b32_dpp v29, v19, v21 row_newbcast:8 row_mask:0xf bank_mask:0xf
    v_and_b32_dpp v30, v19, v22 row_newbcast:8 row_mask:0xf bank_mask:0xf
    v_and_b32_dpp v31, v19, v23 row_newbcast:8 row_mask:0xf bank_mask:0xf
    s_waitcnt vmcnt(3)
    s_bitcmp0_b32 s14, 1
    s_cbranch_scc1 L_sf_92
    s_waitcnt vmcnt(2)
    s_bitcmp0_b32 s15, 1
    s_cbranch_scc1 L_sf_92
    s_waitcnt vmcnt(1)
L_sf_92:
    buffer_load_dwordx4 v[44:47], v1, s[52:55], s97 offen offset:1024 nt
    v_mfma_f32_16x16x32_bf16 v[32:35], v[28:31], v[156:159], v[32:35]
    v_and_b32_dpp v24, v19, v20 row_newbcast:4 row_mask:0xf bank_mask:0xf
    v_and_b32_dpp v25, v19, v21 row_newbcast:4 row_mask:0xf bank_mask:0xf
    v_and_b32_dpp v26, v19, v22 row_newbcast:4 row_mask:0xf bank_mask:0xf
    v_and_b32_dpp v27, v19, v23 row_newbcast:4 row_mask:0xf bank_mask:0xf
    s_waitcnt vmcnt(3)
    s_bitcmp0_b32 s14, 2
    s_cbranch_scc1 L_sf_93
    s_waitcnt vmcnt(2)
    s_bitcmp0_b32 s15, 2
    s_cbranch_scc1 L_sf_93
    s_waitcnt vmcnt(1)
L_sf_93:
    buffer_load_dwordx4 v[48:51], v1, s[52:55], s97 offen offset:2048 nt
    v_mfma_f32_16x16x32_bf16 v[32:35], v[24:27], v[160:163], v[32:35]
    v_and_b32_dpp v28, v19, v20 row_newbcast:12 row_mask:0xf bank_mask:0xf
    v_and_b32_dpp v29, v19, v21 row_newbcast:12 row_mask:0xf bank_mask:0xf
    v_and_b32_dpp v30, v19, v22 row_newbcast:12 row_mask:0xf bank_mask:0xf
    v_and_b32_dpp v31, v19, v23 row_newbcast:12 row_mask:0xf bank_mask:0xf
    s_waitcnt vmcnt(3)
    s_bitcmp0_b32 s14, 3
    s_cbranch_scc1 L_sf_94
    s_waitcnt vmcnt(2)
    s_bitcmp0_b32 s15, 3
    s_cbranch_scc1 L_sf_94
    s_waitcnt vmcnt(1)
L_sf_94:
    buffer_load_dwordx4 v[52:55], v1, s[52:55], s97 offen offset:3072 nt
    s_add_u32 s97, s97, 32768
    v_add_u32 v1, 4096, v1
    v_and_b32 v1, 0x7fff, v1
    v_mfma_f32_16x16x32_bf16 v[32:35], v[28:31], v[164:167], v[32:35]
    v_and_b32_dpp v24, v12, v20 row_newbcast:0 row_mask:0xf bank_mask:0xf
    v_and_b32_dpp v25, v12, v21 row_newbcast:0 row_mask:0xf bank_mask:0xf
    v_and_b32_dpp v26, v12, v22 row_newbcast:0 row_mask:0xf bank_mask:0xf
    v_and_b32_dpp v27, v12, v23 row_newbcast:0 row_mask:0xf bank_mask:0xf
    s_waitcnt vmcnt(3)
    s_bitcmp0_b32 s14, 4
    s_cbranch_scc1 L_sf_95
    s_waitcnt vmcnt(2)
    s_bitcmp0_b32 s15, 4
    s_cbranch_scc1 L_sf_95
    s_waitcnt vmcnt(1)
L_sf_95:
    buffer_load_dwordx4 v[56:59], v1, s[52:55], s97 offen offset:0 nt
    v_mfma_f32_16x16x32_bf16 v[32:35], v[24:27], v[40:43], v[32:35]
    v_and_b32_dpp v28, v12, v20 row_newbcast:8 row_mask:0xf bank_mask:0xf
    v_and_b32_dpp v29, v12, v21 row_newbcast:8 row_mask:0xf bank_mask:0xf
    v_and_b32_dpp v30, v12, v22 row_newbcast:8 row_mask:0xf bank_mask:0xf
    v_and_b32_dpp v31, v12, v23 row_newbcast:8 row_mask:0xf bank_mask:0xf
    s_waitcnt vmcnt(3)
    s_bitcmp0_b32 s14, 5
    s_cbranch_scc1 L_sf_96
    s_waitcnt vmcnt(2)
    s_bitcmp0_b32 s15, 5
    s_cbranch_scc1 L_sf_96
    s_waitcnt vmcnt(1)
L_sf_96:
    buffer_load_dwordx4 v[60:63], v1, s[52:55], s97 offen offset:1024 nt
    v_mfma_f32_16x16x32_bf16 v[32:35], v[28:31], v[44:47], v[32:35]
    v_and_b32_dpp v24, v12, v20 row_newbcast:4 row_mask:0xf bank_mask:0xf
    v_and_b32_dpp v25, v12, v21 row_newbcast:4 row_mask:0xf bank_mask:0xf
    v_and_b32_dpp v26, v12, v22 row_newbcast:4 row_mask:0xf bank_mask:0xf
    v_and_b32_dpp v27, v12, v23 row_newbcast:4 row_mask:0xf bank_mask:0xf
    s_waitcnt vmcnt(3)
    s_bitcmp0_b32 s14, 6
    s_cbranch_scc1 L_sf_97
    s_waitcnt vmcnt(2)
    s_bitcmp0_b32 s15, 6
    s_cbranch_scc1 L_sf_97
    s_waitcnt vmcnt(1)
L_sf_97:
    buffer_load_dwordx4 v[64:67], v1, s[52:55], s97 offen offset:2048 nt
    v_mfma_f32_16x16x32_bf16 v[32:35], v[24:27], v[48:51], v[32:35]
    v_and_b32_dpp v28, v12, v20 row_newbcast:12 row_mask:0xf bank_mask:0xf
    v_and_b32_dpp v29, v12, v21 row_newbcast:12 row_mask:0xf bank_mask:0xf
    v_and_b32_dpp v30, v12, v22 row_newbcast:12 row_mask:0xf bank_mask:0xf
    v_and_b32_dpp v31, v12, v23 row_newbcast:12 row_mask:0xf bank_mask:0xf
    s_waitcnt vmcnt(3)
    s_bitcmp0_b32 s14, 7
    s_cbranch_scc1 L_sf_98
    s_waitcnt vmcnt(2)
    s_bitcmp0_b32 s15, 7
    s_cbranch_scc1 L_sf_98
    s_waitcnt vmcnt(1)
L_sf_98:
    buffer_load_dwordx4 v[68:71], v1, s[52:55], s97 offen offset:3072 nt
    s_add_u32 s97, s97, 32768
    v_add_u32 v1, 4096, v1
    v_and_b32 v1, 0x7fff, v1
    v_mfma_f32_16x16x32_bf16 v[32:35], v[28:31], v[52:55], v[32:35]
    v_and_b32_dpp v24, v13, v20 row_newbcast:0 row_mask:0xf bank_mask:0xf
    v_and_b32_dpp v25, v13, v21 row_newbcast:0 row_mask:0xf bank_mask:0xf
    v_and_b32_dpp v26, v13, v22 row_newbcast:0 row_mask:0xf bank_mask:0xf
    v_and_b32_dpp v27, v13, v23 row_newbcast:0 row_mask:0xf bank_mask:0xf
    s_waitcnt vmcnt(3)
    s_nop 0
    v_mfma_f32_16x16x32_bf16 v[32:35], v[24:27], v[56:59], v[32:35]
    v_and_b32_dpp v28, v13, v20 row_newbcast:8 row_mask:0xf bank_mask:0xf
    v_and_b32_dpp v29, v13, v21 row_newbcast:8 row_mask:0xf bank_mask:0xf
    v_and_b32_dpp v30, v13, v22 row_newbcast:8 row_mask:0xf bank_mask:0xf
    v_and_b32_dpp v31, v13, v23 row_newbcast:8 row_mask:0xf bank_mask:0xf
    s_waitcnt vmcnt(2)
    s_nop 0
    v_mfma_f32_16x16x32_bf16 v[32:35], v[28:31], v[60:63], v[32:35]
    v_and_b32_dpp v24, v13, v20 row_newbcast:4 row_mask:0xf bank_mask:0xf
    v_and_b32_dpp v25, v13, v21 row_newbcast:4 row_mask:0xf bank_mask:0xf
    v_and_b32_dpp v26, v13, v22 row_newbcast:4 row_mask:0xf bank_mask:0xf
    v_and_b32_dpp v27, v13, v23 row_newbcast:4 row_mask:0xf bank_mask:0xf
    s_waitcnt vmcnt(1)
    s_nop 0
    v_mfma_f32_16x16x32_bf16 v[32:35], v[24:27], v[64:67], v[32:35]
    v_and_b32_dpp v28, v13, v20 row_newbcast:12 row_mask:0xf bank_mask:0xf
    v_and_b32_dpp v29, v13, v21 row_newbcast:12 row_mask:0xf bank_mask:0xf
    v_and_b32_dpp v30, v13, v22 row_newbcast:12 row_mask:0xf bank_mask:0xf
    v_and_b32_dpp v31, v13, v23 row_newbcast:12 row_mask:0xf bank_mask:0xf
    s_waitcnt vmcnt(0)
    s_nop 0
    v_mfma_f32_16x16x32_bf16 v[32:35], v[28:31], v[68:71], v[32:35]
    s_branch L_v_join
L_oslow:
    buffer_store_dword v32, v39, s[40:43], s98 offen sc1
    s_branch L_odone
L_qslow:
L_wy_100:
    buffer_load_dword v37, v39, s[44:47], 0 offen sc1
    s_waitcnt vmcnt(0)
    v_cmp_ne_u32 vcc, -1, v37
    s_cbranch_vccz L_wy_100e
    s_sleep 4
    s_sub_u32 s60, s60, 1
    s_cbranch_scc0 L_wy_100
    s_mov_b32 s60, 0
L_wy_100e:
L_qslow2:
    s_branch L_poll_101
L_poll_101s:
    s_sleep 2
L_poll_101:
    buffer_load_dwordx4 v[4:7], v2, s[40:43], s98 offen sc1
    s_sub_u32 s60, s60, 1
    s_cbranch_scc1 L_poll_101t
    s_waitcnt vmcnt(0)
    v_max3_u32 v38, v4, v5, v6
    v_max_u32 v38, v38, v7
    v_cmp_eq_u32 vcc, -1, v38
    s_cbranch_vccnz L_poll_101s
L_poll_101e:
    s_branch L_qok
L_mljob:
    s_lshl_b32 s96, s38, 3
    s_add_u32 s96, s96, s3
    s_lshl3_add_u32 s96, s96, s99
    buffer_store_dwordx2 v[8:9], v36, s[40:43], s96 offen sc1
    s_branch L_mldone
L_service:
    v_mov_b32 v72, 0
    v_mov_b32 v73, 0
    v_mov_b32 v74, 0
    v_mov_b32 v75, 0
    v_mov_b32 v76, 0
    s_mov_b32 s59, 0
    v_mov_b32 v5, 0
    v_mov_b32 v105, 0
    v_mov_b32 v108, 0
    v_mov_b32 v160, 0
    v_mov_b32 v8, 162068
L_lw_102:
    ds_read_b32 v9, v8
    s_waitcnt lgkmcnt(0)
    v_cmp_gt_u32 vcc, 8, v9
    s_cbranch_vccz L_lw_102e
    s_sleep 8
    s_sub_u32 s60, s60, 1
    s_cbranch_scc0 L_lw_102
    s_mov_b32 s60, 0
L_lw_102e:
    v_and_b32 v2, 15, v0
    v_lshlrev_b32 v2, 3, v2
    v_add_u32 v3, 161920, v2
    ds_read_b64 v[8:9], v3
    s_lshl_b32 s99, s37, 5
    s_add_u32 s99, s99, s36
    s_lshl_b32 s99, s99, 7
    s_add_u32 s99, s99, 73728
    s_lshl_b32 s62, s38, 6
    s_add_u32 s62, s62, s99
    s_getreg_b32 s58, hwreg(HW_REG_XCC_ID, 0, 4)
    v_mov_b32 v10, s58
    s_lshl_b32 s98, s34, 5
    s_add_u32 s98, s98, s35
    s_lshl_b32 s63, s98, 2
    s_add_u32 s63, s63, 229376
    s_lshl_b32 s98, s98, 8
    s_add_u32 s98, s98, 90112
    v_lshlrev_b32 v39, 2, v0
    s_bfm_b64 exec, 8, 0
    s_waitcnt lgkmcnt(0)
    buffer_store_dwordx2 v[8:9], v2, s[40:43], s62 offen sc1
    s_mov_b64 exec, 1
    buffer_store_dword v10, v36, s[40:43], s63 offen sc1
    s_mov_b64 exec, -1
    v_mov_b32 v12, 162076
L_lw_103:
    ds_read_b32 v13, v12
    s_waitcnt lgkmcnt(0)
    v_cmp_gt_u32 vcc, 4, v13
    s_cbranch_vccz L_lw_103e
    s_sleep 4
    s_sub_u32 s60, s60, 1
    s_cbranch_scc0 L_lw_103
    s_mov_b32 s60, 0
L_lw_103e:
    v_and_b32 v11, 31, v0
    v_lshlrev_b32 v11, 2, v11
    s_lshl_b32 s63, s34, 7
    s_add_u32 s63, s63, 229376
    buffer_load_dword v12, v39, s[40:43], s98 offen sc1
    s_branch L_poll_104
L_poll_104s:
    s_sleep 16
L_poll_104:
    buffer_load_dwordx2 v[8:9], v2, s[40:43], s99 offen sc1
    buffer_load_dword v10, v11, s[40:43], s63 offen sc1
    s_sub_u32 s60, s60, 1
    s_cbranch_scc1 L_poll_104t
    s_waitcnt vmcnt(0)
    v_max3_u32 v38, v8, v9, v10
    v_cmp_eq_u32 vcc, -1, v38
    s_cbranch_vccnz L_poll_104s
L_poll_104e:
    v_mov_b32 v37, v8
    s_nop 1
    v_max_f32_dpp v37, v37, v37 quad_perm:[1,0,3,2] row_mask:0xf bank_mask:0xf
    s_nop 1
    v_max_f32_dpp v37, v37, v37 quad_perm:[2,3,0,1] row_mask:0xf bank_mask:0xf
    s_nop 1
    v_max_f32_dpp v37, v37, v37 row_ror:4 row_mask:0xf bank_mask:0xf
    s_nop 1
    v_max_f32_dpp v37, v37, v37 row_ror:8 row_mask:0xf bank_mask:0xf
    v_sub_f32 v8, v8, v37
    v_exp_f32 v8, v8
    s_nop 0
    v_mul_f32 v9, v8, v9
    s_nop 1
    v_add_f32_dpp v9, v9, v9 quad_perm:[1,0,3,2] row_mask:0xf bank_mask:0xf
    s_nop 1
    v_add_f32_dpp v9, v9, v9 quad_perm:[2,3,0,1] row_mask:0xf bank_mask:0xf
    s_nop 1
    v_add_f32_dpp v9, v9, v9 row_ror:4 row_mask:0xf bank_mask:0xf
    s_nop 1
    v_add_f32_dpp v9, v9, v9 row_ror:8 row_mask:0xf bank_mask:0xf
    s_getreg_b32 s62, hwreg(HW_REG_XCC_ID, 0, 4)
    v_cmp_ne_u32 vcc, s62, v10
    s_nop 0
    s_cmp_eq_u64 vcc, 0
    s_cselect_b32 s61, 1, 0
    v_rcp_f32 v9, v9
    v_lshrrev_b32 v3, 1, v2
    v_add_u32 v3, 161984, v3
    v_mul_f32 v8, v8, v9
    v_mov_b32 v10, 162072
    v_mov_b32 v11, s61
    ds_write_b32 v3, v8
    ds_write_b32 v10, v11
    s_mov_b32 s3, 1
    v_lshrrev_b32 v9, 4, v0
    v_lshl_add_u32 v8, v9, 2, v2
    s_lshl_b32 s96, s3, 9
    s_add_u32 s96, s96, 157824
    v_lshl_add_u32 v8, v8, 2, s96
    v_lshlrev_b32 v9, 3, v0
    v_add_u32 v9, 157824, v9
    v_mov_b32 v10, 162048
    v_mov_b32 v11, 1
    s_lshl_b32 s96, s38, 5
    s_add_u32 s96, s96, 161984
    v_mov_b32 v3, s96
    s_sub_u32 s62, 8, s39
    s_lshl_b32 s98, s34, 5
    s_add_u32 s98, s98, s35
    s_lshl_b32 s98, s98, 8
    s_add_u32 s98, s98, 90112
    v_lshlrev_b32 v39, 2, v0
    s_branch L_t0b
L_jobend:
    v_lshrrev_b32 v9, 4, v0
    v_lshl_add_u32 v9, v9, 2, v2
    v_lshlrev_b32 v9, 2, v9
    s_mov_b32 exec_hi, 0
    s_nop 1
    buffer_store_dwordx4 v[32:35], v9, s[40:43], s13 offen sc1
    s_endpgm
L_proxy:
    v_mov_b32 v72, 0
    v_mov_b32 v73, 0
    v_mov_b32 v74, 0
    v_mov_b32 v75, 0
    v_mov_b32 v76, 0
    v_mov_b32 v5, 0
    v_mov_b32 v105, 0
    v_mov_b32 v108, 0
    v_mov_b32 v160, 0
    s_barrier
    s_waitcnt lgkmcnt(0)
    s_mov_b32 s40, s32
    s_mov_b32 s41, s33
    s_mov_b32 s42, 589824
    s_mov_b32 s43, 0x20000
    s_mov_b32 s44, s30
    s_mov_b32 s45, s31
    s_mov_b32 s46, 256
    s_mov_b32 s47, 0x20000
    s_sub_u32 s97, 7, s3
    s_mul_i32 s97, s97, 27
    s_cmp_eq_u32 s3, 5
    s_cselect_b32 s97, 32, s97
    s_add_u32 s97, s97, s35
    s_lshl_b32 s97, s97, 9
    s_add_u32 s97, s97, 196608
    v_and_b32 v2, 15, v0
    v_lshlrev_b32 v2, 3, v2
    v_bfe_u32 v20, v0, 4, 1
    v_lshl_add_u32 v20, v20, 2, v2
    v_lshlrev_b32 v20, 2, v20
    s_cmp_lg_u32 s3, 7
    s_cbranch_scc1 L_px6
    s_sub_u32 s96, 6, s59
    v_mov_b32 v8, 162068
L_lw_105:
    ds_read_b32 v9, v8
    s_waitcnt lgkmcnt(0)
    v_cmp_gt_u32 vcc, s96, v9
    s_cbranch_vccz L_lw_105e
    s_sleep 8
    s_sub_u32 s60, s60, 1
    s_cbranch_scc0 L_lw_105
    s_mov_b32 s60, 0
L_lw_105e:
    v_and_b32 v2, 15, v0
    v_lshlrev_b32 v2, 3, v2
    v_add_u32 v3, 161920, v2
    ds_read_b64 v[8:9], v3
    s_lshl_b32 s99, s37, 5
    s_add_u32 s99, s99, s36
    s_lshl_b32 s99, s99, 7
    s_add_u32 s99, s99, 73728
    s_lshl_b32 s62, s38, 6
    s_add_u32 s62, s62, s99
    s_getreg_b32 s58, hwreg(HW_REG_XCC_ID, 0, 4)
    v_mov_b32 v10, s58
    s_lshl_b32 s98, s34, 5
    s_add_u32 s98, s98, s35
    s_lshl_b32 s63, s98, 2
    s_add_u32 s63, s63, 229376
    s_lshl_b32 s98, s98, 8
    s_add_u32 s98, s98, 90112
    v_lshlrev_b32 v39, 2, v0
    s_bfm_b64 exec, s96, 0
    s_waitcnt lgkmcnt(0)
    buffer_store_dwordx2 v[8:9], v2, s[40:43], s62 offen sc1
    s_mov_b64 exec, 1
    buffer_store_dword v10, v36, s[40:43], s63 offen sc1
    s_mov_b64 exec, -1
    s_mov_b32 s100, 4
    s_lshl_b32 s63, s100, 8
    v_and_b32 v8, 15, v0
    v_lshl_add_u32 v8, v8, 4, s63
    v_lshrrev_b32 v9, 4, v0
    v_mul_u32_u24 v5, 1280, v9
    v_add_u32 v5, v5, v8
    v_mul_u32_u24 v4, 1296, v9
    v_add_u32 v4, v4, v8
    v_add_u32 v4, 81920, v4
    v_lshlrev_b32 v6, 1, v5
    v_add_u32 v6, 87104, v6
    s_lshl_b32 s62, s100, 3
    s_add_u32 s62, s62, 97344
    v_lshl_add_u32 v7, v9, 6, s62
    s_mov_b32 s48, s4
    s_mov_b32 s49, s5
    s_mov_b32 s50, 5120
    s_mov_b32 s51, 0x20000
    buffer_load_dwordx4 v[8:11], v5, s[48:51], 0 offen
    s_mov_b32 s62, 20480
    s_mov_b32 s63, 30720
    s_branch L_poll_106
L_poll_106s:
    s_sleep 32
L_poll_106:
    buffer_load_dwordx4 v[12:15], v5, s[40:43], s62 offen sc1
    buffer_load_dwordx4 v[16:19], v5, s[40:43], s63 offen sc1
    s_sub_u32 s60, s60, 1
    s_cbranch_scc1 L_poll_106t
    s_waitcnt vmcnt(0)
    v_max3_u32 v38, v12, v13, v14
    v_max3_u32 v38, v38, v15, v16
    v_max3_u32 v38, v38, v17, v18
    v_max_u32 v38, v38, v19
    v_cmp_eq_u32 vcc, -1, v38
    s_cbranch_vccnz L_poll_106s
L_poll_106e:
    v_lshlrev_b32 v40, 16, v8
    v_and_b32 v41, 0xffff0000, v8
    v_lshlrev_b32 v42, 16, v9
    v_and_b32 v43, 0xffff0000, v9
    v_lshlrev_b32 v44, 16, v10
    v_and_b32 v45, 0xffff0000, v10
    v_lshlrev_b32 v46, 16, v11
    v_and_b32 v47, 0xffff0000, v11
    v_lshlrev_b32 v48, 16, v12
    v_and_b32 v49, 0xffff0000, v12
    v_lshlrev_b32 v50, 16, v13
    v_and_b32 v51, 0xffff0000, v13
    v_lshlrev_b32 v52, 16, v14
    v_and_b32 v53, 0xffff0000, v14
    v_lshlrev_b32 v54, 16, v15
    v_and_b32 v55, 0xffff0000, v15
    v_lshlrev_b32 v56, 16, v16
    v_and_b32 v57, 0xffff0000, v16
    v_lshlrev_b32 v58, 16, v17
    v_and_b32 v59, 0xffff0000, v17
    v_lshlrev_b32 v60, 16, v18
    v_and_b32 v61, 0xffff0000, v18
    v_lshlrev_b32 v62, 16, v19
    v_and_b32 v63, 0xffff0000, v19
    v_mov_b32 v64, 0
    v_mov_b32 v65, 0
    v_mov_b32 v66, 0
    v_mov_b32 v67, 0
    v_mov_b32 v68, 0
    v_mov_b32 v69, 0
    v_mov_b32 v70, 0
    v_mov_b32 v71, 0
    v_bfe_u32 v5, v0, 2, 2
    v_lshlrev_b32 v5, 8, v5
    v_lshrrev_b32 v8, 4, v0
    v_lshl_add_u32 v5, v8, 6, v5
    v_and_b32 v8, 3, v0
    v_lshl_add_u32 v5, v8, 4, v5
    s_lshl_b32 s63, s100, 10
    v_add_u32 v5, s63, v5
    s_or_b32 s96, s59, s39
    s_cbranch_scc0 L_nofrag_107
    v_mov_b32 v104, 162060
L_lw_108:
    ds_read_b32 v105, v104
    s_waitcnt lgkmcnt(0)
    v_cmp_gt_u32 vcc, 4, v105
    s_cbranch_vccz L_lw_108e
    s_sleep 2
    s_sub_u32 s60, s60, 1
    s_cbranch_scc0 L_lw_108
    s_mov_b32 s60, 0
L_lw_108e:
    s_cmp_eq_u32 s59, 0
    s_cbranch_scc1 L_nofrag_107
    v_lshrrev_b32 v109, 4, v0
    v_bfe_u32 v104, v0, 1, 1
    v_lshl_add_u32 v104, v109, 1, v104
    v_bfe_u32 v110, v0, 2, 2
    v_lshl_add_u32 v104, v104, 3, v110
    v_lshlrev_b32 v104, 7, v104
    v_and_b32 v110, 1, v0
    v_lshl_add_u32 v104, v110, 3, v104
    s_lshr_b32 s63, s3, 1
    s_and_b32 s62, s3, 1
    s_lshl_b32 s96, s63, 14
    s_lshl_b32 s100, s62, 6
    s_add_u32 s100, s100, 81920
    s_add_u32 s96, s96, s100
    v_add_u32 v104, s96, v104
    ds_read_b64_tr_b16 v[72:73], v104 offset:0
    ds_read_b64_tr_b16 v[74:75], v104 offset:512
    ds_read_b64_tr_b16 v[76:77], v104 offset:16
    ds_read_b64_tr_b16 v[78:79], v104 offset:528
    ds_read_b64_tr_b16 v[80:81], v104 offset:32
    ds_read_b64_tr_b16 v[82:83], v104 offset:544
    ds_read_b64_tr_b16 v[84:85], v104 offset:48
    ds_read_b64_tr_b16 v[86:87], v104 offset:560
    ds_read_b64_tr_b16 v[88:89], v104 offset:8192
    ds_read_b64_tr_b16 v[90:91], v104 offset:8704
    ds_read_b64_tr_b16 v[92:93], v104 offset:8208
    ds_read_b64_tr_b16 v[94:95], v104 offset:8720
    ds_read_b64_tr_b16 v[96:97], v104 offset:8224
    ds_read_b64_tr_b16 v[98:99], v104 offset:8736
    ds_read_b64_tr_b16 v[100:101], v104 offset:8240
    ds_read_b64_tr_b16 v[102:103], v104 offset:8752
    v_bfe_u32 v105, v0, 1, 3
    v_lshlrev_b32 v105, 8, v105
    v_lshl_add_u32 v105, v109, 5, v105
    v_lshl_add_u32 v105, v110, 4, v105
    v_lshrrev_b32 v106, 3, v0
    v_lshlrev_b32 v106, 7, v106
    v_and_b32 v110, 7, v0
    v_lshl_add_u32 v107, v110, 3, v106
    v_add_u32 v107, s100, v107
    v_lshl_add_u32 v106, v110, 2, v106
    v_add_u32 v106, s96, v106
    v_lshlrev_b32 v108, 2, v0
    s_lshl_b32 s96, s62, 2
    s_add_u32 s96, s96, 162088
    v_mov_b32 v109, s96
    s_lshl_b32 s100, s63, 11
    s_lshl_b32 s96, s34, 13
    s_add_u32 s100, s100, s96
    s_add_u32 s100, s100, 90112
    s_mul_i32 s101, s34, 5120
    s_lshl_b32 s96, s35, 9
    s_add_u32 s101, s101, s96
    s_lshl_b32 s96, s62, 8
    s_add_u32 s101, s101, s96
    s_add_u32 s101, s101, 144384
L_nofrag_107:
    s_cmp_ge_u32 s35, 20
    s_cbranch_scc1 L_nofin_109
    s_lshl1_add_u32 s62, s35, s3
    s_sub_u32 s62, s62, 6
    s_lshl_b32 s57, s62, 7
    s_mul_i32 s63, s62, 0x199a
    s_lshr_b32 s63, s63, 16
    s_mul_i32 s63, s63, 1280
    s_sub_u32 s63, s57, s63
    v_lshrrev_b32 v72, 3, v0
    v_mul_u32_u24 v72, 5120, v72
    v_and_b32 v8, 7, v0
    v_lshl_add_u32 v72, v8, 4, v72
    s_add_u32 s62, s57, 262144
    v_add_u32 v72, s62, v72
    v_add_u32 v73, 40960, v72
    v_add_u32 v74, 81920, v72
    v_add_u32 v75, 122880, v72
    v_bfe_u32 v9, v0, 4, 1
    v_lshlrev_b32 v76, 4, v8
    v_lshl_add_u32 v76, v9, 3, v76
    s_lshl_b32 s62, s57, 1
    s_add_u32 s62, s62, 87104
    v_lshl_add_u32 v77, v76, 1, s62
    s_mov_b32 s48, s22
    s_mov_b32 s49, s23
    s_mov_b32 s50, 1280
    s_mov_b32 s51, 0x20000
    buffer_load_dwordx2 v[86:87], v76, s[48:51], s63 offen
    s_add_u32 s62, s57, 35840
    s_branch L_poll_110
L_poll_110s:
    s_sleep 32
L_poll_110:
    buffer_load_dwordx2 v[8:9], v76, s[40:43], s62 offen sc1
    s_sub_u32 s60, s60, 1
    s_cbranch_scc1 L_poll_110t
    s_waitcnt vmcnt(0)
    v_max_u32 v38, v8, v9
    v_cmp_eq_u32 vcc, -1, v38
    s_cbranch_vccnz L_poll_110s
L_poll_110e:
    v_lshlrev_b32 v78, 16, v86
    v_and_b32 v79, 0xffff0000, v86
    v_lshlrev_b32 v82, 16, v8
    v_and_b32 v83, 0xffff0000, v8
    v_lshlrev_b32 v80, 16, v87
    v_and_b32 v81, 0xffff0000, v87
    v_lshlrev_b32 v84, 16, v9
    v_and_b32 v85, 0xffff0000, v9
    v_bfe_u32 v8, v0, 1, 3
    v_and_b32 v9, 1, v0
    v_lshlrev_b32 v9, 4, v9
    v_mov_b32 v10, 0x3f80
    v_lshlrev_b32 v9, v9, v10
    v_cmp_eq_u32 vcc, 0, v8
    v_mov_b32 v100, 0
    s_nop 0
    v_cndmask_b32 v104, 0, v9, vcc
    v_cmp_eq_u32 vcc, 1, v8
    v_mov_b32 v101, 0
    s_nop 0
    v_cndmask_b32 v105, 0, v9, vcc
    v_cmp_eq_u32 vcc, 2, v8
    v_mov_b32 v102, 0
    s_nop 0
    v_cndmask_b32 v106, 0, v9, vcc
    v_cmp_eq_u32 vcc, 3, v8
    v_mov_b32 v103, 0
    s_nop 0
    v_cndmask_b32 v107, 0, v9, vcc
L_nofin_109:
    v_mov_b32 v12, 162076
L_lw_111:
    ds_read_b32 v13, v12
    s_waitcnt lgkmcnt(0)
    v_cmp_gt_u32 vcc, 4, v13
    s_cbranch_vccz L_lw_111e
    s_sleep 4
    s_sub_u32 s60, s60, 1
    s_cbranch_scc0 L_lw_111
    s_mov_b32 s60, 0
L_lw_111e:
    v_and_b32 v11, 31, v0
    v_lshlrev_b32 v11, 2, v11
    s_lshl_b32 s63, s34, 7
    s_add_u32 s63, s63, 229376
    buffer_load_dword v12, v39, s[40:43], s98 offen sc1
    s_branch L_poll_112
L_poll_112s:
    s_sleep 16
L_poll_112:
    buffer_load_dwordx2 v[8:9], v2, s[40:43], s99 offen sc1
    buffer_load_dword v10, v11, s[40:43], s63 offen sc1
    buffer_load_dwordx4 v[32:35], v20, s[40:43], s97 offen sc1
    s_sub_u32 s60, s60, 1
    s_cbranch_scc1 L_poll_112t
    s_waitcnt vmcnt(0)
    v_max3_u32 v38, v8, v9, v10
    v_max3_u32 v38, v38, v32, v33
    v_max3_u32 v38, v38, v34, v35
    v_cmp_eq_u32 vcc, -1, v38
    s_cbranch_vccnz L_poll_112s
L_poll_112e:
    v_mov_b32 v37, v8
    s_nop 1
    v_max_f32_dpp v37, v37, v37 quad_perm:[1,0,3,2] row_mask:0xf bank_mask:0xf
    s_nop 1
    v_max_f32_dpp v37, v37, v37 quad_perm:[2,3,0,1] row_mask:0xf bank_mask:0xf
    s_nop 1
    v_max_f32_dpp v37, v37, v37 row_ror:4 row_mask:0xf bank_mask:0xf
    s_nop 1
    v_max_f32_dpp v37, v37, v37 row_ror:8 row_mask:0xf bank_mask:0xf
    v_sub_f32 v8, v8, v37
    v_exp_f32 v8, v8
    s_nop 0
    v_mul_f32 v9, v8, v9
    s_nop 1
    v_add_f32_dpp v9, v9, v9 quad_perm:[1,0,3,2] row_mask:0xf bank_mask:0xf
    s_nop 1
    v_add_f32_dpp v9, v9, v9 quad_perm:[2,3,0,1] row_mask:0xf bank_mask:0xf
    s_nop 1
    v_add_f32_dpp v9, v9, v9 row_ror:4 row_mask:0xf bank_mask:0xf
    s_nop 1
    v_add_f32_dpp v9, v9, v9 row_ror:8 row_mask:0xf bank_mask:0xf
    s_getreg_b32 s62, hwreg(HW_REG_XCC_ID, 0, 4)
    v_cmp_ne_u32 vcc, s62, v10
    s_nop 0
    s_cmp_eq_u64 vcc, 0
    s_cselect_b32 s61, 1, 0
    v_rcp_f32 v9, v9
    v_lshrrev_b32 v3, 1, v2
    v_add_u32 v3, 161984, v3
    v_mul_f32 v8, v8, v9
    v_mov_b32 v10, 162072
    v_mov_b32 v11, s61
    ds_write_b32 v3, v8
    ds_write_b32 v10, v11
    s_branch L_pxj
L_px6:
    s_or_b32 s96, s59, s39
    s_cbranch_scc0 L_nofrag_113
    v_mov_b32 v104, 162060
L_lw_114:
    ds_read_b32 v105, v104
    s_waitcnt lgkmcnt(0)
    v_cmp_gt_u32 vcc, 4, v105
    s_cbranch_vccz L_lw_114e
    s_sleep 2
    s_sub_u32 s60, s60, 1
    s_cbranch_scc0 L_lw_114
    s_mov_b32 s60, 0
L_lw_114e:
    s_cmp_eq_u32 s59, 0
    s_cbranch_scc1 L_nofrag_113
    v_lshrrev_b32 v109, 4, v0
    v_bfe_u32 v104, v0, 1, 1
    v_lshl_add_u32 v104, v109, 1, v104
    v_bfe_u32 v110, v0, 2, 2
    v_lshl_add_u32 v104, v104, 3, v110
    v_lshlrev_b32 v104, 7, v104
    v_and_b32 v110, 1, v0
    v_lshl_add_u32 v104, v110, 3, v104
    s_lshr_b32 s63, s3, 1
    s_and_b32 s62, s3, 1
    s_lshl_b32 s96, s63, 14
    s_lshl_b32 s100, s62, 6
    s_add_u32 s100, s100, 81920
    s_add_u32 s96, s96, s100
    v_add_u32 v104, s96, v104
    ds_read_b64_tr_b16 v[72:73], v104 offset:0
    ds_read_b64_tr_b16 v[74:75], v104 offset:512
    ds_read_b64_tr_b16 v[76:77], v104 offset:16
    ds_read_b64_tr_b16 v[78:79], v104 offset:528
    ds_read_b64_tr_b16 v[80:81], v104 offset:32
    ds_read_b64_tr_b16 v[82:83], v104 offset:544
    ds_read_b64_tr_b16 v[84:85], v104 offset:48
    ds_read_b64_tr_b16 v[86:87], v104 offset:560
    ds_read_b64_tr_b16 v[88:89], v104 offset:8192
    ds_read_b64_tr_b16 v[90:91], v104 offset:8704
    ds_read_b64_tr_b16 v[92:93], v104 offset:8208
    ds_read_b64_tr_b16 v[94:95], v104 offset:8720
    ds_read_b64_tr_b16 v[96:97], v104 offset:8224
    ds_read_b64_tr_b16 v[98:99], v104 offset:8736
    ds_read_b64_tr_b16 v[100:101], v104 offset:8240
    ds_read_b64_tr_b16 v[102:103], v104 offset:8752
    v_bfe_u32 v105, v0, 1, 3
    v_lshlrev_b32 v105, 8, v105
    v_lshl_add_u32 v105, v109, 5, v105
    v_lshl_add_u32 v105, v110, 4, v105
    v_lshrrev_b32 v106, 3, v0
    v_lshlrev_b32 v106, 7, v106
    v_and_b32 v110, 7, v0
    v_lshl_add_u32 v107, v110, 3, v106
    v_add_u32 v107, s100, v107
    v_lshl_add_u32 v106, v110, 2, v106
    v_add_u32 v106, s96, v106
    v_lshlrev_b32 v108, 2, v0
    s_lshl_b32 s96, s62, 2
    s_add_u32 s96, s96, 162088
    v_mov_b32 v109, s96
    s_lshl_b32 s100, s63, 11
    s_lshl_b32 s96, s34, 13
    s_add_u32 s100, s100, s96
    s_add_u32 s100, s100, 90112
    s_mul_i32 s101, s34, 5120
    s_lshl_b32 s96, s35, 9
    s_add_u32 s101, s101, s96
    s_lshl_b32 s96, s62, 8
    s_add_u32 s101, s101, s96
    s_add_u32 s101, s101, 144384
L_nofrag_113:
    v_mov_b32 v8, 162068
L_lw_115:
    ds_read_b32 v9, v8
    s_waitcnt lgkmcnt(0)
    v_cmp_gt_u32 vcc, 1, v9
    s_cbranch_vccz L_lw_115e
    s_sleep 32
    s_sub_u32 s60, s60, 1
    s_cbranch_scc0 L_lw_115
    s_mov_b32 s60, 0
L_lw_115e:
    s_cmp_ge_u32 s35, 20
    s_cbranch_scc1 L_nofin_116
    s_lshl1_add_u32 s62, s35, s3
    s_sub_u32 s62, s62, 6
    s_lshl_b32 s57, s62, 7
    s_mul_i32 s63, s62, 0x199a
    s_lshr_b32 s63, s63, 16
    s_mul_i32 s63, s63, 1280
    s_sub_u32 s63, s57, s63
    v_lshrrev_b32 v72, 3, v0
    v_mul_u32_u24 v72, 5120, v72
    v_and_b32 v8, 7, v0
    v_lshl_add_u32 v72, v8, 4, v72
    s_add_u32 s62, s57, 262144
    v_add_u32 v72, s62, v72
    v_add_u32 v73, 40960, v72
    v_add_u32 v74, 81920, v72
    v_add_u32 v75, 122880, v72
    v_bfe_u32 v9, v0, 4, 1
    v_lshlrev_b32 v76, 4, v8
    v_lshl_add_u32 v76, v9, 3, v76
    s_lshl_b32 s62, s57, 1
    s_add_u32 s62, s62, 87104
    v_lshl_add_u32 v77, v76, 1, s62
    s_mov_b32 s48, s22
    s_mov_b32 s49, s23
    s_mov_b32 s50, 1280
    s_mov_b32 s51, 0x20000
    buffer_load_dwordx2 v[86:87], v76, s[48:51], s63 offen
    s_add_u32 s62, s57, 35840
    s_branch L_poll_117
L_poll_117s:
    s_sleep 32
L_poll_117:
    buffer_load_dwordx2 v[8:9], v76, s[40:43], s62 offen sc1
    s_sub_u32 s60, s60, 1
    s_cbranch_scc1 L_poll_117t
    s_waitcnt vmcnt(0)
    v_max_u32 v38, v8, v9
    v_cmp_eq_u32 vcc, -1, v38
    s_cbranch_vccnz L_poll_117s
L_poll_117e:
    v_lshlrev_b32 v78, 16, v86
    v_and_b32 v79, 0xffff0000, v86
    v_lshlrev_b32 v82, 16, v8
    v_and_b32 v83, 0xffff0000, v8
    v_lshlrev_b32 v80, 16, v87
    v_and_b32 v81, 0xffff0000, v87
    v_lshlrev_b32 v84, 16, v9
    v_and_b32 v85, 0xffff0000, v9
    v_bfe_u32 v8, v0, 1, 3
    v_and_b32 v9, 1, v0
    v_lshlrev_b32 v9, 4, v9
    v_mov_b32 v10, 0x3f80
    v_lshlrev_b32 v9, v9, v10
    v_cmp_eq_u32 vcc, 0, v8
    v_mov_b32 v100, 0
    s_nop 0
    v_cndmask_b32 v104, 0, v9, vcc
    v_cmp_eq_u32 vcc, 1, v8
    v_mov_b32 v101, 0
    s_nop 0
    v_cndmask_b32 v105, 0, v9, vcc
    v_cmp_eq_u32 vcc, 2, v8
    v_mov_b32 v102, 0
    s_nop 0
    v_cndmask_b32 v106, 0, v9, vcc
    v_cmp_eq_u32 vcc, 3, v8
    v_mov_b32 v103, 0
    s_nop 0
    v_cndmask_b32 v107, 0, v9, vcc
L_nofin_116:
    v_mov_b32 v8, 162076
L_lw_118:
    ds_read_b32 v9, v8
    s_waitcnt lgkmcnt(0)
    v_cmp_gt_u32 vcc, 4, v9
    s_cbranch_vccz L_lw_118e
    s_sleep 16
    s_sub_u32 s60, s60, 1
    s_cbranch_scc0 L_lw_118
    s_mov_b32 s60, 0
L_lw_118e:
    s_branch L_poll_119
L_poll_119s:
    s_sleep 16
L_poll_119:
    buffer_load_dwordx4 v[32:35], v20, s[40:43], s97 offen sc1
    s_sub_u32 s60, s60, 1
    s_cbranch_scc1 L_poll_119t
    s_waitcnt vmcnt(0)
    v_max3_u32 v38, v32, v33, v34
    v_max_u32 v38, v38, v35
    v_cmp_eq_u32 vcc, -1, v38
    s_cbranch_vccnz L_poll_119s
L_poll_119e:
L_pxj:
    s_cmp_ge_u32 s35, 20
    s_cbranch_scc1 L_pxk
    buffer_load_dwordx4 v[88:91], v72, s[40:43], 0 offen sc1
    buffer_load_dwordx4 v[92:95], v73, s[40:43], 0 offen sc1
    buffer_load_dwordx4 v[96:99], v74, s[40:43], 0 offen sc1
    s_mov_b64 exec, 0xffffff
    buffer_load_dwordx4 v[100:103], v75, s[40:43], 0 offen sc1
    s_mov_b64 exec, -1
L_pxk:
    v_mov_b32 v8, 162048
L_lw_120:
    ds_read_b32 v9, v8
    s_waitcnt lgkmcnt(0)
    v_cmp_gt_u32 vcc, 3, v9
    s_cbranch_vccz L_lw_120e
    s_sleep 2
    s_sub_u32 s60, s60, 1
    s_cbranch_scc0 L_lw_120
    s_mov_b32 s60, 0
L_lw_120e:
    v_lshrrev_b32 v9, 4, v0
    v_lshl_add_u32 v8, v9, 2, v2
    s_lshl_b32 s96, s3, 9
    s_add_u32 s96, s96, 157824
    v_lshl_add_u32 v8, v8, 2, s96
    v_lshlrev_b32 v9, 3, v0
    v_add_u32 v9, 157824, v9
    v_mov_b32 v10, 162048
    v_mov_b32 v11, 1
    s_lshl_b32 s96, s38, 5
    s_add_u32 s96, s96, 161984
    v_mov_b32 v3, s96
    s_sub_u32 s62, 8, s39
    s_lshl_b32 s98, s34, 5
    s_add_u32 s98, s98, s35
    s_lshl_b32 s98, s98, 8
    s_add_u32 s98, s98, 90112
    v_lshlrev_b32 v39, 2, v0
    s_branch L_t0
L_s_role:
    s_cmp_eq_u32 s3, 7
    s_cbranch_scc1 L_t2gate
    s_cmp_gt_u32 s3, 3
    s_cbranch_scc1 L_fin_prep
    s_mov_b32 s48, s18
    s_mov_b32 s49, s19
    s_mov_b32 s50, 3456
    s_mov_b32 s51, 0x20000
    v_lshrrev_b32 v3, 4, v0
    v_bfe_u32 v1, v0, 2, 2
    v_and_b32 v2, 3, v0
    v_lshl_add_u32 v4, v3, 2, v1
    v_lshlrev_b32 v4, 1, v4
    s_lshl_b32 s62, s35, 7
    s_lshl_b32 s63, s3, 5
    s_add_u32 s62, s62, s63
    buffer_load_ushort v82, v4, s[48:51], s62 offen
    v_mov_b32 v72, 162064
L_lw_121:
    ds_read_b32 v73, v72
    s_waitcnt lgkmcnt(0)
    v_cmp_gt_u32 vcc, 4, v73
    s_cbranch_vccz L_lw_121e
    s_sleep 2
    s_sub_u32 s60, s60, 1
    s_cbranch_scc0 L_lw_121
    s_mov_b32 s60, 0
L_lw_121e:
    v_lshrrev_b32 v72, 4, v0
    v_lshlrev_b32 v72, 10, v72
    v_bfe_u32 v73, v0, 2, 2
    v_lshl_add_u32 v72, v73, 7, v72
    v_and_b32 v73, 3, v0
    v_lshl_add_u32 v72, v73, 3, v72
    v_bfe_u32 v73, v0, 3, 2
    v_lshl_add_u32 v72, v73, 5, v72
    v_xor_b32 v72, s63, v72
    v_add_u32 v73, 40960, v72
    v_and_b32 v5, 7, v0
    v_mul_u32_u24 v5, 1296, v5
    v_lshl_add_u32 v5, v3, 4, v5
    v_add_u32 v5, 147456, v5
    ds_read_b64_tr_b16 v[88:89], v72 offset:0
    ds_read_b64_tr_b16 v[90:91], v72 offset:512
    ds_read_b64_tr_b16 v[92:93], v72 offset:4096
    ds_read_b64_tr_b16 v[94:95], v72 offset:4608
    ds_read_b64_tr_b16 v[96:97], v72 offset:8192
    ds_read_b64_tr_b16 v[98:99], v72 offset:8704
    ds_read_b64_tr_b16 v[100:101], v72 offset:12288
    ds_read_b64_tr_b16 v[102:103], v72 offset:12800
    ds_read_b64_tr_b16 v[104:105], v72 offset:16384
    ds_read_b64_tr_b16 v[106:107], v72 offset:16896
    ds_read_b64_tr_b16 v[108:109], v72 offset:20480
    ds_read_b64_tr_b16 v[110:111], v72 offset:20992
    ds_read_b64_tr_b16 v[112:113], v72 offset:24576
    ds_read_b64_tr_b16 v[114:115], v72 offset:25088
    ds_read_b64_tr_b16 v[116:117], v72 offset:28672
    ds_read_b64_tr_b16 v[118:119], v72 offset:29184
    ds_read_b64_tr_b16 v[120:121], v72 offset:32768
    ds_read_b64_tr_b16 v[122:123], v72 offset:33280
    ds_read_b64_tr_b16 v[124:125], v72 offset:36864
    ds_read_b64_tr_b16 v[126:127], v72 offset:37376
    ds_read_b64_tr_b16 v[128:129], v73 offset:0
    ds_read_b64_tr_b16 v[130:131], v73 offset:512
    ds_read_b64_tr_b16 v[132:133], v73 offset:4096
    ds_read_b64_tr_b16 v[134:135], v73 offset:4608
    ds_read_b64_tr_b16 v[136:137], v73 offset:8192
    ds_read_b64_tr_b16 v[138:139], v73 offset:8704
    ds_read_b64_tr_b16 v[140:141], v73 offset:12288
    ds_read_b64_tr_b16 v[142:143], v73 offset:12800
    ds_read_b64_tr_b16 v[144:145], v73 offset:16384
    ds_read_b64_tr_b16 v[146:147], v73 offset:16896
    ds_read_b64_tr_b16 v[148:149], v73 offset:20480
    ds_read_b64_tr_b16 v[150:151], v73 offset:20992
    ds_read_b64_tr_b16 v[152:153], v73 offset:24576
    ds_read_b64_tr_b16 v[154:155], v73 offset:25088
    ds_read_b64_tr_b16 v[156:157], v73 offset:28672
    ds_read_b64_tr_b16 v[158:159], v73 offset:29184
    ds_read_b64_tr_b16 v[160:161], v73 offset:32768
    ds_read_b64_tr_b16 v[162:163], v73 offset:33280
    ds_read_b64_tr_b16 v[164:165], v73 offset:36864
    ds_read_b64_tr_b16 v[166:167], v73 offset:37376
    ds_read_b128 v[8:11], v5 offset:0
    ds_read_b128 v[12:15], v5 offset:64
    ds_read_b128 v[16:19], v5 offset:128
    ds_read_b128 v[20:23], v5 offset:192
    ds_read_b128 v[24:27], v5 offset:256
    ds_read_b128 v[28:31], v5 offset:320
    ds_read_b128 v[32:35], v5 offset:384
    ds_read_b128 v[36:39], v5 offset:448
    ds_read_b128 v[40:43], v5 offset:512
    ds_read_b128 v[44:47], v5 offset:576
    s_waitcnt lgkmcnt(9)
    v_mfma_f32_16x16x32_bf16 v[48:51], v[88:91], v[8:11], 0
    s_waitcnt lgkmcnt(8)
    v_mfma_f32_16x16x32_bf16 v[48:51], v[92:95], v[12:15], v[48:51]
    s_waitcnt lgkmcnt(7)
    v_mfma_f32_16x16x32_bf16 v[48:51], v[96:99], v[16:19], v[48:51]
    s_waitcnt lgkmcnt(6)
    v_mfma_f32_16x16x32_bf16 v[48:51], v[100:103], v[20:23], v[48:51]
    s_waitcnt lgkmcnt(5)
    v_mfma_f32_16x16x32_bf16 v[48:51], v[104:107], v[24:27], v[48:51]
    s_waitcnt lgkmcnt(4)
    v_mfma_f32_16x16x32_bf16 v[48:51], v[108:111], v[28:31], v[48:51]
    s_waitcnt lgkmcnt(3)
    v_mfma_f32_16x16x32_bf16 v[48:51], v[112:115], v[32:35], v[48:51]
    s_waitcnt lgkmcnt(2)
    v_mfma_f32_16x16x32_bf16 v[48:51], v[116:119], v[36:39], v[48:51]
    s_waitcnt lgkmcnt(1)
    v_mfma_f32_16x16x32_bf16 v[48:51], v[120:123], v[40:43], v[48:51]
    s_waitcnt lgkmcnt(0)
    v_mfma_f32_16x16x32_bf16 v[48:51], v[124:127], v[44:47], v[48:51]
    ds_read_b128 v[8:11], v5 offset:640
    ds_read_b128 v[12:15], v5 offset:704
    ds_read_b128 v[16:19], v5 offset:768
    ds_read_b128 v[20:23], v5 offset:832
    ds_read_b128 v[24:27], v5 offset:896
    ds_read_b128 v[28:31], v5 offset:960
    ds_read_b128 v[32:35], v5 offset:1024
    ds_read_b128 v[36:39], v5 offset:1088
    ds_read_b128 v[40:43], v5 offset:1152
    ds_read_b128 v[44:47], v5 offset:1216
    s_waitcnt lgkmcnt(9)
    v_mfma_f32_16x16x32_bf16 v[48:51], v[128:131], v[8:11], v[48:51]
    s_waitcnt lgkmcnt(8)
    v_mfma_f32_16x16x32_bf16 v[48:51], v[132:135], v[12:15], v[48:51]
    s_waitcnt lgkmcnt(7)
    v_mfma_f32_16x16x32_bf16 v[48:51], v[136:139], v[16:19], v[48:51]
    s_waitcnt lgkmcnt(6)
    v_mfma_f32_16x16x32_bf16 v[48:51], v[140:143], v[20:23], v[48:51]
    s_waitcnt lgkmcnt(5)
    v_mfma_f32_16x16x32_bf16 v[48:51], v[144:147], v[24:27], v[48:51]
    s_waitcnt lgkmcnt(4)
    v_mfma_f32_16x16x32_bf16 v[48:51], v[148:151], v[28:31], v[48:51]
    s_waitcnt lgkmcnt(3)
    v_mfma_f32_16x16x32_bf16 v[48:51], v[152:155], v[32:35], v[48:51]
    s_waitcnt lgkmcnt(2)
    v_mfma_f32_16x16x32_bf16 v[48:51], v[156:159], v[36:39], v[48:51]
    s_waitcnt lgkmcnt(1)
    v_mfma_f32_16x16x32_bf16 v[48:51], v[160:163], v[40:43], v[48:51]
    s_waitcnt lgkmcnt(0)
    v_mfma_f32_16x16x32_bf16 v[48:51], v[164:167], v[44:47], v[48:51]
    v_mul_u32_u24 v79, 1296, v2
    v_lshl_add_u32 v79, v1, 6, v79
    v_lshl_add_u32 v79, v3, 4, v79
    v_add_u32 v79, 81920, v79
    v_mul_u32_u24 v80, 144, v2
    v_add3_u32 v80, v80, v4, s63
    v_add_u32 v80, 97600, v80
    v_lshlrev_b32 v81, 6, v2
    v_add_u32 v81, 97344, v81
    v_mov_b32_dpp v84, v48 quad_perm:[0,1,2,3] row_mask:0xf bank_mask:0x1
    v_mov_b32_dpp v85, v48 row_ror:4 row_mask:0xf bank_mask:0x1
    v_mov_b32_dpp v84, v49 row_ror:4 row_mask:0xf bank_mask:0x2
    v_mov_b32_dpp v85, v49 quad_perm:[0,1,2,3] row_mask:0xf bank_mask:0x2
    v_mov_b32_dpp v84, v50 quad_perm:[0,1,2,3] row_mask:0xf bank_mask:0x4
    v_mov_b32_dpp v85, v50 row_ror:4 row_mask:0xf bank_mask:0x4
    v_mov_b32_dpp v84, v51 row_ror:4 row_mask:0xf bank_mask:0x8
    v_mov_b32_dpp v85, v51 quad_perm:[0,1,2,3] row_mask:0xf bank_mask:0x8
    s_mov_b32 s62, 0xbacccccd
    s_mov_b32 s63, 0xbdd2d3e8
    v_mov_b32 v86, 0xc0135761
    s_branch L_ffn1
L_fin_prep:
    s_cmp_lg_u32 s3, 6
    s_cbranch_scc1 L_end
    s_cmp_ge_u32 s35, 20
    s_cbranch_scc1 L_end
    s_barrier
L_gbok:
    s_barrier
L_fin:
    s_mov_b32 s52, s28
    s_mov_b32 s53, s29
    s_mov_b32 s54, 5120
    s_mov_b32 s55, 0x20000
    s_mov_b64 s[4:5], -1
    s_mov_b64 s[6:7], -1
    s_mov_b64 s[8:9], -1
    s_mov_b64 s[10:11], 0xffffff
    s_barrier
    ds_read_b128 v[108:111], v77
    s_barrier
L_yg:
    s_mov_b64 exec, s[4:5]
    buffer_load_dwordx4 v[88:91], v72, s[40:43], 0 offen sc1
    s_mov_b64 exec, s[6:7]
    buffer_load_dwordx4 v[92:95], v73, s[40:43], 0 offen sc1
    s_mov_b64 exec, s[8:9]
    buffer_load_dwordx4 v[96:99], v74, s[40:43], 0 offen sc1
    s_mov_b64 exec, s[10:11]
    buffer_load_dwordx4 v[100:103], v75, s[40:43], 0 offen sc1
    s_mov_b64 exec, -1
    s_sub_u32 s60, s60, 1
    s_cbranch_scc1 L_ygt
    s_waitcnt vmcnt(3)
    v_max3_u32 v3, v88, v89, v90
    v_max_u32 v3, v3, v91
    v_cmp_eq_u32 s[4:5], -1, v3
    s_waitcnt vmcnt(2)
    v_max3_u32 v3, v92, v93, v94
    v_max_u32 v3, v3, v95
    v_cmp_eq_u32 s[6:7], -1, v3
    s_waitcnt vmcnt(1)
    v_max3_u32 v3, v96, v97, v98
    v_max_u32 v3, v3, v99
    v_cmp_eq_u32 s[8:9], -1, v3
    s_waitcnt vmcnt(0)
    v_max3_u32 v3, v100, v101, v102
    v_max_u32 v3, v3, v103
    v_cmp_eq_u32 s[10:11], -1, v3
    s_or_b64 s[16:17], s[4:5], s[6:7]
    s_or_b64 s[16:17], s[16:17], s[8:9]
    s_or_b64 s[16:17], s[16:17], s[10:11]
    s_cbranch_scc1 L_yg
L_ygd:
    v_mfma_f32_16x16x32_bf16 v[112:115], v[104:107], v[88:91], 0
    v_mfma_f32_16x16x32_bf16 v[112:115], v[104:107], v[92:95], v[112:115]
    v_mfma_f32_16x16x32_bf16 v[112:115], v[104:107], v[96:99], v[112:115]
    v_mfma_f32_16x16x32_bf16 v[112:115], v[104:107], v[100:103], v[112:115]
    s_waitcnt lgkmcnt(0)
    v_pk_fma_f32 v[108:109], v[78:79], v[82:83], v[108:109]
    v_pk_fma_f32 v[110:111], v[80:81], v[84:85], v[110:111]
    s_nop 4
    v_add_f32_dpp v112, v112, v112 row_ror:8 row_mask:0xf bank_mask:0xf
    v_add_f32_dpp v113, v113, v113 row_ror:8 row_mask:0xf bank_mask:0xf
    v_add_f32_dpp v114, v114, v114 row_ror:8 row_mask:0xf bank_mask:0xf
    v_add_f32_dpp v115, v115, v115 row_ror:8 row_mask:0xf bank_mask:0xf
    v_pk_fma_f32 v[112:113], v[112:113], v[82:83], v[108:109]
    v_pk_fma_f32 v[114:115], v[114:115], v[84:85], v[110:111]
    v_cvt_pk_bf16_f32 v112, v112, v113
    v_cvt_pk_bf16_f32 v113, v114, v115
    s_mov_b64 exec, 0x00ff00ff
    buffer_store_dwordx2 v[112:113], v76, s[52:55], s57 offen
    s_endpgm
L_t2gate:
    s_cmp_ge_u32 s35, 22
    s_cselect_b32 s62, 0, 0
    v_mov_b32 v8, 162088
L_lw_122:
    ds_read_b32 v9, v8
    s_waitcnt lgkmcnt(0)
    v_cmp_gt_u32 vcc, s62, v9
    s_cbranch_vccz L_lw_122e
    s_sleep 2
    s_sub_u32 s60, s60, 1
    s_cbranch_scc0 L_lw_122
    s_mov_b32 s60, 0
L_lw_122e:
    v_mov_b32 v8, 162048
L_lw_123:
    ds_read_b32 v9, v8
    s_waitcnt lgkmcnt(0)
    v_cmp_gt_u32 vcc, 8, v9
    s_cbranch_vccz L_lw_123e
    s_sleep 2
    s_sub_u32 s60, s60, 1
    s_cbranch_scc0 L_lw_123
    s_mov_b32 s60, 0
L_lw_123e:
    ds_read_b32 v9, v8 offset:24
    s_waitcnt lgkmcnt(0)
    v_readfirstlane_b32 s61, v9
    s_mov_b32 s58, 0x3f80
    s_mov_b32 s59, 0x3f800000
    s_mov_b32 s63, 0xff
L_pg:
    s_bitcmp0_b32 s63, 0
    s_cbranch_scc1 L_pgi0
    s_mov_b32 s62, 155648
    buffer_load_dwordx4 v[8:11], v5, s[40:43], s62 offen sc1
L_pgi0:
    s_bitcmp0_b32 s63, 1
    s_cbranch_scc1 L_pgi1
    s_mov_b32 s62, 160768
    buffer_load_dwordx4 v[12:15], v5, s[40:43], s62 offen sc1
L_pgi1:
    s_bitcmp0_b32 s63, 2
    s_cbranch_scc1 L_pgi2
    s_mov_b32 s62, 165888
    buffer_load_dwordx4 v[16:19], v5, s[40:43], s62 offen sc1
L_pgi2:
    s_bitcmp0_b32 s63, 3
    s_cbranch_scc1 L_pgi3
    s_mov_b32 s62, 171008
    buffer_load_dwordx4 v[20:23], v5, s[40:43], s62 offen sc1
L_pgi3:
    s_bitcmp0_b32 s63, 4
    s_cbranch_scc1 L_pgi4
    s_mov_b32 s62, 176128
    buffer_load_dwordx4 v[24:27], v5, s[40:43], s62 offen sc1
L_pgi4:
    s_bitcmp0_b32 s63, 5
    s_cbranch_scc1 L_pgi5
    s_mov_b32 s62, 181248
    buffer_load_dwordx4 v[28:31], v5, s[40:43], s62 offen sc1
L_pgi5:
    s_bitcmp0_b32 s63, 6
    s_cbranch_scc1 L_pgi6
    s_mov_b32 s62, 186368
    buffer_load_dwordx4 v[32:35], v5, s[40:43], s62 offen sc1
L_pgi6:
    s_bitcmp0_b32 s63, 7
    s_cbranch_scc1 L_pgi7
    s_mov_b32 s62, 191488
    buffer_load_dwordx4 v[36:39], v5, s[40:43], s62 offen sc1
L_pgi7:
    s_sub_u32 s60, s60, 1
    s_cselect_b32 s62, 0, -1
    s_cselect_b32 s60, 0, s60
    s_waitcnt vmcnt(0)
    s_bitcmp0_b32 s63, 0
    s_cbranch_scc1 L_pgc0
    v_max3_u32 v3, v8, v9, v10
    v_max_u32 v3, v3, v11
    v_and_b32 v3, s62, v3
    v_cmp_eq_u32 vcc, -1, v3
    s_cbranch_vccnz L_pgc0
    v_dot2c_f32_bf16 v64, s58, v8
    v_dot2c_f32_bf16 v65, s59, v8
    v_dot2c_f32_bf16 v66, s58, v9
    v_dot2c_f32_bf16 v67, s59, v9
    v_dot2c_f32_bf16 v68, s58, v10
    v_dot2c_f32_bf16 v69, s59, v10
    v_dot2c_f32_bf16 v70, s58, v11
    v_dot2c_f32_bf16 v71, s59, v11
    s_bitset0_b32 s63, 0
L_pgc0:
    s_bitcmp0_b32 s63, 1
    s_cbranch_scc1 L_pgc1
    v_max3_u32 v3, v12, v13, v14
    v_max_u32 v3, v3, v15
    v_and_b32 v3, s62, v3
    v_cmp_eq_u32 vcc, -1, v3
    s_cbranch_vccnz L_pgc1
    v_dot2c_f32_bf16 v64, s58, v12
    v_dot2c_f32_bf16 v65, s59, v12
    v_dot2c_f32_bf16 v66, s58, v13
    v_dot2c_f32_bf16 v67, s59, v13
    v_dot2c_f32_bf16 v68, s58, v14
    v_dot2c_f32_bf16 v69, s59, v14
    v_dot2c_f32_bf16 v70, s58, v15
    v_dot2c_f32_bf16 v71, s59, v15
    s_bitset0_b32 s63, 1
L_pgc1:
    s_bitcmp0_b32 s63, 2
    s_cbranch_scc1 L_pgc2
    v_max3_u32 v3, v16, v17, v18
    v_max_u32 v3, v3, v19
    v_and_b32 v3, s62, v3
    v_cmp_eq_u32 vcc, -1, v3
    s_cbranch_vccnz L_pgc2
    v_dot2c_f32_bf16 v64, s58, v16
    v_dot2c_f32_bf16 v65, s59, v16
    v_dot2c_f32_bf16 v66, s58, v17
    v_dot2c_f32_bf16 v67, s59, v17
    v_dot2c_f32_bf16 v68, s58, v18
    v_dot2c_f32_bf16 v69, s59, v18
    v_dot2c_f32_bf16 v70, s58, v19
    v_dot2c_f32_bf16 v71, s59, v19
    s_bitset0_b32 s63, 2
L_pgc2:
    s_bitcmp0_b32 s63, 3
    s_cbranch_scc1 L_pgc3
    v_max3_u32 v3, v20, v21, v22
    v_max_u32 v3, v3, v23
    v_and_b32 v3, s62, v3
    v_cmp_eq_u32 vcc, -1, v3
    s_cbranch_vccnz L_pgc3
    v_dot2c_f32_bf16 v64, s58, v20
    v_dot2c_f32_bf16 v65, s59, v20
    v_dot2c_f32_bf16 v66, s58, v21
    v_dot2c_f32_bf16 v67, s59, v21
    v_dot2c_f32_bf16 v68, s58, v22
    v_dot2c_f32_bf16 v69, s59, v22
    v_dot2c_f32_bf16 v70, s58, v23
    v_dot2c_f32_bf16 v71, s59, v23
    s_bitset0_b32 s63, 3
L_pgc3:
    s_bitcmp0_b32 s63, 4
    s_cbranch_scc1 L_pgc4
    v_max3_u32 v3, v24, v25, v26
    v_max_u32 v3, v3, v27
    v_and_b32 v3, s62, v3
    v_cmp_eq_u32 vcc, -1, v3
    s_cbranch_vccnz L_pgc4
    v_dot2c_f32_bf16 v64, s58, v24
    v_dot2c_f32_bf16 v65, s59, v24
    v_dot2c_f32_bf16 v66, s58, v25
    v_dot2c_f32_bf16 v67, s59, v25
    v_dot2c_f32_bf16 v68, s58, v26
    v_dot2c_f32_bf16 v69, s59, v26
    v_dot2c_f32_bf16 v70, s58, v27
    v_dot2c_f32_bf16 v71, s59, v27
    s_bitset0_b32 s63, 4
L_pgc4:
    s_bitcmp0_b32 s63, 5
    s_cbranch_scc1 L_pgc5
    v_max3_u32 v3, v28, v29, v30
    v_max_u32 v3, v3, v31
    v_and_b32 v3, s62, v3
    v_cmp_eq_u32 vcc, -1, v3
    s_cbranch_vccnz L_pgc5
    v_dot2c_f32_bf16 v64, s58, v28
    v_dot2c_f32_bf16 v65, s59, v28
    v_dot2c_f32_bf16 v66, s58, v29
    v_dot2c_f32_bf16 v67, s59, v29
    v_dot2c_f32_bf16 v68, s58, v30
    v_dot2c_f32_bf16 v69, s59, v30
    v_dot2c_f32_bf16 v70, s58, v31
    v_dot2c_f32_bf16 v71, s59, v31
    s_bitset0_b32 s63, 5
L_pgc5:
    s_bitcmp0_b32 s63, 6
    s_cbranch_scc1 L_pgc6
    v_max3_u32 v3, v32, v33, v34
    v_max_u32 v3, v3, v35
    v_and_b32 v3, s62, v3
    v_cmp_eq_u32 vcc, -1, v3
    s_cbranch_vccnz L_pgc6
    v_dot2c_f32_bf16 v64, s58, v32
    v_dot2c_f32_bf16 v65, s59, v32
    v_dot2c_f32_bf16 v66, s58, v33
    v_dot2c_f32_bf16 v67, s59, v33
    v_dot2c_f32_bf16 v68, s58, v34
    v_dot2c_f32_bf16 v69, s59, v34
    v_dot2c_f32_bf16 v70, s58, v35
    v_dot2c_f32_bf16 v71, s59, v35
    s_bitset0_b32 s63, 6
L_pgc6:
    s_bitcmp0_b32 s63, 7
    s_cbranch_scc1 L_pgc7
    v_max3_u32 v3, v36, v37, v38
    v_max_u32 v3, v3, v39
    v_and_b32 v3, s62, v3
    v_cmp_eq_u32 vcc, -1, v3
    s_cbranch_vccnz L_pgc7
    v_dot2c_f32_bf16 v64, s58, v36
    v_dot2c_f32_bf16 v65, s59, v36
    v_dot2c_f32_bf16 v66, s58, v37
    v_dot2c_f32_bf16 v67, s59, v37
    v_dot2c_f32_bf16 v68, s58, v38
    v_dot2c_f32_bf16 v69, s59, v38
    v_dot2c_f32_bf16 v70, s58, v39
    v_dot2c_f32_bf16 v71, s59, v39
    s_bitset0_b32 s63, 7
L_pgc7:
    s_bcnt1_i32_b32 s62, s63
    s_cbranch_scc0 L_pgd
    s_cmp_gt_u32 s62, 5
    s_cbranch_scc1 L_pg
    s_ff1_i32_b32 s96, s63
    s_bitset0_b32 s63, s96
    s_mul_i32 s96, s96, 5120
    s_add_u32 s96, s96, 155648
    s_cmp_eq_u32 s62, 1
    s_cbranch_scc1 L_pt1
    s_ff1_i32_b32 s97, s63
    s_bitset0_b32 s63, s97
    s_mul_i32 s97, s97, 5120
    s_add_u32 s97, s97, 155648
    s_cmp_eq_u32 s62, 2
    s_cbranch_scc1 L_pt2
    s_ff1_i32_b32 s98, s63
    s_bitset0_b32 s63, s98
    s_mul_i32 s98, s98, 5120
    s_add_u32 s98, s98, 155648
    s_cmp_eq_u32 s62, 3
    s_cbranch_scc1 L_pt3
    s_ff1_i32_b32 s99, s63
    s_bitset0_b32 s63, s99
    s_mul_i32 s99, s99, 5120
    s_add_u32 s99, s99, 155648
    s_cmp_eq_u32 s62, 4
    s_cbranch_scc1 L_pt4
    s_ff1_i32_b32 s100, s63
    s_bitset0_b32 s63, s100
    s_mul_i32 s100, s100, 5120
    s_add_u32 s100, s100, 155648
L_pt5:
L_poll_124:
    buffer_load_dwordx4 v[16:19], v5, s[40:43], s96 offen sc1
    buffer_load_dwordx4 v[20:23], v5, s[40:43], s97 offen sc1
    buffer_load_dwordx4 v[24:27], v5, s[40:43], s98 offen sc1
    buffer_load_dwordx4 v[28:31], v5, s[40:43], s99 offen sc1
    buffer_load_dwordx4 v[32:35], v5, s[40:43], s100 offen sc1
    s_sub_u32 s60, s60, 1
    s_cbranch_scc1 L_poll_124t
    s_waitcnt vmcnt(0)
    v_max3_u32 v3, v16, v17, v18
    v_max3_u32 v3, v3, v19, v20
    v_max3_u32 v3, v3, v21, v22
    v_max3_u32 v3, v3, v23, v24
    v_max3_u32 v3, v3, v25, v26
    v_max3_u32 v3, v3, v27, v28
    v_max3_u32 v3, v3, v29, v30
    v_max3_u32 v3, v3, v31, v32
    v_max3_u32 v3, v3, v33, v34
    v_max_u32 v3, v3, v35
    v_cmp_eq_u32 vcc, -1, v3
    s_cbranch_vccnz L_poll_124
L_poll_124e:
    v_dot2c_f32_bf16 v64, s58, v16
    v_dot2c_f32_bf16 v65, s59, v16
    v_dot2c_f32_bf16 v66, s58, v17
    v_dot2c_f32_bf16 v67, s59, v17
    v_dot2c_f32_bf16 v68, s58, v18
    v_dot2c_f32_bf16 v69, s59, v18
    v_dot2c_f32_bf16 v70, s58, v19
    v_dot2c_f32_bf16 v71, s59, v19
    v_dot2c_f32_bf16 v64, s58, v20
    v_dot2c_f32_bf16 v65, s59, v20
    v_dot2c_f32_bf16 v66, s58, v21
    v_dot2c_f32_bf16 v67, s59, v21
    v_dot2c_f32_bf16 v68, s58, v22
    v_dot2c_f32_bf16 v69, s59, v22
    v_dot2c_f32_bf16 v70, s58, v23
    v_dot2c_f32_bf16 v71, s59, v23
    v_dot2c_f32_bf16 v64, s58, v24
    v_dot2c_f32_bf16 v65, s59, v24
    v_dot2c_f32_bf16 v66, s58, v25
    v_dot2c_f32_bf16 v67, s59, v25
    v_dot2c_f32_bf16 v68, s58, v26
    v_dot2c_f32_bf16 v69, s59, v26
    v_dot2c_f32_bf16 v70, s58, v27
    v_dot2c_f32_bf16 v71, s59, v27
    v_dot2c_f32_bf16 v64, s58, v28
    v_dot2c_f32_bf16 v65, s59, v28
    v_dot2c_f32_bf16 v66, s58, v29
    v_dot2c_f32_bf16 v67, s59, v29
    v_dot2c_f32_bf16 v68, s58, v30
    v_dot2c_f32_bf16 v69, s59, v30
    v_dot2c_f32_bf16 v70, s58, v31
    v_dot2c_f32_bf16 v71, s59, v31
    v_dot2c_f32_bf16 v64, s58, v32
    v_dot2c_f32_bf16 v65, s59, v32
    v_dot2c_f32_bf16 v66, s58, v33
    v_dot2c_f32_bf16 v67, s59, v33
    v_dot2c_f32_bf16 v68, s58, v34
    v_dot2c_f32_bf16 v69, s59, v34
    v_dot2c_f32_bf16 v70, s58, v35
    v_dot2c_f32_bf16 v71, s59, v35
    s_branch L_pgd
L_pt4:
L_poll_125:
    buffer_load_dwordx4 v[16:19], v5, s[40:43], s96 offen sc1
    buffer_load_dwordx4 v[20:23], v5, s[40:43], s97 offen sc1
    buffer_load_dwordx4 v[24:27], v5, s[40:43], s98 offen sc1
    buffer_load_dwordx4 v[28:31], v5, s[40:43], s99 offen sc1
    s_sub_u32 s60, s60, 1
    s_cbranch_scc1 L_poll_125t
    s_waitcnt vmcnt(0)
    v_max3_u32 v3, v16, v17, v18
    v_max3_u32 v3, v3, v19, v20
    v_max3_u32 v3, v3, v21, v22
    v_max3_u32 v3, v3, v23, v24
    v_max3_u32 v3, v3, v25, v26
    v_max3_u32 v3, v3, v27, v28
    v_max3_u32 v3, v3, v29, v30
    v_max_u32 v3, v3, v31
    v_cmp_eq_u32 vcc, -1, v3
    s_cbranch_vccnz L_poll_125
L_poll_125e:
    v_dot2c_f32_bf16 v64, s58, v16
    v_dot2c_f32_bf16 v65, s59, v16
    v_dot2c_f32_bf16 v66, s58, v17
    v_dot2c_f32_bf16 v67, s59, v17
    v_dot2c_f32_bf16 v68, s58, v18
    v_dot2c_f32_bf16 v69, s59, v18
    v_dot2c_f32_bf16 v70, s58, v19
    v_dot2c_f32_bf16 v71, s59, v19
    v_dot2c_f32_bf16 v64, s58, v20
    v_dot2c_f32_bf16 v65, s59, v20
    v_dot2c_f32_bf16 v66, s58, v21
    v_dot2c_f32_bf16 v67, s59, v21
    v_dot2c_f32_bf16 v68, s58, v22
    v_dot2c_f32_bf16 v69, s59, v22
    v_dot2c_f32_bf16 v70, s58, v23
    v_dot2c_f32_bf16 v71, s59, v23
    v_dot2c_f32_bf16 v64, s58, v24
    v_dot2c_f32_bf16 v65, s59, v24
    v_dot2c_f32_bf16 v66, s58, v25
    v_dot2c_f32_bf16 v67, s59, v25
    v_dot2c_f32_bf16 v68, s58, v26
    v_dot2c_f32_bf16 v69, s59, v26
    v_dot2c_f32_bf16 v70, s58, v27
    v_dot2c_f32_bf16 v71, s59, v27
    v_dot2c_f32_bf16 v64, s58, v28
    v_dot2c_f32_bf16 v65, s59, v28
    v_dot2c_f32_bf16 v66, s58, v29
    v_dot2c_f32_bf16 v67, s59, v29
    v_dot2c_f32_bf16 v68, s58, v30
    v_dot2c_f32_bf16 v69, s59, v30
    v_dot2c_f32_bf16 v70, s58, v31
    v_dot2c_f32_bf16 v71, s59, v31
    s_branch L_pgd
L_pt3:
L_poll_126:
    buffer_load_dwordx4 v[16:19], v5, s[40:43], s96 offen sc1
    buffer_load_dwordx4 v[20:23], v5, s[40:43], s97 offen sc1
    buffer_load_dwordx4 v[24:27], v5, s[40:43], s98 offen sc1
    s_sub_u32 s60, s60, 1
    s_cbranch_scc1 L_poll_126t
    s_waitcnt vmcnt(0)
    v_max3_u32 v3, v16, v17, v18
    v_max3_u32 v3, v3, v19, v20
    v_max3_u32 v3, v3, v21, v22
    v_max3_u32 v3, v3, v23, v24
    v_max3_u32 v3, v3, v25, v26
    v_max_u32 v3, v3, v27
    v_cmp_eq_u32 vcc, -1, v3
    s_cbranch_vccnz L_poll_126
L_poll_126e:
    v_dot2c_f32_bf16 v64, s58, v16
    v_dot2c_f32_bf16 v65, s59, v16
    v_dot2c_f32_bf16 v66, s58, v17
    v_dot2c_f32_bf16 v67, s59, v17
    v_dot2c_f32_bf16 v68, s58, v18
    v_dot2c_f32_bf16 v69, s59, v18
    v_dot2c_f32_bf16 v70, s58, v19
    v_dot2c_f32_bf16 v71, s59, v19
    v_dot2c_f32_bf16 v64, s58, v20
    v_dot2c_f32_bf16 v65, s59, v20
    v_dot2c_f32_bf16 v66, s58, v21
    v_dot2c_f32_bf16 v67, s59, v21
    v_dot2c_f32_bf16 v68, s58, v22
    v_dot2c_f32_bf16 v69, s59, v22
    v_dot2c_f32_bf16 v70, s58, v23
    v_dot2c_f32_bf16 v71, s59, v23
    v_dot2c_f32_bf16 v64, s58, v24
    v_dot2c_f32_bf16 v65, s59, v24
    v_dot2c_f32_bf16 v66, s58, v25
    v_dot2c_f32_bf16 v67, s59, v25
    v_dot2c_f32_bf16 v68, s58, v26
    v_dot2c_f32_bf16 v69, s59, v26
    v_dot2c_f32_bf16 v70, s58, v27
    v_dot2c_f32_bf16 v71, s59, v27
    s_branch L_pgd
L_pt2:
L_poll_127:
    buffer_load_dwordx4 v[16:19], v5, s[40:43], s96 offen sc1
    buffer_load_dwordx4 v[20:23], v5, s[40:43], s97 offen sc1
    s_sub_u32 s60, s60, 1
    s_cbranch_scc1 L_poll_127t
    s_waitcnt vmcnt(0)
    v_max3_u32 v3, v16, v17, v18
    v_max3_u32 v3, v3, v19, v20
    v_max3_u32 v3, v3, v21, v22
    v_max_u32 v3, v3, v23
    v_cmp_eq_u32 vcc, -1, v3
    s_cbranch_vccnz L_poll_127
L_poll_127e:
    v_dot2c_f32_bf16 v64, s58, v16
    v_dot2c_f32_bf16 v65, s59, v16
    v_dot2c_f32_bf16 v66, s58, v17
    v_dot2c_f32_bf16 v67, s59, v17
    v_dot2c_f32_bf16 v68, s58, v18
    v_dot2c_f32_bf16 v69, s59, v18
    v_dot2c_f32_bf16 v70, s58, v19
    v_dot2c_f32_bf16 v71, s59, v19
    v_dot2c_f32_bf16 v64, s58, v20
    v_dot2c_f32_bf16 v65, s59, v20
    v_dot2c_f32_bf16 v66, s58, v21
    v_dot2c_f32_bf16 v67, s59, v21
    v_dot2c_f32_bf16 v68, s58, v22
    v_dot2c_f32_bf16 v69, s59, v22
    v_dot2c_f32_bf16 v70, s58, v23
    v_dot2c_f32_bf16 v71, s59, v23
    s_branch L_pgd
L_pt1:
L_poll_128:
    buffer_load_dwordx4 v[16:19], v5, s[40:43], s96 offen sc1
    s_sub_u32 s60, s60, 1
    s_cbranch_scc1 L_poll_128t
    s_waitcnt vmcnt(0)
    v_max3_u32 v3, v16, v17, v18
    v_max_u32 v3, v3, v19
    v_cmp_eq_u32 vcc, -1, v3
    s_cbranch_vccnz L_poll_128
L_poll_128e:
    v_dot2c_f32_bf16 v64, s58, v16
    v_dot2c_f32_bf16 v65, s59, v16
    v_dot2c_f32_bf16 v66, s58, v17
    v_dot2c_f32_bf16 v67, s59, v17
    v_dot2c_f32_bf16 v68, s58, v18
    v_dot2c_f32_bf16 v69, s59, v18
    v_dot2c_f32_bf16 v70, s58, v19
    v_dot2c_f32_bf16 v71, s59, v19
L_pgd:
    v_pk_fma_f32 v[64:65], v[64:65], v[48:49], v[40:41]
    v_pk_fma_f32 v[66:67], v[66:67], v[50:51], v[42:43]
    v_pk_fma_f32 v[68:69], v[68:69], v[52:53], v[44:45]
    v_pk_fma_f32 v[70:71], v[70:71], v[54:55], v[46:47]
    v_pk_mul_f32 v[56:57], v[64:65], v[56:57]
    v_pk_mul_f32 v[58:59], v[66:67], v[58:59]
    v_pk_mul_f32 v[60:61], v[68:69], v[60:61]
    v_pk_mul_f32 v[62:63], v[70:71], v[62:63]
    v_cvt_pk_bf16_f32 v8, v56, v57
    v_cvt_pk_bf16_f32 v9, v58, v59
    v_cvt_pk_bf16_f32 v10, v60, v61
    v_cvt_pk_bf16_f32 v11, v62, v63
    ds_write_b128 v4, v[8:11]
    v_pk_add_f32 v[40:41], v[64:65], v[66:67]
    v_pk_add_f32 v[42:43], v[68:69], v[70:71]
    v_pk_mul_f32 v[44:45], v[64:65], v[64:65]
    v_pk_mul_f32 v[46:47], v[66:67], v[66:67]
    v_pk_add_f32 v[40:41], v[40:41], v[42:43]
    v_pk_fma_f32 v[44:45], v[68:69], v[68:69], v[44:45]
    v_pk_fma_f32 v[46:47], v[70:71], v[70:71], v[46:47]
    s_waitcnt lgkmcnt(0)
    s_barrier
    v_add_f32 v8, v40, v41
    v_pk_add_f32 v[44:45], v[44:45], v[46:47]
    v_add_f32 v9, v44, v45
    v_add_f32_dpp v8, v8, v8 quad_perm:[1,0,3,2] row_mask:0xf bank_mask:0xf
    s_nop 0
    v_add_f32_dpp v9, v9, v9 quad_perm:[1,0,3,2] row_mask:0xf bank_mask:0xf
    v_add_f32_dpp v8, v8, v8 quad_perm:[2,3,0,1] row_mask:0xf bank_mask:0xf
    s_nop 0
    v_add_f32_dpp v9, v9, v9 quad_perm:[2,3,0,1] row_mask:0xf bank_mask:0xf
    v_add_f32_dpp v8, v8, v8 row_ror:4 row_mask:0xf bank_mask:0xf
    s_nop 0
    v_add_f32_dpp v9, v9, v9 row_ror:4 row_mask:0xf bank_mask:0xf
    v_add_f32_dpp v8, v8, v8 row_ror:8 row_mask:0xf bank_mask:0xf
    s_nop 0
    v_add_f32_dpp v9, v9, v9 row_ror:8 row_mask:0xf bank_mask:0xf
    ds_write_b64 v7, v[8:9]
    s_waitcnt lgkmcnt(0)
    s_barrier
    ds_write_b128 v6, v[64:67]
    ds_write_b128 v6, v[68:71] offset:16
    s_waitcnt vmcnt(0) lgkmcnt(0)
    s_cmp_lg_u32 s3, 7
    s_cbranch_scc1 L_ffn2
    s_cmp_lt_u32 s35, 20
    s_cbranch_scc1 L_fin
    s_endpgm
L_ffn1:
    s_barrier
    ds_read_b128 v[8:11], v79 offset:0
    ds_read_b128 v[12:15], v79 offset:256
    ds_read_b128 v[16:19], v79 offset:512
    ds_read_b128 v[20:23], v79 offset:768
    ds_read_b128 v[24:27], v79 offset:1024
    s_waitcnt vmcnt(0)
    v_lshlrev_b32 v82, 16, v82
    v_add_f32 v85, v85, v82
    s_waitcnt lgkmcnt(4)
    v_mfma_f32_16x16x32_bf16 v[32:35], v[88:91], v[8:11], 0
    v_mfma_f32_16x16x32_bf16 v[36:39], v[92:95], v[8:11], 0
    v_mfma_f32_16x16x32_bf16 v[40:43], v[96:99], v[8:11], 0
    v_mfma_f32_16x16x32_bf16 v[44:47], v[100:103], v[8:11], 0
    s_waitcnt lgkmcnt(3)
    v_mfma_f32_16x16x32_bf16 v[32:35], v[104:107], v[12:15], v[32:35]
    v_mfma_f32_16x16x32_bf16 v[36:39], v[108:111], v[12:15], v[36:39]
    v_mfma_f32_16x16x32_bf16 v[40:43], v[112:115], v[12:15], v[40:43]
    v_mfma_f32_16x16x32_bf16 v[44:47], v[116:119], v[12:15], v[44:47]
    s_waitcnt lgkmcnt(2)
    v_mfma_f32_16x16x32_bf16 v[32:35], v[120:123], v[16:19], v[32:35]
    v_mfma_f32_16x16x32_bf16 v[36:39], v[124:127], v[16:19], v[36:39]
    v_mfma_f32_16x16x32_bf16 v[40:43], v[128:131], v[16:19], v[40:43]
    v_mfma_f32_16x16x32_bf16 v[44:47], v[132:135], v[16:19], v[44:47]
    s_waitcnt lgkmcnt(1)
    s_barrier
    ds_read_b128 v[48:51], v81
    ds_read_b128 v[52:55], v81 offset:16
    ds_read_b64 v[56:57], v81 offset:32
    v_mfma_f32_16x16x32_bf16 v[32:35], v[136:139], v[20:23], v[32:35]
    v_mfma_f32_16x16x32_bf16 v[36:39], v[140:143], v[20:23], v[36:39]
    v_mfma_f32_16x16x32_bf16 v[40:43], v[144:147], v[20:23], v[40:43]
    v_mfma_f32_16x16x32_bf16 v[44:47], v[148:151], v[20:23], v[44:47]
    s_waitcnt lgkmcnt(3)
    v_mfma_f32_16x16x32_bf16 v[32:35], v[152:155], v[24:27], v[32:35]
    v_mfma_f32_16x16x32_bf16 v[36:39], v[156:159], v[24:27], v[36:39]
    s_waitcnt lgkmcnt(0)
    v_pk_add_f32 v[48:49], v[48:49], v[50:51]
    v_pk_add_f32 v[52:53], v[52:53], v[54:55]
    v_mfma_f32_16x16x32_bf16 v[40:43], v[160:163], v[24:27], v[40:43]
    v_pk_add_f32 v[48:49], v[48:49], v[56:57]
    v_pk_add_f32 v[48:49], v[48:49], v[52:53]
    v_mfma_f32_16x16x32_bf16 v[44:47], v[164:167], v[24:27], v[44:47]
    v_mul_f32 v48, s62, v48
    v_mul_f32 v49, s62, v49
    v_mul_f32 v7, v84, v48
    v_fma_f32 v49, -v48, v48, -v49
    v_max_f32 v49, 0, v49
    v_add_f32 v49, 0x3727c5ac, v49
    v_rsq_f32 v49, v49
    v_add_f32_dpp v5, v36, v7 row_ror:12 row_mask:0xf bank_mask:0x1
    v_add_f32_dpp v5, v41, v7 row_ror:12 row_mask:0xf bank_mask:0x2
    v_add_f32_dpp v5, v46, v7 row_ror:12 row_mask:0xf bank_mask:0x4
    v_add_f32_dpp v5, v35, v7 row_ror:12 row_mask:0xf bank_mask:0x8
    v_add_f32_dpp v4, v40, v32 row_ror:8 row_mask:0xf bank_mask:0x1
    v_add_f32_dpp v4, v45, v37 row_ror:8 row_mask:0xf bank_mask:0x2
    v_add_f32_dpp v4, v34, v42 row_ror:8 row_mask:0xf bank_mask:0x4
    v_add_f32_dpp v4, v39, v47 row_ror:8 row_mask:0xf bank_mask:0x8
    v_add_f32_dpp v6, v44, v5 row_ror:4 row_mask:0xf bank_mask:0x1
    v_add_f32_dpp v6, v33, v5 row_ror:4 row_mask:0xf bank_mask:0x2
    v_add_f32_dpp v6, v38, v5 row_ror:4 row_mask:0xf bank_mask:0x4
    v_add_f32_dpp v6, v43, v5 row_ror:4 row_mask:0xf bank_mask:0x8
    v_add_f32 v4, v4, v6
    v_fma_f32 v4, v4, v49, v85
    v_mul_f32 v5, v4, v4
    v_fma_f32 v5, v5, s63, v86
    v_mul_f32 v5, v5, v4
    v_exp_f32 v5, v5
    s_nop 0
    v_add_f32 v5, 1.0, v5
    v_rcp_f32 v5, v5
    s_nop 0
    v_mul_f32 v4, v4, v5
    v_cvt_pk_bf16_f32 v4, v4, v4
    ds_write_b16 v80, v4
    s_waitcnt lgkmcnt(0)
    s_barrier
    s_endpgm
L_h_t1:
    s_cmp_lg_u32 s3, 3
    s_cbranch_scc1 L_h_noclr
    s_sub_u32 s62, s56, 154
    s_cmp_lt_u32 s62, 30
    s_cbranch_scc0 L_h_noclr
    s_lshl_b32 s63, s62, 2
    s_mul_i32 s62, s62, 7168
    s_add_u32 s62, s62, 20480
    v_mov_b32 v4, -1
    v_mov_b32 v5, -1
    v_mov_b32 v6, -1
    v_mov_b32 v7, -1
    v_lshlrev_b32 v8, 4, v0
    buffer_store_dwordx4 v[4:7], v8, s[40:43], s62 offen offset:0 sc1
    buffer_store_dwordx4 v[4:7], v8, s[40:43], s62 offen offset:1024 sc1
    buffer_store_dwordx4 v[4:7], v8, s[40:43], s62 offen offset:2048 sc1
    buffer_store_dwordx4 v[4:7], v8, s[40:43], s62 offen offset:3072 sc1
    s_add_u32 s62, s62, 4096
    buffer_store_dwordx4 v[4:7], v8, s[40:43], s62 offen offset:0 sc1
    buffer_store_dwordx4 v[4:7], v8, s[40:43], s62 offen offset:1024 sc1
    buffer_store_dwordx4 v[4:7], v8, s[40:43], s62 offen offset:2048 sc1
    v_mov_b32 v8, s63
    s_waitcnt vmcnt(0)
    s_mov_b64 exec, 1
    buffer_store_dword v4, v8, s[44:47], 0 offen sc1
    s_mov_b64 exec, -1
L_h_noclr:
    v_lshrrev_b32 v1, 3, v0
    v_mul_u32_u24 v1, 1280, v1
    v_and_b32 v2, 7, v0
    v_lshl_add_u32 v1, v2, 4, v1
    s_lshl2_add_u32 s63, s34, s3
    s_mul_i32 s63, s63, 163840
    s_lshl_b32 s62, s35, 7
    s_add_u32 s63, s63, s62
    s_sub_u32 s63, s63, 2816
    s_lshl_b32 s62, s3, 14
    s_add_u32 s62, s62, 81920
    s_mov_b32 m0, s62
    s_mov_b32 s48, s12
    s_mov_b32 s49, s13
    s_mov_b32 s50, 5242880
    s_mov_b32 s51, 0x20000
    s_add_u32 s100, s39, 1
    s_mov_b32 s62, 8
L_dma_5:
    buffer_load_dwordx4 v1, s[48:51], s63 offen nt lds
    s_add_u32 m0, m0, 1024
    s_add_u32 s63, s63, 10240
    s_cmp_eq_u32 s100, 0
    s_cbranch_scc1 L_dma_5n0
    s_waitcnt vmcnt(7)
    s_cmp_eq_u32 s100, 2
    s_cbranch_scc1 L_dma_5n0
    s_waitcnt vmcnt(3)
L_dma_5n0:
    buffer_load_dwordx4 v1, s[48:51], s63 offen nt lds
    s_add_u32 m0, m0, 1024
    s_add_u32 s63, s63, 10240
    s_cmp_eq_u32 s100, 0
    s_cbranch_scc1 L_dma_5n1
    s_waitcnt vmcnt(7)
    s_cmp_eq_u32 s100, 2
    s_cbranch_scc1 L_dma_5n1
    s_waitcnt vmcnt(3)
L_dma_5n1:
    s_sub_u32 s62, s62, 1
    s_cmp_lg_u32 s62, 0
    s_cbranch_scc1 L_dma_5
    s_cmp_eq_u32 s39, 1
    s_cbranch_scc1 L_h_role
    s_waitcnt vmcnt(0)
    v_mov_b32 v4, 162060
    v_mov_b32 v5, 1
    s_mov_b64 exec, 1
    ds_add_u32 v4, v5
    s_mov_b64 exec, -1
    s_cmp_eq_u32 s3, 0
    s_cbranch_scc1 L_service
    s_endpgm
L_h_role:
    v_mov_b32 v72, 0
    v_mov_b32 v73, 0
    v_mov_b32 v74, 0
    v_mov_b32 v75, 0
    v_mov_b32 v76, 0
    v_lshrrev_b32 v3, 4, v0
    v_and_b32 v2, 3, v0
    v_bfe_u32 v1, v0, 2, 2
    v_mul_u32_u24 v160, 1280, v2
    v_lshl_add_u32 v160, v1, 5, v160
    v_lshl_add_u32 v160, v3, 3, v160
    s_mul_i32 s57, s35, 5120
    s_mul_i32 s62, s3, 320
    s_add_u32 s57, s57, s62
    s_add_u32 s57, s57, 262144
    v_mov_b32 v4, -1
    v_mov_b32 v5, -1
    v_mov_b32 v6, -1
    v_mov_b32 v7, -1
    v_lshlrev_b32 v8, 4, v0
    s_mul_i32 s62, s3, 960
    s_add_u32 s62, s62, s57
    buffer_store_dwordx4 v[4:7], v8, s[40:43], s62 offen sc1
    s_mov_b64 exec, 0xffff
    buffer_store_dwordx4 v[4:7], v8, s[40:43], s62 offen offset:1024 sc1
    s_mov_b64 exec, -1
    v_add_u32 v8, 0, v0
    v_mul_u32_u24 v10, 0xccd, v8
    v_lshrrev_b32 v10, 16, v10
    v_mul_u32_u24 v9, 20, v10
    v_sub_u32 v8, v8, v9
    v_mul_u32_u24 v10, 1280, v10
    v_lshl_add_u32 v10, v8, 4, v10
    v_add_u32 v8, 64, v0
    v_mul_u32_u24 v11, 0xccd, v8
    v_lshrrev_b32 v11, 16, v11
    v_mul_u32_u24 v9, 20, v11
    v_sub_u32 v8, v8, v9
    v_mul_u32_u24 v11, 1280, v11
    v_lshl_add_u32 v11, v8, 4, v11
    v_add_u32 v8, 128, v0
    v_mul_u32_u24 v12, 0xccd, v8
    v_lshrrev_b32 v12, 16, v12
    v_mul_u32_u24 v9, 20, v12
    v_sub_u32 v8, v8, v9
    v_mul_u32_u24 v12, 1280, v12
    v_lshl_add_u32 v12, v8, 4, v12
    v_add_u32 v8, 192, v0
    v_mul_u32_u24 v13, 0xccd, v8
    v_lshrrev_b32 v13, 16, v13
    v_mul_u32_u24 v9, 20, v13
    v_sub_u32 v8, v8, v9
    v_mul_u32_u24 v13, 1280, v13
    v_lshl_add_u32 v13, v8, 4, v13
    v_add_u32 v8, 256, v0
    v_mul_u32_u24 v14, 0xccd, v8
    v_lshrrev_b32 v14, 16, v14
    v_mul_u32_u24 v9, 20, v14
    v_sub_u32 v8, v8, v9
    v_mul_u32_u24 v14, 1280, v14
    v_lshl_add_u32 v14, v8, 4, v14
    s_waitcnt vmcnt(0)
    v_mov_b32 v8, 162060
    v_mov_b32 v9, 1
    s_mov_b64 exec, 1
    ds_add_u32 v8, v9
    s_mov_b64 exec, -1
    s_mov_b32 s48, s20
    s_mov_b32 s49, s21
    s_mov_b32 s50, 2211840
    s_mov_b32 s51, 0x20000
    s_mul_i32 s63, s35, 81920
    s_mul_i32 s62, s3, 320
    s_add_u32 s63, s63, s62
    s_mov_b32 m0, s101
    s_mov_b32 s62, 4
L_w2dma:
    buffer_load_dwordx4 v10, s[48:51], s63 offen nt lds
    s_add_u32 m0, m0, 1024
    s_waitcnt vmcnt(7)
    s_cmp_ge_u32 s35, 22
    s_cbranch_scc1 L_w2n0
    s_waitcnt vmcnt(7)
L_w2n0:
    buffer_load_dwordx4 v11, s[48:51], s63 offen nt lds
    s_add_u32 m0, m0, 1024
    s_waitcnt vmcnt(7)
    s_cmp_ge_u32 s35, 22
    s_cbranch_scc1 L_w2n1
    s_waitcnt vmcnt(7)
L_w2n1:
    buffer_load_dwordx4 v12, s[48:51], s63 offen nt lds
    s_add_u32 m0, m0, 1024
    s_waitcnt vmcnt(7)
    s_cmp_ge_u32 s35, 22
    s_cbranch_scc1 L_w2n2
    s_waitcnt vmcnt(7)
L_w2n2:
    buffer_load_dwordx4 v13, s[48:51], s63 offen nt lds
    s_add_u32 m0, m0, 1024
    s_waitcnt vmcnt(7)
    s_cmp_ge_u32 s35, 22
    s_cbranch_scc1 L_w2n3
    s_waitcnt vmcnt(7)
L_w2n3:
    buffer_load_dwordx4 v14, s[48:51], s63 offen nt lds
    s_add_u32 m0, m0, 1024
    s_waitcnt vmcnt(7)
    s_cmp_ge_u32 s35, 22
    s_cbranch_scc1 L_w2n4
    s_waitcnt vmcnt(7)
L_w2n4:
    s_add_u32 s63, s63, 20480
    s_sub_u32 s62, s62, 1
    s_cmp_lg_u32 s62, 0
    s_cbranch_scc1 L_w2dma
    v_lshl_add_u32 v8, v3, 3, v1
    v_mul_u32_u24 v8, 320, v8
    v_lshl_add_u32 v8, v2, 3, v8
    v_add_u32 v8, s101, v8
    s_waitcnt vmcnt(0)
    ds_read_b64_tr_b16 v[80:81], v8 offset:0
    ds_read_b64_tr_b16 v[82:83], v8 offset:1280
    ds_read_b64_tr_b16 v[84:85], v8 offset:10240
    ds_read_b64_tr_b16 v[86:87], v8 offset:11520
    ds_read_b64_tr_b16 v[88:89], v8 offset:32
    ds_read_b64_tr_b16 v[90:91], v8 offset:1312
    ds_read_b64_tr_b16 v[92:93], v8 offset:10272
    ds_read_b64_tr_b16 v[94:95], v8 offset:11552
    ds_read_b64_tr_b16 v[96:97], v8 offset:64
    ds_read_b64_tr_b16 v[98:99], v8 offset:1344
    ds_read_b64_tr_b16 v[100:101], v8 offset:10304
    ds_read_b64_tr_b16 v[102:103], v8 offset:11584
    ds_read_b64_tr_b16 v[104:105], v8 offset:96
    ds_read_b64_tr_b16 v[106:107], v8 offset:1376
    ds_read_b64_tr_b16 v[108:109], v8 offset:10336
    ds_read_b64_tr_b16 v[110:111], v8 offset:11616
    ds_read_b64_tr_b16 v[112:113], v8 offset:128
    ds_read_b64_tr_b16 v[114:115], v8 offset:1408
    ds_read_b64_tr_b16 v[116:117], v8 offset:10368
    ds_read_b64_tr_b16 v[118:119], v8 offset:11648
    ds_read_b64_tr_b16 v[120:121], v8 offset:160
    ds_read_b64_tr_b16 v[122:123], v8 offset:1440
    ds_read_b64_tr_b16 v[124:125], v8 offset:10400
    ds_read_b64_tr_b16 v[126:127], v8 offset:11680
    ds_read_b64_tr_b16 v[128:129], v8 offset:192
    ds_read_b64_tr_b16 v[130:131], v8 offset:1472
    ds_read_b64_tr_b16 v[132:133], v8 offset:10432
    ds_read_b64_tr_b16 v[134:135], v8 offset:11712
    ds_read_b64_tr_b16 v[136:137], v8 offset:224
    ds_read_b64_tr_b16 v[138:139], v8 offset:1504
    ds_read_b64_tr_b16 v[140:141], v8 offset:10464
    ds_read_b64_tr_b16 v[142:143], v8 offset:11744
    ds_read_b64_tr_b16 v[144:145], v8 offset:256
    ds_read_b64_tr_b16 v[146:147], v8 offset:1536
    ds_read_b64_tr_b16 v[148:149], v8 offset:10496
    ds_read_b64_tr_b16 v[150:151], v8 offset:11776
    ds_read_b64_tr_b16 v[152:153], v8 offset:288
    ds_read_b64_tr_b16 v[154:155], v8 offset:1568
    ds_read_b64_tr_b16 v[156:157], v8 offset:10528
    ds_read_b64_tr_b16 v[158:159], v8 offset:11808
    s_mov_b32 s48, s16
    s_mov_b32 s49, s17
    s_mov_b32 s50, 2211840
    s_mov_b32 s51, 0x20000
    s_lshl_b32 s98, s35, 7
    s_mov_b32 s99, 3456
    v_lshrrev_b32 v9, 3, v0
    v_mul_lo_u32 v10, v9, s99
    v_and_b32 v9, 2, v9
    v_xor_b32 v9, v9, v0
    v_and_b32 v9, 7, v9
    v_lshl_add_u32 v10, v9, 4, v10
    v_add_u32 v10, s98, v10
    v_xor_b32 v11, 64, v10
    s_mul_i32 s63, s3, 552960
    s_mov_b32 m0, s101
    s_waitcnt lgkmcnt(0)
    s_cmp_ge_u32 s35, 22
    s_cselect_b32 s100, 2, 1
    s_mov_b32 s62, 10
L_dma_6:
    buffer_load_dwordx4 v10, s[48:51], s63 offen nt lds
    s_add_u32 m0, m0, 1024
    s_add_u32 s63, s63, 27648
    s_cmp_eq_u32 s100, 0
    s_cbranch_scc1 L_dma_6n0
    s_waitcnt vmcnt(7)
    s_cmp_eq_u32 s100, 2
    s_cbranch_scc1 L_dma_6n0
    s_waitcnt vmcnt(7)
L_dma_6n0:
    buffer_load_dwordx4 v11, s[48:51], s63 offen nt lds
    s_add_u32 m0, m0, 1024
    s_add_u32 s63, s63, 27648
    s_cmp_eq_u32 s100, 0
    s_cbranch_scc1 L_dma_6n1
    s_waitcnt vmcnt(7)
    s_cmp_eq_u32 s100, 2
    s_cbranch_scc1 L_dma_6n1
    s_waitcnt vmcnt(7)
L_dma_6n1:
    s_sub_u32 s62, s62, 1
    s_cmp_lg_u32 s62, 0
    s_cbranch_scc1 L_dma_6
    v_mov_b32 v8, 162068
L_lw_7:
    ds_read_b32 v9, v8
    s_waitcnt lgkmcnt(0)
    v_cmp_gt_u32 vcc, 1, v9
    s_cbranch_vccz L_lw_7e
    s_sleep 8
    s_sub_u32 s60, s60, 1
    s_cbranch_scc0 L_lw_7
    s_mov_b32 s60, 0
L_lw_7e:
    s_cmp_lg_u32 s3, 3
    s_cbranch_scc1 L_h_nomo
    v_and_b32 v4, 15, v0
    v_lshlrev_b32 v4, 4, v4
    v_mul_u32_u24 v5, 1280, v3
    v_add_u32 v5, v5, v4
    v_mul_u32_u24 v6, 1296, v3
    v_add_u32 v6, v6, v4
    v_add_u32 v6, 147456, v6
    s_mov_b32 s62, 30720
    s_mov_b32 s63, 25600
    s_branch L_poll_8
L_poll_8s:
    s_sleep 8
L_poll_8:
    buffer_load_dwordx4 v[40:43], v5, s[40:43], s62 offen offset:0 sc1
    buffer_load_dwordx4 v[44:47], v5, s[40:43], s62 offen offset:256 sc1
    buffer_load_dwordx4 v[48:51], v5, s[40:43], s62 offen offset:512 sc1
    buffer_load_dwordx4 v[52:55], v5, s[40:43], s62 offen offset:768 sc1
    buffer_load_dwordx4 v[56:59], v5, s[40:43], s62 offen offset:1024 sc1
    buffer_load_dwordx4 v[60:63], v5, s[40:43], s63 offen offset:0 sc1
    buffer_load_dwordx4 v[64:67], v5, s[40:43], s63 offen offset:256 sc1
    buffer_load_dwordx4 v[68:71], v5, s[40:43], s63 offen offset:512 sc1
    buffer_load_dwordx4 v[72:75], v5, s[40:43], s63 offen offset:768 sc1
    buffer_load_dwordx4 v[76:79], v5, s[40:43], s63 offen offset:1024 sc1
    s_sub_u32 s60, s60, 1
    s_cbranch_scc1 L_poll_8t
    s_waitcnt vmcnt(0)
    v_max3_u32 v7, v40, v41, v42
    v_max3_u32 v7, v7, v43, v44
    v_max3_u32 v7, v7, v45, v46
    v_max3_u32 v7, v7, v47, v48
    v_max3_u32 v7, v7, v49, v50
    v_max3_u32 v7, v7, v51, v52
    v_max3_u32 v7, v7, v53, v54
    v_max3_u32 v7, v7, v55, v56
    v_max3_u32 v7, v7, v57, v58
    v_max3_u32 v7, v7, v59, v60
    v_max3_u32 v7, v7, v61, v62
    v_max3_u32 v7, v7, v63, v64
    v_max3_u32 v7, v7, v65, v66
    v_max3_u32 v7, v7, v67, v68
    v_max3_u32 v7, v7, v69, v70
    v_max3_u32 v7, v7, v71, v72
    v_max3_u32 v7, v7, v73, v74
    v_max3_u32 v7, v7, v75, v76
    v_max3_u32 v7, v7, v77, v78
    v_max_u32 v7, v7, v79
    v_cmp_eq_u32 vcc, -1, v7
    s_cbranch_vccnz L_poll_8s
L_poll_8e:
    ds_write_b128 v6, v[40:43] offset:0
    ds_write_b128 v6, v[44:47] offset:256
    ds_write_b128 v6, v[48:51] offset:512
    ds_write_b128 v6, v[52:55] offset:768
    ds_write_b128 v6, v[56:59] offset:1024
    ds_write_b128 v6, v[60:63] offset:5184
    ds_write_b128 v6, v[64:67] offset:5440
    ds_write_b128 v6, v[68:71] offset:5696
    ds_write_b128 v6, v[72:75] offset:5952
    ds_write_b128 v6, v[76:79] offset:6208
L_h_nomo:
    v_mul_u32_u24 v4, 144, v2
    v_lshl_add_u32 v4, v3, 4, v4
    v_add_u32 v161, 97600, v4
    s_mov_b32 s100, s3
    s_lshl_b32 s63, s100, 8
    v_and_b32 v8, 15, v0
    v_lshl_add_u32 v8, v8, 4, s63
    v_lshrrev_b32 v9, 4, v0
    v_mul_u32_u24 v5, 1280, v9
    v_add_u32 v5, v5, v8
    v_mul_u32_u24 v4, 1296, v9
    v_add_u32 v4, v4, v8
    v_add_u32 v4, 81920, v4
    v_lshlrev_b32 v6, 1, v5
    v_add_u32 v6, 87104, v6
    s_lshl_b32 s62, s100, 3
    s_add_u32 s62, s62, 97344
    v_lshl_add_u32 v7, v9, 6, s62
    s_mov_b32 s48, s4
    s_mov_b32 s49, s5
    s_mov_b32 s50, 5120
    s_mov_b32 s51, 0x20000
    buffer_load_dwordx4 v[8:11], v5, s[48:51], 0 offen
    s_mov_b32 s62, 20480
    s_mov_b32 s63, 30720
    s_branch L_poll_9
L_poll_9s:
    s_sleep 8
L_poll_9:
    buffer_load_dwordx4 v[12:15], v5, s[40:43], s62 offen sc1
    buffer_load_dwordx4 v[16:19], v5, s[40:43], s63 offen sc1
    s_sub_u32 s60, s60, 1
    s_cbranch_scc1 L_poll_9t
    s_waitcnt vmcnt(0)
    v_max3_u32 v38, v12, v13, v14
    v_max3_u32 v38, v38, v15, v16
    v_max3_u32 v38, v38, v17, v18
    v_max_u32 v38, v38, v19
    v_cmp_eq_u32 vcc, -1, v38
    s_cbranch_vccnz L_poll_9s
L_poll_9e:
    v_lshlrev_b32 v40, 16, v8
    v_and_b32 v41, 0xffff0000, v8
    v_lshlrev_b32 v42, 16, v9
    v_and_b32 v43, 0xffff0000, v9
    v_lshlrev_b32 v44, 16, v10
    v_and_b32 v45, 0xffff0000, v10
    v_lshlrev_b32 v46, 16, v11
    v_and_b32 v47, 0xffff0000, v11
    v_lshlrev_b32 v48, 16, v12
    v_and_b32 v49, 0xffff0000, v12
    v_lshlrev_b32 v50, 16, v13
    v_and_b32 v51, 0xffff0000, v13
    v_lshlrev_b32 v52, 16, v14
    v_and_b32 v53, 0xffff0000, v14
    v_lshlrev_b32 v54, 16, v15
    v_and_b32 v55, 0xffff0000, v15
    v_lshlrev_b32 v56, 16, v16
    v_and_b32 v57, 0xffff0000, v16
    v_lshlrev_b32 v58, 16, v17
    v_and_b32 v59, 0xffff0000, v17
    v_lshlrev_b32 v60, 16, v18
    v_and_b32 v61, 0xffff0000, v18
    v_lshlrev_b32 v62, 16, v19
    v_and_b32 v63, 0xffff0000, v19
    v_mov_b32 v64, 0
    v_mov_b32 v65, 0
    v_mov_b32 v66, 0
    v_mov_b32 v67, 0
    v_mov_b32 v68, 0
    v_mov_b32 v69, 0
    v_mov_b32 v70, 0
    v_mov_b32 v71, 0
    v_bfe_u32 v5, v0, 2, 2
    v_lshlrev_b32 v5, 8, v5
    v_lshrrev_b32 v8, 4, v0
    v_lshl_add_u32 v5, v8, 6, v5
    v_and_b32 v8, 3, v0
    v_lshl_add_u32 v5, v8, 4, v5
    s_lshl_b32 s63, s100, 10
    v_add_u32 v5, s63, v5
    s_waitcnt vmcnt(0) lgkmcnt(0)
    v_mov_b32 v8, 162064
    v_mov_b32 v9, 1
    s_mov_b64 exec, 1
    ds_add_u32 v8, v9
    s_mov_b64 exec, -1
    s_branch L_t2gate
L_ffn2:
    s_barrier
    ds_read_b128 v[8:11], v161
    ds_read_b128 v[12:15], v161 offset:64
    s_cmp_eq_u32 s61, 1
    s_cbranch_scc0 L_f2slow
    s_waitcnt lgkmcnt(1)
    v_mfma_f32_16x16x32_bf16 v[16:19], v[80:83], v[8:11], 0
    v_mfma_f32_16x16x32_bf16 v[20:23], v[88:91], v[8:11], 0
    v_mfma_f32_16x16x32_bf16 v[24:27], v[96:99], v[8:11], 0
    v_mfma_f32_16x16x32_bf16 v[28:31], v[104:107], v[8:11], 0
    s_waitcnt lgkmcnt(0)
    v_mfma_f32_16x16x32_bf16 v[16:19], v[84:87], v[12:15], v[16:19]
    v_mfma_f32_16x16x32_bf16 v[20:23], v[92:95], v[12:15], v[20:23]
    v_mfma_f32_16x16x32_bf16 v[24:27], v[100:103], v[12:15], v[24:27]
    v_mfma_f32_16x16x32_bf16 v[28:31], v[108:111], v[12:15], v[28:31]
    v_mfma_f32_16x16x32_bf16 v[32:35], v[112:115], v[8:11], 0
    v_mfma_f32_16x16x32_bf16 v[36:39], v[120:123], v[8:11], 0
    v_mfma_f32_16x16x32_bf16 v[40:43], v[128:131], v[8:11], 0
    v_mfma_f32_16x16x32_bf16 v[44:47], v[136:139], v[8:11], 0
    v_mfma_f32_16x16x32_bf16 v[32:35], v[116:119], v[12:15], v[32:35]
    v_mfma_f32_16x16x32_bf16 v[36:39], v[124:127], v[12:15], v[36:39]
    v_mfma_f32_16x16x32_bf16 v[40:43], v[132:135], v[12:15], v[40:43]
    v_mfma_f32_16x16x32_bf16 v[44:47], v[140:143], v[12:15], v[44:47]
    v_mfma_f32_16x16x32_bf16 v[48:51], v[144:147], v[8:11], 0
    v_mov_b32_dpp v16, v20 quad_perm:[0,1,2,3] row_mask:0xf bank_mask:0x2
    v_mov_b32_dpp v17, v21 quad_perm:[0,1,2,3] row_mask:0xf bank_mask:0x2
    v_mov_b32_dpp v18, v22 quad_perm:[0,1,2,3] row_mask:0xf bank_mask:0x2
    v_mfma_f32_16x16x32_bf16 v[52:55], v[152:155], v[8:11], 0
    v_mov_b32_dpp v19, v23 quad_perm:[0,1,2,3] row_mask:0xf bank_mask:0x2
    v_mov_b32_dpp v16, v24 quad_perm:[0,1,2,3] row_mask:0xf bank_mask:0x4
    v_mov_b32_dpp v17, v25 quad_perm:[0,1,2,3] row_mask:0xf bank_mask:0x4
    v_mfma_f32_16x16x32_bf16 v[48:51], v[148:151], v[12:15], v[48:51]
    v_mov_b32_dpp v18, v26 quad_perm:[0,1,2,3] row_mask:0xf bank_mask:0x4
    v_mov_b32_dpp v19, v27 quad_perm:[0,1,2,3] row_mask:0xf bank_mask:0x4
    v_mov_b32_dpp v16, v28 quad_perm:[0,1,2,3] row_mask:0xf bank_mask:0x8
    v_mfma_f32_16x16x32_bf16 v[52:55], v[156:159], v[12:15], v[52:55]
    v_mov_b32_dpp v17, v29 quad_perm:[0,1,2,3] row_mask:0xf bank_mask:0x8
    v_mov_b32_dpp v18, v30 quad_perm:[0,1,2,3] row_mask:0xf bank_mask:0x8
    v_mov_b32_dpp v19, v31 quad_perm:[0,1,2,3] row_mask:0xf bank_mask:0x8
    v_cvt_pk_bf16_f32 v16, v16, v17
    v_cvt_pk_bf16_f32 v17, v18, v19
    buffer_store_dwordx2 v[16:17], v160, s[40:43], s57 offen
    v_mov_b32_dpp v32, v36 quad_perm:[0,1,2,3] row_mask:0xf bank_mask:0x2
    v_mov_b32_dpp v33, v37 quad_perm:[0,1,2,3] row_mask:0xf bank_mask:0x2
    v_mov_b32_dpp v34, v38 quad_perm:[0,1,2,3] row_mask:0xf bank_mask:0x2
    v_mov_b32_dpp v35, v39 quad_perm:[0,1,2,3] row_mask:0xf bank_mask:0x2
    v_mov_b32_dpp v32, v40 quad_perm:[0,1,2,3] row_mask:0xf bank_mask:0x4
    v_mov_b32_dpp v33, v41 quad_perm:[0,1,2,3] row_mask:0xf bank_mask:0x4
    v_mov_b32_dpp v34, v42 quad_perm:[0,1,2,3] row_mask:0xf bank_mask:0x4
    v_mov_b32_dpp v35, v43 quad_perm:[0,1,2,3] row_mask:0xf bank_mask:0x4
    v_mov_b32_dpp v32, v44 quad_perm:[0,1,2,3] row_mask:0xf bank_mask:0x8
    v_mov_b32_dpp v33, v45 quad_perm:[0,1,2,3] row_mask:0xf bank_mask:0x8
    v_mov_b32_dpp v34, v46 quad_perm:[0,1,2,3] row_mask:0xf bank_mask:0x8
    v_mov_b32_dpp v35, v47 quad_perm:[0,1,2,3] row_mask:0xf bank_mask:0x8
    v_cvt_pk_bf16_f32 v32, v32, v33
    v_cvt_pk_bf16_f32 v33, v34, v35
    buffer_store_dwordx2 v[32:33], v160, s[40:43], s57 offen offset:128
    v_mov_b32_dpp v48, v52 quad_perm:[0,1,2,3] row_mask:0xf bank_mask:0x2
    v_mov_b32_dpp v49, v53 quad_perm:[0,1,2,3] row_mask:0xf bank_mask:0x2
    v_mov_b32_dpp v50, v54 quad_perm:[0,1,2,3] row_mask:0xf bank_mask:0x2
    v_mov_b32_dpp v51, v55 quad_perm:[0,1,2,3] row_mask:0xf bank_mask:0x2
    v_cvt_pk_bf16_f32 v48, v48, v49
    v_cvt_pk_bf16_f32 v49, v50, v51
    s_mov_b32 exec_lo, 0x00ff00ff
    s_mov_b32 exec_hi, 0x00ff00ff
    buffer_store_dwordx2 v[48:49], v160, s[40:43], s57 offen offset:256
L_f2done:
    s_barrier
    s_endpgm
L_f2slow:
    s_waitcnt lgkmcnt(1)
    v_mfma_f32_16x16x32_bf16 v[16:19], v[80:83], v[8:11], 0
    v_mfma_f32_16x16x32_bf16 v[20:23], v[88:91], v[8:11], 0
    v_mfma_f32_16x16x32_bf16 v[24:27], v[96:99], v[8:11], 0
    v_mfma_f32_16x16x32_bf16 v[28:31], v[104:107], v[8:11], 0
    s_waitcnt lgkmcnt(0)
    v_mfma_f32_16x16x32_bf16 v[16:19], v[84:87], v[12:15], v[16:19]
    v_mfma_f32_16x16x32_bf16 v[20:23], v[92:95], v[12:15], v[20:23]
    v_mfma_f32_16x16x32_bf16 v[24:27], v[100:103], v[12:15], v[24:27]
    v_mfma_f32_16x16x32_bf16 v[28:31], v[108:111], v[12:15], v[28:31]
    v_mfma_f32_16x16x32_bf16 v[32:35], v[112:115], v[8:11], 0
    v_mfma_f32_16x16x32_bf16 v[36:39], v[120:123], v[8:11], 0
    v_mfma_f32_16x16x32_bf16 v[40:43], v[128:131], v[8:11], 0
    v_mfma_f32_16x16x32_bf16 v[44:47], v[136:139], v[8:11], 0
    v_mfma_f32_16x16x32_bf16 v[32:35], v[116:119], v[12:15], v[32:35]
    v_mfma_f32_16x16x32_bf16 v[36:39], v[124:127], v[12:15], v[36:39]
    v_mfma_f32_16x16x32_bf16 v[40:43], v[132:135], v[12:15], v[40:43]
    v_mfma_f32_16x16x32_bf16 v[44:47], v[140:143], v[12:15], v[44:47]
    v_mfma_f32_16x16x32_bf16 v[48:51], v[144:147], v[8:11], 0
    v_mov_b32_dpp v16, v20 quad_perm:[0,1,2,3] row_mask:0xf bank_mask:0x2
    v_mov_b32_dpp v17, v21 quad_perm:[0,1,2,3] row_mask:0xf bank_mask:0x2
    v_mov_b32_dpp v18, v22 quad_perm:[0,1,2,3] row_mask:0xf bank_mask:0x2
    v_mfma_f32_16x16x32_bf16 v[52:55], v[152:155], v[8:11], 0
    v_mov_b32_dpp v19, v23 quad_perm:[0,1,2,3] row_mask:0xf bank_mask:0x2
    v_mov_b32_dpp v16, v24 quad_perm:[0,1,2,3] row_mask:0xf bank_mask:0x4
    v_mov_b32_dpp v17, v25 quad_perm:[0,1,2,3] row_mask:0xf bank_mask:0x4
    v_mfma_f32_16x16x32_bf16 v[48:51], v[148:151], v[12:15], v[48:51]
    v_mov_b32_dpp v18, v26 quad_perm:[0,1,2,3] row_mask:0xf bank_mask:0x4
    v_mov_b32_dpp v19, v27 quad_perm:[0,1,2,3] row_mask:0xf bank_mask:0x4
    v_mov_b32_dpp v16, v28 quad_perm:[0,1,2,3] row_mask:0xf bank_mask:0x8
    v_mfma_f32_16x16x32_bf16 v[52:55], v[156:159], v[12:15], v[52:55]
    v_mov_b32_dpp v17, v29 quad_perm:[0,1,2,3] row_mask:0xf bank_mask:0x8
    v_mov_b32_dpp v18, v30 quad_perm:[0,1,2,3] row_mask:0xf bank_mask:0x8
    v_mov_b32_dpp v19, v31 quad_perm:[0,1,2,3] row_mask:0xf bank_mask:0x8
    v_cvt_pk_bf16_f32 v16, v16, v17
    v_cvt_pk_bf16_f32 v17, v18, v19
    buffer_store_dwordx2 v[16:17], v160, s[40:43], s57 offen sc1
    v_mov_b32_dpp v32, v36 quad_perm:[0,1,2,3] row_mask:0xf bank_mask:0x2
    v_mov_b32_dpp v33, v37 quad_perm:[0,1,2,3] row_mask:0xf bank_mask:0x2
    v_mov_b32_dpp v34, v38 quad_perm:[0,1,2,3] row_mask:0xf bank_mask:0x2
    v_mov_b32_dpp v35, v39 quad_perm:[0,1,2,3] row_mask:0xf bank_mask:0x2
    v_mov_b32_dpp v32, v40 quad_perm:[0,1,2,3] row_mask:0xf bank_mask:0x4
    v_mov_b32_dpp v33, v41 quad_perm:[0,1,2,3] row_mask:0xf bank_mask:0x4
    v_mov_b32_dpp v34, v42 quad_perm:[0,1,2,3] row_mask:0xf bank_mask:0x4
    v_mov_b32_dpp v35, v43 quad_perm:[0,1,2,3] row_mask:0xf bank_mask:0x4
    v_mov_b32_dpp v32, v44 quad_perm:[0,1,2,3] row_mask:0xf bank_mask:0x8
    v_mov_b32_dpp v33, v45 quad_perm:[0,1,2,3] row_mask:0xf bank_mask:0x8
    v_mov_b32_dpp v34, v46 quad_perm:[0,1,2,3] row_mask:0xf bank_mask:0x8
    v_mov_b32_dpp v35, v47 quad_perm:[0,1,2,3] row_mask:0xf bank_mask:0x8
    v_cvt_pk_bf16_f32 v32, v32, v33
    v_cvt_pk_bf16_f32 v33, v34, v35
    buffer_store_dwordx2 v[32:33], v160, s[40:43], s57 offen offset:128 sc1
    v_mov_b32_dpp v48, v52 quad_perm:[0,1,2,3] row_mask:0xf bank_mask:0x2
    v_mov_b32_dpp v49, v53 quad_perm:[0,1,2,3] row_mask:0xf bank_mask:0x2
    v_mov_b32_dpp v50, v54 quad_perm:[0,1,2,3] row_mask:0xf bank_mask:0x2
    v_mov_b32_dpp v51, v55 quad_perm:[0,1,2,3] row_mask:0xf bank_mask:0x2
    v_cvt_pk_bf16_f32 v48, v48, v49
    v_cvt_pk_bf16_f32 v49, v50, v51
    s_mov_b32 exec_lo, 0x00ff00ff
    s_mov_b32 exec_hi, 0x00ff00ff
    buffer_store_dwordx2 v[48:49], v160, s[40:43], s57 offen offset:256 sc1
    s_branch L_f2done
L_poll_3t:
    s_mov_b32 s60, 0
    s_waitcnt vmcnt(0)
    s_branch L_poll_3e
L_poll_4t:
    s_mov_b32 s60, 0
    s_waitcnt vmcnt(0)
    s_branch L_poll_4e
L_poll_8t:
    s_mov_b32 s60, 0
    s_waitcnt vmcnt(0)
    s_branch L_poll_8e
L_poll_9t:
    s_mov_b32 s60, 0
    s_waitcnt vmcnt(0)
    s_branch L_poll_9e
L_poll_99t:
    s_mov_b32 s60, 0
    s_waitcnt vmcnt(0)
    s_branch L_poll_99e
L_poll_101t:
    s_mov_b32 s60, 0
    s_waitcnt vmcnt(0)
    s_branch L_poll_101e
L_poll_104t:
    s_mov_b32 s60, 0
    s_waitcnt vmcnt(0)
    s_branch L_poll_104e
L_poll_106t:
    s_mov_b32 s60, 0
    s_waitcnt vmcnt(0)
    s_branch L_poll_106e
L_poll_110t:
    s_mov_b32 s60, 0
    s_waitcnt vmcnt(0)
    s_branch L_poll_110e
L_poll_112t:
    s_mov_b32 s60, 0
    s_waitcnt vmcnt(0)
    s_branch L_poll_112e
L_poll_117t:
    s_mov_b32 s60, 0
    s_waitcnt vmcnt(0)
    s_branch L_poll_117e
L_poll_119t:
    s_mov_b32 s60, 0
    s_waitcnt vmcnt(0)
    s_branch L_poll_119e
L_ygt:
    s_waitcnt vmcnt(0)
    s_branch L_ygd
L_poll_124t:
    s_mov_b32 s60, 0
    s_waitcnt vmcnt(0)
    s_branch L_poll_124e
L_poll_125t:
    s_mov_b32 s60, 0
    s_waitcnt vmcnt(0)
    s_branch L_poll_125e
L_poll_126t:
    s_mov_b32 s60, 0
    s_waitcnt vmcnt(0)
    s_branch L_poll_126e
L_poll_127t:
    s_mov_b32 s60, 0
    s_waitcnt vmcnt(0)
    s_branch L_poll_127e
L_poll_128t:
    s_mov_b32 s60, 0
    s_waitcnt vmcnt(0)
    s_branch L_poll_128e
L_end:
    s_endpgm
L_codeend:
.section .rodata,"a"
.p2align 6
.amdhsa_kernel adaLN_cond__sliding_block_cached__dense_activation_gelu__decode_kernel
  .amdhsa_next_free_vgpr 168
  .amdhsa_next_free_sgpr 102
  .amdhsa_accum_offset 168
  .amdhsa_group_segment_fixed_size 0
  .amdhsa_kernarg_size 120
  .amdhsa_user_sgpr_count 2
  .amdhsa_user_sgpr_kernarg_segment_ptr 1
  .amdhsa_system_sgpr_workgroup_id_x 1
.end_amdhsa_kernel
```

```asm
; @launch grid=(256,1,1) block=(768,1,1) lds=162176
.amdgcn_target "amdgcn-amd-amdhsa--gfx950"
.text
.globl adaLN_cond__sliding_block_cached__dense_activation_gelu__decode_kernel
.p2align 8
.type adaLN_cond__sliding_block_cached__dense_activation_gelu__decode_kernel,@function
adaLN_cond__sliding_block_cached__dense_activation_gelu__decode_kernel:
    s_load_dwordx16 s[4:19], s[0:1], 0
    s_load_dwordx8 s[20:27], s[0:1], 64
    s_load_dwordx4 s[28:31], s[0:1], 96
    s_load_dwordx2 s[32:33], s[0:1], 112
    s_cmp_ge_u32 s2, 256
    s_cbranch_scc1 L_end
    v_lshrrev_b32 v1, 6, v0
    v_lshlrev_b32 v2, 4, v0
    v_readfirstlane_b32 s3, v1
    v_and_b32 v0, 63, v0
    s_and_b32 s34, s2, 7
    s_lshr_b32 s35, s2, 3
    s_cmp_lg_u32 s35, 21
    s_cbranch_scc1 L_nopf
    s_getpc_b64 s[48:49]
    s_and_b32 s48, s48, 0xffffff00
    s_mov_b32 s50, L_codeend-adaLN_cond__sliding_block_cached__dense_activation_gelu__decode_kernel
    s_mov_b32 s51, 0x20000
    s_mov_b32 s52, 12288
    buffer_load_dwordx4 v[152:155], v2, s[48:51], 0 offen
    buffer_load_dwordx4 v[156:159], v2, s[48:51], s52 offen
L_nopf:
    s_lshr_b32 s36, s35, 3
    s_lshl2_add_u32 s36, s34, s36
    s_bfe_u32 s37, s35, 0x20001
    s_and_b32 s38, s35, 1
    s_cmp_lt_u32 s35, 27
    s_cselect_b32 s39, 1, 0
    s_cmp_eq_u32 s34, 2
    s_cselect_b32 s39, s39, 0
    s_sub_u32 s62, s34, 3
    s_and_b32 s62, s62, 7
    s_mul_i32 s56, s35, 7
    s_add_u32 s56, s56, s62
    s_cmp_eq_u32 s62, 7
    s_cselect_b32 s56, 255, s56
    s_mov_b32 s60, 400000
    s_mov_b32 s61, 0
    v_mov_b32 v36, 0
    s_cmp_lt_u32 s3, 4
    s_cbranch_scc1 L_helpers
    s_sub_u32 s3, s3, 4
    s_cmp_ge_u32 s35, 22
    s_cselect_b32 s59, 1, 0
    s_add_u32 s62, s3, s59
    s_cmp_ge_u32 s62, 6
    s_cselect_b32 s62, s39, 0
    s_cmp_eq_u32 s62, 1
    s_cbranch_scc1 L_proxy
    s_cmp_eq_u32 s59, 1
    s_cselect_b32 s100, 0, 81920
    s_lshl_b32 s62, s3, 13
    s_add_u32 s100, s100, s62
    s_and_b32 s62, s39, s59
    s_cselect_b32 s100, -1, s100
    s_mov_b32 s101, 0
L_stream:
    s_lshl_b32 s62, s37, 5
    s_add_u32 s62, s62, s36
    s_lshl_b32 s63, s62, 21
    s_lshl_b32 s96, s38, 18
    s_add_u32 s63, s63, s96
    s_add_u32 s63, s63, 1572864
    v_lshlrev_b32 v1, 4, v0
    s_lshl_b32 s96, s3, 12
    v_add_u32 v1, s96, v1
    s_mov_b32 s97, 0
    s_mov_b32 s50, 262144
    s_mov_b32 s51, 0x20000
    s_waitcnt lgkmcnt(0)
    s_add_u32 s48, s6, s63
    s_addc_u32 s49, s7, 0
    s_cmp_lt_u32 s56, 40
    s_cbranch_scc0 L_nob0
    s_barrier
L_nob0:
    buffer_load_dwordx4 v[40:43], v1, s[48:51], s97 offen offset:0 nt
    buffer_load_dwordx4 v[44:47], v1, s[48:51], s97 offen offset:1024 nt
    s_cmp_lt_u32 s56, 40
    s_cbranch_scc1 L_stream2
    s_barrier
    s_branch L_stream2
L_helpers:
    s_cmp_lg_u32 s3, 0
    s_cbranch_scc1 L_noinit
    v_lshlrev_b32 v1, 2, v0
    v_add_u32 v1, 161920, v1
    ds_write_b32 v1, v36
L_noinit:
    s_waitcnt lgkmcnt(0)
    s_mov_b32 s40, s32
    s_mov_b32 s41, s33
    s_mov_b32 s42, 589824
    s_mov_b32 s43, 0x20000
    s_mov_b32 s44, s30
    s_mov_b32 s45, s31
    s_mov_b32 s46, 256
    s_mov_b32 s47, 0x20000
    s_lshl2_add_u32 s62, s35, s3
    s_cmp_eq_u32 s62, 87
    s_cbranch_scc1 L_touch
L_notp:
    s_mul_i32 s101, s3, 20480
    s_mov_b32 s96, s56
    s_cmp_lt_u32 s56, 40
    s_cbranch_scc0 L_nothalf
    s_cmp_lt_u32 s3, 2
    s_cbranch_scc1 L_unit
    s_add_u32 s62, s56, 20
    s_cmp_eq_u32 s3, 2
    s_cbranch_scc1 L_job
    s_lshr_b32 s62, s56, 1
    s_and_b32 s63, s56, 1
    s_mul_i32 s63, s63, 5120
    s_lshl_b32 s96, s62, 7
    s_add_u32 s63, s63, s96
    s_cmp_ge_u32 s62, 10
    s_cselect_b32 s62, 8960, 0
    s_add_u32 s63, s63, s62
    v_lshrrev_b32 v1, 4, v0
    v_mul_u32_u24 v1, 1280, v1
    v_and_b32 v2, 15, v0
    v_lshl_add_u32 v1, v2, 3, v1
    v_mov_b32 v4, -1
    v_mov_b32 v5, -1
    buffer_store_dwordx2 v[4:5], v1, s[40:43], s63 offen sc1
    s_lshl_b32 s62, s56, 1
    s_waitcnt vmcnt(0)
    s_mov_b64 exec, 1
    buffer_store_short v4, v36, s[44:47], s62 offen offset:128 sc1
    s_mov_b64 exec, -1
    s_barrier
    s_branch L_service
L_nothalf:
    s_cmp_lt_u32 s56, 104
    s_cbranch_scc1 L_unit
    s_sub_u32 s62, s56, 144
    s_cmp_lt_u32 s62, 10
    s_cbranch_scc0 L_nojob
    s_cmp_lt_u32 s3, 2
    s_cbranch_scc0 L_nojob
    s_mul_i32 s63, s3, 10
    s_add_u32 s62, s62, s63
L_job:
    s_cmp_lt_u32 s62, 59
    s_cbranch_scc0 L_end
    s_mov_b32 s100, s101
    s_lshl_b32 s101, s62, 9
    s_add_u32 s101, s101, 196608
    s_cmp_lt_u32 s62, 27
    s_cselect_b32 s63, 0, 27
    s_cselect_b32 s3, 7, 6
    s_cmp_lt_u32 s62, 54
    s_cselect_b32 s63, s63, 32
    s_cselect_b32 s3, s3, 5
    s_sub_u32 s35, s62, s63
    s_mov_b32 s34, 2
    s_lshr_b32 s36, s35, 3
    s_add_u32 s36, s36, 8
    s_bfe_u32 s37, s35, 0x20001
    s_and_b32 s38, s35, 1
    s_mov_b32 s59, 0
    s_branch L_stream
L_nojob:
    s_barrier
    s_cmp_ge_u32 s35, 22
    s_cbranch_scc1 L_h_t1
    s_cmp_eq_u32 s39, 1
    s_cbranch_scc1 L_h_role
    s_cmp_lt_u32 s96, 144
    s_cbranch_scc1 L_unit
    s_cmp_eq_u32 s3, 3
    s_cbranch_scc1 L_service
    s_endpgm
L_unit:
    v_lshrrev_b32 v3, 4, v0
    v_and_b32 v4, 3, v0
    v_bfe_u32 v7, v0, 2, 2
    v_lshlrev_b32 v64, 5, v7
    v_lshl_add_u32 v64, v3, 3, v64
    s_mov_b32 s14, s3
    s_mov_b32 s15, 3
    s_sub_u32 s62, s96, 40
    s_cmp_lt_u32 s62, 64
    s_cbranch_scc1 L_u_q
    s_mov_b32 s100, 1
    s_sub_u32 s96, s96, 84
    s_mov_b32 s12, 10240
    s_cmp_lt_u32 s56, 40
    s_cbranch_scc0 L_u_full
    s_mov_b32 s100, 0
    s_lshr_b32 s96, s56, 1
    s_and_b32 s62, s56, 1
    s_lshl1_add_u32 s14, s62, s14
    s_mov_b32 s15, 1
    s_cmp_ge_u32 s96, 10
    s_addc_u32 s62, s62, 0
    s_mul_i32 s12, s62, 5120
    s_add_u32 s12, s12, 0
L_u_full:
    s_mov_b32 s97, 0
    s_mov_b32 s99, 7680
    s_mov_b32 s48, s26
    s_mov_b32 s49, s27
    s_mov_b32 s50, 4915200
    s_mov_b32 s51, 0x20000
    s_mov_b32 s52, s24
    s_mov_b32 s53, s25
    s_mov_b32 s54, 5120
    s_mov_b32 s55, 0x20000
    v_and_b32 v6, 15, v0
    v_lshlrev_b32 v6, 4, v6
    v_mul_u32_u24 v5, 1280, v3
    v_add_u32 v5, v5, v6
    s_mul_i32 s62, s14, 320
    buffer_load_dwordx4 v[8:11], v5, s[52:55], s62 offen
    s_mov_b32 exec_lo, 0x000f000f
    s_mov_b32 exec_hi, 0x000f000f
    buffer_load_dwordx4 v[12:15], v5, s[52:55], s62 offen offset:256
    s_mov_b64 exec, -1
    s_lshl_b32 s98, s96, 7
    s_mul_i32 s13, s96, 0x199a
    s_lshr_b32 s13, s13, 16
    s_mul_i32 s63, s13, 3840
    s_add_u32 s57, s98, s63
    s_add_u32 s57, s57, s12
    v_mul_u32_u24 v5, 1280, v4
    v_add_u32 v64, v64, v5
    s_cmp_lg_u32 s13, 1
    s_cbranch_scc1 L_u_go
    s_mov_b32 s52, s4
    s_mov_b32 s53, s5
    s_mov_b32 s54, 5120
    s_mov_b32 s55, 0x20000
    v_lshrrev_b32 v6, 2, v0
    v_lshl_add_u32 v6, v6, 4, v5
    s_sub_u32 s62, s98, 1280
    buffer_load_dwordx4 v[16:19], v6, s[52:55], 0 offen offset:0
    buffer_load_dwordx4 v[20:23], v6, s[52:55], 0 offen offset:256
    buffer_load_dwordx4 v[24:27], v6, s[52:55], 0 offen offset:512
    buffer_load_dwordx4 v[28:31], v6, s[52:55], 0 offen offset:768
    buffer_load_dwordx4 v[32:35], v6, s[52:55], 0 offen offset:1024
    buffer_load_dwordx2 v[66:67], v64, s[52:55], s62 offen
    s_branch L_u_go
L_u_q:
    s_mov_b32 s97, 1
    s_mov_b32 s99, 8192
    s_mov_b32 s100, 0
    s_lshl_b32 s98, s62, 7
    s_add_u32 s57, s98, 40960
    v_lshl_add_u32 v64, v4, 13, v64
    s_mov_b32 s48, s10
    s_mov_b32 s49, s11
    s_mov_b32 s50, 5242880
    s_mov_b32 s51, 0x20000
L_u_go:
    v_lshrrev_b32 v6, 3, v0
    v_mul_lo_u32 v1, v6, s99
    v_and_b32 v6, 2, v6
    v_xor_b32 v6, v6, v0
    v_and_b32 v6, 7, v6
    v_lshl_add_u32 v1, v6, 4, v1
    v_add_u32 v1, s98, v1
    v_xor_b32 v2, 64, v1
    s_mul_i32 s63, s99, s14
    s_mul_i32 s63, s63, 160
    s_lshl_b32 s59, s99, 3
    s_mov_b32 m0, s101
    s_mov_b32 s62, 10
L_dma_1:
    buffer_load_dwordx4 v1, s[48:51], s63 offen nt lds
    s_add_u32 m0, m0, 1024
    s_add_u32 s63, s63, s59
    s_cmp_eq_u32 s100, 0
    s_cbranch_scc1 L_dma_1n0
    s_waitcnt vmcnt(3)
    s_cmp_eq_u32 s100, 2
    s_cbranch_scc1 L_dma_1n0
    s_waitcnt vmcnt(3)
L_dma_1n0:
    buffer_load_dwordx4 v2, s[48:51], s63 offen nt lds
    s_add_u32 m0, m0, 1024
    s_add_u32 s63, s63, s59
    s_cmp_eq_u32 s100, 0
    s_cbranch_scc1 L_dma_1n1
    s_waitcnt vmcnt(3)
    s_cmp_eq_u32 s100, 2
    s_cbranch_scc1 L_dma_1n1
    s_waitcnt vmcnt(3)
L_dma_1n1:
    s_sub_u32 s62, s62, 1
    s_cmp_lg_u32 s62, 0
    s_cbranch_scc1 L_dma_1
    v_min_u32 v65, 29, v0
    v_lshlrev_b32 v65, 2, v65
    s_cmp_lt_u32 s56, 104
    s_cselect_b32 s62, 32, 64
    v_min_u32 v6, 51, v0
    v_lshlrev_b32 v6, 2, v6
    v_cmp_le_u32 vcc, s62, v0
    s_nop 1
    v_cndmask_b32 v65, v65, v6, vcc
    v_mov_b32 v68, -1
    s_cmp_lt_u32 s56, 40
    s_cbranch_scc1 L_u_nofl
    buffer_load_dword v68, v65, s[44:47], 0 offen sc1
L_u_nofl:
    s_cmp_lt_u32 s56, 104
    s_cbranch_scc0 L_u_nob
    s_barrier
L_u_nob:
    v_lshrrev_b32 v60, 4, v0
    v_lshlrev_b32 v60, 10, v60
    v_bfe_u32 v6, v0, 2, 2
    v_lshl_add_u32 v60, v6, 7, v60
    v_and_b32 v6, 3, v0
    v_lshl_add_u32 v60, v6, 3, v60
    v_bfe_u32 v6, v0, 3, 2
    v_lshl_add_u32 v60, v6, 5, v60
    v_xor_b32 v61, 32, v60
    v_xor_b32 v62, 64, v60
    v_xor_b32 v63, 0x60, v60
    v_add_u32 v60, s101, v60
    v_add_u32 v61, s101, v61
    v_add_u32 v62, s101, v62
    v_add_u32 v63, s101, v63
    v_mov_b32 v56, 1.0
    v_mov_b32 v57, 1.0
    v_mov_b32 v58, 1.0
    v_mov_b32 v59, 1.0
    s_mov_b32 s58, 0
    s_cmp_eq_u32 s97, 1
    s_cbranch_scc1 L_u_q2
    s_cmp_eq_u32 s13, 4
    s_cselect_b32 s58, 1.0, 0
    s_cmp_lt_u32 s14, 2
    s_cselect_b32 s62, 1.0, 0
    s_cmp_eq_u32 s13, 1
    s_cselect_b32 s58, s62, s58
    s_cselect_b32 s56, 1, 0
    s_waitcnt vmcnt(20)
    s_mov_b32 s62, 0xbfb8aa3b
    v_lshlrev_b32 v40, 16, v8
    v_and_b32 v41, 0xffff0000, v8
    v_lshlrev_b32 v42, 16, v9
    v_and_b32 v43, 0xffff0000, v9
    v_lshlrev_b32 v44, 16, v10
    v_and_b32 v45, 0xffff0000, v10
    v_lshlrev_b32 v46, 16, v11
    v_and_b32 v47, 0xffff0000, v11
    v_mul_f32 v48, s62, v40
    v_mul_f32 v49, s62, v41
    v_mul_f32 v50, s62, v42
    v_mul_f32 v51, s62, v43
    v_mul_f32 v52, s62, v44
    v_mul_f32 v53, s62, v45
    v_mul_f32 v54, s62, v46
    v_mul_f32 v55, s62, v47
    v_exp_f32 v48, v48
    v_exp_f32 v49, v49
    v_exp_f32 v50, v50
    v_exp_f32 v51, v51
    v_exp_f32 v52, v52
    v_exp_f32 v53, v53
    v_exp_f32 v54, v54
    v_exp_f32 v55, v55
    v_add_f32 v48, 1.0, v48
    v_add_f32 v49, 1.0, v49
    v_add_f32 v50, 1.0, v50
    v_add_f32 v51, 1.0, v51
    v_add_f32 v52, 1.0, v52
    v_add_f32 v53, 1.0, v53
    v_add_f32 v54, 1.0, v54
    v_add_f32 v55, 1.0, v55
    v_rcp_f32 v48, v48
    v_rcp_f32 v49, v49
    v_rcp_f32 v50, v50
    v_rcp_f32 v51, v51
    v_rcp_f32 v52, v52
    v_rcp_f32 v53, v53
    v_rcp_f32 v54, v54
    v_rcp_f32 v55, v55
    v_mul_f32 v40, v40, v48
    v_mul_f32 v41, v41, v49
    v_mul_f32 v42, v42, v50
    v_mul_f32 v43, v43, v51
    v_mul_f32 v44, v44, v52
    v_mul_f32 v45, v45, v53
    v_mul_f32 v46, v46, v54
    v_mul_f32 v47, v47, v55
    v_cvt_pk_bf16_f32 v8, v40, v41
    v_cvt_pk_bf16_f32 v9, v42, v43
    v_cvt_pk_bf16_f32 v10, v44, v45
    v_cvt_pk_bf16_f32 v11, v46, v47
    v_lshlrev_b32 v40, 16, v12
    v_and_b32 v41, 0xffff0000, v12
    v_lshlrev_b32 v42, 16, v13
    v_and_b32 v43, 0xffff0000, v13
    v_lshlrev_b32 v44, 16, v14
    v_and_b32 v45, 0xffff0000, v14
    v_lshlrev_b32 v46, 16, v15
    v_and_b32 v47, 0xffff0000, v15
    v_mul_f32 v48, s62, v40
    v_mul_f32 v49, s62, v41
    v_mul_f32 v50, s62, v42
    v_mul_f32 v51, s62, v43
    v_mul_f32 v52, s62, v44
    v_mul_f32 v53, s62, v45
    v_mul_f32 v54, s62, v46
    v_mul_f32 v55, s62, v47
    v_exp_f32 v48, v48
    v_exp_f32 v49, v49
    v_exp_f32 v50, v50
    v_exp_f32 v51, v51
    v_exp_f32 v52, v52
    v_exp_f32 v53, v53
    v_exp_f32 v54, v54
    v_exp_f32 v55, v55
    v_add_f32 v48, 1.0, v48
    v_add_f32 v49, 1.0, v49
    v_add_f32 v50, 1.0, v50
    v_add_f32 v51, 1.0, v51
    v_add_f32 v52, 1.0, v52
    v_add_f32 v53, 1.0, v53
    v_add_f32 v54, 1.0, v54
    v_add_f32 v55, 1.0, v55
    v_rcp_f32 v48, v48
    v_rcp_f32 v49, v49
    v_rcp_f32 v50, v50
    v_rcp_f32 v51, v51
    v_rcp_f32 v52, v52
    v_rcp_f32 v53, v53
    v_rcp_f32 v54, v54
    v_rcp_f32 v55, v55
    v_mul_f32 v40, v40, v48
    v_mul_f32 v41, v41, v49
    v_mul_f32 v42, v42, v50
    v_mul_f32 v43, v43, v51
    v_mul_f32 v44, v44, v52
    v_mul_f32 v45, v45, v53
    v_mul_f32 v46, v46, v54
    v_mul_f32 v47, v47, v55
    v_cvt_pk_bf16_f32 v12, v40, v41
    v_cvt_pk_bf16_f32 v13, v42, v43
    v_cvt_pk_bf16_f32 v14, v44, v45
    v_cvt_pk_bf16_f32 v15, v46, v47
    s_mul_i32 s62, s3, 1344
    s_add_u32 s62, s62, 151552
    v_mul_u32_u24 v5, 336, v3
    v_and_b32 v6, 15, v0
    v_lshl_add_u32 v5, v6, 4, v5
    v_add_u32 v5, s62, v5
    ds_write_b128 v5, v[8:11]
    s_mov_b32 exec_lo, 0x000f000f
    s_mov_b32 exec_hi, 0x000f000f
    ds_write_b128 v5, v[12:15] offset:256
    s_mov_b64 exec, -1
    v_mul_u32_u24 v5, 336, v4
    v_lshl_add_u32 v5, v3, 4, v5
    v_add_u32 v5, s62, v5
    s_mov_b32 s59, 0x3e800000
    s_cmp_eq_u32 s56, 0
    s_cbranch_scc1 L_u_nost
    v_mov_b32 v40, 0
    v_mov_b32 v41, 0
    s_mov_b32 s62, 0x3f803f80
    v_dot2c_f32_bf16 v40, s62, v16
    v_dot2c_f32_bf16 v41, v16, v16
    v_dot2c_f32_bf16 v40, s62, v17
    v_dot2c_f32_bf16 v41, v17, v17
    v_dot2c_f32_bf16 v40, s62, v18
    v_dot2c_f32_bf16 v41, v18, v18
    v_dot2c_f32_bf16 v40, s62, v19
    v_dot2c_f32_bf16 v41, v19, v19
    v_dot2c_f32_bf16 v40, s62, v20
    v_dot2c_f32_bf16 v41, v20, v20
    v_dot2c_f32_bf16 v40, s62, v21
    v_dot2c_f32_bf16 v41, v21, v21
    v_dot2c_f32_bf16 v40, s62, v22
    v_dot2c_f32_bf16 v41, v22, v22
    v_dot2c_f32_bf16 v40, s62, v23
    v_dot2c_f32_bf16 v41, v23, v23
    v_dot2c_f32_bf16 v40, s62, v24
    v_dot2c_f32_bf16 v41, v24, v24
    v_dot2c_f32_bf16 v40, s62, v25
    v_dot2c_f32_bf16 v41, v25, v25
    v_dot2c_f32_bf16 v40, s62, v26
    v_dot2c_f32_bf16 v41, v26, v26
    v_dot2c_f32_bf16 v40, s62, v27
    v_dot2c_f32_bf16 v41, v27, v27
    v_dot2c_f32_bf16 v40, s62, v28
    v_dot2c_f32_bf16 v41, v28, v28
    v_dot2c_f32_bf16 v40, s62, v29
    v_dot2c_f32_bf16 v41, v29, v29
    v_dot2c_f32_bf16 v40, s62, v30
    v_dot2c_f32_bf16 v41, v30, v30
    v_dot2c_f32_bf16 v40, s62, v31
    v_dot2c_f32_bf16 v41, v31, v31
    v_dot2c_f32_bf16 v40, s62, v32
    v_dot2c_f32_bf16 v41, v32, v32
    v_dot2c_f32_bf16 v40, s62, v33
    v_dot2c_f32_bf16 v41, v33, v33
    v_dot2c_f32_bf16 v40, s62, v34
    v_dot2c_f32_bf16 v41, v34, v34
    v_dot2c_f32_bf16 v40, s62, v35
    v_dot2c_f32_bf16 v41, v35, v35
    s_nop 1
    v_add_f32_dpp v40, v40, v40 row_ror:4 row_mask:0xf bank_mask:0xf
    v_add_f32_dpp v41, v41, v41 row_ror:4 row_mask:0xf bank_mask:0xf
    s_nop 0
    v_add_f32_dpp v40, v40, v40 row_ror:8 row_mask:0xf bank_mask:0xf
    v_add_f32_dpp v41, v41, v41 row_ror:8 row_mask:0xf bank_mask:0xf
    v_mov_b32 v42, v40
    v_mov_b32 v43, v41
    s_nop 0
    v_permlane16_swap_b32 v40, v42
    v_permlane16_swap_b32 v41, v43
    v_add_f32 v40, v40, v42
    v_add_f32 v41, v41, v43
    v_mov_b32 v42, v40
    v_mov_b32 v43, v41
    s_nop 0
    v_permlane32_swap_b32 v40, v42
    v_permlane32_swap_b32 v41, v43
    v_add_f32 v40, v40, v42
    v_add_f32 v41, v41, v43
    s_mov_b32 s62, 0x3acccccd
    v_mul_f32 v40, s62, v40
    v_mul_f32 v41, s62, v41
    v_fma_f32 v41, -v40, v40, v41
    v_max_f32 v41, 0, v41
    v_add_f32 v41, 0x3727c5ac, v41
    v_rsq_f32 v41, v41
    v_lshlrev_b32 v56, 16, v66
    v_and_b32 v57, 0xffff0000, v66
    v_lshlrev_b32 v58, 16, v67
    v_and_b32 v59, 0xffff0000, v67
    v_sub_f32 v56, v56, v40
    v_sub_f32 v57, v57, v40
    v_sub_f32 v58, v58, v40
    v_sub_f32 v59, v59, v40
    v_mul_f32 v56, v56, v41
    v_mul_f32 v57, v57, v41
    v_mul_f32 v58, v58, v41
    v_mul_f32 v59, v59, v41
L_u_nost:
    ds_read_b128 v[8:11], v5 offset:0
    ds_read_b128 v[12:15], v5 offset:64
    ds_read_b128 v[16:19], v5 offset:128
    ds_read_b128 v[20:23], v5 offset:192
    ds_read_b128 v[24:27], v5 offset:256
    s_branch L_u_frag
L_u_q2:
    v_and_b32 v5, 15, v0
    v_mul_u32_u24 v5, 1280, v5
    v_lshl_add_u32 v5, v3, 4, v5
    s_mul_i32 s63, s3, 320
    s_add_u32 s63, s63, 0
    s_mov_b32 s59, 1.0
L_u_frag:
    s_waitcnt vmcnt(0)
    v_cmp_ne_u32 vcc, -1, v68
    s_cbranch_vccz L_u_yok
L_wy_2:
    buffer_load_dword v37, v65, s[44:47], 0 offen sc1
    s_waitcnt vmcnt(0)
    v_cmp_ne_u32 vcc, -1, v37
    s_cbranch_vccz L_wy_2e
    s_sleep 4
    s_sub_u32 s60, s60, 1
    s_cbranch_scc0 L_wy_2
    s_mov_b32 s60, 0
L_wy_2e:
L_u_yok:
    ds_read_b64_tr_b16 v[80:81], v60 offset:0
    ds_read_b64_tr_b16 v[82:83], v60 offset:512
    ds_read_b64_tr_b16 v[84:85], v61 offset:0
    ds_read_b64_tr_b16 v[86:87], v61 offset:512
    ds_read_b64_tr_b16 v[88:89], v62 offset:0
    ds_read_b64_tr_b16 v[90:91], v62 offset:512
    ds_read_b64_tr_b16 v[92:93], v63 offset:0
    ds_read_b64_tr_b16 v[94:95], v63 offset:512
    ds_read_b64_tr_b16 v[96:97], v60 offset:4096
    ds_read_b64_tr_b16 v[98:99], v60 offset:4608
    ds_read_b64_tr_b16 v[100:101], v61 offset:4096
    ds_read_b64_tr_b16 v[102:103], v61 offset:4608
    ds_read_b64_tr_b16 v[104:105], v62 offset:4096
    ds_read_b64_tr_b16 v[106:107], v62 offset:4608
    ds_read_b64_tr_b16 v[108:109], v63 offset:4096
    ds_read_b64_tr_b16 v[110:111], v63 offset:4608
    ds_read_b64_tr_b16 v[112:113], v60 offset:8192
    ds_read_b64_tr_b16 v[114:115], v60 offset:8704
    ds_read_b64_tr_b16 v[116:117], v61 offset:8192
    ds_read_b64_tr_b16 v[118:119], v61 offset:8704
    ds_read_b64_tr_b16 v[120:121], v62 offset:8192
    ds_read_b64_tr_b16 v[122:123], v62 offset:8704
    ds_read_b64_tr_b16 v[124:125], v63 offset:8192
    ds_read_b64_tr_b16 v[126:127], v63 offset:8704
    ds_read_b64_tr_b16 v[128:129], v60 offset:12288
    ds_read_b64_tr_b16 v[130:131], v60 offset:12800
    ds_read_b64_tr_b16 v[132:133], v61 offset:12288
    ds_read_b64_tr_b16 v[134:135], v61 offset:12800
    ds_read_b64_tr_b16 v[136:137], v62 offset:12288
    ds_read_b64_tr_b16 v[138:139], v62 offset:12800
    ds_read_b64_tr_b16 v[140:141], v63 offset:12288
    ds_read_b64_tr_b16 v[142:143], v63 offset:12800
    ds_read_b64_tr_b16 v[144:145], v60 offset:16384
    ds_read_b64_tr_b16 v[146:147], v60 offset:16896
    ds_read_b64_tr_b16 v[148:149], v61 offset:16384
    ds_read_b64_tr_b16 v[150:151], v61 offset:16896
    ds_read_b64_tr_b16 v[152:153], v62 offset:16384
    ds_read_b64_tr_b16 v[154:155], v62 offset:16896
    ds_read_b64_tr_b16 v[156:157], v63 offset:16384
    ds_read_b64_tr_b16 v[158:159], v63 offset:16896
    s_cmp_eq_u32 s97, 0
    s_cbranch_scc1 L_u_mm
    v_lshrrev_b32 v6, 2, v0
    v_mul_u32_u24 v6, 158, v6
    v_and_b32 v6, 0xfffc, v6
    v_and_b32 v7, 3, v0
    v_mul_u32_u24 v7, 5120, v7
    v_add_u32 v6, v6, v7
    s_mov_b64 exec, 0xfff
    s_branch L_poll_3
L_poll_3s:
    s_sleep 4
L_poll_3:
    buffer_load_dword v8, v6, s[40:43], s63 offen offset:3840 sc1
    s_sub_u32 s60, s60, 1
    s_cbranch_scc1 L_poll_3t
    s_waitcnt vmcnt(0)
    v_cmp_eq_u32 vcc, -1, v8
    s_cbranch_vccnz L_poll_3s
L_poll_3e:
    s_mov_b64 exec, -1
    s_branch L_poll_4
L_poll_4s:
    s_sleep 1
L_poll_4:
    buffer_load_dwordx4 v[8:11], v5, s[40:43], s63 offen offset:0 sc1
    buffer_load_dwordx4 v[12:15], v5, s[40:43], s63 offen offset:64 sc1
    buffer_load_dwordx4 v[16:19], v5, s[40:43], s63 offen offset:128 sc1
    buffer_load_dwordx4 v[20:23], v5, s[40:43], s63 offen offset:192 sc1
    buffer_load_dwordx4 v[24:27], v5, s[40:43], s63 offen offset:256 sc1
    s_sub_u32 s60, s60, 1
    s_cbranch_scc1 L_poll_4t
    s_waitcnt vmcnt(0)
    v_max3_u32 v37, v8, v9, v10
    v_max3_u32 v37, v37, v11, v12
    v_max3_u32 v37, v37, v13, v14
    v_max3_u32 v37, v37, v15, v16
    v_max3_u32 v37, v37, v17, v18
    v_max3_u32 v37, v37, v19, v20
    v_max3_u32 v37, v37, v21, v22
    v_max3_u32 v37, v37, v23, v24
    v_max3_u32 v37, v37, v25, v26
    v_max_u32 v37, v37, v27
    v_cmp_eq_u32 vcc, -1, v37
    s_cbranch_vccnz L_poll_4s
L_poll_4e:
L_u_got:
L_u_mm:
    s_waitcnt lgkmcnt(0)
    v_mfma_f32_16x16x32_bf16 v[40:43], v[80:83], v[8:11], 0
    v_mfma_f32_16x16x32_bf16 v[44:47], v[84:87], v[8:11], 0
    v_mfma_f32_16x16x32_bf16 v[48:51], v[88:91], v[8:11], 0
    v_mfma_f32_16x16x32_bf16 v[52:55], v[92:95], v[8:11], 0
    v_mfma_f32_16x16x32_bf16 v[40:43], v[96:99], v[12:15], v[40:43]
    v_mfma_f32_16x16x32_bf16 v[44:47], v[100:103], v[12:15], v[44:47]
    v_mfma_f32_16x16x32_bf16 v[48:51], v[104:107], v[12:15], v[48:51]
    v_mfma_f32_16x16x32_bf16 v[52:55], v[108:111], v[12:15], v[52:55]
    v_mfma_f32_16x16x32_bf16 v[40:43], v[112:115], v[16:19], v[40:43]
    v_mfma_f32_16x16x32_bf16 v[44:47], v[116:119], v[16:19], v[44:47]
    v_mfma_f32_16x16x32_bf16 v[48:51], v[120:123], v[16:19], v[48:51]
    v_mfma_f32_16x16x32_bf16 v[52:55], v[124:127], v[16:19], v[52:55]
    v_mfma_f32_16x16x32_bf16 v[40:43], v[128:131], v[20:23], v[40:43]
    v_mfma_f32_16x16x32_bf16 v[44:47], v[132:135], v[20:23], v[44:47]
    v_mfma_f32_16x16x32_bf16 v[48:51], v[136:139], v[20:23], v[48:51]
    v_mfma_f32_16x16x32_bf16 v[52:55], v[140:143], v[20:23], v[52:55]
    v_mfma_f32_16x16x32_bf16 v[40:43], v[144:147], v[24:27], v[40:43]
    v_mfma_f32_16x16x32_bf16 v[44:47], v[148:151], v[24:27], v[44:47]
    v_mfma_f32_16x16x32_bf16 v[48:51], v[152:155], v[24:27], v[48:51]
    v_mfma_f32_16x16x32_bf16 v[52:55], v[156:159], v[24:27], v[52:55]
    v_lshlrev_b32 v5, 4, v0
    v_add_u32 v5, 147456, v5
    s_lshl_b32 s62, s3, 10
    v_add_u32 v6, s62, v5
    v_mov_b32 v32, 162056
    v_mov_b32 v33, 1
    v_add_f32_dpp v40, v40, v40 row_ror:8 row_mask:0xf bank_mask:0xf
    v_add_f32_dpp v41, v41, v41 row_ror:8 row_mask:0xf bank_mask:0xf
    v_add_f32_dpp v42, v42, v42 row_ror:8 row_mask:0xf bank_mask:0xf
    v_add_f32_dpp v43, v43, v43 row_ror:8 row_mask:0xf bank_mask:0xf
    v_add_f32_dpp v44, v44, v44 row_ror:8 row_mask:0xf bank_mask:0xf
    v_add_f32_dpp v45, v45, v45 row_ror:8 row_mask:0xf bank_mask:0xf
    v_add_f32_dpp v46, v46, v46 row_ror:8 row_mask:0xf bank_mask:0xf
    v_add_f32_dpp v47, v47, v47 row_ror:8 row_mask:0xf bank_mask:0xf
    v_add_f32_dpp v48, v48, v48 row_ror:8 row_mask:0xf bank_mask:0xf
    v_add_f32_dpp v49, v49, v49 row_ror:8 row_mask:0xf bank_mask:0xf
    v_add_f32_dpp v50, v50, v50 row_ror:8 row_mask:0xf bank_mask:0xf
    v_add_f32_dpp v51, v51, v51 row_ror:8 row_mask:0xf bank_mask:0xf
    v_add_f32_dpp v52, v52, v52 row_ror:8 row_mask:0xf bank_mask:0xf
    v_add_f32_dpp v53, v53, v53 row_ror:8 row_mask:0xf bank_mask:0xf
    v_add_f32_dpp v54, v54, v54 row_ror:8 row_mask:0xf bank_mask:0xf
    v_add_f32_dpp v55, v55, v55 row_ror:8 row_mask:0xf bank_mask:0xf
    v_add_f32_dpp v28, v40, v40 row_ror:4 row_mask:0xf bank_mask:0x1
    v_add_f32_dpp v29, v41, v41 row_ror:4 row_mask:0xf bank_mask:0x1
    v_add_f32_dpp v30, v42, v42 row_ror:4 row_mask:0xf bank_mask:0x1
    v_add_f32_dpp v31, v43, v43 row_ror:4 row_mask:0xf bank_mask:0x1
    v_add_f32_dpp v28, v44, v44 row_ror:4 row_mask:0xf bank_mask:0x2
    v_add_f32_dpp v29, v45, v45 row_ror:4 row_mask:0xf bank_mask:0x2
    v_add_f32_dpp v30, v46, v46 row_ror:4 row_mask:0xf bank_mask:0x2
    v_add_f32_dpp v31, v47, v47 row_ror:4 row_mask:0xf bank_mask:0x2
    v_add_f32_dpp v28, v48, v48 row_ror:4 row_mask:0xf bank_mask:0x4
    v_add_f32_dpp v29, v49, v49 row_ror:4 row_mask:0xf bank_mask:0x4
    v_add_f32_dpp v30, v50, v50 row_ror:4 row_mask:0xf bank_mask:0x4
    v_add_f32_dpp v31, v51, v51 row_ror:4 row_mask:0xf bank_mask:0x4
    v_add_f32_dpp v28, v52, v52 row_ror:4 row_mask:0xf bank_mask:0x8
    v_add_f32_dpp v29, v53, v53 row_ror:4 row_mask:0xf bank_mask:0x8
    v_add_f32_dpp v30, v54, v54 row_ror:4 row_mask:0xf bank_mask:0x8
    v_add_f32_dpp v31, v55, v55 row_ror:4 row_mask:0xf bank_mask:0x8
    ds_write_b128 v6, v[28:31]
    s_mov_b64 exec, 1
    ds_add_rtn_u32 v34, v32, v33
    s_mov_b64 exec, -1
    ds_read_b128 v[8:11], v5
    ds_read_b128 v[12:15], v5 offset:1024
    ds_read_b128 v[16:19], v5 offset:2048
    ds_read_b128 v[20:23], v5 offset:3072
    s_waitcnt lgkmcnt(0)
    v_readfirstlane_b32 s62, v34
    v_mov_b32 v24, s58
    s_cmp_eq_u32 s62, s15
    s_cbranch_scc1 L_u_last
    s_cmp_eq_u32 s62, 1
    s_cbranch_scc1 L_service
    s_endpgm
L_u_last:
    v_add_f32 v8, v8, v12
    v_add_f32 v9, v9, v13
    v_add_f32 v10, v10, v14
    v_add_f32 v11, v11, v15
    s_cmp_eq_u32 s15, 1
    s_cbranch_scc1 L_u_two
    v_add_f32 v16, v16, v20
    v_add_f32 v17, v17, v21
    v_add_f32 v18, v18, v22
    v_add_f32 v19, v19, v23
    v_add_f32 v8, v8, v16
    v_add_f32 v9, v9, v17
    v_add_f32 v10, v10, v18
    v_add_f32 v11, v11, v19
L_u_two:
    v_fma_f32 v8, v8, s59, v24
    v_fma_f32 v9, v9, s59, v24
    v_fma_f32 v10, v10, s59, v24
    v_fma_f32 v11, v11, s59, v24
    v_mul_f32 v8, v8, v56
    v_mul_f32 v9, v9, v57
    v_mul_f32 v10, v10, v58
    v_mul_f32 v11, v11, v59
    v_cvt_pk_bf16_f32 v8, v8, v9
    v_cvt_pk_bf16_f32 v9, v10, v11
    buffer_store_dwordx2 v[8:9], v64, s[40:43], s57 offen sc1
    s_endpgm
L_touch:
    s_load_dword s0, s[32:33], 0
    s_load_dword s0, s[30:31], 0
    s_cmp_eq_u32 s39, 1
    s_cbranch_scc1 L_tpr
    s_mov_b32 s62, 16777216
    s_load_dword s0, s[8:9], s62
    s_mov_b32 s62, 83886080
    s_load_dword s0, s[8:9], s62
    s_mov_b32 s62, 150994944
    s_load_dword s0, s[8:9], s62
    s_mov_b32 s62, 218103808
    s_load_dword s0, s[8:9], s62
    s_branch L_tpv
L_tpr:
    s_load_dword s0, s[20:21], 0
    s_mov_b32 s62, 2211836
    s_load_dword s0, s[20:21], s62
    s_load_dword s0, s[16:17], 0
    s_mov_b32 s62, 2211836
    s_load_dword s0, s[16:17], s62
    s_load_dword s0, s[18:19], 0
    s_load_dword s0, s[22:23], 0
    s_load_dword s0, s[28:29], 0
    s_load_dword s0, s[4:5], 0
L_tpv:
    s_lshl_b32 s62, s34, 23
    s_load_dword s0, s[8:9], s62
    s_add_u32 s62, s62, 67108864
    s_load_dword s0, s[8:9], s62
    s_add_u32 s62, s62, 67108864
    s_load_dword s0, s[8:9], s62
    s_add_u32 s62, s62, 67108864
    s_load_dword s0, s[8:9], s62
    s_add_u32 s62, s62, 67108864
    s_branch L_notp
L_stream2:
    s_mov_b32 s12, s100
    s_mov_b32 s13, s101
    s_mov_b32 s40, s32
    s_mov_b32 s41, s33
    s_mov_b32 s42, 589824
    s_mov_b32 s43, 0x20000
    s_mov_b32 s44, s30
    s_mov_b32 s45, s31
    s_mov_b32 s46, 256
    s_mov_b32 s47, 0x20000
    s_bitcmp1_b32 s3, 0
    s_mov_b32 s57, 0xffffffff
    s_mov_b32 s58, 0xffff
    s_mov_b32 s14, 0xffffffff
    s_mov_b32 s15, 0x0
L_pm_10:
    s_cmp_lt_u32 s56, 104
    s_cbranch_scc0 L_pm_11
    s_bitcmp1_b32 s3, 0
    s_mov_b32 s57, 0xffff
    s_mov_b32 s58, 0x0
    s_mov_b32 s14, 0xffffffff
    s_mov_b32 s15, 0x0
L_pm_11:
    s_sub_u32 s96, s56, 43
    s_and_b32 s96, s96, 0xffffffc7
    s_cmp_eq_u32 s96, 0
    s_cbranch_scc0 L_pm_12
    s_bitcmp1_b32 s3, 0
    s_mov_b32 s57, 0x0
    s_mov_b32 s58, 0x0
    s_mov_b32 s14, 0x0
    s_mov_b32 s15, 0x0
L_pm_12:
    s_cmp_lt_u32 s56, 40
    s_cbranch_scc0 L_pm_13
    s_bitcmp1_b32 s3, 0
    s_mov_b32 s57, 0xffffffff
    s_mov_b32 s58, 0xf
    s_mov_b32 s14, 0xffffffff
    s_mov_b32 s15, 0x0
L_pm_13:
    s_cmp_eq_u32 s39, 1
    s_cbranch_scc0 L_pm_14
    s_bitcmp1_b32 s3, 0
    s_mov_b32 s57, 0xff0fff
    s_cselect_b32 s57, 0xff00ffff, s57
    s_mov_b32 s58, 0xfff
    s_mov_b32 s14, 0xff00ff
    s_cselect_b32 s14, 0xff00ff00, s14
    s_mov_b32 s15, 0x0
L_pm_14:
    s_cmp_lg_u32 s13, 0
    s_cbranch_scc0 L_pm_15
    s_bitcmp1_b32 s3, 0
    s_mov_b32 s57, 0xff00ff
    s_cselect_b32 s57, 0xff00ff00, s57
    s_mov_b32 s58, 0x0
    s_mov_b32 s14, 0x0
    s_mov_b32 s15, 0x0
L_pm_15:
    s_and_b32 s96, s39, s59
    s_cbranch_scc0 L_pm_16
    s_bitcmp1_b32 s3, 0
    s_mov_b32 s57, 0xffff
    s_mov_b32 s58, 0xffff
    s_mov_b32 s14, 0x0
    s_mov_b32 s15, 0x0
L_pm_16:
    s_add_u32 s52, s8, s63
    s_addc_u32 s53, s9, 0
    s_mov_b32 s54, 262144
    s_mov_b32 s55, 0x20000
    v_and_b32 v2, 15, v0
    v_lshrrev_b32 v3, 1, v2
    v_and_b32 v37, 1, v2
    v_lshlrev_b32 v37, 4, v37
    v_mov_b32 v38, 0xffff
    v_lshlrev_b32 v37, v37, v38
    v_cmp_eq_u32 vcc, 0, v3
    v_mov_b32 v32, 0
    s_nop 0
    v_cndmask_b32 v20, 0, v37, vcc
    v_cmp_eq_u32 vcc, 1, v3
    v_mov_b32 v33, 0
    s_nop 0
    v_cndmask_b32 v21, 0, v37, vcc
    v_cmp_eq_u32 vcc, 2, v3
    v_mov_b32 v34, 0
    s_nop 0
    v_cndmask_b32 v22, 0, v37, vcc
    v_cmp_eq_u32 vcc, 3, v3
    v_mov_b32 v35, 0
    s_nop 0
    v_cndmask_b32 v23, 0, v37, vcc
    v_lshlrev_b32 v2, 4, v2
    s_lshl_b32 s98, s62, 8
    s_add_u32 s98, s98, 40960
    s_lshl_b32 s99, s62, 7
    s_add_u32 s99, s99, 73728
    s_bitcmp0_b32 s57, 2
    s_cbranch_scc1 L_sf_17
    s_bitcmp0_b32 s58, 2
    s_cbranch_scc1 L_sf_17
    s_waitcnt vmcnt(1)
L_sf_17:
    buffer_load_dwordx4 v[48:51], v1, s[48:51], s97 offen offset:2048 nt
    s_bitcmp0_b32 s57, 3
    s_cbranch_scc1 L_sf_18
    s_waitcnt vmcnt(2)
    s_bitcmp0_b32 s58, 3
    s_cbranch_scc1 L_sf_18
    s_waitcnt vmcnt(1)
L_sf_18:
    buffer_load_dwordx4 v[52:55], v1, s[48:51], s97 offen offset:3072 nt
    s_add_u32 s97, s97, 32768
    v_add_u32 v1, 4096, v1
    v_and_b32 v1, 0x7fff, v1
    s_waitcnt vmcnt(3)
    s_bitcmp0_b32 s57, 4
    s_cbranch_scc1 L_sf_19
    s_waitcnt vmcnt(2)
    s_bitcmp0_b32 s58, 4
    s_cbranch_scc1 L_sf_19
    s_waitcnt vmcnt(1)
L_sf_19:
    buffer_load_dwordx4 v[56:59], v1, s[48:51], s97 offen offset:0 nt
    s_waitcnt vmcnt(3)
    s_bitcmp0_b32 s57, 5
    s_cbranch_scc1 L_sf_20
    s_waitcnt vmcnt(2)
    s_bitcmp0_b32 s58, 5
    s_cbranch_scc1 L_sf_20
    s_waitcnt vmcnt(1)
L_sf_20:
    buffer_load_dwordx4 v[60:63], v1, s[48:51], s97 offen offset:1024 nt
    s_waitcnt vmcnt(3)
    s_bitcmp0_b32 s57, 6
    s_cbranch_scc1 L_sf_21
    s_waitcnt vmcnt(2)
    s_bitcmp0_b32 s58, 6
    s_cbranch_scc1 L_sf_21
    s_waitcnt vmcnt(1)
L_sf_21:
    buffer_load_dwordx4 v[64:67], v1, s[48:51], s97 offen offset:2048 nt
    s_waitcnt vmcnt(3)
    s_bitcmp0_b32 s57, 7
    s_cbranch_scc1 L_sf_22
    s_waitcnt vmcnt(2)
    s_bitcmp0_b32 s58, 7
    s_cbranch_scc1 L_sf_22
    s_waitcnt vmcnt(1)
L_sf_22:
    buffer_load_dwordx4 v[68:71], v1, s[48:51], s97 offen offset:3072 nt
    s_add_u32 s97, s97, 32768
    v_add_u32 v1, 4096, v1
    v_and_b32 v1, 0x7fff, v1
    s_waitcnt vmcnt(3)
    s_bitcmp0_b32 s57, 8
    s_cbranch_scc1 L_sf_23
    s_waitcnt vmcnt(2)
    s_bitcmp0_b32 s58, 8
    s_cbranch_scc1 L_sf_23
    s_waitcnt vmcnt(1)
L_sf_23:
    buffer_load_dwordx4 v[72:75], v1, s[48:51], s97 offen offset:0 nt
    s_waitcnt vmcnt(3)
    s_bitcmp0_b32 s57, 9
    s_cbranch_scc1 L_sf_24
    s_waitcnt vmcnt(2)
    s_bitcmp0_b32 s58, 9
    s_cbranch_scc1 L_sf_24
    s_waitcnt vmcnt(1)
L_sf_24:
    buffer_load_dwordx4 v[76:79], v1, s[48:51], s97 offen offset:1024 nt
    s_waitcnt vmcnt(3)
    s_bitcmp0_b32 s57, 10
    s_cbranch_scc1 L_sf_25
    s_waitcnt vmcnt(2)
    s_bitcmp0_b32 s58, 10
    s_cbranch_scc1 L_sf_25
    s_waitcnt vmcnt(1)
L_sf_25:
    buffer_load_dwordx4 v[80:83], v1, s[48:51], s97 offen offset:2048 nt
    s_waitcnt vmcnt(3)
    s_bitcmp0_b32 s57, 11
    s_cbranch_scc1 L_sf_26
    s_waitcnt vmcnt(2)
    s_bitcmp0_b32 s58, 11
    s_cbranch_scc1 L_sf_26
    s_waitcnt vmcnt(1)
L_sf_26:
    buffer_load_dwordx4 v[84:87], v1, s[48:51], s97 offen offset:3072 nt
    s_add_u32 s97, s97, 32768
    v_add_u32 v1, 4096, v1
    v_and_b32 v1, 0x7fff, v1
    s_waitcnt vmcnt(3)
    s_bitcmp0_b32 s57, 12
    s_cbranch_scc1 L_sf_27
    s_waitcnt vmcnt(2)
    s_bitcmp0_b32 s58, 12
    s_cbranch_scc1 L_sf_27
    s_waitcnt vmcnt(1)
L_sf_27:
    buffer_load_dwordx4 v[88:91], v1, s[48:51], s97 offen offset:0 nt
    s_waitcnt vmcnt(3)
    s_bitcmp0_b32 s57, 13
    s_cbranch_scc1 L_sf_28
    s_waitcnt vmcnt(2)
    s_bitcmp0_b32 s58, 13
    s_cbranch_scc1 L_sf_28
    s_waitcnt vmcnt(1)
L_sf_28:
    buffer_load_dwordx4 v[92:95], v1, s[48:51], s97 offen offset:1024 nt
    s_waitcnt vmcnt(3)
    s_bitcmp0_b32 s57, 14
    s_cbranch_scc1 L_sf_29
    s_waitcnt vmcnt(2)
    s_bitcmp0_b32 s58, 14
    s_cbranch_scc1 L_sf_29
    s_waitcnt vmcnt(1)
L_sf_29:
    buffer_load_dwordx4 v[96:99], v1, s[48:51], s97 offen offset:2048 nt
    s_waitcnt vmcnt(3)
    s_bitcmp0_b32 s57, 15
    s_cbranch_scc1 L_sf_30
    s_waitcnt vmcnt(2)
    s_bitcmp0_b32 s58, 15
    s_cbranch_scc1 L_sf_30
    s_waitcnt vmcnt(1)
L_sf_30:
    buffer_load_dwordx4 v[100:103], v1, s[48:51], s97 offen offset:3072 nt
    s_add_u32 s97, s97, 32768
    v_add_u32 v1, 4096, v1
    v_and_b32 v1, 0x7fff, v1
    s_waitcnt vmcnt(3)
    s_bitcmp0_b32 s57, 16
    s_cbranch_scc1 L_sf_31
    s_waitcnt vmcnt(2)
    s_bitcmp0_b32 s58, 16
    s_cbranch_scc1 L_sf_31
    s_waitcnt vmcnt(1)
L_sf_31:
    buffer_load_dwordx4 v[104:107], v1, s[48:51], s97 offen offset:0 nt
    s_waitcnt vmcnt(3)
    s_bitcmp0_b32 s57, 17
    s_cbranch_scc1 L_sf_32
    s_waitcnt vmcnt(2)
    s_bitcmp0_b32 s58, 17
    s_cbranch_scc1 L_sf_32
    s_waitcnt vmcnt(1)
L_sf_32:
    buffer_load_dwordx4 v[108:111], v1, s[48:51], s97 offen offset:1024 nt
    s_waitcnt vmcnt(3)
    s_bitcmp0_b32 s57, 18
    s_cbranch_scc1 L_sf_33
    s_waitcnt vmcnt(2)
    s_bitcmp0_b32 s58, 18
    s_cbranch_scc1 L_sf_33
    s_waitcnt vmcnt(1)
L_sf_33:
    buffer_load_dwordx4 v[112:115], v1, s[48:51], s97 offen offset:2048 nt
    s_waitcnt vmcnt(3)
    s_bitcmp0_b32 s57, 19
    s_cbranch_scc1 L_sf_34
    s_waitcnt vmcnt(2)
    s_bitcmp0_b32 s58, 19
    s_cbranch_scc1 L_sf_34
    s_waitcnt vmcnt(1)
L_sf_34:
    buffer_load_dwordx4 v[116:119], v1, s[48:51], s97 offen offset:3072 nt
    s_add_u32 s97, s97, 32768
    v_add_u32 v1, 4096, v1
    v_and_b32 v1, 0x7fff, v1
    s_waitcnt vmcnt(3)
    s_bitcmp0_b32 s57, 20
    s_cbranch_scc1 L_sf_35
    s_waitcnt vmcnt(2)
    s_bitcmp0_b32 s58, 20
    s_cbranch_scc1 L_sf_35
    s_waitcnt vmcnt(1)
L_sf_35:
    buffer_load_dwordx4 v[120:123], v1, s[48:51], s97 offen offset:0 nt
    s_waitcnt vmcnt(3)
    s_bitcmp0_b32 s57, 21
    s_cbranch_scc1 L_sf_36
    s_waitcnt vmcnt(2)
    s_bitcmp0_b32 s58, 21
    s_cbranch_scc1 L_sf_36
    s_waitcnt vmcnt(1)
L_sf_36:
    buffer_load_dwordx4 v[124:127], v1, s[48:51], s97 offen offset:1024 nt
    s_cmp_eq_u32 s12, -1
    s_cbranch_scc1 L_k_nopf
    s_waitcnt vmcnt(3)
    s_bitcmp0_b32 s57, 22
    s_cbranch_scc1 L_sf_37
    s_waitcnt vmcnt(2)
    s_bitcmp0_b32 s58, 22
    s_cbranch_scc1 L_sf_37
    s_waitcnt vmcnt(1)
L_sf_37:
    buffer_load_dwordx4 v[128:131], v1, s[48:51], s97 offen offset:2048 nt
    s_waitcnt vmcnt(3)
    s_bitcmp0_b32 s57, 23
    s_cbranch_scc1 L_sf_38
    s_waitcnt vmcnt(2)
    s_bitcmp0_b32 s58, 23
    s_cbranch_scc1 L_sf_38
    s_waitcnt vmcnt(1)
L_sf_38:
    buffer_load_dwordx4 v[132:135], v1, s[48:51], s97 offen offset:3072 nt
    s_add_u32 s97, s97, 32768
    v_add_u32 v1, 4096, v1
    v_and_b32 v1, 0x7fff, v1
    s_waitcnt vmcnt(3)
    s_bitcmp0_b32 s57, 24
    s_cbranch_scc1 L_sf_39
    s_waitcnt vmcnt(2)
    s_bitcmp0_b32 s58, 24
    s_cbranch_scc1 L_sf_39
    s_waitcnt vmcnt(1)
L_sf_39:
    buffer_load_dwordx4 v[136:139], v1, s[48:51], s97 offen offset:0 nt
    s_waitcnt vmcnt(3)
    s_bitcmp0_b32 s57, 25
    s_cbranch_scc1 L_sf_40
    s_waitcnt vmcnt(2)
    s_bitcmp0_b32 s58, 25
    s_cbranch_scc1 L_sf_40
    s_waitcnt vmcnt(1)
L_sf_40:
    buffer_load_dwordx4 v[140:143], v1, s[48:51], s97 offen offset:1024 nt
    s_waitcnt vmcnt(3)
    s_bitcmp0_b32 s57, 26
    s_cbranch_scc1 L_sf_41
    s_waitcnt vmcnt(2)
    s_bitcmp0_b32 s58, 26
    s_cbranch_scc1 L_sf_41
    s_waitcnt vmcnt(1)
L_sf_41:
    buffer_load_dwordx4 v[144:147], v1, s[48:51], s97 offen offset:2048 nt
    s_waitcnt vmcnt(3)
    s_bitcmp0_b32 s57, 27
    s_cbranch_scc1 L_sf_42
    s_waitcnt vmcnt(2)
    s_bitcmp0_b32 s58, 27
    s_cbranch_scc1 L_sf_42
    s_waitcnt vmcnt(1)
L_sf_42:
    buffer_load_dwordx4 v[148:151], v1, s[48:51], s97 offen offset:3072 nt
    s_add_u32 s97, s97, 32768
    v_add_u32 v1, 4096, v1
    v_and_b32 v1, 0x7fff, v1
    s_waitcnt vmcnt(3)
    s_bitcmp0_b32 s57, 28
    s_cbranch_scc1 L_sf_43
    s_waitcnt vmcnt(2)
    s_bitcmp0_b32 s58, 28
    s_cbranch_scc1 L_sf_43
    s_waitcnt vmcnt(1)
L_sf_43:
    buffer_load_dwordx4 v[152:155], v1, s[48:51], s97 offen offset:0 nt
    s_waitcnt vmcnt(3)
    s_bitcmp0_b32 s57, 29
    s_cbranch_scc1 L_sf_44
    s_waitcnt vmcnt(2)
    s_bitcmp0_b32 s58, 29
    s_cbranch_scc1 L_sf_44
    s_waitcnt vmcnt(1)
L_sf_44:
    buffer_load_dwordx4 v[156:159], v1, s[48:51], s97 offen offset:1024 nt
    s_waitcnt vmcnt(3)
    s_bitcmp0_b32 s57, 30
    s_cbranch_scc1 L_sf_45
    s_waitcnt vmcnt(2)
    s_bitcmp0_b32 s58, 30
    s_cbranch_scc1 L_sf_45
    s_waitcnt vmcnt(1)
L_sf_45:
    buffer_load_dwordx4 v[160:163], v1, s[48:51], s97 offen offset:2048 nt
    v_min_u32 v39, 29, v0
    v_lshlrev_b32 v39, 2, v39
    buffer_load_dword v37, v39, s[44:47], 0 offen sc1
    s_waitcnt vmcnt(4)
    s_bitcmp0_b32 s57, 31
    s_cbranch_scc1 L_sf_46
    s_waitcnt vmcnt(3)
    s_bitcmp0_b32 s58, 31
    s_cbranch_scc1 L_sf_46
    s_waitcnt vmcnt(2)
L_sf_46:
    buffer_load_dwordx4 v[164:167], v1, s[48:51], s97 offen offset:3072 nt
    s_mov_b32 s97, 0
    v_add_u32 v1, 4096, v1
    v_and_b32 v1, 0x7fff, v1
    s_waitcnt vmcnt(4)
    s_bitcmp0_b32 s14, 0
    s_cbranch_scc1 L_sf_47
    s_waitcnt vmcnt(3)
    s_bitcmp0_b32 s15, 0
    s_cbranch_scc1 L_sf_47
    s_waitcnt vmcnt(2)
L_sf_47:
    s_add_u32 m0, s12, 0
    s_nop 0
    buffer_load_dwordx4 v1, s[52:55], s97 offen offset:0 nt lds
    s_waitcnt vmcnt(4)
    s_bitcmp0_b32 s14, 1
    s_cbranch_scc1 L_sf_48
    s_waitcnt vmcnt(3)
    s_bitcmp0_b32 s15, 1
    s_cbranch_scc1 L_sf_48
    s_waitcnt vmcnt(1)
L_sf_48:
    buffer_load_dwordx4 v1, s[52:55], s97 offen offset:1024 nt lds
    s_waitcnt vmcnt(4)
    s_bitcmp0_b32 s14, 2
    s_cbranch_scc1 L_sf_49
    s_waitcnt vmcnt(2)
    s_bitcmp0_b32 s15, 2
    s_cbranch_scc1 L_sf_49
    s_waitcnt vmcnt(1)
L_sf_49:
    buffer_load_dwordx4 v1, s[52:55], s97 offen offset:2048 nt lds
    s_waitcnt vmcnt(3)
    s_bitcmp0_b32 s14, 3
    s_cbranch_scc1 L_sf_50
    s_waitcnt vmcnt(2)
    s_bitcmp0_b32 s15, 3
    s_cbranch_scc1 L_sf_50
    s_waitcnt vmcnt(1)
L_sf_50:
    buffer_load_dwordx4 v1, s[52:55], s97 offen offset:3072 nt lds
    s_add_u32 s97, s97, 32768
    v_add_u32 v1, 4096, v1
    v_and_b32 v1, 0x7fff, v1
    v_cmp_eq_u32 vcc, 0, v37
    s_nop 0
    s_or_b32 s96, vcc_lo, vcc_hi
    buffer_load_dwordx4 v[4:7], v2, s[40:43], s98 offen sc1
    s_waitcnt vmcnt(4)
    s_bitcmp0_b32 s14, 4
    s_cbranch_scc1 L_sf_51
    s_waitcnt vmcnt(3)
    s_bitcmp0_b32 s15, 4
    s_cbranch_scc1 L_sf_51
    s_waitcnt vmcnt(2)
L_sf_51:
    s_add_u32 m0, s12, 4096
    s_nop 0
    buffer_load_dwordx4 v1, s[52:55], s97 offen offset:0 nt lds
    s_waitcnt vmcnt(4)
    s_bitcmp0_b32 s14, 5
    s_cbranch_scc1 L_sf_52
    s_waitcnt vmcnt(3)
    s_bitcmp0_b32 s15, 5
    s_cbranch_scc1 L_sf_52
    s_waitcnt vmcnt(2)
L_sf_52:
    buffer_load_dwordx4 v1, s[52:55], s97 offen offset:1024 nt lds
    s_waitcnt vmcnt(4)
    s_bitcmp0_b32 s14, 6
    s_cbranch_scc1 L_sf_53
    s_waitcnt vmcnt(3)
    s_bitcmp0_b32 s15, 6
    s_cbranch_scc1 L_sf_53
    s_waitcnt vmcnt(1)
L_sf_53:
    buffer_load_dwordx4 v1, s[52:55], s97 offen offset:2048 nt lds
    s_waitcnt vmcnt(4)
    s_bitcmp0_b32 s14, 7
    s_cbranch_scc1 L_sf_54
    s_waitcnt vmcnt(2)
    s_bitcmp0_b32 s15, 7
    s_cbranch_scc1 L_sf_54
    s_waitcnt vmcnt(1)
L_sf_54:
    buffer_load_dwordx4 v1, s[52:55], s97 offen offset:3072 nt lds
    s_add_u32 s97, s97, 32768
    v_add_u32 v1, 4096, v1
    v_and_b32 v1, 0x7fff, v1
L_k_join:
    s_waitcnt vmcnt(4)
    v_max3_u32 v38, v4, v5, v6
    v_max_u32 v38, v38, v7
    v_cmp_eq_u32 vcc, -1, v38
    s_cmp_lg_u32 s96, 0
    s_cbranch_scc1 L_qslow
    s_cbranch_vccnz L_qslow2
L_qok:
    v_dot2_f32_bf16 v8, v72, v4, 0
    v_dot2_f32_bf16 v9, v76, v4, 0
    v_dot2_f32_bf16 v10, v80, v4, 0
    v_dot2_f32_bf16 v11, v84, v4, 0
    v_dot2_f32_bf16 v24, v88, v4, 0
    v_dot2_f32_bf16 v25, v92, v4, 0
    v_dot2_f32_bf16 v26, v96, v4, 0
    v_dot2_f32_bf16 v27, v100, v4, 0
    v_dot2_f32_bf16 v8, v73, v5, v8
    v_dot2_f32_bf16 v9, v77, v5, v9
    v_dot2_f32_bf16 v10, v81, v5, v10
    v_dot2_f32_bf16 v11, v85, v5, v11
    v_dot2_f32_bf16 v24, v89, v5, v24
    v_dot2_f32_bf16 v25, v93, v5, v25
    v_dot2_f32_bf16 v26, v97, v5, v26
    v_dot2_f32_bf16 v27, v101, v5, v27
    v_dot2_f32_bf16 v8, v74, v6, v8
    v_dot2_f32_bf16 v9, v78, v6, v9
    v_dot2_f32_bf16 v10, v82, v6, v10
    v_dot2_f32_bf16 v11, v86, v6, v11
    v_dot2_f32_bf16 v24, v90, v6, v24
    v_dot2_f32_bf16 v25, v94, v6, v25
    v_dot2_f32_bf16 v26, v98, v6, v26
    v_dot2_f32_bf16 v27, v102, v6, v27
    v_dot2_f32_bf16 v8, v75, v7, v8
    v_dot2_f32_bf16 v9, v79, v7, v9
    v_dot2_f32_bf16 v10, v83, v7, v10
    v_dot2_f32_bf16 v11, v87, v7, v11
    v_dot2_f32_bf16 v24, v91, v7, v24
    v_dot2_f32_bf16 v25, v95, v7, v25
    v_dot2_f32_bf16 v26, v99, v7, v26
    v_dot2_f32_bf16 v27, v103, v7, v27
    v_add_f32_dpp v8, v8, v8 row_ror:8 row_mask:0xf bank_mask:0x3
    v_add_f32_dpp v10, v10, v10 row_ror:8 row_mask:0xf bank_mask:0x3
    v_add_f32_dpp v24, v24, v24 row_ror:8 row_mask:0xf bank_mask:0x3
    v_add_f32_dpp v26, v26, v26 row_ror:8 row_mask:0xf bank_mask:0x3
    v_add_f32_dpp v8, v9, v9 row_ror:8 row_mask:0xf bank_mask:0xc
    v_add_f32_dpp v10, v11, v11 row_ror:8 row_mask:0xf bank_mask:0xc
    v_add_f32_dpp v24, v25, v25 row_ror:8 row_mask:0xf bank_mask:0xc
    v_add_f32_dpp v26, v27, v27 row_ror:8 row_mask:0xf bank_mask:0xc
    v_add_f32_dpp v14, v8, v8 row_half_mirror row_mask:0xf bank_mask:0x5
    v_add_f32_dpp v15, v24, v24 row_half_mirror row_mask:0xf bank_mask:0x5
    v_add_f32_dpp v14, v10, v10 row_half_mirror row_mask:0xf bank_mask:0xa
    v_add_f32_dpp v15, v26, v26 row_half_mirror row_mask:0xf bank_mask:0xa
    s_nop 0
    v_add_f32_dpp v14, v14, v14 quad_perm:[1,0,3,2] row_mask:0xf bank_mask:0xf
    v_add_f32_dpp v15, v15, v15 quad_perm:[1,0,3,2] row_mask:0xf bank_mask:0xf
    s_nop 0
    v_add_f32_dpp v14, v14, v14 quad_perm:[2,3,0,1] row_mask:0xf bank_mask:0xf
    v_add_f32_dpp v15, v15, v15 quad_perm:[2,3,0,1] row_mask:0xf bank_mask:0xf
    s_waitcnt vmcnt(3)
    s_bitcmp0_b32 s14, 8
    s_cbranch_scc1 L_sf_65
    s_waitcnt vmcnt(2)
    s_bitcmp0_b32 s15, 8
    s_cbranch_scc1 L_sf_65
    s_waitcnt vmcnt(1)
L_sf_65:
    buffer_load_dwordx4 v[72:75], v1, s[52:55], s97 offen offset:0 nt
    v_dot2_f32_bf16 v8, v40, v4, 0
    v_dot2_f32_bf16 v9, v44, v4, 0
    v_dot2_f32_bf16 v10, v48, v4, 0
    v_dot2_f32_bf16 v11, v52, v4, 0
    v_dot2_f32_bf16 v24, v56, v4, 0
    v_dot2_f32_bf16 v25, v60, v4, 0
    v_dot2_f32_bf16 v26, v64, v4, 0
    v_dot2_f32_bf16 v27, v68, v4, 0
    v_dot2_f32_bf16 v28, v104, v4, 0
    v_dot2_f32_bf16 v29, v108, v4, 0
    v_dot2_f32_bf16 v30, v112, v4, 0
    v_dot2_f32_bf16 v31, v116, v4, 0
    v_dot2_f32_bf16 v8, v41, v5, v8
    v_dot2_f32_bf16 v9, v45, v5, v9
    v_dot2_f32_bf16 v10, v49, v5, v10
    v_dot2_f32_bf16 v11, v53, v5, v11
    v_dot2_f32_bf16 v24, v57, v5, v24
    v_dot2_f32_bf16 v25, v61, v5, v25
    v_dot2_f32_bf16 v26, v65, v5, v26
    v_dot2_f32_bf16 v27, v69, v5, v27
    v_dot2_f32_bf16 v28, v105, v5, v28
    v_dot2_f32_bf16 v29, v109, v5, v29
    v_dot2_f32_bf16 v30, v113, v5, v30
    v_dot2_f32_bf16 v31, v117, v5, v31
    v_dot2_f32_bf16 v8, v42, v6, v8
    v_dot2_f32_bf16 v9, v46, v6, v9
    v_dot2_f32_bf16 v10, v50, v6, v10
    v_dot2_f32_bf16 v11, v54, v6, v11
    v_dot2_f32_bf16 v24, v58, v6, v24
    v_dot2_f32_bf16 v25, v62, v6, v25
    v_dot2_f32_bf16 v26, v66, v6, v26
    v_dot2_f32_bf16 v27, v70, v6, v27
    v_dot2_f32_bf16 v28, v106, v6, v28
    v_dot2_f32_bf16 v29, v110, v6, v29
    v_dot2_f32_bf16 v30, v114, v6, v30
    v_dot2_f32_bf16 v31, v118, v6, v31
    v_dot2_f32_bf16 v8, v43, v7, v8
    v_dot2_f32_bf16 v9, v47, v7, v9
    v_dot2_f32_bf16 v10, v51, v7, v10
    v_dot2_f32_bf16 v11, v55, v7, v11
    v_dot2_f32_bf16 v24, v59, v7, v24
    v_dot2_f32_bf16 v25, v63, v7, v25
    v_dot2_f32_bf16 v26, v67, v7, v26
    v_dot2_f32_bf16 v27, v71, v7, v27
    v_dot2_f32_bf16 v28, v107, v7, v28
    v_dot2_f32_bf16 v29, v111, v7, v29
    v_dot2_f32_bf16 v30, v115, v7, v30
    v_dot2_f32_bf16 v31, v119, v7, v31
    v_add_f32_dpp v8, v8, v8 row_ror:8 row_mask:0xf bank_mask:0x3
    v_add_f32_dpp v10, v10, v10 row_ror:8 row_mask:0xf bank_mask:0x3
    v_add_f32_dpp v24, v24, v24 row_ror:8 row_mask:0xf bank_mask:0x3
    v_add_f32_dpp v26, v26, v26 row_ror:8 row_mask:0xf bank_mask:0x3
    v_add_f32_dpp v28, v28, v28 row_ror:8 row_mask:0xf bank_mask:0x3
    v_add_f32_dpp v30, v30, v30 row_ror:8 row_mask:0xf bank_mask:0x3
    v_add_f32_dpp v8, v9, v9 row_ror:8 row_mask:0xf bank_mask:0xc
    v_add_f32_dpp v10, v11, v11 row_ror:8 row_mask:0xf bank_mask:0xc
    v_add_f32_dpp v24, v25, v25 row_ror:8 row_mask:0xf bank_mask:0xc
    v_add_f32_dpp v26, v27, v27 row_ror:8 row_mask:0xf bank_mask:0xc
    v_add_f32_dpp v28, v29, v29 row_ror:8 row_mask:0xf bank_mask:0xc
    v_add_f32_dpp v30, v31, v31 row_ror:8 row_mask:0xf bank_mask:0xc
    v_add_f32_dpp v12, v8, v8 row_half_mirror row_mask:0xf bank_mask:0x5
    v_add_f32_dpp v13, v24, v24 row_half_mirror row_mask:0xf bank_mask:0x5
    v_add_f32_dpp v16, v28, v28 row_half_mirror row_mask:0xf bank_mask:0x5
    v_add_f32_dpp v12, v10, v10 row_half_mirror row_mask:0xf bank_mask:0xa
    v_add_f32_dpp v13, v26, v26 row_half_mirror row_mask:0xf bank_mask:0xa
    v_add_f32_dpp v16, v30, v30 row_half_mirror row_mask:0xf bank_mask:0xa
    v_add_f32_dpp v12, v12, v12 quad_perm:[1,0,3,2] row_mask:0xf bank_mask:0xf
    v_add_f32_dpp v13, v13, v13 quad_perm:[1,0,3,2] row_mask:0xf bank_mask:0xf
    v_add_f32_dpp v16, v16, v16 quad_perm:[1,0,3,2] row_mask:0xf bank_mask:0xf
    v_add_f32_dpp v12, v12, v12 quad_perm:[2,3,0,1] row_mask:0xf bank_mask:0xf
    v_add_f32_dpp v13, v13, v13 quad_perm:[2,3,0,1] row_mask:0xf bank_mask:0xf
    v_add_f32_dpp v16, v16, v16 quad_perm:[2,3,0,1] row_mask:0xf bank_mask:0xf
    s_waitcnt vmcnt(3)
    s_bitcmp0_b32 s14, 9
    s_cbranch_scc1 L_sf_66
    s_waitcnt vmcnt(2)
    s_bitcmp0_b32 s15, 9
    s_cbranch_scc1 L_sf_66
    s_waitcnt vmcnt(1)
L_sf_66:
    buffer_load_dwordx4 v[76:79], v1, s[52:55], s97 offen offset:1024 nt
    v_dot2_f32_bf16 v8, v120, v4, 0
    v_dot2_f32_bf16 v9, v124, v4, 0
    v_dot2_f32_bf16 v10, v128, v4, 0
    v_dot2_f32_bf16 v11, v132, v4, 0
    v_dot2_f32_bf16 v24, v136, v4, 0
    v_dot2_f32_bf16 v25, v140, v4, 0
    v_dot2_f32_bf16 v26, v144, v4, 0
    v_dot2_f32_bf16 v27, v148, v4, 0
    v_dot2_f32_bf16 v8, v121, v5, v8
    v_dot2_f32_bf16 v9, v125, v5, v9
    v_dot2_f32_bf16 v10, v129, v5, v10
    v_dot2_f32_bf16 v11, v133, v5, v11
    v_dot2_f32_bf16 v24, v137, v5, v24
    v_dot2_f32_bf16 v25, v141, v5, v25
    v_dot2_f32_bf16 v26, v145, v5, v26
    v_dot2_f32_bf16 v27, v149, v5, v27
    v_dot2_f32_bf16 v8, v122, v6, v8
    v_dot2_f32_bf16 v9, v126, v6, v9
    v_dot2_f32_bf16 v10, v130, v6, v10
    v_dot2_f32_bf16 v11, v134, v6, v11
    v_dot2_f32_bf16 v24, v138, v6, v24
    v_dot2_f32_bf16 v25, v142, v6, v25
    v_dot2_f32_bf16 v26, v146, v6, v26
    v_dot2_f32_bf16 v27, v150, v6, v27
    v_dot2_f32_bf16 v8, v123, v7, v8
    v_dot2_f32_bf16 v9, v127, v7, v9
    v_dot2_f32_bf16 v10, v131, v7, v10
    v_dot2_f32_bf16 v11, v135, v7, v11
    v_dot2_f32_bf16 v24, v139, v7, v24
    v_dot2_f32_bf16 v25, v143, v7, v25
    v_dot2_f32_bf16 v26, v147, v7, v26
    v_dot2_f32_bf16 v27, v151, v7, v27
    v_add_f32_dpp v8, v8, v8 row_ror:8 row_mask:0xf bank_mask:0x3
    v_add_f32_dpp v10, v10, v10 row_ror:8 row_mask:0xf bank_mask:0x3
    v_add_f32_dpp v24, v24, v24 row_ror:8 row_mask:0xf bank_mask:0x3
    v_add_f32_dpp v26, v26, v26 row_ror:8 row_mask:0xf bank_mask:0x3
    v_add_f32_dpp v8, v9, v9 row_ror:8 row_mask:0xf bank_mask:0xc
    v_add_f32_dpp v10, v11, v11 row_ror:8 row_mask:0xf bank_mask:0xc
    v_add_f32_dpp v24, v25, v25 row_ror:8 row_mask:0xf bank_mask:0xc
    v_add_f32_dpp v26, v27, v27 row_ror:8 row_mask:0xf bank_mask:0xc
    v_add_f32_dpp v17, v8, v8 row_half_mirror row_mask:0xf bank_mask:0x5
    v_add_f32_dpp v18, v24, v24 row_half_mirror row_mask:0xf bank_mask:0x5
    v_add_f32_dpp v17, v10, v10 row_half_mirror row_mask:0xf bank_mask:0xa
    v_add_f32_dpp v18, v26, v26 row_half_mirror row_mask:0xf bank_mask:0xa
    s_nop 0
    v_add_f32_dpp v17, v17, v17 quad_perm:[1,0,3,2] row_mask:0xf bank_mask:0xf
    v_add_f32_dpp v18, v18, v18 quad_perm:[1,0,3,2] row_mask:0xf bank_mask:0xf
    s_nop 0
    v_add_f32_dpp v17, v17, v17 quad_perm:[2,3,0,1] row_mask:0xf bank_mask:0xf
    v_add_f32_dpp v18, v18, v18 quad_perm:[2,3,0,1] row_mask:0xf bank_mask:0xf
    s_waitcnt vmcnt(3)
    s_bitcmp0_b32 s14, 10
    s_cbranch_scc1 L_sf_67
    s_waitcnt vmcnt(2)
    s_bitcmp0_b32 s15, 10
    s_cbranch_scc1 L_sf_67
    s_waitcnt vmcnt(1)
L_sf_67:
    buffer_load_dwordx4 v[80:83], v1, s[52:55], s97 offen offset:2048 nt
    s_waitcnt vmcnt(3)
    s_bitcmp0_b32 s14, 11
    s_cbranch_scc1 L_sf_68
    s_waitcnt vmcnt(2)
    s_bitcmp0_b32 s15, 11
    s_cbranch_scc1 L_sf_68
    s_waitcnt vmcnt(1)
L_sf_68:
    buffer_load_dwordx4 v[84:87], v1, s[52:55], s97 offen offset:3072 nt
    s_add_u32 s97, s97, 32768
    v_add_u32 v1, 4096, v1
    v_and_b32 v1, 0x7fff, v1
    s_cmp_eq_u32 s12, -1
    s_cbranch_scc1 L_nopfrd
    v_lshl_add_u32 v38, v0, 4, s12
    ds_read_b128 v[40:43], v38 offset:0
    ds_read_b128 v[44:47], v38 offset:1024
    ds_read_b128 v[48:51], v38 offset:2048
    ds_read_b128 v[52:55], v38 offset:3072
    ds_read_b128 v[56:59], v38 offset:4096
    ds_read_b128 v[60:63], v38 offset:5120
    ds_read_b128 v[64:67], v38 offset:6144
    ds_read_b128 v[68:71], v38 offset:7168
L_nopfrd:
    v_dot2_f32_bf16 v8, v152, v4, 0
    v_dot2_f32_bf16 v9, v156, v4, 0
    v_dot2_f32_bf16 v10, v160, v4, 0
    v_dot2_f32_bf16 v11, v164, v4, 0
    v_dot2_f32_bf16 v8, v153, v5, v8
    v_dot2_f32_bf16 v9, v157, v5, v9
    v_dot2_f32_bf16 v10, v161, v5, v10
    v_dot2_f32_bf16 v11, v165, v5, v11
    v_dot2_f32_bf16 v8, v154, v6, v8
    v_dot2_f32_bf16 v9, v158, v6, v9
    v_dot2_f32_bf16 v10, v162, v6, v10
    v_dot2_f32_bf16 v11, v166, v6, v11
    v_dot2_f32_bf16 v8, v155, v7, v8
    v_dot2_f32_bf16 v9, v159, v7, v9
    v_dot2_f32_bf16 v10, v163, v7, v10
    v_dot2_f32_bf16 v11, v167, v7, v11
    v_add_f32_dpp v8, v8, v8 row_ror:8 row_mask:0xf bank_mask:0x3
    s_nop 0
    v_add_f32_dpp v10, v10, v10 row_ror:8 row_mask:0xf bank_mask:0x3
    v_add_f32_dpp v8, v9, v9 row_ror:8 row_mask:0xf bank_mask:0xc
    v_add_f32_dpp v10, v11, v11 row_ror:8 row_mask:0xf bank_mask:0xc
    s_nop 0
    v_add_f32_dpp v19, v8, v8 row_half_mirror row_mask:0xf bank_mask:0x5
    v_add_f32_dpp v19, v10, v10 row_half_mirror row_mask:0xf bank_mask:0xa
    s_nop 1
    v_add_f32_dpp v19, v19, v19 quad_perm:[1,0,3,2] row_mask:0xf bank_mask:0xf
    s_nop 1
    v_add_f32_dpp v19, v19, v19 quad_perm:[2,3,0,1] row_mask:0xf bank_mask:0xf
    v_max3_f32 v3, v12, v13, v14
    v_max3_f32 v8, v15, v16, v17
    v_max3_f32 v3, v3, v18, v19
    v_max_f32 v3, v3, v8
    s_nop 1
    v_max_f32_dpp v3, v3, v3 row_ror:4 row_mask:0xf bank_mask:0xf
    s_nop 1
    v_max_f32_dpp v3, v3, v3 row_ror:8 row_mask:0xf bank_mask:0xf
    v_mov_b32 v8, v3
    s_nop 1
    v_permlane16_swap_b32 v3, v8
    v_max_f32 v3, v3, v8
    v_mov_b32 v8, v3
    s_nop 1
    v_permlane32_swap_b32 v3, v8
    v_max_f32 v3, v3, v8
    s_mov_b32 s96, 0x3e0293ee
    v_mul_f32 v8, s96, v3
    v_fma_f32 v12, v12, s96, -v8
    v_fma_f32 v13, v13, s96, -v8
    v_fma_f32 v14, v14, s96, -v8
    v_fma_f32 v15, v15, s96, -v8
    v_fma_f32 v16, v16, s96, -v8
    v_fma_f32 v17, v17, s96, -v8
    v_fma_f32 v18, v18, s96, -v8
    v_fma_f32 v19, v19, s96, -v8
    v_exp_f32 v12, v12
    v_exp_f32 v13, v13
    v_exp_f32 v14, v14
    v_exp_f32 v15, v15
    v_exp_f32 v16, v16
    v_exp_f32 v17, v17
    v_exp_f32 v18, v18
    v_exp_f32 v19, v19
    v_add_f32 v9, v12, v13
    v_add_f32 v10, v14, v15
    v_add_f32 v11, v16, v17
    v_add_f32 v3, v18, v19
    v_add_f32 v9, v9, v10
    v_add_f32 v3, v3, v11
    v_add_f32 v9, v9, v3
    v_cvt_pk_bf16_f32 v12, v12, v12
    v_cvt_pk_bf16_f32 v13, v13, v13
    v_cvt_pk_bf16_f32 v14, v14, v14
    v_cvt_pk_bf16_f32 v15, v15, v15
    v_cvt_pk_bf16_f32 v16, v16, v16
    v_cvt_pk_bf16_f32 v17, v17, v17
    v_cvt_pk_bf16_f32 v18, v18, v18
    v_cvt_pk_bf16_f32 v19, v19, v19
    v_add_f32_dpp v9, v9, v9 row_ror:4 row_mask:0xf bank_mask:0xf
    s_nop 1
    v_add_f32_dpp v9, v9, v9 row_ror:8 row_mask:0xf bank_mask:0xf
    v_mov_b32 v10, v9
    s_nop 1
    v_permlane16_swap_b32 v9, v10
    v_add_f32 v9, v9, v10
    v_mov_b32 v10, v9
    s_nop 1
    v_permlane32_swap_b32 v9, v10
    v_add_f32 v9, v9, v10
    s_mov_b64 exec, 1
    s_cmp_lg_u32 s13, 0
    s_cbranch_scc1 L_mljob
    s_lshl_b32 s96, s3, 3
    s_add_u32 s96, s96, 161920
    v_mov_b32 v10, s96
    v_mov_b32 v11, 162068
    v_mov_b32 v3, 1
    ds_write_b64 v10, v[8:9]
    ds_add_u32 v11, v3
L_mldone:
    s_mov_b64 exec, -1
    v_lshrrev_b32 v2, 1, v2
    v_and_b32_dpp v24, v14, v20 row_newbcast:0 row_mask:0xf bank_mask:0xf
    v_and_b32_dpp v25, v14, v21 row_newbcast:0 row_mask:0xf bank_mask:0xf
    v_and_b32_dpp v26, v14, v22 row_newbcast:0 row_mask:0xf bank_mask:0xf
    v_and_b32_dpp v27, v14, v23 row_newbcast:0 row_mask:0xf bank_mask:0xf
    s_waitcnt vmcnt(3)
    s_bitcmp0_b32 s14, 12
    s_cbranch_scc1 L_sf_69
    s_waitcnt vmcnt(2)
    s_bitcmp0_b32 s15, 12
    s_cbranch_scc1 L_sf_69
    s_waitcnt vmcnt(1)
L_sf_69:
    buffer_load_dwordx4 v[88:91], v1, s[52:55], s97 offen offset:0 nt
    v_mfma_f32_16x16x32_bf16 v[32:35], v[24:27], v[72:75], v[32:35]
    s_cmp_eq_u32 s12, -1
    s_cbranch_scc1 L_nopfpv8
    s_waitcnt lgkmcnt(0)
    v_and_b32_dpp v24, v12, v20 row_newbcast:0 row_mask:0xf bank_mask:0xf
    v_and_b32_dpp v25, v12, v21 row_newbcast:0 row_mask:0xf bank_mask:0xf
    v_and_b32_dpp v26, v12, v22 row_newbcast:0 row_mask:0xf bank_mask:0xf
    v_and_b32_dpp v27, v12, v23 row_newbcast:0 row_mask:0xf bank_mask:0xf
    s_nop 1
    v_mfma_f32_16x16x32_bf16 v[32:35], v[24:27], v[40:43], v[32:35]
    v_and_b32_dpp v28, v12, v20 row_newbcast:8 row_mask:0xf bank_mask:0xf
    v_and_b32_dpp v29, v12, v21 row_newbcast:8 row_mask:0xf bank_mask:0xf
    v_and_b32_dpp v30, v12, v22 row_newbcast:8 row_mask:0xf bank_mask:0xf
    v_and_b32_dpp v31, v12, v23 row_newbcast:8 row_mask:0xf bank_mask:0xf
    s_nop 1
    v_mfma_f32_16x16x32_bf16 v[32:35], v[28:31], v[44:47], v[32:35]
    v_and_b32_dpp v24, v12, v20 row_newbcast:4 row_mask:0xf bank_mask:0xf
    v_and_b32_dpp v25, v12, v21 row_newbcast:4 row_mask:0xf bank_mask:0xf
    v_and_b32_dpp v26, v12, v22 row_newbcast:4 row_mask:0xf bank_mask:0xf
    v_and_b32_dpp v27, v12, v23 row_newbcast:4 row_mask:0xf bank_mask:0xf
    s_nop 1
    v_mfma_f32_16x16x32_bf16 v[32:35], v[24:27], v[48:51], v[32:35]
    v_and_b32_dpp v28, v12, v20 row_newbcast:12 row_mask:0xf bank_mask:0xf
    v_and_b32_dpp v29, v12, v21 row_newbcast:12 row_mask:0xf bank_mask:0xf
    v_and_b32_dpp v30, v12, v22 row_newbcast:12 row_mask:0xf bank_mask:0xf
    v_and_b32_dpp v31, v12, v23 row_newbcast:12 row_mask:0xf bank_mask:0xf
    s_nop 1
    v_mfma_f32_16x16x32_bf16 v[32:35], v[28:31], v[52:55], v[32:35]
L_nopfpv8:
    v_and_b32_dpp v28, v14, v20 row_newbcast:8 row_mask:0xf bank_mask:0xf
    v_and_b32_dpp v29, v14, v21 row_newbcast:8 row_mask:0xf bank_mask:0xf
    v_and_b32_dpp v30, v14, v22 row_newbcast:8 row_mask:0xf bank_mask:0xf
    v_and_b32_dpp v31, v14, v23 row_newbcast:8 row_mask:0xf bank_mask:0xf
    s_waitcnt vmcnt(3)
    s_bitcmp0_b32 s14, 13
    s_cbranch_scc1 L_sf_70
    s_waitcnt vmcnt(2)
    s_bitcmp0_b32 s15, 13
    s_cbranch_scc1 L_sf_70
    s_waitcnt vmcnt(1)
L_sf_70:
    buffer_load_dwordx4 v[92:95], v1, s[52:55], s97 offen offset:1024 nt
    v_mfma_f32_16x16x32_bf16 v[32:35], v[28:31], v[76:79], v[32:35]
    s_cmp_eq_u32 s12, -1
    s_cbranch_scc1 L_nopfpv9
    s_waitcnt lgkmcnt(0)
    v_and_b32_dpp v24, v13, v20 row_newbcast:0 row_mask:0xf bank_mask:0xf
    v_and_b32_dpp v25, v13, v21 row_newbcast:0 row_mask:0xf bank_mask:0xf
    v_and_b32_dpp v26, v13, v22 row_newbcast:0 row_mask:0xf bank_mask:0xf
    v_and_b32_dpp v27, v13, v23 row_newbcast:0 row_mask:0xf bank_mask:0xf
    s_nop 1
    v_mfma_f32_16x16x32_bf16 v[32:35], v[24:27], v[56:59], v[32:35]
    v_and_b32_dpp v28, v13, v20 row_newbcast:8 row_mask:0xf bank_mask:0xf
    v_and_b32_dpp v29, v13, v21 row_newbcast:8 row_mask:0xf bank_mask:0xf
    v_and_b32_dpp v30, v13, v22 row_newbcast:8 row_mask:0xf bank_mask:0xf
    v_and_b32_dpp v31, v13, v23 row_newbcast:8 row_mask:0xf bank_mask:0xf
    s_nop 1
    v_mfma_f32_16x16x32_bf16 v[32:35], v[28:31], v[60:63], v[32:35]
    v_and_b32_dpp v24, v13, v20 row_newbcast:4 row_mask:0xf bank_mask:0xf
    v_and_b32_dpp v25, v13, v21 row_newbcast:4 row_mask:0xf bank_mask:0xf
    v_and_b32_dpp v26, v13, v22 row_newbcast:4 row_mask:0xf bank_mask:0xf
    v_and_b32_dpp v27, v13, v23 row_newbcast:4 row_mask:0xf bank_mask:0xf
    s_nop 1
    v_mfma_f32_16x16x32_bf16 v[32:35], v[24:27], v[64:67], v[32:35]
    v_and_b32_dpp v28, v13, v20 row_newbcast:12 row_mask:0xf bank_mask:0xf
    v_and_b32_dpp v29, v13, v21 row_newbcast:12 row_mask:0xf bank_mask:0xf
    v_and_b32_dpp v30, v13, v22 row_newbcast:12 row_mask:0xf bank_mask:0xf
    v_and_b32_dpp v31, v13, v23 row_newbcast:12 row_mask:0xf bank_mask:0xf
    s_nop 1
    v_mfma_f32_16x16x32_bf16 v[32:35], v[28:31], v[68:71], v[32:35]
L_nopfpv9:
    v_and_b32_dpp v24, v14, v20 row_newbcast:4 row_mask:0xf bank_mask:0xf
    v_and_b32_dpp v25, v14, v21 row_newbcast:4 row_mask:0xf bank_mask:0xf
    v_and_b32_dpp v26, v14, v22 row_newbcast:4 row_mask:0xf bank_mask:0xf
    v_and_b32_dpp v27, v14, v23 row_newbcast:4 row_mask:0xf bank_mask:0xf
    s_waitcnt vmcnt(3)
    s_bitcmp0_b32 s14, 14
    s_cbranch_scc1 L_sf_71
    s_waitcnt vmcnt(2)
    s_bitcmp0_b32 s15, 14
    s_cbranch_scc1 L_sf_71
    s_waitcnt vmcnt(1)
L_sf_71:
    buffer_load_dwordx4 v[96:99], v1, s[52:55], s97 offen offset:2048 nt
    v_mfma_f32_16x16x32_bf16 v[32:35], v[24:27], v[80:83], v[32:35]
    v_and_b32_dpp v28, v14, v20 row_newbcast:12 row_mask:0xf bank_mask:0xf
    v_and_b32_dpp v29, v14, v21 row_newbcast:12 row_mask:0xf bank_mask:0xf
    v_and_b32_dpp v30, v14, v22 row_newbcast:12 row_mask:0xf bank_mask:0xf
    v_and_b32_dpp v31, v14, v23 row_newbcast:12 row_mask:0xf bank_mask:0xf
    s_waitcnt vmcnt(3)
    s_bitcmp0_b32 s14, 15
    s_cbranch_scc1 L_sf_72
    s_waitcnt vmcnt(2)
    s_bitcmp0_b32 s15, 15
    s_cbranch_scc1 L_sf_72
    s_waitcnt vmcnt(1)
L_sf_72:
    buffer_load_dwordx4 v[100:103], v1, s[52:55], s97 offen offset:3072 nt
    s_add_u32 s97, s97, 32768
    v_add_u32 v1, 4096, v1
    v_and_b32 v1, 0x7fff, v1
    v_mfma_f32_16x16x32_bf16 v[32:35], v[28:31], v[84:87], v[32:35]
    v_and_b32_dpp v24, v15, v20 row_newbcast:0 row_mask:0xf bank_mask:0xf
    v_and_b32_dpp v25, v15, v21 row_newbcast:0 row_mask:0xf bank_mask:0xf
    v_and_b32_dpp v26, v15, v22 row_newbcast:0 row_mask:0xf bank_mask:0xf
    v_and_b32_dpp v27, v15, v23 row_newbcast:0 row_mask:0xf bank_mask:0xf
    s_waitcnt vmcnt(3)
    s_bitcmp0_b32 s14, 16
    s_cbranch_scc1 L_sf_73
    s_waitcnt vmcnt(2)
    s_bitcmp0_b32 s15, 16
    s_cbranch_scc1 L_sf_73
    s_waitcnt vmcnt(1)
L_sf_73:
    buffer_load_dwordx4 v[104:107], v1, s[52:55], s97 offen offset:0 nt
    v_mfma_f32_16x16x32_bf16 v[32:35], v[24:27], v[88:91], v[32:35]
    v_and_b32_dpp v28, v15, v20 row_newbcast:8 row_mask:0xf bank_mask:0xf
    v_and_b32_dpp v29, v15, v21 row_newbcast:8 row_mask:0xf bank_mask:0xf
    v_and_b32_dpp v30, v15, v22 row_newbcast:8 row_mask:0xf bank_mask:0xf
    v_and_b32_dpp v31, v15, v23 row_newbcast:8 row_mask:0xf bank_mask:0xf
    s_waitcnt vmcnt(3)
    s_bitcmp0_b32 s14, 17
    s_cbranch_scc1 L_sf_74
    s_waitcnt vmcnt(2)
    s_bitcmp0_b32 s15, 17
    s_cbranch_scc1 L_sf_74
    s_waitcnt vmcnt(1)
L_sf_74:
    buffer_load_dwordx4 v[108:111], v1, s[52:55], s97 offen offset:1024 nt
    v_mfma_f32_16x16x32_bf16 v[32:35], v[28:31], v[92:95], v[32:35]
    v_and_b32_dpp v24, v15, v20 row_newbcast:4 row_mask:0xf bank_mask:0xf
    v_and_b32_dpp v25, v15, v21 row_newbcast:4 row_mask:0xf bank_mask:0xf
    v_and_b32_dpp v26, v15, v22 row_newbcast:4 row_mask:0xf bank_mask:0xf
    v_and_b32_dpp v27, v15, v23 row_newbcast:4 row_mask:0xf bank_mask:0xf
    s_waitcnt vmcnt(3)
    s_bitcmp0_b32 s14, 18
    s_cbranch_scc1 L_sf_75
    s_waitcnt vmcnt(2)
    s_bitcmp0_b32 s15, 18
    s_cbranch_scc1 L_sf_75
    s_waitcnt vmcnt(1)
L_sf_75:
    buffer_load_dwordx4 v[112:115], v1, s[52:55], s97 offen offset:2048 nt
    v_mfma_f32_16x16x32_bf16 v[32:35], v[24:27], v[96:99], v[32:35]
    v_and_b32_dpp v28, v15, v20 row_newbcast:12 row_mask:0xf bank_mask:0xf
    v_and_b32_dpp v29, v15, v21 row_newbcast:12 row_mask:0xf bank_mask:0xf
    v_and_b32_dpp v30, v15, v22 row_newbcast:12 row_mask:0xf bank_mask:0xf
    v_and_b32_dpp v31, v15, v23 row_newbcast:12 row_mask:0xf bank_mask:0xf
    s_waitcnt vmcnt(3)
    s_bitcmp0_b32 s14, 19
    s_cbranch_scc1 L_sf_76
    s_waitcnt vmcnt(2)
    s_bitcmp0_b32 s15, 19
    s_cbranch_scc1 L_sf_76
    s_waitcnt vmcnt(1)
L_sf_76:
    buffer_load_dwordx4 v[116:119], v1, s[52:55], s97 offen offset:3072 nt
    s_add_u32 s97, s97, 32768
    v_add_u32 v1, 4096, v1
    v_and_b32 v1, 0x7fff, v1
    v_mfma_f32_16x16x32_bf16 v[32:35], v[28:31], v[100:103], v[32:35]
    v_and_b32_dpp v24, v16, v20 row_newbcast:0 row_mask:0xf bank_mask:0xf
    v_and_b32_dpp v25, v16, v21 row_newbcast:0 row_mask:0xf bank_mask:0xf
    v_and_b32_dpp v26, v16, v22 row_newbcast:0 row_mask:0xf bank_mask:0xf
    v_and_b32_dpp v27, v16, v23 row_newbcast:0 row_mask:0xf bank_mask:0xf
    s_waitcnt vmcnt(3)
    s_bitcmp0_b32 s14, 20
    s_cbranch_scc1 L_sf_77
    s_waitcnt vmcnt(2)
    s_bitcmp0_b32 s15, 20
    s_cbranch_scc1 L_sf_77
    s_waitcnt vmcnt(1)
L_sf_77:
    buffer_load_dwordx4 v[120:123], v1, s[52:55], s97 offen offset:0 nt
    v_mfma_f32_16x16x32_bf16 v[32:35], v[24:27], v[104:107], v[32:35]
    v_and_b32_dpp v28, v16, v20 row_newbcast:8 row_mask:0xf bank_mask:0xf
    v_and_b32_dpp v29, v16, v21 row_newbcast:8 row_mask:0xf bank_mask:0xf
    v_and_b32_dpp v30, v16, v22 row_newbcast:8 row_mask:0xf bank_mask:0xf
    v_and_b32_dpp v31, v16, v23 row_newbcast:8 row_mask:0xf bank_mask:0xf
    s_waitcnt vmcnt(3)
    s_bitcmp0_b32 s14, 21
    s_cbranch_scc1 L_sf_78
    s_waitcnt vmcnt(2)
    s_bitcmp0_b32 s15, 21
    s_cbranch_scc1 L_sf_78
    s_waitcnt vmcnt(1)
L_sf_78:
    buffer_load_dwordx4 v[124:127], v1, s[52:55], s97 offen offset:1024 nt
    v_mfma_f32_16x16x32_bf16 v[32:35], v[28:31], v[108:111], v[32:35]
    v_and_b32_dpp v24, v16, v20 row_newbcast:4 row_mask:0xf bank_mask:0xf
    v_and_b32_dpp v25, v16, v21 row_newbcast:4 row_mask:0xf bank_mask:0xf
    v_and_b32_dpp v26, v16, v22 row_newbcast:4 row_mask:0xf bank_mask:0xf
    v_and_b32_dpp v27, v16, v23 row_newbcast:4 row_mask:0xf bank_mask:0xf
    s_waitcnt vmcnt(3)
    s_bitcmp0_b32 s14, 22
    s_cbranch_scc1 L_sf_79
    s_waitcnt vmcnt(2)
    s_bitcmp0_b32 s15, 22
    s_cbranch_scc1 L_sf_79
    s_waitcnt vmcnt(1)
L_sf_79:
    buffer_load_dwordx4 v[128:131], v1, s[52:55], s97 offen offset:2048 nt
    v_mfma_f32_16x16x32_bf16 v[32:35], v[24:27], v[112:115], v[32:35]
    v_and_b32_dpp v28, v16, v20 row_newbcast:12 row_mask:0xf bank_mask:0xf
    v_and_b32_dpp v29, v16, v21 row_newbcast:12 row_mask:0xf bank_mask:0xf
    v_and_b32_dpp v30, v16, v22 row_newbcast:12 row_mask:0xf bank_mask:0xf
    v_and_b32_dpp v31, v16, v23 row_newbcast:12 row_mask:0xf bank_mask:0xf
    s_waitcnt vmcnt(3)
    s_bitcmp0_b32 s14, 23
    s_cbranch_scc1 L_sf_80
    s_waitcnt vmcnt(2)
    s_bitcmp0_b32 s15, 23
    s_cbranch_scc1 L_sf_80
    s_waitcnt vmcnt(1)
L_sf_80:
    buffer_load_dwordx4 v[132:135], v1, s[52:55], s97 offen offset:3072 nt
    s_add_u32 s97, s97, 32768
    v_add_u32 v1, 4096, v1
    v_and_b32 v1, 0x7fff, v1
    v_mfma_f32_16x16x32_bf16 v[32:35], v[28:31], v[116:119], v[32:35]
    v_and_b32_dpp v24, v17, v20 row_newbcast:0 row_mask:0xf bank_mask:0xf
    v_and_b32_dpp v25, v17, v21 row_newbcast:0 row_mask:0xf bank_mask:0xf
    v_and_b32_dpp v26, v17, v22 row_newbcast:0 row_mask:0xf bank_mask:0xf
    v_and_b32_dpp v27, v17, v23 row_newbcast:0 row_mask:0xf bank_mask:0xf
    s_waitcnt vmcnt(3)
    s_bitcmp0_b32 s14, 24
    s_cbranch_scc1 L_sf_81
    s_waitcnt vmcnt(2)
    s_bitcmp0_b32 s15, 24
    s_cbranch_scc1 L_sf_81
    s_waitcnt vmcnt(1)
L_sf_81:
    buffer_load_dwordx4 v[136:139], v1, s[52:55], s97 offen offset:0 nt
    v_mfma_f32_16x16x32_bf16 v[32:35], v[24:27], v[120:123], v[32:35]
    s_or_b32 s96, s59, s39
    s_cbranch_scc0 L_nofrag_82
    v_mov_b32 v104, 162060
L_lw_83:
    ds_read_b32 v105, v104
    s_waitcnt lgkmcnt(0)
    v_cmp_gt_u32 vcc, 4, v105
    s_cbranch_vccz L_lw_83e
    s_sleep 2
    s_sub_u32 s60, s60, 1
    s_cbranch_scc0 L_lw_83
    s_mov_b32 s60, 0
L_lw_83e:
    s_cmp_eq_u32 s59, 0
    s_cbranch_scc1 L_nofrag_82
    v_lshrrev_b32 v109, 4, v0
    v_bfe_u32 v104, v0, 1, 1
    v_lshl_add_u32 v104, v109, 1, v104
    v_bfe_u32 v110, v0, 2, 2
    v_lshl_add_u32 v104, v104, 3, v110
    v_lshlrev_b32 v104, 7, v104
    v_and_b32 v110, 1, v0
    v_lshl_add_u32 v104, v110, 3, v104
    s_lshr_b32 s63, s3, 1
    s_and_b32 s62, s3, 1
    s_lshl_b32 s96, s63, 14
    s_lshl_b32 s100, s62, 6
    s_add_u32 s100, s100, 81920
    s_add_u32 s96, s96, s100
    v_add_u32 v104, s96, v104
    ds_read_b64_tr_b16 v[72:73], v104 offset:0
    ds_read_b64_tr_b16 v[74:75], v104 offset:512
    ds_read_b64_tr_b16 v[76:77], v104 offset:16
    ds_read_b64_tr_b16 v[78:79], v104 offset:528
    ds_read_b64_tr_b16 v[80:81], v104 offset:32
    ds_read_b64_tr_b16 v[82:83], v104 offset:544
    ds_read_b64_tr_b16 v[84:85], v104 offset:48
    ds_read_b64_tr_b16 v[86:87], v104 offset:560
    ds_read_b64_tr_b16 v[88:89], v104 offset:8192
    ds_read_b64_tr_b16 v[90:91], v104 offset:8704
    ds_read_b64_tr_b16 v[92:93], v104 offset:8208
    ds_read_b64_tr_b16 v[94:95], v104 offset:8720
    ds_read_b64_tr_b16 v[96:97], v104 offset:8224
    ds_read_b64_tr_b16 v[98:99], v104 offset:8736
    ds_read_b64_tr_b16 v[100:101], v104 offset:8240
    ds_read_b64_tr_b16 v[102:103], v104 offset:8752
    v_bfe_u32 v105, v0, 1, 3
    v_lshlrev_b32 v105, 8, v105
    v_lshl_add_u32 v105, v109, 5, v105
    v_lshl_add_u32 v105, v110, 4, v105
    v_lshrrev_b32 v106, 3, v0
    v_lshlrev_b32 v106, 7, v106
    v_and_b32 v110, 7, v0
    v_lshl_add_u32 v107, v110, 3, v106
    v_add_u32 v107, s100, v107
    v_lshl_add_u32 v106, v110, 2, v106
    v_add_u32 v106, s96, v106
    v_lshlrev_b32 v108, 2, v0
    s_lshl_b32 s96, s62, 2
    s_add_u32 s96, s96, 162088
    v_mov_b32 v109, s96
    s_lshl_b32 s100, s63, 11
    s_lshl_b32 s96, s34, 13
    s_add_u32 s100, s100, s96
    s_add_u32 s100, s100, 90112
    s_mul_i32 s101, s34, 5120
    s_lshl_b32 s96, s35, 9
    s_add_u32 s101, s101, s96
    s_lshl_b32 s96, s62, 8
    s_add_u32 s101, s101, s96
    s_add_u32 s101, s101, 144384
L_nofrag_82:
    v_and_b32_dpp v28, v17, v20 row_newbcast:8 row_mask:0xf bank_mask:0xf
    v_and_b32_dpp v29, v17, v21 row_newbcast:8 row_mask:0xf bank_mask:0xf
    v_and_b32_dpp v30, v17, v22 row_newbcast:8 row_mask:0xf bank_mask:0xf
    v_and_b32_dpp v31, v17, v23 row_newbcast:8 row_mask:0xf bank_mask:0xf
    s_waitcnt vmcnt(3)
    s_bitcmp0_b32 s14, 25
    s_cbranch_scc1 L_sf_84
    s_waitcnt vmcnt(2)
    s_bitcmp0_b32 s15, 25
    s_cbranch_scc1 L_sf_84
    s_waitcnt vmcnt(1)
L_sf_84:
    buffer_load_dwordx4 v[140:143], v1, s[52:55], s97 offen offset:1024 nt
    v_mfma_f32_16x16x32_bf16 v[32:35], v[28:31], v[124:127], v[32:35]
    v_and_b32_dpp v24, v17, v20 row_newbcast:4 row_mask:0xf bank_mask:0xf
    v_and_b32_dpp v25, v17, v21 row_newbcast:4 row_mask:0xf bank_mask:0xf
    v_and_b32_dpp v26, v17, v22 row_newbcast:4 row_mask:0xf bank_mask:0xf
    v_and_b32_dpp v27, v17, v23 row_newbcast:4 row_mask:0xf bank_mask:0xf
    s_waitcnt vmcnt(3)
    s_bitcmp0_b32 s14, 26
    s_cbranch_scc1 L_sf_85
    s_waitcnt vmcnt(2)
    s_bitcmp0_b32 s15, 26
    s_cbranch_scc1 L_sf_85
    s_waitcnt vmcnt(1)
L_sf_85:
    buffer_load_dwordx4 v[144:147], v1, s[52:55], s97 offen offset:2048 nt
    v_mfma_f32_16x16x32_bf16 v[32:35], v[24:27], v[128:131], v[32:35]
    v_mov_b32 v10, 162076
    v_mov_b32 v11, 1
    s_mov_b64 exec, 1
    ds_add_u32 v10, v11
    s_mov_b64 exec, -1
    v_and_b32_dpp v28, v17, v20 row_newbcast:12 row_mask:0xf bank_mask:0xf
    v_and_b32_dpp v29, v17, v21 row_newbcast:12 row_mask:0xf bank_mask:0xf
    v_and_b32_dpp v30, v17, v22 row_newbcast:12 row_mask:0xf bank_mask:0xf
    v_and_b32_dpp v31, v17, v23 row_newbcast:12 row_mask:0xf bank_mask:0xf
    s_waitcnt vmcnt(3)
    s_bitcmp0_b32 s14, 27
    s_cbranch_scc1 L_sf_86
    s_waitcnt vmcnt(2)
    s_bitcmp0_b32 s15, 27
    s_cbranch_scc1 L_sf_86
    s_waitcnt vmcnt(1)
L_sf_86:
    buffer_load_dwordx4 v[148:151], v1, s[52:55], s97 offen offset:3072 nt
    s_add_u32 s97, s97, 32768
    v_add_u32 v1, 4096, v1
    v_and_b32 v1, 0x7fff, v1
    v_mfma_f32_16x16x32_bf16 v[32:35], v[28:31], v[132:135], v[32:35]
    v_and_b32_dpp v24, v18, v20 row_newbcast:0 row_mask:0xf bank_mask:0xf
    v_and_b32_dpp v25, v18, v21 row_newbcast:0 row_mask:0xf bank_mask:0xf
    v_and_b32_dpp v26, v18, v22 row_newbcast:0 row_mask:0xf bank_mask:0xf
    v_and_b32_dpp v27, v18, v23 row_newbcast:0 row_mask:0xf bank_mask:0xf
    s_waitcnt vmcnt(3)
    s_bitcmp0_b32 s14, 28
    s_cbranch_scc1 L_sf_87
    s_waitcnt vmcnt(2)
    s_bitcmp0_b32 s15, 28
    s_cbranch_scc1 L_sf_87
    s_waitcnt vmcnt(1)
L_sf_87:
    buffer_load_dwordx4 v[152:155], v1, s[52:55], s97 offen offset:0 nt
    v_mfma_f32_16x16x32_bf16 v[32:35], v[24:27], v[136:139], v[32:35]
    v_and_b32_dpp v28, v18, v20 row_newbcast:8 row_mask:0xf bank_mask:0xf
    v_and_b32_dpp v29, v18, v21 row_newbcast:8 row_mask:0xf bank_mask:0xf
    v_and_b32_dpp v30, v18, v22 row_newbcast:8 row_mask:0xf bank_mask:0xf
    v_and_b32_dpp v31, v18, v23 row_newbcast:8 row_mask:0xf bank_mask:0xf
    s_waitcnt vmcnt(3)
    s_bitcmp0_b32 s14, 29
    s_cbranch_scc1 L_sf_88
    s_waitcnt vmcnt(2)
    s_bitcmp0_b32 s15, 29
    s_cbranch_scc1 L_sf_88
    s_waitcnt vmcnt(1)
L_sf_88:
    buffer_load_dwordx4 v[156:159], v1, s[52:55], s97 offen offset:1024 nt
    v_mfma_f32_16x16x32_bf16 v[32:35], v[28:31], v[140:143], v[32:35]
    v_and_b32_dpp v24, v18, v20 row_newbcast:4 row_mask:0xf bank_mask:0xf
    v_and_b32_dpp v25, v18, v21 row_newbcast:4 row_mask:0xf bank_mask:0xf
    v_and_b32_dpp v26, v18, v22 row_newbcast:4 row_mask:0xf bank_mask:0xf
    v_and_b32_dpp v27, v18, v23 row_newbcast:4 row_mask:0xf bank_mask:0xf
    s_waitcnt vmcnt(3)
    s_bitcmp0_b32 s14, 30
    s_cbranch_scc1 L_sf_89
    s_waitcnt vmcnt(2)
    s_bitcmp0_b32 s15, 30
    s_cbranch_scc1 L_sf_89
    s_waitcnt vmcnt(1)
L_sf_89:
    buffer_load_dwordx4 v[160:163], v1, s[52:55], s97 offen offset:2048 nt
    v_mfma_f32_16x16x32_bf16 v[32:35], v[24:27], v[144:147], v[32:35]
    v_lshrrev_b32 v9, 4, v0
    v_lshl_add_u32 v8, v9, 2, v2
    s_lshl_b32 s96, s3, 9
    s_add_u32 s96, s96, 157824
    v_lshl_add_u32 v8, v8, 2, s96
    v_lshlrev_b32 v9, 3, v0
    v_add_u32 v9, 157824, v9
    v_mov_b32 v10, 162048
    v_mov_b32 v11, 1
    s_lshl_b32 s96, s38, 5
    s_add_u32 s96, s96, 161984
    v_mov_b32 v3, s96
    s_sub_u32 s62, 8, s39
    s_lshl_b32 s98, s34, 5
    s_add_u32 s98, s98, s35
    s_lshl_b32 s98, s98, 8
    s_add_u32 s98, s98, 90112
    v_lshlrev_b32 v39, 2, v0
    v_and_b32_dpp v28, v18, v20 row_newbcast:12 row_mask:0xf bank_mask:0xf
    v_and_b32_dpp v29, v18, v21 row_newbcast:12 row_mask:0xf bank_mask:0xf
    v_and_b32_dpp v30, v18, v22 row_newbcast:12 row_mask:0xf bank_mask:0xf
    v_and_b32_dpp v31, v18, v23 row_newbcast:12 row_mask:0xf bank_mask:0xf
    s_waitcnt vmcnt(3)
    s_bitcmp0_b32 s14, 31
    s_cbranch_scc1 L_sf_90
    s_waitcnt vmcnt(2)
    s_bitcmp0_b32 s15, 31
    s_cbranch_scc1 L_sf_90
    s_waitcnt vmcnt(1)
L_sf_90:
    buffer_load_dwordx4 v[164:167], v1, s[52:55], s97 offen offset:3072 nt
    s_mov_b32 s97, 0
    v_add_u32 v1, 4096, v1
    v_and_b32 v1, 0x7fff, v1
    v_mfma_f32_16x16x32_bf16 v[32:35], v[28:31], v[148:151], v[32:35]
    s_cmp_eq_u32 s12, -1
    s_cbranch_scc1 L_v_nopf
    v_and_b32_dpp v24, v19, v20 row_newbcast:0 row_mask:0xf bank_mask:0xf
    v_and_b32_dpp v25, v19, v21 row_newbcast:0 row_mask:0xf bank_mask:0xf
    v_and_b32_dpp v26, v19, v22 row_newbcast:0 row_mask:0xf bank_mask:0xf
    v_and_b32_dpp v27, v19, v23 row_newbcast:0 row_mask:0xf bank_mask:0xf
    s_waitcnt vmcnt(3)
    s_nop 0
    v_mfma_f32_16x16x32_bf16 v[32:35], v[24:27], v[152:155], v[32:35]
    v_and_b32_dpp v28, v19, v20 row_newbcast:8 row_mask:0xf bank_mask:0xf
    v_and_b32_dpp v29, v19, v21 row_newbcast:8 row_mask:0xf bank_mask:0xf
    v_and_b32_dpp v30, v19, v22 row_newbcast:8 row_mask:0xf bank_mask:0xf
    v_and_b32_dpp v31, v19, v23 row_newbcast:8 row_mask:0xf bank_mask:0xf
    s_waitcnt vmcnt(2)
    s_nop 0
    v_mfma_f32_16x16x32_bf16 v[32:35], v[28:31], v[156:159], v[32:35]
    v_and_b32_dpp v24, v19, v20 row_newbcast:4 row_mask:0xf bank_mask:0xf
    v_and_b32_dpp v25, v19, v21 row_newbcast:4 row_mask:0xf bank_mask:0xf
    v_and_b32_dpp v26, v19, v22 row_newbcast:4 row_mask:0xf bank_mask:0xf
    v_and_b32_dpp v27, v19, v23 row_newbcast:4 row_mask:0xf bank_mask:0xf
    s_waitcnt vmcnt(1)
    s_nop 0
    v_mfma_f32_16x16x32_bf16 v[32:35], v[24:27], v[160:163], v[32:35]
    v_and_b32_dpp v28, v19, v20 row_newbcast:12 row_mask:0xf bank_mask:0xf
    v_and_b32_dpp v29, v19, v21 row_newbcast:12 row_mask:0xf bank_mask:0xf
    v_and_b32_dpp v30, v19, v22 row_newbcast:12 row_mask:0xf bank_mask:0xf
    v_and_b32_dpp v31, v19, v23 row_newbcast:12 row_mask:0xf bank_mask:0xf
    s_waitcnt vmcnt(0)
    s_nop 0
    v_mfma_f32_16x16x32_bf16 v[32:35], v[28:31], v[164:167], v[32:35]
L_v_join:
    s_cmp_lg_u32 s13, 0
    s_cbranch_scc1 L_jobend
L_t0:
    s_mov_b32 exec_hi, 0
    s_nop 4
    ds_write_b128 v8, v[32:35]
L_t0b:
    s_mov_b64 exec, 1
    ds_add_rtn_u32 v37, v10, v11
    s_mov_b64 exec, -1
    ds_read_b32 v38, v10 offset:24
    ds_read_b128 v[24:27], v3
    ds_read_b128 v[28:31], v3 offset:16
    ds_read_b64 v[144:145], v9 offset:0
    ds_read_b64 v[146:147], v9 offset:512
    ds_read_b64 v[148:149], v9 offset:1024
    ds_read_b64 v[150:151], v9 offset:1536
    ds_read_b64 v[152:153], v9 offset:2048
    ds_read_b64 v[154:155], v9 offset:2560
    ds_read_b64 v[156:157], v9 offset:3072
    ds_read_b64 v[158:159], v9 offset:3584
    s_waitcnt lgkmcnt(10)
    v_readfirstlane_b32 s96, v37
    v_readfirstlane_b32 s61, v38
    s_cmp_lg_u32 s96, s62
    s_cbranch_scc1 L_nopub
    s_waitcnt lgkmcnt(6)
    v_pk_mul_f32 v[144:145], v[144:145], v[24:25] op_sel:[0,0] op_sel_hi:[1,0]
    v_pk_mul_f32 v[146:147], v[146:147], v[24:25] op_sel:[0,1] op_sel_hi:[1,1]
    s_waitcnt lgkmcnt(4)
    v_pk_fma_f32 v[144:145], v[148:149], v[26:27], v[144:145] op_sel:[0,0,0] op_sel_hi:[1,0,1]
    v_pk_fma_f32 v[146:147], v[150:151], v[26:27], v[146:147] op_sel:[0,1,0] op_sel_hi:[1,1,1]
    s_waitcnt lgkmcnt(2)
    v_pk_fma_f32 v[144:145], v[152:153], v[28:29], v[144:145] op_sel:[0,0,0] op_sel_hi:[1,0,1]
    v_pk_fma_f32 v[146:147], v[154:155], v[28:29], v[146:147] op_sel:[0,1,0] op_sel_hi:[1,1,1]
    s_waitcnt lgkmcnt(0)
    v_pk_fma_f32 v[144:145], v[156:157], v[30:31], v[144:145] op_sel:[0,0,0] op_sel_hi:[1,0,1]
    v_pk_fma_f32 v[146:147], v[158:159], v[30:31], v[146:147] op_sel:[0,1,0] op_sel_hi:[1,1,1]
    s_cmp_eq_u32 s61, 1
    v_pk_add_f32 v[144:145], v[144:145], v[146:147]
    v_cvt_pk_bf16_f32 v32, v144, v145
    s_cbranch_scc0 L_oslow
    buffer_store_dword v32, v39, s[40:43], s98 offen
L_odone:
L_nopub:
    s_cmp_eq_u32 s59, 0
    s_cbranch_scc1 L_not1
L_poll_99:
    buffer_load_dwordx4 v[16:19], v105, s[40:43], s100 offen sc1
    buffer_load_dwordx4 v[20:23], v105, s[40:43], s100 offen offset:128 sc1
    s_sub_u32 s60, s60, 1
    s_cbranch_scc1 L_poll_99t
    s_waitcnt vmcnt(0)
    v_max3_u32 v38, v16, v17, v18
    v_max3_u32 v38, v38, v19, v20
    v_max3_u32 v38, v38, v21, v22
    v_max_u32 v38, v38, v23
    v_cmp_eq_u32 vcc, -1, v38
    s_cbranch_vccnz L_poll_99
L_poll_99e:
    v_mfma_f32_16x16x32_bf16 v[112:115], v[16:19], v[72:75], 0
    v_mfma_f32_16x16x32_bf16 v[120:123], v[16:19], v[80:83], 0
    v_mfma_f32_16x16x32_bf16 v[116:119], v[16:19], v[76:79], 0
    v_mfma_f32_16x16x32_bf16 v[124:127], v[16:19], v[84:87], 0
    v_mfma_f32_16x16x32_bf16 v[112:115], v[20:23], v[88:91], v[112:115]
    v_mfma_f32_16x16x32_bf16 v[120:123], v[20:23], v[96:99], v[120:123]
    v_mfma_f32_16x16x32_bf16 v[116:119], v[20:23], v[92:95], v[116:119]
    v_mfma_f32_16x16x32_bf16 v[124:127], v[20:23], v[100:103], v[124:127]
    s_nop 4
    v_pk_add_f32 v[112:113], v[112:113], v[114:115]
    v_pk_add_f32 v[120:121], v[120:121], v[122:123]
    v_pk_add_f32 v[116:117], v[116:117], v[118:119]
    v_pk_add_f32 v[124:125], v[124:125], v[126:127]
    v_add_f32_dpp v12, v113, v112 row_ror:8 row_mask:0xf bank_mask:0x3
    v_add_f32_dpp v12, v120, v121 row_ror:8 row_mask:0xf bank_mask:0xc
    v_add_f32_dpp v13, v117, v116 row_ror:8 row_mask:0xf bank_mask:0x3
    v_add_f32_dpp v13, v124, v125 row_ror:8 row_mask:0xf bank_mask:0xc
    ds_write2_b32 v106, v12, v13 offset0:0 offset1:8
    s_mov_b64 exec, 1
    ds_add_rtn_u32 v37, v109, v11
    s_mov_b64 exec, -1
    ds_read_b64 v[72:73], v107 offset:0
    ds_read_b64 v[74:75], v107 offset:16384
    ds_read_b64 v[76:77], v107 offset:32768
    ds_read_b64 v[78:79], v107 offset:49152
    s_cmp_eq_u32 s34, 2
    s_cselect_b32 s97, s61, 0
    s_waitcnt lgkmcnt(4)
    v_readfirstlane_b32 s96, v37
    s_waitcnt lgkmcnt(2)
    v_pk_add_f32 v[72:73], v[72:73], v[74:75]
    s_cmp_lg_u32 s96, 3
    s_cbranch_scc1 L_not1
    s_cmp_eq_u32 s97, 1
    s_waitcnt lgkmcnt(0)
    v_pk_add_f32 v[76:77], v[76:77], v[78:79]
    v_pk_add_f32 v[72:73], v[72:73], v[76:77]
    v_cvt_pk_bf16_f32 v12, v72, v73
    s_cbranch_scc1 L_pfast
    buffer_store_dword v12, v108, s[40:43], s101 offen sc1
L_pdone:
L_not1:
    s_waitcnt lgkmcnt(0)
    s_cmp_eq_u32 s39, 1
    s_cbranch_scc1 L_s_role
    s_endpgm
L_k_nopf:
    s_waitcnt vmcnt(3)
    s_bitcmp0_b32 s57, 22
    s_cbranch_scc1 L_sf_55
    s_waitcnt vmcnt(2)
    s_bitcmp0_b32 s58, 22
    s_cbranch_scc1 L_sf_55
    s_waitcnt vmcnt(1)
L_sf_55:
    buffer_load_dwordx4 v[128:131], v1, s[48:51], s97 offen offset:2048 nt
    v_min_u32 v39, 29, v0
    v_lshlrev_b32 v39, 2, v39
    buffer_load_dword v37, v39, s[44:47], 0 offen sc1
    s_waitcnt vmcnt(4)
    s_bitcmp0_b32 s57, 23
    s_cbranch_scc1 L_sf_56
    s_waitcnt vmcnt(3)
    s_bitcmp0_b32 s58, 23
    s_cbranch_scc1 L_sf_56
    s_waitcnt vmcnt(2)
L_sf_56:
    buffer_load_dwordx4 v[132:135], v1, s[48:51], s97 offen offset:3072 nt
    s_add_u32 s97, s97, 32768
    v_add_u32 v1, 4096, v1
    v_and_b32 v1, 0x7fff, v1
    s_waitcnt vmcnt(4)
    s_bitcmp0_b32 s57, 24
    s_cbranch_scc1 L_sf_57
    s_waitcnt vmcnt(3)
    s_bitcmp0_b32 s58, 24
    s_cbranch_scc1 L_sf_57
    s_waitcnt vmcnt(2)
L_sf_57:
    buffer_load_dwordx4 v[136:139], v1, s[48:51], s97 offen offset:0 nt
    s_waitcnt vmcnt(4)
    s_bitcmp0_b32 s57, 25
    s_cbranch_scc1 L_sf_58
    s_waitcnt vmcnt(3)
    s_bitcmp0_b32 s58, 25
    s_cbranch_scc1 L_sf_58
    s_waitcnt vmcnt(1)
L_sf_58:
    buffer_load_dwordx4 v[140:143], v1, s[48:51], s97 offen offset:1024 nt
    s_waitcnt vmcnt(4)
    s_bitcmp0_b32 s57, 26
    s_cbranch_scc1 L_sf_59
    s_waitcnt vmcnt(2)
    s_bitcmp0_b32 s58, 26
    s_cbranch_scc1 L_sf_59
    s_waitcnt vmcnt(1)
L_sf_59:
    buffer_load_dwordx4 v[144:147], v1, s[48:51], s97 offen offset:2048 nt
    s_waitcnt vmcnt(3)
    s_bitcmp0_b32 s57, 27
    s_cbranch_scc1 L_sf_60
    s_waitcnt vmcnt(2)
    s_bitcmp0_b32 s58, 27
    s_cbranch_scc1 L_sf_60
    s_waitcnt vmcnt(1)
L_sf_60:
    buffer_load_dwordx4 v[148:151], v1, s[48:51], s97 offen offset:3072 nt
    s_add_u32 s97, s97, 32768
    v_add_u32 v1, 4096, v1
    v_and_b32 v1, 0x7fff, v1
    v_cmp_eq_u32 vcc, 0, v37
    s_nop 0
    s_or_b32 s96, vcc_lo, vcc_hi
    buffer_load_dwordx4 v[4:7], v2, s[40:43], s98 offen sc1
    s_waitcnt vmcnt(4)
    s_bitcmp0_b32 s57, 28
    s_cbranch_scc1 L_sf_61
    s_waitcnt vmcnt(3)
    s_bitcmp0_b32 s58, 28
    s_cbranch_scc1 L_sf_61
    s_waitcnt vmcnt(2)
L_sf_61:
    buffer_load_dwordx4 v[152:155], v1, s[48:51], s97 offen offset:0 nt
    s_waitcnt vmcnt(4)
    s_bitcmp0_b32 s57, 29
    s_cbranch_scc1 L_sf_62
    s_waitcnt vmcnt(3)
    s_bitcmp0_b32 s58, 29
    s_cbranch_scc1 L_sf_62
    s_waitcnt vmcnt(2)
L_sf_62:
    buffer_load_dwordx4 v[156:159], v1, s[48:51], s97 offen offset:1024 nt
    s_waitcnt vmcnt(4)
    s_bitcmp0_b32 s57, 30
    s_cbranch_scc1 L_sf_63
    s_waitcnt vmcnt(3)
    s_bitcmp0_b32 s58, 30
    s_cbranch_scc1 L_sf_63
    s_waitcnt vmcnt(1)
L_sf_63:
    buffer_load_dwordx4 v[160:163], v1, s[48:51], s97 offen offset:2048 nt
    s_waitcnt vmcnt(4)
    s_bitcmp0_b32 s57, 31
    s_cbranch_scc1 L_sf_64
    s_waitcnt vmcnt(2)
    s_bitcmp0_b32 s58, 31
    s_cbranch_scc1 L_sf_64
    s_waitcnt vmcnt(1)
L_sf_64:
    buffer_load_dwordx4 v[164:167], v1, s[48:51], s97 offen offset:3072 nt
    s_mov_b32 s97, 0
    v_add_u32 v1, 4096, v1
    v_and_b32 v1, 0x7fff, v1
    v_add_u32 v1, 8192, v1
    v_and_b32 v1, 0x7fff, v1
    s_mov_b32 s97, 65536
    s_branch L_k_join
L_v_nopf:
    v_and_b32_dpp v24, v19, v20 row_newbcast:0 row_mask:0xf bank_mask:0xf
    v_and_b32_dpp v25, v19, v21 row_newbcast:0 row_mask:0xf bank_mask:0xf
    v_and_b32_dpp v26, v19, v22 row_newbcast:0 row_mask:0xf bank_mask:0xf
    v_and_b32_dpp v27, v19, v23 row_newbcast:0 row_mask:0xf bank_mask:0xf
    s_waitcnt vmcnt(3)
    s_bitcmp0_b32 s14, 0
    s_cbranch_scc1 L_sf_91
    s_waitcnt vmcnt(2)
    s_bitcmp0_b32 s15, 0
    s_cbranch_scc1 L_sf_91
    s_waitcnt vmcnt(1)
L_sf_91:
    buffer_load_dwordx4 v[40:43], v1, s[52:55], s97 offen offset:0 nt
    v_mfma_f32_16x16x32_bf16 v[32:35], v[24:27], v[152:155], v[32:35]
    v_and_b32_dpp v28, v19, v20 row_newbcast:8 row_mask:0xf bank_mask:0xf
    v_and_b32_dpp v29, v19, v21 row_newbcast:8 row_mask:0xf bank_mask:0xf
    v_and_b32_dpp v30, v19, v22 row_newbcast:8 row_mask:0xf bank_mask:0xf
    v_and_b32_dpp v31, v19, v23 row_newbcast:8 row_mask:0xf bank_mask:0xf
    s_waitcnt vmcnt(3)
    s_bitcmp0_b32 s14, 1
    s_cbranch_scc1 L_sf_92
    s_waitcnt vmcnt(2)
    s_bitcmp0_b32 s15, 1
    s_cbranch_scc1 L_sf_92
    s_waitcnt vmcnt(1)
L_sf_92:
    buffer_load_dwordx4 v[44:47], v1, s[52:55], s97 offen offset:1024 nt
    v_mfma_f32_16x16x32_bf16 v[32:35], v[28:31], v[156:159], v[32:35]
    v_and_b32_dpp v24, v19, v20 row_newbcast:4 row_mask:0xf bank_mask:0xf
    v_and_b32_dpp v25, v19, v21 row_newbcast:4 row_mask:0xf bank_mask:0xf
    v_and_b32_dpp v26, v19, v22 row_newbcast:4 row_mask:0xf bank_mask:0xf
    v_and_b32_dpp v27, v19, v23 row_newbcast:4 row_mask:0xf bank_mask:0xf
    s_waitcnt vmcnt(3)
    s_bitcmp0_b32 s14, 2
    s_cbranch_scc1 L_sf_93
    s_waitcnt vmcnt(2)
    s_bitcmp0_b32 s15, 2
    s_cbranch_scc1 L_sf_93
    s_waitcnt vmcnt(1)
L_sf_93:
    buffer_load_dwordx4 v[48:51], v1, s[52:55], s97 offen offset:2048 nt
    v_mfma_f32_16x16x32_bf16 v[32:35], v[24:27], v[160:163], v[32:35]
    v_and_b32_dpp v28, v19, v20 row_newbcast:12 row_mask:0xf bank_mask:0xf
    v_and_b32_dpp v29, v19, v21 row_newbcast:12 row_mask:0xf bank_mask:0xf
    v_and_b32_dpp v30, v19, v22 row_newbcast:12 row_mask:0xf bank_mask:0xf
    v_and_b32_dpp v31, v19, v23 row_newbcast:12 row_mask:0xf bank_mask:0xf
    s_waitcnt vmcnt(3)
    s_bitcmp0_b32 s14, 3
    s_cbranch_scc1 L_sf_94
    s_waitcnt vmcnt(2)
    s_bitcmp0_b32 s15, 3
    s_cbranch_scc1 L_sf_94
    s_waitcnt vmcnt(1)
L_sf_94:
    buffer_load_dwordx4 v[52:55], v1, s[52:55], s97 offen offset:3072 nt
    s_add_u32 s97, s97, 32768
    v_add_u32 v1, 4096, v1
    v_and_b32 v1, 0x7fff, v1
    v_mfma_f32_16x16x32_bf16 v[32:35], v[28:31], v[164:167], v[32:35]
    v_and_b32_dpp v24, v12, v20 row_newbcast:0 row_mask:0xf bank_mask:0xf
    v_and_b32_dpp v25, v12, v21 row_newbcast:0 row_mask:0xf bank_mask:0xf
    v_and_b32_dpp v26, v12, v22 row_newbcast:0 row_mask:0xf bank_mask:0xf
    v_and_b32_dpp v27, v12, v23 row_newbcast:0 row_mask:0xf bank_mask:0xf
    s_waitcnt vmcnt(3)
    s_bitcmp0_b32 s14, 4
    s_cbranch_scc1 L_sf_95
    s_waitcnt vmcnt(2)
    s_bitcmp0_b32 s15, 4
    s_cbranch_scc1 L_sf_95
    s_waitcnt vmcnt(1)
L_sf_95:
    buffer_load_dwordx4 v[56:59], v1, s[52:55], s97 offen offset:0 nt
    v_mfma_f32_16x16x32_bf16 v[32:35], v[24:27], v[40:43], v[32:35]
    v_and_b32_dpp v28, v12, v20 row_newbcast:8 row_mask:0xf bank_mask:0xf
    v_and_b32_dpp v29, v12, v21 row_newbcast:8 row_mask:0xf bank_mask:0xf
    v_and_b32_dpp v30, v12, v22 row_newbcast:8 row_mask:0xf bank_mask:0xf
    v_and_b32_dpp v31, v12, v23 row_newbcast:8 row_mask:0xf bank_mask:0xf
    s_waitcnt vmcnt(3)
    s_bitcmp0_b32 s14, 5
    s_cbranch_scc1 L_sf_96
    s_waitcnt vmcnt(2)
    s_bitcmp0_b32 s15, 5
    s_cbranch_scc1 L_sf_96
    s_waitcnt vmcnt(1)
L_sf_96:
    buffer_load_dwordx4 v[60:63], v1, s[52:55], s97 offen offset:1024 nt
    v_mfma_f32_16x16x32_bf16 v[32:35], v[28:31], v[44:47], v[32:35]
    v_and_b32_dpp v24, v12, v20 row_newbcast:4 row_mask:0xf bank_mask:0xf
    v_and_b32_dpp v25, v12, v21 row_newbcast:4 row_mask:0xf bank_mask:0xf
    v_and_b32_dpp v26, v12, v22 row_newbcast:4 row_mask:0xf bank_mask:0xf
    v_and_b32_dpp v27, v12, v23 row_newbcast:4 row_mask:0xf bank_mask:0xf
    s_waitcnt vmcnt(3)
    s_bitcmp0_b32 s14, 6
    s_cbranch_scc1 L_sf_97
    s_waitcnt vmcnt(2)
    s_bitcmp0_b32 s15, 6
    s_cbranch_scc1 L_sf_97
    s_waitcnt vmcnt(1)
L_sf_97:
    buffer_load_dwordx4 v[64:67], v1, s[52:55], s97 offen offset:2048 nt
    v_mfma_f32_16x16x32_bf16 v[32:35], v[24:27], v[48:51], v[32:35]
    v_and_b32_dpp v28, v12, v20 row_newbcast:12 row_mask:0xf bank_mask:0xf
    v_and_b32_dpp v29, v12, v21 row_newbcast:12 row_mask:0xf bank_mask:0xf
    v_and_b32_dpp v30, v12, v22 row_newbcast:12 row_mask:0xf bank_mask:0xf
    v_and_b32_dpp v31, v12, v23 row_newbcast:12 row_mask:0xf bank_mask:0xf
    s_waitcnt vmcnt(3)
    s_bitcmp0_b32 s14, 7
    s_cbranch_scc1 L_sf_98
    s_waitcnt vmcnt(2)
    s_bitcmp0_b32 s15, 7
    s_cbranch_scc1 L_sf_98
    s_waitcnt vmcnt(1)
L_sf_98:
    buffer_load_dwordx4 v[68:71], v1, s[52:55], s97 offen offset:3072 nt
    s_add_u32 s97, s97, 32768
    v_add_u32 v1, 4096, v1
    v_and_b32 v1, 0x7fff, v1
    v_mfma_f32_16x16x32_bf16 v[32:35], v[28:31], v[52:55], v[32:35]
    v_and_b32_dpp v24, v13, v20 row_newbcast:0 row_mask:0xf bank_mask:0xf
    v_and_b32_dpp v25, v13, v21 row_newbcast:0 row_mask:0xf bank_mask:0xf
    v_and_b32_dpp v26, v13, v22 row_newbcast:0 row_mask:0xf bank_mask:0xf
    v_and_b32_dpp v27, v13, v23 row_newbcast:0 row_mask:0xf bank_mask:0xf
    s_waitcnt vmcnt(3)
    s_nop 0
    v_mfma_f32_16x16x32_bf16 v[32:35], v[24:27], v[56:59], v[32:35]
    v_and_b32_dpp v28, v13, v20 row_newbcast:8 row_mask:0xf bank_mask:0xf
    v_and_b32_dpp v29, v13, v21 row_newbcast:8 row_mask:0xf bank_mask:0xf
    v_and_b32_dpp v30, v13, v22 row_newbcast:8 row_mask:0xf bank_mask:0xf
    v_and_b32_dpp v31, v13, v23 row_newbcast:8 row_mask:0xf bank_mask:0xf
    s_waitcnt vmcnt(2)
    s_nop 0
    v_mfma_f32_16x16x32_bf16 v[32:35], v[28:31], v[60:63], v[32:35]
    v_and_b32_dpp v24, v13, v20 row_newbcast:4 row_mask:0xf bank_mask:0xf
    v_and_b32_dpp v25, v13, v21 row_newbcast:4 row_mask:0xf bank_mask:0xf
    v_and_b32_dpp v26, v13, v22 row_newbcast:4 row_mask:0xf bank_mask:0xf
    v_and_b32_dpp v27, v13, v23 row_newbcast:4 row_mask:0xf bank_mask:0xf
    s_waitcnt vmcnt(1)
    s_nop 0
    v_mfma_f32_16x16x32_bf16 v[32:35], v[24:27], v[64:67], v[32:35]
    v_and_b32_dpp v28, v13, v20 row_newbcast:12 row_mask:0xf bank_mask:0xf
    v_and_b32_dpp v29, v13, v21 row_newbcast:12 row_mask:0xf bank_mask:0xf
    v_and_b32_dpp v30, v13, v22 row_newbcast:12 row_mask:0xf bank_mask:0xf
    v_and_b32_dpp v31, v13, v23 row_newbcast:12 row_mask:0xf bank_mask:0xf
    s_waitcnt vmcnt(0)
    s_nop 0
    v_mfma_f32_16x16x32_bf16 v[32:35], v[28:31], v[68:71], v[32:35]
    s_branch L_v_join
L_oslow:
    buffer_store_dword v32, v39, s[40:43], s98 offen sc1
    s_branch L_odone
L_qslow:
L_wy_100:
    buffer_load_dword v37, v39, s[44:47], 0 offen sc1
    s_waitcnt vmcnt(0)
    v_cmp_ne_u32 vcc, -1, v37
    s_cbranch_vccz L_wy_100e
    s_sleep 4
    s_sub_u32 s60, s60, 1
    s_cbranch_scc0 L_wy_100
    s_mov_b32 s60, 0
L_wy_100e:
L_qslow2:
    s_branch L_poll_101
L_poll_101s:
    s_sleep 2
L_poll_101:
    buffer_load_dwordx4 v[4:7], v2, s[40:43], s98 offen sc1
    s_sub_u32 s60, s60, 1
    s_cbranch_scc1 L_poll_101t
    s_waitcnt vmcnt(0)
    v_max3_u32 v38, v4, v5, v6
    v_max_u32 v38, v38, v7
    v_cmp_eq_u32 vcc, -1, v38
    s_cbranch_vccnz L_poll_101s
L_poll_101e:
    s_branch L_qok
L_mljob:
    s_lshl_b32 s96, s38, 3
    s_add_u32 s96, s96, s3
    s_lshl3_add_u32 s96, s96, s99
    buffer_store_dwordx2 v[8:9], v36, s[40:43], s96 offen sc1
    s_branch L_mldone
L_service:
    v_mov_b32 v72, 0
    v_mov_b32 v73, 0
    v_mov_b32 v74, 0
    v_mov_b32 v75, 0
    v_mov_b32 v76, 0
    s_mov_b32 s59, 0
    v_mov_b32 v5, 0
    v_mov_b32 v105, 0
    v_mov_b32 v108, 0
    v_mov_b32 v160, 0
    v_mov_b32 v8, 162068
L_lw_102:
    ds_read_b32 v9, v8
    s_waitcnt lgkmcnt(0)
    v_cmp_gt_u32 vcc, 8, v9
    s_cbranch_vccz L_lw_102e
    s_sleep 8
    s_sub_u32 s60, s60, 1
    s_cbranch_scc0 L_lw_102
    s_mov_b32 s60, 0
L_lw_102e:
    v_and_b32 v2, 15, v0
    v_lshlrev_b32 v2, 3, v2
    v_add_u32 v3, 161920, v2
    ds_read_b64 v[8:9], v3
    s_lshl_b32 s99, s37, 5
    s_add_u32 s99, s99, s36
    s_lshl_b32 s99, s99, 7
    s_add_u32 s99, s99, 73728
    s_lshl_b32 s62, s38, 6
    s_add_u32 s62, s62, s99
    s_getreg_b32 s58, hwreg(HW_REG_XCC_ID, 0, 4)
    v_mov_b32 v10, s58
    s_lshl_b32 s98, s34, 5
    s_add_u32 s98, s98, s35
    s_lshl_b32 s63, s98, 2
    s_add_u32 s63, s63, 229376
    s_lshl_b32 s98, s98, 8
    s_add_u32 s98, s98, 90112
    v_lshlrev_b32 v39, 2, v0
    s_bfm_b64 exec, 8, 0
    s_waitcnt lgkmcnt(0)
    buffer_store_dwordx2 v[8:9], v2, s[40:43], s62 offen sc1
    s_mov_b64 exec, 1
    buffer_store_dword v10, v36, s[40:43], s63 offen sc1
    s_mov_b64 exec, -1
    v_mov_b32 v12, 162076
L_lw_103:
    ds_read_b32 v13, v12
    s_waitcnt lgkmcnt(0)
    v_cmp_gt_u32 vcc, 4, v13
    s_cbranch_vccz L_lw_103e
    s_sleep 4
    s_sub_u32 s60, s60, 1
    s_cbranch_scc0 L_lw_103
    s_mov_b32 s60, 0
L_lw_103e:
    v_and_b32 v11, 31, v0
    v_lshlrev_b32 v11, 2, v11
    s_lshl_b32 s63, s34, 7
    s_add_u32 s63, s63, 229376
    buffer_load_dword v12, v39, s[40:43], s98 offen sc1
    s_branch L_poll_104
L_poll_104s:
    s_sleep 16
L_poll_104:
    buffer_load_dwordx2 v[8:9], v2, s[40:43], s99 offen sc1
    buffer_load_dword v10, v11, s[40:43], s63 offen sc1
    s_sub_u32 s60, s60, 1
    s_cbranch_scc1 L_poll_104t
    s_waitcnt vmcnt(0)
    v_max3_u32 v38, v8, v9, v10
    v_cmp_eq_u32 vcc, -1, v38
    s_cbranch_vccnz L_poll_104s
L_poll_104e:
    v_mov_b32 v37, v8
    s_nop 1
    v_max_f32_dpp v37, v37, v37 quad_perm:[1,0,3,2] row_mask:0xf bank_mask:0xf
    s_nop 1
    v_max_f32_dpp v37, v37, v37 quad_perm:[2,3,0,1] row_mask:0xf bank_mask:0xf
    s_nop 1
    v_max_f32_dpp v37, v37, v37 row_ror:4 row_mask:0xf bank_mask:0xf
    s_nop 1
    v_max_f32_dpp v37, v37, v37 row_ror:8 row_mask:0xf bank_mask:0xf
    v_sub_f32 v8, v8, v37
    v_exp_f32 v8, v8
    s_nop 0
    v_mul_f32 v9, v8, v9
    s_nop 1
    v_add_f32_dpp v9, v9, v9 quad_perm:[1,0,3,2] row_mask:0xf bank_mask:0xf
    s_nop 1
    v_add_f32_dpp v9, v9, v9 quad_perm:[2,3,0,1] row_mask:0xf bank_mask:0xf
    s_nop 1
    v_add_f32_dpp v9, v9, v9 row_ror:4 row_mask:0xf bank_mask:0xf
    s_nop 1
    v_add_f32_dpp v9, v9, v9 row_ror:8 row_mask:0xf bank_mask:0xf
    s_getreg_b32 s62, hwreg(HW_REG_XCC_ID, 0, 4)
    v_cmp_ne_u32 vcc, s62, v10
    s_nop 0
    s_cmp_eq_u64 vcc, 0
    s_cselect_b32 s61, 1, 0
    v_rcp_f32 v9, v9
    v_lshrrev_b32 v3, 1, v2
    v_add_u32 v3, 161984, v3
    v_mul_f32 v8, v8, v9
    v_mov_b32 v10, 162072
    v_mov_b32 v11, s61
    ds_write_b32 v3, v8
    ds_write_b32 v10, v11
    s_mov_b32 s3, 1
    v_lshrrev_b32 v9, 4, v0
    v_lshl_add_u32 v8, v9, 2, v2
    s_lshl_b32 s96, s3, 9
    s_add_u32 s96, s96, 157824
    v_lshl_add_u32 v8, v8, 2, s96
    v_lshlrev_b32 v9, 3, v0
    v_add_u32 v9, 157824, v9
    v_mov_b32 v10, 162048
    v_mov_b32 v11, 1
    s_lshl_b32 s96, s38, 5
    s_add_u32 s96, s96, 161984
    v_mov_b32 v3, s96
    s_sub_u32 s62, 8, s39
    s_lshl_b32 s98, s34, 5
    s_add_u32 s98, s98, s35
    s_lshl_b32 s98, s98, 8
    s_add_u32 s98, s98, 90112
    v_lshlrev_b32 v39, 2, v0
    s_branch L_t0b
L_jobend:
    v_lshrrev_b32 v9, 4, v0
    v_lshl_add_u32 v9, v9, 2, v2
    v_lshlrev_b32 v9, 2, v9
    s_mov_b32 exec_hi, 0
    s_nop 1
    buffer_store_dwordx4 v[32:35], v9, s[40:43], s13 offen sc1
    s_endpgm
L_proxy:
    v_mov_b32 v72, 0
    v_mov_b32 v73, 0
    v_mov_b32 v74, 0
    v_mov_b32 v75, 0
    v_mov_b32 v76, 0
    v_mov_b32 v5, 0
    v_mov_b32 v105, 0
    v_mov_b32 v108, 0
    v_mov_b32 v160, 0
    s_barrier
    s_waitcnt lgkmcnt(0)
    s_mov_b32 s40, s32
    s_mov_b32 s41, s33
    s_mov_b32 s42, 589824
    s_mov_b32 s43, 0x20000
    s_mov_b32 s44, s30
    s_mov_b32 s45, s31
    s_mov_b32 s46, 256
    s_mov_b32 s47, 0x20000
    s_sub_u32 s97, 7, s3
    s_mul_i32 s97, s97, 27
    s_cmp_eq_u32 s3, 5
    s_cselect_b32 s97, 32, s97
    s_add_u32 s97, s97, s35
    s_lshl_b32 s97, s97, 9
    s_add_u32 s97, s97, 196608
    v_and_b32 v2, 15, v0
    v_lshlrev_b32 v2, 3, v2
    v_bfe_u32 v20, v0, 4, 1
    v_lshl_add_u32 v20, v20, 2, v2
    v_lshlrev_b32 v20, 2, v20
    s_cmp_lg_u32 s3, 7
    s_cbranch_scc1 L_px6
    s_sub_u32 s96, 6, s59
    v_mov_b32 v8, 162068
L_lw_105:
    ds_read_b32 v9, v8
    s_waitcnt lgkmcnt(0)
    v_cmp_gt_u32 vcc, s96, v9
    s_cbranch_vccz L_lw_105e
    s_sleep 8
    s_sub_u32 s60, s60, 1
    s_cbranch_scc0 L_lw_105
    s_mov_b32 s60, 0
L_lw_105e:
    v_and_b32 v2, 15, v0
    v_lshlrev_b32 v2, 3, v2
    v_add_u32 v3, 161920, v2
    ds_read_b64 v[8:9], v3
    s_lshl_b32 s99, s37, 5
    s_add_u32 s99, s99, s36
    s_lshl_b32 s99, s99, 7
    s_add_u32 s99, s99, 73728
    s_lshl_b32 s62, s38, 6
    s_add_u32 s62, s62, s99
    s_getreg_b32 s58, hwreg(HW_REG_XCC_ID, 0, 4)
    v_mov_b32 v10, s58
    s_lshl_b32 s98, s34, 5
    s_add_u32 s98, s98, s35
    s_lshl_b32 s63, s98, 2
    s_add_u32 s63, s63, 229376
    s_lshl_b32 s98, s98, 8
    s_add_u32 s98, s98, 90112
    v_lshlrev_b32 v39, 2, v0
    s_bfm_b64 exec, s96, 0
    s_waitcnt lgkmcnt(0)
    buffer_store_dwordx2 v[8:9], v2, s[40:43], s62 offen sc1
    s_mov_b64 exec, 1
    buffer_store_dword v10, v36, s[40:43], s63 offen sc1
    s_mov_b64 exec, -1
    s_mov_b32 s100, 4
    s_lshl_b32 s63, s100, 8
    v_and_b32 v8, 15, v0
    v_lshl_add_u32 v8, v8, 4, s63
    v_lshrrev_b32 v9, 4, v0
    v_mul_u32_u24 v5, 1280, v9
    v_add_u32 v5, v5, v8
    v_mul_u32_u24 v4, 1296, v9
    v_add_u32 v4, v4, v8
    v_add_u32 v4, 81920, v4
    v_lshlrev_b32 v6, 1, v5
    v_add_u32 v6, 87104, v6
    s_lshl_b32 s62, s100, 3
    s_add_u32 s62, s62, 97344
    v_lshl_add_u32 v7, v9, 6, s62
    s_mov_b32 s48, s4
    s_mov_b32 s49, s5
    s_mov_b32 s50, 5120
    s_mov_b32 s51, 0x20000
    buffer_load_dwordx4 v[8:11], v5, s[48:51], 0 offen
    s_mov_b32 s62, 20480
    s_mov_b32 s63, 30720
    s_branch L_poll_106
L_poll_106s:
    s_sleep 32
L_poll_106:
    buffer_load_dwordx4 v[12:15], v5, s[40:43], s62 offen sc1
    buffer_load_dwordx4 v[16:19], v5, s[40:43], s63 offen sc1
    s_sub_u32 s60, s60, 1
    s_cbranch_scc1 L_poll_106t
    s_waitcnt vmcnt(0)
    v_max3_u32 v38, v12, v13, v14
    v_max3_u32 v38, v38, v15, v16
    v_max3_u32 v38, v38, v17, v18
    v_max_u32 v38, v38, v19
    v_cmp_eq_u32 vcc, -1, v38
    s_cbranch_vccnz L_poll_106s
L_poll_106e:
    v_lshlrev_b32 v40, 16, v8
    v_and_b32 v41, 0xffff0000, v8
    v_lshlrev_b32 v42, 16, v9
    v_and_b32 v43, 0xffff0000, v9
    v_lshlrev_b32 v44, 16, v10
    v_and_b32 v45, 0xffff0000, v10
    v_lshlrev_b32 v46, 16, v11
    v_and_b32 v47, 0xffff0000, v11
    v_lshlrev_b32 v48, 16, v12
    v_and_b32 v49, 0xffff0000, v12
    v_lshlrev_b32 v50, 16, v13
    v_and_b32 v51, 0xffff0000, v13
    v_lshlrev_b32 v52, 16, v14
    v_and_b32 v53, 0xffff0000, v14
    v_lshlrev_b32 v54, 16, v15
    v_and_b32 v55, 0xffff0000, v15
    v_lshlrev_b32 v56, 16, v16
    v_and_b32 v57, 0xffff0000, v16
    v_lshlrev_b32 v58, 16, v17
    v_and_b32 v59, 0xffff0000, v17
    v_lshlrev_b32 v60, 16, v18
    v_and_b32 v61, 0xffff0000, v18
    v_lshlrev_b32 v62, 16, v19
    v_and_b32 v63, 0xffff0000, v19
    v_mov_b32 v64, 0
    v_mov_b32 v65, 0
    v_mov_b32 v66, 0
    v_mov_b32 v67, 0
    v_mov_b32 v68, 0
    v_mov_b32 v69, 0
    v_mov_b32 v70, 0
    v_mov_b32 v71, 0
    v_bfe_u32 v5, v0, 2, 2
    v_lshlrev_b32 v5, 8, v5
    v_lshrrev_b32 v8, 4, v0
    v_lshl_add_u32 v5, v8, 6, v5
    v_and_b32 v8, 3, v0
    v_lshl_add_u32 v5, v8, 4, v5
    s_lshl_b32 s63, s100, 10
    v_add_u32 v5, s63, v5
    s_or_b32 s96, s59, s39
    s_cbranch_scc0 L_nofrag_107
    v_mov_b32 v104, 162060
L_lw_108:
    ds_read_b32 v105, v104
    s_waitcnt lgkmcnt(0)
    v_cmp_gt_u32 vcc, 4, v105
    s_cbranch_vccz L_lw_108e
    s_sleep 2
    s_sub_u32 s60, s60, 1
    s_cbranch_scc0 L_lw_108
    s_mov_b32 s60, 0
L_lw_108e:
    s_cmp_eq_u32 s59, 0
    s_cbranch_scc1 L_nofrag_107
    v_lshrrev_b32 v109, 4, v0
    v_bfe_u32 v104, v0, 1, 1
    v_lshl_add_u32 v104, v109, 1, v104
    v_bfe_u32 v110, v0, 2, 2
    v_lshl_add_u32 v104, v104, 3, v110
    v_lshlrev_b32 v104, 7, v104
    v_and_b32 v110, 1, v0
    v_lshl_add_u32 v104, v110, 3, v104
    s_lshr_b32 s63, s3, 1
    s_and_b32 s62, s3, 1
    s_lshl_b32 s96, s63, 14
    s_lshl_b32 s100, s62, 6
    s_add_u32 s100, s100, 81920
    s_add_u32 s96, s96, s100
    v_add_u32 v104, s96, v104
    ds_read_b64_tr_b16 v[72:73], v104 offset:0
    ds_read_b64_tr_b16 v[74:75], v104 offset:512
    ds_read_b64_tr_b16 v[76:77], v104 offset:16
    ds_read_b64_tr_b16 v[78:79], v104 offset:528
    ds_read_b64_tr_b16 v[80:81], v104 offset:32
    ds_read_b64_tr_b16 v[82:83], v104 offset:544
    ds_read_b64_tr_b16 v[84:85], v104 offset:48
    ds_read_b64_tr_b16 v[86:87], v104 offset:560
    ds_read_b64_tr_b16 v[88:89], v104 offset:8192
    ds_read_b64_tr_b16 v[90:91], v104 offset:8704
    ds_read_b64_tr_b16 v[92:93], v104 offset:8208
    ds_read_b64_tr_b16 v[94:95], v104 offset:8720
    ds_read_b64_tr_b16 v[96:97], v104 offset:8224
    ds_read_b64_tr_b16 v[98:99], v104 offset:8736
    ds_read_b64_tr_b16 v[100:101], v104 offset:8240
    ds_read_b64_tr_b16 v[102:103], v104 offset:8752
    v_bfe_u32 v105, v0, 1, 3
    v_lshlrev_b32 v105, 8, v105
    v_lshl_add_u32 v105, v109, 5, v105
    v_lshl_add_u32 v105, v110, 4, v105
    v_lshrrev_b32 v106, 3, v0
    v_lshlrev_b32 v106, 7, v106
    v_and_b32 v110, 7, v0
    v_lshl_add_u32 v107, v110, 3, v106
    v_add_u32 v107, s100, v107
    v_lshl_add_u32 v106, v110, 2, v106
    v_add_u32 v106, s96, v106
    v_lshlrev_b32 v108, 2, v0
    s_lshl_b32 s96, s62, 2
    s_add_u32 s96, s96, 162088
    v_mov_b32 v109, s96
    s_lshl_b32 s100, s63, 11
    s_lshl_b32 s96, s34, 13
    s_add_u32 s100, s100, s96
    s_add_u32 s100, s100, 90112
    s_mul_i32 s101, s34, 5120
    s_lshl_b32 s96, s35, 9
    s_add_u32 s101, s101, s96
    s_lshl_b32 s96, s62, 8
    s_add_u32 s101, s101, s96
    s_add_u32 s101, s101, 144384
L_nofrag_107:
    s_cmp_ge_u32 s35, 20
    s_cbranch_scc1 L_nofin_109
    s_lshl1_add_u32 s62, s35, s3
    s_sub_u32 s62, s62, 6
    s_lshl_b32 s57, s62, 7
    s_mul_i32 s63, s62, 0x199a
    s_lshr_b32 s63, s63, 16
    s_mul_i32 s63, s63, 1280
    s_sub_u32 s63, s57, s63
    v_lshrrev_b32 v72, 3, v0
    v_mul_u32_u24 v72, 5120, v72
    v_and_b32 v8, 7, v0
    v_lshl_add_u32 v72, v8, 4, v72
    s_add_u32 s62, s57, 262144
    v_add_u32 v72, s62, v72
    v_add_u32 v73, 40960, v72
    v_add_u32 v74, 81920, v72
    v_add_u32 v75, 122880, v72
    v_bfe_u32 v9, v0, 4, 1
    v_lshlrev_b32 v76, 4, v8
    v_lshl_add_u32 v76, v9, 3, v76
    s_lshl_b32 s62, s57, 1
    s_add_u32 s62, s62, 87104
    v_lshl_add_u32 v77, v76, 1, s62
    s_mov_b32 s48, s22
    s_mov_b32 s49, s23
    s_mov_b32 s50, 1280
    s_mov_b32 s51, 0x20000
    buffer_load_dwordx2 v[86:87], v76, s[48:51], s63 offen
    s_add_u32 s62, s57, 35840
    s_branch L_poll_110
L_poll_110s:
    s_sleep 32
L_poll_110:
    buffer_load_dwordx2 v[8:9], v76, s[40:43], s62 offen sc1
    s_sub_u32 s60, s60, 1
    s_cbranch_scc1 L_poll_110t
    s_waitcnt vmcnt(0)
    v_max_u32 v38, v8, v9
    v_cmp_eq_u32 vcc, -1, v38
    s_cbranch_vccnz L_poll_110s
L_poll_110e:
    v_lshlrev_b32 v78, 16, v86
    v_and_b32 v79, 0xffff0000, v86
    v_lshlrev_b32 v82, 16, v8
    v_and_b32 v83, 0xffff0000, v8
    v_lshlrev_b32 v80, 16, v87
    v_and_b32 v81, 0xffff0000, v87
    v_lshlrev_b32 v84, 16, v9
    v_and_b32 v85, 0xffff0000, v9
    v_bfe_u32 v8, v0, 1, 3
    v_and_b32 v9, 1, v0
    v_lshlrev_b32 v9, 4, v9
    v_mov_b32 v10, 0x3f80
    v_lshlrev_b32 v9, v9, v10
    v_cmp_eq_u32 vcc, 0, v8
    v_mov_b32 v100, 0
    s_nop 0
    v_cndmask_b32 v104, 0, v9, vcc
    v_cmp_eq_u32 vcc, 1, v8
    v_mov_b32 v101, 0
    s_nop 0
    v_cndmask_b32 v105, 0, v9, vcc
    v_cmp_eq_u32 vcc, 2, v8
    v_mov_b32 v102, 0
    s_nop 0
    v_cndmask_b32 v106, 0, v9, vcc
    v_cmp_eq_u32 vcc, 3, v8
    v_mov_b32 v103, 0
    s_nop 0
    v_cndmask_b32 v107, 0, v9, vcc
L_nofin_109:
    v_mov_b32 v12, 162076
L_lw_111:
    ds_read_b32 v13, v12
    s_waitcnt lgkmcnt(0)
    v_cmp_gt_u32 vcc, 4, v13
    s_cbranch_vccz L_lw_111e
    s_sleep 4
    s_sub_u32 s60, s60, 1
    s_cbranch_scc0 L_lw_111
    s_mov_b32 s60, 0
L_lw_111e:
    v_and_b32 v11, 31, v0
    v_lshlrev_b32 v11, 2, v11
    s_lshl_b32 s63, s34, 7
    s_add_u32 s63, s63, 229376
    buffer_load_dword v12, v39, s[40:43], s98 offen sc1
    s_branch L_poll_112
L_poll_112s:
    s_sleep 4
L_poll_112:
    buffer_load_dwordx2 v[8:9], v2, s[40:43], s99 offen sc1
    buffer_load_dword v10, v11, s[40:43], s63 offen sc1
    buffer_load_dwordx4 v[32:35], v20, s[40:43], s97 offen sc1
    s_sub_u32 s60, s60, 1
    s_cbranch_scc1 L_poll_112t
    s_waitcnt vmcnt(0)
    v_max3_u32 v38, v8, v9, v10
    v_max3_u32 v38, v38, v32, v33
    v_max3_u32 v38, v38, v34, v35
    v_cmp_eq_u32 vcc, -1, v38
    s_cbranch_vccnz L_poll_112s
L_poll_112e:
    v_mov_b32 v37, v8
    s_nop 1
    v_max_f32_dpp v37, v37, v37 quad_perm:[1,0,3,2] row_mask:0xf bank_mask:0xf
    s_nop 1
    v_max_f32_dpp v37, v37, v37 quad_perm:[2,3,0,1] row_mask:0xf bank_mask:0xf
    s_nop 1
    v_max_f32_dpp v37, v37, v37 row_ror:4 row_mask:0xf bank_mask:0xf
    s_nop 1
    v_max_f32_dpp v37, v37, v37 row_ror:8 row_mask:0xf bank_mask:0xf
    v_sub_f32 v8, v8, v37
    v_exp_f32 v8, v8
    s_nop 0
    v_mul_f32 v9, v8, v9
    s_nop 1
    v_add_f32_dpp v9, v9, v9 quad_perm:[1,0,3,2] row_mask:0xf bank_mask:0xf
    s_nop 1
    v_add_f32_dpp v9, v9, v9 quad_perm:[2,3,0,1] row_mask:0xf bank_mask:0xf
    s_nop 1
    v_add_f32_dpp v9, v9, v9 row_ror:4 row_mask:0xf bank_mask:0xf
    s_nop 1
    v_add_f32_dpp v9, v9, v9 row_ror:8 row_mask:0xf bank_mask:0xf
    s_getreg_b32 s62, hwreg(HW_REG_XCC_ID, 0, 4)
    v_cmp_ne_u32 vcc, s62, v10
    s_nop 0
    s_cmp_eq_u64 vcc, 0
    s_cselect_b32 s61, 1, 0
    v_rcp_f32 v9, v9
    v_lshrrev_b32 v3, 1, v2
    v_add_u32 v3, 161984, v3
    v_mul_f32 v8, v8, v9
    v_mov_b32 v10, 162072
    v_mov_b32 v11, s61
    ds_write_b32 v3, v8
    ds_write_b32 v10, v11
    s_branch L_pxj
L_px6:
    s_or_b32 s96, s59, s39
    s_cbranch_scc0 L_nofrag_113
    v_mov_b32 v104, 162060
L_lw_114:
    ds_read_b32 v105, v104
    s_waitcnt lgkmcnt(0)
    v_cmp_gt_u32 vcc, 4, v105
    s_cbranch_vccz L_lw_114e
    s_sleep 2
    s_sub_u32 s60, s60, 1
    s_cbranch_scc0 L_lw_114
    s_mov_b32 s60, 0
L_lw_114e:
    s_cmp_eq_u32 s59, 0
    s_cbranch_scc1 L_nofrag_113
    v_lshrrev_b32 v109, 4, v0
    v_bfe_u32 v104, v0, 1, 1
    v_lshl_add_u32 v104, v109, 1, v104
    v_bfe_u32 v110, v0, 2, 2
    v_lshl_add_u32 v104, v104, 3, v110
    v_lshlrev_b32 v104, 7, v104
    v_and_b32 v110, 1, v0
    v_lshl_add_u32 v104, v110, 3, v104
    s_lshr_b32 s63, s3, 1
    s_and_b32 s62, s3, 1
    s_lshl_b32 s96, s63, 14
    s_lshl_b32 s100, s62, 6
    s_add_u32 s100, s100, 81920
    s_add_u32 s96, s96, s100
    v_add_u32 v104, s96, v104
    ds_read_b64_tr_b16 v[72:73], v104 offset:0
    ds_read_b64_tr_b16 v[74:75], v104 offset:512
    ds_read_b64_tr_b16 v[76:77], v104 offset:16
    ds_read_b64_tr_b16 v[78:79], v104 offset:528
    ds_read_b64_tr_b16 v[80:81], v104 offset:32
    ds_read_b64_tr_b16 v[82:83], v104 offset:544
    ds_read_b64_tr_b16 v[84:85], v104 offset:48
    ds_read_b64_tr_b16 v[86:87], v104 offset:560
    ds_read_b64_tr_b16 v[88:89], v104 offset:8192
    ds_read_b64_tr_b16 v[90:91], v104 offset:8704
    ds_read_b64_tr_b16 v[92:93], v104 offset:8208
    ds_read_b64_tr_b16 v[94:95], v104 offset:8720
    ds_read_b64_tr_b16 v[96:97], v104 offset:8224
    ds_read_b64_tr_b16 v[98:99], v104 offset:8736
    ds_read_b64_tr_b16 v[100:101], v104 offset:8240
    ds_read_b64_tr_b16 v[102:103], v104 offset:8752
    v_bfe_u32 v105, v0, 1, 3
    v_lshlrev_b32 v105, 8, v105
    v_lshl_add_u32 v105, v109, 5, v105
    v_lshl_add_u32 v105, v110, 4, v105
    v_lshrrev_b32 v106, 3, v0
    v_lshlrev_b32 v106, 7, v106
    v_and_b32 v110, 7, v0
    v_lshl_add_u32 v107, v110, 3, v106
    v_add_u32 v107, s100, v107
    v_lshl_add_u32 v106, v110, 2, v106
    v_add_u32 v106, s96, v106
    v_lshlrev_b32 v108, 2, v0
    s_lshl_b32 s96, s62, 2
    s_add_u32 s96, s96, 162088
    v_mov_b32 v109, s96
    s_lshl_b32 s100, s63, 11
    s_lshl_b32 s96, s34, 13
    s_add_u32 s100, s100, s96
    s_add_u32 s100, s100, 90112
    s_mul_i32 s101, s34, 5120
    s_lshl_b32 s96, s35, 9
    s_add_u32 s101, s101, s96
    s_lshl_b32 s96, s62, 8
    s_add_u32 s101, s101, s96
    s_add_u32 s101, s101, 144384
L_nofrag_113:
    v_mov_b32 v8, 162068
L_lw_115:
    ds_read_b32 v9, v8
    s_waitcnt lgkmcnt(0)
    v_cmp_gt_u32 vcc, 1, v9
    s_cbranch_vccz L_lw_115e
    s_sleep 32
    s_sub_u32 s60, s60, 1
    s_cbranch_scc0 L_lw_115
    s_mov_b32 s60, 0
L_lw_115e:
    s_cmp_ge_u32 s35, 20
    s_cbranch_scc1 L_nofin_116
    s_lshl1_add_u32 s62, s35, s3
    s_sub_u32 s62, s62, 6
    s_lshl_b32 s57, s62, 7
    s_mul_i32 s63, s62, 0x199a
    s_lshr_b32 s63, s63, 16
    s_mul_i32 s63, s63, 1280
    s_sub_u32 s63, s57, s63
    v_lshrrev_b32 v72, 3, v0
    v_mul_u32_u24 v72, 5120, v72
    v_and_b32 v8, 7, v0
    v_lshl_add_u32 v72, v8, 4, v72
    s_add_u32 s62, s57, 262144
    v_add_u32 v72, s62, v72
    v_add_u32 v73, 40960, v72
    v_add_u32 v74, 81920, v72
    v_add_u32 v75, 122880, v72
    v_bfe_u32 v9, v0, 4, 1
    v_lshlrev_b32 v76, 4, v8
    v_lshl_add_u32 v76, v9, 3, v76
    s_lshl_b32 s62, s57, 1
    s_add_u32 s62, s62, 87104
    v_lshl_add_u32 v77, v76, 1, s62
    s_mov_b32 s48, s22
    s_mov_b32 s49, s23
    s_mov_b32 s50, 1280
    s_mov_b32 s51, 0x20000
    buffer_load_dwordx2 v[86:87], v76, s[48:51], s63 offen
    s_add_u32 s62, s57, 35840
    s_branch L_poll_117
L_poll_117s:
    s_sleep 32
L_poll_117:
    buffer_load_dwordx2 v[8:9], v76, s[40:43], s62 offen sc1
    s_sub_u32 s60, s60, 1
    s_cbranch_scc1 L_poll_117t
    s_waitcnt vmcnt(0)
    v_max_u32 v38, v8, v9
    v_cmp_eq_u32 vcc, -1, v38
    s_cbranch_vccnz L_poll_117s
L_poll_117e:
    v_lshlrev_b32 v78, 16, v86
    v_and_b32 v79, 0xffff0000, v86
    v_lshlrev_b32 v82, 16, v8
    v_and_b32 v83, 0xffff0000, v8
    v_lshlrev_b32 v80, 16, v87
    v_and_b32 v81, 0xffff0000, v87
    v_lshlrev_b32 v84, 16, v9
    v_and_b32 v85, 0xffff0000, v9
    v_bfe_u32 v8, v0, 1, 3
    v_and_b32 v9, 1, v0
    v_lshlrev_b32 v9, 4, v9
    v_mov_b32 v10, 0x3f80
    v_lshlrev_b32 v9, v9, v10
    v_cmp_eq_u32 vcc, 0, v8
    v_mov_b32 v100, 0
    s_nop 0
    v_cndmask_b32 v104, 0, v9, vcc
    v_cmp_eq_u32 vcc, 1, v8
    v_mov_b32 v101, 0
    s_nop 0
    v_cndmask_b32 v105, 0, v9, vcc
    v_cmp_eq_u32 vcc, 2, v8
    v_mov_b32 v102, 0
    s_nop 0
    v_cndmask_b32 v106, 0, v9, vcc
    v_cmp_eq_u32 vcc, 3, v8
    v_mov_b32 v103, 0
    s_nop 0
    v_cndmask_b32 v107, 0, v9, vcc
L_nofin_116:
    v_mov_b32 v8, 162076
L_lw_118:
    ds_read_b32 v9, v8
    s_waitcnt lgkmcnt(0)
    v_cmp_gt_u32 vcc, 4, v9
    s_cbranch_vccz L_lw_118e
    s_sleep 16
    s_sub_u32 s60, s60, 1
    s_cbranch_scc0 L_lw_118
    s_mov_b32 s60, 0
L_lw_118e:
    s_branch L_poll_119
L_poll_119s:
    s_sleep 4
L_poll_119:
    buffer_load_dwordx4 v[32:35], v20, s[40:43], s97 offen sc1
    s_sub_u32 s60, s60, 1
    s_cbranch_scc1 L_poll_119t
    s_waitcnt vmcnt(0)
    v_max3_u32 v38, v32, v33, v34
    v_max_u32 v38, v38, v35
    v_cmp_eq_u32 vcc, -1, v38
    s_cbranch_vccnz L_poll_119s
L_poll_119e:
L_pxj:
    s_cmp_ge_u32 s35, 20
    s_cbranch_scc1 L_pxk
    buffer_load_dwordx4 v[88:91], v72, s[40:43], 0 offen sc1
    buffer_load_dwordx4 v[92:95], v73, s[40:43], 0 offen sc1
    buffer_load_dwordx4 v[96:99], v74, s[40:43], 0 offen sc1
    s_mov_b64 exec, 0xffffff
    buffer_load_dwordx4 v[100:103], v75, s[40:43], 0 offen sc1
    s_mov_b64 exec, -1
L_pxk:
    v_mov_b32 v8, 162048
L_lw_120:
    ds_read_b32 v9, v8
    s_waitcnt lgkmcnt(0)
    v_cmp_gt_u32 vcc, 3, v9
    s_cbranch_vccz L_lw_120e
    s_sleep 2
    s_sub_u32 s60, s60, 1
    s_cbranch_scc0 L_lw_120
    s_mov_b32 s60, 0
L_lw_120e:
    v_lshrrev_b32 v9, 4, v0
    v_lshl_add_u32 v8, v9, 2, v2
    s_lshl_b32 s96, s3, 9
    s_add_u32 s96, s96, 157824
    v_lshl_add_u32 v8, v8, 2, s96
    v_lshlrev_b32 v9, 3, v0
    v_add_u32 v9, 157824, v9
    v_mov_b32 v10, 162048
    v_mov_b32 v11, 1
    s_lshl_b32 s96, s38, 5
    s_add_u32 s96, s96, 161984
    v_mov_b32 v3, s96
    s_sub_u32 s62, 8, s39
    s_lshl_b32 s98, s34, 5
    s_add_u32 s98, s98, s35
    s_lshl_b32 s98, s98, 8
    s_add_u32 s98, s98, 90112
    v_lshlrev_b32 v39, 2, v0
    s_branch L_t0
L_s_role:
    s_cmp_eq_u32 s3, 7
    s_cbranch_scc1 L_t2gate
    s_cmp_gt_u32 s3, 3
    s_cbranch_scc1 L_fin_prep
    s_mov_b32 s48, s18
    s_mov_b32 s49, s19
    s_mov_b32 s50, 3456
    s_mov_b32 s51, 0x20000
    v_lshrrev_b32 v3, 4, v0
    v_bfe_u32 v1, v0, 2, 2
    v_and_b32 v2, 3, v0
    v_lshl_add_u32 v4, v3, 2, v1
    v_lshlrev_b32 v4, 1, v4
    s_lshl_b32 s62, s35, 7
    s_lshl_b32 s63, s3, 5
    s_add_u32 s62, s62, s63
    buffer_load_ushort v82, v4, s[48:51], s62 offen
    v_mov_b32 v72, 162064
L_lw_121:
    ds_read_b32 v73, v72
    s_waitcnt lgkmcnt(0)
    v_cmp_gt_u32 vcc, 4, v73
    s_cbranch_vccz L_lw_121e
    s_sleep 2
    s_sub_u32 s60, s60, 1
    s_cbranch_scc0 L_lw_121
    s_mov_b32 s60, 0
L_lw_121e:
    v_lshrrev_b32 v72, 4, v0
    v_lshlrev_b32 v72, 10, v72
    v_bfe_u32 v73, v0, 2, 2
    v_lshl_add_u32 v72, v73, 7, v72
    v_and_b32 v73, 3, v0
    v_lshl_add_u32 v72, v73, 3, v72
    v_bfe_u32 v73, v0, 3, 2
    v_lshl_add_u32 v72, v73, 5, v72
    v_xor_b32 v72, s63, v72
    v_add_u32 v73, 40960, v72
    v_and_b32 v5, 7, v0
    v_mul_u32_u24 v5, 1296, v5
    v_lshl_add_u32 v5, v3, 4, v5
    v_add_u32 v5, 147456, v5
    ds_read_b64_tr_b16 v[88:89], v72 offset:0
    ds_read_b64_tr_b16 v[90:91], v72 offset:512
    ds_read_b64_tr_b16 v[92:93], v72 offset:4096
    ds_read_b64_tr_b16 v[94:95], v72 offset:4608
    ds_read_b64_tr_b16 v[96:97], v72 offset:8192
    ds_read_b64_tr_b16 v[98:99], v72 offset:8704
    ds_read_b64_tr_b16 v[100:101], v72 offset:12288
    ds_read_b64_tr_b16 v[102:103], v72 offset:12800
    ds_read_b64_tr_b16 v[104:105], v72 offset:16384
    ds_read_b64_tr_b16 v[106:107], v72 offset:16896
    ds_read_b64_tr_b16 v[108:109], v72 offset:20480
    ds_read_b64_tr_b16 v[110:111], v72 offset:20992
    ds_read_b64_tr_b16 v[112:113], v72 offset:24576
    ds_read_b64_tr_b16 v[114:115], v72 offset:25088
    ds_read_b64_tr_b16 v[116:117], v72 offset:28672
    ds_read_b64_tr_b16 v[118:119], v72 offset:29184
    ds_read_b64_tr_b16 v[120:121], v72 offset:32768
    ds_read_b64_tr_b16 v[122:123], v72 offset:33280
    ds_read_b64_tr_b16 v[124:125], v72 offset:36864
    ds_read_b64_tr_b16 v[126:127], v72 offset:37376
    ds_read_b64_tr_b16 v[128:129], v73 offset:0
    ds_read_b64_tr_b16 v[130:131], v73 offset:512
    ds_read_b64_tr_b16 v[132:133], v73 offset:4096
    ds_read_b64_tr_b16 v[134:135], v73 offset:4608
    ds_read_b64_tr_b16 v[136:137], v73 offset:8192
    ds_read_b64_tr_b16 v[138:139], v73 offset:8704
    ds_read_b64_tr_b16 v[140:141], v73 offset:12288
    ds_read_b64_tr_b16 v[142:143], v73 offset:12800
    ds_read_b64_tr_b16 v[144:145], v73 offset:16384
    ds_read_b64_tr_b16 v[146:147], v73 offset:16896
    ds_read_b64_tr_b16 v[148:149], v73 offset:20480
    ds_read_b64_tr_b16 v[150:151], v73 offset:20992
    ds_read_b64_tr_b16 v[152:153], v73 offset:24576
    ds_read_b64_tr_b16 v[154:155], v73 offset:25088
    ds_read_b64_tr_b16 v[156:157], v73 offset:28672
    ds_read_b64_tr_b16 v[158:159], v73 offset:29184
    ds_read_b64_tr_b16 v[160:161], v73 offset:32768
    ds_read_b64_tr_b16 v[162:163], v73 offset:33280
    ds_read_b64_tr_b16 v[164:165], v73 offset:36864
    ds_read_b64_tr_b16 v[166:167], v73 offset:37376
    ds_read_b128 v[8:11], v5 offset:0
    ds_read_b128 v[12:15], v5 offset:64
    ds_read_b128 v[16:19], v5 offset:128
    ds_read_b128 v[20:23], v5 offset:192
    ds_read_b128 v[24:27], v5 offset:256
    ds_read_b128 v[28:31], v5 offset:320
    ds_read_b128 v[32:35], v5 offset:384
    ds_read_b128 v[36:39], v5 offset:448
    ds_read_b128 v[40:43], v5 offset:512
    ds_read_b128 v[44:47], v5 offset:576
    s_waitcnt lgkmcnt(9)
    v_mfma_f32_16x16x32_bf16 v[48:51], v[88:91], v[8:11], 0
    s_waitcnt lgkmcnt(8)
    v_mfma_f32_16x16x32_bf16 v[48:51], v[92:95], v[12:15], v[48:51]
    s_waitcnt lgkmcnt(7)
    v_mfma_f32_16x16x32_bf16 v[48:51], v[96:99], v[16:19], v[48:51]
    s_waitcnt lgkmcnt(6)
    v_mfma_f32_16x16x32_bf16 v[48:51], v[100:103], v[20:23], v[48:51]
    s_waitcnt lgkmcnt(5)
    v_mfma_f32_16x16x32_bf16 v[48:51], v[104:107], v[24:27], v[48:51]
    s_waitcnt lgkmcnt(4)
    v_mfma_f32_16x16x32_bf16 v[48:51], v[108:111], v[28:31], v[48:51]
    s_waitcnt lgkmcnt(3)
    v_mfma_f32_16x16x32_bf16 v[48:51], v[112:115], v[32:35], v[48:51]
    s_waitcnt lgkmcnt(2)
    v_mfma_f32_16x16x32_bf16 v[48:51], v[116:119], v[36:39], v[48:51]
    s_waitcnt lgkmcnt(1)
    v_mfma_f32_16x16x32_bf16 v[48:51], v[120:123], v[40:43], v[48:51]
    s_waitcnt lgkmcnt(0)
    v_mfma_f32_16x16x32_bf16 v[48:51], v[124:127], v[44:47], v[48:51]
    ds_read_b128 v[8:11], v5 offset:640
    ds_read_b128 v[12:15], v5 offset:704
    ds_read_b128 v[16:19], v5 offset:768
    ds_read_b128 v[20:23], v5 offset:832
    ds_read_b128 v[24:27], v5 offset:896
    ds_read_b128 v[28:31], v5 offset:960
    ds_read_b128 v[32:35], v5 offset:1024
    ds_read_b128 v[36:39], v5 offset:1088
    ds_read_b128 v[40:43], v5 offset:1152
    ds_read_b128 v[44:47], v5 offset:1216
    s_waitcnt lgkmcnt(9)
    v_mfma_f32_16x16x32_bf16 v[48:51], v[128:131], v[8:11], v[48:51]
    s_waitcnt lgkmcnt(8)
    v_mfma_f32_16x16x32_bf16 v[48:51], v[132:135], v[12:15], v[48:51]
    s_waitcnt lgkmcnt(7)
    v_mfma_f32_16x16x32_bf16 v[48:51], v[136:139], v[16:19], v[48:51]
    s_waitcnt lgkmcnt(6)
    v_mfma_f32_16x16x32_bf16 v[48:51], v[140:143], v[20:23], v[48:51]
    s_waitcnt lgkmcnt(5)
    v_mfma_f32_16x16x32_bf16 v[48:51], v[144:147], v[24:27], v[48:51]
    s_waitcnt lgkmcnt(4)
    v_mfma_f32_16x16x32_bf16 v[48:51], v[148:151], v[28:31], v[48:51]
    s_waitcnt lgkmcnt(3)
    v_mfma_f32_16x16x32_bf16 v[48:51], v[152:155], v[32:35], v[48:51]
    s_waitcnt lgkmcnt(2)
    v_mfma_f32_16x16x32_bf16 v[48:51], v[156:159], v[36:39], v[48:51]
    s_waitcnt lgkmcnt(1)
    v_mfma_f32_16x16x32_bf16 v[48:51], v[160:163], v[40:43], v[48:51]
    s_waitcnt lgkmcnt(0)
    v_mfma_f32_16x16x32_bf16 v[48:51], v[164:167], v[44:47], v[48:51]
    v_mul_u32_u24 v79, 1296, v2
    v_lshl_add_u32 v79, v1, 6, v79
    v_lshl_add_u32 v79, v3, 4, v79
    v_add_u32 v79, 81920, v79
    v_mul_u32_u24 v80, 144, v2
    v_add3_u32 v80, v80, v4, s63
    v_add_u32 v80, 97600, v80
    v_lshlrev_b32 v81, 6, v2
    v_add_u32 v81, 97344, v81
    v_mov_b32_dpp v84, v48 quad_perm:[0,1,2,3] row_mask:0xf bank_mask:0x1
    v_mov_b32_dpp v85, v48 row_ror:4 row_mask:0xf bank_mask:0x1
    v_mov_b32_dpp v84, v49 row_ror:4 row_mask:0xf bank_mask:0x2
    v_mov_b32_dpp v85, v49 quad_perm:[0,1,2,3] row_mask:0xf bank_mask:0x2
    v_mov_b32_dpp v84, v50 quad_perm:[0,1,2,3] row_mask:0xf bank_mask:0x4
    v_mov_b32_dpp v85, v50 row_ror:4 row_mask:0xf bank_mask:0x4
    v_mov_b32_dpp v84, v51 row_ror:4 row_mask:0xf bank_mask:0x8
    v_mov_b32_dpp v85, v51 quad_perm:[0,1,2,3] row_mask:0xf bank_mask:0x8
    s_mov_b32 s62, 0xbacccccd
    s_mov_b32 s63, 0xbdd2d3e8
    v_mov_b32 v86, 0xc0135761
    s_branch L_ffn1
L_fin_prep:
    s_cmp_lg_u32 s3, 6
    s_cbranch_scc1 L_end
    s_cmp_ge_u32 s35, 20
    s_cbranch_scc1 L_end
    s_barrier
L_gbok:
    s_barrier
L_fin:
    s_mov_b32 s52, s28
    s_mov_b32 s53, s29
    s_mov_b32 s54, 5120
    s_mov_b32 s55, 0x20000
    s_mov_b64 s[4:5], -1
    s_mov_b64 s[6:7], -1
    s_mov_b64 s[8:9], -1
    s_mov_b64 s[10:11], 0xffffff
    s_barrier
    ds_read_b128 v[108:111], v77
    s_barrier
L_yg:
    s_mov_b64 exec, s[4:5]
    buffer_load_dwordx4 v[88:91], v72, s[40:43], 0 offen sc1
    s_mov_b64 exec, s[6:7]
    buffer_load_dwordx4 v[92:95], v73, s[40:43], 0 offen sc1
    s_mov_b64 exec, s[8:9]
    buffer_load_dwordx4 v[96:99], v74, s[40:43], 0 offen sc1
    s_mov_b64 exec, s[10:11]
    buffer_load_dwordx4 v[100:103], v75, s[40:43], 0 offen sc1
    s_mov_b64 exec, -1
    s_sub_u32 s60, s60, 1
    s_cbranch_scc1 L_ygt
    s_waitcnt vmcnt(3)
    v_max3_u32 v3, v88, v89, v90
    v_max_u32 v3, v3, v91
    v_cmp_eq_u32 s[4:5], -1, v3
    s_waitcnt vmcnt(2)
    v_max3_u32 v3, v92, v93, v94
    v_max_u32 v3, v3, v95
    v_cmp_eq_u32 s[6:7], -1, v3
    s_waitcnt vmcnt(1)
    v_max3_u32 v3, v96, v97, v98
    v_max_u32 v3, v3, v99
    v_cmp_eq_u32 s[8:9], -1, v3
    s_waitcnt vmcnt(0)
    v_max3_u32 v3, v100, v101, v102
    v_max_u32 v3, v3, v103
    v_cmp_eq_u32 s[10:11], -1, v3
    s_or_b64 s[16:17], s[4:5], s[6:7]
    s_or_b64 s[16:17], s[16:17], s[8:9]
    s_or_b64 s[16:17], s[16:17], s[10:11]
    s_cbranch_scc1 L_yg
L_ygd:
    v_mfma_f32_16x16x32_bf16 v[112:115], v[104:107], v[88:91], 0
    v_mfma_f32_16x16x32_bf16 v[112:115], v[104:107], v[92:95], v[112:115]
    v_mfma_f32_16x16x32_bf16 v[112:115], v[104:107], v[96:99], v[112:115]
    v_mfma_f32_16x16x32_bf16 v[112:115], v[104:107], v[100:103], v[112:115]
    s_waitcnt lgkmcnt(0)
    v_pk_fma_f32 v[108:109], v[78:79], v[82:83], v[108:109]
    v_pk_fma_f32 v[110:111], v[80:81], v[84:85], v[110:111]
    s_nop 4
    v_add_f32_dpp v112, v112, v112 row_ror:8 row_mask:0xf bank_mask:0xf
    v_add_f32_dpp v113, v113, v113 row_ror:8 row_mask:0xf bank_mask:0xf
    v_add_f32_dpp v114, v114, v114 row_ror:8 row_mask:0xf bank_mask:0xf
    v_add_f32_dpp v115, v115, v115 row_ror:8 row_mask:0xf bank_mask:0xf
    v_pk_fma_f32 v[112:113], v[112:113], v[82:83], v[108:109]
    v_pk_fma_f32 v[114:115], v[114:115], v[84:85], v[110:111]
    v_cvt_pk_bf16_f32 v112, v112, v113
    v_cvt_pk_bf16_f32 v113, v114, v115
    s_mov_b64 exec, 0x00ff00ff
    buffer_store_dwordx2 v[112:113], v76, s[52:55], s57 offen
    s_endpgm
L_t2gate:
    s_cmp_ge_u32 s35, 22
    s_cselect_b32 s62, 0, 0
    v_mov_b32 v8, 162088
L_lw_122:
    ds_read_b32 v9, v8
    s_waitcnt lgkmcnt(0)
    v_cmp_gt_u32 vcc, s62, v9
    s_cbranch_vccz L_lw_122e
    s_sleep 2
    s_sub_u32 s60, s60, 1
    s_cbranch_scc0 L_lw_122
    s_mov_b32 s60, 0
L_lw_122e:
    v_mov_b32 v8, 162048
L_lw_123:
    ds_read_b32 v9, v8
    s_waitcnt lgkmcnt(0)
    v_cmp_gt_u32 vcc, 8, v9
    s_cbranch_vccz L_lw_123e
    s_sleep 2
    s_sub_u32 s60, s60, 1
    s_cbranch_scc0 L_lw_123
    s_mov_b32 s60, 0
L_lw_123e:
    ds_read_b32 v9, v8 offset:24
    s_waitcnt lgkmcnt(0)
    v_readfirstlane_b32 s61, v9
    s_mov_b32 s58, 0x3f80
    s_mov_b32 s59, 0x3f800000
    s_mov_b32 s63, 0xff
L_prb:
    s_bcnt1_i32_b32 s62, s63
    s_mov_b32 s97, s63
    s_ff1_i32_b32 s12, s97
    s_bitset0_b32 s97, s12
    s_mul_i32 s4, s12, 5120
    s_add_u32 s4, s4, 155648
    s_cmp_eq_u32 s62, 1
    s_cbranch_scc1 L_pi1
    s_ff1_i32_b32 s13, s97
    s_bitset0_b32 s97, s13
    s_mul_i32 s5, s13, 5120
    s_add_u32 s5, s5, 155648
    s_cmp_eq_u32 s62, 2
    s_cbranch_scc1 L_pi2
    s_ff1_i32_b32 s14, s97
    s_bitset0_b32 s97, s14
    s_mul_i32 s6, s14, 5120
    s_add_u32 s6, s6, 155648
    s_cmp_eq_u32 s62, 3
    s_cbranch_scc1 L_pi3
    s_ff1_i32_b32 s15, s97
    s_bitset0_b32 s97, s15
    s_mul_i32 s7, s15, 5120
    s_add_u32 s7, s7, 155648
    s_cmp_eq_u32 s62, 4
    s_cbranch_scc1 L_pi4
    s_ff1_i32_b32 s16, s97
    s_bitset0_b32 s97, s16
    s_mul_i32 s8, s16, 5120
    s_add_u32 s8, s8, 155648
    s_cmp_eq_u32 s62, 5
    s_cbranch_scc1 L_pi5
    s_ff1_i32_b32 s17, s97
    s_bitset0_b32 s97, s17
    s_mul_i32 s9, s17, 5120
    s_add_u32 s9, s9, 155648
    s_cmp_eq_u32 s62, 6
    s_cbranch_scc1 L_pi6
    s_ff1_i32_b32 s18, s97
    s_bitset0_b32 s97, s18
    s_mul_i32 s10, s18, 5120
    s_add_u32 s10, s10, 155648
    s_cmp_eq_u32 s62, 7
    s_cbranch_scc1 L_pi7
    s_ff1_i32_b32 s19, s97
    s_bitset0_b32 s97, s19
    s_mul_i32 s11, s19, 5120
    s_add_u32 s11, s11, 155648
L_pi8:
    buffer_load_dwordx4 v[36:39], v5, s[40:43], s11 offen sc1
L_pi7:
    buffer_load_dwordx4 v[32:35], v5, s[40:43], s10 offen sc1
L_pi6:
    buffer_load_dwordx4 v[28:31], v5, s[40:43], s9 offen sc1
L_pi5:
    buffer_load_dwordx4 v[24:27], v5, s[40:43], s8 offen sc1
L_pi4:
    buffer_load_dwordx4 v[20:23], v5, s[40:43], s7 offen sc1
L_pi3:
    buffer_load_dwordx4 v[16:19], v5, s[40:43], s6 offen sc1
L_pi2:
    buffer_load_dwordx4 v[12:15], v5, s[40:43], s5 offen sc1
    buffer_load_dwordx4 v[8:11], v5, s[40:43], s4 offen sc1
    s_sub_u32 s60, s60, 1
    s_cbranch_scc1 L_pto
    s_waitcnt vmcnt(0)
    v_max3_u32 v3, v8, v9, v10
    v_max_u32 v3, v3, v11
    v_cmp_eq_u32 vcc, -1, v3
    s_cbranch_vccz L_pgot0
    v_max3_u32 v3, v12, v13, v14
    v_max_u32 v3, v3, v15
    v_cmp_eq_u32 vcc, -1, v3
    s_cbranch_vccz L_pgot1
    s_cmp_eq_u32 s62, 2
    s_cbranch_scc1 L_pi2
    v_max3_u32 v3, v16, v17, v18
    v_max_u32 v3, v3, v19
    v_cmp_eq_u32 vcc, -1, v3
    s_cbranch_vccz L_pgot2
    s_cmp_eq_u32 s62, 3
    s_cbranch_scc1 L_pi3
    v_max3_u32 v3, v20, v21, v22
    v_max_u32 v3, v3, v23
    v_cmp_eq_u32 vcc, -1, v3
    s_cbranch_vccz L_pgot3
    s_cmp_eq_u32 s62, 4
    s_cbranch_scc1 L_pi4
    v_max3_u32 v3, v24, v25, v26
    v_max_u32 v3, v3, v27
    v_cmp_eq_u32 vcc, -1, v3
    s_cbranch_vccz L_pgot4
    s_cmp_eq_u32 s62, 5
    s_cbranch_scc1 L_pi5
    v_max3_u32 v3, v28, v29, v30
    v_max_u32 v3, v3, v31
    v_cmp_eq_u32 vcc, -1, v3
    s_cbranch_vccz L_pgot5
    s_cmp_eq_u32 s62, 6
    s_cbranch_scc1 L_pi6
    v_max3_u32 v3, v32, v33, v34
    v_max_u32 v3, v3, v35
    v_cmp_eq_u32 vcc, -1, v3
    s_cbranch_vccz L_pgot6
    s_cmp_eq_u32 s62, 7
    s_cbranch_scc1 L_pi7
    v_max3_u32 v3, v36, v37, v38
    v_max_u32 v3, v3, v39
    v_cmp_eq_u32 vcc, -1, v3
    s_cbranch_vccz L_pgot7
    s_branch L_pi8
L_pgot0:
    v_dot2c_f32_bf16 v64, s58, v8
    v_dot2c_f32_bf16 v65, s59, v8
    v_dot2c_f32_bf16 v66, s58, v9
    v_dot2c_f32_bf16 v67, s59, v9
    v_dot2c_f32_bf16 v68, s58, v10
    v_dot2c_f32_bf16 v69, s59, v10
    v_dot2c_f32_bf16 v70, s58, v11
    v_dot2c_f32_bf16 v71, s59, v11
    s_bitset0_b32 s63, s12
    s_cmp_eq_u32 s63, 0
    s_cbranch_scc1 L_pgd
L_pn0:
    s_cmp_eq_u32 s62, 1
    s_cbranch_scc1 L_prb
    v_max3_u32 v3, v12, v13, v14
    v_max_u32 v3, v3, v15
    v_cmp_eq_u32 vcc, -1, v3
    s_cbranch_vccnz L_pn1
L_pgot1:
    v_dot2c_f32_bf16 v64, s58, v12
    v_dot2c_f32_bf16 v65, s59, v12
    v_dot2c_f32_bf16 v66, s58, v13
    v_dot2c_f32_bf16 v67, s59, v13
    v_dot2c_f32_bf16 v68, s58, v14
    v_dot2c_f32_bf16 v69, s59, v14
    v_dot2c_f32_bf16 v70, s58, v15
    v_dot2c_f32_bf16 v71, s59, v15
    s_bitset0_b32 s63, s13
    s_cmp_eq_u32 s63, 0
    s_cbranch_scc1 L_pgd
L_pn1:
    s_cmp_eq_u32 s62, 2
    s_cbranch_scc1 L_prb
    v_max3_u32 v3, v16, v17, v18
    v_max_u32 v3, v3, v19
    v_cmp_eq_u32 vcc, -1, v3
    s_cbranch_vccnz L_pn2
L_pgot2:
    v_dot2c_f32_bf16 v64, s58, v16
    v_dot2c_f32_bf16 v65, s59, v16
    v_dot2c_f32_bf16 v66, s58, v17
    v_dot2c_f32_bf16 v67, s59, v17
    v_dot2c_f32_bf16 v68, s58, v18
    v_dot2c_f32_bf16 v69, s59, v18
    v_dot2c_f32_bf16 v70, s58, v19
    v_dot2c_f32_bf16 v71, s59, v19
    s_bitset0_b32 s63, s14
    s_cmp_eq_u32 s63, 0
    s_cbranch_scc1 L_pgd
L_pn2:
    s_cmp_eq_u32 s62, 3
    s_cbranch_scc1 L_prb
    v_max3_u32 v3, v20, v21, v22
    v_max_u32 v3, v3, v23
    v_cmp_eq_u32 vcc, -1, v3
    s_cbranch_vccnz L_pn3
L_pgot3:
    v_dot2c_f32_bf16 v64, s58, v20
    v_dot2c_f32_bf16 v65, s59, v20
    v_dot2c_f32_bf16 v66, s58, v21
    v_dot2c_f32_bf16 v67, s59, v21
    v_dot2c_f32_bf16 v68, s58, v22
    v_dot2c_f32_bf16 v69, s59, v22
    v_dot2c_f32_bf16 v70, s58, v23
    v_dot2c_f32_bf16 v71, s59, v23
    s_bitset0_b32 s63, s15
    s_cmp_eq_u32 s63, 0
    s_cbranch_scc1 L_pgd
L_pn3:
    s_cmp_eq_u32 s62, 4
    s_cbranch_scc1 L_prb
    v_max3_u32 v3, v24, v25, v26
    v_max_u32 v3, v3, v27
    v_cmp_eq_u32 vcc, -1, v3
    s_cbranch_vccnz L_pn4
L_pgot4:
    v_dot2c_f32_bf16 v64, s58, v24
    v_dot2c_f32_bf16 v65, s59, v24
    v_dot2c_f32_bf16 v66, s58, v25
    v_dot2c_f32_bf16 v67, s59, v25
    v_dot2c_f32_bf16 v68, s58, v26
    v_dot2c_f32_bf16 v69, s59, v26
    v_dot2c_f32_bf16 v70, s58, v27
    v_dot2c_f32_bf16 v71, s59, v27
    s_bitset0_b32 s63, s16
    s_cmp_eq_u32 s63, 0
    s_cbranch_scc1 L_pgd
L_pn4:
    s_cmp_eq_u32 s62, 5
    s_cbranch_scc1 L_prb
    v_max3_u32 v3, v28, v29, v30
    v_max_u32 v3, v3, v31
    v_cmp_eq_u32 vcc, -1, v3
    s_cbranch_vccnz L_pn5
L_pgot5:
    v_dot2c_f32_bf16 v64, s58, v28
    v_dot2c_f32_bf16 v65, s59, v28
    v_dot2c_f32_bf16 v66, s58, v29
    v_dot2c_f32_bf16 v67, s59, v29
    v_dot2c_f32_bf16 v68, s58, v30
    v_dot2c_f32_bf16 v69, s59, v30
    v_dot2c_f32_bf16 v70, s58, v31
    v_dot2c_f32_bf16 v71, s59, v31
    s_bitset0_b32 s63, s17
    s_cmp_eq_u32 s63, 0
    s_cbranch_scc1 L_pgd
L_pn5:
    s_cmp_eq_u32 s62, 6
    s_cbranch_scc1 L_prb
    v_max3_u32 v3, v32, v33, v34
    v_max_u32 v3, v3, v35
    v_cmp_eq_u32 vcc, -1, v3
    s_cbranch_vccnz L_pn6
L_pgot6:
    v_dot2c_f32_bf16 v64, s58, v32
    v_dot2c_f32_bf16 v65, s59, v32
    v_dot2c_f32_bf16 v66, s58, v33
    v_dot2c_f32_bf16 v67, s59, v33
    v_dot2c_f32_bf16 v68, s58, v34
    v_dot2c_f32_bf16 v69, s59, v34
    v_dot2c_f32_bf16 v70, s58, v35
    v_dot2c_f32_bf16 v71, s59, v35
    s_bitset0_b32 s63, s18
    s_cmp_eq_u32 s63, 0
    s_cbranch_scc1 L_pgd
L_pn6:
    s_cmp_eq_u32 s62, 7
    s_cbranch_scc1 L_prb
    v_max3_u32 v3, v36, v37, v38
    v_max_u32 v3, v3, v39
    v_cmp_eq_u32 vcc, -1, v3
    s_cbranch_vccnz L_pn7
L_pgot7:
    v_dot2c_f32_bf16 v64, s58, v36
    v_dot2c_f32_bf16 v65, s59, v36
    v_dot2c_f32_bf16 v66, s58, v37
    v_dot2c_f32_bf16 v67, s59, v37
    v_dot2c_f32_bf16 v68, s58, v38
    v_dot2c_f32_bf16 v69, s59, v38
    v_dot2c_f32_bf16 v70, s58, v39
    v_dot2c_f32_bf16 v71, s59, v39
    s_bitset0_b32 s63, s19
    s_cmp_eq_u32 s63, 0
    s_cbranch_scc1 L_pgd
L_pn7:
    s_branch L_prb
L_pi1:
L_poll_124:
    buffer_load_dwordx4 v[8:11], v5, s[40:43], s4 offen sc1
    s_sub_u32 s60, s60, 1
    s_cbranch_scc1 L_poll_124t
    s_waitcnt vmcnt(0)
    v_max3_u32 v3, v8, v9, v10
    v_max_u32 v3, v3, v11
    v_cmp_eq_u32 vcc, -1, v3
    s_cbranch_vccnz L_poll_124
L_poll_124e:
    v_dot2c_f32_bf16 v64, s58, v8
    v_dot2c_f32_bf16 v65, s59, v8
    v_dot2c_f32_bf16 v66, s58, v9
    v_dot2c_f32_bf16 v67, s59, v9
    v_dot2c_f32_bf16 v68, s58, v10
    v_dot2c_f32_bf16 v69, s59, v10
    v_dot2c_f32_bf16 v70, s58, v11
    v_dot2c_f32_bf16 v71, s59, v11
L_pgd:
    v_pk_fma_f32 v[64:65], v[64:65], v[48:49], v[40:41]
    v_pk_fma_f32 v[66:67], v[66:67], v[50:51], v[42:43]
    v_pk_fma_f32 v[68:69], v[68:69], v[52:53], v[44:45]
    v_pk_fma_f32 v[70:71], v[70:71], v[54:55], v[46:47]
    v_pk_mul_f32 v[56:57], v[64:65], v[56:57]
    v_pk_mul_f32 v[58:59], v[66:67], v[58:59]
    v_pk_mul_f32 v[60:61], v[68:69], v[60:61]
    v_pk_mul_f32 v[62:63], v[70:71], v[62:63]
    v_cvt_pk_bf16_f32 v8, v56, v57
    v_cvt_pk_bf16_f32 v9, v58, v59
    v_cvt_pk_bf16_f32 v10, v60, v61
    v_cvt_pk_bf16_f32 v11, v62, v63
    ds_write_b128 v4, v[8:11]
    v_pk_add_f32 v[40:41], v[64:65], v[66:67]
    v_pk_add_f32 v[42:43], v[68:69], v[70:71]
    v_pk_mul_f32 v[44:45], v[64:65], v[64:65]
    v_pk_mul_f32 v[46:47], v[66:67], v[66:67]
    v_pk_add_f32 v[40:41], v[40:41], v[42:43]
    v_pk_fma_f32 v[44:45], v[68:69], v[68:69], v[44:45]
    v_pk_fma_f32 v[46:47], v[70:71], v[70:71], v[46:47]
    s_waitcnt lgkmcnt(0)
    s_barrier
    v_add_f32 v8, v40, v41
    v_pk_add_f32 v[44:45], v[44:45], v[46:47]
    v_add_f32 v9, v44, v45
    v_add_f32_dpp v8, v8, v8 quad_perm:[1,0,3,2] row_mask:0xf bank_mask:0xf
    s_nop 0
    v_add_f32_dpp v9, v9, v9 quad_perm:[1,0,3,2] row_mask:0xf bank_mask:0xf
    v_add_f32_dpp v8, v8, v8 quad_perm:[2,3,0,1] row_mask:0xf bank_mask:0xf
    s_nop 0
    v_add_f32_dpp v9, v9, v9 quad_perm:[2,3,0,1] row_mask:0xf bank_mask:0xf
    v_add_f32_dpp v8, v8, v8 row_ror:4 row_mask:0xf bank_mask:0xf
    s_nop 0
    v_add_f32_dpp v9, v9, v9 row_ror:4 row_mask:0xf bank_mask:0xf
    v_add_f32_dpp v8, v8, v8 row_ror:8 row_mask:0xf bank_mask:0xf
    s_nop 0
    v_add_f32_dpp v9, v9, v9 row_ror:8 row_mask:0xf bank_mask:0xf
    ds_write_b64 v7, v[8:9]
    s_waitcnt lgkmcnt(0)
    s_barrier
    ds_write_b128 v6, v[64:67]
    ds_write_b128 v6, v[68:71] offset:16
    s_waitcnt vmcnt(0) lgkmcnt(0)
    s_cmp_lg_u32 s3, 7
    s_cbranch_scc1 L_ffn2
    s_cmp_lt_u32 s35, 20
    s_cbranch_scc1 L_fin
    s_endpgm
L_ffn1:
    s_barrier
    ds_read_b128 v[8:11], v79 offset:0
    ds_read_b128 v[12:15], v79 offset:256
    ds_read_b128 v[16:19], v79 offset:512
    ds_read_b128 v[20:23], v79 offset:768
    ds_read_b128 v[24:27], v79 offset:1024
    s_waitcnt vmcnt(0)
    v_lshlrev_b32 v82, 16, v82
    v_add_f32 v85, v85, v82
    s_waitcnt lgkmcnt(4)
    v_mfma_f32_16x16x32_bf16 v[32:35], v[88:91], v[8:11], 0
    v_mfma_f32_16x16x32_bf16 v[36:39], v[92:95], v[8:11], 0
    v_mfma_f32_16x16x32_bf16 v[40:43], v[96:99], v[8:11], 0
    v_mfma_f32_16x16x32_bf16 v[44:47], v[100:103], v[8:11], 0
    s_waitcnt lgkmcnt(3)
    v_mfma_f32_16x16x32_bf16 v[32:35], v[104:107], v[12:15], v[32:35]
    v_mfma_f32_16x16x32_bf16 v[36:39], v[108:111], v[12:15], v[36:39]
    v_mfma_f32_16x16x32_bf16 v[40:43], v[112:115], v[12:15], v[40:43]
    v_mfma_f32_16x16x32_bf16 v[44:47], v[116:119], v[12:15], v[44:47]
    s_waitcnt lgkmcnt(2)
    v_mfma_f32_16x16x32_bf16 v[32:35], v[120:123], v[16:19], v[32:35]
    v_mfma_f32_16x16x32_bf16 v[36:39], v[124:127], v[16:19], v[36:39]
    v_mfma_f32_16x16x32_bf16 v[40:43], v[128:131], v[16:19], v[40:43]
    v_mfma_f32_16x16x32_bf16 v[44:47], v[132:135], v[16:19], v[44:47]
    s_waitcnt lgkmcnt(1)
    s_barrier
    ds_read_b128 v[48:51], v81
    ds_read_b128 v[52:55], v81 offset:16
    ds_read_b64 v[56:57], v81 offset:32
    v_mfma_f32_16x16x32_bf16 v[32:35], v[136:139], v[20:23], v[32:35]
    v_mfma_f32_16x16x32_bf16 v[36:39], v[140:143], v[20:23], v[36:39]
    v_mfma_f32_16x16x32_bf16 v[40:43], v[144:147], v[20:23], v[40:43]
    v_mfma_f32_16x16x32_bf16 v[44:47], v[148:151], v[20:23], v[44:47]
    s_waitcnt lgkmcnt(3)
    v_mfma_f32_16x16x32_bf16 v[32:35], v[152:155], v[24:27], v[32:35]
    v_mfma_f32_16x16x32_bf16 v[36:39], v[156:159], v[24:27], v[36:39]
    s_waitcnt lgkmcnt(0)
    v_pk_add_f32 v[48:49], v[48:49], v[50:51]
    v_pk_add_f32 v[52:53], v[52:53], v[54:55]
    v_mfma_f32_16x16x32_bf16 v[40:43], v[160:163], v[24:27], v[40:43]
    v_pk_add_f32 v[48:49], v[48:49], v[56:57]
    v_pk_add_f32 v[48:49], v[48:49], v[52:53]
    v_mfma_f32_16x16x32_bf16 v[44:47], v[164:167], v[24:27], v[44:47]
    v_mul_f32 v48, s62, v48
    v_mul_f32 v49, s62, v49
    v_mul_f32 v7, v84, v48
    v_fma_f32 v49, -v48, v48, -v49
    v_max_f32 v49, 0, v49
    v_add_f32 v49, 0x3727c5ac, v49
    v_rsq_f32 v49, v49
    v_add_f32_dpp v5, v36, v7 row_ror:12 row_mask:0xf bank_mask:0x1
    v_add_f32_dpp v5, v41, v7 row_ror:12 row_mask:0xf bank_mask:0x2
    v_add_f32_dpp v5, v46, v7 row_ror:12 row_mask:0xf bank_mask:0x4
    v_add_f32_dpp v5, v35, v7 row_ror:12 row_mask:0xf bank_mask:0x8
    v_add_f32_dpp v4, v40, v32 row_ror:8 row_mask:0xf bank_mask:0x1
    v_add_f32_dpp v4, v45, v37 row_ror:8 row_mask:0xf bank_mask:0x2
    v_add_f32_dpp v4, v34, v42 row_ror:8 row_mask:0xf bank_mask:0x4
    v_add_f32_dpp v4, v39, v47 row_ror:8 row_mask:0xf bank_mask:0x8
    v_add_f32_dpp v6, v44, v5 row_ror:4 row_mask:0xf bank_mask:0x1
    v_add_f32_dpp v6, v33, v5 row_ror:4 row_mask:0xf bank_mask:0x2
    v_add_f32_dpp v6, v38, v5 row_ror:4 row_mask:0xf bank_mask:0x4
    v_add_f32_dpp v6, v43, v5 row_ror:4 row_mask:0xf bank_mask:0x8
    v_add_f32 v4, v4, v6
    v_fma_f32 v4, v4, v49, v85
    v_mul_f32 v5, v4, v4
    v_fma_f32 v5, v5, s63, v86
    v_mul_f32 v5, v5, v4
    v_exp_f32 v5, v5
    s_nop 0
    v_add_f32 v5, 1.0, v5
    v_rcp_f32 v5, v5
    s_nop 0
    v_mul_f32 v4, v4, v5
    v_cvt_pk_bf16_f32 v4, v4, v4
    ds_write_b16 v80, v4
    s_waitcnt lgkmcnt(0)
    s_barrier
    s_endpgm
L_h_t1:
    s_cmp_lg_u32 s3, 3
    s_cbranch_scc1 L_h_noclr
    s_sub_u32 s62, s56, 154
    s_cmp_lt_u32 s62, 30
    s_cbranch_scc0 L_h_noclr
    s_lshl_b32 s63, s62, 2
    s_mul_i32 s62, s62, 7168
    s_add_u32 s62, s62, 20480
    v_mov_b32 v4, -1
    v_mov_b32 v5, -1
    v_mov_b32 v6, -1
    v_mov_b32 v7, -1
    v_lshlrev_b32 v8, 4, v0
    buffer_store_dwordx4 v[4:7], v8, s[40:43], s62 offen offset:0 sc1
    buffer_store_dwordx4 v[4:7], v8, s[40:43], s62 offen offset:1024 sc1
    buffer_store_dwordx4 v[4:7], v8, s[40:43], s62 offen offset:2048 sc1
    buffer_store_dwordx4 v[4:7], v8, s[40:43], s62 offen offset:3072 sc1
    s_add_u32 s62, s62, 4096
    buffer_store_dwordx4 v[4:7], v8, s[40:43], s62 offen offset:0 sc1
    buffer_store_dwordx4 v[4:7], v8, s[40:43], s62 offen offset:1024 sc1
    buffer_store_dwordx4 v[4:7], v8, s[40:43], s62 offen offset:2048 sc1
    v_mov_b32 v8, s63
    s_waitcnt vmcnt(0)
    s_mov_b64 exec, 1
    buffer_store_dword v4, v8, s[44:47], 0 offen sc1
    s_mov_b64 exec, -1
L_h_noclr:
    v_lshrrev_b32 v1, 3, v0
    v_mul_u32_u24 v1, 1280, v1
    v_and_b32 v2, 7, v0
    v_lshl_add_u32 v1, v2, 4, v1
    s_lshl2_add_u32 s63, s34, s3
    s_mul_i32 s63, s63, 163840
    s_lshl_b32 s62, s35, 7
    s_add_u32 s63, s63, s62
    s_sub_u32 s63, s63, 2816
    s_lshl_b32 s62, s3, 14
    s_add_u32 s62, s62, 81920
    s_mov_b32 m0, s62
    s_mov_b32 s48, s12
    s_mov_b32 s49, s13
    s_mov_b32 s50, 5242880
    s_mov_b32 s51, 0x20000
    s_add_u32 s100, s39, 1
    s_mov_b32 s62, 8
L_dma_5:
    buffer_load_dwordx4 v1, s[48:51], s63 offen nt lds
    s_add_u32 m0, m0, 1024
    s_add_u32 s63, s63, 10240
    s_cmp_eq_u32 s100, 0
    s_cbranch_scc1 L_dma_5n0
    s_waitcnt vmcnt(7)
    s_cmp_eq_u32 s100, 2
    s_cbranch_scc1 L_dma_5n0
    s_waitcnt vmcnt(3)
L_dma_5n0:
    buffer_load_dwordx4 v1, s[48:51], s63 offen nt lds
    s_add_u32 m0, m0, 1024
    s_add_u32 s63, s63, 10240
    s_cmp_eq_u32 s100, 0
    s_cbranch_scc1 L_dma_5n1
    s_waitcnt vmcnt(7)
    s_cmp_eq_u32 s100, 2
    s_cbranch_scc1 L_dma_5n1
    s_waitcnt vmcnt(3)
L_dma_5n1:
    s_sub_u32 s62, s62, 1
    s_cmp_lg_u32 s62, 0
    s_cbranch_scc1 L_dma_5
    s_cmp_eq_u32 s39, 1
    s_cbranch_scc1 L_h_role
    s_waitcnt vmcnt(0)
    v_mov_b32 v4, 162060
    v_mov_b32 v5, 1
    s_mov_b64 exec, 1
    ds_add_u32 v4, v5
    s_mov_b64 exec, -1
    s_cmp_eq_u32 s3, 0
    s_cbranch_scc1 L_service
    s_endpgm
L_h_role:
    v_mov_b32 v72, 0
    v_mov_b32 v73, 0
    v_mov_b32 v74, 0
    v_mov_b32 v75, 0
    v_mov_b32 v76, 0
    v_lshrrev_b32 v3, 4, v0
    v_and_b32 v2, 3, v0
    v_bfe_u32 v1, v0, 2, 2
    v_mul_u32_u24 v160, 1280, v2
    v_lshl_add_u32 v160, v1, 5, v160
    v_lshl_add_u32 v160, v3, 3, v160
    s_mul_i32 s57, s35, 5120
    s_mul_i32 s62, s3, 320
    s_add_u32 s57, s57, s62
    s_add_u32 s57, s57, 262144
    v_mov_b32 v4, -1
    v_mov_b32 v5, -1
    v_mov_b32 v6, -1
    v_mov_b32 v7, -1
    v_lshlrev_b32 v8, 4, v0
    s_mul_i32 s62, s3, 960
    s_add_u32 s62, s62, s57
    buffer_store_dwordx4 v[4:7], v8, s[40:43], s62 offen sc1
    s_mov_b64 exec, 0xffff
    buffer_store_dwordx4 v[4:7], v8, s[40:43], s62 offen offset:1024 sc1
    s_mov_b64 exec, -1
    v_add_u32 v8, 0, v0
    v_mul_u32_u24 v10, 0xccd, v8
    v_lshrrev_b32 v10, 16, v10
    v_mul_u32_u24 v9, 20, v10
    v_sub_u32 v8, v8, v9
    v_mul_u32_u24 v10, 1280, v10
    v_lshl_add_u32 v10, v8, 4, v10
    v_add_u32 v8, 64, v0
    v_mul_u32_u24 v11, 0xccd, v8
    v_lshrrev_b32 v11, 16, v11
    v_mul_u32_u24 v9, 20, v11
    v_sub_u32 v8, v8, v9
    v_mul_u32_u24 v11, 1280, v11
    v_lshl_add_u32 v11, v8, 4, v11
    v_add_u32 v8, 128, v0
    v_mul_u32_u24 v12, 0xccd, v8
    v_lshrrev_b32 v12, 16, v12
    v_mul_u32_u24 v9, 20, v12
    v_sub_u32 v8, v8, v9
    v_mul_u32_u24 v12, 1280, v12
    v_lshl_add_u32 v12, v8, 4, v12
    v_add_u32 v8, 192, v0
    v_mul_u32_u24 v13, 0xccd, v8
    v_lshrrev_b32 v13, 16, v13
    v_mul_u32_u24 v9, 20, v13
    v_sub_u32 v8, v8, v9
    v_mul_u32_u24 v13, 1280, v13
    v_lshl_add_u32 v13, v8, 4, v13
    v_add_u32 v8, 256, v0
    v_mul_u32_u24 v14, 0xccd, v8
    v_lshrrev_b32 v14, 16, v14
    v_mul_u32_u24 v9, 20, v14
    v_sub_u32 v8, v8, v9
    v_mul_u32_u24 v14, 1280, v14
    v_lshl_add_u32 v14, v8, 4, v14
    s_waitcnt vmcnt(0)
    v_mov_b32 v8, 162060
    v_mov_b32 v9, 1
    s_mov_b64 exec, 1
    ds_add_u32 v8, v9
    s_mov_b64 exec, -1
    s_mov_b32 s48, s20
    s_mov_b32 s49, s21
    s_mov_b32 s50, 2211840
    s_mov_b32 s51, 0x20000
    s_mul_i32 s63, s35, 81920
    s_mul_i32 s62, s3, 320
    s_add_u32 s63, s63, s62
    s_mov_b32 m0, s101
    s_mov_b32 s62, 4
L_w2dma:
    buffer_load_dwordx4 v10, s[48:51], s63 offen nt lds
    s_add_u32 m0, m0, 1024
    s_waitcnt vmcnt(7)
    s_cmp_ge_u32 s35, 22
    s_cbranch_scc1 L_w2n0
    s_waitcnt vmcnt(7)
L_w2n0:
    buffer_load_dwordx4 v11, s[48:51], s63 offen nt lds
    s_add_u32 m0, m0, 1024
    s_waitcnt vmcnt(7)
    s_cmp_ge_u32 s35, 22
    s_cbranch_scc1 L_w2n1
    s_waitcnt vmcnt(7)
L_w2n1:
    buffer_load_dwordx4 v12, s[48:51], s63 offen nt lds
    s_add_u32 m0, m0, 1024
    s_waitcnt vmcnt(7)
    s_cmp_ge_u32 s35, 22
    s_cbranch_scc1 L_w2n2
    s_waitcnt vmcnt(7)
L_w2n2:
    buffer_load_dwordx4 v13, s[48:51], s63 offen nt lds
    s_add_u32 m0, m0, 1024
    s_waitcnt vmcnt(7)
    s_cmp_ge_u32 s35, 22
    s_cbranch_scc1 L_w2n3
    s_waitcnt vmcnt(7)
L_w2n3:
    buffer_load_dwordx4 v14, s[48:51], s63 offen nt lds
    s_add_u32 m0, m0, 1024
    s_waitcnt vmcnt(7)
    s_cmp_ge_u32 s35, 22
    s_cbranch_scc1 L_w2n4
    s_waitcnt vmcnt(7)
L_w2n4:
    s_add_u32 s63, s63, 20480
    s_sub_u32 s62, s62, 1
    s_cmp_lg_u32 s62, 0
    s_cbranch_scc1 L_w2dma
    v_lshl_add_u32 v8, v3, 3, v1
    v_mul_u32_u24 v8, 320, v8
    v_lshl_add_u32 v8, v2, 3, v8
    v_add_u32 v8, s101, v8
    s_waitcnt vmcnt(0)
    ds_read_b64_tr_b16 v[80:81], v8 offset:0
    ds_read_b64_tr_b16 v[82:83], v8 offset:1280
    ds_read_b64_tr_b16 v[84:85], v8 offset:10240
    ds_read_b64_tr_b16 v[86:87], v8 offset:11520
    ds_read_b64_tr_b16 v[88:89], v8 offset:32
    ds_read_b64_tr_b16 v[90:91], v8 offset:1312
    ds_read_b64_tr_b16 v[92:93], v8 offset:10272
    ds_read_b64_tr_b16 v[94:95], v8 offset:11552
    ds_read_b64_tr_b16 v[96:97], v8 offset:64
    ds_read_b64_tr_b16 v[98:99], v8 offset:1344
    ds_read_b64_tr_b16 v[100:101], v8 offset:10304
    ds_read_b64_tr_b16 v[102:103], v8 offset:11584
    ds_read_b64_tr_b16 v[104:105], v8 offset:96
    ds_read_b64_tr_b16 v[106:107], v8 offset:1376
    ds_read_b64_tr_b16 v[108:109], v8 offset:10336
    ds_read_b64_tr_b16 v[110:111], v8 offset:11616
    ds_read_b64_tr_b16 v[112:113], v8 offset:128
    ds_read_b64_tr_b16 v[114:115], v8 offset:1408
    ds_read_b64_tr_b16 v[116:117], v8 offset:10368
    ds_read_b64_tr_b16 v[118:119], v8 offset:11648
    ds_read_b64_tr_b16 v[120:121], v8 offset:160
    ds_read_b64_tr_b16 v[122:123], v8 offset:1440
    ds_read_b64_tr_b16 v[124:125], v8 offset:10400
    ds_read_b64_tr_b16 v[126:127], v8 offset:11680
    ds_read_b64_tr_b16 v[128:129], v8 offset:192
    ds_read_b64_tr_b16 v[130:131], v8 offset:1472
    ds_read_b64_tr_b16 v[132:133], v8 offset:10432
    ds_read_b64_tr_b16 v[134:135], v8 offset:11712
    ds_read_b64_tr_b16 v[136:137], v8 offset:224
    ds_read_b64_tr_b16 v[138:139], v8 offset:1504
    ds_read_b64_tr_b16 v[140:141], v8 offset:10464
    ds_read_b64_tr_b16 v[142:143], v8 offset:11744
    ds_read_b64_tr_b16 v[144:145], v8 offset:256
    ds_read_b64_tr_b16 v[146:147], v8 offset:1536
    ds_read_b64_tr_b16 v[148:149], v8 offset:10496
    ds_read_b64_tr_b16 v[150:151], v8 offset:11776
    ds_read_b64_tr_b16 v[152:153], v8 offset:288
    ds_read_b64_tr_b16 v[154:155], v8 offset:1568
    ds_read_b64_tr_b16 v[156:157], v8 offset:10528
    ds_read_b64_tr_b16 v[158:159], v8 offset:11808
    s_mov_b32 s48, s16
    s_mov_b32 s49, s17
    s_mov_b32 s50, 2211840
    s_mov_b32 s51, 0x20000
    s_lshl_b32 s98, s35, 7
    s_mov_b32 s99, 3456
    v_lshrrev_b32 v9, 3, v0
    v_mul_lo_u32 v10, v9, s99
    v_and_b32 v9, 2, v9
    v_xor_b32 v9, v9, v0
    v_and_b32 v9, 7, v9
    v_lshl_add_u32 v10, v9, 4, v10
    v_add_u32 v10, s98, v10
    v_xor_b32 v11, 64, v10
    s_mul_i32 s63, s3, 552960
    s_mov_b32 m0, s101
    s_waitcnt lgkmcnt(0)
    s_cmp_ge_u32 s35, 22
    s_cselect_b32 s100, 2, 1
    s_mov_b32 s62, 10
L_dma_6:
    buffer_load_dwordx4 v10, s[48:51], s63 offen nt lds
    s_add_u32 m0, m0, 1024
    s_add_u32 s63, s63, 27648
    s_cmp_eq_u32 s100, 0
    s_cbranch_scc1 L_dma_6n0
    s_waitcnt vmcnt(7)
    s_cmp_eq_u32 s100, 2
    s_cbranch_scc1 L_dma_6n0
    s_waitcnt vmcnt(7)
L_dma_6n0:
    buffer_load_dwordx4 v11, s[48:51], s63 offen nt lds
    s_add_u32 m0, m0, 1024
    s_add_u32 s63, s63, 27648
    s_cmp_eq_u32 s100, 0
    s_cbranch_scc1 L_dma_6n1
    s_waitcnt vmcnt(7)
    s_cmp_eq_u32 s100, 2
    s_cbranch_scc1 L_dma_6n1
    s_waitcnt vmcnt(7)
L_dma_6n1:
    s_sub_u32 s62, s62, 1
    s_cmp_lg_u32 s62, 0
    s_cbranch_scc1 L_dma_6
    v_mov_b32 v8, 162068
L_lw_7:
    ds_read_b32 v9, v8
    s_waitcnt lgkmcnt(0)
    v_cmp_gt_u32 vcc, 1, v9
    s_cbranch_vccz L_lw_7e
    s_sleep 8
    s_sub_u32 s60, s60, 1
    s_cbranch_scc0 L_lw_7
    s_mov_b32 s60, 0
L_lw_7e:
    s_cmp_lg_u32 s3, 3
    s_cbranch_scc1 L_h_nomo
    v_and_b32 v4, 15, v0
    v_lshlrev_b32 v4, 4, v4
    v_mul_u32_u24 v5, 1280, v3
    v_add_u32 v5, v5, v4
    v_mul_u32_u24 v6, 1296, v3
    v_add_u32 v6, v6, v4
    v_add_u32 v6, 147456, v6
    s_mov_b32 s62, 30720
    s_mov_b32 s63, 25600
    s_branch L_poll_8
L_poll_8s:
    s_sleep 8
L_poll_8:
    buffer_load_dwordx4 v[40:43], v5, s[40:43], s62 offen offset:0 sc1
    buffer_load_dwordx4 v[44:47], v5, s[40:43], s62 offen offset:256 sc1
    buffer_load_dwordx4 v[48:51], v5, s[40:43], s62 offen offset:512 sc1
    buffer_load_dwordx4 v[52:55], v5, s[40:43], s62 offen offset:768 sc1
    buffer_load_dwordx4 v[56:59], v5, s[40:43], s62 offen offset:1024 sc1
    buffer_load_dwordx4 v[60:63], v5, s[40:43], s63 offen offset:0 sc1
    buffer_load_dwordx4 v[64:67], v5, s[40:43], s63 offen offset:256 sc1
    buffer_load_dwordx4 v[68:71], v5, s[40:43], s63 offen offset:512 sc1
    buffer_load_dwordx4 v[72:75], v5, s[40:43], s63 offen offset:768 sc1
    buffer_load_dwordx4 v[76:79], v5, s[40:43], s63 offen offset:1024 sc1
    s_sub_u32 s60, s60, 1
    s_cbranch_scc1 L_poll_8t
    s_waitcnt vmcnt(0)
    v_max3_u32 v7, v40, v41, v42
    v_max3_u32 v7, v7, v43, v44
    v_max3_u32 v7, v7, v45, v46
    v_max3_u32 v7, v7, v47, v48
    v_max3_u32 v7, v7, v49, v50
    v_max3_u32 v7, v7, v51, v52
    v_max3_u32 v7, v7, v53, v54
    v_max3_u32 v7, v7, v55, v56
    v_max3_u32 v7, v7, v57, v58
    v_max3_u32 v7, v7, v59, v60
    v_max3_u32 v7, v7, v61, v62
    v_max3_u32 v7, v7, v63, v64
    v_max3_u32 v7, v7, v65, v66
    v_max3_u32 v7, v7, v67, v68
    v_max3_u32 v7, v7, v69, v70
    v_max3_u32 v7, v7, v71, v72
    v_max3_u32 v7, v7, v73, v74
    v_max3_u32 v7, v7, v75, v76
    v_max3_u32 v7, v7, v77, v78
    v_max_u32 v7, v7, v79
    v_cmp_eq_u32 vcc, -1, v7
    s_cbranch_vccnz L_poll_8s
L_poll_8e:
    ds_write_b128 v6, v[40:43] offset:0
    ds_write_b128 v6, v[44:47] offset:256
    ds_write_b128 v6, v[48:51] offset:512
    ds_write_b128 v6, v[52:55] offset:768
    ds_write_b128 v6, v[56:59] offset:1024
    ds_write_b128 v6, v[60:63] offset:5184
    ds_write_b128 v6, v[64:67] offset:5440
    ds_write_b128 v6, v[68:71] offset:5696
    ds_write_b128 v6, v[72:75] offset:5952
    ds_write_b128 v6, v[76:79] offset:6208
L_h_nomo:
    v_mul_u32_u24 v4, 144, v2
    v_lshl_add_u32 v4, v3, 4, v4
    v_add_u32 v161, 97600, v4
    s_mov_b32 s100, s3
    s_lshl_b32 s63, s100, 8
    v_and_b32 v8, 15, v0
    v_lshl_add_u32 v8, v8, 4, s63
    v_lshrrev_b32 v9, 4, v0
    v_mul_u32_u24 v5, 1280, v9
    v_add_u32 v5, v5, v8
    v_mul_u32_u24 v4, 1296, v9
    v_add_u32 v4, v4, v8
    v_add_u32 v4, 81920, v4
    v_lshlrev_b32 v6, 1, v5
    v_add_u32 v6, 87104, v6
    s_lshl_b32 s62, s100, 3
    s_add_u32 s62, s62, 97344
    v_lshl_add_u32 v7, v9, 6, s62
    s_mov_b32 s48, s4
    s_mov_b32 s49, s5
    s_mov_b32 s50, 5120
    s_mov_b32 s51, 0x20000
    buffer_load_dwordx4 v[8:11], v5, s[48:51], 0 offen
    s_mov_b32 s62, 20480
    s_mov_b32 s63, 30720
    s_branch L_poll_9
L_poll_9s:
    s_sleep 8
L_poll_9:
    buffer_load_dwordx4 v[12:15], v5, s[40:43], s62 offen sc1
    buffer_load_dwordx4 v[16:19], v5, s[40:43], s63 offen sc1
    s_sub_u32 s60, s60, 1
    s_cbranch_scc1 L_poll_9t
    s_waitcnt vmcnt(0)
    v_max3_u32 v38, v12, v13, v14
    v_max3_u32 v38, v38, v15, v16
    v_max3_u32 v38, v38, v17, v18
    v_max_u32 v38, v38, v19
    v_cmp_eq_u32 vcc, -1, v38
    s_cbranch_vccnz L_poll_9s
L_poll_9e:
    v_lshlrev_b32 v40, 16, v8
    v_and_b32 v41, 0xffff0000, v8
    v_lshlrev_b32 v42, 16, v9
    v_and_b32 v43, 0xffff0000, v9
    v_lshlrev_b32 v44, 16, v10
    v_and_b32 v45, 0xffff0000, v10
    v_lshlrev_b32 v46, 16, v11
    v_and_b32 v47, 0xffff0000, v11
    v_lshlrev_b32 v48, 16, v12
    v_and_b32 v49, 0xffff0000, v12
    v_lshlrev_b32 v50, 16, v13
    v_and_b32 v51, 0xffff0000, v13
    v_lshlrev_b32 v52, 16, v14
    v_and_b32 v53, 0xffff0000, v14
    v_lshlrev_b32 v54, 16, v15
    v_and_b32 v55, 0xffff0000, v15
    v_lshlrev_b32 v56, 16, v16
    v_and_b32 v57, 0xffff0000, v16
    v_lshlrev_b32 v58, 16, v17
    v_and_b32 v59, 0xffff0000, v17
    v_lshlrev_b32 v60, 16, v18
    v_and_b32 v61, 0xffff0000, v18
    v_lshlrev_b32 v62, 16, v19
    v_and_b32 v63, 0xffff0000, v19
    v_mov_b32 v64, 0
    v_mov_b32 v65, 0
    v_mov_b32 v66, 0
    v_mov_b32 v67, 0
    v_mov_b32 v68, 0
    v_mov_b32 v69, 0
    v_mov_b32 v70, 0
    v_mov_b32 v71, 0
    v_bfe_u32 v5, v0, 2, 2
    v_lshlrev_b32 v5, 8, v5
    v_lshrrev_b32 v8, 4, v0
    v_lshl_add_u32 v5, v8, 6, v5
    v_and_b32 v8, 3, v0
    v_lshl_add_u32 v5, v8, 4, v5
    s_lshl_b32 s63, s100, 10
    v_add_u32 v5, s63, v5
    s_waitcnt vmcnt(0) lgkmcnt(0)
    v_mov_b32 v8, 162064
    v_mov_b32 v9, 1
    s_mov_b64 exec, 1
    ds_add_u32 v8, v9
    s_mov_b64 exec, -1
    s_branch L_t2gate
L_ffn2:
    s_barrier
    ds_read_b128 v[8:11], v161
    ds_read_b128 v[12:15], v161 offset:64
    s_cmp_eq_u32 s61, 1
    s_cbranch_scc0 L_f2slow
    s_waitcnt lgkmcnt(1)
    v_mfma_f32_16x16x32_bf16 v[16:19], v[80:83], v[8:11], 0
    v_mfma_f32_16x16x32_bf16 v[20:23], v[88:91], v[8:11], 0
    v_mfma_f32_16x16x32_bf16 v[24:27], v[96:99], v[8:11], 0
    v_mfma_f32_16x16x32_bf16 v[28:31], v[104:107], v[8:11], 0
    s_waitcnt lgkmcnt(0)
    v_mfma_f32_16x16x32_bf16 v[16:19], v[84:87], v[12:15], v[16:19]
    v_mfma_f32_16x16x32_bf16 v[20:23], v[92:95], v[12:15], v[20:23]
    v_mfma_f32_16x16x32_bf16 v[24:27], v[100:103], v[12:15], v[24:27]
    v_mfma_f32_16x16x32_bf16 v[28:31], v[108:111], v[12:15], v[28:31]
    v_mfma_f32_16x16x32_bf16 v[32:35], v[112:115], v[8:11], 0
    v_mfma_f32_16x16x32_bf16 v[36:39], v[120:123], v[8:11], 0
    v_mfma_f32_16x16x32_bf16 v[40:43], v[128:131], v[8:11], 0
    v_mfma_f32_16x16x32_bf16 v[44:47], v[136:139], v[8:11], 0
    v_mfma_f32_16x16x32_bf16 v[32:35], v[116:119], v[12:15], v[32:35]
    v_mfma_f32_16x16x32_bf16 v[36:39], v[124:127], v[12:15], v[36:39]
    v_mfma_f32_16x16x32_bf16 v[40:43], v[132:135], v[12:15], v[40:43]
    v_mfma_f32_16x16x32_bf16 v[44:47], v[140:143], v[12:15], v[44:47]
    v_mfma_f32_16x16x32_bf16 v[48:51], v[144:147], v[8:11], 0
    v_mov_b32_dpp v16, v20 quad_perm:[0,1,2,3] row_mask:0xf bank_mask:0x2
    v_mov_b32_dpp v17, v21 quad_perm:[0,1,2,3] row_mask:0xf bank_mask:0x2
    v_mov_b32_dpp v18, v22 quad_perm:[0,1,2,3] row_mask:0xf bank_mask:0x2
    v_mfma_f32_16x16x32_bf16 v[52:55], v[152:155], v[8:11], 0
    v_mov_b32_dpp v19, v23 quad_perm:[0,1,2,3] row_mask:0xf bank_mask:0x2
    v_mov_b32_dpp v16, v24 quad_perm:[0,1,2,3] row_mask:0xf bank_mask:0x4
    v_mov_b32_dpp v17, v25 quad_perm:[0,1,2,3] row_mask:0xf bank_mask:0x4
    v_mfma_f32_16x16x32_bf16 v[48:51], v[148:151], v[12:15], v[48:51]
    v_mov_b32_dpp v18, v26 quad_perm:[0,1,2,3] row_mask:0xf bank_mask:0x4
    v_mov_b32_dpp v19, v27 quad_perm:[0,1,2,3] row_mask:0xf bank_mask:0x4
    v_mov_b32_dpp v16, v28 quad_perm:[0,1,2,3] row_mask:0xf bank_mask:0x8
    v_mfma_f32_16x16x32_bf16 v[52:55], v[156:159], v[12:15], v[52:55]
    v_mov_b32_dpp v17, v29 quad_perm:[0,1,2,3] row_mask:0xf bank_mask:0x8
    v_mov_b32_dpp v18, v30 quad_perm:[0,1,2,3] row_mask:0xf bank_mask:0x8
    v_mov_b32_dpp v19, v31 quad_perm:[0,1,2,3] row_mask:0xf bank_mask:0x8
    v_cvt_pk_bf16_f32 v16, v16, v17
    v_cvt_pk_bf16_f32 v17, v18, v19
    buffer_store_dwordx2 v[16:17], v160, s[40:43], s57 offen
    v_mov_b32_dpp v32, v36 quad_perm:[0,1,2,3] row_mask:0xf bank_mask:0x2
    v_mov_b32_dpp v33, v37 quad_perm:[0,1,2,3] row_mask:0xf bank_mask:0x2
    v_mov_b32_dpp v34, v38 quad_perm:[0,1,2,3] row_mask:0xf bank_mask:0x2
    v_mov_b32_dpp v35, v39 quad_perm:[0,1,2,3] row_mask:0xf bank_mask:0x2
    v_mov_b32_dpp v32, v40 quad_perm:[0,1,2,3] row_mask:0xf bank_mask:0x4
    v_mov_b32_dpp v33, v41 quad_perm:[0,1,2,3] row_mask:0xf bank_mask:0x4
    v_mov_b32_dpp v34, v42 quad_perm:[0,1,2,3] row_mask:0xf bank_mask:0x4
    v_mov_b32_dpp v35, v43 quad_perm:[0,1,2,3] row_mask:0xf bank_mask:0x4
    v_mov_b32_dpp v32, v44 quad_perm:[0,1,2,3] row_mask:0xf bank_mask:0x8
    v_mov_b32_dpp v33, v45 quad_perm:[0,1,2,3] row_mask:0xf bank_mask:0x8
    v_mov_b32_dpp v34, v46 quad_perm:[0,1,2,3] row_mask:0xf bank_mask:0x8
    v_mov_b32_dpp v35, v47 quad_perm:[0,1,2,3] row_mask:0xf bank_mask:0x8
    v_cvt_pk_bf16_f32 v32, v32, v33
    v_cvt_pk_bf16_f32 v33, v34, v35
    buffer_store_dwordx2 v[32:33], v160, s[40:43], s57 offen offset:128
    v_mov_b32_dpp v48, v52 quad_perm:[0,1,2,3] row_mask:0xf bank_mask:0x2
    v_mov_b32_dpp v49, v53 quad_perm:[0,1,2,3] row_mask:0xf bank_mask:0x2
    v_mov_b32_dpp v50, v54 quad_perm:[0,1,2,3] row_mask:0xf bank_mask:0x2
    v_mov_b32_dpp v51, v55 quad_perm:[0,1,2,3] row_mask:0xf bank_mask:0x2
    v_cvt_pk_bf16_f32 v48, v48, v49
    v_cvt_pk_bf16_f32 v49, v50, v51
    s_mov_b32 exec_lo, 0x00ff00ff
    s_mov_b32 exec_hi, 0x00ff00ff
    buffer_store_dwordx2 v[48:49], v160, s[40:43], s57 offen offset:256
L_f2done:
    s_barrier
    s_endpgm
L_f2slow:
    s_waitcnt lgkmcnt(1)
    v_mfma_f32_16x16x32_bf16 v[16:19], v[80:83], v[8:11], 0
    v_mfma_f32_16x16x32_bf16 v[20:23], v[88:91], v[8:11], 0
    v_mfma_f32_16x16x32_bf16 v[24:27], v[96:99], v[8:11], 0
    v_mfma_f32_16x16x32_bf16 v[28:31], v[104:107], v[8:11], 0
    s_waitcnt lgkmcnt(0)
    v_mfma_f32_16x16x32_bf16 v[16:19], v[84:87], v[12:15], v[16:19]
    v_mfma_f32_16x16x32_bf16 v[20:23], v[92:95], v[12:15], v[20:23]
    v_mfma_f32_16x16x32_bf16 v[24:27], v[100:103], v[12:15], v[24:27]
    v_mfma_f32_16x16x32_bf16 v[28:31], v[108:111], v[12:15], v[28:31]
    v_mfma_f32_16x16x32_bf16 v[32:35], v[112:115], v[8:11], 0
    v_mfma_f32_16x16x32_bf16 v[36:39], v[120:123], v[8:11], 0
    v_mfma_f32_16x16x32_bf16 v[40:43], v[128:131], v[8:11], 0
    v_mfma_f32_16x16x32_bf16 v[44:47], v[136:139], v[8:11], 0
    v_mfma_f32_16x16x32_bf16 v[32:35], v[116:119], v[12:15], v[32:35]
    v_mfma_f32_16x16x32_bf16 v[36:39], v[124:127], v[12:15], v[36:39]
    v_mfma_f32_16x16x32_bf16 v[40:43], v[132:135], v[12:15], v[40:43]
    v_mfma_f32_16x16x32_bf16 v[44:47], v[140:143], v[12:15], v[44:47]
    v_mfma_f32_16x16x32_bf16 v[48:51], v[144:147], v[8:11], 0
    v_mov_b32_dpp v16, v20 quad_perm:[0,1,2,3] row_mask:0xf bank_mask:0x2
    v_mov_b32_dpp v17, v21 quad_perm:[0,1,2,3] row_mask:0xf bank_mask:0x2
    v_mov_b32_dpp v18, v22 quad_perm:[0,1,2,3] row_mask:0xf bank_mask:0x2
    v_mfma_f32_16x16x32_bf16 v[52:55], v[152:155], v[8:11], 0
    v_mov_b32_dpp v19, v23 quad_perm:[0,1,2,3] row_mask:0xf bank_mask:0x2
    v_mov_b32_dpp v16, v24 quad_perm:[0,1,2,3] row_mask:0xf bank_mask:0x4
    v_mov_b32_dpp v17, v25 quad_perm:[0,1,2,3] row_mask:0xf bank_mask:0x4
    v_mfma_f32_16x16x32_bf16 v[48:51], v[148:151], v[12:15], v[48:51]
    v_mov_b32_dpp v18, v26 quad_perm:[0,1,2,3] row_mask:0xf bank_mask:0x4
    v_mov_b32_dpp v19, v27 quad_perm:[0,1,2,3] row_mask:0xf bank_mask:0x4
    v_mov_b32_dpp v16, v28 quad_perm:[0,1,2,3] row_mask:0xf bank_mask:0x8
    v_mfma_f32_16x16x32_bf16 v[52:55], v[156:159], v[12:15], v[52:55]
    v_mov_b32_dpp v17, v29 quad_perm:[0,1,2,3] row_mask:0xf bank_mask:0x8
    v_mov_b32_dpp v18, v30 quad_perm:[0,1,2,3] row_mask:0xf bank_mask:0x8
    v_mov_b32_dpp v19, v31 quad_perm:[0,1,2,3] row_mask:0xf bank_mask:0x8
    v_cvt_pk_bf16_f32 v16, v16, v17
    v_cvt_pk_bf16_f32 v17, v18, v19
    buffer_store_dwordx2 v[16:17], v160, s[40:43], s57 offen sc1
    v_mov_b32_dpp v32, v36 quad_perm:[0,1,2,3] row_mask:0xf bank_mask:0x2
    v_mov_b32_dpp v33, v37 quad_perm:[0,1,2,3] row_mask:0xf bank_mask:0x2
    v_mov_b32_dpp v34, v38 quad_perm:[0,1,2,3] row_mask:0xf bank_mask:0x2
    v_mov_b32_dpp v35, v39 quad_perm:[0,1,2,3] row_mask:0xf bank_mask:0x2
    v_mov_b32_dpp v32, v40 quad_perm:[0,1,2,3] row_mask:0xf bank_mask:0x4
    v_mov_b32_dpp v33, v41 quad_perm:[0,1,2,3] row_mask:0xf bank_mask:0x4
    v_mov_b32_dpp v34, v42 quad_perm:[0,1,2,3] row_mask:0xf bank_mask:0x4
    v_mov_b32_dpp v35, v43 quad_perm:[0,1,2,3] row_mask:0xf bank_mask:0x4
    v_mov_b32_dpp v32, v44 quad_perm:[0,1,2,3] row_mask:0xf bank_mask:0x8
    v_mov_b32_dpp v33, v45 quad_perm:[0,1,2,3] row_mask:0xf bank_mask:0x8
    v_mov_b32_dpp v34, v46 quad_perm:[0,1,2,3] row_mask:0xf bank_mask:0x8
    v_mov_b32_dpp v35, v47 quad_perm:[0,1,2,3] row_mask:0xf bank_mask:0x8
    v_cvt_pk_bf16_f32 v32, v32, v33
    v_cvt_pk_bf16_f32 v33, v34, v35
    buffer_store_dwordx2 v[32:33], v160, s[40:43], s57 offen offset:128 sc1
    v_mov_b32_dpp v48, v52 quad_perm:[0,1,2,3] row_mask:0xf bank_mask:0x2
    v_mov_b32_dpp v49, v53 quad_perm:[0,1,2,3] row_mask:0xf bank_mask:0x2
    v_mov_b32_dpp v50, v54 quad_perm:[0,1,2,3] row_mask:0xf bank_mask:0x2
    v_mov_b32_dpp v51, v55 quad_perm:[0,1,2,3] row_mask:0xf bank_mask:0x2
    v_cvt_pk_bf16_f32 v48, v48, v49
    v_cvt_pk_bf16_f32 v49, v50, v51
    s_mov_b32 exec_lo, 0x00ff00ff
    s_mov_b32 exec_hi, 0x00ff00ff
    buffer_store_dwordx2 v[48:49], v160, s[40:43], s57 offen offset:256 sc1
    s_branch L_f2done
L_poll_3t:
    s_mov_b32 s60, 0
    s_waitcnt vmcnt(0)
    s_branch L_poll_3e
L_poll_4t:
    s_mov_b32 s60, 0
    s_waitcnt vmcnt(0)
    s_branch L_poll_4e
L_poll_8t:
    s_mov_b32 s60, 0
    s_waitcnt vmcnt(0)
    s_branch L_poll_8e
L_poll_9t:
    s_mov_b32 s60, 0
    s_waitcnt vmcnt(0)
    s_branch L_poll_9e
L_poll_99t:
    s_mov_b32 s60, 0
    s_waitcnt vmcnt(0)
    s_branch L_poll_99e
L_pfast:
    buffer_store_dword v12, v108, s[40:43], s101 offen
    s_branch L_pdone
L_poll_101t:
    s_mov_b32 s60, 0
    s_waitcnt vmcnt(0)
    s_branch L_poll_101e
L_poll_104t:
    s_mov_b32 s60, 0
    s_waitcnt vmcnt(0)
    s_branch L_poll_104e
L_poll_106t:
    s_mov_b32 s60, 0
    s_waitcnt vmcnt(0)
    s_branch L_poll_106e
L_poll_110t:
    s_mov_b32 s60, 0
    s_waitcnt vmcnt(0)
    s_branch L_poll_110e
L_poll_112t:
    s_mov_b32 s60, 0
    s_waitcnt vmcnt(0)
    s_branch L_poll_112e
L_poll_117t:
    s_mov_b32 s60, 0
    s_waitcnt vmcnt(0)
    s_branch L_poll_117e
L_poll_119t:
    s_mov_b32 s60, 0
    s_waitcnt vmcnt(0)
    s_branch L_poll_119e
L_ygt:
    s_waitcnt vmcnt(0)
    s_branch L_ygd
L_pto:
    s_mov_b32 s60, 0
    s_waitcnt vmcnt(0)
    s_branch L_pgot0
L_poll_124t:
    s_mov_b32 s60, 0
    s_waitcnt vmcnt(0)
    s_branch L_poll_124e
L_end:
    s_endpgm
L_codeend:
.section .rodata,"a"
.p2align 6
.amdhsa_kernel adaLN_cond__sliding_block_cached__dense_activation_gelu__decode_kernel
  .amdhsa_next_free_vgpr 168
  .amdhsa_next_free_sgpr 102
  .amdhsa_accum_offset 168
  .amdhsa_group_segment_fixed_size 0
  .amdhsa_kernarg_size 120
  .amdhsa_user_sgpr_count 2
  .amdhsa_user_sgpr_kernarg_segment_ptr 1
  .amdhsa_system_sgpr_workgroup_id_x 1
.end_amdhsa_kernel
```

```asm
; @launch grid=(256,1,1) block=(768,1,1) lds=162176
.amdgcn_target "amdgcn-amd-amdhsa--gfx950"
.text
.globl adaLN_cond__sliding_block_cached__dense_activation_gelu__decode_kernel
.p2align 8
.type adaLN_cond__sliding_block_cached__dense_activation_gelu__decode_kernel,@function
adaLN_cond__sliding_block_cached__dense_activation_gelu__decode_kernel:
    s_load_dwordx16 s[4:19], s[0:1], 0
    s_load_dwordx8 s[20:27], s[0:1], 64
    s_load_dwordx4 s[28:31], s[0:1], 96
    s_load_dwordx2 s[32:33], s[0:1], 112
    s_cmp_ge_u32 s2, 256
    s_cbranch_scc1 L_end
    v_lshrrev_b32 v1, 6, v0
    v_lshlrev_b32 v2, 4, v0
    v_readfirstlane_b32 s3, v1
    v_and_b32 v0, 63, v0
    s_and_b32 s34, s2, 7
    s_lshr_b32 s35, s2, 3
    s_cmp_lg_u32 s35, 21
    s_cbranch_scc1 L_nopf
    s_getpc_b64 s[48:49]
    s_and_b32 s48, s48, 0xffffff00
    s_mov_b32 s50, L_codeend-adaLN_cond__sliding_block_cached__dense_activation_gelu__decode_kernel
    s_mov_b32 s51, 0x20000
    s_mov_b32 s52, 12288
    buffer_load_dwordx4 v[152:155], v2, s[48:51], 0 offen
    buffer_load_dwordx4 v[156:159], v2, s[48:51], s52 offen
L_nopf:
    s_lshr_b32 s36, s35, 3
    s_lshl2_add_u32 s36, s34, s36
    s_bfe_u32 s37, s35, 0x20001
    s_and_b32 s38, s35, 1
    s_cmp_lt_u32 s35, 27
    s_cselect_b32 s39, 1, 0
    s_cmp_eq_u32 s34, 2
    s_cselect_b32 s39, s39, 0
    s_sub_u32 s62, s34, 3
    s_and_b32 s62, s62, 7
    s_mul_i32 s56, s35, 7
    s_add_u32 s56, s56, s62
    s_cmp_eq_u32 s62, 7
    s_cselect_b32 s56, 255, s56
    s_mov_b32 s60, 400000
    s_mov_b32 s61, 0
    v_mov_b32 v36, 0
    s_cmp_lt_u32 s3, 4
    s_cbranch_scc1 L_helpers
    s_sub_u32 s3, s3, 4
    s_cmp_ge_u32 s35, 22
    s_cselect_b32 s59, 1, 0
    s_add_u32 s62, s3, s59
    s_cmp_ge_u32 s62, 6
    s_cselect_b32 s62, s39, 0
    s_cmp_eq_u32 s62, 1
    s_cbranch_scc1 L_proxy
    s_cmp_eq_u32 s59, 1
    s_cselect_b32 s100, 0, 81920
    s_lshl_b32 s62, s3, 13
    s_add_u32 s100, s100, s62
    s_and_b32 s62, s39, s59
    s_cselect_b32 s100, -1, s100
    s_mov_b32 s101, 0
L_stream:
    s_lshl_b32 s62, s37, 5
    s_add_u32 s62, s62, s36
    s_lshl_b32 s63, s62, 21
    s_lshl_b32 s96, s38, 18
    s_add_u32 s63, s63, s96
    s_add_u32 s63, s63, 1572864
    v_lshlrev_b32 v1, 4, v0
    s_lshl_b32 s96, s3, 12
    v_add_u32 v1, s96, v1
    s_mov_b32 s97, 0
    s_mov_b32 s50, 262144
    s_mov_b32 s51, 0x20000
    s_waitcnt lgkmcnt(0)
    s_add_u32 s48, s6, s63
    s_addc_u32 s49, s7, 0
    s_cmp_lt_u32 s56, 40
    s_cbranch_scc0 L_nob0
    s_barrier
L_nob0:
    buffer_load_dwordx4 v[40:43], v1, s[48:51], s97 offen offset:0 nt
    buffer_load_dwordx4 v[44:47], v1, s[48:51], s97 offen offset:1024 nt
    s_cmp_lt_u32 s56, 40
    s_cbranch_scc1 L_stream2
    s_barrier
    s_branch L_stream2
L_helpers:
    s_cmp_lg_u32 s3, 0
    s_cbranch_scc1 L_noinit
    v_lshlrev_b32 v1, 2, v0
    v_add_u32 v1, 161920, v1
    ds_write_b32 v1, v36
L_noinit:
    s_waitcnt lgkmcnt(0)
    s_mov_b32 s40, s32
    s_mov_b32 s41, s33
    s_mov_b32 s42, 589824
    s_mov_b32 s43, 0x20000
    s_mov_b32 s44, s30
    s_mov_b32 s45, s31
    s_mov_b32 s46, 256
    s_mov_b32 s47, 0x20000
    s_lshl2_add_u32 s62, s35, s3
    s_cmp_eq_u32 s62, 87
    s_cbranch_scc1 L_touch
L_notp:
    s_mul_i32 s101, s3, 20480
    s_mov_b32 s96, s56
    s_cmp_lt_u32 s56, 40
    s_cbranch_scc0 L_nothalf
    s_cmp_lt_u32 s3, 2
    s_cbranch_scc1 L_unit
    s_add_u32 s62, s56, 20
    s_cmp_eq_u32 s3, 2
    s_cbranch_scc1 L_job
    s_lshr_b32 s62, s56, 1
    s_and_b32 s63, s56, 1
    s_mul_i32 s63, s63, 5120
    s_lshl_b32 s96, s62, 7
    s_add_u32 s63, s63, s96
    s_cmp_ge_u32 s62, 10
    s_cselect_b32 s62, 8960, 0
    s_add_u32 s63, s63, s62
    v_lshrrev_b32 v1, 4, v0
    v_mul_u32_u24 v1, 1280, v1
    v_and_b32 v2, 15, v0
    v_lshl_add_u32 v1, v2, 3, v1
    v_mov_b32 v4, -1
    v_mov_b32 v5, -1
    buffer_store_dwordx2 v[4:5], v1, s[40:43], s63 offen sc1
    s_lshl_b32 s62, s56, 1
    s_waitcnt vmcnt(0)
    s_mov_b64 exec, 1
    buffer_store_short v4, v36, s[44:47], s62 offen offset:128 sc1
    s_mov_b64 exec, -1
    s_barrier
    s_branch L_service
L_nothalf:
    s_cmp_lt_u32 s56, 104
    s_cbranch_scc1 L_unit
    s_sub_u32 s62, s56, 144
    s_cmp_lt_u32 s62, 10
    s_cbranch_scc0 L_nojob
    s_cmp_lt_u32 s3, 2
    s_cbranch_scc0 L_nojob
    s_mul_i32 s63, s3, 10
    s_add_u32 s62, s62, s63
L_job:
    s_cmp_lt_u32 s62, 59
    s_cbranch_scc0 L_end
    s_mov_b32 s100, s101
    s_lshl_b32 s101, s62, 9
    s_add_u32 s101, s101, 196608
    s_cmp_lt_u32 s62, 27
    s_cselect_b32 s63, 0, 27
    s_cselect_b32 s3, 7, 6
    s_cmp_lt_u32 s62, 54
    s_cselect_b32 s63, s63, 32
    s_cselect_b32 s3, s3, 5
    s_sub_u32 s35, s62, s63
    s_mov_b32 s34, 2
    s_lshr_b32 s36, s35, 3
    s_add_u32 s36, s36, 8
    s_bfe_u32 s37, s35, 0x20001
    s_and_b32 s38, s35, 1
    s_mov_b32 s59, 0
    s_branch L_stream
L_nojob:
    s_barrier
    s_cmp_ge_u32 s35, 22
    s_cbranch_scc1 L_h_t1
    s_cmp_eq_u32 s39, 1
    s_cbranch_scc1 L_h_role
    s_cmp_lt_u32 s96, 144
    s_cbranch_scc1 L_unit
    s_cmp_eq_u32 s3, 3
    s_cbranch_scc1 L_service
    s_endpgm
L_unit:
    v_lshrrev_b32 v3, 4, v0
    v_and_b32 v4, 3, v0
    v_bfe_u32 v7, v0, 2, 2
    v_lshlrev_b32 v64, 5, v7
    v_lshl_add_u32 v64, v3, 3, v64
    s_mov_b32 s14, s3
    s_mov_b32 s15, 3
    s_sub_u32 s62, s96, 40
    s_cmp_lt_u32 s62, 64
    s_cbranch_scc1 L_u_q
    s_mov_b32 s100, 1
    s_sub_u32 s96, s96, 84
    s_mov_b32 s12, 10240
    s_cmp_lt_u32 s56, 40
    s_cbranch_scc0 L_u_full
    s_mov_b32 s100, 0
    s_lshr_b32 s96, s56, 1
    s_and_b32 s62, s56, 1
    s_lshl1_add_u32 s14, s62, s14
    s_mov_b32 s15, 1
    s_cmp_ge_u32 s96, 10
    s_addc_u32 s62, s62, 0
    s_mul_i32 s12, s62, 5120
    s_add_u32 s12, s12, 0
L_u_full:
    s_mov_b32 s97, 0
    s_mov_b32 s99, 7680
    s_mov_b32 s48, s26
    s_mov_b32 s49, s27
    s_mov_b32 s50, 4915200
    s_mov_b32 s51, 0x20000
    s_mov_b32 s52, s24
    s_mov_b32 s53, s25
    s_mov_b32 s54, 5120
    s_mov_b32 s55, 0x20000
    v_and_b32 v6, 15, v0
    v_lshlrev_b32 v6, 4, v6
    v_mul_u32_u24 v5, 1280, v3
    v_add_u32 v5, v5, v6
    s_mul_i32 s62, s14, 320
    buffer_load_dwordx4 v[8:11], v5, s[52:55], s62 offen
    s_mov_b32 exec_lo, 0x000f000f
    s_mov_b32 exec_hi, 0x000f000f
    buffer_load_dwordx4 v[12:15], v5, s[52:55], s62 offen offset:256
    s_mov_b64 exec, -1
    s_lshl_b32 s98, s96, 7
    s_mul_i32 s13, s96, 0x199a
    s_lshr_b32 s13, s13, 16
    s_mul_i32 s63, s13, 3840
    s_add_u32 s57, s98, s63
    s_add_u32 s57, s57, s12
    v_mul_u32_u24 v5, 1280, v4
    v_add_u32 v64, v64, v5
    s_cmp_lg_u32 s13, 1
    s_cbranch_scc1 L_u_go
    s_mov_b32 s52, s4
    s_mov_b32 s53, s5
    s_mov_b32 s54, 5120
    s_mov_b32 s55, 0x20000
    v_lshrrev_b32 v6, 2, v0
    v_lshl_add_u32 v6, v6, 4, v5
    s_sub_u32 s62, s98, 1280
    buffer_load_dwordx4 v[16:19], v6, s[52:55], 0 offen offset:0
    buffer_load_dwordx4 v[20:23], v6, s[52:55], 0 offen offset:256
    buffer_load_dwordx4 v[24:27], v6, s[52:55], 0 offen offset:512
    buffer_load_dwordx4 v[28:31], v6, s[52:55], 0 offen offset:768
    buffer_load_dwordx4 v[32:35], v6, s[52:55], 0 offen offset:1024
    buffer_load_dwordx2 v[66:67], v64, s[52:55], s62 offen
    s_branch L_u_go
L_u_q:
    s_mov_b32 s97, 1
    s_mov_b32 s99, 8192
    s_mov_b32 s100, 0
    s_lshl_b32 s98, s62, 7
    s_add_u32 s57, s98, 40960
    v_lshl_add_u32 v64, v4, 13, v64
    s_mov_b32 s48, s10
    s_mov_b32 s49, s11
    s_mov_b32 s50, 5242880
    s_mov_b32 s51, 0x20000
L_u_go:
    v_lshrrev_b32 v6, 3, v0
    v_mul_lo_u32 v1, v6, s99
    v_and_b32 v6, 2, v6
    v_xor_b32 v6, v6, v0
    v_and_b32 v6, 7, v6
    v_lshl_add_u32 v1, v6, 4, v1
    v_add_u32 v1, s98, v1
    v_xor_b32 v2, 64, v1
    s_mul_i32 s63, s99, s14
    s_mul_i32 s63, s63, 160
    s_lshl_b32 s59, s99, 3
    s_mov_b32 m0, s101
    s_mov_b32 s62, 10
L_dma_1:
    buffer_load_dwordx4 v1, s[48:51], s63 offen nt lds
    s_add_u32 m0, m0, 1024
    s_add_u32 s63, s63, s59
    s_cmp_eq_u32 s100, 0
    s_cbranch_scc1 L_dma_1n0
    s_waitcnt vmcnt(3)
    s_cmp_eq_u32 s100, 2
    s_cbranch_scc1 L_dma_1n0
    s_waitcnt vmcnt(3)
L_dma_1n0:
    buffer_load_dwordx4 v2, s[48:51], s63 offen nt lds
    s_add_u32 m0, m0, 1024
    s_add_u32 s63, s63, s59
    s_cmp_eq_u32 s100, 0
    s_cbranch_scc1 L_dma_1n1
    s_waitcnt vmcnt(3)
    s_cmp_eq_u32 s100, 2
    s_cbranch_scc1 L_dma_1n1
    s_waitcnt vmcnt(3)
L_dma_1n1:
    s_sub_u32 s62, s62, 1
    s_cmp_lg_u32 s62, 0
    s_cbranch_scc1 L_dma_1
    v_min_u32 v65, 29, v0
    v_lshlrev_b32 v65, 2, v65
    s_cmp_lt_u32 s56, 104
    s_cselect_b32 s62, 32, 64
    v_min_u32 v6, 51, v0
    v_lshlrev_b32 v6, 2, v6
    v_cmp_le_u32 vcc, s62, v0
    s_nop 1
    v_cndmask_b32 v65, v65, v6, vcc
    v_mov_b32 v68, -1
    s_cmp_lt_u32 s56, 40
    s_cbranch_scc1 L_u_nofl
    buffer_load_dword v68, v65, s[44:47], 0 offen sc1
L_u_nofl:
    s_cmp_lt_u32 s56, 104
    s_cbranch_scc0 L_u_nob
    s_barrier
L_u_nob:
    v_lshrrev_b32 v60, 4, v0
    v_lshlrev_b32 v60, 10, v60
    v_bfe_u32 v6, v0, 2, 2
    v_lshl_add_u32 v60, v6, 7, v60
    v_and_b32 v6, 3, v0
    v_lshl_add_u32 v60, v6, 3, v60
    v_bfe_u32 v6, v0, 3, 2
    v_lshl_add_u32 v60, v6, 5, v60
    v_xor_b32 v61, 32, v60
    v_xor_b32 v62, 64, v60
    v_xor_b32 v63, 0x60, v60
    v_add_u32 v60, s101, v60
    v_add_u32 v61, s101, v61
    v_add_u32 v62, s101, v62
    v_add_u32 v63, s101, v63
    v_mov_b32 v56, 1.0
    v_mov_b32 v57, 1.0
    v_mov_b32 v58, 1.0
    v_mov_b32 v59, 1.0
    s_mov_b32 s58, 0
    s_cmp_eq_u32 s97, 1
    s_cbranch_scc1 L_u_q2
    s_cmp_eq_u32 s13, 4
    s_cselect_b32 s58, 1.0, 0
    s_cmp_lt_u32 s14, 2
    s_cselect_b32 s62, 1.0, 0
    s_cmp_eq_u32 s13, 1
    s_cselect_b32 s58, s62, s58
    s_cselect_b32 s56, 1, 0
    s_waitcnt vmcnt(20)
    s_mov_b32 s62, 0xbfb8aa3b
    v_lshlrev_b32 v40, 16, v8
    v_and_b32 v41, 0xffff0000, v8
    v_lshlrev_b32 v42, 16, v9
    v_and_b32 v43, 0xffff0000, v9
    v_lshlrev_b32 v44, 16, v10
    v_and_b32 v45, 0xffff0000, v10
    v_lshlrev_b32 v46, 16, v11
    v_and_b32 v47, 0xffff0000, v11
    v_mul_f32 v48, s62, v40
    v_mul_f32 v49, s62, v41
    v_mul_f32 v50, s62, v42
    v_mul_f32 v51, s62, v43
    v_mul_f32 v52, s62, v44
    v_mul_f32 v53, s62, v45
    v_mul_f32 v54, s62, v46
    v_mul_f32 v55, s62, v47
    v_exp_f32 v48, v48
    v_exp_f32 v49, v49
    v_exp_f32 v50, v50
    v_exp_f32 v51, v51
    v_exp_f32 v52, v52
    v_exp_f32 v53, v53
    v_exp_f32 v54, v54
    v_exp_f32 v55, v55
    v_add_f32 v48, 1.0, v48
    v_add_f32 v49, 1.0, v49
    v_add_f32 v50, 1.0, v50
    v_add_f32 v51, 1.0, v51
    v_add_f32 v52, 1.0, v52
    v_add_f32 v53, 1.0, v53
    v_add_f32 v54, 1.0, v54
    v_add_f32 v55, 1.0, v55
    v_rcp_f32 v48, v48
    v_rcp_f32 v49, v49
    v_rcp_f32 v50, v50
    v_rcp_f32 v51, v51
    v_rcp_f32 v52, v52
    v_rcp_f32 v53, v53
    v_rcp_f32 v54, v54
    v_rcp_f32 v55, v55
    v_mul_f32 v40, v40, v48
    v_mul_f32 v41, v41, v49
    v_mul_f32 v42, v42, v50
    v_mul_f32 v43, v43, v51
    v_mul_f32 v44, v44, v52
    v_mul_f32 v45, v45, v53
    v_mul_f32 v46, v46, v54
    v_mul_f32 v47, v47, v55
    v_cvt_pk_bf16_f32 v8, v40, v41
    v_cvt_pk_bf16_f32 v9, v42, v43
    v_cvt_pk_bf16_f32 v10, v44, v45
    v_cvt_pk_bf16_f32 v11, v46, v47
    v_lshlrev_b32 v40, 16, v12
    v_and_b32 v41, 0xffff0000, v12
    v_lshlrev_b32 v42, 16, v13
    v_and_b32 v43, 0xffff0000, v13
    v_lshlrev_b32 v44, 16, v14
    v_and_b32 v45, 0xffff0000, v14
    v_lshlrev_b32 v46, 16, v15
    v_and_b32 v47, 0xffff0000, v15
    v_mul_f32 v48, s62, v40
    v_mul_f32 v49, s62, v41
    v_mul_f32 v50, s62, v42
    v_mul_f32 v51, s62, v43
    v_mul_f32 v52, s62, v44
    v_mul_f32 v53, s62, v45
    v_mul_f32 v54, s62, v46
    v_mul_f32 v55, s62, v47
    v_exp_f32 v48, v48
    v_exp_f32 v49, v49
    v_exp_f32 v50, v50
    v_exp_f32 v51, v51
    v_exp_f32 v52, v52
    v_exp_f32 v53, v53
    v_exp_f32 v54, v54
    v_exp_f32 v55, v55
    v_add_f32 v48, 1.0, v48
    v_add_f32 v49, 1.0, v49
    v_add_f32 v50, 1.0, v50
    v_add_f32 v51, 1.0, v51
    v_add_f32 v52, 1.0, v52
    v_add_f32 v53, 1.0, v53
    v_add_f32 v54, 1.0, v54
    v_add_f32 v55, 1.0, v55
    v_rcp_f32 v48, v48
    v_rcp_f32 v49, v49
    v_rcp_f32 v50, v50
    v_rcp_f32 v51, v51
    v_rcp_f32 v52, v52
    v_rcp_f32 v53, v53
    v_rcp_f32 v54, v54
    v_rcp_f32 v55, v55
    v_mul_f32 v40, v40, v48
    v_mul_f32 v41, v41, v49
    v_mul_f32 v42, v42, v50
    v_mul_f32 v43, v43, v51
    v_mul_f32 v44, v44, v52
    v_mul_f32 v45, v45, v53
    v_mul_f32 v46, v46, v54
    v_mul_f32 v47, v47, v55
    v_cvt_pk_bf16_f32 v12, v40, v41
    v_cvt_pk_bf16_f32 v13, v42, v43
    v_cvt_pk_bf16_f32 v14, v44, v45
    v_cvt_pk_bf16_f32 v15, v46, v47
    s_mul_i32 s62, s3, 1344
    s_add_u32 s62, s62, 151552
    v_mul_u32_u24 v5, 336, v3
    v_and_b32 v6, 15, v0
    v_lshl_add_u32 v5, v6, 4, v5
    v_add_u32 v5, s62, v5
    ds_write_b128 v5, v[8:11]
    s_mov_b32 exec_lo, 0x000f000f
    s_mov_b32 exec_hi, 0x000f000f
    ds_write_b128 v5, v[12:15] offset:256
    s_mov_b64 exec, -1
    v_mul_u32_u24 v5, 336, v4
    v_lshl_add_u32 v5, v3, 4, v5
    v_add_u32 v5, s62, v5
    s_mov_b32 s59, 0x3e800000
    s_cmp_eq_u32 s56, 0
    s_cbranch_scc1 L_u_nost
    v_mov_b32 v40, 0
    v_mov_b32 v41, 0
    s_mov_b32 s62, 0x3f803f80
    v_dot2c_f32_bf16 v40, s62, v16
    v_dot2c_f32_bf16 v41, v16, v16
    v_dot2c_f32_bf16 v40, s62, v17
    v_dot2c_f32_bf16 v41, v17, v17
    v_dot2c_f32_bf16 v40, s62, v18
    v_dot2c_f32_bf16 v41, v18, v18
    v_dot2c_f32_bf16 v40, s62, v19
    v_dot2c_f32_bf16 v41, v19, v19
    v_dot2c_f32_bf16 v40, s62, v20
    v_dot2c_f32_bf16 v41, v20, v20
    v_dot2c_f32_bf16 v40, s62, v21
    v_dot2c_f32_bf16 v41, v21, v21
    v_dot2c_f32_bf16 v40, s62, v22
    v_dot2c_f32_bf16 v41, v22, v22
    v_dot2c_f32_bf16 v40, s62, v23
    v_dot2c_f32_bf16 v41, v23, v23
    v_dot2c_f32_bf16 v40, s62, v24
    v_dot2c_f32_bf16 v41, v24, v24
    v_dot2c_f32_bf16 v40, s62, v25
    v_dot2c_f32_bf16 v41, v25, v25
    v_dot2c_f32_bf16 v40, s62, v26
    v_dot2c_f32_bf16 v41, v26, v26
    v_dot2c_f32_bf16 v40, s62, v27
    v_dot2c_f32_bf16 v41, v27, v27
    v_dot2c_f32_bf16 v40, s62, v28
    v_dot2c_f32_bf16 v41, v28, v28
    v_dot2c_f32_bf16 v40, s62, v29
    v_dot2c_f32_bf16 v41, v29, v29
    v_dot2c_f32_bf16 v40, s62, v30
    v_dot2c_f32_bf16 v41, v30, v30
    v_dot2c_f32_bf16 v40, s62, v31
    v_dot2c_f32_bf16 v41, v31, v31
    v_dot2c_f32_bf16 v40, s62, v32
    v_dot2c_f32_bf16 v41, v32, v32
    v_dot2c_f32_bf16 v40, s62, v33
    v_dot2c_f32_bf16 v41, v33, v33
    v_dot2c_f32_bf16 v40, s62, v34
    v_dot2c_f32_bf16 v41, v34, v34
    v_dot2c_f32_bf16 v40, s62, v35
    v_dot2c_f32_bf16 v41, v35, v35
    s_nop 1
    v_add_f32_dpp v40, v40, v40 row_ror:4 row_mask:0xf bank_mask:0xf
    v_add_f32_dpp v41, v41, v41 row_ror:4 row_mask:0xf bank_mask:0xf
    s_nop 0
    v_add_f32_dpp v40, v40, v40 row_ror:8 row_mask:0xf bank_mask:0xf
    v_add_f32_dpp v41, v41, v41 row_ror:8 row_mask:0xf bank_mask:0xf
    v_mov_b32 v42, v40
    v_mov_b32 v43, v41
    s_nop 0
    v_permlane16_swap_b32 v40, v42
    v_permlane16_swap_b32 v41, v43
    v_add_f32 v40, v40, v42
    v_add_f32 v41, v41, v43
    v_mov_b32 v42, v40
    v_mov_b32 v43, v41
    s_nop 0
    v_permlane32_swap_b32 v40, v42
    v_permlane32_swap_b32 v41, v43
    v_add_f32 v40, v40, v42
    v_add_f32 v41, v41, v43
    s_mov_b32 s62, 0x3acccccd
    v_mul_f32 v40, s62, v40
    v_mul_f32 v41, s62, v41
    v_fma_f32 v41, -v40, v40, v41
    v_max_f32 v41, 0, v41
    v_add_f32 v41, 0x3727c5ac, v41
    v_rsq_f32 v41, v41
    v_lshlrev_b32 v56, 16, v66
    v_and_b32 v57, 0xffff0000, v66
    v_lshlrev_b32 v58, 16, v67
    v_and_b32 v59, 0xffff0000, v67
    v_sub_f32 v56, v56, v40
    v_sub_f32 v57, v57, v40
    v_sub_f32 v58, v58, v40
    v_sub_f32 v59, v59, v40
    v_mul_f32 v56, v56, v41
    v_mul_f32 v57, v57, v41
    v_mul_f32 v58, v58, v41
    v_mul_f32 v59, v59, v41
L_u_nost:
    ds_read_b128 v[8:11], v5 offset:0
    ds_read_b128 v[12:15], v5 offset:64
    ds_read_b128 v[16:19], v5 offset:128
    ds_read_b128 v[20:23], v5 offset:192
    ds_read_b128 v[24:27], v5 offset:256
    s_branch L_u_frag
L_u_q2:
    v_and_b32 v5, 15, v0
    v_mul_u32_u24 v5, 1280, v5
    v_lshl_add_u32 v5, v3, 4, v5
    s_mul_i32 s63, s3, 320
    s_add_u32 s63, s63, 0
    s_mov_b32 s59, 1.0
L_u_frag:
    s_waitcnt vmcnt(0)
    v_cmp_ne_u32 vcc, -1, v68
    s_cbranch_vccz L_u_yok
L_wy_2:
    buffer_load_dword v37, v65, s[44:47], 0 offen sc1
    s_waitcnt vmcnt(0)
    v_cmp_ne_u32 vcc, -1, v37
    s_cbranch_vccz L_wy_2e
    s_sleep 4
    s_sub_u32 s60, s60, 1
    s_cbranch_scc0 L_wy_2
    s_mov_b32 s60, 0
L_wy_2e:
L_u_yok:
    ds_read_b64_tr_b16 v[80:81], v60 offset:0
    ds_read_b64_tr_b16 v[82:83], v60 offset:512
    ds_read_b64_tr_b16 v[84:85], v61 offset:0
    ds_read_b64_tr_b16 v[86:87], v61 offset:512
    ds_read_b64_tr_b16 v[88:89], v62 offset:0
    ds_read_b64_tr_b16 v[90:91], v62 offset:512
    ds_read_b64_tr_b16 v[92:93], v63 offset:0
    ds_read_b64_tr_b16 v[94:95], v63 offset:512
    ds_read_b64_tr_b16 v[96:97], v60 offset:4096
    ds_read_b64_tr_b16 v[98:99], v60 offset:4608
    ds_read_b64_tr_b16 v[100:101], v61 offset:4096
    ds_read_b64_tr_b16 v[102:103], v61 offset:4608
    ds_read_b64_tr_b16 v[104:105], v62 offset:4096
    ds_read_b64_tr_b16 v[106:107], v62 offset:4608
    ds_read_b64_tr_b16 v[108:109], v63 offset:4096
    ds_read_b64_tr_b16 v[110:111], v63 offset:4608
    ds_read_b64_tr_b16 v[112:113], v60 offset:8192
    ds_read_b64_tr_b16 v[114:115], v60 offset:8704
    ds_read_b64_tr_b16 v[116:117], v61 offset:8192
    ds_read_b64_tr_b16 v[118:119], v61 offset:8704
    ds_read_b64_tr_b16 v[120:121], v62 offset:8192
    ds_read_b64_tr_b16 v[122:123], v62 offset:8704
    ds_read_b64_tr_b16 v[124:125], v63 offset:8192
    ds_read_b64_tr_b16 v[126:127], v63 offset:8704
    ds_read_b64_tr_b16 v[128:129], v60 offset:12288
    ds_read_b64_tr_b16 v[130:131], v60 offset:12800
    ds_read_b64_tr_b16 v[132:133], v61 offset:12288
    ds_read_b64_tr_b16 v[134:135], v61 offset:12800
    ds_read_b64_tr_b16 v[136:137], v62 offset:12288
    ds_read_b64_tr_b16 v[138:139], v62 offset:12800
    ds_read_b64_tr_b16 v[140:141], v63 offset:12288
    ds_read_b64_tr_b16 v[142:143], v63 offset:12800
    ds_read_b64_tr_b16 v[144:145], v60 offset:16384
    ds_read_b64_tr_b16 v[146:147], v60 offset:16896
    ds_read_b64_tr_b16 v[148:149], v61 offset:16384
    ds_read_b64_tr_b16 v[150:151], v61 offset:16896
    ds_read_b64_tr_b16 v[152:153], v62 offset:16384
    ds_read_b64_tr_b16 v[154:155], v62 offset:16896
    ds_read_b64_tr_b16 v[156:157], v63 offset:16384
    ds_read_b64_tr_b16 v[158:159], v63 offset:16896
    s_cmp_eq_u32 s97, 0
    s_cbranch_scc1 L_u_mm
    v_lshrrev_b32 v6, 2, v0
    v_mul_u32_u24 v6, 158, v6
    v_and_b32 v6, 0xfffc, v6
    v_and_b32 v7, 3, v0
    v_mul_u32_u24 v7, 5120, v7
    v_add_u32 v6, v6, v7
    s_mov_b64 exec, 0xfff
    s_branch L_poll_3
L_poll_3s:
    s_sleep 4
L_poll_3:
    buffer_load_dword v8, v6, s[40:43], s63 offen offset:3840 sc1
    s_sub_u32 s60, s60, 1
    s_cbranch_scc1 L_poll_3t
    s_waitcnt vmcnt(0)
    v_cmp_eq_u32 vcc, -1, v8
    s_cbranch_vccnz L_poll_3s
L_poll_3e:
    s_mov_b64 exec, -1
    s_branch L_poll_4
L_poll_4s:
    s_sleep 1
L_poll_4:
    buffer_load_dwordx4 v[8:11], v5, s[40:43], s63 offen offset:0 sc1
    buffer_load_dwordx4 v[12:15], v5, s[40:43], s63 offen offset:64 sc1
    buffer_load_dwordx4 v[16:19], v5, s[40:43], s63 offen offset:128 sc1
    buffer_load_dwordx4 v[20:23], v5, s[40:43], s63 offen offset:192 sc1
    buffer_load_dwordx4 v[24:27], v5, s[40:43], s63 offen offset:256 sc1
    s_sub_u32 s60, s60, 1
    s_cbranch_scc1 L_poll_4t
    s_waitcnt vmcnt(0)
    v_max3_u32 v37, v8, v9, v10
    v_max3_u32 v37, v37, v11, v12
    v_max3_u32 v37, v37, v13, v14
    v_max3_u32 v37, v37, v15, v16
    v_max3_u32 v37, v37, v17, v18
    v_max3_u32 v37, v37, v19, v20
    v_max3_u32 v37, v37, v21, v22
    v_max3_u32 v37, v37, v23, v24
    v_max3_u32 v37, v37, v25, v26
    v_max_u32 v37, v37, v27
    v_cmp_eq_u32 vcc, -1, v37
    s_cbranch_vccnz L_poll_4s
L_poll_4e:
L_u_got:
L_u_mm:
    s_waitcnt lgkmcnt(0)
    v_mfma_f32_16x16x32_bf16 v[40:43], v[80:83], v[8:11], 0
    v_mfma_f32_16x16x32_bf16 v[44:47], v[84:87], v[8:11], 0
    v_mfma_f32_16x16x32_bf16 v[48:51], v[88:91], v[8:11], 0
    v_mfma_f32_16x16x32_bf16 v[52:55], v[92:95], v[8:11], 0
    v_mfma_f32_16x16x32_bf16 v[40:43], v[96:99], v[12:15], v[40:43]
    v_mfma_f32_16x16x32_bf16 v[44:47], v[100:103], v[12:15], v[44:47]
    v_mfma_f32_16x16x32_bf16 v[48:51], v[104:107], v[12:15], v[48:51]
    v_mfma_f32_16x16x32_bf16 v[52:55], v[108:111], v[12:15], v[52:55]
    v_mfma_f32_16x16x32_bf16 v[40:43], v[112:115], v[16:19], v[40:43]
    v_mfma_f32_16x16x32_bf16 v[44:47], v[116:119], v[16:19], v[44:47]
    v_mfma_f32_16x16x32_bf16 v[48:51], v[120:123], v[16:19], v[48:51]
    v_mfma_f32_16x16x32_bf16 v[52:55], v[124:127], v[16:19], v[52:55]
    v_mfma_f32_16x16x32_bf16 v[40:43], v[128:131], v[20:23], v[40:43]
    v_mfma_f32_16x16x32_bf16 v[44:47], v[132:135], v[20:23], v[44:47]
    v_mfma_f32_16x16x32_bf16 v[48:51], v[136:139], v[20:23], v[48:51]
    v_mfma_f32_16x16x32_bf16 v[52:55], v[140:143], v[20:23], v[52:55]
    v_mfma_f32_16x16x32_bf16 v[40:43], v[144:147], v[24:27], v[40:43]
    v_mfma_f32_16x16x32_bf16 v[44:47], v[148:151], v[24:27], v[44:47]
    v_mfma_f32_16x16x32_bf16 v[48:51], v[152:155], v[24:27], v[48:51]
    v_mfma_f32_16x16x32_bf16 v[52:55], v[156:159], v[24:27], v[52:55]
    v_lshlrev_b32 v5, 4, v0
    v_add_u32 v5, 147456, v5
    s_lshl_b32 s62, s3, 10
    v_add_u32 v6, s62, v5
    v_mov_b32 v32, 162056
    v_mov_b32 v33, 1
    v_add_f32_dpp v40, v40, v40 row_ror:8 row_mask:0xf bank_mask:0xf
    v_add_f32_dpp v41, v41, v41 row_ror:8 row_mask:0xf bank_mask:0xf
    v_add_f32_dpp v42, v42, v42 row_ror:8 row_mask:0xf bank_mask:0xf
    v_add_f32_dpp v43, v43, v43 row_ror:8 row_mask:0xf bank_mask:0xf
    v_add_f32_dpp v44, v44, v44 row_ror:8 row_mask:0xf bank_mask:0xf
    v_add_f32_dpp v45, v45, v45 row_ror:8 row_mask:0xf bank_mask:0xf
    v_add_f32_dpp v46, v46, v46 row_ror:8 row_mask:0xf bank_mask:0xf
    v_add_f32_dpp v47, v47, v47 row_ror:8 row_mask:0xf bank_mask:0xf
    v_add_f32_dpp v48, v48, v48 row_ror:8 row_mask:0xf bank_mask:0xf
    v_add_f32_dpp v49, v49, v49 row_ror:8 row_mask:0xf bank_mask:0xf
    v_add_f32_dpp v50, v50, v50 row_ror:8 row_mask:0xf bank_mask:0xf
    v_add_f32_dpp v51, v51, v51 row_ror:8 row_mask:0xf bank_mask:0xf
    v_add_f32_dpp v52, v52, v52 row_ror:8 row_mask:0xf bank_mask:0xf
    v_add_f32_dpp v53, v53, v53 row_ror:8 row_mask:0xf bank_mask:0xf
    v_add_f32_dpp v54, v54, v54 row_ror:8 row_mask:0xf bank_mask:0xf
    v_add_f32_dpp v55, v55, v55 row_ror:8 row_mask:0xf bank_mask:0xf
    v_add_f32_dpp v28, v40, v40 row_ror:4 row_mask:0xf bank_mask:0x1
    v_add_f32_dpp v29, v41, v41 row_ror:4 row_mask:0xf bank_mask:0x1
    v_add_f32_dpp v30, v42, v42 row_ror:4 row_mask:0xf bank_mask:0x1
    v_add_f32_dpp v31, v43, v43 row_ror:4 row_mask:0xf bank_mask:0x1
    v_add_f32_dpp v28, v44, v44 row_ror:4 row_mask:0xf bank_mask:0x2
    v_add_f32_dpp v29, v45, v45 row_ror:4 row_mask:0xf bank_mask:0x2
    v_add_f32_dpp v30, v46, v46 row_ror:4 row_mask:0xf bank_mask:0x2
    v_add_f32_dpp v31, v47, v47 row_ror:4 row_mask:0xf bank_mask:0x2
    v_add_f32_dpp v28, v48, v48 row_ror:4 row_mask:0xf bank_mask:0x4
    v_add_f32_dpp v29, v49, v49 row_ror:4 row_mask:0xf bank_mask:0x4
    v_add_f32_dpp v30, v50, v50 row_ror:4 row_mask:0xf bank_mask:0x4
    v_add_f32_dpp v31, v51, v51 row_ror:4 row_mask:0xf bank_mask:0x4
    v_add_f32_dpp v28, v52, v52 row_ror:4 row_mask:0xf bank_mask:0x8
    v_add_f32_dpp v29, v53, v53 row_ror:4 row_mask:0xf bank_mask:0x8
    v_add_f32_dpp v30, v54, v54 row_ror:4 row_mask:0xf bank_mask:0x8
    v_add_f32_dpp v31, v55, v55 row_ror:4 row_mask:0xf bank_mask:0x8
    ds_write_b128 v6, v[28:31]
    s_mov_b64 exec, 1
    ds_add_rtn_u32 v34, v32, v33
    s_mov_b64 exec, -1
    ds_read_b128 v[8:11], v5
    ds_read_b128 v[12:15], v5 offset:1024
    ds_read_b128 v[16:19], v5 offset:2048
    ds_read_b128 v[20:23], v5 offset:3072
    s_waitcnt lgkmcnt(0)
    v_readfirstlane_b32 s62, v34
    v_mov_b32 v24, s58
    s_cmp_eq_u32 s62, s15
    s_cbranch_scc1 L_u_last
    s_cmp_eq_u32 s62, 1
    s_cbranch_scc1 L_service
    s_endpgm
L_u_last:
    v_add_f32 v8, v8, v12
    v_add_f32 v9, v9, v13
    v_add_f32 v10, v10, v14
    v_add_f32 v11, v11, v15
    s_cmp_eq_u32 s15, 1
    s_cbranch_scc1 L_u_two
    v_add_f32 v16, v16, v20
    v_add_f32 v17, v17, v21
    v_add_f32 v18, v18, v22
    v_add_f32 v19, v19, v23
    v_add_f32 v8, v8, v16
    v_add_f32 v9, v9, v17
    v_add_f32 v10, v10, v18
    v_add_f32 v11, v11, v19
L_u_two:
    v_fma_f32 v8, v8, s59, v24
    v_fma_f32 v9, v9, s59, v24
    v_fma_f32 v10, v10, s59, v24
    v_fma_f32 v11, v11, s59, v24
    v_mul_f32 v8, v8, v56
    v_mul_f32 v9, v9, v57
    v_mul_f32 v10, v10, v58
    v_mul_f32 v11, v11, v59
    v_cvt_pk_bf16_f32 v8, v8, v9
    v_cvt_pk_bf16_f32 v9, v10, v11
    buffer_store_dwordx2 v[8:9], v64, s[40:43], s57 offen sc1
    s_endpgm
L_touch:
    s_load_dword s0, s[32:33], 0
    s_load_dword s0, s[30:31], 0
    s_cmp_eq_u32 s39, 1
    s_cbranch_scc1 L_tpr
    s_mov_b32 s62, 16777216
    s_load_dword s0, s[8:9], s62
    s_mov_b32 s62, 83886080
    s_load_dword s0, s[8:9], s62
    s_mov_b32 s62, 150994944
    s_load_dword s0, s[8:9], s62
    s_mov_b32 s62, 218103808
    s_load_dword s0, s[8:9], s62
    s_branch L_tpv
L_tpr:
    s_load_dword s0, s[20:21], 0
    s_mov_b32 s62, 2211836
    s_load_dword s0, s[20:21], s62
    s_load_dword s0, s[16:17], 0
    s_mov_b32 s62, 2211836
    s_load_dword s0, s[16:17], s62
    s_load_dword s0, s[18:19], 0
    s_load_dword s0, s[22:23], 0
    s_load_dword s0, s[28:29], 0
    s_load_dword s0, s[4:5], 0
L_tpv:
    s_lshl_b32 s62, s34, 23
    s_load_dword s0, s[8:9], s62
    s_add_u32 s62, s62, 67108864
    s_load_dword s0, s[8:9], s62
    s_add_u32 s62, s62, 67108864
    s_load_dword s0, s[8:9], s62
    s_add_u32 s62, s62, 67108864
    s_load_dword s0, s[8:9], s62
    s_add_u32 s62, s62, 67108864
    s_branch L_notp
L_stream2:
    s_mov_b32 s12, s100
    s_mov_b32 s13, s101
    s_mov_b32 s40, s32
    s_mov_b32 s41, s33
    s_mov_b32 s42, 589824
    s_mov_b32 s43, 0x20000
    s_mov_b32 s44, s30
    s_mov_b32 s45, s31
    s_mov_b32 s46, 256
    s_mov_b32 s47, 0x20000
    s_bitcmp1_b32 s3, 0
    s_mov_b32 s57, 0xffffffff
    s_mov_b32 s58, 0xffff
    s_mov_b32 s14, 0xffffffff
    s_mov_b32 s15, 0x0
L_pm_10:
    s_cmp_lt_u32 s56, 104
    s_cbranch_scc0 L_pm_11
    s_bitcmp1_b32 s3, 0
    s_mov_b32 s57, 0xffff
    s_mov_b32 s58, 0x0
    s_mov_b32 s14, 0xffffffff
    s_mov_b32 s15, 0x0
L_pm_11:
    s_sub_u32 s96, s56, 43
    s_and_b32 s96, s96, 0xffffffc7
    s_cmp_eq_u32 s96, 0
    s_cbranch_scc0 L_pm_12
    s_bitcmp1_b32 s3, 0
    s_mov_b32 s57, 0x0
    s_mov_b32 s58, 0x0
    s_mov_b32 s14, 0x0
    s_mov_b32 s15, 0x0
L_pm_12:
    s_cmp_lt_u32 s56, 40
    s_cbranch_scc0 L_pm_13
    s_bitcmp1_b32 s3, 0
    s_mov_b32 s57, 0xffffffff
    s_mov_b32 s58, 0xf
    s_mov_b32 s14, 0xffffffff
    s_mov_b32 s15, 0x0
L_pm_13:
    s_cmp_eq_u32 s39, 1
    s_cbranch_scc0 L_pm_14
    s_bitcmp1_b32 s3, 0
    s_mov_b32 s57, 0xff0fff
    s_cselect_b32 s57, 0xff00ffff, s57
    s_mov_b32 s58, 0xfff
    s_mov_b32 s14, 0xff00ff
    s_cselect_b32 s14, 0xff00ff00, s14
    s_mov_b32 s15, 0x0
L_pm_14:
    s_cmp_lg_u32 s13, 0
    s_cbranch_scc0 L_pm_15
    s_bitcmp1_b32 s3, 0
    s_mov_b32 s57, 0xff00ff
    s_cselect_b32 s57, 0xff00ff00, s57
    s_mov_b32 s58, 0x0
    s_mov_b32 s14, 0x0
    s_mov_b32 s15, 0x0
L_pm_15:
    s_and_b32 s96, s39, s59
    s_cbranch_scc0 L_pm_16
    s_bitcmp1_b32 s3, 0
    s_mov_b32 s57, 0xffff
    s_mov_b32 s58, 0xffff
    s_mov_b32 s14, 0x0
    s_mov_b32 s15, 0x0
L_pm_16:
    s_add_u32 s52, s8, s63
    s_addc_u32 s53, s9, 0
    s_mov_b32 s54, 262144
    s_mov_b32 s55, 0x20000
    v_and_b32 v2, 15, v0
    v_lshrrev_b32 v3, 1, v2
    v_and_b32 v37, 1, v2
    v_lshlrev_b32 v37, 4, v37
    v_mov_b32 v38, 0xffff
    v_lshlrev_b32 v37, v37, v38
    v_cmp_eq_u32 vcc, 0, v3
    v_mov_b32 v32, 0
    s_nop 0
    v_cndmask_b32 v20, 0, v37, vcc
    v_cmp_eq_u32 vcc, 1, v3
    v_mov_b32 v33, 0
    s_nop 0
    v_cndmask_b32 v21, 0, v37, vcc
    v_cmp_eq_u32 vcc, 2, v3
    v_mov_b32 v34, 0
    s_nop 0
    v_cndmask_b32 v22, 0, v37, vcc
    v_cmp_eq_u32 vcc, 3, v3
    v_mov_b32 v35, 0
    s_nop 0
    v_cndmask_b32 v23, 0, v37, vcc
    v_lshlrev_b32 v2, 4, v2
    s_lshl_b32 s98, s62, 8
    s_add_u32 s98, s98, 40960
    s_lshl_b32 s99, s62, 7
    s_add_u32 s99, s99, 73728
    s_bitcmp0_b32 s57, 2
    s_cbranch_scc1 L_sf_17
    s_bitcmp0_b32 s58, 2
    s_cbranch_scc1 L_sf_17
    s_waitcnt vmcnt(1)
L_sf_17:
    buffer_load_dwordx4 v[48:51], v1, s[48:51], s97 offen offset:2048 nt
    s_bitcmp0_b32 s57, 3
    s_cbranch_scc1 L_sf_18
    s_waitcnt vmcnt(2)
    s_bitcmp0_b32 s58, 3
    s_cbranch_scc1 L_sf_18
    s_waitcnt vmcnt(1)
L_sf_18:
    buffer_load_dwordx4 v[52:55], v1, s[48:51], s97 offen offset:3072 nt
    s_add_u32 s97, s97, 32768
    v_add_u32 v1, 4096, v1
    v_and_b32 v1, 0x7fff, v1
    s_waitcnt vmcnt(3)
    s_bitcmp0_b32 s57, 4
    s_cbranch_scc1 L_sf_19
    s_waitcnt vmcnt(2)
    s_bitcmp0_b32 s58, 4
    s_cbranch_scc1 L_sf_19
    s_waitcnt vmcnt(1)
L_sf_19:
    buffer_load_dwordx4 v[56:59], v1, s[48:51], s97 offen offset:0 nt
    s_waitcnt vmcnt(3)
    s_bitcmp0_b32 s57, 5
    s_cbranch_scc1 L_sf_20
    s_waitcnt vmcnt(2)
    s_bitcmp0_b32 s58, 5
    s_cbranch_scc1 L_sf_20
    s_waitcnt vmcnt(1)
L_sf_20:
    buffer_load_dwordx4 v[60:63], v1, s[48:51], s97 offen offset:1024 nt
    s_waitcnt vmcnt(3)
    s_bitcmp0_b32 s57, 6
    s_cbranch_scc1 L_sf_21
    s_waitcnt vmcnt(2)
    s_bitcmp0_b32 s58, 6
    s_cbranch_scc1 L_sf_21
    s_waitcnt vmcnt(1)
L_sf_21:
    buffer_load_dwordx4 v[64:67], v1, s[48:51], s97 offen offset:2048 nt
    s_waitcnt vmcnt(3)
    s_bitcmp0_b32 s57, 7
    s_cbranch_scc1 L_sf_22
    s_waitcnt vmcnt(2)
    s_bitcmp0_b32 s58, 7
    s_cbranch_scc1 L_sf_22
    s_waitcnt vmcnt(1)
L_sf_22:
    buffer_load_dwordx4 v[68:71], v1, s[48:51], s97 offen offset:3072 nt
    s_add_u32 s97, s97, 32768
    v_add_u32 v1, 4096, v1
    v_and_b32 v1, 0x7fff, v1
    s_waitcnt vmcnt(3)
    s_bitcmp0_b32 s57, 8
    s_cbranch_scc1 L_sf_23
    s_waitcnt vmcnt(2)
    s_bitcmp0_b32 s58, 8
    s_cbranch_scc1 L_sf_23
    s_waitcnt vmcnt(1)
L_sf_23:
    buffer_load_dwordx4 v[72:75], v1, s[48:51], s97 offen offset:0 nt
    s_waitcnt vmcnt(3)
    s_bitcmp0_b32 s57, 9
    s_cbranch_scc1 L_sf_24
    s_waitcnt vmcnt(2)
    s_bitcmp0_b32 s58, 9
    s_cbranch_scc1 L_sf_24
    s_waitcnt vmcnt(1)
L_sf_24:
    buffer_load_dwordx4 v[76:79], v1, s[48:51], s97 offen offset:1024 nt
    s_waitcnt vmcnt(3)
    s_bitcmp0_b32 s57, 10
    s_cbranch_scc1 L_sf_25
    s_waitcnt vmcnt(2)
    s_bitcmp0_b32 s58, 10
    s_cbranch_scc1 L_sf_25
    s_waitcnt vmcnt(1)
L_sf_25:
    buffer_load_dwordx4 v[80:83], v1, s[48:51], s97 offen offset:2048 nt
    s_waitcnt vmcnt(3)
    s_bitcmp0_b32 s57, 11
    s_cbranch_scc1 L_sf_26
    s_waitcnt vmcnt(2)
    s_bitcmp0_b32 s58, 11
    s_cbranch_scc1 L_sf_26
    s_waitcnt vmcnt(1)
L_sf_26:
    buffer_load_dwordx4 v[84:87], v1, s[48:51], s97 offen offset:3072 nt
    s_add_u32 s97, s97, 32768
    v_add_u32 v1, 4096, v1
    v_and_b32 v1, 0x7fff, v1
    s_waitcnt vmcnt(3)
    s_bitcmp0_b32 s57, 12
    s_cbranch_scc1 L_sf_27
    s_waitcnt vmcnt(2)
    s_bitcmp0_b32 s58, 12
    s_cbranch_scc1 L_sf_27
    s_waitcnt vmcnt(1)
L_sf_27:
    buffer_load_dwordx4 v[88:91], v1, s[48:51], s97 offen offset:0 nt
    s_waitcnt vmcnt(3)
    s_bitcmp0_b32 s57, 13
    s_cbranch_scc1 L_sf_28
    s_waitcnt vmcnt(2)
    s_bitcmp0_b32 s58, 13
    s_cbranch_scc1 L_sf_28
    s_waitcnt vmcnt(1)
L_sf_28:
    buffer_load_dwordx4 v[92:95], v1, s[48:51], s97 offen offset:1024 nt
    s_waitcnt vmcnt(3)
    s_bitcmp0_b32 s57, 14
    s_cbranch_scc1 L_sf_29
    s_waitcnt vmcnt(2)
    s_bitcmp0_b32 s58, 14
    s_cbranch_scc1 L_sf_29
    s_waitcnt vmcnt(1)
L_sf_29:
    buffer_load_dwordx4 v[96:99], v1, s[48:51], s97 offen offset:2048 nt
    s_waitcnt vmcnt(3)
    s_bitcmp0_b32 s57, 15
    s_cbranch_scc1 L_sf_30
    s_waitcnt vmcnt(2)
    s_bitcmp0_b32 s58, 15
    s_cbranch_scc1 L_sf_30
    s_waitcnt vmcnt(1)
L_sf_30:
    buffer_load_dwordx4 v[100:103], v1, s[48:51], s97 offen offset:3072 nt
    s_add_u32 s97, s97, 32768
    v_add_u32 v1, 4096, v1
    v_and_b32 v1, 0x7fff, v1
    s_waitcnt vmcnt(3)
    s_bitcmp0_b32 s57, 16
    s_cbranch_scc1 L_sf_31
    s_waitcnt vmcnt(2)
    s_bitcmp0_b32 s58, 16
    s_cbranch_scc1 L_sf_31
    s_waitcnt vmcnt(1)
L_sf_31:
    buffer_load_dwordx4 v[104:107], v1, s[48:51], s97 offen offset:0 nt
    s_waitcnt vmcnt(3)
    s_bitcmp0_b32 s57, 17
    s_cbranch_scc1 L_sf_32
    s_waitcnt vmcnt(2)
    s_bitcmp0_b32 s58, 17
    s_cbranch_scc1 L_sf_32
    s_waitcnt vmcnt(1)
L_sf_32:
    buffer_load_dwordx4 v[108:111], v1, s[48:51], s97 offen offset:1024 nt
    s_waitcnt vmcnt(3)
    s_bitcmp0_b32 s57, 18
    s_cbranch_scc1 L_sf_33
    s_waitcnt vmcnt(2)
    s_bitcmp0_b32 s58, 18
    s_cbranch_scc1 L_sf_33
    s_waitcnt vmcnt(1)
L_sf_33:
    buffer_load_dwordx4 v[112:115], v1, s[48:51], s97 offen offset:2048 nt
    s_waitcnt vmcnt(3)
    s_bitcmp0_b32 s57, 19
    s_cbranch_scc1 L_sf_34
    s_waitcnt vmcnt(2)
    s_bitcmp0_b32 s58, 19
    s_cbranch_scc1 L_sf_34
    s_waitcnt vmcnt(1)
L_sf_34:
    buffer_load_dwordx4 v[116:119], v1, s[48:51], s97 offen offset:3072 nt
    s_add_u32 s97, s97, 32768
    v_add_u32 v1, 4096, v1
    v_and_b32 v1, 0x7fff, v1
    s_waitcnt vmcnt(3)
    s_bitcmp0_b32 s57, 20
    s_cbranch_scc1 L_sf_35
    s_waitcnt vmcnt(2)
    s_bitcmp0_b32 s58, 20
    s_cbranch_scc1 L_sf_35
    s_waitcnt vmcnt(1)
L_sf_35:
    buffer_load_dwordx4 v[120:123], v1, s[48:51], s97 offen offset:0 nt
    s_waitcnt vmcnt(3)
    s_bitcmp0_b32 s57, 21
    s_cbranch_scc1 L_sf_36
    s_waitcnt vmcnt(2)
    s_bitcmp0_b32 s58, 21
    s_cbranch_scc1 L_sf_36
    s_waitcnt vmcnt(1)
L_sf_36:
    buffer_load_dwordx4 v[124:127], v1, s[48:51], s97 offen offset:1024 nt
    s_cmp_eq_u32 s12, -1
    s_cbranch_scc1 L_k_nopf
    s_waitcnt vmcnt(3)
    s_bitcmp0_b32 s57, 22
    s_cbranch_scc1 L_sf_37
    s_waitcnt vmcnt(2)
    s_bitcmp0_b32 s58, 22
    s_cbranch_scc1 L_sf_37
    s_waitcnt vmcnt(1)
L_sf_37:
    buffer_load_dwordx4 v[128:131], v1, s[48:51], s97 offen offset:2048 nt
    s_waitcnt vmcnt(3)
    s_bitcmp0_b32 s57, 23
    s_cbranch_scc1 L_sf_38
    s_waitcnt vmcnt(2)
    s_bitcmp0_b32 s58, 23
    s_cbranch_scc1 L_sf_38
    s_waitcnt vmcnt(1)
L_sf_38:
    buffer_load_dwordx4 v[132:135], v1, s[48:51], s97 offen offset:3072 nt
    s_add_u32 s97, s97, 32768
    v_add_u32 v1, 4096, v1
    v_and_b32 v1, 0x7fff, v1
    s_waitcnt vmcnt(3)
    s_bitcmp0_b32 s57, 24
    s_cbranch_scc1 L_sf_39
    s_waitcnt vmcnt(2)
    s_bitcmp0_b32 s58, 24
    s_cbranch_scc1 L_sf_39
    s_waitcnt vmcnt(1)
L_sf_39:
    buffer_load_dwordx4 v[136:139], v1, s[48:51], s97 offen offset:0 nt
    s_waitcnt vmcnt(3)
    s_bitcmp0_b32 s57, 25
    s_cbranch_scc1 L_sf_40
    s_waitcnt vmcnt(2)
    s_bitcmp0_b32 s58, 25
    s_cbranch_scc1 L_sf_40
    s_waitcnt vmcnt(1)
L_sf_40:
    buffer_load_dwordx4 v[140:143], v1, s[48:51], s97 offen offset:1024 nt
    s_waitcnt vmcnt(3)
    s_bitcmp0_b32 s57, 26
    s_cbranch_scc1 L_sf_41
    s_waitcnt vmcnt(2)
    s_bitcmp0_b32 s58, 26
    s_cbranch_scc1 L_sf_41
    s_waitcnt vmcnt(1)
L_sf_41:
    buffer_load_dwordx4 v[144:147], v1, s[48:51], s97 offen offset:2048 nt
    s_waitcnt vmcnt(3)
    s_bitcmp0_b32 s57, 27
    s_cbranch_scc1 L_sf_42
    s_waitcnt vmcnt(2)
    s_bitcmp0_b32 s58, 27
    s_cbranch_scc1 L_sf_42
    s_waitcnt vmcnt(1)
L_sf_42:
    buffer_load_dwordx4 v[148:151], v1, s[48:51], s97 offen offset:3072 nt
    s_add_u32 s97, s97, 32768
    v_add_u32 v1, 4096, v1
    v_and_b32 v1, 0x7fff, v1
    s_waitcnt vmcnt(3)
    s_bitcmp0_b32 s57, 28
    s_cbranch_scc1 L_sf_43
    s_waitcnt vmcnt(2)
    s_bitcmp0_b32 s58, 28
    s_cbranch_scc1 L_sf_43
    s_waitcnt vmcnt(1)
L_sf_43:
    buffer_load_dwordx4 v[152:155], v1, s[48:51], s97 offen offset:0 nt
    s_waitcnt vmcnt(3)
    s_bitcmp0_b32 s57, 29
    s_cbranch_scc1 L_sf_44
    s_waitcnt vmcnt(2)
    s_bitcmp0_b32 s58, 29
    s_cbranch_scc1 L_sf_44
    s_waitcnt vmcnt(1)
L_sf_44:
    buffer_load_dwordx4 v[156:159], v1, s[48:51], s97 offen offset:1024 nt
    s_waitcnt vmcnt(3)
    s_bitcmp0_b32 s57, 30
    s_cbranch_scc1 L_sf_45
    s_waitcnt vmcnt(2)
    s_bitcmp0_b32 s58, 30
    s_cbranch_scc1 L_sf_45
    s_waitcnt vmcnt(1)
L_sf_45:
    buffer_load_dwordx4 v[160:163], v1, s[48:51], s97 offen offset:2048 nt
    v_min_u32 v39, 29, v0
    v_lshlrev_b32 v39, 2, v39
    buffer_load_dword v37, v39, s[44:47], 0 offen sc1
    s_waitcnt vmcnt(4)
    s_bitcmp0_b32 s57, 31
    s_cbranch_scc1 L_sf_46
    s_waitcnt vmcnt(3)
    s_bitcmp0_b32 s58, 31
    s_cbranch_scc1 L_sf_46
    s_waitcnt vmcnt(2)
L_sf_46:
    buffer_load_dwordx4 v[164:167], v1, s[48:51], s97 offen offset:3072 nt
    s_mov_b32 s97, 0
    v_add_u32 v1, 4096, v1
    v_and_b32 v1, 0x7fff, v1
    s_waitcnt vmcnt(4)
    s_bitcmp0_b32 s14, 0
    s_cbranch_scc1 L_sf_47
    s_waitcnt vmcnt(3)
    s_bitcmp0_b32 s15, 0
    s_cbranch_scc1 L_sf_47
    s_waitcnt vmcnt(2)
L_sf_47:
    s_add_u32 m0, s12, 0
    s_nop 0
    buffer_load_dwordx4 v1, s[52:55], s97 offen offset:0 nt lds
    s_waitcnt vmcnt(4)
    s_bitcmp0_b32 s14, 1
    s_cbranch_scc1 L_sf_48
    s_waitcnt vmcnt(3)
    s_bitcmp0_b32 s15, 1
    s_cbranch_scc1 L_sf_48
    s_waitcnt vmcnt(1)
L_sf_48:
    buffer_load_dwordx4 v1, s[52:55], s97 offen offset:1024 nt lds
    s_waitcnt vmcnt(4)
    s_bitcmp0_b32 s14, 2
    s_cbranch_scc1 L_sf_49
    s_waitcnt vmcnt(2)
    s_bitcmp0_b32 s15, 2
    s_cbranch_scc1 L_sf_49
    s_waitcnt vmcnt(1)
L_sf_49:
    buffer_load_dwordx4 v1, s[52:55], s97 offen offset:2048 nt lds
    s_waitcnt vmcnt(3)
    s_bitcmp0_b32 s14, 3
    s_cbranch_scc1 L_sf_50
    s_waitcnt vmcnt(2)
    s_bitcmp0_b32 s15, 3
    s_cbranch_scc1 L_sf_50
    s_waitcnt vmcnt(1)
L_sf_50:
    buffer_load_dwordx4 v1, s[52:55], s97 offen offset:3072 nt lds
    s_add_u32 s97, s97, 32768
    v_add_u32 v1, 4096, v1
    v_and_b32 v1, 0x7fff, v1
    v_cmp_eq_u32 vcc, 0, v37
    s_nop 0
    s_or_b32 s96, vcc_lo, vcc_hi
    buffer_load_dwordx4 v[4:7], v2, s[40:43], s98 offen sc1
    s_waitcnt vmcnt(4)
    s_bitcmp0_b32 s14, 4
    s_cbranch_scc1 L_sf_51
    s_waitcnt vmcnt(3)
    s_bitcmp0_b32 s15, 4
    s_cbranch_scc1 L_sf_51
    s_waitcnt vmcnt(2)
L_sf_51:
    s_add_u32 m0, s12, 4096
    s_nop 0
    buffer_load_dwordx4 v1, s[52:55], s97 offen offset:0 nt lds
    s_waitcnt vmcnt(4)
    s_bitcmp0_b32 s14, 5
    s_cbranch_scc1 L_sf_52
    s_waitcnt vmcnt(3)
    s_bitcmp0_b32 s15, 5
    s_cbranch_scc1 L_sf_52
    s_waitcnt vmcnt(2)
L_sf_52:
    buffer_load_dwordx4 v1, s[52:55], s97 offen offset:1024 nt lds
    s_waitcnt vmcnt(4)
    s_bitcmp0_b32 s14, 6
    s_cbranch_scc1 L_sf_53
    s_waitcnt vmcnt(3)
    s_bitcmp0_b32 s15, 6
    s_cbranch_scc1 L_sf_53
    s_waitcnt vmcnt(1)
L_sf_53:
    buffer_load_dwordx4 v1, s[52:55], s97 offen offset:2048 nt lds
    s_waitcnt vmcnt(4)
    s_bitcmp0_b32 s14, 7
    s_cbranch_scc1 L_sf_54
    s_waitcnt vmcnt(2)
    s_bitcmp0_b32 s15, 7
    s_cbranch_scc1 L_sf_54
    s_waitcnt vmcnt(1)
L_sf_54:
    buffer_load_dwordx4 v1, s[52:55], s97 offen offset:3072 nt lds
    s_add_u32 s97, s97, 32768
    v_add_u32 v1, 4096, v1
    v_and_b32 v1, 0x7fff, v1
L_k_join:
    s_waitcnt vmcnt(4)
    v_max3_u32 v38, v4, v5, v6
    v_max_u32 v38, v38, v7
    v_cmp_eq_u32 vcc, -1, v38
    s_cmp_lg_u32 s96, 0
    s_cbranch_scc1 L_qslow
    s_cbranch_vccnz L_qslow2
L_qok:
    v_dot2_f32_bf16 v8, v72, v4, 0
    v_dot2_f32_bf16 v9, v76, v4, 0
    v_dot2_f32_bf16 v10, v80, v4, 0
    v_dot2_f32_bf16 v11, v84, v4, 0
    v_dot2_f32_bf16 v24, v88, v4, 0
    v_dot2_f32_bf16 v25, v92, v4, 0
    v_dot2_f32_bf16 v26, v96, v4, 0
    v_dot2_f32_bf16 v27, v100, v4, 0
    v_dot2_f32_bf16 v8, v73, v5, v8
    v_dot2_f32_bf16 v9, v77, v5, v9
    v_dot2_f32_bf16 v10, v81, v5, v10
    v_dot2_f32_bf16 v11, v85, v5, v11
    v_dot2_f32_bf16 v24, v89, v5, v24
    v_dot2_f32_bf16 v25, v93, v5, v25
    v_dot2_f32_bf16 v26, v97, v5, v26
    v_dot2_f32_bf16 v27, v101, v5, v27
    v_dot2_f32_bf16 v8, v74, v6, v8
    v_dot2_f32_bf16 v9, v78, v6, v9
    v_dot2_f32_bf16 v10, v82, v6, v10
    v_dot2_f32_bf16 v11, v86, v6, v11
    v_dot2_f32_bf16 v24, v90, v6, v24
    v_dot2_f32_bf16 v25, v94, v6, v25
    v_dot2_f32_bf16 v26, v98, v6, v26
    v_dot2_f32_bf16 v27, v102, v6, v27
    v_dot2_f32_bf16 v8, v75, v7, v8
    v_dot2_f32_bf16 v9, v79, v7, v9
    v_dot2_f32_bf16 v10, v83, v7, v10
    v_dot2_f32_bf16 v11, v87, v7, v11
    v_dot2_f32_bf16 v24, v91, v7, v24
    v_dot2_f32_bf16 v25, v95, v7, v25
    v_dot2_f32_bf16 v26, v99, v7, v26
    v_dot2_f32_bf16 v27, v103, v7, v27
    v_add_f32_dpp v8, v8, v8 row_ror:8 row_mask:0xf bank_mask:0x3
    v_add_f32_dpp v10, v10, v10 row_ror:8 row_mask:0xf bank_mask:0x3
    v_add_f32_dpp v24, v24, v24 row_ror:8 row_mask:0xf bank_mask:0x3
    v_add_f32_dpp v26, v26, v26 row_ror:8 row_mask:0xf bank_mask:0x3
    v_add_f32_dpp v8, v9, v9 row_ror:8 row_mask:0xf bank_mask:0xc
    v_add_f32_dpp v10, v11, v11 row_ror:8 row_mask:0xf bank_mask:0xc
    v_add_f32_dpp v24, v25, v25 row_ror:8 row_mask:0xf bank_mask:0xc
    v_add_f32_dpp v26, v27, v27 row_ror:8 row_mask:0xf bank_mask:0xc
    v_add_f32_dpp v14, v8, v8 row_half_mirror row_mask:0xf bank_mask:0x5
    v_add_f32_dpp v15, v24, v24 row_half_mirror row_mask:0xf bank_mask:0x5
    v_add_f32_dpp v14, v10, v10 row_half_mirror row_mask:0xf bank_mask:0xa
    v_add_f32_dpp v15, v26, v26 row_half_mirror row_mask:0xf bank_mask:0xa
    s_nop 0
    v_add_f32_dpp v14, v14, v14 quad_perm:[1,0,3,2] row_mask:0xf bank_mask:0xf
    v_add_f32_dpp v15, v15, v15 quad_perm:[1,0,3,2] row_mask:0xf bank_mask:0xf
    s_nop 0
    v_add_f32_dpp v14, v14, v14 quad_perm:[2,3,0,1] row_mask:0xf bank_mask:0xf
    v_add_f32_dpp v15, v15, v15 quad_perm:[2,3,0,1] row_mask:0xf bank_mask:0xf
    s_waitcnt vmcnt(3)
    s_bitcmp0_b32 s14, 8
    s_cbranch_scc1 L_sf_65
    s_waitcnt vmcnt(2)
    s_bitcmp0_b32 s15, 8
    s_cbranch_scc1 L_sf_65
    s_waitcnt vmcnt(1)
L_sf_65:
    buffer_load_dwordx4 v[72:75], v1, s[52:55], s97 offen offset:0 nt
    v_dot2_f32_bf16 v8, v40, v4, 0
    v_dot2_f32_bf16 v9, v44, v4, 0
    v_dot2_f32_bf16 v10, v48, v4, 0
    v_dot2_f32_bf16 v11, v52, v4, 0
    v_dot2_f32_bf16 v24, v56, v4, 0
    v_dot2_f32_bf16 v25, v60, v4, 0
    v_dot2_f32_bf16 v26, v64, v4, 0
    v_dot2_f32_bf16 v27, v68, v4, 0
    v_dot2_f32_bf16 v28, v104, v4, 0
    v_dot2_f32_bf16 v29, v108, v4, 0
    v_dot2_f32_bf16 v30, v112, v4, 0
    v_dot2_f32_bf16 v31, v116, v4, 0
    v_dot2_f32_bf16 v8, v41, v5, v8
    v_dot2_f32_bf16 v9, v45, v5, v9
    v_dot2_f32_bf16 v10, v49, v5, v10
    v_dot2_f32_bf16 v11, v53, v5, v11
    v_dot2_f32_bf16 v24, v57, v5, v24
    v_dot2_f32_bf16 v25, v61, v5, v25
    v_dot2_f32_bf16 v26, v65, v5, v26
    v_dot2_f32_bf16 v27, v69, v5, v27
    v_dot2_f32_bf16 v28, v105, v5, v28
    v_dot2_f32_bf16 v29, v109, v5, v29
    v_dot2_f32_bf16 v30, v113, v5, v30
    v_dot2_f32_bf16 v31, v117, v5, v31
    v_dot2_f32_bf16 v8, v42, v6, v8
    v_dot2_f32_bf16 v9, v46, v6, v9
    v_dot2_f32_bf16 v10, v50, v6, v10
    v_dot2_f32_bf16 v11, v54, v6, v11
    v_dot2_f32_bf16 v24, v58, v6, v24
    v_dot2_f32_bf16 v25, v62, v6, v25
    v_dot2_f32_bf16 v26, v66, v6, v26
    v_dot2_f32_bf16 v27, v70, v6, v27
    v_dot2_f32_bf16 v28, v106, v6, v28
    v_dot2_f32_bf16 v29, v110, v6, v29
    v_dot2_f32_bf16 v30, v114, v6, v30
    v_dot2_f32_bf16 v31, v118, v6, v31
    v_dot2_f32_bf16 v8, v43, v7, v8
    v_dot2_f32_bf16 v9, v47, v7, v9
    v_dot2_f32_bf16 v10, v51, v7, v10
    v_dot2_f32_bf16 v11, v55, v7, v11
    v_dot2_f32_bf16 v24, v59, v7, v24
    v_dot2_f32_bf16 v25, v63, v7, v25
    v_dot2_f32_bf16 v26, v67, v7, v26
    v_dot2_f32_bf16 v27, v71, v7, v27
    v_dot2_f32_bf16 v28, v107, v7, v28
    v_dot2_f32_bf16 v29, v111, v7, v29
    v_dot2_f32_bf16 v30, v115, v7, v30
    v_dot2_f32_bf16 v31, v119, v7, v31
    v_add_f32_dpp v8, v8, v8 row_ror:8 row_mask:0xf bank_mask:0x3
    v_add_f32_dpp v10, v10, v10 row_ror:8 row_mask:0xf bank_mask:0x3
    v_add_f32_dpp v24, v24, v24 row_ror:8 row_mask:0xf bank_mask:0x3
    v_add_f32_dpp v26, v26, v26 row_ror:8 row_mask:0xf bank_mask:0x3
    v_add_f32_dpp v28, v28, v28 row_ror:8 row_mask:0xf bank_mask:0x3
    v_add_f32_dpp v30, v30, v30 row_ror:8 row_mask:0xf bank_mask:0x3
    v_add_f32_dpp v8, v9, v9 row_ror:8 row_mask:0xf bank_mask:0xc
    v_add_f32_dpp v10, v11, v11 row_ror:8 row_mask:0xf bank_mask:0xc
    v_add_f32_dpp v24, v25, v25 row_ror:8 row_mask:0xf bank_mask:0xc
    v_add_f32_dpp v26, v27, v27 row_ror:8 row_mask:0xf bank_mask:0xc
    v_add_f32_dpp v28, v29, v29 row_ror:8 row_mask:0xf bank_mask:0xc
    v_add_f32_dpp v30, v31, v31 row_ror:8 row_mask:0xf bank_mask:0xc
    v_add_f32_dpp v12, v8, v8 row_half_mirror row_mask:0xf bank_mask:0x5
    v_add_f32_dpp v13, v24, v24 row_half_mirror row_mask:0xf bank_mask:0x5
    v_add_f32_dpp v16, v28, v28 row_half_mirror row_mask:0xf bank_mask:0x5
    v_add_f32_dpp v12, v10, v10 row_half_mirror row_mask:0xf bank_mask:0xa
    v_add_f32_dpp v13, v26, v26 row_half_mirror row_mask:0xf bank_mask:0xa
    v_add_f32_dpp v16, v30, v30 row_half_mirror row_mask:0xf bank_mask:0xa
    v_add_f32_dpp v12, v12, v12 quad_perm:[1,0,3,2] row_mask:0xf bank_mask:0xf
    v_add_f32_dpp v13, v13, v13 quad_perm:[1,0,3,2] row_mask:0xf bank_mask:0xf
    v_add_f32_dpp v16, v16, v16 quad_perm:[1,0,3,2] row_mask:0xf bank_mask:0xf
    v_add_f32_dpp v12, v12, v12 quad_perm:[2,3,0,1] row_mask:0xf bank_mask:0xf
    v_add_f32_dpp v13, v13, v13 quad_perm:[2,3,0,1] row_mask:0xf bank_mask:0xf
    v_add_f32_dpp v16, v16, v16 quad_perm:[2,3,0,1] row_mask:0xf bank_mask:0xf
    s_waitcnt vmcnt(3)
    s_bitcmp0_b32 s14, 9
    s_cbranch_scc1 L_sf_66
    s_waitcnt vmcnt(2)
    s_bitcmp0_b32 s15, 9
    s_cbranch_scc1 L_sf_66
    s_waitcnt vmcnt(1)
L_sf_66:
    buffer_load_dwordx4 v[76:79], v1, s[52:55], s97 offen offset:1024 nt
    v_dot2_f32_bf16 v8, v120, v4, 0
    v_dot2_f32_bf16 v9, v124, v4, 0
    v_dot2_f32_bf16 v10, v128, v4, 0
    v_dot2_f32_bf16 v11, v132, v4, 0
    v_dot2_f32_bf16 v24, v136, v4, 0
    v_dot2_f32_bf16 v25, v140, v4, 0
    v_dot2_f32_bf16 v26, v144, v4, 0
    v_dot2_f32_bf16 v27, v148, v4, 0
    v_dot2_f32_bf16 v8, v121, v5, v8
    v_dot2_f32_bf16 v9, v125, v5, v9
    v_dot2_f32_bf16 v10, v129, v5, v10
    v_dot2_f32_bf16 v11, v133, v5, v11
    v_dot2_f32_bf16 v24, v137, v5, v24
    v_dot2_f32_bf16 v25, v141, v5, v25
    v_dot2_f32_bf16 v26, v145, v5, v26
    v_dot2_f32_bf16 v27, v149, v5, v27
    v_dot2_f32_bf16 v8, v122, v6, v8
    v_dot2_f32_bf16 v9, v126, v6, v9
    v_dot2_f32_bf16 v10, v130, v6, v10
    v_dot2_f32_bf16 v11, v134, v6, v11
    v_dot2_f32_bf16 v24, v138, v6, v24
    v_dot2_f32_bf16 v25, v142, v6, v25
    v_dot2_f32_bf16 v26, v146, v6, v26
    v_dot2_f32_bf16 v27, v150, v6, v27
    v_dot2_f32_bf16 v8, v123, v7, v8
    v_dot2_f32_bf16 v9, v127, v7, v9
    v_dot2_f32_bf16 v10, v131, v7, v10
    v_dot2_f32_bf16 v11, v135, v7, v11
    v_dot2_f32_bf16 v24, v139, v7, v24
    v_dot2_f32_bf16 v25, v143, v7, v25
    v_dot2_f32_bf16 v26, v147, v7, v26
    v_dot2_f32_bf16 v27, v151, v7, v27
    v_add_f32_dpp v8, v8, v8 row_ror:8 row_mask:0xf bank_mask:0x3
    v_add_f32_dpp v10, v10, v10 row_ror:8 row_mask:0xf bank_mask:0x3
    v_add_f32_dpp v24, v24, v24 row_ror:8 row_mask:0xf bank_mask:0x3
    v_add_f32_dpp v26, v26, v26 row_ror:8 row_mask:0xf bank_mask:0x3
    v_add_f32_dpp v8, v9, v9 row_ror:8 row_mask:0xf bank_mask:0xc
    v_add_f32_dpp v10, v11, v11 row_ror:8 row_mask:0xf bank_mask:0xc
    v_add_f32_dpp v24, v25, v25 row_ror:8 row_mask:0xf bank_mask:0xc
    v_add_f32_dpp v26, v27, v27 row_ror:8 row_mask:0xf bank_mask:0xc
    v_add_f32_dpp v17, v8, v8 row_half_mirror row_mask:0xf bank_mask:0x5
    v_add_f32_dpp v18, v24, v24 row_half_mirror row_mask:0xf bank_mask:0x5
    v_add_f32_dpp v17, v10, v10 row_half_mirror row_mask:0xf bank_mask:0xa
    v_add_f32_dpp v18, v26, v26 row_half_mirror row_mask:0xf bank_mask:0xa
    s_nop 0
    v_add_f32_dpp v17, v17, v17 quad_perm:[1,0,3,2] row_mask:0xf bank_mask:0xf
    v_add_f32_dpp v18, v18, v18 quad_perm:[1,0,3,2] row_mask:0xf bank_mask:0xf
    s_nop 0
    v_add_f32_dpp v17, v17, v17 quad_perm:[2,3,0,1] row_mask:0xf bank_mask:0xf
    v_add_f32_dpp v18, v18, v18 quad_perm:[2,3,0,1] row_mask:0xf bank_mask:0xf
    s_waitcnt vmcnt(3)
    s_bitcmp0_b32 s14, 10
    s_cbranch_scc1 L_sf_67
    s_waitcnt vmcnt(2)
    s_bitcmp0_b32 s15, 10
    s_cbranch_scc1 L_sf_67
    s_waitcnt vmcnt(1)
L_sf_67:
    buffer_load_dwordx4 v[80:83], v1, s[52:55], s97 offen offset:2048 nt
    s_waitcnt vmcnt(3)
    s_bitcmp0_b32 s14, 11
    s_cbranch_scc1 L_sf_68
    s_waitcnt vmcnt(2)
    s_bitcmp0_b32 s15, 11
    s_cbranch_scc1 L_sf_68
    s_waitcnt vmcnt(1)
L_sf_68:
    buffer_load_dwordx4 v[84:87], v1, s[52:55], s97 offen offset:3072 nt
    s_add_u32 s97, s97, 32768
    v_add_u32 v1, 4096, v1
    v_and_b32 v1, 0x7fff, v1
    s_cmp_eq_u32 s12, -1
    s_cbranch_scc1 L_nopfrd
    v_lshl_add_u32 v38, v0, 4, s12
    ds_read_b128 v[40:43], v38 offset:0
    ds_read_b128 v[44:47], v38 offset:1024
    ds_read_b128 v[48:51], v38 offset:2048
    ds_read_b128 v[52:55], v38 offset:3072
    ds_read_b128 v[56:59], v38 offset:4096
    ds_read_b128 v[60:63], v38 offset:5120
    ds_read_b128 v[64:67], v38 offset:6144
    ds_read_b128 v[68:71], v38 offset:7168
L_nopfrd:
    v_dot2_f32_bf16 v8, v152, v4, 0
    v_dot2_f32_bf16 v9, v156, v4, 0
    v_dot2_f32_bf16 v10, v160, v4, 0
    v_dot2_f32_bf16 v11, v164, v4, 0
    v_dot2_f32_bf16 v8, v153, v5, v8
    v_dot2_f32_bf16 v9, v157, v5, v9
    v_dot2_f32_bf16 v10, v161, v5, v10
    v_dot2_f32_bf16 v11, v165, v5, v11
    v_dot2_f32_bf16 v8, v154, v6, v8
    v_dot2_f32_bf16 v9, v158, v6, v9
    v_dot2_f32_bf16 v10, v162, v6, v10
    v_dot2_f32_bf16 v11, v166, v6, v11
    v_dot2_f32_bf16 v8, v155, v7, v8
    v_dot2_f32_bf16 v9, v159, v7, v9
    v_dot2_f32_bf16 v10, v163, v7, v10
    v_dot2_f32_bf16 v11, v167, v7, v11
    v_add_f32_dpp v8, v8, v8 row_ror:8 row_mask:0xf bank_mask:0x3
    s_nop 0
    v_add_f32_dpp v10, v10, v10 row_ror:8 row_mask:0xf bank_mask:0x3
    v_add_f32_dpp v8, v9, v9 row_ror:8 row_mask:0xf bank_mask:0xc
    v_add_f32_dpp v10, v11, v11 row_ror:8 row_mask:0xf bank_mask:0xc
    s_nop 0
    v_add_f32_dpp v19, v8, v8 row_half_mirror row_mask:0xf bank_mask:0x5
    v_add_f32_dpp v19, v10, v10 row_half_mirror row_mask:0xf bank_mask:0xa
    s_nop 1
    v_add_f32_dpp v19, v19, v19 quad_perm:[1,0,3,2] row_mask:0xf bank_mask:0xf
    s_nop 1
    v_add_f32_dpp v19, v19, v19 quad_perm:[2,3,0,1] row_mask:0xf bank_mask:0xf
    v_max3_f32 v3, v12, v13, v14
    v_max3_f32 v8, v15, v16, v17
    v_max3_f32 v3, v3, v18, v19
    v_max_f32 v3, v3, v8
    s_nop 1
    v_max_f32_dpp v3, v3, v3 row_ror:4 row_mask:0xf bank_mask:0xf
    s_nop 1
    v_max_f32_dpp v3, v3, v3 row_ror:8 row_mask:0xf bank_mask:0xf
    v_mov_b32 v8, v3
    s_nop 1
    v_permlane16_swap_b32 v3, v8
    v_max_f32 v3, v3, v8
    v_mov_b32 v8, v3
    s_nop 1
    v_permlane32_swap_b32 v3, v8
    v_max_f32 v3, v3, v8
    s_mov_b32 s96, 0x3e0293ee
    v_mul_f32 v8, s96, v3
    v_fma_f32 v12, v12, s96, -v8
    v_fma_f32 v13, v13, s96, -v8
    v_fma_f32 v14, v14, s96, -v8
    v_fma_f32 v15, v15, s96, -v8
    v_fma_f32 v16, v16, s96, -v8
    v_fma_f32 v17, v17, s96, -v8
    v_fma_f32 v18, v18, s96, -v8
    v_fma_f32 v19, v19, s96, -v8
    v_exp_f32 v12, v12
    v_exp_f32 v13, v13
    v_exp_f32 v14, v14
    v_exp_f32 v15, v15
    v_exp_f32 v16, v16
    v_exp_f32 v17, v17
    v_exp_f32 v18, v18
    v_exp_f32 v19, v19
    v_add_f32 v9, v12, v13
    v_add_f32 v10, v14, v15
    v_add_f32 v11, v16, v17
    v_add_f32 v3, v18, v19
    v_add_f32 v9, v9, v10
    v_add_f32 v3, v3, v11
    v_add_f32 v9, v9, v3
    v_cvt_pk_bf16_f32 v12, v12, v12
    v_cvt_pk_bf16_f32 v13, v13, v13
    v_cvt_pk_bf16_f32 v14, v14, v14
    v_cvt_pk_bf16_f32 v15, v15, v15
    v_cvt_pk_bf16_f32 v16, v16, v16
    v_cvt_pk_bf16_f32 v17, v17, v17
    v_cvt_pk_bf16_f32 v18, v18, v18
    v_cvt_pk_bf16_f32 v19, v19, v19
    v_add_f32_dpp v9, v9, v9 row_ror:4 row_mask:0xf bank_mask:0xf
    s_nop 1
    v_add_f32_dpp v9, v9, v9 row_ror:8 row_mask:0xf bank_mask:0xf
    v_mov_b32 v10, v9
    s_nop 1
    v_permlane16_swap_b32 v9, v10
    v_add_f32 v9, v9, v10
    v_mov_b32 v10, v9
    s_nop 1
    v_permlane32_swap_b32 v9, v10
    v_add_f32 v9, v9, v10
    s_mov_b64 exec, 1
    s_cmp_lg_u32 s13, 0
    s_cbranch_scc1 L_mljob
    s_lshl_b32 s96, s3, 3
    s_add_u32 s96, s96, 161920
    v_mov_b32 v10, s96
    v_mov_b32 v11, 162068
    v_mov_b32 v3, 1
    ds_write_b64 v10, v[8:9]
    ds_add_u32 v11, v3
L_mldone:
    s_mov_b64 exec, -1
    v_lshrrev_b32 v2, 1, v2
    v_and_b32_dpp v24, v14, v20 row_newbcast:0 row_mask:0xf bank_mask:0xf
    v_and_b32_dpp v25, v14, v21 row_newbcast:0 row_mask:0xf bank_mask:0xf
    v_and_b32_dpp v26, v14, v22 row_newbcast:0 row_mask:0xf bank_mask:0xf
    v_and_b32_dpp v27, v14, v23 row_newbcast:0 row_mask:0xf bank_mask:0xf
    s_waitcnt vmcnt(3)
    s_bitcmp0_b32 s14, 12
    s_cbranch_scc1 L_sf_69
    s_waitcnt vmcnt(2)
    s_bitcmp0_b32 s15, 12
    s_cbranch_scc1 L_sf_69
    s_waitcnt vmcnt(1)
L_sf_69:
    buffer_load_dwordx4 v[88:91], v1, s[52:55], s97 offen offset:0 nt
    v_mfma_f32_16x16x32_bf16 v[32:35], v[24:27], v[72:75], v[32:35]
    s_cmp_eq_u32 s12, -1
    s_cbranch_scc1 L_nopfpv8
    s_waitcnt lgkmcnt(0)
    v_and_b32_dpp v24, v12, v20 row_newbcast:0 row_mask:0xf bank_mask:0xf
    v_and_b32_dpp v25, v12, v21 row_newbcast:0 row_mask:0xf bank_mask:0xf
    v_and_b32_dpp v26, v12, v22 row_newbcast:0 row_mask:0xf bank_mask:0xf
    v_and_b32_dpp v27, v12, v23 row_newbcast:0 row_mask:0xf bank_mask:0xf
    s_nop 1
    v_mfma_f32_16x16x32_bf16 v[32:35], v[24:27], v[40:43], v[32:35]
    v_and_b32_dpp v28, v12, v20 row_newbcast:8 row_mask:0xf bank_mask:0xf
    v_and_b32_dpp v29, v12, v21 row_newbcast:8 row_mask:0xf bank_mask:0xf
    v_and_b32_dpp v30, v12, v22 row_newbcast:8 row_mask:0xf bank_mask:0xf
    v_and_b32_dpp v31, v12, v23 row_newbcast:8 row_mask:0xf bank_mask:0xf
    s_nop 1
    v_mfma_f32_16x16x32_bf16 v[32:35], v[28:31], v[44:47], v[32:35]
    v_and_b32_dpp v24, v12, v20 row_newbcast:4 row_mask:0xf bank_mask:0xf
    v_and_b32_dpp v25, v12, v21 row_newbcast:4 row_mask:0xf bank_mask:0xf
    v_and_b32_dpp v26, v12, v22 row_newbcast:4 row_mask:0xf bank_mask:0xf
    v_and_b32_dpp v27, v12, v23 row_newbcast:4 row_mask:0xf bank_mask:0xf
    s_nop 1
    v_mfma_f32_16x16x32_bf16 v[32:35], v[24:27], v[48:51], v[32:35]
    v_and_b32_dpp v28, v12, v20 row_newbcast:12 row_mask:0xf bank_mask:0xf
    v_and_b32_dpp v29, v12, v21 row_newbcast:12 row_mask:0xf bank_mask:0xf
    v_and_b32_dpp v30, v12, v22 row_newbcast:12 row_mask:0xf bank_mask:0xf
    v_and_b32_dpp v31, v12, v23 row_newbcast:12 row_mask:0xf bank_mask:0xf
    s_nop 1
    v_mfma_f32_16x16x32_bf16 v[32:35], v[28:31], v[52:55], v[32:35]
L_nopfpv8:
    v_and_b32_dpp v28, v14, v20 row_newbcast:8 row_mask:0xf bank_mask:0xf
    v_and_b32_dpp v29, v14, v21 row_newbcast:8 row_mask:0xf bank_mask:0xf
    v_and_b32_dpp v30, v14, v22 row_newbcast:8 row_mask:0xf bank_mask:0xf
    v_and_b32_dpp v31, v14, v23 row_newbcast:8 row_mask:0xf bank_mask:0xf
    s_waitcnt vmcnt(3)
    s_bitcmp0_b32 s14, 13
    s_cbranch_scc1 L_sf_70
    s_waitcnt vmcnt(2)
    s_bitcmp0_b32 s15, 13
    s_cbranch_scc1 L_sf_70
    s_waitcnt vmcnt(1)
L_sf_70:
    buffer_load_dwordx4 v[92:95], v1, s[52:55], s97 offen offset:1024 nt
    v_mfma_f32_16x16x32_bf16 v[32:35], v[28:31], v[76:79], v[32:35]
    s_cmp_eq_u32 s12, -1
    s_cbranch_scc1 L_nopfpv9
    s_waitcnt lgkmcnt(0)
    v_and_b32_dpp v24, v13, v20 row_newbcast:0 row_mask:0xf bank_mask:0xf
    v_and_b32_dpp v25, v13, v21 row_newbcast:0 row_mask:0xf bank_mask:0xf
    v_and_b32_dpp v26, v13, v22 row_newbcast:0 row_mask:0xf bank_mask:0xf
    v_and_b32_dpp v27, v13, v23 row_newbcast:0 row_mask:0xf bank_mask:0xf
    s_nop 1
    v_mfma_f32_16x16x32_bf16 v[32:35], v[24:27], v[56:59], v[32:35]
    v_and_b32_dpp v28, v13, v20 row_newbcast:8 row_mask:0xf bank_mask:0xf
    v_and_b32_dpp v29, v13, v21 row_newbcast:8 row_mask:0xf bank_mask:0xf
    v_and_b32_dpp v30, v13, v22 row_newbcast:8 row_mask:0xf bank_mask:0xf
    v_and_b32_dpp v31, v13, v23 row_newbcast:8 row_mask:0xf bank_mask:0xf
    s_nop 1
    v_mfma_f32_16x16x32_bf16 v[32:35], v[28:31], v[60:63], v[32:35]
    v_and_b32_dpp v24, v13, v20 row_newbcast:4 row_mask:0xf bank_mask:0xf
    v_and_b32_dpp v25, v13, v21 row_newbcast:4 row_mask:0xf bank_mask:0xf
    v_and_b32_dpp v26, v13, v22 row_newbcast:4 row_mask:0xf bank_mask:0xf
    v_and_b32_dpp v27, v13, v23 row_newbcast:4 row_mask:0xf bank_mask:0xf
    s_nop 1
    v_mfma_f32_16x16x32_bf16 v[32:35], v[24:27], v[64:67], v[32:35]
    v_and_b32_dpp v28, v13, v20 row_newbcast:12 row_mask:0xf bank_mask:0xf
    v_and_b32_dpp v29, v13, v21 row_newbcast:12 row_mask:0xf bank_mask:0xf
    v_and_b32_dpp v30, v13, v22 row_newbcast:12 row_mask:0xf bank_mask:0xf
    v_and_b32_dpp v31, v13, v23 row_newbcast:12 row_mask:0xf bank_mask:0xf
    s_nop 1
    v_mfma_f32_16x16x32_bf16 v[32:35], v[28:31], v[68:71], v[32:35]
L_nopfpv9:
    v_and_b32_dpp v24, v14, v20 row_newbcast:4 row_mask:0xf bank_mask:0xf
    v_and_b32_dpp v25, v14, v21 row_newbcast:4 row_mask:0xf bank_mask:0xf
    v_and_b32_dpp v26, v14, v22 row_newbcast:4 row_mask:0xf bank_mask:0xf
    v_and_b32_dpp v27, v14, v23 row_newbcast:4 row_mask:0xf bank_mask:0xf
    s_waitcnt vmcnt(3)
    s_bitcmp0_b32 s14, 14
    s_cbranch_scc1 L_sf_71
    s_waitcnt vmcnt(2)
    s_bitcmp0_b32 s15, 14
    s_cbranch_scc1 L_sf_71
    s_waitcnt vmcnt(1)
L_sf_71:
    buffer_load_dwordx4 v[96:99], v1, s[52:55], s97 offen offset:2048 nt
    v_mfma_f32_16x16x32_bf16 v[32:35], v[24:27], v[80:83], v[32:35]
    v_and_b32_dpp v28, v14, v20 row_newbcast:12 row_mask:0xf bank_mask:0xf
    v_and_b32_dpp v29, v14, v21 row_newbcast:12 row_mask:0xf bank_mask:0xf
    v_and_b32_dpp v30, v14, v22 row_newbcast:12 row_mask:0xf bank_mask:0xf
    v_and_b32_dpp v31, v14, v23 row_newbcast:12 row_mask:0xf bank_mask:0xf
    s_waitcnt vmcnt(3)
    s_bitcmp0_b32 s14, 15
    s_cbranch_scc1 L_sf_72
    s_waitcnt vmcnt(2)
    s_bitcmp0_b32 s15, 15
    s_cbranch_scc1 L_sf_72
    s_waitcnt vmcnt(1)
L_sf_72:
    buffer_load_dwordx4 v[100:103], v1, s[52:55], s97 offen offset:3072 nt
    s_add_u32 s97, s97, 32768
    v_add_u32 v1, 4096, v1
    v_and_b32 v1, 0x7fff, v1
    v_mfma_f32_16x16x32_bf16 v[32:35], v[28:31], v[84:87], v[32:35]
    v_and_b32_dpp v24, v15, v20 row_newbcast:0 row_mask:0xf bank_mask:0xf
    v_and_b32_dpp v25, v15, v21 row_newbcast:0 row_mask:0xf bank_mask:0xf
    v_and_b32_dpp v26, v15, v22 row_newbcast:0 row_mask:0xf bank_mask:0xf
    v_and_b32_dpp v27, v15, v23 row_newbcast:0 row_mask:0xf bank_mask:0xf
    s_waitcnt vmcnt(3)
    s_bitcmp0_b32 s14, 16
    s_cbranch_scc1 L_sf_73
    s_waitcnt vmcnt(2)
    s_bitcmp0_b32 s15, 16
    s_cbranch_scc1 L_sf_73
    s_waitcnt vmcnt(1)
L_sf_73:
    buffer_load_dwordx4 v[104:107], v1, s[52:55], s97 offen offset:0 nt
    v_mfma_f32_16x16x32_bf16 v[32:35], v[24:27], v[88:91], v[32:35]
    v_and_b32_dpp v28, v15, v20 row_newbcast:8 row_mask:0xf bank_mask:0xf
    v_and_b32_dpp v29, v15, v21 row_newbcast:8 row_mask:0xf bank_mask:0xf
    v_and_b32_dpp v30, v15, v22 row_newbcast:8 row_mask:0xf bank_mask:0xf
    v_and_b32_dpp v31, v15, v23 row_newbcast:8 row_mask:0xf bank_mask:0xf
    s_waitcnt vmcnt(3)
    s_bitcmp0_b32 s14, 17
    s_cbranch_scc1 L_sf_74
    s_waitcnt vmcnt(2)
    s_bitcmp0_b32 s15, 17
    s_cbranch_scc1 L_sf_74
    s_waitcnt vmcnt(1)
L_sf_74:
    buffer_load_dwordx4 v[108:111], v1, s[52:55], s97 offen offset:1024 nt
    v_mfma_f32_16x16x32_bf16 v[32:35], v[28:31], v[92:95], v[32:35]
    v_and_b32_dpp v24, v15, v20 row_newbcast:4 row_mask:0xf bank_mask:0xf
    v_and_b32_dpp v25, v15, v21 row_newbcast:4 row_mask:0xf bank_mask:0xf
    v_and_b32_dpp v26, v15, v22 row_newbcast:4 row_mask:0xf bank_mask:0xf
    v_and_b32_dpp v27, v15, v23 row_newbcast:4 row_mask:0xf bank_mask:0xf
    s_waitcnt vmcnt(3)
    s_bitcmp0_b32 s14, 18
    s_cbranch_scc1 L_sf_75
    s_waitcnt vmcnt(2)
    s_bitcmp0_b32 s15, 18
    s_cbranch_scc1 L_sf_75
    s_waitcnt vmcnt(1)
L_sf_75:
    buffer_load_dwordx4 v[112:115], v1, s[52:55], s97 offen offset:2048 nt
    v_mfma_f32_16x16x32_bf16 v[32:35], v[24:27], v[96:99], v[32:35]
    v_and_b32_dpp v28, v15, v20 row_newbcast:12 row_mask:0xf bank_mask:0xf
    v_and_b32_dpp v29, v15, v21 row_newbcast:12 row_mask:0xf bank_mask:0xf
    v_and_b32_dpp v30, v15, v22 row_newbcast:12 row_mask:0xf bank_mask:0xf
    v_and_b32_dpp v31, v15, v23 row_newbcast:12 row_mask:0xf bank_mask:0xf
    s_waitcnt vmcnt(3)
    s_bitcmp0_b32 s14, 19
    s_cbranch_scc1 L_sf_76
    s_waitcnt vmcnt(2)
    s_bitcmp0_b32 s15, 19
    s_cbranch_scc1 L_sf_76
    s_waitcnt vmcnt(1)
L_sf_76:
    buffer_load_dwordx4 v[116:119], v1, s[52:55], s97 offen offset:3072 nt
    s_add_u32 s97, s97, 32768
    v_add_u32 v1, 4096, v1
    v_and_b32 v1, 0x7fff, v1
    v_mfma_f32_16x16x32_bf16 v[32:35], v[28:31], v[100:103], v[32:35]
    v_and_b32_dpp v24, v16, v20 row_newbcast:0 row_mask:0xf bank_mask:0xf
    v_and_b32_dpp v25, v16, v21 row_newbcast:0 row_mask:0xf bank_mask:0xf
    v_and_b32_dpp v26, v16, v22 row_newbcast:0 row_mask:0xf bank_mask:0xf
    v_and_b32_dpp v27, v16, v23 row_newbcast:0 row_mask:0xf bank_mask:0xf
    s_waitcnt vmcnt(3)
    s_bitcmp0_b32 s14, 20
    s_cbranch_scc1 L_sf_77
    s_waitcnt vmcnt(2)
    s_bitcmp0_b32 s15, 20
    s_cbranch_scc1 L_sf_77
    s_waitcnt vmcnt(1)
L_sf_77:
    buffer_load_dwordx4 v[120:123], v1, s[52:55], s97 offen offset:0 nt
    v_mfma_f32_16x16x32_bf16 v[32:35], v[24:27], v[104:107], v[32:35]
    v_and_b32_dpp v28, v16, v20 row_newbcast:8 row_mask:0xf bank_mask:0xf
    v_and_b32_dpp v29, v16, v21 row_newbcast:8 row_mask:0xf bank_mask:0xf
    v_and_b32_dpp v30, v16, v22 row_newbcast:8 row_mask:0xf bank_mask:0xf
    v_and_b32_dpp v31, v16, v23 row_newbcast:8 row_mask:0xf bank_mask:0xf
    s_waitcnt vmcnt(3)
    s_bitcmp0_b32 s14, 21
    s_cbranch_scc1 L_sf_78
    s_waitcnt vmcnt(2)
    s_bitcmp0_b32 s15, 21
    s_cbranch_scc1 L_sf_78
    s_waitcnt vmcnt(1)
L_sf_78:
    buffer_load_dwordx4 v[124:127], v1, s[52:55], s97 offen offset:1024 nt
    v_mfma_f32_16x16x32_bf16 v[32:35], v[28:31], v[108:111], v[32:35]
    v_and_b32_dpp v24, v16, v20 row_newbcast:4 row_mask:0xf bank_mask:0xf
    v_and_b32_dpp v25, v16, v21 row_newbcast:4 row_mask:0xf bank_mask:0xf
    v_and_b32_dpp v26, v16, v22 row_newbcast:4 row_mask:0xf bank_mask:0xf
    v_and_b32_dpp v27, v16, v23 row_newbcast:4 row_mask:0xf bank_mask:0xf
    s_waitcnt vmcnt(3)
    s_bitcmp0_b32 s14, 22
    s_cbranch_scc1 L_sf_79
    s_waitcnt vmcnt(2)
    s_bitcmp0_b32 s15, 22
    s_cbranch_scc1 L_sf_79
    s_waitcnt vmcnt(1)
L_sf_79:
    buffer_load_dwordx4 v[128:131], v1, s[52:55], s97 offen offset:2048 nt
    v_mfma_f32_16x16x32_bf16 v[32:35], v[24:27], v[112:115], v[32:35]
    v_and_b32_dpp v28, v16, v20 row_newbcast:12 row_mask:0xf bank_mask:0xf
    v_and_b32_dpp v29, v16, v21 row_newbcast:12 row_mask:0xf bank_mask:0xf
    v_and_b32_dpp v30, v16, v22 row_newbcast:12 row_mask:0xf bank_mask:0xf
    v_and_b32_dpp v31, v16, v23 row_newbcast:12 row_mask:0xf bank_mask:0xf
    s_waitcnt vmcnt(3)
    s_bitcmp0_b32 s14, 23
    s_cbranch_scc1 L_sf_80
    s_waitcnt vmcnt(2)
    s_bitcmp0_b32 s15, 23
    s_cbranch_scc1 L_sf_80
    s_waitcnt vmcnt(1)
L_sf_80:
    buffer_load_dwordx4 v[132:135], v1, s[52:55], s97 offen offset:3072 nt
    s_add_u32 s97, s97, 32768
    v_add_u32 v1, 4096, v1
    v_and_b32 v1, 0x7fff, v1
    v_mfma_f32_16x16x32_bf16 v[32:35], v[28:31], v[116:119], v[32:35]
    v_and_b32_dpp v24, v17, v20 row_newbcast:0 row_mask:0xf bank_mask:0xf
    v_and_b32_dpp v25, v17, v21 row_newbcast:0 row_mask:0xf bank_mask:0xf
    v_and_b32_dpp v26, v17, v22 row_newbcast:0 row_mask:0xf bank_mask:0xf
    v_and_b32_dpp v27, v17, v23 row_newbcast:0 row_mask:0xf bank_mask:0xf
    s_waitcnt vmcnt(3)
    s_bitcmp0_b32 s14, 24
    s_cbranch_scc1 L_sf_81
    s_waitcnt vmcnt(2)
    s_bitcmp0_b32 s15, 24
    s_cbranch_scc1 L_sf_81
    s_waitcnt vmcnt(1)
L_sf_81:
    buffer_load_dwordx4 v[136:139], v1, s[52:55], s97 offen offset:0 nt
    v_mfma_f32_16x16x32_bf16 v[32:35], v[24:27], v[120:123], v[32:35]
    s_or_b32 s96, s59, s39
    s_cbranch_scc0 L_nofrag_82
    v_mov_b32 v104, 162060
L_lw_83:
    ds_read_b32 v105, v104
    s_waitcnt lgkmcnt(0)
    v_cmp_gt_u32 vcc, 4, v105
    s_cbranch_vccz L_lw_83e
    s_sleep 2
    s_sub_u32 s60, s60, 1
    s_cbranch_scc0 L_lw_83
    s_mov_b32 s60, 0
L_lw_83e:
    s_cmp_eq_u32 s59, 0
    s_cbranch_scc1 L_nofrag_82
    v_lshrrev_b32 v109, 4, v0
    v_bfe_u32 v104, v0, 1, 1
    v_lshl_add_u32 v104, v109, 1, v104
    v_bfe_u32 v110, v0, 2, 2
    v_lshl_add_u32 v104, v104, 3, v110
    v_lshlrev_b32 v104, 7, v104
    v_and_b32 v110, 1, v0
    v_lshl_add_u32 v104, v110, 3, v104
    s_lshr_b32 s63, s3, 1
    s_and_b32 s62, s3, 1
    s_lshl_b32 s96, s63, 14
    s_lshl_b32 s100, s62, 6
    s_add_u32 s100, s100, 81920
    s_add_u32 s96, s96, s100
    v_add_u32 v104, s96, v104
    ds_read_b64_tr_b16 v[72:73], v104 offset:0
    ds_read_b64_tr_b16 v[74:75], v104 offset:512
    ds_read_b64_tr_b16 v[76:77], v104 offset:16
    ds_read_b64_tr_b16 v[78:79], v104 offset:528
    ds_read_b64_tr_b16 v[80:81], v104 offset:32
    ds_read_b64_tr_b16 v[82:83], v104 offset:544
    ds_read_b64_tr_b16 v[84:85], v104 offset:48
    ds_read_b64_tr_b16 v[86:87], v104 offset:560
    ds_read_b64_tr_b16 v[88:89], v104 offset:8192
    ds_read_b64_tr_b16 v[90:91], v104 offset:8704
    ds_read_b64_tr_b16 v[92:93], v104 offset:8208
    ds_read_b64_tr_b16 v[94:95], v104 offset:8720
    ds_read_b64_tr_b16 v[96:97], v104 offset:8224
    ds_read_b64_tr_b16 v[98:99], v104 offset:8736
    ds_read_b64_tr_b16 v[100:101], v104 offset:8240
    ds_read_b64_tr_b16 v[102:103], v104 offset:8752
    v_bfe_u32 v105, v0, 1, 3
    v_lshlrev_b32 v105, 8, v105
    v_lshl_add_u32 v105, v109, 5, v105
    v_lshl_add_u32 v105, v110, 4, v105
    v_lshrrev_b32 v106, 3, v0
    v_lshlrev_b32 v106, 7, v106
    v_and_b32 v110, 7, v0
    v_lshl_add_u32 v107, v110, 3, v106
    v_add_u32 v107, s100, v107
    v_lshl_add_u32 v106, v110, 2, v106
    v_add_u32 v106, s96, v106
    v_lshlrev_b32 v108, 2, v0
    s_lshl_b32 s96, s62, 2
    s_add_u32 s96, s96, 162088
    v_mov_b32 v109, s96
    s_lshl_b32 s100, s63, 11
    s_lshl_b32 s96, s34, 13
    s_add_u32 s100, s100, s96
    s_add_u32 s100, s100, 90112
    s_mul_i32 s101, s34, 5120
    s_lshl_b32 s96, s35, 9
    s_add_u32 s101, s101, s96
    s_lshl_b32 s96, s62, 8
    s_add_u32 s101, s101, s96
    s_add_u32 s101, s101, 144384
L_nofrag_82:
    v_and_b32_dpp v28, v17, v20 row_newbcast:8 row_mask:0xf bank_mask:0xf
    v_and_b32_dpp v29, v17, v21 row_newbcast:8 row_mask:0xf bank_mask:0xf
    v_and_b32_dpp v30, v17, v22 row_newbcast:8 row_mask:0xf bank_mask:0xf
    v_and_b32_dpp v31, v17, v23 row_newbcast:8 row_mask:0xf bank_mask:0xf
    s_waitcnt vmcnt(3)
    s_bitcmp0_b32 s14, 25
    s_cbranch_scc1 L_sf_84
    s_waitcnt vmcnt(2)
    s_bitcmp0_b32 s15, 25
    s_cbranch_scc1 L_sf_84
    s_waitcnt vmcnt(1)
L_sf_84:
    buffer_load_dwordx4 v[140:143], v1, s[52:55], s97 offen offset:1024 nt
    v_mfma_f32_16x16x32_bf16 v[32:35], v[28:31], v[124:127], v[32:35]
    v_and_b32_dpp v24, v17, v20 row_newbcast:4 row_mask:0xf bank_mask:0xf
    v_and_b32_dpp v25, v17, v21 row_newbcast:4 row_mask:0xf bank_mask:0xf
    v_and_b32_dpp v26, v17, v22 row_newbcast:4 row_mask:0xf bank_mask:0xf
    v_and_b32_dpp v27, v17, v23 row_newbcast:4 row_mask:0xf bank_mask:0xf
    s_waitcnt vmcnt(3)
    s_bitcmp0_b32 s14, 26
    s_cbranch_scc1 L_sf_85
    s_waitcnt vmcnt(2)
    s_bitcmp0_b32 s15, 26
    s_cbranch_scc1 L_sf_85
    s_waitcnt vmcnt(1)
L_sf_85:
    buffer_load_dwordx4 v[144:147], v1, s[52:55], s97 offen offset:2048 nt
    v_mfma_f32_16x16x32_bf16 v[32:35], v[24:27], v[128:131], v[32:35]
    v_mov_b32 v10, 162076
    v_mov_b32 v11, 1
    s_mov_b64 exec, 1
    ds_add_u32 v10, v11
    s_mov_b64 exec, -1
    v_and_b32_dpp v28, v17, v20 row_newbcast:12 row_mask:0xf bank_mask:0xf
    v_and_b32_dpp v29, v17, v21 row_newbcast:12 row_mask:0xf bank_mask:0xf
    v_and_b32_dpp v30, v17, v22 row_newbcast:12 row_mask:0xf bank_mask:0xf
    v_and_b32_dpp v31, v17, v23 row_newbcast:12 row_mask:0xf bank_mask:0xf
    s_waitcnt vmcnt(3)
    s_bitcmp0_b32 s14, 27
    s_cbranch_scc1 L_sf_86
    s_waitcnt vmcnt(2)
    s_bitcmp0_b32 s15, 27
    s_cbranch_scc1 L_sf_86
    s_waitcnt vmcnt(1)
L_sf_86:
    buffer_load_dwordx4 v[148:151], v1, s[52:55], s97 offen offset:3072 nt
    s_add_u32 s97, s97, 32768
    v_add_u32 v1, 4096, v1
    v_and_b32 v1, 0x7fff, v1
    v_mfma_f32_16x16x32_bf16 v[32:35], v[28:31], v[132:135], v[32:35]
    v_and_b32_dpp v24, v18, v20 row_newbcast:0 row_mask:0xf bank_mask:0xf
    v_and_b32_dpp v25, v18, v21 row_newbcast:0 row_mask:0xf bank_mask:0xf
    v_and_b32_dpp v26, v18, v22 row_newbcast:0 row_mask:0xf bank_mask:0xf
    v_and_b32_dpp v27, v18, v23 row_newbcast:0 row_mask:0xf bank_mask:0xf
    s_waitcnt vmcnt(3)
    s_bitcmp0_b32 s14, 28
    s_cbranch_scc1 L_sf_87
    s_waitcnt vmcnt(2)
    s_bitcmp0_b32 s15, 28
    s_cbranch_scc1 L_sf_87
    s_waitcnt vmcnt(1)
L_sf_87:
    buffer_load_dwordx4 v[152:155], v1, s[52:55], s97 offen offset:0 nt
    v_mfma_f32_16x16x32_bf16 v[32:35], v[24:27], v[136:139], v[32:35]
    v_and_b32_dpp v28, v18, v20 row_newbcast:8 row_mask:0xf bank_mask:0xf
    v_and_b32_dpp v29, v18, v21 row_newbcast:8 row_mask:0xf bank_mask:0xf
    v_and_b32_dpp v30, v18, v22 row_newbcast:8 row_mask:0xf bank_mask:0xf
    v_and_b32_dpp v31, v18, v23 row_newbcast:8 row_mask:0xf bank_mask:0xf
    s_waitcnt vmcnt(3)
    s_bitcmp0_b32 s14, 29
    s_cbranch_scc1 L_sf_88
    s_waitcnt vmcnt(2)
    s_bitcmp0_b32 s15, 29
    s_cbranch_scc1 L_sf_88
    s_waitcnt vmcnt(1)
L_sf_88:
    buffer_load_dwordx4 v[156:159], v1, s[52:55], s97 offen offset:1024 nt
    v_mfma_f32_16x16x32_bf16 v[32:35], v[28:31], v[140:143], v[32:35]
    v_and_b32_dpp v24, v18, v20 row_newbcast:4 row_mask:0xf bank_mask:0xf
    v_and_b32_dpp v25, v18, v21 row_newbcast:4 row_mask:0xf bank_mask:0xf
    v_and_b32_dpp v26, v18, v22 row_newbcast:4 row_mask:0xf bank_mask:0xf
    v_and_b32_dpp v27, v18, v23 row_newbcast:4 row_mask:0xf bank_mask:0xf
    s_waitcnt vmcnt(3)
    s_bitcmp0_b32 s14, 30
    s_cbranch_scc1 L_sf_89
    s_waitcnt vmcnt(2)
    s_bitcmp0_b32 s15, 30
    s_cbranch_scc1 L_sf_89
    s_waitcnt vmcnt(1)
L_sf_89:
    buffer_load_dwordx4 v[160:163], v1, s[52:55], s97 offen offset:2048 nt
    v_mfma_f32_16x16x32_bf16 v[32:35], v[24:27], v[144:147], v[32:35]
    v_lshrrev_b32 v9, 4, v0
    v_lshl_add_u32 v8, v9, 2, v2
    s_lshl_b32 s96, s3, 9
    s_add_u32 s96, s96, 157824
    v_lshl_add_u32 v8, v8, 2, s96
    v_lshlrev_b32 v9, 3, v0
    v_add_u32 v9, 157824, v9
    v_mov_b32 v10, 162048
    v_mov_b32 v11, 1
    s_lshl_b32 s96, s38, 5
    s_add_u32 s96, s96, 161984
    v_mov_b32 v3, s96
    s_sub_u32 s62, 8, s39
    s_lshl_b32 s98, s34, 5
    s_add_u32 s98, s98, s35
    s_lshl_b32 s98, s98, 8
    s_add_u32 s98, s98, 90112
    v_lshlrev_b32 v39, 2, v0
    v_and_b32_dpp v28, v18, v20 row_newbcast:12 row_mask:0xf bank_mask:0xf
    v_and_b32_dpp v29, v18, v21 row_newbcast:12 row_mask:0xf bank_mask:0xf
    v_and_b32_dpp v30, v18, v22 row_newbcast:12 row_mask:0xf bank_mask:0xf
    v_and_b32_dpp v31, v18, v23 row_newbcast:12 row_mask:0xf bank_mask:0xf
    s_waitcnt vmcnt(3)
    s_bitcmp0_b32 s14, 31
    s_cbranch_scc1 L_sf_90
    s_waitcnt vmcnt(2)
    s_bitcmp0_b32 s15, 31
    s_cbranch_scc1 L_sf_90
    s_waitcnt vmcnt(1)
L_sf_90:
    buffer_load_dwordx4 v[164:167], v1, s[52:55], s97 offen offset:3072 nt
    s_mov_b32 s97, 0
    v_add_u32 v1, 4096, v1
    v_and_b32 v1, 0x7fff, v1
    v_mfma_f32_16x16x32_bf16 v[32:35], v[28:31], v[148:151], v[32:35]
    s_cmp_eq_u32 s12, -1
    s_cbranch_scc1 L_v_nopf
    v_and_b32_dpp v24, v19, v20 row_newbcast:0 row_mask:0xf bank_mask:0xf
    v_and_b32_dpp v25, v19, v21 row_newbcast:0 row_mask:0xf bank_mask:0xf
    v_and_b32_dpp v26, v19, v22 row_newbcast:0 row_mask:0xf bank_mask:0xf
    v_and_b32_dpp v27, v19, v23 row_newbcast:0 row_mask:0xf bank_mask:0xf
    s_waitcnt vmcnt(3)
    s_nop 0
    v_mfma_f32_16x16x32_bf16 v[32:35], v[24:27], v[152:155], v[32:35]
    v_and_b32_dpp v28, v19, v20 row_newbcast:8 row_mask:0xf bank_mask:0xf
    v_and_b32_dpp v29, v19, v21 row_newbcast:8 row_mask:0xf bank_mask:0xf
    v_and_b32_dpp v30, v19, v22 row_newbcast:8 row_mask:0xf bank_mask:0xf
    v_and_b32_dpp v31, v19, v23 row_newbcast:8 row_mask:0xf bank_mask:0xf
    s_waitcnt vmcnt(2)
    s_nop 0
    v_mfma_f32_16x16x32_bf16 v[32:35], v[28:31], v[156:159], v[32:35]
    v_and_b32_dpp v24, v19, v20 row_newbcast:4 row_mask:0xf bank_mask:0xf
    v_and_b32_dpp v25, v19, v21 row_newbcast:4 row_mask:0xf bank_mask:0xf
    v_and_b32_dpp v26, v19, v22 row_newbcast:4 row_mask:0xf bank_mask:0xf
    v_and_b32_dpp v27, v19, v23 row_newbcast:4 row_mask:0xf bank_mask:0xf
    s_waitcnt vmcnt(1)
    s_nop 0
    v_mfma_f32_16x16x32_bf16 v[32:35], v[24:27], v[160:163], v[32:35]
    v_and_b32_dpp v28, v19, v20 row_newbcast:12 row_mask:0xf bank_mask:0xf
    v_and_b32_dpp v29, v19, v21 row_newbcast:12 row_mask:0xf bank_mask:0xf
    v_and_b32_dpp v30, v19, v22 row_newbcast:12 row_mask:0xf bank_mask:0xf
    v_and_b32_dpp v31, v19, v23 row_newbcast:12 row_mask:0xf bank_mask:0xf
    s_waitcnt vmcnt(0)
    s_nop 0
    v_mfma_f32_16x16x32_bf16 v[32:35], v[28:31], v[164:167], v[32:35]
L_v_join:
    s_cmp_lg_u32 s13, 0
    s_cbranch_scc1 L_jobend
L_t0:
    s_mov_b32 exec_hi, 0
    s_nop 4
    ds_write_b128 v8, v[32:35]
L_t0b:
    s_mov_b64 exec, 1
    ds_add_rtn_u32 v37, v10, v11
    s_mov_b64 exec, -1
    ds_read_b32 v38, v10 offset:24
    ds_read_b128 v[24:27], v3
    ds_read_b128 v[28:31], v3 offset:16
    ds_read_b64 v[144:145], v9 offset:0
    ds_read_b64 v[146:147], v9 offset:512
    ds_read_b64 v[148:149], v9 offset:1024
    ds_read_b64 v[150:151], v9 offset:1536
    ds_read_b64 v[152:153], v9 offset:2048
    ds_read_b64 v[154:155], v9 offset:2560
    ds_read_b64 v[156:157], v9 offset:3072
    ds_read_b64 v[158:159], v9 offset:3584
    s_waitcnt lgkmcnt(10)
    v_readfirstlane_b32 s96, v37
    v_readfirstlane_b32 s61, v38
    s_cmp_lg_u32 s96, s62
    s_cbranch_scc1 L_nopub
    s_waitcnt lgkmcnt(6)
    v_pk_mul_f32 v[144:145], v[144:145], v[24:25] op_sel:[0,0] op_sel_hi:[1,0]
    v_pk_mul_f32 v[146:147], v[146:147], v[24:25] op_sel:[0,1] op_sel_hi:[1,1]
    s_waitcnt lgkmcnt(4)
    v_pk_fma_f32 v[144:145], v[148:149], v[26:27], v[144:145] op_sel:[0,0,0] op_sel_hi:[1,0,1]
    v_pk_fma_f32 v[146:147], v[150:151], v[26:27], v[146:147] op_sel:[0,1,0] op_sel_hi:[1,1,1]
    s_waitcnt lgkmcnt(2)
    v_pk_fma_f32 v[144:145], v[152:153], v[28:29], v[144:145] op_sel:[0,0,0] op_sel_hi:[1,0,1]
    v_pk_fma_f32 v[146:147], v[154:155], v[28:29], v[146:147] op_sel:[0,1,0] op_sel_hi:[1,1,1]
    s_waitcnt lgkmcnt(0)
    v_pk_fma_f32 v[144:145], v[156:157], v[30:31], v[144:145] op_sel:[0,0,0] op_sel_hi:[1,0,1]
    v_pk_fma_f32 v[146:147], v[158:159], v[30:31], v[146:147] op_sel:[0,1,0] op_sel_hi:[1,1,1]
    s_cmp_eq_u32 s61, 1
    v_pk_add_f32 v[144:145], v[144:145], v[146:147]
    v_cvt_pk_bf16_f32 v32, v144, v145
    s_cbranch_scc0 L_oslow
    buffer_store_dword v32, v39, s[40:43], s98 offen
L_odone:
L_nopub:
    s_cmp_eq_u32 s59, 0
    s_cbranch_scc1 L_not1
L_poll_99:
    buffer_load_dwordx4 v[16:19], v105, s[40:43], s100 offen sc1
    buffer_load_dwordx4 v[20:23], v105, s[40:43], s100 offen offset:128 sc1
    s_sub_u32 s60, s60, 1
    s_cbranch_scc1 L_poll_99t
    s_waitcnt vmcnt(0)
    v_max3_u32 v38, v16, v17, v18
    v_max3_u32 v38, v38, v19, v20
    v_max3_u32 v38, v38, v21, v22
    v_max_u32 v38, v38, v23
    v_cmp_eq_u32 vcc, -1, v38
    s_cbranch_vccnz L_poll_99
L_poll_99e:
    v_mfma_f32_16x16x32_bf16 v[112:115], v[16:19], v[72:75], 0
    v_mfma_f32_16x16x32_bf16 v[120:123], v[16:19], v[80:83], 0
    v_mfma_f32_16x16x32_bf16 v[116:119], v[16:19], v[76:79], 0
    v_mfma_f32_16x16x32_bf16 v[124:127], v[16:19], v[84:87], 0
    v_mfma_f32_16x16x32_bf16 v[112:115], v[20:23], v[88:91], v[112:115]
    v_mfma_f32_16x16x32_bf16 v[120:123], v[20:23], v[96:99], v[120:123]
    v_mfma_f32_16x16x32_bf16 v[116:119], v[20:23], v[92:95], v[116:119]
    v_mfma_f32_16x16x32_bf16 v[124:127], v[20:23], v[100:103], v[124:127]
    s_nop 4
    v_pk_add_f32 v[112:113], v[112:113], v[114:115]
    v_pk_add_f32 v[120:121], v[120:121], v[122:123]
    v_pk_add_f32 v[116:117], v[116:117], v[118:119]
    v_pk_add_f32 v[124:125], v[124:125], v[126:127]
    v_add_f32_dpp v12, v113, v112 row_ror:8 row_mask:0xf bank_mask:0x3
    v_add_f32_dpp v12, v120, v121 row_ror:8 row_mask:0xf bank_mask:0xc
    v_add_f32_dpp v13, v117, v116 row_ror:8 row_mask:0xf bank_mask:0x3
    v_add_f32_dpp v13, v124, v125 row_ror:8 row_mask:0xf bank_mask:0xc
    ds_write2_b32 v106, v12, v13 offset0:0 offset1:8
    s_mov_b64 exec, 1
    ds_add_rtn_u32 v37, v109, v11
    s_mov_b64 exec, -1
    ds_read_b64 v[72:73], v107 offset:0
    ds_read_b64 v[74:75], v107 offset:16384
    ds_read_b64 v[76:77], v107 offset:32768
    ds_read_b64 v[78:79], v107 offset:49152
    s_cmp_eq_u32 s34, 2
    s_cselect_b32 s97, s61, 0
    s_waitcnt lgkmcnt(4)
    v_readfirstlane_b32 s96, v37
    s_waitcnt lgkmcnt(2)
    v_pk_add_f32 v[72:73], v[72:73], v[74:75]
    s_cmp_lg_u32 s96, 3
    s_cbranch_scc1 L_not1
    s_cmp_eq_u32 s97, 1
    s_waitcnt lgkmcnt(0)
    v_pk_add_f32 v[76:77], v[76:77], v[78:79]
    v_pk_add_f32 v[72:73], v[72:73], v[76:77]
    v_cvt_pk_bf16_f32 v12, v72, v73
    s_cbranch_scc1 L_pfast
    buffer_store_dword v12, v108, s[40:43], s101 offen sc1
L_pdone:
L_not1:
    s_waitcnt lgkmcnt(0)
    s_cmp_eq_u32 s39, 1
    s_cbranch_scc1 L_s_role
    s_endpgm
L_k_nopf:
    s_waitcnt vmcnt(3)
    s_bitcmp0_b32 s57, 22
    s_cbranch_scc1 L_sf_55
    s_waitcnt vmcnt(2)
    s_bitcmp0_b32 s58, 22
    s_cbranch_scc1 L_sf_55
    s_waitcnt vmcnt(1)
L_sf_55:
    buffer_load_dwordx4 v[128:131], v1, s[48:51], s97 offen offset:2048 nt
    v_min_u32 v39, 29, v0
    v_lshlrev_b32 v39, 2, v39
    buffer_load_dword v37, v39, s[44:47], 0 offen sc1
    s_waitcnt vmcnt(4)
    s_bitcmp0_b32 s57, 23
    s_cbranch_scc1 L_sf_56
    s_waitcnt vmcnt(3)
    s_bitcmp0_b32 s58, 23
    s_cbranch_scc1 L_sf_56
    s_waitcnt vmcnt(2)
L_sf_56:
    buffer_load_dwordx4 v[132:135], v1, s[48:51], s97 offen offset:3072 nt
    s_add_u32 s97, s97, 32768
    v_add_u32 v1, 4096, v1
    v_and_b32 v1, 0x7fff, v1
    s_waitcnt vmcnt(4)
    s_bitcmp0_b32 s57, 24
    s_cbranch_scc1 L_sf_57
    s_waitcnt vmcnt(3)
    s_bitcmp0_b32 s58, 24
    s_cbranch_scc1 L_sf_57
    s_waitcnt vmcnt(2)
L_sf_57:
    buffer_load_dwordx4 v[136:139], v1, s[48:51], s97 offen offset:0 nt
    s_waitcnt vmcnt(4)
    s_bitcmp0_b32 s57, 25
    s_cbranch_scc1 L_sf_58
    s_waitcnt vmcnt(3)
    s_bitcmp0_b32 s58, 25
    s_cbranch_scc1 L_sf_58
    s_waitcnt vmcnt(1)
L_sf_58:
    buffer_load_dwordx4 v[140:143], v1, s[48:51], s97 offen offset:1024 nt
    s_waitcnt vmcnt(4)
    s_bitcmp0_b32 s57, 26
    s_cbranch_scc1 L_sf_59
    s_waitcnt vmcnt(2)
    s_bitcmp0_b32 s58, 26
    s_cbranch_scc1 L_sf_59
    s_waitcnt vmcnt(1)
L_sf_59:
    buffer_load_dwordx4 v[144:147], v1, s[48:51], s97 offen offset:2048 nt
    s_waitcnt vmcnt(3)
    s_bitcmp0_b32 s57, 27
    s_cbranch_scc1 L_sf_60
    s_waitcnt vmcnt(2)
    s_bitcmp0_b32 s58, 27
    s_cbranch_scc1 L_sf_60
    s_waitcnt vmcnt(1)
L_sf_60:
    buffer_load_dwordx4 v[148:151], v1, s[48:51], s97 offen offset:3072 nt
    s_add_u32 s97, s97, 32768
    v_add_u32 v1, 4096, v1
    v_and_b32 v1, 0x7fff, v1
    v_cmp_eq_u32 vcc, 0, v37
    s_nop 0
    s_or_b32 s96, vcc_lo, vcc_hi
    buffer_load_dwordx4 v[4:7], v2, s[40:43], s98 offen sc1
    s_waitcnt vmcnt(4)
    s_bitcmp0_b32 s57, 28
    s_cbranch_scc1 L_sf_61
    s_waitcnt vmcnt(3)
    s_bitcmp0_b32 s58, 28
    s_cbranch_scc1 L_sf_61
    s_waitcnt vmcnt(2)
L_sf_61:
    buffer_load_dwordx4 v[152:155], v1, s[48:51], s97 offen offset:0 nt
    s_waitcnt vmcnt(4)
    s_bitcmp0_b32 s57, 29
    s_cbranch_scc1 L_sf_62
    s_waitcnt vmcnt(3)
    s_bitcmp0_b32 s58, 29
    s_cbranch_scc1 L_sf_62
    s_waitcnt vmcnt(2)
L_sf_62:
    buffer_load_dwordx4 v[156:159], v1, s[48:51], s97 offen offset:1024 nt
    s_waitcnt vmcnt(4)
    s_bitcmp0_b32 s57, 30
    s_cbranch_scc1 L_sf_63
    s_waitcnt vmcnt(3)
    s_bitcmp0_b32 s58, 30
    s_cbranch_scc1 L_sf_63
    s_waitcnt vmcnt(1)
L_sf_63:
    buffer_load_dwordx4 v[160:163], v1, s[48:51], s97 offen offset:2048 nt
    s_waitcnt vmcnt(4)
    s_bitcmp0_b32 s57, 31
    s_cbranch_scc1 L_sf_64
    s_waitcnt vmcnt(2)
    s_bitcmp0_b32 s58, 31
    s_cbranch_scc1 L_sf_64
    s_waitcnt vmcnt(1)
L_sf_64:
    buffer_load_dwordx4 v[164:167], v1, s[48:51], s97 offen offset:3072 nt
    s_mov_b32 s97, 0
    v_add_u32 v1, 4096, v1
    v_and_b32 v1, 0x7fff, v1
    v_add_u32 v1, 8192, v1
    v_and_b32 v1, 0x7fff, v1
    s_mov_b32 s97, 65536
    s_branch L_k_join
L_v_nopf:
    v_and_b32_dpp v24, v19, v20 row_newbcast:0 row_mask:0xf bank_mask:0xf
    v_and_b32_dpp v25, v19, v21 row_newbcast:0 row_mask:0xf bank_mask:0xf
    v_and_b32_dpp v26, v19, v22 row_newbcast:0 row_mask:0xf bank_mask:0xf
    v_and_b32_dpp v27, v19, v23 row_newbcast:0 row_mask:0xf bank_mask:0xf
    s_waitcnt vmcnt(3)
    s_bitcmp0_b32 s14, 0
    s_cbranch_scc1 L_sf_91
    s_waitcnt vmcnt(2)
    s_bitcmp0_b32 s15, 0
    s_cbranch_scc1 L_sf_91
    s_waitcnt vmcnt(1)
L_sf_91:
    buffer_load_dwordx4 v[40:43], v1, s[52:55], s97 offen offset:0 nt
    v_mfma_f32_16x16x32_bf16 v[32:35], v[24:27], v[152:155], v[32:35]
    v_and_b32_dpp v28, v19, v20 row_newbcast:8 row_mask:0xf bank_mask:0xf
    v_and_b32_dpp v29, v19, v21 row_newbcast:8 row_mask:0xf bank_mask:0xf
    v_and_b32_dpp v30, v19, v22 row_newbcast:8 row_mask:0xf bank_mask:0xf
    v_and_b32_dpp v31, v19, v23 row_newbcast:8 row_mask:0xf bank_mask:0xf
    s_waitcnt vmcnt(3)
    s_bitcmp0_b32 s14, 1
    s_cbranch_scc1 L_sf_92
    s_waitcnt vmcnt(2)
    s_bitcmp0_b32 s15, 1
    s_cbranch_scc1 L_sf_92
    s_waitcnt vmcnt(1)
L_sf_92:
    buffer_load_dwordx4 v[44:47], v1, s[52:55], s97 offen offset:1024 nt
    v_mfma_f32_16x16x32_bf16 v[32:35], v[28:31], v[156:159], v[32:35]
    v_and_b32_dpp v24, v19, v20 row_newbcast:4 row_mask:0xf bank_mask:0xf
    v_and_b32_dpp v25, v19, v21 row_newbcast:4 row_mask:0xf bank_mask:0xf
    v_and_b32_dpp v26, v19, v22 row_newbcast:4 row_mask:0xf bank_mask:0xf
    v_and_b32_dpp v27, v19, v23 row_newbcast:4 row_mask:0xf bank_mask:0xf
    s_waitcnt vmcnt(3)
    s_bitcmp0_b32 s14, 2
    s_cbranch_scc1 L_sf_93
    s_waitcnt vmcnt(2)
    s_bitcmp0_b32 s15, 2
    s_cbranch_scc1 L_sf_93
    s_waitcnt vmcnt(1)
L_sf_93:
    buffer_load_dwordx4 v[48:51], v1, s[52:55], s97 offen offset:2048 nt
    v_mfma_f32_16x16x32_bf16 v[32:35], v[24:27], v[160:163], v[32:35]
    v_and_b32_dpp v28, v19, v20 row_newbcast:12 row_mask:0xf bank_mask:0xf
    v_and_b32_dpp v29, v19, v21 row_newbcast:12 row_mask:0xf bank_mask:0xf
    v_and_b32_dpp v30, v19, v22 row_newbcast:12 row_mask:0xf bank_mask:0xf
    v_and_b32_dpp v31, v19, v23 row_newbcast:12 row_mask:0xf bank_mask:0xf
    s_waitcnt vmcnt(3)
    s_bitcmp0_b32 s14, 3
    s_cbranch_scc1 L_sf_94
    s_waitcnt vmcnt(2)
    s_bitcmp0_b32 s15, 3
    s_cbranch_scc1 L_sf_94
    s_waitcnt vmcnt(1)
L_sf_94:
    buffer_load_dwordx4 v[52:55], v1, s[52:55], s97 offen offset:3072 nt
    s_add_u32 s97, s97, 32768
    v_add_u32 v1, 4096, v1
    v_and_b32 v1, 0x7fff, v1
    v_mfma_f32_16x16x32_bf16 v[32:35], v[28:31], v[164:167], v[32:35]
    v_and_b32_dpp v24, v12, v20 row_newbcast:0 row_mask:0xf bank_mask:0xf
    v_and_b32_dpp v25, v12, v21 row_newbcast:0 row_mask:0xf bank_mask:0xf
    v_and_b32_dpp v26, v12, v22 row_newbcast:0 row_mask:0xf bank_mask:0xf
    v_and_b32_dpp v27, v12, v23 row_newbcast:0 row_mask:0xf bank_mask:0xf
    s_waitcnt vmcnt(3)
    s_bitcmp0_b32 s14, 4
    s_cbranch_scc1 L_sf_95
    s_waitcnt vmcnt(2)
    s_bitcmp0_b32 s15, 4
    s_cbranch_scc1 L_sf_95
    s_waitcnt vmcnt(1)
L_sf_95:
    buffer_load_dwordx4 v[56:59], v1, s[52:55], s97 offen offset:0 nt
    v_mfma_f32_16x16x32_bf16 v[32:35], v[24:27], v[40:43], v[32:35]
    v_and_b32_dpp v28, v12, v20 row_newbcast:8 row_mask:0xf bank_mask:0xf
    v_and_b32_dpp v29, v12, v21 row_newbcast:8 row_mask:0xf bank_mask:0xf
    v_and_b32_dpp v30, v12, v22 row_newbcast:8 row_mask:0xf bank_mask:0xf
    v_and_b32_dpp v31, v12, v23 row_newbcast:8 row_mask:0xf bank_mask:0xf
    s_waitcnt vmcnt(3)
    s_bitcmp0_b32 s14, 5
    s_cbranch_scc1 L_sf_96
    s_waitcnt vmcnt(2)
    s_bitcmp0_b32 s15, 5
    s_cbranch_scc1 L_sf_96
    s_waitcnt vmcnt(1)
L_sf_96:
    buffer_load_dwordx4 v[60:63], v1, s[52:55], s97 offen offset:1024 nt
    v_mfma_f32_16x16x32_bf16 v[32:35], v[28:31], v[44:47], v[32:35]
    v_and_b32_dpp v24, v12, v20 row_newbcast:4 row_mask:0xf bank_mask:0xf
    v_and_b32_dpp v25, v12, v21 row_newbcast:4 row_mask:0xf bank_mask:0xf
    v_and_b32_dpp v26, v12, v22 row_newbcast:4 row_mask:0xf bank_mask:0xf
    v_and_b32_dpp v27, v12, v23 row_newbcast:4 row_mask:0xf bank_mask:0xf
    s_waitcnt vmcnt(3)
    s_bitcmp0_b32 s14, 6
    s_cbranch_scc1 L_sf_97
    s_waitcnt vmcnt(2)
    s_bitcmp0_b32 s15, 6
    s_cbranch_scc1 L_sf_97
    s_waitcnt vmcnt(1)
L_sf_97:
    buffer_load_dwordx4 v[64:67], v1, s[52:55], s97 offen offset:2048 nt
    v_mfma_f32_16x16x32_bf16 v[32:35], v[24:27], v[48:51], v[32:35]
    v_and_b32_dpp v28, v12, v20 row_newbcast:12 row_mask:0xf bank_mask:0xf
    v_and_b32_dpp v29, v12, v21 row_newbcast:12 row_mask:0xf bank_mask:0xf
    v_and_b32_dpp v30, v12, v22 row_newbcast:12 row_mask:0xf bank_mask:0xf
    v_and_b32_dpp v31, v12, v23 row_newbcast:12 row_mask:0xf bank_mask:0xf
    s_waitcnt vmcnt(3)
    s_bitcmp0_b32 s14, 7
    s_cbranch_scc1 L_sf_98
    s_waitcnt vmcnt(2)
    s_bitcmp0_b32 s15, 7
    s_cbranch_scc1 L_sf_98
    s_waitcnt vmcnt(1)
L_sf_98:
    buffer_load_dwordx4 v[68:71], v1, s[52:55], s97 offen offset:3072 nt
    s_add_u32 s97, s97, 32768
    v_add_u32 v1, 4096, v1
    v_and_b32 v1, 0x7fff, v1
    v_mfma_f32_16x16x32_bf16 v[32:35], v[28:31], v[52:55], v[32:35]
    v_and_b32_dpp v24, v13, v20 row_newbcast:0 row_mask:0xf bank_mask:0xf
    v_and_b32_dpp v25, v13, v21 row_newbcast:0 row_mask:0xf bank_mask:0xf
    v_and_b32_dpp v26, v13, v22 row_newbcast:0 row_mask:0xf bank_mask:0xf
    v_and_b32_dpp v27, v13, v23 row_newbcast:0 row_mask:0xf bank_mask:0xf
    s_waitcnt vmcnt(3)
    s_nop 0
    v_mfma_f32_16x16x32_bf16 v[32:35], v[24:27], v[56:59], v[32:35]
    v_and_b32_dpp v28, v13, v20 row_newbcast:8 row_mask:0xf bank_mask:0xf
    v_and_b32_dpp v29, v13, v21 row_newbcast:8 row_mask:0xf bank_mask:0xf
    v_and_b32_dpp v30, v13, v22 row_newbcast:8 row_mask:0xf bank_mask:0xf
    v_and_b32_dpp v31, v13, v23 row_newbcast:8 row_mask:0xf bank_mask:0xf
    s_waitcnt vmcnt(2)
    s_nop 0
    v_mfma_f32_16x16x32_bf16 v[32:35], v[28:31], v[60:63], v[32:35]
    v_and_b32_dpp v24, v13, v20 row_newbcast:4 row_mask:0xf bank_mask:0xf
    v_and_b32_dpp v25, v13, v21 row_newbcast:4 row_mask:0xf bank_mask:0xf
    v_and_b32_dpp v26, v13, v22 row_newbcast:4 row_mask:0xf bank_mask:0xf
    v_and_b32_dpp v27, v13, v23 row_newbcast:4 row_mask:0xf bank_mask:0xf
    s_waitcnt vmcnt(1)
    s_nop 0
    v_mfma_f32_16x16x32_bf16 v[32:35], v[24:27], v[64:67], v[32:35]
    v_and_b32_dpp v28, v13, v20 row_newbcast:12 row_mask:0xf bank_mask:0xf
    v_and_b32_dpp v29, v13, v21 row_newbcast:12 row_mask:0xf bank_mask:0xf
    v_and_b32_dpp v30, v13, v22 row_newbcast:12 row_mask:0xf bank_mask:0xf
    v_and_b32_dpp v31, v13, v23 row_newbcast:12 row_mask:0xf bank_mask:0xf
    s_waitcnt vmcnt(0)
    s_nop 0
    v_mfma_f32_16x16x32_bf16 v[32:35], v[28:31], v[68:71], v[32:35]
    s_branch L_v_join
L_oslow:
    buffer_store_dword v32, v39, s[40:43], s98 offen sc1
    s_branch L_odone
L_qslow:
L_wy_100:
    buffer_load_dword v37, v39, s[44:47], 0 offen sc1
    s_waitcnt vmcnt(0)
    v_cmp_ne_u32 vcc, -1, v37
    s_cbranch_vccz L_wy_100e
    s_sleep 4
    s_sub_u32 s60, s60, 1
    s_cbranch_scc0 L_wy_100
    s_mov_b32 s60, 0
L_wy_100e:
L_qslow2:
    s_branch L_poll_101
L_poll_101s:
    s_sleep 2
L_poll_101:
    buffer_load_dwordx4 v[4:7], v2, s[40:43], s98 offen sc1
    s_sub_u32 s60, s60, 1
    s_cbranch_scc1 L_poll_101t
    s_waitcnt vmcnt(0)
    v_max3_u32 v38, v4, v5, v6
    v_max_u32 v38, v38, v7
    v_cmp_eq_u32 vcc, -1, v38
    s_cbranch_vccnz L_poll_101s
L_poll_101e:
    s_branch L_qok
L_mljob:
    s_lshl_b32 s96, s38, 3
    s_add_u32 s96, s96, s3
    s_lshl3_add_u32 s96, s96, s99
    buffer_store_dwordx2 v[8:9], v36, s[40:43], s96 offen sc1
    s_branch L_mldone
L_service:
    v_mov_b32 v72, 0
    v_mov_b32 v73, 0
    v_mov_b32 v74, 0
    v_mov_b32 v75, 0
    v_mov_b32 v76, 0
    s_mov_b32 s59, 0
    v_mov_b32 v5, 0
    v_mov_b32 v105, 0
    v_mov_b32 v108, 0
    v_mov_b32 v160, 0
    v_mov_b32 v8, 162068
L_lw_102:
    ds_read_b32 v9, v8
    s_waitcnt lgkmcnt(0)
    v_cmp_gt_u32 vcc, 8, v9
    s_cbranch_vccz L_lw_102e
    s_sleep 8
    s_sub_u32 s60, s60, 1
    s_cbranch_scc0 L_lw_102
    s_mov_b32 s60, 0
L_lw_102e:
    v_and_b32 v2, 15, v0
    v_lshlrev_b32 v2, 3, v2
    v_add_u32 v3, 161920, v2
    ds_read_b64 v[8:9], v3
    s_lshl_b32 s99, s37, 5
    s_add_u32 s99, s99, s36
    s_lshl_b32 s99, s99, 7
    s_add_u32 s99, s99, 73728
    s_lshl_b32 s62, s38, 6
    s_add_u32 s62, s62, s99
    s_getreg_b32 s58, hwreg(HW_REG_XCC_ID, 0, 4)
    v_mov_b32 v10, s58
    s_lshl_b32 s98, s34, 5
    s_add_u32 s98, s98, s35
    s_lshl_b32 s63, s98, 2
    s_add_u32 s63, s63, 229376
    s_lshl_b32 s98, s98, 8
    s_add_u32 s98, s98, 90112
    v_lshlrev_b32 v39, 2, v0
    s_bfm_b64 exec, 8, 0
    s_waitcnt lgkmcnt(0)
    buffer_store_dwordx2 v[8:9], v2, s[40:43], s62 offen sc1
    s_mov_b64 exec, 1
    buffer_store_dword v10, v36, s[40:43], s63 offen sc1
    s_mov_b64 exec, -1
    v_mov_b32 v12, 162076
L_lw_103:
    ds_read_b32 v13, v12
    s_waitcnt lgkmcnt(0)
    v_cmp_gt_u32 vcc, 4, v13
    s_cbranch_vccz L_lw_103e
    s_sleep 4
    s_sub_u32 s60, s60, 1
    s_cbranch_scc0 L_lw_103
    s_mov_b32 s60, 0
L_lw_103e:
    v_and_b32 v11, 31, v0
    v_lshlrev_b32 v11, 2, v11
    s_lshl_b32 s63, s34, 7
    s_add_u32 s63, s63, 229376
    buffer_load_dword v12, v39, s[40:43], s98 offen sc1
    s_branch L_poll_104
L_poll_104s:
    s_sleep 16
L_poll_104:
    buffer_load_dwordx2 v[8:9], v2, s[40:43], s99 offen sc1
    buffer_load_dword v10, v11, s[40:43], s63 offen sc1
    s_sub_u32 s60, s60, 1
    s_cbranch_scc1 L_poll_104t
    s_waitcnt vmcnt(0)
    v_max3_u32 v38, v8, v9, v10
    v_cmp_eq_u32 vcc, -1, v38
    s_cbranch_vccnz L_poll_104s
L_poll_104e:
    v_mov_b32 v37, v8
    s_nop 1
    v_max_f32_dpp v37, v37, v37 quad_perm:[1,0,3,2] row_mask:0xf bank_mask:0xf
    s_nop 1
    v_max_f32_dpp v37, v37, v37 quad_perm:[2,3,0,1] row_mask:0xf bank_mask:0xf
    s_nop 1
    v_max_f32_dpp v37, v37, v37 row_ror:4 row_mask:0xf bank_mask:0xf
    s_nop 1
    v_max_f32_dpp v37, v37, v37 row_ror:8 row_mask:0xf bank_mask:0xf
    v_sub_f32 v8, v8, v37
    v_exp_f32 v8, v8
    s_nop 0
    v_mul_f32 v9, v8, v9
    s_nop 1
    v_add_f32_dpp v9, v9, v9 quad_perm:[1,0,3,2] row_mask:0xf bank_mask:0xf
    s_nop 1
    v_add_f32_dpp v9, v9, v9 quad_perm:[2,3,0,1] row_mask:0xf bank_mask:0xf
    s_nop 1
    v_add_f32_dpp v9, v9, v9 row_ror:4 row_mask:0xf bank_mask:0xf
    s_nop 1
    v_add_f32_dpp v9, v9, v9 row_ror:8 row_mask:0xf bank_mask:0xf
    s_getreg_b32 s62, hwreg(HW_REG_XCC_ID, 0, 4)
    v_cmp_ne_u32 vcc, s62, v10
    s_nop 0
    s_cmp_eq_u64 vcc, 0
    s_cselect_b32 s61, 1, 0
    v_rcp_f32 v9, v9
    v_lshrrev_b32 v3, 1, v2
    v_add_u32 v3, 161984, v3
    v_mul_f32 v8, v8, v9
    v_mov_b32 v10, 162072
    v_mov_b32 v11, s61
    ds_write_b32 v3, v8
    ds_write_b32 v10, v11
    s_mov_b32 s3, 1
    v_lshrrev_b32 v9, 4, v0
    v_lshl_add_u32 v8, v9, 2, v2
    s_lshl_b32 s96, s3, 9
    s_add_u32 s96, s96, 157824
    v_lshl_add_u32 v8, v8, 2, s96
    v_lshlrev_b32 v9, 3, v0
    v_add_u32 v9, 157824, v9
    v_mov_b32 v10, 162048
    v_mov_b32 v11, 1
    s_lshl_b32 s96, s38, 5
    s_add_u32 s96, s96, 161984
    v_mov_b32 v3, s96
    s_sub_u32 s62, 8, s39
    s_lshl_b32 s98, s34, 5
    s_add_u32 s98, s98, s35
    s_lshl_b32 s98, s98, 8
    s_add_u32 s98, s98, 90112
    v_lshlrev_b32 v39, 2, v0
    s_branch L_t0b
L_jobend:
    v_lshrrev_b32 v9, 4, v0
    v_lshl_add_u32 v9, v9, 2, v2
    v_lshlrev_b32 v9, 2, v9
    s_mov_b32 exec_hi, 0
    s_nop 1
    buffer_store_dwordx4 v[32:35], v9, s[40:43], s13 offen sc1
    s_endpgm
L_proxy:
    v_mov_b32 v72, 0
    v_mov_b32 v73, 0
    v_mov_b32 v74, 0
    v_mov_b32 v75, 0
    v_mov_b32 v76, 0
    v_mov_b32 v5, 0
    v_mov_b32 v105, 0
    v_mov_b32 v108, 0
    v_mov_b32 v160, 0
    s_barrier
    s_waitcnt lgkmcnt(0)
    s_mov_b32 s40, s32
    s_mov_b32 s41, s33
    s_mov_b32 s42, 589824
    s_mov_b32 s43, 0x20000
    s_mov_b32 s44, s30
    s_mov_b32 s45, s31
    s_mov_b32 s46, 256
    s_mov_b32 s47, 0x20000
    s_sub_u32 s97, 7, s3
    s_mul_i32 s97, s97, 27
    s_cmp_eq_u32 s3, 5
    s_cselect_b32 s97, 32, s97
    s_add_u32 s97, s97, s35
    s_lshl_b32 s97, s97, 9
    s_add_u32 s97, s97, 196608
    v_and_b32 v2, 15, v0
    v_lshlrev_b32 v2, 3, v2
    v_bfe_u32 v20, v0, 4, 1
    v_lshl_add_u32 v20, v20, 2, v2
    v_lshlrev_b32 v20, 2, v20
    s_cmp_lg_u32 s3, 7
    s_cbranch_scc1 L_px6
    s_sub_u32 s96, 6, s59
    v_mov_b32 v8, 162068
L_lw_105:
    ds_read_b32 v9, v8
    s_waitcnt lgkmcnt(0)
    v_cmp_gt_u32 vcc, s96, v9
    s_cbranch_vccz L_lw_105e
    s_sleep 8
    s_sub_u32 s60, s60, 1
    s_cbranch_scc0 L_lw_105
    s_mov_b32 s60, 0
L_lw_105e:
    v_and_b32 v2, 15, v0
    v_lshlrev_b32 v2, 3, v2
    v_add_u32 v3, 161920, v2
    ds_read_b64 v[8:9], v3
    s_lshl_b32 s99, s37, 5
    s_add_u32 s99, s99, s36
    s_lshl_b32 s99, s99, 7
    s_add_u32 s99, s99, 73728
    s_lshl_b32 s62, s38, 6
    s_add_u32 s62, s62, s99
    s_getreg_b32 s58, hwreg(HW_REG_XCC_ID, 0, 4)
    v_mov_b32 v10, s58
    s_lshl_b32 s98, s34, 5
    s_add_u32 s98, s98, s35
    s_lshl_b32 s63, s98, 2
    s_add_u32 s63, s63, 229376
    s_lshl_b32 s98, s98, 8
    s_add_u32 s98, s98, 90112
    v_lshlrev_b32 v39, 2, v0
    s_bfm_b64 exec, s96, 0
    s_waitcnt lgkmcnt(0)
    buffer_store_dwordx2 v[8:9], v2, s[40:43], s62 offen sc1
    s_mov_b64 exec, 1
    buffer_store_dword v10, v36, s[40:43], s63 offen sc1
    s_mov_b64 exec, -1
    s_mov_b32 s100, 4
    s_lshl_b32 s63, s100, 8
    v_and_b32 v8, 15, v0
    v_lshl_add_u32 v8, v8, 4, s63
    v_lshrrev_b32 v9, 4, v0
    v_mul_u32_u24 v5, 1280, v9
    v_add_u32 v5, v5, v8
    v_mul_u32_u24 v4, 1296, v9
    v_add_u32 v4, v4, v8
    v_add_u32 v4, 82944, v4
    v_lshlrev_b32 v6, 1, v5
    v_add_u32 v6, 99328, v6
    s_lshl_b32 s62, s100, 3
    s_add_u32 s62, s62, 88128
    v_lshl_add_u32 v7, v9, 6, s62
    s_mov_b32 s48, s4
    s_mov_b32 s49, s5
    s_mov_b32 s50, 5120
    s_mov_b32 s51, 0x20000
    buffer_load_dwordx4 v[8:11], v5, s[48:51], 0 offen
    s_mov_b32 s62, 20480
    s_mov_b32 s63, 30720
    s_branch L_poll_106
L_poll_106s:
    s_sleep 32
L_poll_106:
    buffer_load_dwordx4 v[12:15], v5, s[40:43], s62 offen sc1
    buffer_load_dwordx4 v[16:19], v5, s[40:43], s63 offen sc1
    s_sub_u32 s60, s60, 1
    s_cbranch_scc1 L_poll_106t
    s_waitcnt vmcnt(0)
    v_max3_u32 v38, v12, v13, v14
    v_max3_u32 v38, v38, v15, v16
    v_max3_u32 v38, v38, v17, v18
    v_max_u32 v38, v38, v19
    v_cmp_eq_u32 vcc, -1, v38
    s_cbranch_vccnz L_poll_106s
L_poll_106e:
    v_lshlrev_b32 v40, 16, v8
    v_and_b32 v41, 0xffff0000, v8
    v_lshlrev_b32 v42, 16, v9
    v_and_b32 v43, 0xffff0000, v9
    v_lshlrev_b32 v44, 16, v10
    v_and_b32 v45, 0xffff0000, v10
    v_lshlrev_b32 v46, 16, v11
    v_and_b32 v47, 0xffff0000, v11
    v_lshlrev_b32 v48, 16, v12
    v_and_b32 v49, 0xffff0000, v12
    v_lshlrev_b32 v50, 16, v13
    v_and_b32 v51, 0xffff0000, v13
    v_lshlrev_b32 v52, 16, v14
    v_and_b32 v53, 0xffff0000, v14
    v_lshlrev_b32 v54, 16, v15
    v_and_b32 v55, 0xffff0000, v15
    v_lshlrev_b32 v56, 16, v16
    v_and_b32 v57, 0xffff0000, v16
    v_lshlrev_b32 v58, 16, v17
    v_and_b32 v59, 0xffff0000, v17
    v_lshlrev_b32 v60, 16, v18
    v_and_b32 v61, 0xffff0000, v18
    v_lshlrev_b32 v62, 16, v19
    v_and_b32 v63, 0xffff0000, v19
    v_mov_b32 v64, 0
    v_mov_b32 v65, 0
    v_mov_b32 v66, 0
    v_mov_b32 v67, 0
    v_mov_b32 v68, 0
    v_mov_b32 v69, 0
    v_mov_b32 v70, 0
    v_mov_b32 v71, 0
    v_bfe_u32 v5, v0, 2, 2
    v_lshlrev_b32 v5, 8, v5
    v_lshrrev_b32 v8, 4, v0
    v_lshl_add_u32 v5, v8, 6, v5
    v_and_b32 v8, 3, v0
    v_lshl_add_u32 v5, v8, 4, v5
    s_lshl_b32 s63, s100, 10
    v_add_u32 v5, s63, v5
    s_or_b32 s96, s59, s39
    s_cbranch_scc0 L_nofrag_107
    v_mov_b32 v104, 162060
L_lw_108:
    ds_read_b32 v105, v104
    s_waitcnt lgkmcnt(0)
    v_cmp_gt_u32 vcc, 4, v105
    s_cbranch_vccz L_lw_108e
    s_sleep 2
    s_sub_u32 s60, s60, 1
    s_cbranch_scc0 L_lw_108
    s_mov_b32 s60, 0
L_lw_108e:
    s_cmp_eq_u32 s59, 0
    s_cbranch_scc1 L_nofrag_107
    v_lshrrev_b32 v109, 4, v0
    v_bfe_u32 v104, v0, 1, 1
    v_lshl_add_u32 v104, v109, 1, v104
    v_bfe_u32 v110, v0, 2, 2
    v_lshl_add_u32 v104, v104, 3, v110
    v_lshlrev_b32 v104, 7, v104
    v_and_b32 v110, 1, v0
    v_lshl_add_u32 v104, v110, 3, v104
    s_lshr_b32 s63, s3, 1
    s_and_b32 s62, s3, 1
    s_lshl_b32 s96, s63, 14
    s_lshl_b32 s100, s62, 6
    s_add_u32 s100, s100, 81920
    s_add_u32 s96, s96, s100
    v_add_u32 v104, s96, v104
    ds_read_b64_tr_b16 v[72:73], v104 offset:0
    ds_read_b64_tr_b16 v[74:75], v104 offset:512
    ds_read_b64_tr_b16 v[76:77], v104 offset:16
    ds_read_b64_tr_b16 v[78:79], v104 offset:528
    ds_read_b64_tr_b16 v[80:81], v104 offset:32
    ds_read_b64_tr_b16 v[82:83], v104 offset:544
    ds_read_b64_tr_b16 v[84:85], v104 offset:48
    ds_read_b64_tr_b16 v[86:87], v104 offset:560
    ds_read_b64_tr_b16 v[88:89], v104 offset:8192
    ds_read_b64_tr_b16 v[90:91], v104 offset:8704
    ds_read_b64_tr_b16 v[92:93], v104 offset:8208
    ds_read_b64_tr_b16 v[94:95], v104 offset:8720
    ds_read_b64_tr_b16 v[96:97], v104 offset:8224
    ds_read_b64_tr_b16 v[98:99], v104 offset:8736
    ds_read_b64_tr_b16 v[100:101], v104 offset:8240
    ds_read_b64_tr_b16 v[102:103], v104 offset:8752
    v_bfe_u32 v105, v0, 1, 3
    v_lshlrev_b32 v105, 8, v105
    v_lshl_add_u32 v105, v109, 5, v105
    v_lshl_add_u32 v105, v110, 4, v105
    v_lshrrev_b32 v106, 3, v0
    v_lshlrev_b32 v106, 7, v106
    v_and_b32 v110, 7, v0
    v_lshl_add_u32 v107, v110, 3, v106
    v_add_u32 v107, s100, v107
    v_lshl_add_u32 v106, v110, 2, v106
    v_add_u32 v106, s96, v106
    v_lshlrev_b32 v108, 2, v0
    s_lshl_b32 s96, s62, 2
    s_add_u32 s96, s96, 162088
    v_mov_b32 v109, s96
    s_lshl_b32 s100, s63, 11
    s_lshl_b32 s96, s34, 13
    s_add_u32 s100, s100, s96
    s_add_u32 s100, s100, 90112
    s_mul_i32 s101, s34, 5120
    s_lshl_b32 s96, s35, 9
    s_add_u32 s101, s101, s96
    s_lshl_b32 s96, s62, 8
    s_add_u32 s101, s101, s96
    s_add_u32 s101, s101, 144384
L_nofrag_107:
    s_cmp_ge_u32 s35, 20
    s_cbranch_scc1 L_nofin_109
    s_lshl1_add_u32 s62, s35, s3
    s_sub_u32 s62, s62, 6
    s_lshl_b32 s57, s62, 7
    s_mul_i32 s63, s62, 0x199a
    s_lshr_b32 s63, s63, 16
    s_mul_i32 s63, s63, 1280
    s_sub_u32 s63, s57, s63
    v_lshrrev_b32 v72, 3, v0
    v_mul_u32_u24 v72, 5120, v72
    v_and_b32 v8, 7, v0
    v_lshl_add_u32 v72, v8, 4, v72
    s_add_u32 s62, s57, 262144
    v_add_u32 v72, s62, v72
    v_add_u32 v73, 40960, v72
    v_add_u32 v74, 81920, v72
    v_add_u32 v75, 122880, v72
    v_bfe_u32 v9, v0, 4, 1
    v_lshlrev_b32 v76, 4, v8
    v_lshl_add_u32 v76, v9, 3, v76
    s_lshl_b32 s62, s57, 1
    s_add_u32 s62, s62, 99328
    v_lshl_add_u32 v77, v76, 1, s62
    s_mov_b32 s48, s22
    s_mov_b32 s49, s23
    s_mov_b32 s50, 1280
    s_mov_b32 s51, 0x20000
    buffer_load_dwordx2 v[86:87], v76, s[48:51], s63 offen
    s_add_u32 s62, s57, 35840
    s_branch L_poll_110
L_poll_110s:
    s_sleep 32
L_poll_110:
    buffer_load_dwordx2 v[8:9], v76, s[40:43], s62 offen sc1
    s_sub_u32 s60, s60, 1
    s_cbranch_scc1 L_poll_110t
    s_waitcnt vmcnt(0)
    v_max_u32 v38, v8, v9
    v_cmp_eq_u32 vcc, -1, v38
    s_cbranch_vccnz L_poll_110s
L_poll_110e:
    v_lshlrev_b32 v78, 16, v86
    v_and_b32 v79, 0xffff0000, v86
    v_lshlrev_b32 v82, 16, v8
    v_and_b32 v83, 0xffff0000, v8
    v_lshlrev_b32 v80, 16, v87
    v_and_b32 v81, 0xffff0000, v87
    v_lshlrev_b32 v84, 16, v9
    v_and_b32 v85, 0xffff0000, v9
    v_bfe_u32 v8, v0, 1, 3
    v_and_b32 v9, 1, v0
    v_lshlrev_b32 v9, 4, v9
    v_mov_b32 v10, 0x3f80
    v_lshlrev_b32 v9, v9, v10
    v_cmp_eq_u32 vcc, 0, v8
    v_mov_b32 v100, 0
    s_nop 0
    v_cndmask_b32 v104, 0, v9, vcc
    v_cmp_eq_u32 vcc, 1, v8
    v_mov_b32 v101, 0
    s_nop 0
    v_cndmask_b32 v105, 0, v9, vcc
    v_cmp_eq_u32 vcc, 2, v8
    v_mov_b32 v102, 0
    s_nop 0
    v_cndmask_b32 v106, 0, v9, vcc
    v_cmp_eq_u32 vcc, 3, v8
    v_mov_b32 v103, 0
    s_nop 0
    v_cndmask_b32 v107, 0, v9, vcc
L_nofin_109:
    v_mov_b32 v12, 162076
L_lw_111:
    ds_read_b32 v13, v12
    s_waitcnt lgkmcnt(0)
    v_cmp_gt_u32 vcc, 4, v13
    s_cbranch_vccz L_lw_111e
    s_sleep 4
    s_sub_u32 s60, s60, 1
    s_cbranch_scc0 L_lw_111
    s_mov_b32 s60, 0
L_lw_111e:
    v_and_b32 v11, 31, v0
    v_lshlrev_b32 v11, 2, v11
    s_lshl_b32 s63, s34, 7
    s_add_u32 s63, s63, 229376
    buffer_load_dword v12, v39, s[40:43], s98 offen sc1
    s_branch L_poll_112
L_poll_112s:
    s_sleep 4
L_poll_112:
    buffer_load_dwordx2 v[8:9], v2, s[40:43], s99 offen sc1
    buffer_load_dword v10, v11, s[40:43], s63 offen sc1
    buffer_load_dwordx4 v[32:35], v20, s[40:43], s97 offen sc1
    s_sub_u32 s60, s60, 1
    s_cbranch_scc1 L_poll_112t
    s_waitcnt vmcnt(0)
    v_max3_u32 v38, v8, v9, v10
    v_max3_u32 v38, v38, v32, v33
    v_max3_u32 v38, v38, v34, v35
    v_cmp_eq_u32 vcc, -1, v38
    s_cbranch_vccnz L_poll_112s
L_poll_112e:
    v_mov_b32 v37, v8
    s_nop 1
    v_max_f32_dpp v37, v37, v37 quad_perm:[1,0,3,2] row_mask:0xf bank_mask:0xf
    s_nop 1
    v_max_f32_dpp v37, v37, v37 quad_perm:[2,3,0,1] row_mask:0xf bank_mask:0xf
    s_nop 1
    v_max_f32_dpp v37, v37, v37 row_ror:4 row_mask:0xf bank_mask:0xf
    s_nop 1
    v_max_f32_dpp v37, v37, v37 row_ror:8 row_mask:0xf bank_mask:0xf
    v_sub_f32 v8, v8, v37
    v_exp_f32 v8, v8
    s_nop 0
    v_mul_f32 v9, v8, v9
    s_nop 1
    v_add_f32_dpp v9, v9, v9 quad_perm:[1,0,3,2] row_mask:0xf bank_mask:0xf
    s_nop 1
    v_add_f32_dpp v9, v9, v9 quad_perm:[2,3,0,1] row_mask:0xf bank_mask:0xf
    s_nop 1
    v_add_f32_dpp v9, v9, v9 row_ror:4 row_mask:0xf bank_mask:0xf
    s_nop 1
    v_add_f32_dpp v9, v9, v9 row_ror:8 row_mask:0xf bank_mask:0xf
    s_getreg_b32 s62, hwreg(HW_REG_XCC_ID, 0, 4)
    v_cmp_ne_u32 vcc, s62, v10
    s_nop 0
    s_cmp_eq_u64 vcc, 0
    s_cselect_b32 s61, 1, 0
    v_rcp_f32 v9, v9
    v_lshrrev_b32 v3, 1, v2
    v_add_u32 v3, 161984, v3
    v_mul_f32 v8, v8, v9
    v_mov_b32 v10, 162072
    v_mov_b32 v11, s61
    ds_write_b32 v3, v8
    ds_write_b32 v10, v11
    s_branch L_pxj
L_px6:
    s_or_b32 s96, s59, s39
    s_cbranch_scc0 L_nofrag_113
    v_mov_b32 v104, 162060
L_lw_114:
    ds_read_b32 v105, v104
    s_waitcnt lgkmcnt(0)
    v_cmp_gt_u32 vcc, 4, v105
    s_cbranch_vccz L_lw_114e
    s_sleep 2
    s_sub_u32 s60, s60, 1
    s_cbranch_scc0 L_lw_114
    s_mov_b32 s60, 0
L_lw_114e:
    s_cmp_eq_u32 s59, 0
    s_cbranch_scc1 L_nofrag_113
    v_lshrrev_b32 v109, 4, v0
    v_bfe_u32 v104, v0, 1, 1
    v_lshl_add_u32 v104, v109, 1, v104
    v_bfe_u32 v110, v0, 2, 2
    v_lshl_add_u32 v104, v104, 3, v110
    v_lshlrev_b32 v104, 7, v104
    v_and_b32 v110, 1, v0
    v_lshl_add_u32 v104, v110, 3, v104
    s_lshr_b32 s63, s3, 1
    s_and_b32 s62, s3, 1
    s_lshl_b32 s96, s63, 14
    s_lshl_b32 s100, s62, 6
    s_add_u32 s100, s100, 81920
    s_add_u32 s96, s96, s100
    v_add_u32 v104, s96, v104
    ds_read_b64_tr_b16 v[72:73], v104 offset:0
    ds_read_b64_tr_b16 v[74:75], v104 offset:512
    ds_read_b64_tr_b16 v[76:77], v104 offset:16
    ds_read_b64_tr_b16 v[78:79], v104 offset:528
    ds_read_b64_tr_b16 v[80:81], v104 offset:32
    ds_read_b64_tr_b16 v[82:83], v104 offset:544
    ds_read_b64_tr_b16 v[84:85], v104 offset:48
    ds_read_b64_tr_b16 v[86:87], v104 offset:560
    ds_read_b64_tr_b16 v[88:89], v104 offset:8192
    ds_read_b64_tr_b16 v[90:91], v104 offset:8704
    ds_read_b64_tr_b16 v[92:93], v104 offset:8208
    ds_read_b64_tr_b16 v[94:95], v104 offset:8720
    ds_read_b64_tr_b16 v[96:97], v104 offset:8224
    ds_read_b64_tr_b16 v[98:99], v104 offset:8736
    ds_read_b64_tr_b16 v[100:101], v104 offset:8240
    ds_read_b64_tr_b16 v[102:103], v104 offset:8752
    v_bfe_u32 v105, v0, 1, 3
    v_lshlrev_b32 v105, 8, v105
    v_lshl_add_u32 v105, v109, 5, v105
    v_lshl_add_u32 v105, v110, 4, v105
    v_lshrrev_b32 v106, 3, v0
    v_lshlrev_b32 v106, 7, v106
    v_and_b32 v110, 7, v0
    v_lshl_add_u32 v107, v110, 3, v106
    v_add_u32 v107, s100, v107
    v_lshl_add_u32 v106, v110, 2, v106
    v_add_u32 v106, s96, v106
    v_lshlrev_b32 v108, 2, v0
    s_lshl_b32 s96, s62, 2
    s_add_u32 s96, s96, 162088
    v_mov_b32 v109, s96
    s_lshl_b32 s100, s63, 11
    s_lshl_b32 s96, s34, 13
    s_add_u32 s100, s100, s96
    s_add_u32 s100, s100, 90112
    s_mul_i32 s101, s34, 5120
    s_lshl_b32 s96, s35, 9
    s_add_u32 s101, s101, s96
    s_lshl_b32 s96, s62, 8
    s_add_u32 s101, s101, s96
    s_add_u32 s101, s101, 144384
L_nofrag_113:
    v_mov_b32 v8, 162068
L_lw_115:
    ds_read_b32 v9, v8
    s_waitcnt lgkmcnt(0)
    v_cmp_gt_u32 vcc, 1, v9
    s_cbranch_vccz L_lw_115e
    s_sleep 32
    s_sub_u32 s60, s60, 1
    s_cbranch_scc0 L_lw_115
    s_mov_b32 s60, 0
L_lw_115e:
    s_cmp_ge_u32 s35, 20
    s_cbranch_scc1 L_nofin_116
    s_lshl1_add_u32 s62, s35, s3
    s_sub_u32 s62, s62, 6
    s_lshl_b32 s57, s62, 7
    s_mul_i32 s63, s62, 0x199a
    s_lshr_b32 s63, s63, 16
    s_mul_i32 s63, s63, 1280
    s_sub_u32 s63, s57, s63
    v_lshrrev_b32 v72, 3, v0
    v_mul_u32_u24 v72, 5120, v72
    v_and_b32 v8, 7, v0
    v_lshl_add_u32 v72, v8, 4, v72
    s_add_u32 s62, s57, 262144
    v_add_u32 v72, s62, v72
    v_add_u32 v73, 40960, v72
    v_add_u32 v74, 81920, v72
    v_add_u32 v75, 122880, v72
    v_bfe_u32 v9, v0, 4, 1
    v_lshlrev_b32 v76, 4, v8
    v_lshl_add_u32 v76, v9, 3, v76
    s_lshl_b32 s62, s57, 1
    s_add_u32 s62, s62, 99328
    v_lshl_add_u32 v77, v76, 1, s62
    s_mov_b32 s48, s22
    s_mov_b32 s49, s23
    s_mov_b32 s50, 1280
    s_mov_b32 s51, 0x20000
    buffer_load_dwordx2 v[86:87], v76, s[48:51], s63 offen
    s_add_u32 s62, s57, 35840
    s_branch L_poll_117
L_poll_117s:
    s_sleep 32
L_poll_117:
    buffer_load_dwordx2 v[8:9], v76, s[40:43], s62 offen sc1
    s_sub_u32 s60, s60, 1
    s_cbranch_scc1 L_poll_117t
    s_waitcnt vmcnt(0)
    v_max_u32 v38, v8, v9
    v_cmp_eq_u32 vcc, -1, v38
    s_cbranch_vccnz L_poll_117s
L_poll_117e:
    v_lshlrev_b32 v78, 16, v86
    v_and_b32 v79, 0xffff0000, v86
    v_lshlrev_b32 v82, 16, v8
    v_and_b32 v83, 0xffff0000, v8
    v_lshlrev_b32 v80, 16, v87
    v_and_b32 v81, 0xffff0000, v87
    v_lshlrev_b32 v84, 16, v9
    v_and_b32 v85, 0xffff0000, v9
    v_bfe_u32 v8, v0, 1, 3
    v_and_b32 v9, 1, v0
    v_lshlrev_b32 v9, 4, v9
    v_mov_b32 v10, 0x3f80
    v_lshlrev_b32 v9, v9, v10
    v_cmp_eq_u32 vcc, 0, v8
    v_mov_b32 v100, 0
    s_nop 0
    v_cndmask_b32 v104, 0, v9, vcc
    v_cmp_eq_u32 vcc, 1, v8
    v_mov_b32 v101, 0
    s_nop 0
    v_cndmask_b32 v105, 0, v9, vcc
    v_cmp_eq_u32 vcc, 2, v8
    v_mov_b32 v102, 0
    s_nop 0
    v_cndmask_b32 v106, 0, v9, vcc
    v_cmp_eq_u32 vcc, 3, v8
    v_mov_b32 v103, 0
    s_nop 0
    v_cndmask_b32 v107, 0, v9, vcc
L_nofin_116:
    v_mov_b32 v8, 162076
L_lw_118:
    ds_read_b32 v9, v8
    s_waitcnt lgkmcnt(0)
    v_cmp_gt_u32 vcc, 4, v9
    s_cbranch_vccz L_lw_118e
    s_sleep 16
    s_sub_u32 s60, s60, 1
    s_cbranch_scc0 L_lw_118
    s_mov_b32 s60, 0
L_lw_118e:
    s_branch L_poll_119
L_poll_119s:
    s_sleep 4
L_poll_119:
    buffer_load_dwordx4 v[32:35], v20, s[40:43], s97 offen sc1
    s_sub_u32 s60, s60, 1
    s_cbranch_scc1 L_poll_119t
    s_waitcnt vmcnt(0)
    v_max3_u32 v38, v32, v33, v34
    v_max_u32 v38, v38, v35
    v_cmp_eq_u32 vcc, -1, v38
    s_cbranch_vccnz L_poll_119s
L_poll_119e:
L_pxj:
    s_cmp_ge_u32 s35, 20
    s_cbranch_scc1 L_pxk
    buffer_load_dwordx4 v[88:91], v72, s[40:43], 0 offen sc1
    buffer_load_dwordx4 v[92:95], v73, s[40:43], 0 offen sc1
    buffer_load_dwordx4 v[96:99], v74, s[40:43], 0 offen sc1
    s_mov_b64 exec, 0xffffff
    buffer_load_dwordx4 v[100:103], v75, s[40:43], 0 offen sc1
    s_mov_b64 exec, -1
L_pxk:
    v_mov_b32 v8, 162048
L_lw_120:
    ds_read_b32 v9, v8
    s_waitcnt lgkmcnt(0)
    v_cmp_gt_u32 vcc, 3, v9
    s_cbranch_vccz L_lw_120e
    s_sleep 2
    s_sub_u32 s60, s60, 1
    s_cbranch_scc0 L_lw_120
    s_mov_b32 s60, 0
L_lw_120e:
    v_lshrrev_b32 v9, 4, v0
    v_lshl_add_u32 v8, v9, 2, v2
    s_lshl_b32 s96, s3, 9
    s_add_u32 s96, s96, 157824
    v_lshl_add_u32 v8, v8, 2, s96
    v_lshlrev_b32 v9, 3, v0
    v_add_u32 v9, 157824, v9
    v_mov_b32 v10, 162048
    v_mov_b32 v11, 1
    s_lshl_b32 s96, s38, 5
    s_add_u32 s96, s96, 161984
    v_mov_b32 v3, s96
    s_sub_u32 s62, 8, s39
    s_lshl_b32 s98, s34, 5
    s_add_u32 s98, s98, s35
    s_lshl_b32 s98, s98, 8
    s_add_u32 s98, s98, 90112
    v_lshlrev_b32 v39, 2, v0
    s_branch L_t0
L_s_role:
    s_cmp_eq_u32 s3, 7
    s_cbranch_scc1 L_t2gate
    s_cmp_gt_u32 s3, 3
    s_cbranch_scc1 L_fin_prep
    s_mov_b32 s48, s18
    s_mov_b32 s49, s19
    s_mov_b32 s50, 3456
    s_mov_b32 s51, 0x20000
    v_lshrrev_b32 v3, 4, v0
    v_bfe_u32 v1, v0, 2, 2
    v_and_b32 v2, 3, v0
    v_lshl_add_u32 v4, v3, 2, v1
    v_lshlrev_b32 v4, 1, v4
    s_lshl_b32 s62, s35, 7
    s_lshl_b32 s63, s3, 5
    s_add_u32 s62, s62, s63
    buffer_load_ushort v82, v4, s[48:51], s62 offen
    v_mov_b32 v72, 162064
L_lw_121:
    ds_read_b32 v73, v72
    s_waitcnt lgkmcnt(0)
    v_cmp_gt_u32 vcc, 4, v73
    s_cbranch_vccz L_lw_121e
    s_sleep 2
    s_sub_u32 s60, s60, 1
    s_cbranch_scc0 L_lw_121
    s_mov_b32 s60, 0
L_lw_121e:
    v_lshrrev_b32 v72, 4, v0
    v_lshlrev_b32 v72, 10, v72
    v_bfe_u32 v73, v0, 2, 2
    v_lshl_add_u32 v72, v73, 7, v72
    v_and_b32 v73, 3, v0
    v_lshl_add_u32 v72, v73, 3, v72
    v_bfe_u32 v73, v0, 3, 2
    v_lshl_add_u32 v72, v73, 5, v72
    v_xor_b32 v72, s63, v72
    v_add_u32 v73, 40960, v72
    v_and_b32 v5, 7, v0
    v_mul_u32_u24 v5, 1296, v5
    v_lshl_add_u32 v5, v3, 4, v5
    v_add_u32 v5, 147456, v5
    ds_read_b64_tr_b16 v[88:89], v72 offset:0
    ds_read_b64_tr_b16 v[90:91], v72 offset:512
    ds_read_b64_tr_b16 v[92:93], v72 offset:4096
    ds_read_b64_tr_b16 v[94:95], v72 offset:4608
    ds_read_b64_tr_b16 v[96:97], v72 offset:8192
    ds_read_b64_tr_b16 v[98:99], v72 offset:8704
    ds_read_b64_tr_b16 v[100:101], v72 offset:12288
    ds_read_b64_tr_b16 v[102:103], v72 offset:12800
    ds_read_b64_tr_b16 v[104:105], v72 offset:16384
    ds_read_b64_tr_b16 v[106:107], v72 offset:16896
    ds_read_b64_tr_b16 v[108:109], v72 offset:20480
    ds_read_b64_tr_b16 v[110:111], v72 offset:20992
    ds_read_b64_tr_b16 v[112:113], v72 offset:24576
    ds_read_b64_tr_b16 v[114:115], v72 offset:25088
    ds_read_b64_tr_b16 v[116:117], v72 offset:28672
    ds_read_b64_tr_b16 v[118:119], v72 offset:29184
    ds_read_b64_tr_b16 v[120:121], v72 offset:32768
    ds_read_b64_tr_b16 v[122:123], v72 offset:33280
    ds_read_b64_tr_b16 v[124:125], v72 offset:36864
    ds_read_b64_tr_b16 v[126:127], v72 offset:37376
    ds_read_b64_tr_b16 v[128:129], v73 offset:0
    ds_read_b64_tr_b16 v[130:131], v73 offset:512
    ds_read_b64_tr_b16 v[132:133], v73 offset:4096
    ds_read_b64_tr_b16 v[134:135], v73 offset:4608
    ds_read_b64_tr_b16 v[136:137], v73 offset:8192
    ds_read_b64_tr_b16 v[138:139], v73 offset:8704
    ds_read_b64_tr_b16 v[140:141], v73 offset:12288
    ds_read_b64_tr_b16 v[142:143], v73 offset:12800
    ds_read_b64_tr_b16 v[144:145], v73 offset:16384
    ds_read_b64_tr_b16 v[146:147], v73 offset:16896
    ds_read_b64_tr_b16 v[148:149], v73 offset:20480
    ds_read_b64_tr_b16 v[150:151], v73 offset:20992
    ds_read_b64_tr_b16 v[152:153], v73 offset:24576
    ds_read_b64_tr_b16 v[154:155], v73 offset:25088
    ds_read_b64_tr_b16 v[156:157], v73 offset:28672
    ds_read_b64_tr_b16 v[158:159], v73 offset:29184
    ds_read_b64_tr_b16 v[160:161], v73 offset:32768
    ds_read_b64_tr_b16 v[162:163], v73 offset:33280
    ds_read_b64_tr_b16 v[164:165], v73 offset:36864
    ds_read_b64_tr_b16 v[166:167], v73 offset:37376
    ds_read_b128 v[8:11], v5 offset:0
    ds_read_b128 v[12:15], v5 offset:64
    ds_read_b128 v[16:19], v5 offset:128
    ds_read_b128 v[20:23], v5 offset:192
    ds_read_b128 v[24:27], v5 offset:256
    ds_read_b128 v[28:31], v5 offset:320
    ds_read_b128 v[32:35], v5 offset:384
    ds_read_b128 v[36:39], v5 offset:448
    ds_read_b128 v[40:43], v5 offset:512
    ds_read_b128 v[44:47], v5 offset:576
    s_waitcnt lgkmcnt(9)
    v_mfma_f32_16x16x32_bf16 v[48:51], v[88:91], v[8:11], 0
    s_waitcnt lgkmcnt(8)
    v_mfma_f32_16x16x32_bf16 v[48:51], v[92:95], v[12:15], v[48:51]
    s_waitcnt lgkmcnt(7)
    v_mfma_f32_16x16x32_bf16 v[48:51], v[96:99], v[16:19], v[48:51]
    s_waitcnt lgkmcnt(6)
    v_mfma_f32_16x16x32_bf16 v[48:51], v[100:103], v[20:23], v[48:51]
    s_waitcnt lgkmcnt(5)
    v_mfma_f32_16x16x32_bf16 v[48:51], v[104:107], v[24:27], v[48:51]
    s_waitcnt lgkmcnt(4)
    v_mfma_f32_16x16x32_bf16 v[48:51], v[108:111], v[28:31], v[48:51]
    s_waitcnt lgkmcnt(3)
    v_mfma_f32_16x16x32_bf16 v[48:51], v[112:115], v[32:35], v[48:51]
    s_waitcnt lgkmcnt(2)
    v_mfma_f32_16x16x32_bf16 v[48:51], v[116:119], v[36:39], v[48:51]
    s_waitcnt lgkmcnt(1)
    v_mfma_f32_16x16x32_bf16 v[48:51], v[120:123], v[40:43], v[48:51]
    s_waitcnt lgkmcnt(0)
    v_mfma_f32_16x16x32_bf16 v[48:51], v[124:127], v[44:47], v[48:51]
    ds_read_b128 v[8:11], v5 offset:640
    ds_read_b128 v[12:15], v5 offset:704
    ds_read_b128 v[16:19], v5 offset:768
    ds_read_b128 v[20:23], v5 offset:832
    ds_read_b128 v[24:27], v5 offset:896
    ds_read_b128 v[28:31], v5 offset:960
    ds_read_b128 v[32:35], v5 offset:1024
    ds_read_b128 v[36:39], v5 offset:1088
    ds_read_b128 v[40:43], v5 offset:1152
    ds_read_b128 v[44:47], v5 offset:1216
    s_waitcnt lgkmcnt(9)
    v_mfma_f32_16x16x32_bf16 v[48:51], v[128:131], v[8:11], v[48:51]
    s_waitcnt lgkmcnt(8)
    v_mfma_f32_16x16x32_bf16 v[48:51], v[132:135], v[12:15], v[48:51]
    s_waitcnt lgkmcnt(7)
    v_mfma_f32_16x16x32_bf16 v[48:51], v[136:139], v[16:19], v[48:51]
    s_waitcnt lgkmcnt(6)
    v_mfma_f32_16x16x32_bf16 v[48:51], v[140:143], v[20:23], v[48:51]
    s_waitcnt lgkmcnt(5)
    v_mfma_f32_16x16x32_bf16 v[48:51], v[144:147], v[24:27], v[48:51]
    s_waitcnt lgkmcnt(4)
    v_mfma_f32_16x16x32_bf16 v[48:51], v[148:151], v[28:31], v[48:51]
    s_waitcnt lgkmcnt(3)
    v_mfma_f32_16x16x32_bf16 v[48:51], v[152:155], v[32:35], v[48:51]
    s_waitcnt lgkmcnt(2)
    v_mfma_f32_16x16x32_bf16 v[48:51], v[156:159], v[36:39], v[48:51]
    s_waitcnt lgkmcnt(1)
    v_mfma_f32_16x16x32_bf16 v[48:51], v[160:163], v[40:43], v[48:51]
    s_waitcnt lgkmcnt(0)
    v_mfma_f32_16x16x32_bf16 v[48:51], v[164:167], v[44:47], v[48:51]
    v_mul_u32_u24 v79, 1296, v2
    v_lshl_add_u32 v79, v1, 6, v79
    v_lshl_add_u32 v79, v3, 4, v79
    v_add_u32 v79, 82944, v79
    v_mul_u32_u24 v80, 144, v2
    v_add3_u32 v80, v80, v4, s63
    v_add_u32 v80, 88384, v80
    v_lshlrev_b32 v81, 6, v2
    v_add_u32 v81, 88128, v81
    v_mov_b32_dpp v84, v48 quad_perm:[0,1,2,3] row_mask:0xf bank_mask:0x1
    v_mov_b32_dpp v85, v48 row_ror:4 row_mask:0xf bank_mask:0x1
    v_mov_b32_dpp v84, v49 row_ror:4 row_mask:0xf bank_mask:0x2
    v_mov_b32_dpp v85, v49 quad_perm:[0,1,2,3] row_mask:0xf bank_mask:0x2
    v_mov_b32_dpp v84, v50 quad_perm:[0,1,2,3] row_mask:0xf bank_mask:0x4
    v_mov_b32_dpp v85, v50 row_ror:4 row_mask:0xf bank_mask:0x4
    v_mov_b32_dpp v84, v51 row_ror:4 row_mask:0xf bank_mask:0x8
    v_mov_b32_dpp v85, v51 quad_perm:[0,1,2,3] row_mask:0xf bank_mask:0x8
    s_mov_b32 s62, 0xbacccccd
    s_mov_b32 s63, 0xbdd2d3e8
    v_mov_b32 v86, 0xc0135761
    s_branch L_ffn1
L_fin_prep:
    s_cmp_lg_u32 s3, 6
    s_cbranch_scc1 L_end
    s_cmp_ge_u32 s35, 20
    s_cbranch_scc1 L_end
    s_barrier
L_gbok:
    s_barrier
L_fin:
    s_mov_b32 s52, s28
    s_mov_b32 s53, s29
    s_mov_b32 s54, 5120
    s_mov_b32 s55, 0x20000
    s_mov_b64 s[4:5], -1
    s_mov_b64 s[6:7], -1
    s_mov_b64 s[8:9], -1
    s_mov_b64 s[10:11], 0xffffff
    s_barrier
    ds_read_b128 v[108:111], v77
    s_barrier
L_yg:
    s_mov_b64 exec, s[4:5]
    buffer_load_dwordx4 v[88:91], v72, s[40:43], 0 offen sc1
    s_mov_b64 exec, s[6:7]
    buffer_load_dwordx4 v[92:95], v73, s[40:43], 0 offen sc1
    s_mov_b64 exec, s[8:9]
    buffer_load_dwordx4 v[96:99], v74, s[40:43], 0 offen sc1
    s_mov_b64 exec, s[10:11]
    buffer_load_dwordx4 v[100:103], v75, s[40:43], 0 offen sc1
    s_mov_b64 exec, -1
    s_sub_u32 s60, s60, 1
    s_cbranch_scc1 L_ygt
    s_waitcnt vmcnt(3)
    v_max3_u32 v3, v88, v89, v90
    v_max_u32 v3, v3, v91
    v_cmp_eq_u32 s[4:5], -1, v3
    s_waitcnt vmcnt(2)
    v_max3_u32 v3, v92, v93, v94
    v_max_u32 v3, v3, v95
    v_cmp_eq_u32 s[6:7], -1, v3
    s_waitcnt vmcnt(1)
    v_max3_u32 v3, v96, v97, v98
    v_max_u32 v3, v3, v99
    v_cmp_eq_u32 s[8:9], -1, v3
    s_waitcnt vmcnt(0)
    v_max3_u32 v3, v100, v101, v102
    v_max_u32 v3, v3, v103
    v_cmp_eq_u32 s[10:11], -1, v3
    s_or_b64 s[16:17], s[4:5], s[6:7]
    s_or_b64 s[16:17], s[16:17], s[8:9]
    s_or_b64 s[16:17], s[16:17], s[10:11]
    s_cbranch_scc1 L_yg
L_ygd:
    v_mfma_f32_16x16x32_bf16 v[112:115], v[104:107], v[88:91], 0
    v_mfma_f32_16x16x32_bf16 v[112:115], v[104:107], v[92:95], v[112:115]
    v_mfma_f32_16x16x32_bf16 v[112:115], v[104:107], v[96:99], v[112:115]
    v_mfma_f32_16x16x32_bf16 v[112:115], v[104:107], v[100:103], v[112:115]
    s_waitcnt lgkmcnt(0)
    v_pk_fma_f32 v[108:109], v[78:79], v[82:83], v[108:109]
    v_pk_fma_f32 v[110:111], v[80:81], v[84:85], v[110:111]
    s_nop 4
    v_add_f32_dpp v112, v112, v112 row_ror:8 row_mask:0xf bank_mask:0xf
    v_add_f32_dpp v113, v113, v113 row_ror:8 row_mask:0xf bank_mask:0xf
    v_add_f32_dpp v114, v114, v114 row_ror:8 row_mask:0xf bank_mask:0xf
    v_add_f32_dpp v115, v115, v115 row_ror:8 row_mask:0xf bank_mask:0xf
    v_pk_fma_f32 v[112:113], v[112:113], v[82:83], v[108:109]
    v_pk_fma_f32 v[114:115], v[114:115], v[84:85], v[110:111]
    v_cvt_pk_bf16_f32 v112, v112, v113
    v_cvt_pk_bf16_f32 v113, v114, v115
    s_mov_b64 exec, 0x00ff00ff
    buffer_store_dwordx2 v[112:113], v76, s[52:55], s57 offen
    s_endpgm
L_t2gate:
    v_mov_b32 v8, 162048
L_lw_122:
    ds_read_b32 v9, v8
    s_waitcnt lgkmcnt(0)
    v_cmp_gt_u32 vcc, 8, v9
    s_cbranch_vccz L_lw_122e
    s_sleep 2
    s_sub_u32 s60, s60, 1
    s_cbranch_scc0 L_lw_122
    s_mov_b32 s60, 0
L_lw_122e:
    ds_read_b32 v9, v8 offset:24
    s_waitcnt lgkmcnt(0)
    v_readfirstlane_b32 s61, v9
    s_mov_b32 s58, 0x3f80
    s_mov_b32 s59, 0x3f800000
    s_mov_b32 s63, 0xff
L_prb:
    s_bcnt1_i32_b32 s62, s63
    s_mov_b32 s97, s63
    s_ff1_i32_b32 s12, s97
    s_bitset0_b32 s97, s12
    s_mul_i32 s4, s12, 5120
    s_add_u32 s4, s4, 155648
    s_cmp_eq_u32 s62, 1
    s_cbranch_scc1 L_pi1
    s_ff1_i32_b32 s13, s97
    s_bitset0_b32 s97, s13
    s_mul_i32 s5, s13, 5120
    s_add_u32 s5, s5, 155648
    s_cmp_eq_u32 s62, 2
    s_cbranch_scc1 L_pi2
    s_ff1_i32_b32 s14, s97
    s_bitset0_b32 s97, s14
    s_mul_i32 s6, s14, 5120
    s_add_u32 s6, s6, 155648
    s_cmp_eq_u32 s62, 3
    s_cbranch_scc1 L_pi3
    s_ff1_i32_b32 s15, s97
    s_bitset0_b32 s97, s15
    s_mul_i32 s7, s15, 5120
    s_add_u32 s7, s7, 155648
    s_cmp_eq_u32 s62, 4
    s_cbranch_scc1 L_pi4
    s_ff1_i32_b32 s16, s97
    s_bitset0_b32 s97, s16
    s_mul_i32 s8, s16, 5120
    s_add_u32 s8, s8, 155648
    s_cmp_eq_u32 s62, 5
    s_cbranch_scc1 L_pi5
    s_ff1_i32_b32 s17, s97
    s_bitset0_b32 s97, s17
    s_mul_i32 s9, s17, 5120
    s_add_u32 s9, s9, 155648
    s_cmp_eq_u32 s62, 6
    s_cbranch_scc1 L_pi6
    s_ff1_i32_b32 s18, s97
    s_bitset0_b32 s97, s18
    s_mul_i32 s10, s18, 5120
    s_add_u32 s10, s10, 155648
    s_cmp_eq_u32 s62, 7
    s_cbranch_scc1 L_pi7
    s_ff1_i32_b32 s19, s97
    s_bitset0_b32 s97, s19
    s_mul_i32 s11, s19, 5120
    s_add_u32 s11, s11, 155648
L_pi8:
    buffer_load_dwordx4 v[36:39], v5, s[40:43], s11 offen sc1
L_pi7:
    buffer_load_dwordx4 v[32:35], v5, s[40:43], s10 offen sc1
L_pi6:
    buffer_load_dwordx4 v[28:31], v5, s[40:43], s9 offen sc1
L_pi5:
    buffer_load_dwordx4 v[24:27], v5, s[40:43], s8 offen sc1
L_pi4:
    buffer_load_dwordx4 v[20:23], v5, s[40:43], s7 offen sc1
L_pi3:
    buffer_load_dwordx4 v[16:19], v5, s[40:43], s6 offen sc1
L_pi2:
    buffer_load_dwordx4 v[12:15], v5, s[40:43], s5 offen sc1
    buffer_load_dwordx4 v[8:11], v5, s[40:43], s4 offen sc1
    s_sub_u32 s60, s60, 1
    s_cbranch_scc1 L_pto
    s_waitcnt vmcnt(0)
    v_max3_u32 v3, v8, v9, v10
    v_max_u32 v3, v3, v11
    v_cmp_eq_u32 vcc, -1, v3
    s_cbranch_vccz L_pgot0
    v_max3_u32 v3, v12, v13, v14
    v_max_u32 v3, v3, v15
    v_cmp_eq_u32 vcc, -1, v3
    s_cbranch_vccz L_pgot1
    s_cmp_eq_u32 s62, 2
    s_cbranch_scc1 L_pi2
    v_max3_u32 v3, v16, v17, v18
    v_max_u32 v3, v3, v19
    v_cmp_eq_u32 vcc, -1, v3
    s_cbranch_vccz L_pgot2
    s_cmp_eq_u32 s62, 3
    s_cbranch_scc1 L_pi3
    v_max3_u32 v3, v20, v21, v22
    v_max_u32 v3, v3, v23
    v_cmp_eq_u32 vcc, -1, v3
    s_cbranch_vccz L_pgot3
    s_cmp_eq_u32 s62, 4
    s_cbranch_scc1 L_pi4
    v_max3_u32 v3, v24, v25, v26
    v_max_u32 v3, v3, v27
    v_cmp_eq_u32 vcc, -1, v3
    s_cbranch_vccz L_pgot4
    s_cmp_eq_u32 s62, 5
    s_cbranch_scc1 L_pi5
    v_max3_u32 v3, v28, v29, v30
    v_max_u32 v3, v3, v31
    v_cmp_eq_u32 vcc, -1, v3
    s_cbranch_vccz L_pgot5
    s_cmp_eq_u32 s62, 6
    s_cbranch_scc1 L_pi6
    v_max3_u32 v3, v32, v33, v34
    v_max_u32 v3, v3, v35
    v_cmp_eq_u32 vcc, -1, v3
    s_cbranch_vccz L_pgot6
    s_cmp_eq_u32 s62, 7
    s_cbranch_scc1 L_pi7
    v_max3_u32 v3, v36, v37, v38
    v_max_u32 v3, v3, v39
    v_cmp_eq_u32 vcc, -1, v3
    s_cbranch_vccz L_pgot7
    s_branch L_pi8
L_pgot0:
    v_dot2c_f32_bf16 v64, s58, v8
    v_dot2c_f32_bf16 v65, s59, v8
    v_dot2c_f32_bf16 v66, s58, v9
    v_dot2c_f32_bf16 v67, s59, v9
    v_dot2c_f32_bf16 v68, s58, v10
    v_dot2c_f32_bf16 v69, s59, v10
    v_dot2c_f32_bf16 v70, s58, v11
    v_dot2c_f32_bf16 v71, s59, v11
    s_bitset0_b32 s63, s12
    s_cmp_eq_u32 s63, 0
    s_cbranch_scc1 L_pgd
L_pn0:
    s_cmp_eq_u32 s62, 1
    s_cbranch_scc1 L_prb
    v_max3_u32 v3, v12, v13, v14
    v_max_u32 v3, v3, v15
    v_cmp_eq_u32 vcc, -1, v3
    s_cbranch_vccnz L_pn1
L_pgot1:
    v_dot2c_f32_bf16 v64, s58, v12
    v_dot2c_f32_bf16 v65, s59, v12
    v_dot2c_f32_bf16 v66, s58, v13
    v_dot2c_f32_bf16 v67, s59, v13
    v_dot2c_f32_bf16 v68, s58, v14
    v_dot2c_f32_bf16 v69, s59, v14
    v_dot2c_f32_bf16 v70, s58, v15
    v_dot2c_f32_bf16 v71, s59, v15
    s_bitset0_b32 s63, s13
    s_cmp_eq_u32 s63, 0
    s_cbranch_scc1 L_pgd
L_pn1:
    s_cmp_eq_u32 s62, 2
    s_cbranch_scc1 L_prb
    v_max3_u32 v3, v16, v17, v18
    v_max_u32 v3, v3, v19
    v_cmp_eq_u32 vcc, -1, v3
    s_cbranch_vccnz L_pn2
L_pgot2:
    v_dot2c_f32_bf16 v64, s58, v16
    v_dot2c_f32_bf16 v65, s59, v16
    v_dot2c_f32_bf16 v66, s58, v17
    v_dot2c_f32_bf16 v67, s59, v17
    v_dot2c_f32_bf16 v68, s58, v18
    v_dot2c_f32_bf16 v69, s59, v18
    v_dot2c_f32_bf16 v70, s58, v19
    v_dot2c_f32_bf16 v71, s59, v19
    s_bitset0_b32 s63, s14
    s_cmp_eq_u32 s63, 0
    s_cbranch_scc1 L_pgd
L_pn2:
    s_cmp_eq_u32 s62, 3
    s_cbranch_scc1 L_prb
    v_max3_u32 v3, v20, v21, v22
    v_max_u32 v3, v3, v23
    v_cmp_eq_u32 vcc, -1, v3
    s_cbranch_vccnz L_pn3
L_pgot3:
    v_dot2c_f32_bf16 v64, s58, v20
    v_dot2c_f32_bf16 v65, s59, v20
    v_dot2c_f32_bf16 v66, s58, v21
    v_dot2c_f32_bf16 v67, s59, v21
    v_dot2c_f32_bf16 v68, s58, v22
    v_dot2c_f32_bf16 v69, s59, v22
    v_dot2c_f32_bf16 v70, s58, v23
    v_dot2c_f32_bf16 v71, s59, v23
    s_bitset0_b32 s63, s15
    s_cmp_eq_u32 s63, 0
    s_cbranch_scc1 L_pgd
L_pn3:
    s_cmp_eq_u32 s62, 4
    s_cbranch_scc1 L_prb
    v_max3_u32 v3, v24, v25, v26
    v_max_u32 v3, v3, v27
    v_cmp_eq_u32 vcc, -1, v3
    s_cbranch_vccnz L_pn4
L_pgot4:
    v_dot2c_f32_bf16 v64, s58, v24
    v_dot2c_f32_bf16 v65, s59, v24
    v_dot2c_f32_bf16 v66, s58, v25
    v_dot2c_f32_bf16 v67, s59, v25
    v_dot2c_f32_bf16 v68, s58, v26
    v_dot2c_f32_bf16 v69, s59, v26
    v_dot2c_f32_bf16 v70, s58, v27
    v_dot2c_f32_bf16 v71, s59, v27
    s_bitset0_b32 s63, s16
    s_cmp_eq_u32 s63, 0
    s_cbranch_scc1 L_pgd
L_pn4:
    s_cmp_eq_u32 s62, 5
    s_cbranch_scc1 L_prb
    v_max3_u32 v3, v28, v29, v30
    v_max_u32 v3, v3, v31
    v_cmp_eq_u32 vcc, -1, v3
    s_cbranch_vccnz L_pn5
L_pgot5:
    v_dot2c_f32_bf16 v64, s58, v28
    v_dot2c_f32_bf16 v65, s59, v28
    v_dot2c_f32_bf16 v66, s58, v29
    v_dot2c_f32_bf16 v67, s59, v29
    v_dot2c_f32_bf16 v68, s58, v30
    v_dot2c_f32_bf16 v69, s59, v30
    v_dot2c_f32_bf16 v70, s58, v31
    v_dot2c_f32_bf16 v71, s59, v31
    s_bitset0_b32 s63, s17
    s_cmp_eq_u32 s63, 0
    s_cbranch_scc1 L_pgd
L_pn5:
    s_cmp_eq_u32 s62, 6
    s_cbranch_scc1 L_prb
    v_max3_u32 v3, v32, v33, v34
    v_max_u32 v3, v3, v35
    v_cmp_eq_u32 vcc, -1, v3
    s_cbranch_vccnz L_pn6
L_pgot6:
    v_dot2c_f32_bf16 v64, s58, v32
    v_dot2c_f32_bf16 v65, s59, v32
    v_dot2c_f32_bf16 v66, s58, v33
    v_dot2c_f32_bf16 v67, s59, v33
    v_dot2c_f32_bf16 v68, s58, v34
    v_dot2c_f32_bf16 v69, s59, v34
    v_dot2c_f32_bf16 v70, s58, v35
    v_dot2c_f32_bf16 v71, s59, v35
    s_bitset0_b32 s63, s18
    s_cmp_eq_u32 s63, 0
    s_cbranch_scc1 L_pgd
L_pn6:
    s_cmp_eq_u32 s62, 7
    s_cbranch_scc1 L_prb
    v_max3_u32 v3, v36, v37, v38
    v_max_u32 v3, v3, v39
    v_cmp_eq_u32 vcc, -1, v3
    s_cbranch_vccnz L_pn7
L_pgot7:
    v_dot2c_f32_bf16 v64, s58, v36
    v_dot2c_f32_bf16 v65, s59, v36
    v_dot2c_f32_bf16 v66, s58, v37
    v_dot2c_f32_bf16 v67, s59, v37
    v_dot2c_f32_bf16 v68, s58, v38
    v_dot2c_f32_bf16 v69, s59, v38
    v_dot2c_f32_bf16 v70, s58, v39
    v_dot2c_f32_bf16 v71, s59, v39
    s_bitset0_b32 s63, s19
    s_cmp_eq_u32 s63, 0
    s_cbranch_scc1 L_pgd
L_pn7:
    s_branch L_prb
L_pi1:
L_poll_123:
    buffer_load_dwordx4 v[8:11], v5, s[40:43], s4 offen sc1
    s_sub_u32 s60, s60, 1
    s_cbranch_scc1 L_poll_123t
    s_waitcnt vmcnt(0)
    v_max3_u32 v3, v8, v9, v10
    v_max_u32 v3, v3, v11
    v_cmp_eq_u32 vcc, -1, v3
    s_cbranch_vccnz L_poll_123
L_poll_123e:
    v_dot2c_f32_bf16 v64, s58, v8
    v_dot2c_f32_bf16 v65, s59, v8
    v_dot2c_f32_bf16 v66, s58, v9
    v_dot2c_f32_bf16 v67, s59, v9
    v_dot2c_f32_bf16 v68, s58, v10
    v_dot2c_f32_bf16 v69, s59, v10
    v_dot2c_f32_bf16 v70, s58, v11
    v_dot2c_f32_bf16 v71, s59, v11
L_pgd:
    v_pk_fma_f32 v[64:65], v[64:65], v[48:49], v[40:41]
    v_pk_fma_f32 v[66:67], v[66:67], v[50:51], v[42:43]
    v_pk_fma_f32 v[68:69], v[68:69], v[52:53], v[44:45]
    v_pk_fma_f32 v[70:71], v[70:71], v[54:55], v[46:47]
    v_pk_mul_f32 v[56:57], v[64:65], v[56:57]
    v_pk_mul_f32 v[58:59], v[66:67], v[58:59]
    v_pk_mul_f32 v[60:61], v[68:69], v[60:61]
    v_pk_mul_f32 v[62:63], v[70:71], v[62:63]
    v_cvt_pk_bf16_f32 v8, v56, v57
    v_cvt_pk_bf16_f32 v9, v58, v59
    v_cvt_pk_bf16_f32 v10, v60, v61
    v_cvt_pk_bf16_f32 v11, v62, v63
    ds_write_b128 v4, v[8:11]
    v_pk_add_f32 v[40:41], v[64:65], v[66:67]
    v_pk_add_f32 v[42:43], v[68:69], v[70:71]
    v_pk_mul_f32 v[44:45], v[64:65], v[64:65]
    v_pk_mul_f32 v[46:47], v[66:67], v[66:67]
    v_pk_add_f32 v[40:41], v[40:41], v[42:43]
    v_pk_fma_f32 v[44:45], v[68:69], v[68:69], v[44:45]
    v_pk_fma_f32 v[46:47], v[70:71], v[70:71], v[46:47]
    s_waitcnt lgkmcnt(0)
    s_barrier
    v_add_f32 v8, v40, v41
    v_pk_add_f32 v[44:45], v[44:45], v[46:47]
    v_add_f32 v9, v44, v45
    v_add_f32_dpp v8, v8, v8 quad_perm:[1,0,3,2] row_mask:0xf bank_mask:0xf
    s_nop 0
    v_add_f32_dpp v9, v9, v9 quad_perm:[1,0,3,2] row_mask:0xf bank_mask:0xf
    v_add_f32_dpp v8, v8, v8 quad_perm:[2,3,0,1] row_mask:0xf bank_mask:0xf
    s_nop 0
    v_add_f32_dpp v9, v9, v9 quad_perm:[2,3,0,1] row_mask:0xf bank_mask:0xf
    v_add_f32_dpp v8, v8, v8 row_ror:4 row_mask:0xf bank_mask:0xf
    s_nop 0
    v_add_f32_dpp v9, v9, v9 row_ror:4 row_mask:0xf bank_mask:0xf
    v_add_f32_dpp v8, v8, v8 row_ror:8 row_mask:0xf bank_mask:0xf
    s_nop 0
    v_add_f32_dpp v9, v9, v9 row_ror:8 row_mask:0xf bank_mask:0xf
    ds_write_b64 v7, v[8:9]
    s_waitcnt lgkmcnt(0)
    s_barrier
    ds_write_b128 v6, v[64:67]
    ds_write_b128 v6, v[68:71] offset:16
    s_waitcnt vmcnt(0) lgkmcnt(0)
    s_cmp_lg_u32 s3, 7
    s_cbranch_scc1 L_ffn2
    s_cmp_lt_u32 s35, 20
    s_cbranch_scc1 L_fin
    s_endpgm
L_ffn1:
    s_barrier
    ds_read_b128 v[8:11], v79 offset:0
    ds_read_b128 v[12:15], v79 offset:256
    ds_read_b128 v[16:19], v79 offset:512
    ds_read_b128 v[20:23], v79 offset:768
    ds_read_b128 v[24:27], v79 offset:1024
    s_waitcnt vmcnt(0)
    v_lshlrev_b32 v82, 16, v82
    v_add_f32 v85, v85, v82
    s_waitcnt lgkmcnt(4)
    v_mfma_f32_16x16x32_bf16 v[32:35], v[88:91], v[8:11], 0
    v_mfma_f32_16x16x32_bf16 v[36:39], v[92:95], v[8:11], 0
    v_mfma_f32_16x16x32_bf16 v[40:43], v[96:99], v[8:11], 0
    v_mfma_f32_16x16x32_bf16 v[44:47], v[100:103], v[8:11], 0
    s_waitcnt lgkmcnt(3)
    v_mfma_f32_16x16x32_bf16 v[32:35], v[104:107], v[12:15], v[32:35]
    v_mfma_f32_16x16x32_bf16 v[36:39], v[108:111], v[12:15], v[36:39]
    v_mfma_f32_16x16x32_bf16 v[40:43], v[112:115], v[12:15], v[40:43]
    v_mfma_f32_16x16x32_bf16 v[44:47], v[116:119], v[12:15], v[44:47]
    s_waitcnt lgkmcnt(2)
    v_mfma_f32_16x16x32_bf16 v[32:35], v[120:123], v[16:19], v[32:35]
    v_mfma_f32_16x16x32_bf16 v[36:39], v[124:127], v[16:19], v[36:39]
    v_mfma_f32_16x16x32_bf16 v[40:43], v[128:131], v[16:19], v[40:43]
    v_mfma_f32_16x16x32_bf16 v[44:47], v[132:135], v[16:19], v[44:47]
    s_waitcnt lgkmcnt(1)
    s_barrier
    ds_read_b128 v[48:51], v81
    ds_read_b128 v[52:55], v81 offset:16
    ds_read_b64 v[56:57], v81 offset:32
    v_mfma_f32_16x16x32_bf16 v[32:35], v[136:139], v[20:23], v[32:35]
    v_mfma_f32_16x16x32_bf16 v[36:39], v[140:143], v[20:23], v[36:39]
    v_mfma_f32_16x16x32_bf16 v[40:43], v[144:147], v[20:23], v[40:43]
    v_mfma_f32_16x16x32_bf16 v[44:47], v[148:151], v[20:23], v[44:47]
    s_waitcnt lgkmcnt(3)
    v_mfma_f32_16x16x32_bf16 v[32:35], v[152:155], v[24:27], v[32:35]
    v_mfma_f32_16x16x32_bf16 v[36:39], v[156:159], v[24:27], v[36:39]
    s_waitcnt lgkmcnt(0)
    v_pk_add_f32 v[48:49], v[48:49], v[50:51]
    v_pk_add_f32 v[52:53], v[52:53], v[54:55]
    v_mfma_f32_16x16x32_bf16 v[40:43], v[160:163], v[24:27], v[40:43]
    v_pk_add_f32 v[48:49], v[48:49], v[56:57]
    v_pk_add_f32 v[48:49], v[48:49], v[52:53]
    v_mfma_f32_16x16x32_bf16 v[44:47], v[164:167], v[24:27], v[44:47]
    v_mul_f32 v48, s62, v48
    v_mul_f32 v49, s62, v49
    v_mul_f32 v7, v84, v48
    v_fma_f32 v49, -v48, v48, -v49
    v_max_f32 v49, 0, v49
    v_add_f32 v49, 0x3727c5ac, v49
    v_rsq_f32 v49, v49
    v_add_f32_dpp v5, v36, v7 row_ror:12 row_mask:0xf bank_mask:0x1
    v_add_f32_dpp v5, v41, v7 row_ror:12 row_mask:0xf bank_mask:0x2
    v_add_f32_dpp v5, v46, v7 row_ror:12 row_mask:0xf bank_mask:0x4
    v_add_f32_dpp v5, v35, v7 row_ror:12 row_mask:0xf bank_mask:0x8
    v_add_f32_dpp v4, v40, v32 row_ror:8 row_mask:0xf bank_mask:0x1
    v_add_f32_dpp v4, v45, v37 row_ror:8 row_mask:0xf bank_mask:0x2
    v_add_f32_dpp v4, v34, v42 row_ror:8 row_mask:0xf bank_mask:0x4
    v_add_f32_dpp v4, v39, v47 row_ror:8 row_mask:0xf bank_mask:0x8
    v_add_f32_dpp v6, v44, v5 row_ror:4 row_mask:0xf bank_mask:0x1
    v_add_f32_dpp v6, v33, v5 row_ror:4 row_mask:0xf bank_mask:0x2
    v_add_f32_dpp v6, v38, v5 row_ror:4 row_mask:0xf bank_mask:0x4
    v_add_f32_dpp v6, v43, v5 row_ror:4 row_mask:0xf bank_mask:0x8
    v_add_f32 v4, v4, v6
    v_fma_f32 v4, v4, v49, v85
    v_mul_f32 v5, v4, v4
    v_fma_f32 v5, v5, s63, v86
    v_mul_f32 v5, v5, v4
    v_exp_f32 v5, v5
    s_nop 0
    v_add_f32 v5, 1.0, v5
    v_rcp_f32 v5, v5
    s_nop 0
    v_mul_f32 v4, v4, v5
    v_cvt_pk_bf16_f32 v4, v4, v4
    ds_write_b16 v80, v4
    s_waitcnt lgkmcnt(0)
    s_barrier
    s_endpgm
L_h_t1:
    s_cmp_lg_u32 s3, 3
    s_cbranch_scc1 L_h_noclr
    s_sub_u32 s62, s56, 154
    s_cmp_lt_u32 s62, 30
    s_cbranch_scc0 L_h_noclr
    s_lshl_b32 s63, s62, 2
    s_mul_i32 s62, s62, 7168
    s_add_u32 s62, s62, 20480
    v_mov_b32 v4, -1
    v_mov_b32 v5, -1
    v_mov_b32 v6, -1
    v_mov_b32 v7, -1
    v_lshlrev_b32 v8, 4, v0
    buffer_store_dwordx4 v[4:7], v8, s[40:43], s62 offen offset:0 sc1
    buffer_store_dwordx4 v[4:7], v8, s[40:43], s62 offen offset:1024 sc1
    buffer_store_dwordx4 v[4:7], v8, s[40:43], s62 offen offset:2048 sc1
    buffer_store_dwordx4 v[4:7], v8, s[40:43], s62 offen offset:3072 sc1
    s_add_u32 s62, s62, 4096
    buffer_store_dwordx4 v[4:7], v8, s[40:43], s62 offen offset:0 sc1
    buffer_store_dwordx4 v[4:7], v8, s[40:43], s62 offen offset:1024 sc1
    buffer_store_dwordx4 v[4:7], v8, s[40:43], s62 offen offset:2048 sc1
    v_mov_b32 v8, s63
    s_waitcnt vmcnt(0)
    s_mov_b64 exec, 1
    buffer_store_dword v4, v8, s[44:47], 0 offen sc1
    s_mov_b64 exec, -1
L_h_noclr:
    v_lshrrev_b32 v1, 3, v0
    v_mul_u32_u24 v1, 1280, v1
    v_and_b32 v2, 7, v0
    v_lshl_add_u32 v1, v2, 4, v1
    s_lshl2_add_u32 s63, s34, s3
    s_mul_i32 s63, s63, 163840
    s_lshl_b32 s62, s35, 7
    s_add_u32 s63, s63, s62
    s_sub_u32 s63, s63, 2816
    s_lshl_b32 s62, s3, 14
    s_add_u32 s62, s62, 81920
    s_mov_b32 m0, s62
    s_mov_b32 s48, s12
    s_mov_b32 s49, s13
    s_mov_b32 s50, 5242880
    s_mov_b32 s51, 0x20000
    s_add_u32 s100, s39, 1
    s_mov_b32 s62, 8
L_dma_5:
    buffer_load_dwordx4 v1, s[48:51], s63 offen nt lds
    s_add_u32 m0, m0, 1024
    s_add_u32 s63, s63, 10240
    s_cmp_eq_u32 s100, 0
    s_cbranch_scc1 L_dma_5n0
    s_waitcnt vmcnt(7)
    s_cmp_eq_u32 s100, 2
    s_cbranch_scc1 L_dma_5n0
    s_waitcnt vmcnt(3)
L_dma_5n0:
    buffer_load_dwordx4 v1, s[48:51], s63 offen nt lds
    s_add_u32 m0, m0, 1024
    s_add_u32 s63, s63, 10240
    s_cmp_eq_u32 s100, 0
    s_cbranch_scc1 L_dma_5n1
    s_waitcnt vmcnt(7)
    s_cmp_eq_u32 s100, 2
    s_cbranch_scc1 L_dma_5n1
    s_waitcnt vmcnt(3)
L_dma_5n1:
    s_sub_u32 s62, s62, 1
    s_cmp_lg_u32 s62, 0
    s_cbranch_scc1 L_dma_5
    s_cmp_eq_u32 s39, 1
    s_cbranch_scc1 L_h_role
    s_waitcnt vmcnt(0)
    v_mov_b32 v4, 162060
    v_mov_b32 v5, 1
    s_mov_b64 exec, 1
    ds_add_u32 v4, v5
    s_mov_b64 exec, -1
    s_cmp_eq_u32 s3, 0
    s_cbranch_scc1 L_service
    s_endpgm
L_h_role:
    v_mov_b32 v72, 0
    v_mov_b32 v73, 0
    v_mov_b32 v74, 0
    v_mov_b32 v75, 0
    v_mov_b32 v76, 0
    v_lshrrev_b32 v3, 4, v0
    v_and_b32 v2, 3, v0
    v_bfe_u32 v1, v0, 2, 2
    v_mul_u32_u24 v160, 1280, v2
    v_lshl_add_u32 v160, v1, 5, v160
    v_lshl_add_u32 v160, v3, 3, v160
    s_mul_i32 s57, s35, 5120
    s_mul_i32 s62, s3, 320
    s_add_u32 s57, s57, s62
    s_add_u32 s57, s57, 262144
    v_mov_b32 v4, -1
    v_mov_b32 v5, -1
    v_mov_b32 v6, -1
    v_mov_b32 v7, -1
    v_lshlrev_b32 v8, 4, v0
    s_mul_i32 s62, s3, 960
    s_add_u32 s62, s62, s57
    buffer_store_dwordx4 v[4:7], v8, s[40:43], s62 offen sc1
    s_mov_b64 exec, 0xffff
    buffer_store_dwordx4 v[4:7], v8, s[40:43], s62 offen offset:1024 sc1
    s_mov_b64 exec, -1
    v_add_u32 v8, 0, v0
    v_mul_u32_u24 v10, 0xccd, v8
    v_lshrrev_b32 v10, 16, v10
    v_mul_u32_u24 v9, 20, v10
    v_sub_u32 v8, v8, v9
    v_mul_u32_u24 v10, 1280, v10
    v_lshl_add_u32 v10, v8, 4, v10
    v_add_u32 v8, 64, v0
    v_mul_u32_u24 v11, 0xccd, v8
    v_lshrrev_b32 v11, 16, v11
    v_mul_u32_u24 v9, 20, v11
    v_sub_u32 v8, v8, v9
    v_mul_u32_u24 v11, 1280, v11
    v_lshl_add_u32 v11, v8, 4, v11
    v_add_u32 v8, 128, v0
    v_mul_u32_u24 v12, 0xccd, v8
    v_lshrrev_b32 v12, 16, v12
    v_mul_u32_u24 v9, 20, v12
    v_sub_u32 v8, v8, v9
    v_mul_u32_u24 v12, 1280, v12
    v_lshl_add_u32 v12, v8, 4, v12
    v_add_u32 v8, 192, v0
    v_mul_u32_u24 v13, 0xccd, v8
    v_lshrrev_b32 v13, 16, v13
    v_mul_u32_u24 v9, 20, v13
    v_sub_u32 v8, v8, v9
    v_mul_u32_u24 v13, 1280, v13
    v_lshl_add_u32 v13, v8, 4, v13
    v_add_u32 v8, 256, v0
    v_mul_u32_u24 v14, 0xccd, v8
    v_lshrrev_b32 v14, 16, v14
    v_mul_u32_u24 v9, 20, v14
    v_sub_u32 v8, v8, v9
    v_mul_u32_u24 v14, 1280, v14
    v_lshl_add_u32 v14, v8, 4, v14
    s_waitcnt vmcnt(0)
    v_mov_b32 v8, 162060
    v_mov_b32 v9, 1
    s_mov_b64 exec, 1
    ds_add_u32 v8, v9
    s_mov_b64 exec, -1
    s_mov_b32 s48, s20
    s_mov_b32 s49, s21
    s_mov_b32 s50, 2211840
    s_mov_b32 s51, 0x20000
    s_mul_i32 s63, s35, 81920
    s_mul_i32 s62, s3, 320
    s_add_u32 s63, s63, s62
    s_mov_b32 m0, s101
    s_mov_b32 s62, 4
L_w2dma:
    buffer_load_dwordx4 v10, s[48:51], s63 offen nt lds
    s_add_u32 m0, m0, 1024
    s_waitcnt vmcnt(7)
    s_cmp_ge_u32 s35, 22
    s_cbranch_scc1 L_w2n0
    s_waitcnt vmcnt(7)
L_w2n0:
    buffer_load_dwordx4 v11, s[48:51], s63 offen nt lds
    s_add_u32 m0, m0, 1024
    s_waitcnt vmcnt(7)
    s_cmp_ge_u32 s35, 22
    s_cbranch_scc1 L_w2n1
    s_waitcnt vmcnt(7)
L_w2n1:
    buffer_load_dwordx4 v12, s[48:51], s63 offen nt lds
    s_add_u32 m0, m0, 1024
    s_waitcnt vmcnt(7)
    s_cmp_ge_u32 s35, 22
    s_cbranch_scc1 L_w2n2
    s_waitcnt vmcnt(7)
L_w2n2:
    buffer_load_dwordx4 v13, s[48:51], s63 offen nt lds
    s_add_u32 m0, m0, 1024
    s_waitcnt vmcnt(7)
    s_cmp_ge_u32 s35, 22
    s_cbranch_scc1 L_w2n3
    s_waitcnt vmcnt(7)
L_w2n3:
    buffer_load_dwordx4 v14, s[48:51], s63 offen nt lds
    s_add_u32 m0, m0, 1024
    s_waitcnt vmcnt(7)
    s_cmp_ge_u32 s35, 22
    s_cbranch_scc1 L_w2n4
    s_waitcnt vmcnt(7)
L_w2n4:
    s_add_u32 s63, s63, 20480
    s_sub_u32 s62, s62, 1
    s_cmp_lg_u32 s62, 0
    s_cbranch_scc1 L_w2dma
    v_lshl_add_u32 v8, v3, 3, v1
    v_mul_u32_u24 v8, 320, v8
    v_lshl_add_u32 v8, v2, 3, v8
    v_add_u32 v8, s101, v8
    s_waitcnt vmcnt(0)
    ds_read_b64_tr_b16 v[80:81], v8 offset:0
    ds_read_b64_tr_b16 v[82:83], v8 offset:1280
    ds_read_b64_tr_b16 v[84:85], v8 offset:10240
    ds_read_b64_tr_b16 v[86:87], v8 offset:11520
    ds_read_b64_tr_b16 v[88:89], v8 offset:32
    ds_read_b64_tr_b16 v[90:91], v8 offset:1312
    ds_read_b64_tr_b16 v[92:93], v8 offset:10272
    ds_read_b64_tr_b16 v[94:95], v8 offset:11552
    ds_read_b64_tr_b16 v[96:97], v8 offset:64
    ds_read_b64_tr_b16 v[98:99], v8 offset:1344
    ds_read_b64_tr_b16 v[100:101], v8 offset:10304
    ds_read_b64_tr_b16 v[102:103], v8 offset:11584
    ds_read_b64_tr_b16 v[104:105], v8 offset:96
    ds_read_b64_tr_b16 v[106:107], v8 offset:1376
    ds_read_b64_tr_b16 v[108:109], v8 offset:10336
    ds_read_b64_tr_b16 v[110:111], v8 offset:11616
    ds_read_b64_tr_b16 v[112:113], v8 offset:128
    ds_read_b64_tr_b16 v[114:115], v8 offset:1408
    ds_read_b64_tr_b16 v[116:117], v8 offset:10368
    ds_read_b64_tr_b16 v[118:119], v8 offset:11648
    ds_read_b64_tr_b16 v[120:121], v8 offset:160
    ds_read_b64_tr_b16 v[122:123], v8 offset:1440
    ds_read_b64_tr_b16 v[124:125], v8 offset:10400
    ds_read_b64_tr_b16 v[126:127], v8 offset:11680
    ds_read_b64_tr_b16 v[128:129], v8 offset:192
    ds_read_b64_tr_b16 v[130:131], v8 offset:1472
    ds_read_b64_tr_b16 v[132:133], v8 offset:10432
    ds_read_b64_tr_b16 v[134:135], v8 offset:11712
    ds_read_b64_tr_b16 v[136:137], v8 offset:224
    ds_read_b64_tr_b16 v[138:139], v8 offset:1504
    ds_read_b64_tr_b16 v[140:141], v8 offset:10464
    ds_read_b64_tr_b16 v[142:143], v8 offset:11744
    ds_read_b64_tr_b16 v[144:145], v8 offset:256
    ds_read_b64_tr_b16 v[146:147], v8 offset:1536
    ds_read_b64_tr_b16 v[148:149], v8 offset:10496
    ds_read_b64_tr_b16 v[150:151], v8 offset:11776
    ds_read_b64_tr_b16 v[152:153], v8 offset:288
    ds_read_b64_tr_b16 v[154:155], v8 offset:1568
    ds_read_b64_tr_b16 v[156:157], v8 offset:10528
    ds_read_b64_tr_b16 v[158:159], v8 offset:11808
    s_mov_b32 s48, s16
    s_mov_b32 s49, s17
    s_mov_b32 s50, 2211840
    s_mov_b32 s51, 0x20000
    s_lshl_b32 s98, s35, 7
    s_mov_b32 s99, 3456
    v_lshrrev_b32 v9, 3, v0
    v_mul_lo_u32 v10, v9, s99
    v_and_b32 v9, 2, v9
    v_xor_b32 v9, v9, v0
    v_and_b32 v9, 7, v9
    v_lshl_add_u32 v10, v9, 4, v10
    v_add_u32 v10, s98, v10
    v_xor_b32 v11, 64, v10
    s_mul_i32 s63, s3, 552960
    s_mov_b32 m0, s101
    s_waitcnt lgkmcnt(0)
    s_cmp_ge_u32 s35, 22
    s_cselect_b32 s100, 2, 1
    s_mov_b32 s62, 10
L_dma_6:
    buffer_load_dwordx4 v10, s[48:51], s63 offen nt lds
    s_add_u32 m0, m0, 1024
    s_add_u32 s63, s63, 27648
    s_cmp_eq_u32 s100, 0
    s_cbranch_scc1 L_dma_6n0
    s_waitcnt vmcnt(7)
    s_cmp_eq_u32 s100, 2
    s_cbranch_scc1 L_dma_6n0
    s_waitcnt vmcnt(7)
L_dma_6n0:
    buffer_load_dwordx4 v11, s[48:51], s63 offen nt lds
    s_add_u32 m0, m0, 1024
    s_add_u32 s63, s63, 27648
    s_cmp_eq_u32 s100, 0
    s_cbranch_scc1 L_dma_6n1
    s_waitcnt vmcnt(7)
    s_cmp_eq_u32 s100, 2
    s_cbranch_scc1 L_dma_6n1
    s_waitcnt vmcnt(7)
L_dma_6n1:
    s_sub_u32 s62, s62, 1
    s_cmp_lg_u32 s62, 0
    s_cbranch_scc1 L_dma_6
    v_mov_b32 v8, 162068
L_lw_7:
    ds_read_b32 v9, v8
    s_waitcnt lgkmcnt(0)
    v_cmp_gt_u32 vcc, 1, v9
    s_cbranch_vccz L_lw_7e
    s_sleep 8
    s_sub_u32 s60, s60, 1
    s_cbranch_scc0 L_lw_7
    s_mov_b32 s60, 0
L_lw_7e:
    s_cmp_lg_u32 s3, 3
    s_cbranch_scc1 L_h_nomo
    v_and_b32 v4, 15, v0
    v_lshlrev_b32 v4, 4, v4
    v_mul_u32_u24 v5, 1280, v3
    v_add_u32 v5, v5, v4
    v_mul_u32_u24 v6, 1296, v3
    v_add_u32 v6, v6, v4
    v_add_u32 v6, 147456, v6
    s_mov_b32 s62, 30720
    s_mov_b32 s63, 25600
    s_branch L_poll_8
L_poll_8s:
    s_sleep 8
L_poll_8:
    buffer_load_dwordx4 v[40:43], v5, s[40:43], s62 offen offset:0 sc1
    buffer_load_dwordx4 v[44:47], v5, s[40:43], s62 offen offset:256 sc1
    buffer_load_dwordx4 v[48:51], v5, s[40:43], s62 offen offset:512 sc1
    buffer_load_dwordx4 v[52:55], v5, s[40:43], s62 offen offset:768 sc1
    buffer_load_dwordx4 v[56:59], v5, s[40:43], s62 offen offset:1024 sc1
    buffer_load_dwordx4 v[60:63], v5, s[40:43], s63 offen offset:0 sc1
    buffer_load_dwordx4 v[64:67], v5, s[40:43], s63 offen offset:256 sc1
    buffer_load_dwordx4 v[68:71], v5, s[40:43], s63 offen offset:512 sc1
    buffer_load_dwordx4 v[72:75], v5, s[40:43], s63 offen offset:768 sc1
    buffer_load_dwordx4 v[76:79], v5, s[40:43], s63 offen offset:1024 sc1
    s_sub_u32 s60, s60, 1
    s_cbranch_scc1 L_poll_8t
    s_waitcnt vmcnt(0)
    v_max3_u32 v7, v40, v41, v42
    v_max3_u32 v7, v7, v43, v44
    v_max3_u32 v7, v7, v45, v46
    v_max3_u32 v7, v7, v47, v48
    v_max3_u32 v7, v7, v49, v50
    v_max3_u32 v7, v7, v51, v52
    v_max3_u32 v7, v7, v53, v54
    v_max3_u32 v7, v7, v55, v56
    v_max3_u32 v7, v7, v57, v58
    v_max3_u32 v7, v7, v59, v60
    v_max3_u32 v7, v7, v61, v62
    v_max3_u32 v7, v7, v63, v64
    v_max3_u32 v7, v7, v65, v66
    v_max3_u32 v7, v7, v67, v68
    v_max3_u32 v7, v7, v69, v70
    v_max3_u32 v7, v7, v71, v72
    v_max3_u32 v7, v7, v73, v74
    v_max3_u32 v7, v7, v75, v76
    v_max3_u32 v7, v7, v77, v78
    v_max_u32 v7, v7, v79
    v_cmp_eq_u32 vcc, -1, v7
    s_cbranch_vccnz L_poll_8s
L_poll_8e:
    ds_write_b128 v6, v[40:43] offset:0
    ds_write_b128 v6, v[44:47] offset:256
    ds_write_b128 v6, v[48:51] offset:512
    ds_write_b128 v6, v[52:55] offset:768
    ds_write_b128 v6, v[56:59] offset:1024
    ds_write_b128 v6, v[60:63] offset:5184
    ds_write_b128 v6, v[64:67] offset:5440
    ds_write_b128 v6, v[68:71] offset:5696
    ds_write_b128 v6, v[72:75] offset:5952
    ds_write_b128 v6, v[76:79] offset:6208
L_h_nomo:
    v_mul_u32_u24 v4, 144, v2
    v_lshl_add_u32 v4, v3, 4, v4
    v_add_u32 v161, 88384, v4
    s_mov_b32 s100, s3
    s_lshl_b32 s63, s100, 8
    v_and_b32 v8, 15, v0
    v_lshl_add_u32 v8, v8, 4, s63
    v_lshrrev_b32 v9, 4, v0
    v_mul_u32_u24 v5, 1280, v9
    v_add_u32 v5, v5, v8
    v_mul_u32_u24 v4, 1296, v9
    v_add_u32 v4, v4, v8
    v_add_u32 v4, 82944, v4
    v_lshlrev_b32 v6, 1, v5
    v_add_u32 v6, 99328, v6
    s_lshl_b32 s62, s100, 3
    s_add_u32 s62, s62, 88128
    v_lshl_add_u32 v7, v9, 6, s62
    s_mov_b32 s48, s4
    s_mov_b32 s49, s5
    s_mov_b32 s50, 5120
    s_mov_b32 s51, 0x20000
    buffer_load_dwordx4 v[8:11], v5, s[48:51], 0 offen
    s_mov_b32 s62, 20480
    s_mov_b32 s63, 30720
    s_branch L_poll_9
L_poll_9s:
    s_sleep 8
L_poll_9:
    buffer_load_dwordx4 v[12:15], v5, s[40:43], s62 offen sc1
    buffer_load_dwordx4 v[16:19], v5, s[40:43], s63 offen sc1
    s_sub_u32 s60, s60, 1
    s_cbranch_scc1 L_poll_9t
    s_waitcnt vmcnt(0)
    v_max3_u32 v38, v12, v13, v14
    v_max3_u32 v38, v38, v15, v16
    v_max3_u32 v38, v38, v17, v18
    v_max_u32 v38, v38, v19
    v_cmp_eq_u32 vcc, -1, v38
    s_cbranch_vccnz L_poll_9s
L_poll_9e:
    v_lshlrev_b32 v40, 16, v8
    v_and_b32 v41, 0xffff0000, v8
    v_lshlrev_b32 v42, 16, v9
    v_and_b32 v43, 0xffff0000, v9
    v_lshlrev_b32 v44, 16, v10
    v_and_b32 v45, 0xffff0000, v10
    v_lshlrev_b32 v46, 16, v11
    v_and_b32 v47, 0xffff0000, v11
    v_lshlrev_b32 v48, 16, v12
    v_and_b32 v49, 0xffff0000, v12
    v_lshlrev_b32 v50, 16, v13
    v_and_b32 v51, 0xffff0000, v13
    v_lshlrev_b32 v52, 16, v14
    v_and_b32 v53, 0xffff0000, v14
    v_lshlrev_b32 v54, 16, v15
    v_and_b32 v55, 0xffff0000, v15
    v_lshlrev_b32 v56, 16, v16
    v_and_b32 v57, 0xffff0000, v16
    v_lshlrev_b32 v58, 16, v17
    v_and_b32 v59, 0xffff0000, v17
    v_lshlrev_b32 v60, 16, v18
    v_and_b32 v61, 0xffff0000, v18
    v_lshlrev_b32 v62, 16, v19
    v_and_b32 v63, 0xffff0000, v19
    v_mov_b32 v64, 0
    v_mov_b32 v65, 0
    v_mov_b32 v66, 0
    v_mov_b32 v67, 0
    v_mov_b32 v68, 0
    v_mov_b32 v69, 0
    v_mov_b32 v70, 0
    v_mov_b32 v71, 0
    v_bfe_u32 v5, v0, 2, 2
    v_lshlrev_b32 v5, 8, v5
    v_lshrrev_b32 v8, 4, v0
    v_lshl_add_u32 v5, v8, 6, v5
    v_and_b32 v8, 3, v0
    v_lshl_add_u32 v5, v8, 4, v5
    s_lshl_b32 s63, s100, 10
    v_add_u32 v5, s63, v5
    s_waitcnt vmcnt(0) lgkmcnt(0)
    v_mov_b32 v8, 162064
    v_mov_b32 v9, 1
    s_mov_b64 exec, 1
    ds_add_u32 v8, v9
    s_mov_b64 exec, -1
    s_branch L_t2gate
L_ffn2:
    s_barrier
    ds_read_b128 v[8:11], v161
    ds_read_b128 v[12:15], v161 offset:64
    s_cmp_eq_u32 s61, 1
    s_cbranch_scc0 L_f2slow
    s_waitcnt lgkmcnt(1)
    v_mfma_f32_16x16x32_bf16 v[16:19], v[80:83], v[8:11], 0
    v_mfma_f32_16x16x32_bf16 v[20:23], v[88:91], v[8:11], 0
    v_mfma_f32_16x16x32_bf16 v[24:27], v[96:99], v[8:11], 0
    v_mfma_f32_16x16x32_bf16 v[28:31], v[104:107], v[8:11], 0
    s_waitcnt lgkmcnt(0)
    v_mfma_f32_16x16x32_bf16 v[16:19], v[84:87], v[12:15], v[16:19]
    v_mfma_f32_16x16x32_bf16 v[20:23], v[92:95], v[12:15], v[20:23]
    v_mfma_f32_16x16x32_bf16 v[24:27], v[100:103], v[12:15], v[24:27]
    v_mfma_f32_16x16x32_bf16 v[28:31], v[108:111], v[12:15], v[28:31]
    v_mfma_f32_16x16x32_bf16 v[32:35], v[112:115], v[8:11], 0
    v_mfma_f32_16x16x32_bf16 v[36:39], v[120:123], v[8:11], 0
    v_mfma_f32_16x16x32_bf16 v[40:43], v[128:131], v[8:11], 0
    v_mfma_f32_16x16x32_bf16 v[44:47], v[136:139], v[8:11], 0
    v_mfma_f32_16x16x32_bf16 v[32:35], v[116:119], v[12:15], v[32:35]
    v_mfma_f32_16x16x32_bf16 v[36:39], v[124:127], v[12:15], v[36:39]
    v_mfma_f32_16x16x32_bf16 v[40:43], v[132:135], v[12:15], v[40:43]
    v_mfma_f32_16x16x32_bf16 v[44:47], v[140:143], v[12:15], v[44:47]
    v_mfma_f32_16x16x32_bf16 v[48:51], v[144:147], v[8:11], 0
    v_mov_b32_dpp v16, v20 quad_perm:[0,1,2,3] row_mask:0xf bank_mask:0x2
    v_mov_b32_dpp v17, v21 quad_perm:[0,1,2,3] row_mask:0xf bank_mask:0x2
    v_mov_b32_dpp v18, v22 quad_perm:[0,1,2,3] row_mask:0xf bank_mask:0x2
    v_mfma_f32_16x16x32_bf16 v[52:55], v[152:155], v[8:11], 0
    v_mov_b32_dpp v19, v23 quad_perm:[0,1,2,3] row_mask:0xf bank_mask:0x2
    v_mov_b32_dpp v16, v24 quad_perm:[0,1,2,3] row_mask:0xf bank_mask:0x4
    v_mov_b32_dpp v17, v25 quad_perm:[0,1,2,3] row_mask:0xf bank_mask:0x4
    v_mfma_f32_16x16x32_bf16 v[48:51], v[148:151], v[12:15], v[48:51]
    v_mov_b32_dpp v18, v26 quad_perm:[0,1,2,3] row_mask:0xf bank_mask:0x4
    v_mov_b32_dpp v19, v27 quad_perm:[0,1,2,3] row_mask:0xf bank_mask:0x4
    v_mov_b32_dpp v16, v28 quad_perm:[0,1,2,3] row_mask:0xf bank_mask:0x8
    v_mfma_f32_16x16x32_bf16 v[52:55], v[156:159], v[12:15], v[52:55]
    v_mov_b32_dpp v17, v29 quad_perm:[0,1,2,3] row_mask:0xf bank_mask:0x8
    v_mov_b32_dpp v18, v30 quad_perm:[0,1,2,3] row_mask:0xf bank_mask:0x8
    v_mov_b32_dpp v19, v31 quad_perm:[0,1,2,3] row_mask:0xf bank_mask:0x8
    v_cvt_pk_bf16_f32 v16, v16, v17
    v_cvt_pk_bf16_f32 v17, v18, v19
    buffer_store_dwordx2 v[16:17], v160, s[40:43], s57 offen
    v_mov_b32_dpp v32, v36 quad_perm:[0,1,2,3] row_mask:0xf bank_mask:0x2
    v_mov_b32_dpp v33, v37 quad_perm:[0,1,2,3] row_mask:0xf bank_mask:0x2
    v_mov_b32_dpp v34, v38 quad_perm:[0,1,2,3] row_mask:0xf bank_mask:0x2
    v_mov_b32_dpp v35, v39 quad_perm:[0,1,2,3] row_mask:0xf bank_mask:0x2
    v_mov_b32_dpp v32, v40 quad_perm:[0,1,2,3] row_mask:0xf bank_mask:0x4
    v_mov_b32_dpp v33, v41 quad_perm:[0,1,2,3] row_mask:0xf bank_mask:0x4
    v_mov_b32_dpp v34, v42 quad_perm:[0,1,2,3] row_mask:0xf bank_mask:0x4
    v_mov_b32_dpp v35, v43 quad_perm:[0,1,2,3] row_mask:0xf bank_mask:0x4
    v_mov_b32_dpp v32, v44 quad_perm:[0,1,2,3] row_mask:0xf bank_mask:0x8
    v_mov_b32_dpp v33, v45 quad_perm:[0,1,2,3] row_mask:0xf bank_mask:0x8
    v_mov_b32_dpp v34, v46 quad_perm:[0,1,2,3] row_mask:0xf bank_mask:0x8
    v_mov_b32_dpp v35, v47 quad_perm:[0,1,2,3] row_mask:0xf bank_mask:0x8
    v_cvt_pk_bf16_f32 v32, v32, v33
    v_cvt_pk_bf16_f32 v33, v34, v35
    buffer_store_dwordx2 v[32:33], v160, s[40:43], s57 offen offset:128
    v_mov_b32_dpp v48, v52 quad_perm:[0,1,2,3] row_mask:0xf bank_mask:0x2
    v_mov_b32_dpp v49, v53 quad_perm:[0,1,2,3] row_mask:0xf bank_mask:0x2
    v_mov_b32_dpp v50, v54 quad_perm:[0,1,2,3] row_mask:0xf bank_mask:0x2
    v_mov_b32_dpp v51, v55 quad_perm:[0,1,2,3] row_mask:0xf bank_mask:0x2
    v_cvt_pk_bf16_f32 v48, v48, v49
    v_cvt_pk_bf16_f32 v49, v50, v51
    s_mov_b32 exec_lo, 0x00ff00ff
    s_mov_b32 exec_hi, 0x00ff00ff
    buffer_store_dwordx2 v[48:49], v160, s[40:43], s57 offen offset:256
L_f2done:
    s_barrier
    s_endpgm
L_f2slow:
    s_waitcnt lgkmcnt(1)
    v_mfma_f32_16x16x32_bf16 v[16:19], v[80:83], v[8:11], 0
    v_mfma_f32_16x16x32_bf16 v[20:23], v[88:91], v[8:11], 0
    v_mfma_f32_16x16x32_bf16 v[24:27], v[96:99], v[8:11], 0
    v_mfma_f32_16x16x32_bf16 v[28:31], v[104:107], v[8:11], 0
    s_waitcnt lgkmcnt(0)
    v_mfma_f32_16x16x32_bf16 v[16:19], v[84:87], v[12:15], v[16:19]
    v_mfma_f32_16x16x32_bf16 v[20:23], v[92:95], v[12:15], v[20:23]
    v_mfma_f32_16x16x32_bf16 v[24:27], v[100:103], v[12:15], v[24:27]
    v_mfma_f32_16x16x32_bf16 v[28:31], v[108:111], v[12:15], v[28:31]
    v_mfma_f32_16x16x32_bf16 v[32:35], v[112:115], v[8:11], 0
    v_mfma_f32_16x16x32_bf16 v[36:39], v[120:123], v[8:11], 0
    v_mfma_f32_16x16x32_bf16 v[40:43], v[128:131], v[8:11], 0
    v_mfma_f32_16x16x32_bf16 v[44:47], v[136:139], v[8:11], 0
    v_mfma_f32_16x16x32_bf16 v[32:35], v[116:119], v[12:15], v[32:35]
    v_mfma_f32_16x16x32_bf16 v[36:39], v[124:127], v[12:15], v[36:39]
    v_mfma_f32_16x16x32_bf16 v[40:43], v[132:135], v[12:15], v[40:43]
    v_mfma_f32_16x16x32_bf16 v[44:47], v[140:143], v[12:15], v[44:47]
    v_mfma_f32_16x16x32_bf16 v[48:51], v[144:147], v[8:11], 0
    v_mov_b32_dpp v16, v20 quad_perm:[0,1,2,3] row_mask:0xf bank_mask:0x2
    v_mov_b32_dpp v17, v21 quad_perm:[0,1,2,3] row_mask:0xf bank_mask:0x2
    v_mov_b32_dpp v18, v22 quad_perm:[0,1,2,3] row_mask:0xf bank_mask:0x2
    v_mfma_f32_16x16x32_bf16 v[52:55], v[152:155], v[8:11], 0
    v_mov_b32_dpp v19, v23 quad_perm:[0,1,2,3] row_mask:0xf bank_mask:0x2
    v_mov_b32_dpp v16, v24 quad_perm:[0,1,2,3] row_mask:0xf bank_mask:0x4
    v_mov_b32_dpp v17, v25 quad_perm:[0,1,2,3] row_mask:0xf bank_mask:0x4
    v_mfma_f32_16x16x32_bf16 v[48:51], v[148:151], v[12:15], v[48:51]
    v_mov_b32_dpp v18, v26 quad_perm:[0,1,2,3] row_mask:0xf bank_mask:0x4
    v_mov_b32_dpp v19, v27 quad_perm:[0,1,2,3] row_mask:0xf bank_mask:0x4
    v_mov_b32_dpp v16, v28 quad_perm:[0,1,2,3] row_mask:0xf bank_mask:0x8
    v_mfma_f32_16x16x32_bf16 v[52:55], v[156:159], v[12:15], v[52:55]
    v_mov_b32_dpp v17, v29 quad_perm:[0,1,2,3] row_mask:0xf bank_mask:0x8
    v_mov_b32_dpp v18, v30 quad_perm:[0,1,2,3] row_mask:0xf bank_mask:0x8
    v_mov_b32_dpp v19, v31 quad_perm:[0,1,2,3] row_mask:0xf bank_mask:0x8
    v_cvt_pk_bf16_f32 v16, v16, v17
    v_cvt_pk_bf16_f32 v17, v18, v19
    buffer_store_dwordx2 v[16:17], v160, s[40:43], s57 offen sc1
    v_mov_b32_dpp v32, v36 quad_perm:[0,1,2,3] row_mask:0xf bank_mask:0x2
    v_mov_b32_dpp v33, v37 quad_perm:[0,1,2,3] row_mask:0xf bank_mask:0x2
    v_mov_b32_dpp v34, v38 quad_perm:[0,1,2,3] row_mask:0xf bank_mask:0x2
    v_mov_b32_dpp v35, v39 quad_perm:[0,1,2,3] row_mask:0xf bank_mask:0x2
    v_mov_b32_dpp v32, v40 quad_perm:[0,1,2,3] row_mask:0xf bank_mask:0x4
    v_mov_b32_dpp v33, v41 quad_perm:[0,1,2,3] row_mask:0xf bank_mask:0x4
    v_mov_b32_dpp v34, v42 quad_perm:[0,1,2,3] row_mask:0xf bank_mask:0x4
    v_mov_b32_dpp v35, v43 quad_perm:[0,1,2,3] row_mask:0xf bank_mask:0x4
    v_mov_b32_dpp v32, v44 quad_perm:[0,1,2,3] row_mask:0xf bank_mask:0x8
    v_mov_b32_dpp v33, v45 quad_perm:[0,1,2,3] row_mask:0xf bank_mask:0x8
    v_mov_b32_dpp v34, v46 quad_perm:[0,1,2,3] row_mask:0xf bank_mask:0x8
    v_mov_b32_dpp v35, v47 quad_perm:[0,1,2,3] row_mask:0xf bank_mask:0x8
    v_cvt_pk_bf16_f32 v32, v32, v33
    v_cvt_pk_bf16_f32 v33, v34, v35
    buffer_store_dwordx2 v[32:33], v160, s[40:43], s57 offen offset:128 sc1
    v_mov_b32_dpp v48, v52 quad_perm:[0,1,2,3] row_mask:0xf bank_mask:0x2
    v_mov_b32_dpp v49, v53 quad_perm:[0,1,2,3] row_mask:0xf bank_mask:0x2
    v_mov_b32_dpp v50, v54 quad_perm:[0,1,2,3] row_mask:0xf bank_mask:0x2
    v_mov_b32_dpp v51, v55 quad_perm:[0,1,2,3] row_mask:0xf bank_mask:0x2
    v_cvt_pk_bf16_f32 v48, v48, v49
    v_cvt_pk_bf16_f32 v49, v50, v51
    s_mov_b32 exec_lo, 0x00ff00ff
    s_mov_b32 exec_hi, 0x00ff00ff
    buffer_store_dwordx2 v[48:49], v160, s[40:43], s57 offen offset:256 sc1
    s_branch L_f2done
L_poll_3t:
    s_mov_b32 s60, 0
    s_waitcnt vmcnt(0)
    s_branch L_poll_3e
L_poll_4t:
    s_mov_b32 s60, 0
    s_waitcnt vmcnt(0)
    s_branch L_poll_4e
L_poll_8t:
    s_mov_b32 s60, 0
    s_waitcnt vmcnt(0)
    s_branch L_poll_8e
L_poll_9t:
    s_mov_b32 s60, 0
    s_waitcnt vmcnt(0)
    s_branch L_poll_9e
L_poll_99t:
    s_mov_b32 s60, 0
    s_waitcnt vmcnt(0)
    s_branch L_poll_99e
L_pfast:
    buffer_store_dword v12, v108, s[40:43], s101 offen
    s_branch L_pdone
L_poll_101t:
    s_mov_b32 s60, 0
    s_waitcnt vmcnt(0)
    s_branch L_poll_101e
L_poll_104t:
    s_mov_b32 s60, 0
    s_waitcnt vmcnt(0)
    s_branch L_poll_104e
L_poll_106t:
    s_mov_b32 s60, 0
    s_waitcnt vmcnt(0)
    s_branch L_poll_106e
L_poll_110t:
    s_mov_b32 s60, 0
    s_waitcnt vmcnt(0)
    s_branch L_poll_110e
L_poll_112t:
    s_mov_b32 s60, 0
    s_waitcnt vmcnt(0)
    s_branch L_poll_112e
L_poll_117t:
    s_mov_b32 s60, 0
    s_waitcnt vmcnt(0)
    s_branch L_poll_117e
L_poll_119t:
    s_mov_b32 s60, 0
    s_waitcnt vmcnt(0)
    s_branch L_poll_119e
L_ygt:
    s_waitcnt vmcnt(0)
    s_branch L_ygd
L_pto:
    s_mov_b32 s60, 0
    s_waitcnt vmcnt(0)
    s_branch L_pgot0
L_poll_123t:
    s_mov_b32 s60, 0
    s_waitcnt vmcnt(0)
    s_branch L_poll_123e
L_end:
    s_endpgm
L_codeend:
.section .rodata,"a"
.p2align 6
.amdhsa_kernel adaLN_cond__sliding_block_cached__dense_activation_gelu__decode_kernel
  .amdhsa_next_free_vgpr 168
  .amdhsa_next_free_sgpr 102
  .amdhsa_accum_offset 168
  .amdhsa_group_segment_fixed_size 0
  .amdhsa_kernarg_size 120
  .amdhsa_user_sgpr_count 2
  .amdhsa_user_sgpr_kernarg_segment_ptr 1
  .amdhsa_system_sgpr_workgroup_id_x 1
.end_amdhsa_kernel
```

```asm
; @launch grid=(256,1,1) block=(768,1,1) lds=162176
.amdgcn_target "amdgcn-amd-amdhsa--gfx950"
.text
.globl adaLN_cond__sliding_block_cached__dense_activation_gelu__decode_kernel
.p2align 8
.type adaLN_cond__sliding_block_cached__dense_activation_gelu__decode_kernel,@function
adaLN_cond__sliding_block_cached__dense_activation_gelu__decode_kernel:
    s_load_dwordx16 s[4:19], s[0:1], 0
    s_load_dwordx8 s[20:27], s[0:1], 64
    s_load_dwordx4 s[28:31], s[0:1], 96
    s_load_dwordx2 s[32:33], s[0:1], 112
    s_cmp_ge_u32 s2, 256
    s_cbranch_scc1 L_end
    v_lshrrev_b32 v1, 6, v0
    v_lshlrev_b32 v2, 4, v0
    v_readfirstlane_b32 s3, v1
    v_and_b32 v0, 63, v0
    s_and_b32 s34, s2, 7
    s_lshr_b32 s35, s2, 3
    s_cmp_lg_u32 s35, 21
    s_cbranch_scc1 L_nopf
    s_getpc_b64 s[48:49]
    s_and_b32 s48, s48, 0xffffff00
    s_mov_b32 s50, L_codeend-adaLN_cond__sliding_block_cached__dense_activation_gelu__decode_kernel
    s_mov_b32 s51, 0x20000
    s_mov_b32 s52, 12288
    buffer_load_dwordx4 v[152:155], v2, s[48:51], 0 offen
    buffer_load_dwordx4 v[156:159], v2, s[48:51], s52 offen
L_nopf:
    s_lshr_b32 s36, s35, 3
    s_lshl2_add_u32 s36, s34, s36
    s_bfe_u32 s37, s35, 0x20001
    s_and_b32 s38, s35, 1
    s_cmp_lt_u32 s35, 27
    s_cselect_b32 s39, 1, 0
    s_cmp_eq_u32 s34, 2
    s_cselect_b32 s39, s39, 0
    s_sub_u32 s62, s34, 3
    s_and_b32 s62, s62, 7
    s_mul_i32 s56, s35, 7
    s_add_u32 s56, s56, s62
    s_cmp_eq_u32 s62, 7
    s_cselect_b32 s56, 255, s56
    s_mov_b32 s60, 400000
    s_mov_b32 s61, 0
    v_mov_b32 v36, 0
    s_cmp_lt_u32 s3, 4
    s_cbranch_scc1 L_helpers
    s_sub_u32 s3, s3, 4
    s_cmp_ge_u32 s35, 22
    s_cselect_b32 s59, 1, 0
    s_add_u32 s62, s3, s59
    s_cmp_ge_u32 s62, 6
    s_cselect_b32 s62, s39, 0
    s_cmp_eq_u32 s62, 1
    s_cbranch_scc1 L_proxy
    s_cmp_eq_u32 s59, 1
    s_cselect_b32 s100, 0, 81920
    s_lshl_b32 s62, s3, 13
    s_add_u32 s100, s100, s62
    s_and_b32 s62, s39, s59
    s_cselect_b32 s100, -1, s100
    s_mov_b32 s101, 0
L_stream:
    s_lshl_b32 s62, s37, 5
    s_add_u32 s62, s62, s36
    s_lshl_b32 s63, s62, 21
    s_lshl_b32 s96, s38, 18
    s_add_u32 s63, s63, s96
    s_add_u32 s63, s63, 1572864
    v_lshlrev_b32 v1, 4, v0
    s_lshl_b32 s96, s3, 12
    v_add_u32 v1, s96, v1
    s_mov_b32 s97, 0
    s_mov_b32 s50, 262144
    s_mov_b32 s51, 0x20000
    s_waitcnt lgkmcnt(0)
    s_add_u32 s48, s6, s63
    s_addc_u32 s49, s7, 0
    s_cmp_lt_u32 s56, 40
    s_cbranch_scc0 L_nob0
    s_barrier
L_nob0:
    buffer_load_dwordx4 v[40:43], v1, s[48:51], s97 offen offset:0 nt
    buffer_load_dwordx4 v[44:47], v1, s[48:51], s97 offen offset:1024 nt
    s_cmp_lt_u32 s56, 40
    s_cbranch_scc1 L_stream2
    s_barrier
    s_branch L_stream2
L_helpers:
    s_cmp_lg_u32 s3, 0
    s_cbranch_scc1 L_noinit
    v_lshlrev_b32 v1, 2, v0
    v_add_u32 v1, 161920, v1
    ds_write_b32 v1, v36
L_noinit:
    s_waitcnt lgkmcnt(0)
    s_mov_b32 s40, s32
    s_mov_b32 s41, s33
    s_mov_b32 s42, 589824
    s_mov_b32 s43, 0x20000
    s_mov_b32 s44, s30
    s_mov_b32 s45, s31
    s_mov_b32 s46, 256
    s_mov_b32 s47, 0x20000
    s_lshl2_add_u32 s62, s35, s3
    s_cmp_eq_u32 s62, 87
    s_cbranch_scc1 L_touch
L_notp:
    s_mul_i32 s101, s3, 20480
    s_mov_b32 s96, s56
    s_cmp_lt_u32 s56, 40
    s_cbranch_scc0 L_nothalf
    s_cmp_lt_u32 s3, 2
    s_cbranch_scc1 L_unit
    s_add_u32 s62, s56, 20
    s_cmp_eq_u32 s3, 2
    s_cbranch_scc1 L_job
    s_lshr_b32 s62, s56, 1
    s_and_b32 s63, s56, 1
    s_mul_i32 s63, s63, 5120
    s_lshl_b32 s96, s62, 7
    s_add_u32 s63, s63, s96
    s_cmp_ge_u32 s62, 10
    s_cselect_b32 s62, 8960, 0
    s_add_u32 s63, s63, s62
    v_lshrrev_b32 v1, 4, v0
    v_mul_u32_u24 v1, 1280, v1
    v_and_b32 v2, 15, v0
    v_lshl_add_u32 v1, v2, 3, v1
    v_mov_b32 v4, -1
    v_mov_b32 v5, -1
    buffer_store_dwordx2 v[4:5], v1, s[40:43], s63 offen sc1
    s_lshl_b32 s62, s56, 1
    s_waitcnt vmcnt(0)
    s_mov_b64 exec, 1
    buffer_store_short v4, v36, s[44:47], s62 offen offset:128 sc1
    s_mov_b64 exec, -1
    s_barrier
    s_branch L_service
L_nothalf:
    s_cmp_lt_u32 s56, 104
    s_cbranch_scc1 L_unit
    s_sub_u32 s62, s56, 144
    s_cmp_lt_u32 s62, 10
    s_cbranch_scc0 L_nojob
    s_cmp_lt_u32 s3, 2
    s_cbranch_scc0 L_nojob
    s_mul_i32 s63, s3, 10
    s_add_u32 s62, s62, s63
L_job:
    s_cmp_lt_u32 s62, 59
    s_cbranch_scc0 L_end
    s_mov_b32 s100, s101
    s_lshl_b32 s101, s62, 9
    s_add_u32 s101, s101, 196608
    s_cmp_lt_u32 s62, 27
    s_cselect_b32 s63, 0, 27
    s_cselect_b32 s3, 7, 6
    s_cmp_lt_u32 s62, 54
    s_cselect_b32 s63, s63, 32
    s_cselect_b32 s3, s3, 5
    s_sub_u32 s35, s62, s63
    s_mov_b32 s34, 2
    s_lshr_b32 s36, s35, 3
    s_add_u32 s36, s36, 8
    s_bfe_u32 s37, s35, 0x20001
    s_and_b32 s38, s35, 1
    s_mov_b32 s59, 0
    s_branch L_stream
L_nojob:
    s_barrier
    s_cmp_ge_u32 s35, 22
    s_cbranch_scc1 L_h_t1
    s_cmp_eq_u32 s39, 1
    s_cbranch_scc1 L_h_role
    s_cmp_lt_u32 s96, 144
    s_cbranch_scc1 L_unit
    s_cmp_eq_u32 s3, 3
    s_cbranch_scc1 L_service
    s_endpgm
L_unit:
    v_lshrrev_b32 v3, 4, v0
    v_and_b32 v4, 3, v0
    v_bfe_u32 v7, v0, 2, 2
    v_lshlrev_b32 v64, 5, v7
    v_lshl_add_u32 v64, v3, 3, v64
    s_mov_b32 s14, s3
    s_mov_b32 s15, 3
    s_sub_u32 s62, s96, 40
    s_cmp_lt_u32 s62, 64
    s_cbranch_scc1 L_u_q
    s_mov_b32 s100, 1
    s_sub_u32 s96, s96, 84
    s_mov_b32 s12, 10240
    s_cmp_lt_u32 s56, 40
    s_cbranch_scc0 L_u_full
    s_mov_b32 s100, 0
    s_lshr_b32 s96, s56, 1
    s_and_b32 s62, s56, 1
    s_lshl1_add_u32 s14, s62, s14
    s_mov_b32 s15, 1
    s_cmp_ge_u32 s96, 10
    s_addc_u32 s62, s62, 0
    s_mul_i32 s12, s62, 5120
    s_add_u32 s12, s12, 0
L_u_full:
    s_mov_b32 s97, 0
    s_mov_b32 s99, 7680
    s_mov_b32 s48, s26
    s_mov_b32 s49, s27
    s_mov_b32 s50, 4915200
    s_mov_b32 s51, 0x20000
    s_mov_b32 s52, s24
    s_mov_b32 s53, s25
    s_mov_b32 s54, 5120
    s_mov_b32 s55, 0x20000
    v_and_b32 v6, 15, v0
    v_lshlrev_b32 v6, 4, v6
    v_mul_u32_u24 v5, 1280, v3
    v_add_u32 v5, v5, v6
    s_mul_i32 s62, s14, 320
    buffer_load_dwordx4 v[8:11], v5, s[52:55], s62 offen
    s_mov_b32 exec_lo, 0x000f000f
    s_mov_b32 exec_hi, 0x000f000f
    buffer_load_dwordx4 v[12:15], v5, s[52:55], s62 offen offset:256
    s_mov_b64 exec, -1
    s_lshl_b32 s98, s96, 7
    s_mul_i32 s13, s96, 0x199a
    s_lshr_b32 s13, s13, 16
    s_mul_i32 s63, s13, 3840
    s_add_u32 s57, s98, s63
    s_add_u32 s57, s57, s12
    v_mul_u32_u24 v5, 1280, v4
    v_add_u32 v64, v64, v5
    s_cmp_lg_u32 s13, 1
    s_cbranch_scc1 L_u_go
    s_mov_b32 s52, s4
    s_mov_b32 s53, s5
    s_mov_b32 s54, 5120
    s_mov_b32 s55, 0x20000
    v_lshrrev_b32 v6, 2, v0
    v_lshl_add_u32 v6, v6, 4, v5
    s_sub_u32 s62, s98, 1280
    buffer_load_dwordx4 v[16:19], v6, s[52:55], 0 offen offset:0
    buffer_load_dwordx4 v[20:23], v6, s[52:55], 0 offen offset:256
    buffer_load_dwordx4 v[24:27], v6, s[52:55], 0 offen offset:512
    buffer_load_dwordx4 v[28:31], v6, s[52:55], 0 offen offset:768
    buffer_load_dwordx4 v[32:35], v6, s[52:55], 0 offen offset:1024
    buffer_load_dwordx2 v[66:67], v64, s[52:55], s62 offen
    s_branch L_u_go
L_u_q:
    s_mov_b32 s97, 1
    s_mov_b32 s99, 8192
    s_mov_b32 s100, 0
    s_lshl_b32 s98, s62, 7
    s_add_u32 s57, s98, 40960
    v_lshl_add_u32 v64, v4, 13, v64
    s_mov_b32 s48, s10
    s_mov_b32 s49, s11
    s_mov_b32 s50, 5242880
    s_mov_b32 s51, 0x20000
L_u_go:
    v_lshrrev_b32 v6, 3, v0
    v_mul_lo_u32 v1, v6, s99
    v_and_b32 v6, 2, v6
    v_xor_b32 v6, v6, v0
    v_and_b32 v6, 7, v6
    v_lshl_add_u32 v1, v6, 4, v1
    v_add_u32 v1, s98, v1
    v_xor_b32 v2, 64, v1
    s_mul_i32 s63, s99, s14
    s_mul_i32 s63, s63, 160
    s_lshl_b32 s59, s99, 3
    s_mov_b32 m0, s101
    s_mov_b32 s62, 10
L_dma_1:
    buffer_load_dwordx4 v1, s[48:51], s63 offen nt lds
    s_add_u32 m0, m0, 1024
    s_add_u32 s63, s63, s59
    s_cmp_eq_u32 s100, 0
    s_cbranch_scc1 L_dma_1n0
    s_waitcnt vmcnt(3)
    s_cmp_eq_u32 s100, 2
    s_cbranch_scc1 L_dma_1n0
    s_waitcnt vmcnt(3)
L_dma_1n0:
    buffer_load_dwordx4 v2, s[48:51], s63 offen nt lds
    s_add_u32 m0, m0, 1024
    s_add_u32 s63, s63, s59
    s_cmp_eq_u32 s100, 0
    s_cbranch_scc1 L_dma_1n1
    s_waitcnt vmcnt(3)
    s_cmp_eq_u32 s100, 2
    s_cbranch_scc1 L_dma_1n1
    s_waitcnt vmcnt(3)
L_dma_1n1:
    s_sub_u32 s62, s62, 1
    s_cmp_lg_u32 s62, 0
    s_cbranch_scc1 L_dma_1
    v_min_u32 v65, 29, v0
    v_lshlrev_b32 v65, 2, v65
    s_cmp_lt_u32 s56, 104
    s_cselect_b32 s62, 32, 64
    v_min_u32 v6, 51, v0
    v_lshlrev_b32 v6, 2, v6
    v_cmp_le_u32 vcc, s62, v0
    s_nop 1
    v_cndmask_b32 v65, v65, v6, vcc
    v_mov_b32 v68, -1
    s_cmp_lt_u32 s56, 40
    s_cbranch_scc1 L_u_nofl
    buffer_load_dword v68, v65, s[44:47], 0 offen sc1
L_u_nofl:
    s_cmp_lt_u32 s56, 104
    s_cbranch_scc0 L_u_nob
    s_barrier
L_u_nob:
    v_lshrrev_b32 v60, 4, v0
    v_lshlrev_b32 v60, 10, v60
    v_bfe_u32 v6, v0, 2, 2
    v_lshl_add_u32 v60, v6, 7, v60
    v_and_b32 v6, 3, v0
    v_lshl_add_u32 v60, v6, 3, v60
    v_bfe_u32 v6, v0, 3, 2
    v_lshl_add_u32 v60, v6, 5, v60
    v_xor_b32 v61, 32, v60
    v_xor_b32 v62, 64, v60
    v_xor_b32 v63, 0x60, v60
    v_add_u32 v60, s101, v60
    v_add_u32 v61, s101, v61
    v_add_u32 v62, s101, v62
    v_add_u32 v63, s101, v63
    v_mov_b32 v56, 1.0
    v_mov_b32 v57, 1.0
    v_mov_b32 v58, 1.0
    v_mov_b32 v59, 1.0
    s_mov_b32 s58, 0
    s_cmp_eq_u32 s97, 1
    s_cbranch_scc1 L_u_q2
    s_cmp_eq_u32 s13, 4
    s_cselect_b32 s58, 1.0, 0
    s_cmp_lt_u32 s14, 2
    s_cselect_b32 s62, 1.0, 0
    s_cmp_eq_u32 s13, 1
    s_cselect_b32 s58, s62, s58
    s_cselect_b32 s56, 1, 0
    s_waitcnt vmcnt(20)
    s_mov_b32 s62, 0xbfb8aa3b
    v_lshlrev_b32 v40, 16, v8
    v_and_b32 v41, 0xffff0000, v8
    v_lshlrev_b32 v42, 16, v9
    v_and_b32 v43, 0xffff0000, v9
    v_lshlrev_b32 v44, 16, v10
    v_and_b32 v45, 0xffff0000, v10
    v_lshlrev_b32 v46, 16, v11
    v_and_b32 v47, 0xffff0000, v11
    v_mul_f32 v48, s62, v40
    v_mul_f32 v49, s62, v41
    v_mul_f32 v50, s62, v42
    v_mul_f32 v51, s62, v43
    v_mul_f32 v52, s62, v44
    v_mul_f32 v53, s62, v45
    v_mul_f32 v54, s62, v46
    v_mul_f32 v55, s62, v47
    v_exp_f32 v48, v48
    v_exp_f32 v49, v49
    v_exp_f32 v50, v50
    v_exp_f32 v51, v51
    v_exp_f32 v52, v52
    v_exp_f32 v53, v53
    v_exp_f32 v54, v54
    v_exp_f32 v55, v55
    v_add_f32 v48, 1.0, v48
    v_add_f32 v49, 1.0, v49
    v_add_f32 v50, 1.0, v50
    v_add_f32 v51, 1.0, v51
    v_add_f32 v52, 1.0, v52
    v_add_f32 v53, 1.0, v53
    v_add_f32 v54, 1.0, v54
    v_add_f32 v55, 1.0, v55
    v_rcp_f32 v48, v48
    v_rcp_f32 v49, v49
    v_rcp_f32 v50, v50
    v_rcp_f32 v51, v51
    v_rcp_f32 v52, v52
    v_rcp_f32 v53, v53
    v_rcp_f32 v54, v54
    v_rcp_f32 v55, v55
    v_mul_f32 v40, v40, v48
    v_mul_f32 v41, v41, v49
    v_mul_f32 v42, v42, v50
    v_mul_f32 v43, v43, v51
    v_mul_f32 v44, v44, v52
    v_mul_f32 v45, v45, v53
    v_mul_f32 v46, v46, v54
    v_mul_f32 v47, v47, v55
    v_cvt_pk_bf16_f32 v8, v40, v41
    v_cvt_pk_bf16_f32 v9, v42, v43
    v_cvt_pk_bf16_f32 v10, v44, v45
    v_cvt_pk_bf16_f32 v11, v46, v47
    v_lshlrev_b32 v40, 16, v12
    v_and_b32 v41, 0xffff0000, v12
    v_lshlrev_b32 v42, 16, v13
    v_and_b32 v43, 0xffff0000, v13
    v_lshlrev_b32 v44, 16, v14
    v_and_b32 v45, 0xffff0000, v14
    v_lshlrev_b32 v46, 16, v15
    v_and_b32 v47, 0xffff0000, v15
    v_mul_f32 v48, s62, v40
    v_mul_f32 v49, s62, v41
    v_mul_f32 v50, s62, v42
    v_mul_f32 v51, s62, v43
    v_mul_f32 v52, s62, v44
    v_mul_f32 v53, s62, v45
    v_mul_f32 v54, s62, v46
    v_mul_f32 v55, s62, v47
    v_exp_f32 v48, v48
    v_exp_f32 v49, v49
    v_exp_f32 v50, v50
    v_exp_f32 v51, v51
    v_exp_f32 v52, v52
    v_exp_f32 v53, v53
    v_exp_f32 v54, v54
    v_exp_f32 v55, v55
    v_add_f32 v48, 1.0, v48
    v_add_f32 v49, 1.0, v49
    v_add_f32 v50, 1.0, v50
    v_add_f32 v51, 1.0, v51
    v_add_f32 v52, 1.0, v52
    v_add_f32 v53, 1.0, v53
    v_add_f32 v54, 1.0, v54
    v_add_f32 v55, 1.0, v55
    v_rcp_f32 v48, v48
    v_rcp_f32 v49, v49
    v_rcp_f32 v50, v50
    v_rcp_f32 v51, v51
    v_rcp_f32 v52, v52
    v_rcp_f32 v53, v53
    v_rcp_f32 v54, v54
    v_rcp_f32 v55, v55
    v_mul_f32 v40, v40, v48
    v_mul_f32 v41, v41, v49
    v_mul_f32 v42, v42, v50
    v_mul_f32 v43, v43, v51
    v_mul_f32 v44, v44, v52
    v_mul_f32 v45, v45, v53
    v_mul_f32 v46, v46, v54
    v_mul_f32 v47, v47, v55
    v_cvt_pk_bf16_f32 v12, v40, v41
    v_cvt_pk_bf16_f32 v13, v42, v43
    v_cvt_pk_bf16_f32 v14, v44, v45
    v_cvt_pk_bf16_f32 v15, v46, v47
    s_mul_i32 s62, s3, 1344
    s_add_u32 s62, s62, 151552
    v_mul_u32_u24 v5, 336, v3
    v_and_b32 v6, 15, v0
    v_lshl_add_u32 v5, v6, 4, v5
    v_add_u32 v5, s62, v5
    ds_write_b128 v5, v[8:11]
    s_mov_b32 exec_lo, 0x000f000f
    s_mov_b32 exec_hi, 0x000f000f
    ds_write_b128 v5, v[12:15] offset:256
    s_mov_b64 exec, -1
    v_mul_u32_u24 v5, 336, v4
    v_lshl_add_u32 v5, v3, 4, v5
    v_add_u32 v5, s62, v5
    s_mov_b32 s59, 0x3e800000
    s_cmp_eq_u32 s56, 0
    s_cbranch_scc1 L_u_nost
    v_mov_b32 v40, 0
    v_mov_b32 v41, 0
    s_mov_b32 s62, 0x3f803f80
    v_dot2c_f32_bf16 v40, s62, v16
    v_dot2c_f32_bf16 v41, v16, v16
    v_dot2c_f32_bf16 v40, s62, v17
    v_dot2c_f32_bf16 v41, v17, v17
    v_dot2c_f32_bf16 v40, s62, v18
    v_dot2c_f32_bf16 v41, v18, v18
    v_dot2c_f32_bf16 v40, s62, v19
    v_dot2c_f32_bf16 v41, v19, v19
    v_dot2c_f32_bf16 v40, s62, v20
    v_dot2c_f32_bf16 v41, v20, v20
    v_dot2c_f32_bf16 v40, s62, v21
    v_dot2c_f32_bf16 v41, v21, v21
    v_dot2c_f32_bf16 v40, s62, v22
    v_dot2c_f32_bf16 v41, v22, v22
    v_dot2c_f32_bf16 v40, s62, v23
    v_dot2c_f32_bf16 v41, v23, v23
    v_dot2c_f32_bf16 v40, s62, v24
    v_dot2c_f32_bf16 v41, v24, v24
    v_dot2c_f32_bf16 v40, s62, v25
    v_dot2c_f32_bf16 v41, v25, v25
    v_dot2c_f32_bf16 v40, s62, v26
    v_dot2c_f32_bf16 v41, v26, v26
    v_dot2c_f32_bf16 v40, s62, v27
    v_dot2c_f32_bf16 v41, v27, v27
    v_dot2c_f32_bf16 v40, s62, v28
    v_dot2c_f32_bf16 v41, v28, v28
    v_dot2c_f32_bf16 v40, s62, v29
    v_dot2c_f32_bf16 v41, v29, v29
    v_dot2c_f32_bf16 v40, s62, v30
    v_dot2c_f32_bf16 v41, v30, v30
    v_dot2c_f32_bf16 v40, s62, v31
    v_dot2c_f32_bf16 v41, v31, v31
    v_dot2c_f32_bf16 v40, s62, v32
    v_dot2c_f32_bf16 v41, v32, v32
    v_dot2c_f32_bf16 v40, s62, v33
    v_dot2c_f32_bf16 v41, v33, v33
    v_dot2c_f32_bf16 v40, s62, v34
    v_dot2c_f32_bf16 v41, v34, v34
    v_dot2c_f32_bf16 v40, s62, v35
    v_dot2c_f32_bf16 v41, v35, v35
    s_nop 1
    v_add_f32_dpp v40, v40, v40 row_ror:4 row_mask:0xf bank_mask:0xf
    v_add_f32_dpp v41, v41, v41 row_ror:4 row_mask:0xf bank_mask:0xf
    s_nop 0
    v_add_f32_dpp v40, v40, v40 row_ror:8 row_mask:0xf bank_mask:0xf
    v_add_f32_dpp v41, v41, v41 row_ror:8 row_mask:0xf bank_mask:0xf
    v_mov_b32 v42, v40
    v_mov_b32 v43, v41
    s_nop 0
    v_permlane16_swap_b32 v40, v42
    v_permlane16_swap_b32 v41, v43
    v_add_f32 v40, v40, v42
    v_add_f32 v41, v41, v43
    v_mov_b32 v42, v40
    v_mov_b32 v43, v41
    s_nop 0
    v_permlane32_swap_b32 v40, v42
    v_permlane32_swap_b32 v41, v43
    v_add_f32 v40, v40, v42
    v_add_f32 v41, v41, v43
    s_mov_b32 s62, 0x3acccccd
    v_mul_f32 v40, s62, v40
    v_mul_f32 v41, s62, v41
    v_fma_f32 v41, -v40, v40, v41
    v_max_f32 v41, 0, v41
    v_add_f32 v41, 0x3727c5ac, v41
    v_rsq_f32 v41, v41
    v_lshlrev_b32 v56, 16, v66
    v_and_b32 v57, 0xffff0000, v66
    v_lshlrev_b32 v58, 16, v67
    v_and_b32 v59, 0xffff0000, v67
    v_sub_f32 v56, v56, v40
    v_sub_f32 v57, v57, v40
    v_sub_f32 v58, v58, v40
    v_sub_f32 v59, v59, v40
    v_mul_f32 v56, v56, v41
    v_mul_f32 v57, v57, v41
    v_mul_f32 v58, v58, v41
    v_mul_f32 v59, v59, v41
L_u_nost:
    ds_read_b128 v[8:11], v5 offset:0
    ds_read_b128 v[12:15], v5 offset:64
    ds_read_b128 v[16:19], v5 offset:128
    ds_read_b128 v[20:23], v5 offset:192
    ds_read_b128 v[24:27], v5 offset:256
    s_branch L_u_frag
L_u_q2:
    v_and_b32 v5, 15, v0
    v_mul_u32_u24 v5, 1280, v5
    v_lshl_add_u32 v5, v3, 4, v5
    s_mul_i32 s63, s3, 320
    s_add_u32 s63, s63, 0
    s_mov_b32 s59, 1.0
L_u_frag:
    s_waitcnt vmcnt(0)
    v_cmp_ne_u32 vcc, -1, v68
    s_cbranch_vccz L_u_yok
L_wy_2:
    buffer_load_dword v37, v65, s[44:47], 0 offen sc1
    s_waitcnt vmcnt(0)
    v_cmp_ne_u32 vcc, -1, v37
    s_cbranch_vccz L_wy_2e
    s_sleep 4
    s_sub_u32 s60, s60, 1
    s_cbranch_scc0 L_wy_2
    s_mov_b32 s60, 0
L_wy_2e:
L_u_yok:
    ds_read_b64_tr_b16 v[80:81], v60 offset:0
    ds_read_b64_tr_b16 v[82:83], v60 offset:512
    ds_read_b64_tr_b16 v[84:85], v61 offset:0
    ds_read_b64_tr_b16 v[86:87], v61 offset:512
    ds_read_b64_tr_b16 v[88:89], v62 offset:0
    ds_read_b64_tr_b16 v[90:91], v62 offset:512
    ds_read_b64_tr_b16 v[92:93], v63 offset:0
    ds_read_b64_tr_b16 v[94:95], v63 offset:512
    ds_read_b64_tr_b16 v[96:97], v60 offset:4096
    ds_read_b64_tr_b16 v[98:99], v60 offset:4608
    ds_read_b64_tr_b16 v[100:101], v61 offset:4096
    ds_read_b64_tr_b16 v[102:103], v61 offset:4608
    ds_read_b64_tr_b16 v[104:105], v62 offset:4096
    ds_read_b64_tr_b16 v[106:107], v62 offset:4608
    ds_read_b64_tr_b16 v[108:109], v63 offset:4096
    ds_read_b64_tr_b16 v[110:111], v63 offset:4608
    ds_read_b64_tr_b16 v[112:113], v60 offset:8192
    ds_read_b64_tr_b16 v[114:115], v60 offset:8704
    ds_read_b64_tr_b16 v[116:117], v61 offset:8192
    ds_read_b64_tr_b16 v[118:119], v61 offset:8704
    ds_read_b64_tr_b16 v[120:121], v62 offset:8192
    ds_read_b64_tr_b16 v[122:123], v62 offset:8704
    ds_read_b64_tr_b16 v[124:125], v63 offset:8192
    ds_read_b64_tr_b16 v[126:127], v63 offset:8704
    ds_read_b64_tr_b16 v[128:129], v60 offset:12288
    ds_read_b64_tr_b16 v[130:131], v60 offset:12800
    ds_read_b64_tr_b16 v[132:133], v61 offset:12288
    ds_read_b64_tr_b16 v[134:135], v61 offset:12800
    ds_read_b64_tr_b16 v[136:137], v62 offset:12288
    ds_read_b64_tr_b16 v[138:139], v62 offset:12800
    ds_read_b64_tr_b16 v[140:141], v63 offset:12288
    ds_read_b64_tr_b16 v[142:143], v63 offset:12800
    ds_read_b64_tr_b16 v[144:145], v60 offset:16384
    ds_read_b64_tr_b16 v[146:147], v60 offset:16896
    ds_read_b64_tr_b16 v[148:149], v61 offset:16384
    ds_read_b64_tr_b16 v[150:151], v61 offset:16896
    ds_read_b64_tr_b16 v[152:153], v62 offset:16384
    ds_read_b64_tr_b16 v[154:155], v62 offset:16896
    ds_read_b64_tr_b16 v[156:157], v63 offset:16384
    ds_read_b64_tr_b16 v[158:159], v63 offset:16896
    s_cmp_eq_u32 s97, 0
    s_cbranch_scc1 L_u_mm
    v_lshrrev_b32 v6, 2, v0
    v_mul_u32_u24 v6, 158, v6
    v_and_b32 v6, 0xfffc, v6
    v_and_b32 v7, 3, v0
    v_mul_u32_u24 v7, 5120, v7
    v_add_u32 v6, v6, v7
    s_mov_b64 exec, 0xfff
    s_branch L_poll_3
L_poll_3s:
    s_sleep 4
L_poll_3:
    buffer_load_dword v8, v6, s[40:43], s63 offen offset:3840 sc1
    s_sub_u32 s60, s60, 1
    s_cbranch_scc1 L_poll_3t
    s_waitcnt vmcnt(0)
    v_cmp_eq_u32 vcc, -1, v8
    s_cbranch_vccnz L_poll_3s
L_poll_3e:
    s_mov_b64 exec, -1
    s_branch L_poll_4
L_poll_4s:
    s_sleep 1
L_poll_4:
    buffer_load_dwordx4 v[8:11], v5, s[40:43], s63 offen offset:0 sc1
    buffer_load_dwordx4 v[12:15], v5, s[40:43], s63 offen offset:64 sc1
    buffer_load_dwordx4 v[16:19], v5, s[40:43], s63 offen offset:128 sc1
    buffer_load_dwordx4 v[20:23], v5, s[40:43], s63 offen offset:192 sc1
    buffer_load_dwordx4 v[24:27], v5, s[40:43], s63 offen offset:256 sc1
    s_sub_u32 s60, s60, 1
    s_cbranch_scc1 L_poll_4t
    s_waitcnt vmcnt(0)
    v_max3_u32 v37, v8, v9, v10
    v_max3_u32 v37, v37, v11, v12
    v_max3_u32 v37, v37, v13, v14
    v_max3_u32 v37, v37, v15, v16
    v_max3_u32 v37, v37, v17, v18
    v_max3_u32 v37, v37, v19, v20
    v_max3_u32 v37, v37, v21, v22
    v_max3_u32 v37, v37, v23, v24
    v_max3_u32 v37, v37, v25, v26
    v_max_u32 v37, v37, v27
    v_cmp_eq_u32 vcc, -1, v37
    s_cbranch_vccnz L_poll_4s
L_poll_4e:
L_u_got:
L_u_mm:
    s_waitcnt lgkmcnt(0)
    v_mfma_f32_16x16x32_bf16 v[40:43], v[80:83], v[8:11], 0
    v_mfma_f32_16x16x32_bf16 v[44:47], v[84:87], v[8:11], 0
    v_mfma_f32_16x16x32_bf16 v[48:51], v[88:91], v[8:11], 0
    v_mfma_f32_16x16x32_bf16 v[52:55], v[92:95], v[8:11], 0
    v_mfma_f32_16x16x32_bf16 v[40:43], v[96:99], v[12:15], v[40:43]
    v_mfma_f32_16x16x32_bf16 v[44:47], v[100:103], v[12:15], v[44:47]
    v_mfma_f32_16x16x32_bf16 v[48:51], v[104:107], v[12:15], v[48:51]
    v_mfma_f32_16x16x32_bf16 v[52:55], v[108:111], v[12:15], v[52:55]
    v_mfma_f32_16x16x32_bf16 v[40:43], v[112:115], v[16:19], v[40:43]
    v_mfma_f32_16x16x32_bf16 v[44:47], v[116:119], v[16:19], v[44:47]
    v_mfma_f32_16x16x32_bf16 v[48:51], v[120:123], v[16:19], v[48:51]
    v_mfma_f32_16x16x32_bf16 v[52:55], v[124:127], v[16:19], v[52:55]
    v_mfma_f32_16x16x32_bf16 v[40:43], v[128:131], v[20:23], v[40:43]
    v_mfma_f32_16x16x32_bf16 v[44:47], v[132:135], v[20:23], v[44:47]
    v_mfma_f32_16x16x32_bf16 v[48:51], v[136:139], v[20:23], v[48:51]
    v_mfma_f32_16x16x32_bf16 v[52:55], v[140:143], v[20:23], v[52:55]
    v_mfma_f32_16x16x32_bf16 v[40:43], v[144:147], v[24:27], v[40:43]
    v_mfma_f32_16x16x32_bf16 v[44:47], v[148:151], v[24:27], v[44:47]
    v_mfma_f32_16x16x32_bf16 v[48:51], v[152:155], v[24:27], v[48:51]
    v_mfma_f32_16x16x32_bf16 v[52:55], v[156:159], v[24:27], v[52:55]
    v_lshlrev_b32 v5, 4, v0
    v_add_u32 v5, 147456, v5
    s_lshl_b32 s62, s3, 10
    v_add_u32 v6, s62, v5
    v_mov_b32 v32, 162056
    v_mov_b32 v33, 1
    v_add_f32_dpp v40, v40, v40 row_ror:8 row_mask:0xf bank_mask:0xf
    v_add_f32_dpp v41, v41, v41 row_ror:8 row_mask:0xf bank_mask:0xf
    v_add_f32_dpp v42, v42, v42 row_ror:8 row_mask:0xf bank_mask:0xf
    v_add_f32_dpp v43, v43, v43 row_ror:8 row_mask:0xf bank_mask:0xf
    v_add_f32_dpp v44, v44, v44 row_ror:8 row_mask:0xf bank_mask:0xf
    v_add_f32_dpp v45, v45, v45 row_ror:8 row_mask:0xf bank_mask:0xf
    v_add_f32_dpp v46, v46, v46 row_ror:8 row_mask:0xf bank_mask:0xf
    v_add_f32_dpp v47, v47, v47 row_ror:8 row_mask:0xf bank_mask:0xf
    v_add_f32_dpp v48, v48, v48 row_ror:8 row_mask:0xf bank_mask:0xf
    v_add_f32_dpp v49, v49, v49 row_ror:8 row_mask:0xf bank_mask:0xf
    v_add_f32_dpp v50, v50, v50 row_ror:8 row_mask:0xf bank_mask:0xf
    v_add_f32_dpp v51, v51, v51 row_ror:8 row_mask:0xf bank_mask:0xf
    v_add_f32_dpp v52, v52, v52 row_ror:8 row_mask:0xf bank_mask:0xf
    v_add_f32_dpp v53, v53, v53 row_ror:8 row_mask:0xf bank_mask:0xf
    v_add_f32_dpp v54, v54, v54 row_ror:8 row_mask:0xf bank_mask:0xf
    v_add_f32_dpp v55, v55, v55 row_ror:8 row_mask:0xf bank_mask:0xf
    v_add_f32_dpp v28, v40, v40 row_ror:4 row_mask:0xf bank_mask:0x1
    v_add_f32_dpp v29, v41, v41 row_ror:4 row_mask:0xf bank_mask:0x1
    v_add_f32_dpp v30, v42, v42 row_ror:4 row_mask:0xf bank_mask:0x1
    v_add_f32_dpp v31, v43, v43 row_ror:4 row_mask:0xf bank_mask:0x1
    v_add_f32_dpp v28, v44, v44 row_ror:4 row_mask:0xf bank_mask:0x2
    v_add_f32_dpp v29, v45, v45 row_ror:4 row_mask:0xf bank_mask:0x2
    v_add_f32_dpp v30, v46, v46 row_ror:4 row_mask:0xf bank_mask:0x2
    v_add_f32_dpp v31, v47, v47 row_ror:4 row_mask:0xf bank_mask:0x2
    v_add_f32_dpp v28, v48, v48 row_ror:4 row_mask:0xf bank_mask:0x4
    v_add_f32_dpp v29, v49, v49 row_ror:4 row_mask:0xf bank_mask:0x4
    v_add_f32_dpp v30, v50, v50 row_ror:4 row_mask:0xf bank_mask:0x4
    v_add_f32_dpp v31, v51, v51 row_ror:4 row_mask:0xf bank_mask:0x4
    v_add_f32_dpp v28, v52, v52 row_ror:4 row_mask:0xf bank_mask:0x8
    v_add_f32_dpp v29, v53, v53 row_ror:4 row_mask:0xf bank_mask:0x8
    v_add_f32_dpp v30, v54, v54 row_ror:4 row_mask:0xf bank_mask:0x8
    v_add_f32_dpp v31, v55, v55 row_ror:4 row_mask:0xf bank_mask:0x8
    ds_write_b128 v6, v[28:31]
    s_mov_b64 exec, 1
    ds_add_rtn_u32 v34, v32, v33
    s_mov_b64 exec, -1
    ds_read_b128 v[8:11], v5
    ds_read_b128 v[12:15], v5 offset:1024
    ds_read_b128 v[16:19], v5 offset:2048
    ds_read_b128 v[20:23], v5 offset:3072
    s_waitcnt lgkmcnt(0)
    v_readfirstlane_b32 s62, v34
    v_mov_b32 v24, s58
    s_cmp_eq_u32 s62, s15
    s_cbranch_scc1 L_u_last
    s_cmp_eq_u32 s62, 1
    s_cbranch_scc1 L_service
    s_endpgm
L_u_last:
    v_add_f32 v8, v8, v12
    v_add_f32 v9, v9, v13
    v_add_f32 v10, v10, v14
    v_add_f32 v11, v11, v15
    s_cmp_eq_u32 s15, 1
    s_cbranch_scc1 L_u_two
    v_add_f32 v16, v16, v20
    v_add_f32 v17, v17, v21
    v_add_f32 v18, v18, v22
    v_add_f32 v19, v19, v23
    v_add_f32 v8, v8, v16
    v_add_f32 v9, v9, v17
    v_add_f32 v10, v10, v18
    v_add_f32 v11, v11, v19
L_u_two:
    v_fma_f32 v8, v8, s59, v24
    v_fma_f32 v9, v9, s59, v24
    v_fma_f32 v10, v10, s59, v24
    v_fma_f32 v11, v11, s59, v24
    v_mul_f32 v8, v8, v56
    v_mul_f32 v9, v9, v57
    v_mul_f32 v10, v10, v58
    v_mul_f32 v11, v11, v59
    v_cvt_pk_bf16_f32 v8, v8, v9
    v_cvt_pk_bf16_f32 v9, v10, v11
    buffer_store_dwordx2 v[8:9], v64, s[40:43], s57 offen sc1
    s_endpgm
L_touch:
    s_load_dword s0, s[32:33], 0
    s_load_dword s0, s[30:31], 0
    s_cmp_eq_u32 s39, 1
    s_cbranch_scc1 L_tpr
    s_mov_b32 s62, 16777216
    s_load_dword s0, s[8:9], s62
    s_mov_b32 s62, 83886080
    s_load_dword s0, s[8:9], s62
    s_mov_b32 s62, 150994944
    s_load_dword s0, s[8:9], s62
    s_mov_b32 s62, 218103808
    s_load_dword s0, s[8:9], s62
    s_branch L_tpv
L_tpr:
    s_load_dword s0, s[20:21], 0
    s_mov_b32 s62, 2211836
    s_load_dword s0, s[20:21], s62
    s_load_dword s0, s[16:17], 0
    s_mov_b32 s62, 2211836
    s_load_dword s0, s[16:17], s62
    s_load_dword s0, s[18:19], 0
    s_load_dword s0, s[22:23], 0
    s_load_dword s0, s[28:29], 0
    s_load_dword s0, s[4:5], 0
L_tpv:
    s_lshl_b32 s62, s34, 23
    s_load_dword s0, s[8:9], s62
    s_add_u32 s62, s62, 67108864
    s_load_dword s0, s[8:9], s62
    s_add_u32 s62, s62, 67108864
    s_load_dword s0, s[8:9], s62
    s_add_u32 s62, s62, 67108864
    s_load_dword s0, s[8:9], s62
    s_add_u32 s62, s62, 67108864
    s_branch L_notp
L_stream2:
    s_mov_b32 s12, s100
    s_mov_b32 s13, s101
    s_mov_b32 s40, s32
    s_mov_b32 s41, s33
    s_mov_b32 s42, 589824
    s_mov_b32 s43, 0x20000
    s_mov_b32 s44, s30
    s_mov_b32 s45, s31
    s_mov_b32 s46, 256
    s_mov_b32 s47, 0x20000
    s_bitcmp1_b32 s3, 0
    s_mov_b32 s57, 0xffffffff
    s_mov_b32 s58, 0xffff
    s_mov_b32 s14, 0xffffffff
    s_mov_b32 s15, 0x0
L_pm_10:
    s_cmp_lt_u32 s56, 104
    s_cbranch_scc0 L_pm_11
    s_bitcmp1_b32 s3, 0
    s_mov_b32 s57, 0xffff
    s_mov_b32 s58, 0x0
    s_mov_b32 s14, 0xffffffff
    s_mov_b32 s15, 0x0
L_pm_11:
    s_sub_u32 s96, s56, 43
    s_and_b32 s96, s96, 0xffffffc7
    s_cmp_eq_u32 s96, 0
    s_cbranch_scc0 L_pm_12
    s_bitcmp1_b32 s3, 0
    s_mov_b32 s57, 0x0
    s_mov_b32 s58, 0x0
    s_mov_b32 s14, 0x0
    s_mov_b32 s15, 0x0
L_pm_12:
    s_cmp_lt_u32 s56, 40
    s_cbranch_scc0 L_pm_13
    s_bitcmp1_b32 s3, 0
    s_mov_b32 s57, 0xffffffff
    s_mov_b32 s58, 0xf
    s_mov_b32 s14, 0xffffffff
    s_mov_b32 s15, 0x0
L_pm_13:
    s_cmp_eq_u32 s39, 1
    s_cbranch_scc0 L_pm_14
    s_bitcmp1_b32 s3, 0
    s_mov_b32 s57, 0xff0fff
    s_cselect_b32 s57, 0xff00ffff, s57
    s_mov_b32 s58, 0xfff
    s_mov_b32 s14, 0xff00ff
    s_cselect_b32 s14, 0xff00ff00, s14
    s_mov_b32 s15, 0x0
L_pm_14:
    s_cmp_lg_u32 s13, 0
    s_cbranch_scc0 L_pm_15
    s_bitcmp1_b32 s3, 0
    s_mov_b32 s57, 0xff00ff
    s_cselect_b32 s57, 0xff00ff00, s57
    s_mov_b32 s58, 0x0
    s_mov_b32 s14, 0x0
    s_mov_b32 s15, 0x0
L_pm_15:
    s_and_b32 s96, s39, s59
    s_cbranch_scc0 L_pm_16
    s_bitcmp1_b32 s3, 0
    s_mov_b32 s57, 0xffff
    s_mov_b32 s58, 0xffff
    s_mov_b32 s14, 0x0
    s_mov_b32 s15, 0x0
L_pm_16:
    s_add_u32 s52, s8, s63
    s_addc_u32 s53, s9, 0
    s_mov_b32 s54, 262144
    s_mov_b32 s55, 0x20000
    v_and_b32 v2, 15, v0
    v_lshrrev_b32 v3, 1, v2
    v_and_b32 v37, 1, v2
    v_lshlrev_b32 v37, 4, v37
    v_mov_b32 v38, 0xffff
    v_lshlrev_b32 v37, v37, v38
    v_cmp_eq_u32 vcc, 0, v3
    v_mov_b32 v32, 0
    s_nop 0
    v_cndmask_b32 v20, 0, v37, vcc
    v_cmp_eq_u32 vcc, 1, v3
    v_mov_b32 v33, 0
    s_nop 0
    v_cndmask_b32 v21, 0, v37, vcc
    v_cmp_eq_u32 vcc, 2, v3
    v_mov_b32 v34, 0
    s_nop 0
    v_cndmask_b32 v22, 0, v37, vcc
    v_cmp_eq_u32 vcc, 3, v3
    v_mov_b32 v35, 0
    s_nop 0
    v_cndmask_b32 v23, 0, v37, vcc
    v_lshlrev_b32 v2, 4, v2
    s_lshl_b32 s98, s62, 8
    s_add_u32 s98, s98, 40960
    s_lshl_b32 s99, s62, 7
    s_add_u32 s99, s99, 73728
    s_bitcmp0_b32 s57, 2
    s_cbranch_scc1 L_sf_17
    s_bitcmp0_b32 s58, 2
    s_cbranch_scc1 L_sf_17
    s_waitcnt vmcnt(1)
L_sf_17:
    buffer_load_dwordx4 v[48:51], v1, s[48:51], s97 offen offset:2048 nt
    s_bitcmp0_b32 s57, 3
    s_cbranch_scc1 L_sf_18
    s_waitcnt vmcnt(2)
    s_bitcmp0_b32 s58, 3
    s_cbranch_scc1 L_sf_18
    s_waitcnt vmcnt(1)
L_sf_18:
    buffer_load_dwordx4 v[52:55], v1, s[48:51], s97 offen offset:3072 nt
    s_add_u32 s97, s97, 32768
    v_add_u32 v1, 4096, v1
    v_and_b32 v1, 0x7fff, v1
    s_waitcnt vmcnt(3)
    s_bitcmp0_b32 s57, 4
    s_cbranch_scc1 L_sf_19
    s_waitcnt vmcnt(2)
    s_bitcmp0_b32 s58, 4
    s_cbranch_scc1 L_sf_19
    s_waitcnt vmcnt(1)
L_sf_19:
    buffer_load_dwordx4 v[56:59], v1, s[48:51], s97 offen offset:0 nt
    s_waitcnt vmcnt(3)
    s_bitcmp0_b32 s57, 5
    s_cbranch_scc1 L_sf_20
    s_waitcnt vmcnt(2)
    s_bitcmp0_b32 s58, 5
    s_cbranch_scc1 L_sf_20
    s_waitcnt vmcnt(1)
L_sf_20:
    buffer_load_dwordx4 v[60:63], v1, s[48:51], s97 offen offset:1024 nt
    s_waitcnt vmcnt(3)
    s_bitcmp0_b32 s57, 6
    s_cbranch_scc1 L_sf_21
    s_waitcnt vmcnt(2)
    s_bitcmp0_b32 s58, 6
    s_cbranch_scc1 L_sf_21
    s_waitcnt vmcnt(1)
L_sf_21:
    buffer_load_dwordx4 v[64:67], v1, s[48:51], s97 offen offset:2048 nt
    s_waitcnt vmcnt(3)
    s_bitcmp0_b32 s57, 7
    s_cbranch_scc1 L_sf_22
    s_waitcnt vmcnt(2)
    s_bitcmp0_b32 s58, 7
    s_cbranch_scc1 L_sf_22
    s_waitcnt vmcnt(1)
L_sf_22:
    buffer_load_dwordx4 v[68:71], v1, s[48:51], s97 offen offset:3072 nt
    s_add_u32 s97, s97, 32768
    v_add_u32 v1, 4096, v1
    v_and_b32 v1, 0x7fff, v1
    s_waitcnt vmcnt(3)
    s_bitcmp0_b32 s57, 8
    s_cbranch_scc1 L_sf_23
    s_waitcnt vmcnt(2)
    s_bitcmp0_b32 s58, 8
    s_cbranch_scc1 L_sf_23
    s_waitcnt vmcnt(1)
L_sf_23:
    buffer_load_dwordx4 v[72:75], v1, s[48:51], s97 offen offset:0 nt
    s_waitcnt vmcnt(3)
    s_bitcmp0_b32 s57, 9
    s_cbranch_scc1 L_sf_24
    s_waitcnt vmcnt(2)
    s_bitcmp0_b32 s58, 9
    s_cbranch_scc1 L_sf_24
    s_waitcnt vmcnt(1)
L_sf_24:
    buffer_load_dwordx4 v[76:79], v1, s[48:51], s97 offen offset:1024 nt
    s_waitcnt vmcnt(3)
    s_bitcmp0_b32 s57, 10
    s_cbranch_scc1 L_sf_25
    s_waitcnt vmcnt(2)
    s_bitcmp0_b32 s58, 10
    s_cbranch_scc1 L_sf_25
    s_waitcnt vmcnt(1)
L_sf_25:
    buffer_load_dwordx4 v[80:83], v1, s[48:51], s97 offen offset:2048 nt
    s_waitcnt vmcnt(3)
    s_bitcmp0_b32 s57, 11
    s_cbranch_scc1 L_sf_26
    s_waitcnt vmcnt(2)
    s_bitcmp0_b32 s58, 11
    s_cbranch_scc1 L_sf_26
    s_waitcnt vmcnt(1)
L_sf_26:
    buffer_load_dwordx4 v[84:87], v1, s[48:51], s97 offen offset:3072 nt
    s_add_u32 s97, s97, 32768
    v_add_u32 v1, 4096, v1
    v_and_b32 v1, 0x7fff, v1
    s_waitcnt vmcnt(3)
    s_bitcmp0_b32 s57, 12
    s_cbranch_scc1 L_sf_27
    s_waitcnt vmcnt(2)
    s_bitcmp0_b32 s58, 12
    s_cbranch_scc1 L_sf_27
    s_waitcnt vmcnt(1)
L_sf_27:
    buffer_load_dwordx4 v[88:91], v1, s[48:51], s97 offen offset:0 nt
    s_waitcnt vmcnt(3)
    s_bitcmp0_b32 s57, 13
    s_cbranch_scc1 L_sf_28
    s_waitcnt vmcnt(2)
    s_bitcmp0_b32 s58, 13
    s_cbranch_scc1 L_sf_28
    s_waitcnt vmcnt(1)
L_sf_28:
    buffer_load_dwordx4 v[92:95], v1, s[48:51], s97 offen offset:1024 nt
    s_waitcnt vmcnt(3)
    s_bitcmp0_b32 s57, 14
    s_cbranch_scc1 L_sf_29
    s_waitcnt vmcnt(2)
    s_bitcmp0_b32 s58, 14
    s_cbranch_scc1 L_sf_29
    s_waitcnt vmcnt(1)
L_sf_29:
    buffer_load_dwordx4 v[96:99], v1, s[48:51], s97 offen offset:2048 nt
    s_waitcnt vmcnt(3)
    s_bitcmp0_b32 s57, 15
    s_cbranch_scc1 L_sf_30
    s_waitcnt vmcnt(2)
    s_bitcmp0_b32 s58, 15
    s_cbranch_scc1 L_sf_30
    s_waitcnt vmcnt(1)
L_sf_30:
    buffer_load_dwordx4 v[100:103], v1, s[48:51], s97 offen offset:3072 nt
    s_add_u32 s97, s97, 32768
    v_add_u32 v1, 4096, v1
    v_and_b32 v1, 0x7fff, v1
    s_waitcnt vmcnt(3)
    s_bitcmp0_b32 s57, 16
    s_cbranch_scc1 L_sf_31
    s_waitcnt vmcnt(2)
    s_bitcmp0_b32 s58, 16
    s_cbranch_scc1 L_sf_31
    s_waitcnt vmcnt(1)
L_sf_31:
    buffer_load_dwordx4 v[104:107], v1, s[48:51], s97 offen offset:0 nt
    s_waitcnt vmcnt(3)
    s_bitcmp0_b32 s57, 17
    s_cbranch_scc1 L_sf_32
    s_waitcnt vmcnt(2)
    s_bitcmp0_b32 s58, 17
    s_cbranch_scc1 L_sf_32
    s_waitcnt vmcnt(1)
L_sf_32:
    buffer_load_dwordx4 v[108:111], v1, s[48:51], s97 offen offset:1024 nt
    s_waitcnt vmcnt(3)
    s_bitcmp0_b32 s57, 18
    s_cbranch_scc1 L_sf_33
    s_waitcnt vmcnt(2)
    s_bitcmp0_b32 s58, 18
    s_cbranch_scc1 L_sf_33
    s_waitcnt vmcnt(1)
L_sf_33:
    buffer_load_dwordx4 v[112:115], v1, s[48:51], s97 offen offset:2048 nt
    s_waitcnt vmcnt(3)
    s_bitcmp0_b32 s57, 19
    s_cbranch_scc1 L_sf_34
    s_waitcnt vmcnt(2)
    s_bitcmp0_b32 s58, 19
    s_cbranch_scc1 L_sf_34
    s_waitcnt vmcnt(1)
L_sf_34:
    buffer_load_dwordx4 v[116:119], v1, s[48:51], s97 offen offset:3072 nt
    s_add_u32 s97, s97, 32768
    v_add_u32 v1, 4096, v1
    v_and_b32 v1, 0x7fff, v1
    s_waitcnt vmcnt(3)
    s_bitcmp0_b32 s57, 20
    s_cbranch_scc1 L_sf_35
    s_waitcnt vmcnt(2)
    s_bitcmp0_b32 s58, 20
    s_cbranch_scc1 L_sf_35
    s_waitcnt vmcnt(1)
L_sf_35:
    buffer_load_dwordx4 v[120:123], v1, s[48:51], s97 offen offset:0 nt
    s_waitcnt vmcnt(3)
    s_bitcmp0_b32 s57, 21
    s_cbranch_scc1 L_sf_36
    s_waitcnt vmcnt(2)
    s_bitcmp0_b32 s58, 21
    s_cbranch_scc1 L_sf_36
    s_waitcnt vmcnt(1)
L_sf_36:
    buffer_load_dwordx4 v[124:127], v1, s[48:51], s97 offen offset:1024 nt
    s_cmp_eq_u32 s12, -1
    s_cbranch_scc1 L_k_nopf
    s_waitcnt vmcnt(3)
    s_bitcmp0_b32 s57, 22
    s_cbranch_scc1 L_sf_37
    s_waitcnt vmcnt(2)
    s_bitcmp0_b32 s58, 22
    s_cbranch_scc1 L_sf_37
    s_waitcnt vmcnt(1)
L_sf_37:
    buffer_load_dwordx4 v[128:131], v1, s[48:51], s97 offen offset:2048 nt
    s_waitcnt vmcnt(3)
    s_bitcmp0_b32 s57, 23
    s_cbranch_scc1 L_sf_38
    s_waitcnt vmcnt(2)
    s_bitcmp0_b32 s58, 23
    s_cbranch_scc1 L_sf_38
    s_waitcnt vmcnt(1)
L_sf_38:
    buffer_load_dwordx4 v[132:135], v1, s[48:51], s97 offen offset:3072 nt
    s_add_u32 s97, s97, 32768
    v_add_u32 v1, 4096, v1
    v_and_b32 v1, 0x7fff, v1
    s_waitcnt vmcnt(3)
    s_bitcmp0_b32 s57, 24
    s_cbranch_scc1 L_sf_39
    s_waitcnt vmcnt(2)
    s_bitcmp0_b32 s58, 24
    s_cbranch_scc1 L_sf_39
    s_waitcnt vmcnt(1)
L_sf_39:
    buffer_load_dwordx4 v[136:139], v1, s[48:51], s97 offen offset:0 nt
    s_waitcnt vmcnt(3)
    s_bitcmp0_b32 s57, 25
    s_cbranch_scc1 L_sf_40
    s_waitcnt vmcnt(2)
    s_bitcmp0_b32 s58, 25
    s_cbranch_scc1 L_sf_40
    s_waitcnt vmcnt(1)
L_sf_40:
    buffer_load_dwordx4 v[140:143], v1, s[48:51], s97 offen offset:1024 nt
    s_waitcnt vmcnt(3)
    s_bitcmp0_b32 s57, 26
    s_cbranch_scc1 L_sf_41
    s_waitcnt vmcnt(2)
    s_bitcmp0_b32 s58, 26
    s_cbranch_scc1 L_sf_41
    s_waitcnt vmcnt(1)
L_sf_41:
    buffer_load_dwordx4 v[144:147], v1, s[48:51], s97 offen offset:2048 nt
    s_waitcnt vmcnt(3)
    s_bitcmp0_b32 s57, 27
    s_cbranch_scc1 L_sf_42
    s_waitcnt vmcnt(2)
    s_bitcmp0_b32 s58, 27
    s_cbranch_scc1 L_sf_42
    s_waitcnt vmcnt(1)
L_sf_42:
    buffer_load_dwordx4 v[148:151], v1, s[48:51], s97 offen offset:3072 nt
    s_add_u32 s97, s97, 32768
    v_add_u32 v1, 4096, v1
    v_and_b32 v1, 0x7fff, v1
    s_waitcnt vmcnt(3)
    s_bitcmp0_b32 s57, 28
    s_cbranch_scc1 L_sf_43
    s_waitcnt vmcnt(2)
    s_bitcmp0_b32 s58, 28
    s_cbranch_scc1 L_sf_43
    s_waitcnt vmcnt(1)
L_sf_43:
    buffer_load_dwordx4 v[152:155], v1, s[48:51], s97 offen offset:0 nt
    s_waitcnt vmcnt(3)
    s_bitcmp0_b32 s57, 29
    s_cbranch_scc1 L_sf_44
    s_waitcnt vmcnt(2)
    s_bitcmp0_b32 s58, 29
    s_cbranch_scc1 L_sf_44
    s_waitcnt vmcnt(1)
L_sf_44:
    buffer_load_dwordx4 v[156:159], v1, s[48:51], s97 offen offset:1024 nt
    s_waitcnt vmcnt(3)
    s_bitcmp0_b32 s57, 30
    s_cbranch_scc1 L_sf_45
    s_waitcnt vmcnt(2)
    s_bitcmp0_b32 s58, 30
    s_cbranch_scc1 L_sf_45
    s_waitcnt vmcnt(1)
L_sf_45:
    buffer_load_dwordx4 v[160:163], v1, s[48:51], s97 offen offset:2048 nt
    v_min_u32 v39, 29, v0
    v_lshlrev_b32 v39, 2, v39
    buffer_load_dword v37, v39, s[44:47], 0 offen sc1
    s_waitcnt vmcnt(4)
    s_bitcmp0_b32 s57, 31
    s_cbranch_scc1 L_sf_46
    s_waitcnt vmcnt(3)
    s_bitcmp0_b32 s58, 31
    s_cbranch_scc1 L_sf_46
    s_waitcnt vmcnt(2)
L_sf_46:
    buffer_load_dwordx4 v[164:167], v1, s[48:51], s97 offen offset:3072 nt
    s_mov_b32 s97, 0
    v_add_u32 v1, 4096, v1
    v_and_b32 v1, 0x7fff, v1
    s_waitcnt vmcnt(4)
    s_bitcmp0_b32 s14, 0
    s_cbranch_scc1 L_sf_47
    s_waitcnt vmcnt(3)
    s_bitcmp0_b32 s15, 0
    s_cbranch_scc1 L_sf_47
    s_waitcnt vmcnt(2)
L_sf_47:
    s_add_u32 m0, s12, 0
    s_nop 0
    buffer_load_dwordx4 v1, s[52:55], s97 offen offset:0 nt lds
    s_waitcnt vmcnt(4)
    s_bitcmp0_b32 s14, 1
    s_cbranch_scc1 L_sf_48
    s_waitcnt vmcnt(3)
    s_bitcmp0_b32 s15, 1
    s_cbranch_scc1 L_sf_48
    s_waitcnt vmcnt(1)
L_sf_48:
    buffer_load_dwordx4 v1, s[52:55], s97 offen offset:1024 nt lds
    s_waitcnt vmcnt(4)
    s_bitcmp0_b32 s14, 2
    s_cbranch_scc1 L_sf_49
    s_waitcnt vmcnt(2)
    s_bitcmp0_b32 s15, 2
    s_cbranch_scc1 L_sf_49
    s_waitcnt vmcnt(1)
L_sf_49:
    buffer_load_dwordx4 v1, s[52:55], s97 offen offset:2048 nt lds
    s_waitcnt vmcnt(3)
    s_bitcmp0_b32 s14, 3
    s_cbranch_scc1 L_sf_50
    s_waitcnt vmcnt(2)
    s_bitcmp0_b32 s15, 3
    s_cbranch_scc1 L_sf_50
    s_waitcnt vmcnt(1)
L_sf_50:
    buffer_load_dwordx4 v1, s[52:55], s97 offen offset:3072 nt lds
    s_add_u32 s97, s97, 32768
    v_add_u32 v1, 4096, v1
    v_and_b32 v1, 0x7fff, v1
    v_cmp_eq_u32 vcc, 0, v37
    s_nop 0
    s_or_b32 s96, vcc_lo, vcc_hi
    buffer_load_dwordx4 v[4:7], v2, s[40:43], s98 offen sc1
    s_waitcnt vmcnt(4)
    s_bitcmp0_b32 s14, 4
    s_cbranch_scc1 L_sf_51
    s_waitcnt vmcnt(3)
    s_bitcmp0_b32 s15, 4
    s_cbranch_scc1 L_sf_51
    s_waitcnt vmcnt(2)
L_sf_51:
    s_add_u32 m0, s12, 4096
    s_nop 0
    buffer_load_dwordx4 v1, s[52:55], s97 offen offset:0 nt lds
    s_waitcnt vmcnt(4)
    s_bitcmp0_b32 s14, 5
    s_cbranch_scc1 L_sf_52
    s_waitcnt vmcnt(3)
    s_bitcmp0_b32 s15, 5
    s_cbranch_scc1 L_sf_52
    s_waitcnt vmcnt(2)
L_sf_52:
    buffer_load_dwordx4 v1, s[52:55], s97 offen offset:1024 nt lds
    s_waitcnt vmcnt(4)
    s_bitcmp0_b32 s14, 6
    s_cbranch_scc1 L_sf_53
    s_waitcnt vmcnt(3)
    s_bitcmp0_b32 s15, 6
    s_cbranch_scc1 L_sf_53
    s_waitcnt vmcnt(1)
L_sf_53:
    buffer_load_dwordx4 v1, s[52:55], s97 offen offset:2048 nt lds
    s_waitcnt vmcnt(4)
    s_bitcmp0_b32 s14, 7
    s_cbranch_scc1 L_sf_54
    s_waitcnt vmcnt(2)
    s_bitcmp0_b32 s15, 7
    s_cbranch_scc1 L_sf_54
    s_waitcnt vmcnt(1)
L_sf_54:
    buffer_load_dwordx4 v1, s[52:55], s97 offen offset:3072 nt lds
    s_add_u32 s97, s97, 32768
    v_add_u32 v1, 4096, v1
    v_and_b32 v1, 0x7fff, v1
L_k_join:
    s_waitcnt vmcnt(4)
    v_max3_u32 v38, v4, v5, v6
    v_max_u32 v38, v38, v7
    v_cmp_eq_u32 vcc, -1, v38
    s_cmp_lg_u32 s96, 0
    s_cbranch_scc1 L_qslow
    s_cbranch_vccnz L_qslow2
L_qok:
    v_dot2_f32_bf16 v8, v72, v4, 0
    v_dot2_f32_bf16 v9, v76, v4, 0
    v_dot2_f32_bf16 v10, v80, v4, 0
    v_dot2_f32_bf16 v11, v84, v4, 0
    v_dot2_f32_bf16 v24, v88, v4, 0
    v_dot2_f32_bf16 v25, v92, v4, 0
    v_dot2_f32_bf16 v26, v96, v4, 0
    v_dot2_f32_bf16 v27, v100, v4, 0
    v_dot2_f32_bf16 v8, v73, v5, v8
    v_dot2_f32_bf16 v9, v77, v5, v9
    v_dot2_f32_bf16 v10, v81, v5, v10
    v_dot2_f32_bf16 v11, v85, v5, v11
    v_dot2_f32_bf16 v24, v89, v5, v24
    v_dot2_f32_bf16 v25, v93, v5, v25
    v_dot2_f32_bf16 v26, v97, v5, v26
    v_dot2_f32_bf16 v27, v101, v5, v27
    v_dot2_f32_bf16 v8, v74, v6, v8
    v_dot2_f32_bf16 v9, v78, v6, v9
    v_dot2_f32_bf16 v10, v82, v6, v10
    v_dot2_f32_bf16 v11, v86, v6, v11
    v_dot2_f32_bf16 v24, v90, v6, v24
    v_dot2_f32_bf16 v25, v94, v6, v25
    v_dot2_f32_bf16 v26, v98, v6, v26
    v_dot2_f32_bf16 v27, v102, v6, v27
    v_dot2_f32_bf16 v8, v75, v7, v8
    v_dot2_f32_bf16 v9, v79, v7, v9
    v_dot2_f32_bf16 v10, v83, v7, v10
    v_dot2_f32_bf16 v11, v87, v7, v11
    v_dot2_f32_bf16 v24, v91, v7, v24
    v_dot2_f32_bf16 v25, v95, v7, v25
    v_dot2_f32_bf16 v26, v99, v7, v26
    v_dot2_f32_bf16 v27, v103, v7, v27
    v_add_f32_dpp v8, v8, v8 row_ror:8 row_mask:0xf bank_mask:0x3
    v_add_f32_dpp v10, v10, v10 row_ror:8 row_mask:0xf bank_mask:0x3
    v_add_f32_dpp v24, v24, v24 row_ror:8 row_mask:0xf bank_mask:0x3
    v_add_f32_dpp v26, v26, v26 row_ror:8 row_mask:0xf bank_mask:0x3
    v_add_f32_dpp v8, v9, v9 row_ror:8 row_mask:0xf bank_mask:0xc
    v_add_f32_dpp v10, v11, v11 row_ror:8 row_mask:0xf bank_mask:0xc
    v_add_f32_dpp v24, v25, v25 row_ror:8 row_mask:0xf bank_mask:0xc
    v_add_f32_dpp v26, v27, v27 row_ror:8 row_mask:0xf bank_mask:0xc
    v_add_f32_dpp v14, v8, v8 row_half_mirror row_mask:0xf bank_mask:0x5
    v_add_f32_dpp v15, v24, v24 row_half_mirror row_mask:0xf bank_mask:0x5
    v_add_f32_dpp v14, v10, v10 row_half_mirror row_mask:0xf bank_mask:0xa
    v_add_f32_dpp v15, v26, v26 row_half_mirror row_mask:0xf bank_mask:0xa
    s_nop 0
    v_add_f32_dpp v14, v14, v14 quad_perm:[1,0,3,2] row_mask:0xf bank_mask:0xf
    v_add_f32_dpp v15, v15, v15 quad_perm:[1,0,3,2] row_mask:0xf bank_mask:0xf
    s_nop 0
    v_add_f32_dpp v14, v14, v14 quad_perm:[2,3,0,1] row_mask:0xf bank_mask:0xf
    v_add_f32_dpp v15, v15, v15 quad_perm:[2,3,0,1] row_mask:0xf bank_mask:0xf
    s_waitcnt vmcnt(3)
    s_bitcmp0_b32 s14, 8
    s_cbranch_scc1 L_sf_65
    s_waitcnt vmcnt(2)
    s_bitcmp0_b32 s15, 8
    s_cbranch_scc1 L_sf_65
    s_waitcnt vmcnt(1)
L_sf_65:
    buffer_load_dwordx4 v[72:75], v1, s[52:55], s97 offen offset:0 nt
    v_dot2_f32_bf16 v8, v40, v4, 0
    v_dot2_f32_bf16 v9, v44, v4, 0
    v_dot2_f32_bf16 v10, v48, v4, 0
    v_dot2_f32_bf16 v11, v52, v4, 0
    v_dot2_f32_bf16 v24, v56, v4, 0
    v_dot2_f32_bf16 v25, v60, v4, 0
    v_dot2_f32_bf16 v26, v64, v4, 0
    v_dot2_f32_bf16 v27, v68, v4, 0
    v_dot2_f32_bf16 v28, v104, v4, 0
    v_dot2_f32_bf16 v29, v108, v4, 0
    v_dot2_f32_bf16 v30, v112, v4, 0
    v_dot2_f32_bf16 v31, v116, v4, 0
    v_dot2_f32_bf16 v8, v41, v5, v8
    v_dot2_f32_bf16 v9, v45, v5, v9
    v_dot2_f32_bf16 v10, v49, v5, v10
    v_dot2_f32_bf16 v11, v53, v5, v11
    v_dot2_f32_bf16 v24, v57, v5, v24
    v_dot2_f32_bf16 v25, v61, v5, v25
    v_dot2_f32_bf16 v26, v65, v5, v26
    v_dot2_f32_bf16 v27, v69, v5, v27
    v_dot2_f32_bf16 v28, v105, v5, v28
    v_dot2_f32_bf16 v29, v109, v5, v29
    v_dot2_f32_bf16 v30, v113, v5, v30
    v_dot2_f32_bf16 v31, v117, v5, v31
    v_dot2_f32_bf16 v8, v42, v6, v8
    v_dot2_f32_bf16 v9, v46, v6, v9
    v_dot2_f32_bf16 v10, v50, v6, v10
    v_dot2_f32_bf16 v11, v54, v6, v11
    v_dot2_f32_bf16 v24, v58, v6, v24
    v_dot2_f32_bf16 v25, v62, v6, v25
    v_dot2_f32_bf16 v26, v66, v6, v26
    v_dot2_f32_bf16 v27, v70, v6, v27
    v_dot2_f32_bf16 v28, v106, v6, v28
    v_dot2_f32_bf16 v29, v110, v6, v29
    v_dot2_f32_bf16 v30, v114, v6, v30
    v_dot2_f32_bf16 v31, v118, v6, v31
    v_dot2_f32_bf16 v8, v43, v7, v8
    v_dot2_f32_bf16 v9, v47, v7, v9
    v_dot2_f32_bf16 v10, v51, v7, v10
    v_dot2_f32_bf16 v11, v55, v7, v11
    v_dot2_f32_bf16 v24, v59, v7, v24
    v_dot2_f32_bf16 v25, v63, v7, v25
    v_dot2_f32_bf16 v26, v67, v7, v26
    v_dot2_f32_bf16 v27, v71, v7, v27
    v_dot2_f32_bf16 v28, v107, v7, v28
    v_dot2_f32_bf16 v29, v111, v7, v29
    v_dot2_f32_bf16 v30, v115, v7, v30
    v_dot2_f32_bf16 v31, v119, v7, v31
    v_add_f32_dpp v8, v8, v8 row_ror:8 row_mask:0xf bank_mask:0x3
    v_add_f32_dpp v10, v10, v10 row_ror:8 row_mask:0xf bank_mask:0x3
    v_add_f32_dpp v24, v24, v24 row_ror:8 row_mask:0xf bank_mask:0x3
    v_add_f32_dpp v26, v26, v26 row_ror:8 row_mask:0xf bank_mask:0x3
    v_add_f32_dpp v28, v28, v28 row_ror:8 row_mask:0xf bank_mask:0x3
    v_add_f32_dpp v30, v30, v30 row_ror:8 row_mask:0xf bank_mask:0x3
    v_add_f32_dpp v8, v9, v9 row_ror:8 row_mask:0xf bank_mask:0xc
    v_add_f32_dpp v10, v11, v11 row_ror:8 row_mask:0xf bank_mask:0xc
    v_add_f32_dpp v24, v25, v25 row_ror:8 row_mask:0xf bank_mask:0xc
    v_add_f32_dpp v26, v27, v27 row_ror:8 row_mask:0xf bank_mask:0xc
    v_add_f32_dpp v28, v29, v29 row_ror:8 row_mask:0xf bank_mask:0xc
    v_add_f32_dpp v30, v31, v31 row_ror:8 row_mask:0xf bank_mask:0xc
    v_add_f32_dpp v12, v8, v8 row_half_mirror row_mask:0xf bank_mask:0x5
    v_add_f32_dpp v13, v24, v24 row_half_mirror row_mask:0xf bank_mask:0x5
    v_add_f32_dpp v16, v28, v28 row_half_mirror row_mask:0xf bank_mask:0x5
    v_add_f32_dpp v12, v10, v10 row_half_mirror row_mask:0xf bank_mask:0xa
    v_add_f32_dpp v13, v26, v26 row_half_mirror row_mask:0xf bank_mask:0xa
    v_add_f32_dpp v16, v30, v30 row_half_mirror row_mask:0xf bank_mask:0xa
    v_add_f32_dpp v12, v12, v12 quad_perm:[1,0,3,2] row_mask:0xf bank_mask:0xf
    v_add_f32_dpp v13, v13, v13 quad_perm:[1,0,3,2] row_mask:0xf bank_mask:0xf
    v_add_f32_dpp v16, v16, v16 quad_perm:[1,0,3,2] row_mask:0xf bank_mask:0xf
    v_add_f32_dpp v12, v12, v12 quad_perm:[2,3,0,1] row_mask:0xf bank_mask:0xf
    v_add_f32_dpp v13, v13, v13 quad_perm:[2,3,0,1] row_mask:0xf bank_mask:0xf
    v_add_f32_dpp v16, v16, v16 quad_perm:[2,3,0,1] row_mask:0xf bank_mask:0xf
    s_waitcnt vmcnt(3)
    s_bitcmp0_b32 s14, 9
    s_cbranch_scc1 L_sf_66
    s_waitcnt vmcnt(2)
    s_bitcmp0_b32 s15, 9
    s_cbranch_scc1 L_sf_66
    s_waitcnt vmcnt(1)
L_sf_66:
    buffer_load_dwordx4 v[76:79], v1, s[52:55], s97 offen offset:1024 nt
    v_dot2_f32_bf16 v8, v120, v4, 0
    v_dot2_f32_bf16 v9, v124, v4, 0
    v_dot2_f32_bf16 v10, v128, v4, 0
    v_dot2_f32_bf16 v11, v132, v4, 0
    v_dot2_f32_bf16 v24, v136, v4, 0
    v_dot2_f32_bf16 v25, v140, v4, 0
    v_dot2_f32_bf16 v26, v144, v4, 0
    v_dot2_f32_bf16 v27, v148, v4, 0
    v_dot2_f32_bf16 v8, v121, v5, v8
    v_dot2_f32_bf16 v9, v125, v5, v9
    v_dot2_f32_bf16 v10, v129, v5, v10
    v_dot2_f32_bf16 v11, v133, v5, v11
    v_dot2_f32_bf16 v24, v137, v5, v24
    v_dot2_f32_bf16 v25, v141, v5, v25
    v_dot2_f32_bf16 v26, v145, v5, v26
    v_dot2_f32_bf16 v27, v149, v5, v27
    v_dot2_f32_bf16 v8, v122, v6, v8
    v_dot2_f32_bf16 v9, v126, v6, v9
    v_dot2_f32_bf16 v10, v130, v6, v10
    v_dot2_f32_bf16 v11, v134, v6, v11
    v_dot2_f32_bf16 v24, v138, v6, v24
    v_dot2_f32_bf16 v25, v142, v6, v25
    v_dot2_f32_bf16 v26, v146, v6, v26
    v_dot2_f32_bf16 v27, v150, v6, v27
    v_dot2_f32_bf16 v8, v123, v7, v8
    v_dot2_f32_bf16 v9, v127, v7, v9
    v_dot2_f32_bf16 v10, v131, v7, v10
    v_dot2_f32_bf16 v11, v135, v7, v11
    v_dot2_f32_bf16 v24, v139, v7, v24
    v_dot2_f32_bf16 v25, v143, v7, v25
    v_dot2_f32_bf16 v26, v147, v7, v26
    v_dot2_f32_bf16 v27, v151, v7, v27
    v_add_f32_dpp v8, v8, v8 row_ror:8 row_mask:0xf bank_mask:0x3
    v_add_f32_dpp v10, v10, v10 row_ror:8 row_mask:0xf bank_mask:0x3
    v_add_f32_dpp v24, v24, v24 row_ror:8 row_mask:0xf bank_mask:0x3
    v_add_f32_dpp v26, v26, v26 row_ror:8 row_mask:0xf bank_mask:0x3
    v_add_f32_dpp v8, v9, v9 row_ror:8 row_mask:0xf bank_mask:0xc
    v_add_f32_dpp v10, v11, v11 row_ror:8 row_mask:0xf bank_mask:0xc
    v_add_f32_dpp v24, v25, v25 row_ror:8 row_mask:0xf bank_mask:0xc
    v_add_f32_dpp v26, v27, v27 row_ror:8 row_mask:0xf bank_mask:0xc
    v_add_f32_dpp v17, v8, v8 row_half_mirror row_mask:0xf bank_mask:0x5
    v_add_f32_dpp v18, v24, v24 row_half_mirror row_mask:0xf bank_mask:0x5
    v_add_f32_dpp v17, v10, v10 row_half_mirror row_mask:0xf bank_mask:0xa
    v_add_f32_dpp v18, v26, v26 row_half_mirror row_mask:0xf bank_mask:0xa
    s_nop 0
    v_add_f32_dpp v17, v17, v17 quad_perm:[1,0,3,2] row_mask:0xf bank_mask:0xf
    v_add_f32_dpp v18, v18, v18 quad_perm:[1,0,3,2] row_mask:0xf bank_mask:0xf
    s_nop 0
    v_add_f32_dpp v17, v17, v17 quad_perm:[2,3,0,1] row_mask:0xf bank_mask:0xf
    v_add_f32_dpp v18, v18, v18 quad_perm:[2,3,0,1] row_mask:0xf bank_mask:0xf
    s_waitcnt vmcnt(3)
    s_bitcmp0_b32 s14, 10
    s_cbranch_scc1 L_sf_67
    s_waitcnt vmcnt(2)
    s_bitcmp0_b32 s15, 10
    s_cbranch_scc1 L_sf_67
    s_waitcnt vmcnt(1)
L_sf_67:
    buffer_load_dwordx4 v[80:83], v1, s[52:55], s97 offen offset:2048 nt
    s_waitcnt vmcnt(3)
    s_bitcmp0_b32 s14, 11
    s_cbranch_scc1 L_sf_68
    s_waitcnt vmcnt(2)
    s_bitcmp0_b32 s15, 11
    s_cbranch_scc1 L_sf_68
    s_waitcnt vmcnt(1)
L_sf_68:
    buffer_load_dwordx4 v[84:87], v1, s[52:55], s97 offen offset:3072 nt
    s_add_u32 s97, s97, 32768
    v_add_u32 v1, 4096, v1
    v_and_b32 v1, 0x7fff, v1
    s_cmp_eq_u32 s12, -1
    s_cbranch_scc1 L_nopfrd
    v_lshl_add_u32 v38, v0, 4, s12
    ds_read_b128 v[40:43], v38 offset:0
    ds_read_b128 v[44:47], v38 offset:1024
    ds_read_b128 v[48:51], v38 offset:2048
    ds_read_b128 v[52:55], v38 offset:3072
    ds_read_b128 v[56:59], v38 offset:4096
    ds_read_b128 v[60:63], v38 offset:5120
    ds_read_b128 v[64:67], v38 offset:6144
    ds_read_b128 v[68:71], v38 offset:7168
L_nopfrd:
    v_dot2_f32_bf16 v8, v152, v4, 0
    v_dot2_f32_bf16 v9, v156, v4, 0
    v_dot2_f32_bf16 v10, v160, v4, 0
    v_dot2_f32_bf16 v11, v164, v4, 0
    v_dot2_f32_bf16 v8, v153, v5, v8
    v_dot2_f32_bf16 v9, v157, v5, v9
    v_dot2_f32_bf16 v10, v161, v5, v10
    v_dot2_f32_bf16 v11, v165, v5, v11
    v_dot2_f32_bf16 v8, v154, v6, v8
    v_dot2_f32_bf16 v9, v158, v6, v9
    v_dot2_f32_bf16 v10, v162, v6, v10
    v_dot2_f32_bf16 v11, v166, v6, v11
    v_dot2_f32_bf16 v8, v155, v7, v8
    v_dot2_f32_bf16 v9, v159, v7, v9
    v_dot2_f32_bf16 v10, v163, v7, v10
    v_dot2_f32_bf16 v11, v167, v7, v11
    v_add_f32_dpp v8, v8, v8 row_ror:8 row_mask:0xf bank_mask:0x3
    s_nop 0
    v_add_f32_dpp v10, v10, v10 row_ror:8 row_mask:0xf bank_mask:0x3
    v_add_f32_dpp v8, v9, v9 row_ror:8 row_mask:0xf bank_mask:0xc
    v_add_f32_dpp v10, v11, v11 row_ror:8 row_mask:0xf bank_mask:0xc
    s_nop 0
    v_add_f32_dpp v19, v8, v8 row_half_mirror row_mask:0xf bank_mask:0x5
    v_add_f32_dpp v19, v10, v10 row_half_mirror row_mask:0xf bank_mask:0xa
    s_nop 1
    v_add_f32_dpp v19, v19, v19 quad_perm:[1,0,3,2] row_mask:0xf bank_mask:0xf
    s_nop 1
    v_add_f32_dpp v19, v19, v19 quad_perm:[2,3,0,1] row_mask:0xf bank_mask:0xf
    v_max3_f32 v3, v12, v13, v14
    v_max3_f32 v8, v15, v16, v17
    v_max3_f32 v3, v3, v18, v19
    v_max_f32 v3, v3, v8
    s_nop 1
    v_max_f32_dpp v3, v3, v3 row_ror:4 row_mask:0xf bank_mask:0xf
    s_nop 1
    v_max_f32_dpp v3, v3, v3 row_ror:8 row_mask:0xf bank_mask:0xf
    v_mov_b32 v8, v3
    s_nop 1
    v_permlane16_swap_b32 v3, v8
    v_max_f32 v3, v3, v8
    v_mov_b32 v8, v3
    s_nop 1
    v_permlane32_swap_b32 v3, v8
    v_max_f32 v3, v3, v8
    s_mov_b32 s96, 0x3e0293ee
    v_mul_f32 v8, s96, v3
    v_fma_f32 v12, v12, s96, -v8
    v_fma_f32 v13, v13, s96, -v8
    v_fma_f32 v14, v14, s96, -v8
    v_fma_f32 v15, v15, s96, -v8
    v_fma_f32 v16, v16, s96, -v8
    v_fma_f32 v17, v17, s96, -v8
    v_fma_f32 v18, v18, s96, -v8
    v_fma_f32 v19, v19, s96, -v8
    v_exp_f32 v12, v12
    v_exp_f32 v13, v13
    v_exp_f32 v14, v14
    v_exp_f32 v15, v15
    v_exp_f32 v16, v16
    v_exp_f32 v17, v17
    v_exp_f32 v18, v18
    v_exp_f32 v19, v19
    v_add_f32 v9, v12, v13
    v_add_f32 v10, v14, v15
    v_add_f32 v11, v16, v17
    v_add_f32 v3, v18, v19
    v_add_f32 v9, v9, v10
    v_add_f32 v3, v3, v11
    v_add_f32 v9, v9, v3
    v_cvt_pk_bf16_f32 v12, v12, v12
    v_cvt_pk_bf16_f32 v13, v13, v13
    v_cvt_pk_bf16_f32 v14, v14, v14
    v_cvt_pk_bf16_f32 v15, v15, v15
    v_cvt_pk_bf16_f32 v16, v16, v16
    v_cvt_pk_bf16_f32 v17, v17, v17
    v_cvt_pk_bf16_f32 v18, v18, v18
    v_cvt_pk_bf16_f32 v19, v19, v19
    v_add_f32_dpp v9, v9, v9 row_ror:4 row_mask:0xf bank_mask:0xf
    s_nop 1
    v_add_f32_dpp v9, v9, v9 row_ror:8 row_mask:0xf bank_mask:0xf
    v_mov_b32 v10, v9
    s_nop 1
    v_permlane16_swap_b32 v9, v10
    v_add_f32 v9, v9, v10
    v_mov_b32 v10, v9
    s_nop 1
    v_permlane32_swap_b32 v9, v10
    v_add_f32 v9, v9, v10
    s_mov_b64 exec, 1
    s_cmp_lg_u32 s13, 0
    s_cbranch_scc1 L_mljob
    s_lshl_b32 s96, s3, 3
    s_add_u32 s96, s96, 161920
    v_mov_b32 v10, s96
    v_mov_b32 v11, 162068
    v_mov_b32 v3, 1
    ds_write_b64 v10, v[8:9]
    ds_add_u32 v11, v3
L_mldone:
    s_mov_b64 exec, -1
    v_lshrrev_b32 v2, 1, v2
    v_and_b32_dpp v24, v14, v20 row_newbcast:0 row_mask:0xf bank_mask:0xf
    v_and_b32_dpp v25, v14, v21 row_newbcast:0 row_mask:0xf bank_mask:0xf
    v_and_b32_dpp v26, v14, v22 row_newbcast:0 row_mask:0xf bank_mask:0xf
    v_and_b32_dpp v27, v14, v23 row_newbcast:0 row_mask:0xf bank_mask:0xf
    s_waitcnt vmcnt(3)
    s_bitcmp0_b32 s14, 12
    s_cbranch_scc1 L_sf_69
    s_waitcnt vmcnt(2)
    s_bitcmp0_b32 s15, 12
    s_cbranch_scc1 L_sf_69
    s_waitcnt vmcnt(1)
L_sf_69:
    buffer_load_dwordx4 v[88:91], v1, s[52:55], s97 offen offset:0 nt
    v_mfma_f32_16x16x32_bf16 v[32:35], v[24:27], v[72:75], v[32:35]
    s_cmp_eq_u32 s12, -1
    s_cbranch_scc1 L_nopfpv8
    s_waitcnt lgkmcnt(0)
    v_and_b32_dpp v24, v12, v20 row_newbcast:0 row_mask:0xf bank_mask:0xf
    v_and_b32_dpp v25, v12, v21 row_newbcast:0 row_mask:0xf bank_mask:0xf
    v_and_b32_dpp v26, v12, v22 row_newbcast:0 row_mask:0xf bank_mask:0xf
    v_and_b32_dpp v27, v12, v23 row_newbcast:0 row_mask:0xf bank_mask:0xf
    s_nop 1
    v_mfma_f32_16x16x32_bf16 v[32:35], v[24:27], v[40:43], v[32:35]
    v_and_b32_dpp v28, v12, v20 row_newbcast:8 row_mask:0xf bank_mask:0xf
    v_and_b32_dpp v29, v12, v21 row_newbcast:8 row_mask:0xf bank_mask:0xf
    v_and_b32_dpp v30, v12, v22 row_newbcast:8 row_mask:0xf bank_mask:0xf
    v_and_b32_dpp v31, v12, v23 row_newbcast:8 row_mask:0xf bank_mask:0xf
    s_nop 1
    v_mfma_f32_16x16x32_bf16 v[32:35], v[28:31], v[44:47], v[32:35]
    v_and_b32_dpp v24, v12, v20 row_newbcast:4 row_mask:0xf bank_mask:0xf
    v_and_b32_dpp v25, v12, v21 row_newbcast:4 row_mask:0xf bank_mask:0xf
    v_and_b32_dpp v26, v12, v22 row_newbcast:4 row_mask:0xf bank_mask:0xf
    v_and_b32_dpp v27, v12, v23 row_newbcast:4 row_mask:0xf bank_mask:0xf
    s_nop 1
    v_mfma_f32_16x16x32_bf16 v[32:35], v[24:27], v[48:51], v[32:35]
    v_and_b32_dpp v28, v12, v20 row_newbcast:12 row_mask:0xf bank_mask:0xf
    v_and_b32_dpp v29, v12, v21 row_newbcast:12 row_mask:0xf bank_mask:0xf
    v_and_b32_dpp v30, v12, v22 row_newbcast:12 row_mask:0xf bank_mask:0xf
    v_and_b32_dpp v31, v12, v23 row_newbcast:12 row_mask:0xf bank_mask:0xf
    s_nop 1
    v_mfma_f32_16x16x32_bf16 v[32:35], v[28:31], v[52:55], v[32:35]
L_nopfpv8:
    v_and_b32_dpp v28, v14, v20 row_newbcast:8 row_mask:0xf bank_mask:0xf
    v_and_b32_dpp v29, v14, v21 row_newbcast:8 row_mask:0xf bank_mask:0xf
    v_and_b32_dpp v30, v14, v22 row_newbcast:8 row_mask:0xf bank_mask:0xf
    v_and_b32_dpp v31, v14, v23 row_newbcast:8 row_mask:0xf bank_mask:0xf
    s_waitcnt vmcnt(3)
    s_bitcmp0_b32 s14, 13
    s_cbranch_scc1 L_sf_70
    s_waitcnt vmcnt(2)
    s_bitcmp0_b32 s15, 13
    s_cbranch_scc1 L_sf_70
    s_waitcnt vmcnt(1)
L_sf_70:
    buffer_load_dwordx4 v[92:95], v1, s[52:55], s97 offen offset:1024 nt
    v_mfma_f32_16x16x32_bf16 v[32:35], v[28:31], v[76:79], v[32:35]
    s_cmp_eq_u32 s12, -1
    s_cbranch_scc1 L_nopfpv9
    s_waitcnt lgkmcnt(0)
    v_and_b32_dpp v24, v13, v20 row_newbcast:0 row_mask:0xf bank_mask:0xf
    v_and_b32_dpp v25, v13, v21 row_newbcast:0 row_mask:0xf bank_mask:0xf
    v_and_b32_dpp v26, v13, v22 row_newbcast:0 row_mask:0xf bank_mask:0xf
    v_and_b32_dpp v27, v13, v23 row_newbcast:0 row_mask:0xf bank_mask:0xf
    s_nop 1
    v_mfma_f32_16x16x32_bf16 v[32:35], v[24:27], v[56:59], v[32:35]
    v_and_b32_dpp v28, v13, v20 row_newbcast:8 row_mask:0xf bank_mask:0xf
    v_and_b32_dpp v29, v13, v21 row_newbcast:8 row_mask:0xf bank_mask:0xf
    v_and_b32_dpp v30, v13, v22 row_newbcast:8 row_mask:0xf bank_mask:0xf
    v_and_b32_dpp v31, v13, v23 row_newbcast:8 row_mask:0xf bank_mask:0xf
    s_nop 1
    v_mfma_f32_16x16x32_bf16 v[32:35], v[28:31], v[60:63], v[32:35]
    v_and_b32_dpp v24, v13, v20 row_newbcast:4 row_mask:0xf bank_mask:0xf
    v_and_b32_dpp v25, v13, v21 row_newbcast:4 row_mask:0xf bank_mask:0xf
    v_and_b32_dpp v26, v13, v22 row_newbcast:4 row_mask:0xf bank_mask:0xf
    v_and_b32_dpp v27, v13, v23 row_newbcast:4 row_mask:0xf bank_mask:0xf
    s_nop 1
    v_mfma_f32_16x16x32_bf16 v[32:35], v[24:27], v[64:67], v[32:35]
    v_and_b32_dpp v28, v13, v20 row_newbcast:12 row_mask:0xf bank_mask:0xf
    v_and_b32_dpp v29, v13, v21 row_newbcast:12 row_mask:0xf bank_mask:0xf
    v_and_b32_dpp v30, v13, v22 row_newbcast:12 row_mask:0xf bank_mask:0xf
    v_and_b32_dpp v31, v13, v23 row_newbcast:12 row_mask:0xf bank_mask:0xf
    s_nop 1
    v_mfma_f32_16x16x32_bf16 v[32:35], v[28:31], v[68:71], v[32:35]
L_nopfpv9:
    v_and_b32_dpp v24, v14, v20 row_newbcast:4 row_mask:0xf bank_mask:0xf
    v_and_b32_dpp v25, v14, v21 row_newbcast:4 row_mask:0xf bank_mask:0xf
    v_and_b32_dpp v26, v14, v22 row_newbcast:4 row_mask:0xf bank_mask:0xf
    v_and_b32_dpp v27, v14, v23 row_newbcast:4 row_mask:0xf bank_mask:0xf
    s_waitcnt vmcnt(3)
    s_bitcmp0_b32 s14, 14
    s_cbranch_scc1 L_sf_71
    s_waitcnt vmcnt(2)
    s_bitcmp0_b32 s15, 14
    s_cbranch_scc1 L_sf_71
    s_waitcnt vmcnt(1)
L_sf_71:
    buffer_load_dwordx4 v[96:99], v1, s[52:55], s97 offen offset:2048 nt
    v_mfma_f32_16x16x32_bf16 v[32:35], v[24:27], v[80:83], v[32:35]
    v_and_b32_dpp v28, v14, v20 row_newbcast:12 row_mask:0xf bank_mask:0xf
    v_and_b32_dpp v29, v14, v21 row_newbcast:12 row_mask:0xf bank_mask:0xf
    v_and_b32_dpp v30, v14, v22 row_newbcast:12 row_mask:0xf bank_mask:0xf
    v_and_b32_dpp v31, v14, v23 row_newbcast:12 row_mask:0xf bank_mask:0xf
    s_waitcnt vmcnt(3)
    s_bitcmp0_b32 s14, 15
    s_cbranch_scc1 L_sf_72
    s_waitcnt vmcnt(2)
    s_bitcmp0_b32 s15, 15
    s_cbranch_scc1 L_sf_72
    s_waitcnt vmcnt(1)
L_sf_72:
    buffer_load_dwordx4 v[100:103], v1, s[52:55], s97 offen offset:3072 nt
    s_add_u32 s97, s97, 32768
    v_add_u32 v1, 4096, v1
    v_and_b32 v1, 0x7fff, v1
    v_mfma_f32_16x16x32_bf16 v[32:35], v[28:31], v[84:87], v[32:35]
    v_and_b32_dpp v24, v15, v20 row_newbcast:0 row_mask:0xf bank_mask:0xf
    v_and_b32_dpp v25, v15, v21 row_newbcast:0 row_mask:0xf bank_mask:0xf
    v_and_b32_dpp v26, v15, v22 row_newbcast:0 row_mask:0xf bank_mask:0xf
    v_and_b32_dpp v27, v15, v23 row_newbcast:0 row_mask:0xf bank_mask:0xf
    s_waitcnt vmcnt(3)
    s_bitcmp0_b32 s14, 16
    s_cbranch_scc1 L_sf_73
    s_waitcnt vmcnt(2)
    s_bitcmp0_b32 s15, 16
    s_cbranch_scc1 L_sf_73
    s_waitcnt vmcnt(1)
L_sf_73:
    buffer_load_dwordx4 v[104:107], v1, s[52:55], s97 offen offset:0 nt
    v_mfma_f32_16x16x32_bf16 v[32:35], v[24:27], v[88:91], v[32:35]
    v_and_b32_dpp v28, v15, v20 row_newbcast:8 row_mask:0xf bank_mask:0xf
    v_and_b32_dpp v29, v15, v21 row_newbcast:8 row_mask:0xf bank_mask:0xf
    v_and_b32_dpp v30, v15, v22 row_newbcast:8 row_mask:0xf bank_mask:0xf
    v_and_b32_dpp v31, v15, v23 row_newbcast:8 row_mask:0xf bank_mask:0xf
    s_waitcnt vmcnt(3)
    s_bitcmp0_b32 s14, 17
    s_cbranch_scc1 L_sf_74
    s_waitcnt vmcnt(2)
    s_bitcmp0_b32 s15, 17
    s_cbranch_scc1 L_sf_74
    s_waitcnt vmcnt(1)
L_sf_74:
    buffer_load_dwordx4 v[108:111], v1, s[52:55], s97 offen offset:1024 nt
    v_mfma_f32_16x16x32_bf16 v[32:35], v[28:31], v[92:95], v[32:35]
    v_and_b32_dpp v24, v15, v20 row_newbcast:4 row_mask:0xf bank_mask:0xf
    v_and_b32_dpp v25, v15, v21 row_newbcast:4 row_mask:0xf bank_mask:0xf
    v_and_b32_dpp v26, v15, v22 row_newbcast:4 row_mask:0xf bank_mask:0xf
    v_and_b32_dpp v27, v15, v23 row_newbcast:4 row_mask:0xf bank_mask:0xf
    s_waitcnt vmcnt(3)
    s_bitcmp0_b32 s14, 18
    s_cbranch_scc1 L_sf_75
    s_waitcnt vmcnt(2)
    s_bitcmp0_b32 s15, 18
    s_cbranch_scc1 L_sf_75
    s_waitcnt vmcnt(1)
L_sf_75:
    buffer_load_dwordx4 v[112:115], v1, s[52:55], s97 offen offset:2048 nt
    v_mfma_f32_16x16x32_bf16 v[32:35], v[24:27], v[96:99], v[32:35]
    v_and_b32_dpp v28, v15, v20 row_newbcast:12 row_mask:0xf bank_mask:0xf
    v_and_b32_dpp v29, v15, v21 row_newbcast:12 row_mask:0xf bank_mask:0xf
    v_and_b32_dpp v30, v15, v22 row_newbcast:12 row_mask:0xf bank_mask:0xf
    v_and_b32_dpp v31, v15, v23 row_newbcast:12 row_mask:0xf bank_mask:0xf
    s_waitcnt vmcnt(3)
    s_bitcmp0_b32 s14, 19
    s_cbranch_scc1 L_sf_76
    s_waitcnt vmcnt(2)
    s_bitcmp0_b32 s15, 19
    s_cbranch_scc1 L_sf_76
    s_waitcnt vmcnt(1)
L_sf_76:
    buffer_load_dwordx4 v[116:119], v1, s[52:55], s97 offen offset:3072 nt
    s_add_u32 s97, s97, 32768
    v_add_u32 v1, 4096, v1
    v_and_b32 v1, 0x7fff, v1
    v_mfma_f32_16x16x32_bf16 v[32:35], v[28:31], v[100:103], v[32:35]
    v_and_b32_dpp v24, v16, v20 row_newbcast:0 row_mask:0xf bank_mask:0xf
    v_and_b32_dpp v25, v16, v21 row_newbcast:0 row_mask:0xf bank_mask:0xf
    v_and_b32_dpp v26, v16, v22 row_newbcast:0 row_mask:0xf bank_mask:0xf
    v_and_b32_dpp v27, v16, v23 row_newbcast:0 row_mask:0xf bank_mask:0xf
    s_waitcnt vmcnt(3)
    s_bitcmp0_b32 s14, 20
    s_cbranch_scc1 L_sf_77
    s_waitcnt vmcnt(2)
    s_bitcmp0_b32 s15, 20
    s_cbranch_scc1 L_sf_77
    s_waitcnt vmcnt(1)
L_sf_77:
    buffer_load_dwordx4 v[120:123], v1, s[52:55], s97 offen offset:0 nt
    v_mfma_f32_16x16x32_bf16 v[32:35], v[24:27], v[104:107], v[32:35]
    v_and_b32_dpp v28, v16, v20 row_newbcast:8 row_mask:0xf bank_mask:0xf
    v_and_b32_dpp v29, v16, v21 row_newbcast:8 row_mask:0xf bank_mask:0xf
    v_and_b32_dpp v30, v16, v22 row_newbcast:8 row_mask:0xf bank_mask:0xf
    v_and_b32_dpp v31, v16, v23 row_newbcast:8 row_mask:0xf bank_mask:0xf
    s_waitcnt vmcnt(3)
    s_bitcmp0_b32 s14, 21
    s_cbranch_scc1 L_sf_78
    s_waitcnt vmcnt(2)
    s_bitcmp0_b32 s15, 21
    s_cbranch_scc1 L_sf_78
    s_waitcnt vmcnt(1)
L_sf_78:
    buffer_load_dwordx4 v[124:127], v1, s[52:55], s97 offen offset:1024 nt
    v_mfma_f32_16x16x32_bf16 v[32:35], v[28:31], v[108:111], v[32:35]
    v_and_b32_dpp v24, v16, v20 row_newbcast:4 row_mask:0xf bank_mask:0xf
    v_and_b32_dpp v25, v16, v21 row_newbcast:4 row_mask:0xf bank_mask:0xf
    v_and_b32_dpp v26, v16, v22 row_newbcast:4 row_mask:0xf bank_mask:0xf
    v_and_b32_dpp v27, v16, v23 row_newbcast:4 row_mask:0xf bank_mask:0xf
    s_waitcnt vmcnt(3)
    s_bitcmp0_b32 s14, 22
    s_cbranch_scc1 L_sf_79
    s_waitcnt vmcnt(2)
    s_bitcmp0_b32 s15, 22
    s_cbranch_scc1 L_sf_79
    s_waitcnt vmcnt(1)
L_sf_79:
    buffer_load_dwordx4 v[128:131], v1, s[52:55], s97 offen offset:2048 nt
    v_mfma_f32_16x16x32_bf16 v[32:35], v[24:27], v[112:115], v[32:35]
    v_and_b32_dpp v28, v16, v20 row_newbcast:12 row_mask:0xf bank_mask:0xf
    v_and_b32_dpp v29, v16, v21 row_newbcast:12 row_mask:0xf bank_mask:0xf
    v_and_b32_dpp v30, v16, v22 row_newbcast:12 row_mask:0xf bank_mask:0xf
    v_and_b32_dpp v31, v16, v23 row_newbcast:12 row_mask:0xf bank_mask:0xf
    s_waitcnt vmcnt(3)
    s_bitcmp0_b32 s14, 23
    s_cbranch_scc1 L_sf_80
    s_waitcnt vmcnt(2)
    s_bitcmp0_b32 s15, 23
    s_cbranch_scc1 L_sf_80
    s_waitcnt vmcnt(1)
L_sf_80:
    buffer_load_dwordx4 v[132:135], v1, s[52:55], s97 offen offset:3072 nt
    s_add_u32 s97, s97, 32768
    v_add_u32 v1, 4096, v1
    v_and_b32 v1, 0x7fff, v1
    v_mfma_f32_16x16x32_bf16 v[32:35], v[28:31], v[116:119], v[32:35]
    v_and_b32_dpp v24, v17, v20 row_newbcast:0 row_mask:0xf bank_mask:0xf
    v_and_b32_dpp v25, v17, v21 row_newbcast:0 row_mask:0xf bank_mask:0xf
    v_and_b32_dpp v26, v17, v22 row_newbcast:0 row_mask:0xf bank_mask:0xf
    v_and_b32_dpp v27, v17, v23 row_newbcast:0 row_mask:0xf bank_mask:0xf
    s_waitcnt vmcnt(3)
    s_bitcmp0_b32 s14, 24
    s_cbranch_scc1 L_sf_81
    s_waitcnt vmcnt(2)
    s_bitcmp0_b32 s15, 24
    s_cbranch_scc1 L_sf_81
    s_waitcnt vmcnt(1)
L_sf_81:
    buffer_load_dwordx4 v[136:139], v1, s[52:55], s97 offen offset:0 nt
    v_mfma_f32_16x16x32_bf16 v[32:35], v[24:27], v[120:123], v[32:35]
    s_or_b32 s96, s59, s39
    s_cbranch_scc0 L_nofrag_82
    v_mov_b32 v104, 162060
L_lw_83:
    ds_read_b32 v105, v104
    s_waitcnt lgkmcnt(0)
    v_cmp_gt_u32 vcc, 4, v105
    s_cbranch_vccz L_lw_83e
    s_sleep 2
    s_sub_u32 s60, s60, 1
    s_cbranch_scc0 L_lw_83
    s_mov_b32 s60, 0
L_lw_83e:
    s_cmp_eq_u32 s59, 0
    s_cbranch_scc1 L_nofrag_82
    v_bfe_u32 v104, v0, 2, 1
    v_bfe_u32 v110, v0, 4, 1
    v_lshl_add_u32 v104, v110, 2, v104
    v_and_b32 v110, 8, v0
    v_add_u32 v104, v104, v110
    v_lshrrev_b32 v110, 5, v0
    v_lshl_add_u32 v104, v110, 4, v104
    v_bfe_u32 v111, v0, 0, 1
    v_mul_u32_u24 v111, 0xaaaa, v111
    v_add_u32 v111, 0x4444, v111
    v_mov_b32 v112, 0
    v_mov_b32 v113, 0
    v_mov_b32 v114, 0
    v_mov_b32 v115, 0
    v_mov_b32 v116, 0
    v_mov_b32 v117, 0
    v_mov_b32 v118, 0
    v_mov_b32 v119, 0
    v_lshlrev_b32 v104, 7, v104
    v_and_b32 v110, 3, v0
    v_lshl_add_u32 v104, v110, 3, v104
    v_lshrrev_b32 v109, 4, v0
    v_and_b32 v110, 1, v0
    s_lshr_b32 s63, s3, 1
    s_and_b32 s62, s3, 1
    s_lshl_b32 s96, s63, 14
    s_lshl_b32 s100, s62, 6
    s_add_u32 s100, s100, 81920
    s_add_u32 s96, s96, s100
    v_add_u32 v104, s96, v104
    ds_read_b64_tr_b16 v[72:73], v104 offset:0
    ds_read_b64_tr_b16 v[74:75], v104 offset:256
    ds_read_b64_tr_b16 v[76:77], v104 offset:4096
    ds_read_b64_tr_b16 v[78:79], v104 offset:4352
    ds_read_b64_tr_b16 v[80:81], v104 offset:32
    ds_read_b64_tr_b16 v[82:83], v104 offset:288
    ds_read_b64_tr_b16 v[84:85], v104 offset:4128
    ds_read_b64_tr_b16 v[86:87], v104 offset:4384
    ds_read_b64_tr_b16 v[88:89], v104 offset:8192
    ds_read_b64_tr_b16 v[90:91], v104 offset:8448
    ds_read_b64_tr_b16 v[92:93], v104 offset:12288
    ds_read_b64_tr_b16 v[94:95], v104 offset:12544
    ds_read_b64_tr_b16 v[96:97], v104 offset:8224
    ds_read_b64_tr_b16 v[98:99], v104 offset:8480
    ds_read_b64_tr_b16 v[100:101], v104 offset:12320
    ds_read_b64_tr_b16 v[102:103], v104 offset:12576
    v_bfe_u32 v105, v0, 1, 3
    v_lshlrev_b32 v105, 8, v105
    v_lshl_add_u32 v105, v109, 5, v105
    v_lshl_add_u32 v105, v110, 4, v105
    v_lshrrev_b32 v106, 3, v0
    v_lshlrev_b32 v106, 7, v106
    v_and_b32 v110, 7, v0
    v_lshl_add_u32 v107, v110, 3, v106
    v_add_u32 v107, s100, v107
    v_lshlrev_b32 v106, 8, v109
    v_and_b32 v110, 15, v0
    v_lshl_add_u32 v106, v110, 2, v106
    v_add_u32 v106, s96, v106
    v_lshlrev_b32 v108, 2, v0
    s_lshl_b32 s96, s62, 2
    s_add_u32 s96, s96, 162088
    v_mov_b32 v109, s96
    s_lshl_b32 s100, s63, 11
    s_lshl_b32 s96, s34, 13
    s_add_u32 s100, s100, s96
    s_add_u32 s100, s100, 90112
    s_mul_i32 s101, s34, 5120
    s_lshl_b32 s96, s35, 9
    s_add_u32 s101, s101, s96
    s_lshl_b32 s96, s62, 8
    s_add_u32 s101, s101, s96
    s_add_u32 s101, s101, 144384
L_nofrag_82:
    v_and_b32_dpp v28, v17, v20 row_newbcast:8 row_mask:0xf bank_mask:0xf
    v_and_b32_dpp v29, v17, v21 row_newbcast:8 row_mask:0xf bank_mask:0xf
    v_and_b32_dpp v30, v17, v22 row_newbcast:8 row_mask:0xf bank_mask:0xf
    v_and_b32_dpp v31, v17, v23 row_newbcast:8 row_mask:0xf bank_mask:0xf
    s_waitcnt vmcnt(3)
    s_bitcmp0_b32 s14, 25
    s_cbranch_scc1 L_sf_84
    s_waitcnt vmcnt(2)
    s_bitcmp0_b32 s15, 25
    s_cbranch_scc1 L_sf_84
    s_waitcnt vmcnt(1)
L_sf_84:
    buffer_load_dwordx4 v[140:143], v1, s[52:55], s97 offen offset:1024 nt
    v_mfma_f32_16x16x32_bf16 v[32:35], v[28:31], v[124:127], v[32:35]
    v_and_b32_dpp v24, v17, v20 row_newbcast:4 row_mask:0xf bank_mask:0xf
    v_and_b32_dpp v25, v17, v21 row_newbcast:4 row_mask:0xf bank_mask:0xf
    v_and_b32_dpp v26, v17, v22 row_newbcast:4 row_mask:0xf bank_mask:0xf
    v_and_b32_dpp v27, v17, v23 row_newbcast:4 row_mask:0xf bank_mask:0xf
    s_waitcnt vmcnt(3)
    s_bitcmp0_b32 s14, 26
    s_cbranch_scc1 L_sf_85
    s_waitcnt vmcnt(2)
    s_bitcmp0_b32 s15, 26
    s_cbranch_scc1 L_sf_85
    s_waitcnt vmcnt(1)
L_sf_85:
    buffer_load_dwordx4 v[144:147], v1, s[52:55], s97 offen offset:2048 nt
    v_mfma_f32_16x16x32_bf16 v[32:35], v[24:27], v[128:131], v[32:35]
    v_mov_b32 v10, 162076
    v_mov_b32 v11, 1
    s_mov_b64 exec, 1
    ds_add_u32 v10, v11
    s_mov_b64 exec, -1
    v_and_b32_dpp v28, v17, v20 row_newbcast:12 row_mask:0xf bank_mask:0xf
    v_and_b32_dpp v29, v17, v21 row_newbcast:12 row_mask:0xf bank_mask:0xf
    v_and_b32_dpp v30, v17, v22 row_newbcast:12 row_mask:0xf bank_mask:0xf
    v_and_b32_dpp v31, v17, v23 row_newbcast:12 row_mask:0xf bank_mask:0xf
    s_waitcnt vmcnt(3)
    s_bitcmp0_b32 s14, 27
    s_cbranch_scc1 L_sf_86
    s_waitcnt vmcnt(2)
    s_bitcmp0_b32 s15, 27
    s_cbranch_scc1 L_sf_86
    s_waitcnt vmcnt(1)
L_sf_86:
    buffer_load_dwordx4 v[148:151], v1, s[52:55], s97 offen offset:3072 nt
    s_add_u32 s97, s97, 32768
    v_add_u32 v1, 4096, v1
    v_and_b32 v1, 0x7fff, v1
    v_mfma_f32_16x16x32_bf16 v[32:35], v[28:31], v[132:135], v[32:35]
    v_and_b32_dpp v24, v18, v20 row_newbcast:0 row_mask:0xf bank_mask:0xf
    v_and_b32_dpp v25, v18, v21 row_newbcast:0 row_mask:0xf bank_mask:0xf
    v_and_b32_dpp v26, v18, v22 row_newbcast:0 row_mask:0xf bank_mask:0xf
    v_and_b32_dpp v27, v18, v23 row_newbcast:0 row_mask:0xf bank_mask:0xf
    s_waitcnt vmcnt(3)
    s_bitcmp0_b32 s14, 28
    s_cbranch_scc1 L_sf_87
    s_waitcnt vmcnt(2)
    s_bitcmp0_b32 s15, 28
    s_cbranch_scc1 L_sf_87
    s_waitcnt vmcnt(1)
L_sf_87:
    buffer_load_dwordx4 v[152:155], v1, s[52:55], s97 offen offset:0 nt
    v_mfma_f32_16x16x32_bf16 v[32:35], v[24:27], v[136:139], v[32:35]
    v_and_b32_dpp v28, v18, v20 row_newbcast:8 row_mask:0xf bank_mask:0xf
    v_and_b32_dpp v29, v18, v21 row_newbcast:8 row_mask:0xf bank_mask:0xf
    v_and_b32_dpp v30, v18, v22 row_newbcast:8 row_mask:0xf bank_mask:0xf
    v_and_b32_dpp v31, v18, v23 row_newbcast:8 row_mask:0xf bank_mask:0xf
    s_waitcnt vmcnt(3)
    s_bitcmp0_b32 s14, 29
    s_cbranch_scc1 L_sf_88
    s_waitcnt vmcnt(2)
    s_bitcmp0_b32 s15, 29
    s_cbranch_scc1 L_sf_88
    s_waitcnt vmcnt(1)
L_sf_88:
    buffer_load_dwordx4 v[156:159], v1, s[52:55], s97 offen offset:1024 nt
    v_mfma_f32_16x16x32_bf16 v[32:35], v[28:31], v[140:143], v[32:35]
    v_and_b32_dpp v24, v18, v20 row_newbcast:4 row_mask:0xf bank_mask:0xf
    v_and_b32_dpp v25, v18, v21 row_newbcast:4 row_mask:0xf bank_mask:0xf
    v_and_b32_dpp v26, v18, v22 row_newbcast:4 row_mask:0xf bank_mask:0xf
    v_and_b32_dpp v27, v18, v23 row_newbcast:4 row_mask:0xf bank_mask:0xf
    s_waitcnt vmcnt(3)
    s_bitcmp0_b32 s14, 30
    s_cbranch_scc1 L_sf_89
    s_waitcnt vmcnt(2)
    s_bitcmp0_b32 s15, 30
    s_cbranch_scc1 L_sf_89
    s_waitcnt vmcnt(1)
L_sf_89:
    buffer_load_dwordx4 v[160:163], v1, s[52:55], s97 offen offset:2048 nt
    v_mfma_f32_16x16x32_bf16 v[32:35], v[24:27], v[144:147], v[32:35]
    v_lshrrev_b32 v9, 4, v0
    v_lshl_add_u32 v8, v9, 2, v2
    s_lshl_b32 s96, s3, 9
    s_add_u32 s96, s96, 157824
    v_lshl_add_u32 v8, v8, 2, s96
    v_lshlrev_b32 v9, 3, v0
    v_add_u32 v9, 157824, v9
    v_mov_b32 v10, 162048
    v_mov_b32 v11, 1
    s_lshl_b32 s96, s38, 5
    s_add_u32 s96, s96, 161984
    v_mov_b32 v3, s96
    s_sub_u32 s62, 8, s39
    s_lshl_b32 s98, s34, 5
    s_add_u32 s98, s98, s35
    s_lshl_b32 s98, s98, 8
    s_add_u32 s98, s98, 90112
    v_lshlrev_b32 v39, 2, v0
    v_and_b32_dpp v28, v18, v20 row_newbcast:12 row_mask:0xf bank_mask:0xf
    v_and_b32_dpp v29, v18, v21 row_newbcast:12 row_mask:0xf bank_mask:0xf
    v_and_b32_dpp v30, v18, v22 row_newbcast:12 row_mask:0xf bank_mask:0xf
    v_and_b32_dpp v31, v18, v23 row_newbcast:12 row_mask:0xf bank_mask:0xf
    s_waitcnt vmcnt(3)
    s_bitcmp0_b32 s14, 31
    s_cbranch_scc1 L_sf_90
    s_waitcnt vmcnt(2)
    s_bitcmp0_b32 s15, 31
    s_cbranch_scc1 L_sf_90
    s_waitcnt vmcnt(1)
L_sf_90:
    buffer_load_dwordx4 v[164:167], v1, s[52:55], s97 offen offset:3072 nt
    s_mov_b32 s97, 0
    v_add_u32 v1, 4096, v1
    v_and_b32 v1, 0x7fff, v1
    v_mfma_f32_16x16x32_bf16 v[32:35], v[28:31], v[148:151], v[32:35]
    s_cmp_eq_u32 s12, -1
    s_cbranch_scc1 L_v_nopf
    v_and_b32_dpp v24, v19, v20 row_newbcast:0 row_mask:0xf bank_mask:0xf
    v_and_b32_dpp v25, v19, v21 row_newbcast:0 row_mask:0xf bank_mask:0xf
    v_and_b32_dpp v26, v19, v22 row_newbcast:0 row_mask:0xf bank_mask:0xf
    v_and_b32_dpp v27, v19, v23 row_newbcast:0 row_mask:0xf bank_mask:0xf
    s_waitcnt vmcnt(3)
    s_nop 0
    v_mfma_f32_16x16x32_bf16 v[32:35], v[24:27], v[152:155], v[32:35]
    v_and_b32_dpp v28, v19, v20 row_newbcast:8 row_mask:0xf bank_mask:0xf
    v_and_b32_dpp v29, v19, v21 row_newbcast:8 row_mask:0xf bank_mask:0xf
    v_and_b32_dpp v30, v19, v22 row_newbcast:8 row_mask:0xf bank_mask:0xf
    v_and_b32_dpp v31, v19, v23 row_newbcast:8 row_mask:0xf bank_mask:0xf
    s_waitcnt vmcnt(2)
    s_nop 0
    v_mfma_f32_16x16x32_bf16 v[32:35], v[28:31], v[156:159], v[32:35]
    v_and_b32_dpp v24, v19, v20 row_newbcast:4 row_mask:0xf bank_mask:0xf
    v_and_b32_dpp v25, v19, v21 row_newbcast:4 row_mask:0xf bank_mask:0xf
    v_and_b32_dpp v26, v19, v22 row_newbcast:4 row_mask:0xf bank_mask:0xf
    v_and_b32_dpp v27, v19, v23 row_newbcast:4 row_mask:0xf bank_mask:0xf
    s_waitcnt vmcnt(1)
    s_nop 0
    v_mfma_f32_16x16x32_bf16 v[32:35], v[24:27], v[160:163], v[32:35]
    v_and_b32_dpp v28, v19, v20 row_newbcast:12 row_mask:0xf bank_mask:0xf
    v_and_b32_dpp v29, v19, v21 row_newbcast:12 row_mask:0xf bank_mask:0xf
    v_and_b32_dpp v30, v19, v22 row_newbcast:12 row_mask:0xf bank_mask:0xf
    v_and_b32_dpp v31, v19, v23 row_newbcast:12 row_mask:0xf bank_mask:0xf
    s_waitcnt vmcnt(0)
    s_nop 0
    v_mfma_f32_16x16x32_bf16 v[32:35], v[28:31], v[164:167], v[32:35]
L_v_join:
    s_cmp_lg_u32 s13, 0
    s_cbranch_scc1 L_jobend
L_t0:
    s_mov_b32 exec_hi, 0
    s_nop 4
    ds_write_b128 v8, v[32:35]
L_t0b:
    s_mov_b64 exec, 1
    ds_add_rtn_u32 v37, v10, v11
    s_mov_b64 exec, -1
    ds_read_b32 v38, v10 offset:24
    ds_read_b128 v[24:27], v3
    ds_read_b128 v[28:31], v3 offset:16
    ds_read_b64 v[144:145], v9 offset:0
    ds_read_b64 v[146:147], v9 offset:512
    ds_read_b64 v[148:149], v9 offset:1024
    ds_read_b64 v[150:151], v9 offset:1536
    ds_read_b64 v[152:153], v9 offset:2048
    ds_read_b64 v[154:155], v9 offset:2560
    ds_read_b64 v[156:157], v9 offset:3072
    ds_read_b64 v[158:159], v9 offset:3584
    s_waitcnt lgkmcnt(10)
    v_readfirstlane_b32 s96, v37
    v_readfirstlane_b32 s61, v38
    s_cmp_lg_u32 s96, s62
    s_cbranch_scc1 L_nopub
    s_waitcnt lgkmcnt(6)
    v_pk_mul_f32 v[144:145], v[144:145], v[24:25] op_sel:[0,0] op_sel_hi:[1,0]
    v_pk_mul_f32 v[146:147], v[146:147], v[24:25] op_sel:[0,1] op_sel_hi:[1,1]
    s_waitcnt lgkmcnt(4)
    v_pk_fma_f32 v[144:145], v[148:149], v[26:27], v[144:145] op_sel:[0,0,0] op_sel_hi:[1,0,1]
    v_pk_fma_f32 v[146:147], v[150:151], v[26:27], v[146:147] op_sel:[0,1,0] op_sel_hi:[1,1,1]
    s_waitcnt lgkmcnt(2)
    v_pk_fma_f32 v[144:145], v[152:153], v[28:29], v[144:145] op_sel:[0,0,0] op_sel_hi:[1,0,1]
    v_pk_fma_f32 v[146:147], v[154:155], v[28:29], v[146:147] op_sel:[0,1,0] op_sel_hi:[1,1,1]
    s_waitcnt lgkmcnt(0)
    v_pk_fma_f32 v[144:145], v[156:157], v[30:31], v[144:145] op_sel:[0,0,0] op_sel_hi:[1,0,1]
    v_pk_fma_f32 v[146:147], v[158:159], v[30:31], v[146:147] op_sel:[0,1,0] op_sel_hi:[1,1,1]
    s_cmp_eq_u32 s61, 1
    v_pk_add_f32 v[144:145], v[144:145], v[146:147]
    v_cvt_pk_bf16_f32 v32, v144, v145
    s_cbranch_scc0 L_oslow
    buffer_store_dword v32, v39, s[40:43], s98 offen
L_odone:
L_nopub:
    s_cmp_eq_u32 s59, 0
    s_cbranch_scc1 L_not1
L_poll_99:
    buffer_load_dwordx4 v[16:19], v105, s[40:43], s100 offen sc1
    buffer_load_dwordx4 v[20:23], v105, s[40:43], s100 offen offset:128 sc1
    s_sub_u32 s60, s60, 1
    s_cbranch_scc1 L_poll_99t
    s_waitcnt vmcnt(0)
    v_max3_u32 v38, v16, v17, v18
    v_max3_u32 v38, v38, v19, v20
    v_max3_u32 v38, v38, v21, v22
    v_max_u32 v38, v38, v23
    v_cmp_eq_u32 vcc, -1, v38
    s_cbranch_vccnz L_poll_99
L_poll_99e:
    v_smfmac_f32_16x16x64_bf16 v[112:115], v[16:19], v[72:79], v111
    v_smfmac_f32_16x16x64_bf16 v[116:119], v[16:19], v[80:87], v111
    v_smfmac_f32_16x16x64_bf16 v[112:115], v[20:23], v[88:95], v111
    v_smfmac_f32_16x16x64_bf16 v[116:119], v[20:23], v[96:103], v111
    s_nop 6
    v_pk_add_f32 v[112:113], v[112:113], v[114:115]
    v_pk_add_f32 v[116:117], v[116:117], v[118:119]
    v_add_f32 v12, v112, v113
    v_add_f32 v13, v116, v117
    ds_write2_b32 v106, v12, v13 offset0:0 offset1:32
    s_mov_b64 exec, 1
    ds_add_rtn_u32 v37, v109, v11
    s_mov_b64 exec, -1
    ds_read_b64 v[72:73], v107 offset:0
    ds_read_b64 v[74:75], v107 offset:16384
    ds_read_b64 v[76:77], v107 offset:32768
    ds_read_b64 v[78:79], v107 offset:49152
    s_cmp_eq_u32 s34, 2
    s_cselect_b32 s97, s61, 0
    s_waitcnt lgkmcnt(4)
    v_readfirstlane_b32 s96, v37
    s_waitcnt lgkmcnt(2)
    v_pk_add_f32 v[72:73], v[72:73], v[74:75]
    s_cmp_lg_u32 s96, 3
    s_cbranch_scc1 L_not1
    s_cmp_eq_u32 s97, 1
    s_waitcnt lgkmcnt(0)
    v_pk_add_f32 v[76:77], v[76:77], v[78:79]
    v_pk_add_f32 v[72:73], v[72:73], v[76:77]
    v_cvt_pk_bf16_f32 v12, v72, v73
    s_cbranch_scc1 L_pfast
    buffer_store_dword v12, v108, s[40:43], s101 offen sc1
L_pdone:
L_not1:
    s_waitcnt lgkmcnt(0)
    s_cmp_eq_u32 s39, 1
    s_cbranch_scc1 L_s_role
    s_endpgm
L_k_nopf:
    s_waitcnt vmcnt(3)
    s_bitcmp0_b32 s57, 22
    s_cbranch_scc1 L_sf_55
    s_waitcnt vmcnt(2)
    s_bitcmp0_b32 s58, 22
    s_cbranch_scc1 L_sf_55
    s_waitcnt vmcnt(1)
L_sf_55:
    buffer_load_dwordx4 v[128:131], v1, s[48:51], s97 offen offset:2048 nt
    v_min_u32 v39, 29, v0
    v_lshlrev_b32 v39, 2, v39
    buffer_load_dword v37, v39, s[44:47], 0 offen sc1
    s_waitcnt vmcnt(4)
    s_bitcmp0_b32 s57, 23
    s_cbranch_scc1 L_sf_56
    s_waitcnt vmcnt(3)
    s_bitcmp0_b32 s58, 23
    s_cbranch_scc1 L_sf_56
    s_waitcnt vmcnt(2)
L_sf_56:
    buffer_load_dwordx4 v[132:135], v1, s[48:51], s97 offen offset:3072 nt
    s_add_u32 s97, s97, 32768
    v_add_u32 v1, 4096, v1
    v_and_b32 v1, 0x7fff, v1
    s_waitcnt vmcnt(4)
    s_bitcmp0_b32 s57, 24
    s_cbranch_scc1 L_sf_57
    s_waitcnt vmcnt(3)
    s_bitcmp0_b32 s58, 24
    s_cbranch_scc1 L_sf_57
    s_waitcnt vmcnt(2)
L_sf_57:
    buffer_load_dwordx4 v[136:139], v1, s[48:51], s97 offen offset:0 nt
    s_waitcnt vmcnt(4)
    s_bitcmp0_b32 s57, 25
    s_cbranch_scc1 L_sf_58
    s_waitcnt vmcnt(3)
    s_bitcmp0_b32 s58, 25
    s_cbranch_scc1 L_sf_58
    s_waitcnt vmcnt(1)
L_sf_58:
    buffer_load_dwordx4 v[140:143], v1, s[48:51], s97 offen offset:1024 nt
    s_waitcnt vmcnt(4)
    s_bitcmp0_b32 s57, 26
    s_cbranch_scc1 L_sf_59
    s_waitcnt vmcnt(2)
    s_bitcmp0_b32 s58, 26
    s_cbranch_scc1 L_sf_59
    s_waitcnt vmcnt(1)
L_sf_59:
    buffer_load_dwordx4 v[144:147], v1, s[48:51], s97 offen offset:2048 nt
    s_waitcnt vmcnt(3)
    s_bitcmp0_b32 s57, 27
    s_cbranch_scc1 L_sf_60
    s_waitcnt vmcnt(2)
    s_bitcmp0_b32 s58, 27
    s_cbranch_scc1 L_sf_60
    s_waitcnt vmcnt(1)
L_sf_60:
    buffer_load_dwordx4 v[148:151], v1, s[48:51], s97 offen offset:3072 nt
    s_add_u32 s97, s97, 32768
    v_add_u32 v1, 4096, v1
    v_and_b32 v1, 0x7fff, v1
    v_cmp_eq_u32 vcc, 0, v37
    s_nop 0
    s_or_b32 s96, vcc_lo, vcc_hi
    buffer_load_dwordx4 v[4:7], v2, s[40:43], s98 offen sc1
    s_waitcnt vmcnt(4)
    s_bitcmp0_b32 s57, 28
    s_cbranch_scc1 L_sf_61
    s_waitcnt vmcnt(3)
    s_bitcmp0_b32 s58, 28
    s_cbranch_scc1 L_sf_61
    s_waitcnt vmcnt(2)
L_sf_61:
    buffer_load_dwordx4 v[152:155], v1, s[48:51], s97 offen offset:0 nt
    s_waitcnt vmcnt(4)
    s_bitcmp0_b32 s57, 29
    s_cbranch_scc1 L_sf_62
    s_waitcnt vmcnt(3)
    s_bitcmp0_b32 s58, 29
    s_cbranch_scc1 L_sf_62
    s_waitcnt vmcnt(2)
L_sf_62:
    buffer_load_dwordx4 v[156:159], v1, s[48:51], s97 offen offset:1024 nt
    s_waitcnt vmcnt(4)
    s_bitcmp0_b32 s57, 30
    s_cbranch_scc1 L_sf_63
    s_waitcnt vmcnt(3)
    s_bitcmp0_b32 s58, 30
    s_cbranch_scc1 L_sf_63
    s_waitcnt vmcnt(1)
L_sf_63:
    buffer_load_dwordx4 v[160:163], v1, s[48:51], s97 offen offset:2048 nt
    s_waitcnt vmcnt(4)
    s_bitcmp0_b32 s57, 31
    s_cbranch_scc1 L_sf_64
    s_waitcnt vmcnt(2)
    s_bitcmp0_b32 s58, 31
    s_cbranch_scc1 L_sf_64
    s_waitcnt vmcnt(1)
L_sf_64:
    buffer_load_dwordx4 v[164:167], v1, s[48:51], s97 offen offset:3072 nt
    s_mov_b32 s97, 0
    v_add_u32 v1, 4096, v1
    v_and_b32 v1, 0x7fff, v1
    v_add_u32 v1, 8192, v1
    v_and_b32 v1, 0x7fff, v1
    s_mov_b32 s97, 65536
    s_branch L_k_join
L_v_nopf:
    v_and_b32_dpp v24, v19, v20 row_newbcast:0 row_mask:0xf bank_mask:0xf
    v_and_b32_dpp v25, v19, v21 row_newbcast:0 row_mask:0xf bank_mask:0xf
    v_and_b32_dpp v26, v19, v22 row_newbcast:0 row_mask:0xf bank_mask:0xf
    v_and_b32_dpp v27, v19, v23 row_newbcast:0 row_mask:0xf bank_mask:0xf
    s_waitcnt vmcnt(3)
    s_bitcmp0_b32 s14, 0
    s_cbranch_scc1 L_sf_91
    s_waitcnt vmcnt(2)
    s_bitcmp0_b32 s15, 0
    s_cbranch_scc1 L_sf_91
    s_waitcnt vmcnt(1)
L_sf_91:
    buffer_load_dwordx4 v[40:43], v1, s[52:55], s97 offen offset:0 nt
    v_mfma_f32_16x16x32_bf16 v[32:35], v[24:27], v[152:155], v[32:35]
    v_and_b32_dpp v28, v19, v20 row_newbcast:8 row_mask:0xf bank_mask:0xf
    v_and_b32_dpp v29, v19, v21 row_newbcast:8 row_mask:0xf bank_mask:0xf
    v_and_b32_dpp v30, v19, v22 row_newbcast:8 row_mask:0xf bank_mask:0xf
    v_and_b32_dpp v31, v19, v23 row_newbcast:8 row_mask:0xf bank_mask:0xf
    s_waitcnt vmcnt(3)
    s_bitcmp0_b32 s14, 1
    s_cbranch_scc1 L_sf_92
    s_waitcnt vmcnt(2)
    s_bitcmp0_b32 s15, 1
    s_cbranch_scc1 L_sf_92
    s_waitcnt vmcnt(1)
L_sf_92:
    buffer_load_dwordx4 v[44:47], v1, s[52:55], s97 offen offset:1024 nt
    v_mfma_f32_16x16x32_bf16 v[32:35], v[28:31], v[156:159], v[32:35]
    v_and_b32_dpp v24, v19, v20 row_newbcast:4 row_mask:0xf bank_mask:0xf
    v_and_b32_dpp v25, v19, v21 row_newbcast:4 row_mask:0xf bank_mask:0xf
    v_and_b32_dpp v26, v19, v22 row_newbcast:4 row_mask:0xf bank_mask:0xf
    v_and_b32_dpp v27, v19, v23 row_newbcast:4 row_mask:0xf bank_mask:0xf
    s_waitcnt vmcnt(3)
    s_bitcmp0_b32 s14, 2
    s_cbranch_scc1 L_sf_93
    s_waitcnt vmcnt(2)
    s_bitcmp0_b32 s15, 2
    s_cbranch_scc1 L_sf_93
    s_waitcnt vmcnt(1)
L_sf_93:
    buffer_load_dwordx4 v[48:51], v1, s[52:55], s97 offen offset:2048 nt
    v_mfma_f32_16x16x32_bf16 v[32:35], v[24:27], v[160:163], v[32:35]
    v_and_b32_dpp v28, v19, v20 row_newbcast:12 row_mask:0xf bank_mask:0xf
    v_and_b32_dpp v29, v19, v21 row_newbcast:12 row_mask:0xf bank_mask:0xf
    v_and_b32_dpp v30, v19, v22 row_newbcast:12 row_mask:0xf bank_mask:0xf
    v_and_b32_dpp v31, v19, v23 row_newbcast:12 row_mask:0xf bank_mask:0xf
    s_waitcnt vmcnt(3)
    s_bitcmp0_b32 s14, 3
    s_cbranch_scc1 L_sf_94
    s_waitcnt vmcnt(2)
    s_bitcmp0_b32 s15, 3
    s_cbranch_scc1 L_sf_94
    s_waitcnt vmcnt(1)
L_sf_94:
    buffer_load_dwordx4 v[52:55], v1, s[52:55], s97 offen offset:3072 nt
    s_add_u32 s97, s97, 32768
    v_add_u32 v1, 4096, v1
    v_and_b32 v1, 0x7fff, v1
    v_mfma_f32_16x16x32_bf16 v[32:35], v[28:31], v[164:167], v[32:35]
    v_and_b32_dpp v24, v12, v20 row_newbcast:0 row_mask:0xf bank_mask:0xf
    v_and_b32_dpp v25, v12, v21 row_newbcast:0 row_mask:0xf bank_mask:0xf
    v_and_b32_dpp v26, v12, v22 row_newbcast:0 row_mask:0xf bank_mask:0xf
    v_and_b32_dpp v27, v12, v23 row_newbcast:0 row_mask:0xf bank_mask:0xf
    s_waitcnt vmcnt(3)
    s_bitcmp0_b32 s14, 4
    s_cbranch_scc1 L_sf_95
    s_waitcnt vmcnt(2)
    s_bitcmp0_b32 s15, 4
    s_cbranch_scc1 L_sf_95
    s_waitcnt vmcnt(1)
L_sf_95:
    buffer_load_dwordx4 v[56:59], v1, s[52:55], s97 offen offset:0 nt
    v_mfma_f32_16x16x32_bf16 v[32:35], v[24:27], v[40:43], v[32:35]
    v_and_b32_dpp v28, v12, v20 row_newbcast:8 row_mask:0xf bank_mask:0xf
    v_and_b32_dpp v29, v12, v21 row_newbcast:8 row_mask:0xf bank_mask:0xf
    v_and_b32_dpp v30, v12, v22 row_newbcast:8 row_mask:0xf bank_mask:0xf
    v_and_b32_dpp v31, v12, v23 row_newbcast:8 row_mask:0xf bank_mask:0xf
    s_waitcnt vmcnt(3)
    s_bitcmp0_b32 s14, 5
    s_cbranch_scc1 L_sf_96
    s_waitcnt vmcnt(2)
    s_bitcmp0_b32 s15, 5
    s_cbranch_scc1 L_sf_96
    s_waitcnt vmcnt(1)
L_sf_96:
    buffer_load_dwordx4 v[60:63], v1, s[52:55], s97 offen offset:1024 nt
    v_mfma_f32_16x16x32_bf16 v[32:35], v[28:31], v[44:47], v[32:35]
    v_and_b32_dpp v24, v12, v20 row_newbcast:4 row_mask:0xf bank_mask:0xf
    v_and_b32_dpp v25, v12, v21 row_newbcast:4 row_mask:0xf bank_mask:0xf
    v_and_b32_dpp v26, v12, v22 row_newbcast:4 row_mask:0xf bank_mask:0xf
    v_and_b32_dpp v27, v12, v23 row_newbcast:4 row_mask:0xf bank_mask:0xf
    s_waitcnt vmcnt(3)
    s_bitcmp0_b32 s14, 6
    s_cbranch_scc1 L_sf_97
    s_waitcnt vmcnt(2)
    s_bitcmp0_b32 s15, 6
    s_cbranch_scc1 L_sf_97
    s_waitcnt vmcnt(1)
L_sf_97:
    buffer_load_dwordx4 v[64:67], v1, s[52:55], s97 offen offset:2048 nt
    v_mfma_f32_16x16x32_bf16 v[32:35], v[24:27], v[48:51], v[32:35]
    v_and_b32_dpp v28, v12, v20 row_newbcast:12 row_mask:0xf bank_mask:0xf
    v_and_b32_dpp v29, v12, v21 row_newbcast:12 row_mask:0xf bank_mask:0xf
    v_and_b32_dpp v30, v12, v22 row_newbcast:12 row_mask:0xf bank_mask:0xf
    v_and_b32_dpp v31, v12, v23 row_newbcast:12 row_mask:0xf bank_mask:0xf
    s_waitcnt vmcnt(3)
    s_bitcmp0_b32 s14, 7
    s_cbranch_scc1 L_sf_98
    s_waitcnt vmcnt(2)
    s_bitcmp0_b32 s15, 7
    s_cbranch_scc1 L_sf_98
    s_waitcnt vmcnt(1)
L_sf_98:
    buffer_load_dwordx4 v[68:71], v1, s[52:55], s97 offen offset:3072 nt
    s_add_u32 s97, s97, 32768
    v_add_u32 v1, 4096, v1
    v_and_b32 v1, 0x7fff, v1
    v_mfma_f32_16x16x32_bf16 v[32:35], v[28:31], v[52:55], v[32:35]
    v_and_b32_dpp v24, v13, v20 row_newbcast:0 row_mask:0xf bank_mask:0xf
    v_and_b32_dpp v25, v13, v21 row_newbcast:0 row_mask:0xf bank_mask:0xf
    v_and_b32_dpp v26, v13, v22 row_newbcast:0 row_mask:0xf bank_mask:0xf
    v_and_b32_dpp v27, v13, v23 row_newbcast:0 row_mask:0xf bank_mask:0xf
    s_waitcnt vmcnt(3)
    s_nop 0
    v_mfma_f32_16x16x32_bf16 v[32:35], v[24:27], v[56:59], v[32:35]
    v_and_b32_dpp v28, v13, v20 row_newbcast:8 row_mask:0xf bank_mask:0xf
    v_and_b32_dpp v29, v13, v21 row_newbcast:8 row_mask:0xf bank_mask:0xf
    v_and_b32_dpp v30, v13, v22 row_newbcast:8 row_mask:0xf bank_mask:0xf
    v_and_b32_dpp v31, v13, v23 row_newbcast:8 row_mask:0xf bank_mask:0xf
    s_waitcnt vmcnt(2)
    s_nop 0
    v_mfma_f32_16x16x32_bf16 v[32:35], v[28:31], v[60:63], v[32:35]
    v_and_b32_dpp v24, v13, v20 row_newbcast:4 row_mask:0xf bank_mask:0xf
    v_and_b32_dpp v25, v13, v21 row_newbcast:4 row_mask:0xf bank_mask:0xf
    v_and_b32_dpp v26, v13, v22 row_newbcast:4 row_mask:0xf bank_mask:0xf
    v_and_b32_dpp v27, v13, v23 row_newbcast:4 row_mask:0xf bank_mask:0xf
    s_waitcnt vmcnt(1)
    s_nop 0
    v_mfma_f32_16x16x32_bf16 v[32:35], v[24:27], v[64:67], v[32:35]
    v_and_b32_dpp v28, v13, v20 row_newbcast:12 row_mask:0xf bank_mask:0xf
    v_and_b32_dpp v29, v13, v21 row_newbcast:12 row_mask:0xf bank_mask:0xf
    v_and_b32_dpp v30, v13, v22 row_newbcast:12 row_mask:0xf bank_mask:0xf
    v_and_b32_dpp v31, v13, v23 row_newbcast:12 row_mask:0xf bank_mask:0xf
    s_waitcnt vmcnt(0)
    s_nop 0
    v_mfma_f32_16x16x32_bf16 v[32:35], v[28:31], v[68:71], v[32:35]
    s_branch L_v_join
L_oslow:
    buffer_store_dword v32, v39, s[40:43], s98 offen sc1
    s_branch L_odone
L_qslow:
L_wy_100:
    buffer_load_dword v37, v39, s[44:47], 0 offen sc1
    s_waitcnt vmcnt(0)
    v_cmp_ne_u32 vcc, -1, v37
    s_cbranch_vccz L_wy_100e
    s_sleep 4
    s_sub_u32 s60, s60, 1
    s_cbranch_scc0 L_wy_100
    s_mov_b32 s60, 0
L_wy_100e:
L_qslow2:
    s_branch L_poll_101
L_poll_101s:
    s_sleep 2
L_poll_101:
    buffer_load_dwordx4 v[4:7], v2, s[40:43], s98 offen sc1
    s_sub_u32 s60, s60, 1
    s_cbranch_scc1 L_poll_101t
    s_waitcnt vmcnt(0)
    v_max3_u32 v38, v4, v5, v6
    v_max_u32 v38, v38, v7
    v_cmp_eq_u32 vcc, -1, v38
    s_cbranch_vccnz L_poll_101s
L_poll_101e:
    s_branch L_qok
L_mljob:
    s_lshl_b32 s96, s38, 3
    s_add_u32 s96, s96, s3
    s_lshl3_add_u32 s96, s96, s99
    buffer_store_dwordx2 v[8:9], v36, s[40:43], s96 offen sc1
    s_branch L_mldone
L_service:
    v_mov_b32 v72, 0
    v_mov_b32 v73, 0
    v_mov_b32 v74, 0
    v_mov_b32 v75, 0
    v_mov_b32 v76, 0
    s_mov_b32 s59, 0
    v_mov_b32 v5, 0
    v_mov_b32 v105, 0
    v_mov_b32 v108, 0
    v_mov_b32 v160, 0
    v_mov_b32 v163, 0
    v_mov_b32 v8, 162068
L_lw_102:
    ds_read_b32 v9, v8
    s_waitcnt lgkmcnt(0)
    v_cmp_gt_u32 vcc, 8, v9
    s_cbranch_vccz L_lw_102e
    s_sleep 8
    s_sub_u32 s60, s60, 1
    s_cbranch_scc0 L_lw_102
    s_mov_b32 s60, 0
L_lw_102e:
    v_and_b32 v2, 15, v0
    v_lshlrev_b32 v2, 3, v2
    v_add_u32 v3, 161920, v2
    ds_read_b64 v[8:9], v3
    s_lshl_b32 s99, s37, 5
    s_add_u32 s99, s99, s36
    s_lshl_b32 s99, s99, 7
    s_add_u32 s99, s99, 73728
    s_lshl_b32 s62, s38, 6
    s_add_u32 s62, s62, s99
    s_getreg_b32 s58, hwreg(HW_REG_XCC_ID, 0, 4)
    v_mov_b32 v10, s58
    s_lshl_b32 s98, s34, 5
    s_add_u32 s98, s98, s35
    s_lshl_b32 s63, s98, 2
    s_add_u32 s63, s63, 229376
    s_lshl_b32 s98, s98, 8
    s_add_u32 s98, s98, 90112
    v_lshlrev_b32 v39, 2, v0
    s_bfm_b64 exec, 8, 0
    s_waitcnt lgkmcnt(0)
    buffer_store_dwordx2 v[8:9], v2, s[40:43], s62 offen sc1
    s_mov_b64 exec, 1
    buffer_store_dword v10, v36, s[40:43], s63 offen sc1
    s_mov_b64 exec, -1
    v_mov_b32 v12, 162076
L_lw_103:
    ds_read_b32 v13, v12
    s_waitcnt lgkmcnt(0)
    v_cmp_gt_u32 vcc, 4, v13
    s_cbranch_vccz L_lw_103e
    s_sleep 4
    s_sub_u32 s60, s60, 1
    s_cbranch_scc0 L_lw_103
    s_mov_b32 s60, 0
L_lw_103e:
    v_and_b32 v11, 31, v0
    v_lshlrev_b32 v11, 2, v11
    s_lshl_b32 s63, s34, 7
    s_add_u32 s63, s63, 229376
    buffer_load_dword v12, v39, s[40:43], s98 offen sc1
    s_branch L_poll_104
L_poll_104s:
    s_sleep 16
L_poll_104:
    buffer_load_dwordx2 v[8:9], v2, s[40:43], s99 offen sc1
    buffer_load_dword v10, v11, s[40:43], s63 offen sc1
    s_sub_u32 s60, s60, 1
    s_cbranch_scc1 L_poll_104t
    s_waitcnt vmcnt(0)
    v_max3_u32 v38, v8, v9, v10
    v_cmp_eq_u32 vcc, -1, v38
    s_cbranch_vccnz L_poll_104s
L_poll_104e:
    v_mov_b32 v37, v8
    s_nop 1
    v_max_f32_dpp v37, v37, v37 quad_perm:[1,0,3,2] row_mask:0xf bank_mask:0xf
    s_nop 1
    v_max_f32_dpp v37, v37, v37 quad_perm:[2,3,0,1] row_mask:0xf bank_mask:0xf
    s_nop 1
    v_max_f32_dpp v37, v37, v37 row_ror:4 row_mask:0xf bank_mask:0xf
    s_nop 1
    v_max_f32_dpp v37, v37, v37 row_ror:8 row_mask:0xf bank_mask:0xf
    v_sub_f32 v8, v8, v37
    v_exp_f32 v8, v8
    s_nop 0
    v_mul_f32 v9, v8, v9
    s_nop 1
    v_add_f32_dpp v9, v9, v9 quad_perm:[1,0,3,2] row_mask:0xf bank_mask:0xf
    s_nop 1
    v_add_f32_dpp v9, v9, v9 quad_perm:[2,3,0,1] row_mask:0xf bank_mask:0xf
    s_nop 1
    v_add_f32_dpp v9, v9, v9 row_ror:4 row_mask:0xf bank_mask:0xf
    s_nop 1
    v_add_f32_dpp v9, v9, v9 row_ror:8 row_mask:0xf bank_mask:0xf
    s_getreg_b32 s62, hwreg(HW_REG_XCC_ID, 0, 4)
    v_cmp_ne_u32 vcc, s62, v10
    s_nop 0
    s_cmp_eq_u64 vcc, 0
    s_cselect_b32 s61, 1, 0
    v_rcp_f32 v9, v9
    v_lshrrev_b32 v3, 1, v2
    v_add_u32 v3, 161984, v3
    v_mul_f32 v8, v8, v9
    v_mov_b32 v10, 162072
    v_mov_b32 v11, s61
    ds_write_b32 v3, v8
    ds_write_b32 v10, v11
    s_mov_b32 s3, 1
    v_lshrrev_b32 v9, 4, v0
    v_lshl_add_u32 v8, v9, 2, v2
    s_lshl_b32 s96, s3, 9
    s_add_u32 s96, s96, 157824
    v_lshl_add_u32 v8, v8, 2, s96
    v_lshlrev_b32 v9, 3, v0
    v_add_u32 v9, 157824, v9
    v_mov_b32 v10, 162048
    v_mov_b32 v11, 1
    s_lshl_b32 s96, s38, 5
    s_add_u32 s96, s96, 161984
    v_mov_b32 v3, s96
    s_sub_u32 s62, 8, s39
    s_lshl_b32 s98, s34, 5
    s_add_u32 s98, s98, s35
    s_lshl_b32 s98, s98, 8
    s_add_u32 s98, s98, 90112
    v_lshlrev_b32 v39, 2, v0
    s_branch L_t0b
L_jobend:
    v_lshrrev_b32 v9, 4, v0
    v_lshl_add_u32 v9, v9, 2, v2
    v_lshlrev_b32 v9, 2, v9
    s_mov_b32 exec_hi, 0
    s_nop 1
    buffer_store_dwordx4 v[32:35], v9, s[40:43], s13 offen sc1
    s_endpgm
L_proxy:
    v_mov_b32 v72, 0
    v_mov_b32 v73, 0
    v_mov_b32 v74, 0
    v_mov_b32 v75, 0
    v_mov_b32 v76, 0
    v_mov_b32 v5, 0
    v_mov_b32 v105, 0
    v_mov_b32 v108, 0
    v_mov_b32 v160, 0
    v_mov_b32 v163, 0
    s_barrier
    s_waitcnt lgkmcnt(0)
    s_mov_b32 s40, s32
    s_mov_b32 s41, s33
    s_mov_b32 s42, 589824
    s_mov_b32 s43, 0x20000
    s_mov_b32 s44, s30
    s_mov_b32 s45, s31
    s_mov_b32 s46, 256
    s_mov_b32 s47, 0x20000
    s_sub_u32 s97, 7, s3
    s_mul_i32 s97, s97, 27
    s_cmp_eq_u32 s3, 5
    s_cselect_b32 s97, 32, s97
    s_add_u32 s97, s97, s35
    s_lshl_b32 s97, s97, 9
    s_add_u32 s97, s97, 196608
    v_and_b32 v2, 15, v0
    v_lshlrev_b32 v2, 3, v2
    v_bfe_u32 v20, v0, 4, 1
    v_lshl_add_u32 v20, v20, 2, v2
    v_lshlrev_b32 v20, 2, v20
    s_cmp_lg_u32 s3, 7
    s_cbranch_scc1 L_px6
    s_sub_u32 s96, 6, s59
    v_mov_b32 v8, 162068
L_lw_105:
    ds_read_b32 v9, v8
    s_waitcnt lgkmcnt(0)
    v_cmp_gt_u32 vcc, s96, v9
    s_cbranch_vccz L_lw_105e
    s_sleep 8
    s_sub_u32 s60, s60, 1
    s_cbranch_scc0 L_lw_105
    s_mov_b32 s60, 0
L_lw_105e:
    v_and_b32 v2, 15, v0
    v_lshlrev_b32 v2, 3, v2
    v_add_u32 v3, 161920, v2
    ds_read_b64 v[8:9], v3
    s_lshl_b32 s99, s37, 5
    s_add_u32 s99, s99, s36
    s_lshl_b32 s99, s99, 7
    s_add_u32 s99, s99, 73728
    s_lshl_b32 s62, s38, 6
    s_add_u32 s62, s62, s99
    s_getreg_b32 s58, hwreg(HW_REG_XCC_ID, 0, 4)
    v_mov_b32 v10, s58
    s_lshl_b32 s98, s34, 5
    s_add_u32 s98, s98, s35
    s_lshl_b32 s63, s98, 2
    s_add_u32 s63, s63, 229376
    s_lshl_b32 s98, s98, 8
    s_add_u32 s98, s98, 90112
    v_lshlrev_b32 v39, 2, v0
    s_bfm_b64 exec, s96, 0
    s_waitcnt lgkmcnt(0)
    buffer_store_dwordx2 v[8:9], v2, s[40:43], s62 offen sc1
    s_mov_b64 exec, 1
    buffer_store_dword v10, v36, s[40:43], s63 offen sc1
    s_mov_b64 exec, -1
    s_mov_b32 s100, 4
    s_lshl_b32 s63, s100, 8
    v_and_b32 v8, 15, v0
    v_lshl_add_u32 v8, v8, 4, s63
    v_lshrrev_b32 v9, 4, v0
    v_mul_u32_u24 v5, 1280, v9
    v_add_u32 v5, v5, v8
    v_mul_u32_u24 v4, 1296, v9
    v_add_u32 v4, v4, v8
    v_add_u32 v4, 82944, v4
    v_lshlrev_b32 v6, 1, v5
    v_add_u32 v6, 99328, v6
    s_lshl_b32 s62, s100, 9
    s_add_u32 s62, s62, 88128
    v_lshl_add_u32 v7, v0, 3, s62
    s_mov_b32 s48, s4
    s_mov_b32 s49, s5
    s_mov_b32 s50, 5120
    s_mov_b32 s51, 0x20000
    buffer_load_dwordx4 v[8:11], v5, s[48:51], 0 offen
    s_mov_b32 s62, 20480
    s_mov_b32 s63, 30720
    s_branch L_poll_106
L_poll_106s:
    s_sleep 32
L_poll_106:
    buffer_load_dwordx4 v[12:15], v5, s[40:43], s62 offen sc1
    buffer_load_dwordx4 v[16:19], v5, s[40:43], s63 offen sc1
    s_sub_u32 s60, s60, 1
    s_cbranch_scc1 L_poll_106t
    s_waitcnt vmcnt(0)
    v_max3_u32 v38, v12, v13, v14
    v_max3_u32 v38, v38, v15, v16
    v_max3_u32 v38, v38, v17, v18
    v_max_u32 v38, v38, v19
    v_cmp_eq_u32 vcc, -1, v38
    s_cbranch_vccnz L_poll_106s
L_poll_106e:
    v_lshlrev_b32 v40, 16, v8
    v_and_b32 v41, 0xffff0000, v8
    v_lshlrev_b32 v42, 16, v9
    v_and_b32 v43, 0xffff0000, v9
    v_lshlrev_b32 v44, 16, v10
    v_and_b32 v45, 0xffff0000, v10
    v_lshlrev_b32 v46, 16, v11
    v_and_b32 v47, 0xffff0000, v11
    v_lshlrev_b32 v48, 16, v12
    v_and_b32 v49, 0xffff0000, v12
    v_lshlrev_b32 v50, 16, v13
    v_and_b32 v51, 0xffff0000, v13
    v_lshlrev_b32 v52, 16, v14
    v_and_b32 v53, 0xffff0000, v14
    v_lshlrev_b32 v54, 16, v15
    v_and_b32 v55, 0xffff0000, v15
    v_lshlrev_b32 v56, 16, v16
    v_and_b32 v57, 0xffff0000, v16
    v_lshlrev_b32 v58, 16, v17
    v_and_b32 v59, 0xffff0000, v17
    v_lshlrev_b32 v60, 16, v18
    v_and_b32 v61, 0xffff0000, v18
    v_lshlrev_b32 v62, 16, v19
    v_and_b32 v63, 0xffff0000, v19
    v_mov_b32 v64, 0
    v_mov_b32 v65, 0
    v_mov_b32 v66, 0
    v_mov_b32 v67, 0
    v_mov_b32 v68, 0
    v_mov_b32 v69, 0
    v_mov_b32 v70, 0
    v_mov_b32 v71, 0
    v_bfe_u32 v5, v0, 2, 2
    v_lshlrev_b32 v5, 8, v5
    v_lshrrev_b32 v8, 4, v0
    v_lshl_add_u32 v5, v8, 6, v5
    v_and_b32 v8, 3, v0
    v_lshl_add_u32 v5, v8, 4, v5
    s_lshl_b32 s63, s100, 10
    v_add_u32 v5, s63, v5
    s_or_b32 s96, s59, s39
    s_cbranch_scc0 L_nofrag_107
    v_mov_b32 v104, 162060
L_lw_108:
    ds_read_b32 v105, v104
    s_waitcnt lgkmcnt(0)
    v_cmp_gt_u32 vcc, 4, v105
    s_cbranch_vccz L_lw_108e
    s_sleep 2
    s_sub_u32 s60, s60, 1
    s_cbranch_scc0 L_lw_108
    s_mov_b32 s60, 0
L_lw_108e:
    s_cmp_eq_u32 s59, 0
    s_cbranch_scc1 L_nofrag_107
    v_bfe_u32 v104, v0, 2, 1
    v_bfe_u32 v110, v0, 4, 1
    v_lshl_add_u32 v104, v110, 2, v104
    v_and_b32 v110, 8, v0
    v_add_u32 v104, v104, v110
    v_lshrrev_b32 v110, 5, v0
    v_lshl_add_u32 v104, v110, 4, v104
    v_bfe_u32 v111, v0, 0, 1
    v_mul_u32_u24 v111, 0xaaaa, v111
    v_add_u32 v111, 0x4444, v111
    v_mov_b32 v112, 0
    v_mov_b32 v113, 0
    v_mov_b32 v114, 0
    v_mov_b32 v115, 0
    v_mov_b32 v116, 0
    v_mov_b32 v117, 0
    v_mov_b32 v118, 0
    v_mov_b32 v119, 0
    v_lshlrev_b32 v104, 7, v104
    v_and_b32 v110, 3, v0
    v_lshl_add_u32 v104, v110, 3, v104
    v_lshrrev_b32 v109, 4, v0
    v_and_b32 v110, 1, v0
    s_lshr_b32 s63, s3, 1
    s_and_b32 s62, s3, 1
    s_lshl_b32 s96, s63, 14
    s_lshl_b32 s100, s62, 6
    s_add_u32 s100, s100, 81920
    s_add_u32 s96, s96, s100
    v_add_u32 v104, s96, v104
    ds_read_b64_tr_b16 v[72:73], v104 offset:0
    ds_read_b64_tr_b16 v[74:75], v104 offset:256
    ds_read_b64_tr_b16 v[76:77], v104 offset:4096
    ds_read_b64_tr_b16 v[78:79], v104 offset:4352
    ds_read_b64_tr_b16 v[80:81], v104 offset:32
    ds_read_b64_tr_b16 v[82:83], v104 offset:288
    ds_read_b64_tr_b16 v[84:85], v104 offset:4128
    ds_read_b64_tr_b16 v[86:87], v104 offset:4384
    ds_read_b64_tr_b16 v[88:89], v104 offset:8192
    ds_read_b64_tr_b16 v[90:91], v104 offset:8448
    ds_read_b64_tr_b16 v[92:93], v104 offset:12288
    ds_read_b64_tr_b16 v[94:95], v104 offset:12544
    ds_read_b64_tr_b16 v[96:97], v104 offset:8224
    ds_read_b64_tr_b16 v[98:99], v104 offset:8480
    ds_read_b64_tr_b16 v[100:101], v104 offset:12320
    ds_read_b64_tr_b16 v[102:103], v104 offset:12576
    v_bfe_u32 v105, v0, 1, 3
    v_lshlrev_b32 v105, 8, v105
    v_lshl_add_u32 v105, v109, 5, v105
    v_lshl_add_u32 v105, v110, 4, v105
    v_lshrrev_b32 v106, 3, v0
    v_lshlrev_b32 v106, 7, v106
    v_and_b32 v110, 7, v0
    v_lshl_add_u32 v107, v110, 3, v106
    v_add_u32 v107, s100, v107
    v_lshlrev_b32 v106, 8, v109
    v_and_b32 v110, 15, v0
    v_lshl_add_u32 v106, v110, 2, v106
    v_add_u32 v106, s96, v106
    v_lshlrev_b32 v108, 2, v0
    s_lshl_b32 s96, s62, 2
    s_add_u32 s96, s96, 162088
    v_mov_b32 v109, s96
    s_lshl_b32 s100, s63, 11
    s_lshl_b32 s96, s34, 13
    s_add_u32 s100, s100, s96
    s_add_u32 s100, s100, 90112
    s_mul_i32 s101, s34, 5120
    s_lshl_b32 s96, s35, 9
    s_add_u32 s101, s101, s96
    s_lshl_b32 s96, s62, 8
    s_add_u32 s101, s101, s96
    s_add_u32 s101, s101, 144384
L_nofrag_107:
    s_cmp_ge_u32 s35, 20
    s_cbranch_scc1 L_nofin_109
    s_lshl1_add_u32 s62, s35, s3
    s_sub_u32 s62, s62, 6
    s_lshl_b32 s57, s62, 7
    s_mul_i32 s63, s62, 0x199a
    s_lshr_b32 s63, s63, 16
    s_mul_i32 s63, s63, 1280
    s_sub_u32 s63, s57, s63
    v_lshrrev_b32 v72, 3, v0
    v_mul_u32_u24 v72, 5120, v72
    v_and_b32 v8, 7, v0
    v_lshl_add_u32 v72, v8, 4, v72
    s_add_u32 s62, s57, 262144
    v_add_u32 v72, s62, v72
    v_add_u32 v73, 40960, v72
    v_add_u32 v74, 81920, v72
    v_add_u32 v75, 122880, v72
    v_bfe_u32 v9, v0, 4, 1
    v_lshlrev_b32 v76, 4, v8
    v_lshl_add_u32 v76, v9, 3, v76
    s_lshl_b32 s62, s57, 1
    s_add_u32 s62, s62, 99328
    v_lshl_add_u32 v77, v76, 1, s62
    s_mov_b32 s48, s22
    s_mov_b32 s49, s23
    s_mov_b32 s50, 1280
    s_mov_b32 s51, 0x20000
    buffer_load_dwordx2 v[86:87], v76, s[48:51], s63 offen
    s_add_u32 s62, s57, 35840
    s_branch L_poll_110
L_poll_110s:
    s_sleep 32
L_poll_110:
    buffer_load_dwordx2 v[8:9], v76, s[40:43], s62 offen sc1
    s_sub_u32 s60, s60, 1
    s_cbranch_scc1 L_poll_110t
    s_waitcnt vmcnt(0)
    v_max_u32 v38, v8, v9
    v_cmp_eq_u32 vcc, -1, v38
    s_cbranch_vccnz L_poll_110s
L_poll_110e:
    v_lshlrev_b32 v78, 16, v86
    v_and_b32 v79, 0xffff0000, v86
    v_lshlrev_b32 v82, 16, v8
    v_and_b32 v83, 0xffff0000, v8
    v_lshlrev_b32 v80, 16, v87
    v_and_b32 v81, 0xffff0000, v87
    v_lshlrev_b32 v84, 16, v9
    v_and_b32 v85, 0xffff0000, v9
    v_bfe_u32 v8, v0, 1, 3
    v_and_b32 v9, 1, v0
    v_lshlrev_b32 v9, 4, v9
    v_mov_b32 v10, 0x3f80
    v_lshlrev_b32 v9, v9, v10
    v_cmp_eq_u32 vcc, 0, v8
    v_mov_b32 v100, 0
    s_nop 0
    v_cndmask_b32 v104, 0, v9, vcc
    v_cmp_eq_u32 vcc, 1, v8
    v_mov_b32 v101, 0
    s_nop 0
    v_cndmask_b32 v105, 0, v9, vcc
    v_cmp_eq_u32 vcc, 2, v8
    v_mov_b32 v102, 0
    s_nop 0
    v_cndmask_b32 v106, 0, v9, vcc
    v_cmp_eq_u32 vcc, 3, v8
    v_mov_b32 v103, 0
    s_nop 0
    v_cndmask_b32 v107, 0, v9, vcc
L_nofin_109:
    v_mov_b32 v12, 162076
L_lw_111:
    ds_read_b32 v13, v12
    s_waitcnt lgkmcnt(0)
    v_cmp_gt_u32 vcc, 4, v13
    s_cbranch_vccz L_lw_111e
    s_sleep 4
    s_sub_u32 s60, s60, 1
    s_cbranch_scc0 L_lw_111
    s_mov_b32 s60, 0
L_lw_111e:
    v_and_b32 v11, 31, v0
    v_lshlrev_b32 v11, 2, v11
    s_lshl_b32 s63, s34, 7
    s_add_u32 s63, s63, 229376
    buffer_load_dword v12, v39, s[40:43], s98 offen sc1
    s_branch L_poll_112
L_poll_112s:
    s_sleep 4
L_poll_112:
    buffer_load_dwordx2 v[8:9], v2, s[40:43], s99 offen sc1
    buffer_load_dword v10, v11, s[40:43], s63 offen sc1
    buffer_load_dwordx4 v[32:35], v20, s[40:43], s97 offen sc1
    s_sub_u32 s60, s60, 1
    s_cbranch_scc1 L_poll_112t
    s_waitcnt vmcnt(0)
    v_max3_u32 v38, v8, v9, v10
    v_max3_u32 v38, v38, v32, v33
    v_max3_u32 v38, v38, v34, v35
    v_cmp_eq_u32 vcc, -1, v38
    s_cbranch_vccnz L_poll_112s
L_poll_112e:
    v_mov_b32 v37, v8
    s_nop 1
    v_max_f32_dpp v37, v37, v37 quad_perm:[1,0,3,2] row_mask:0xf bank_mask:0xf
    s_nop 1
    v_max_f32_dpp v37, v37, v37 quad_perm:[2,3,0,1] row_mask:0xf bank_mask:0xf
    s_nop 1
    v_max_f32_dpp v37, v37, v37 row_ror:4 row_mask:0xf bank_mask:0xf
    s_nop 1
    v_max_f32_dpp v37, v37, v37 row_ror:8 row_mask:0xf bank_mask:0xf
    v_sub_f32 v8, v8, v37
    v_exp_f32 v8, v8
    s_nop 0
    v_mul_f32 v9, v8, v9
    s_nop 1
    v_add_f32_dpp v9, v9, v9 quad_perm:[1,0,3,2] row_mask:0xf bank_mask:0xf
    s_nop 1
    v_add_f32_dpp v9, v9, v9 quad_perm:[2,3,0,1] row_mask:0xf bank_mask:0xf
    s_nop 1
    v_add_f32_dpp v9, v9, v9 row_ror:4 row_mask:0xf bank_mask:0xf
    s_nop 1
    v_add_f32_dpp v9, v9, v9 row_ror:8 row_mask:0xf bank_mask:0xf
    s_getreg_b32 s62, hwreg(HW_REG_XCC_ID, 0, 4)
    v_cmp_ne_u32 vcc, s62, v10
    s_nop 0
    s_cmp_eq_u64 vcc, 0
    s_cselect_b32 s61, 1, 0
    v_rcp_f32 v9, v9
    v_lshrrev_b32 v3, 1, v2
    v_add_u32 v3, 161984, v3
    v_mul_f32 v8, v8, v9
    v_mov_b32 v10, 162072
    v_mov_b32 v11, s61
    ds_write_b32 v3, v8
    ds_write_b32 v10, v11
    s_branch L_pxj
L_px6:
    s_or_b32 s96, s59, s39
    s_cbranch_scc0 L_nofrag_113
    v_mov_b32 v104, 162060
L_lw_114:
    ds_read_b32 v105, v104
    s_waitcnt lgkmcnt(0)
    v_cmp_gt_u32 vcc, 4, v105
    s_cbranch_vccz L_lw_114e
    s_sleep 2
    s_sub_u32 s60, s60, 1
    s_cbranch_scc0 L_lw_114
    s_mov_b32 s60, 0
L_lw_114e:
    s_cmp_eq_u32 s59, 0
    s_cbranch_scc1 L_nofrag_113
    v_bfe_u32 v104, v0, 2, 1
    v_bfe_u32 v110, v0, 4, 1
    v_lshl_add_u32 v104, v110, 2, v104
    v_and_b32 v110, 8, v0
    v_add_u32 v104, v104, v110
    v_lshrrev_b32 v110, 5, v0
    v_lshl_add_u32 v104, v110, 4, v104
    v_bfe_u32 v111, v0, 0, 1
    v_mul_u32_u24 v111, 0xaaaa, v111
    v_add_u32 v111, 0x4444, v111
    v_mov_b32 v112, 0
    v_mov_b32 v113, 0
    v_mov_b32 v114, 0
    v_mov_b32 v115, 0
    v_mov_b32 v116, 0
    v_mov_b32 v117, 0
    v_mov_b32 v118, 0
    v_mov_b32 v119, 0
    v_lshlrev_b32 v104, 7, v104
    v_and_b32 v110, 3, v0
    v_lshl_add_u32 v104, v110, 3, v104
    v_lshrrev_b32 v109, 4, v0
    v_and_b32 v110, 1, v0
    s_lshr_b32 s63, s3, 1
    s_and_b32 s62, s3, 1
    s_lshl_b32 s96, s63, 14
    s_lshl_b32 s100, s62, 6
    s_add_u32 s100, s100, 81920
    s_add_u32 s96, s96, s100
    v_add_u32 v104, s96, v104
    ds_read_b64_tr_b16 v[72:73], v104 offset:0
    ds_read_b64_tr_b16 v[74:75], v104 offset:256
    ds_read_b64_tr_b16 v[76:77], v104 offset:4096
    ds_read_b64_tr_b16 v[78:79], v104 offset:4352
    ds_read_b64_tr_b16 v[80:81], v104 offset:32
    ds_read_b64_tr_b16 v[82:83], v104 offset:288
    ds_read_b64_tr_b16 v[84:85], v104 offset:4128
    ds_read_b64_tr_b16 v[86:87], v104 offset:4384
    ds_read_b64_tr_b16 v[88:89], v104 offset:8192
    ds_read_b64_tr_b16 v[90:91], v104 offset:8448
    ds_read_b64_tr_b16 v[92:93], v104 offset:12288
    ds_read_b64_tr_b16 v[94:95], v104 offset:12544
    ds_read_b64_tr_b16 v[96:97], v104 offset:8224
    ds_read_b64_tr_b16 v[98:99], v104 offset:8480
    ds_read_b64_tr_b16 v[100:101], v104 offset:12320
    ds_read_b64_tr_b16 v[102:103], v104 offset:12576
    v_bfe_u32 v105, v0, 1, 3
    v_lshlrev_b32 v105, 8, v105
    v_lshl_add_u32 v105, v109, 5, v105
    v_lshl_add_u32 v105, v110, 4, v105
    v_lshrrev_b32 v106, 3, v0
    v_lshlrev_b32 v106, 7, v106
    v_and_b32 v110, 7, v0
    v_lshl_add_u32 v107, v110, 3, v106
    v_add_u32 v107, s100, v107
    v_lshlrev_b32 v106, 8, v109
    v_and_b32 v110, 15, v0
    v_lshl_add_u32 v106, v110, 2, v106
    v_add_u32 v106, s96, v106
    v_lshlrev_b32 v108, 2, v0
    s_lshl_b32 s96, s62, 2
    s_add_u32 s96, s96, 162088
    v_mov_b32 v109, s96
    s_lshl_b32 s100, s63, 11
    s_lshl_b32 s96, s34, 13
    s_add_u32 s100, s100, s96
    s_add_u32 s100, s100, 90112
    s_mul_i32 s101, s34, 5120
    s_lshl_b32 s96, s35, 9
    s_add_u32 s101, s101, s96
    s_lshl_b32 s96, s62, 8
    s_add_u32 s101, s101, s96
    s_add_u32 s101, s101, 144384
L_nofrag_113:
    v_mov_b32 v8, 162068
L_lw_115:
    ds_read_b32 v9, v8
    s_waitcnt lgkmcnt(0)
    v_cmp_gt_u32 vcc, 1, v9
    s_cbranch_vccz L_lw_115e
    s_sleep 32
    s_sub_u32 s60, s60, 1
    s_cbranch_scc0 L_lw_115
    s_mov_b32 s60, 0
L_lw_115e:
    s_cmp_ge_u32 s35, 20
    s_cbranch_scc1 L_nofin_116
    s_lshl1_add_u32 s62, s35, s3
    s_sub_u32 s62, s62, 6
    s_lshl_b32 s57, s62, 7
    s_mul_i32 s63, s62, 0x199a
    s_lshr_b32 s63, s63, 16
    s_mul_i32 s63, s63, 1280
    s_sub_u32 s63, s57, s63
    v_lshrrev_b32 v72, 3, v0
    v_mul_u32_u24 v72, 5120, v72
    v_and_b32 v8, 7, v0
    v_lshl_add_u32 v72, v8, 4, v72
    s_add_u32 s62, s57, 262144
    v_add_u32 v72, s62, v72
    v_add_u32 v73, 40960, v72
    v_add_u32 v74, 81920, v72
    v_add_u32 v75, 122880, v72
    v_bfe_u32 v9, v0, 4, 1
    v_lshlrev_b32 v76, 4, v8
    v_lshl_add_u32 v76, v9, 3, v76
    s_lshl_b32 s62, s57, 1
    s_add_u32 s62, s62, 99328
    v_lshl_add_u32 v77, v76, 1, s62
    s_mov_b32 s48, s22
    s_mov_b32 s49, s23
    s_mov_b32 s50, 1280
    s_mov_b32 s51, 0x20000
    buffer_load_dwordx2 v[86:87], v76, s[48:51], s63 offen
    s_add_u32 s62, s57, 35840
    s_branch L_poll_117
L_poll_117s:
    s_sleep 32
L_poll_117:
    buffer_load_dwordx2 v[8:9], v76, s[40:43], s62 offen sc1
    s_sub_u32 s60, s60, 1
    s_cbranch_scc1 L_poll_117t
    s_waitcnt vmcnt(0)
    v_max_u32 v38, v8, v9
    v_cmp_eq_u32 vcc, -1, v38
    s_cbranch_vccnz L_poll_117s
L_poll_117e:
    v_lshlrev_b32 v78, 16, v86
    v_and_b32 v79, 0xffff0000, v86
    v_lshlrev_b32 v82, 16, v8
    v_and_b32 v83, 0xffff0000, v8
    v_lshlrev_b32 v80, 16, v87
    v_and_b32 v81, 0xffff0000, v87
    v_lshlrev_b32 v84, 16, v9
    v_and_b32 v85, 0xffff0000, v9
    v_bfe_u32 v8, v0, 1, 3
    v_and_b32 v9, 1, v0
    v_lshlrev_b32 v9, 4, v9
    v_mov_b32 v10, 0x3f80
    v_lshlrev_b32 v9, v9, v10
    v_cmp_eq_u32 vcc, 0, v8
    v_mov_b32 v100, 0
    s_nop 0
    v_cndmask_b32 v104, 0, v9, vcc
    v_cmp_eq_u32 vcc, 1, v8
    v_mov_b32 v101, 0
    s_nop 0
    v_cndmask_b32 v105, 0, v9, vcc
    v_cmp_eq_u32 vcc, 2, v8
    v_mov_b32 v102, 0
    s_nop 0
    v_cndmask_b32 v106, 0, v9, vcc
    v_cmp_eq_u32 vcc, 3, v8
    v_mov_b32 v103, 0
    s_nop 0
    v_cndmask_b32 v107, 0, v9, vcc
L_nofin_116:
    v_mov_b32 v8, 162076
L_lw_118:
    ds_read_b32 v9, v8
    s_waitcnt lgkmcnt(0)
    v_cmp_gt_u32 vcc, 4, v9
    s_cbranch_vccz L_lw_118e
    s_sleep 16
    s_sub_u32 s60, s60, 1
    s_cbranch_scc0 L_lw_118
    s_mov_b32 s60, 0
L_lw_118e:
    s_branch L_poll_119
L_poll_119s:
    s_sleep 4
L_poll_119:
    buffer_load_dwordx4 v[32:35], v20, s[40:43], s97 offen sc1
    s_sub_u32 s60, s60, 1
    s_cbranch_scc1 L_poll_119t
    s_waitcnt vmcnt(0)
    v_max3_u32 v38, v32, v33, v34
    v_max_u32 v38, v38, v35
    v_cmp_eq_u32 vcc, -1, v38
    s_cbranch_vccnz L_poll_119s
L_poll_119e:
L_pxj:
    s_cmp_ge_u32 s35, 20
    s_cbranch_scc1 L_pxk
    buffer_load_dwordx4 v[88:91], v72, s[40:43], 0 offen sc1
    buffer_load_dwordx4 v[92:95], v73, s[40:43], 0 offen sc1
    buffer_load_dwordx4 v[96:99], v74, s[40:43], 0 offen sc1
    s_mov_b64 exec, 0xffffff
    buffer_load_dwordx4 v[100:103], v75, s[40:43], 0 offen sc1
    s_mov_b64 exec, -1
L_pxk:
    v_mov_b32 v8, 162048
L_lw_120:
    ds_read_b32 v9, v8
    s_waitcnt lgkmcnt(0)
    v_cmp_gt_u32 vcc, 3, v9
    s_cbranch_vccz L_lw_120e
    s_sleep 2
    s_sub_u32 s60, s60, 1
    s_cbranch_scc0 L_lw_120
    s_mov_b32 s60, 0
L_lw_120e:
    v_lshrrev_b32 v9, 4, v0
    v_lshl_add_u32 v8, v9, 2, v2
    s_lshl_b32 s96, s3, 9
    s_add_u32 s96, s96, 157824
    v_lshl_add_u32 v8, v8, 2, s96
    v_lshlrev_b32 v9, 3, v0
    v_add_u32 v9, 157824, v9
    v_mov_b32 v10, 162048
    v_mov_b32 v11, 1
    s_lshl_b32 s96, s38, 5
    s_add_u32 s96, s96, 161984
    v_mov_b32 v3, s96
    s_sub_u32 s62, 8, s39
    s_lshl_b32 s98, s34, 5
    s_add_u32 s98, s98, s35
    s_lshl_b32 s98, s98, 8
    s_add_u32 s98, s98, 90112
    v_lshlrev_b32 v39, 2, v0
    s_branch L_t0
L_s_role:
    s_cmp_eq_u32 s3, 7
    s_cbranch_scc1 L_t2gate
    s_cmp_gt_u32 s3, 3
    s_cbranch_scc1 L_fin_prep
    s_mov_b32 s48, s18
    s_mov_b32 s49, s19
    s_mov_b32 s50, 3456
    s_mov_b32 s51, 0x20000
    v_lshrrev_b32 v3, 4, v0
    v_and_b32 v4, 15, v0
    v_lshlrev_b32 v4, 1, v4
    s_lshl_b32 s62, s35, 7
    s_lshl_b32 s63, s3, 5
    s_add_u32 s62, s62, s63
    buffer_load_ushort v82, v4, s[48:51], s62 offen
    v_mov_b32 v72, 162064
L_lw_121:
    ds_read_b32 v73, v72
    s_waitcnt lgkmcnt(0)
    v_cmp_gt_u32 vcc, 4, v73
    s_cbranch_vccz L_lw_121e
    s_sleep 2
    s_sub_u32 s60, s60, 1
    s_cbranch_scc0 L_lw_121
    s_mov_b32 s60, 0
L_lw_121e:
    v_bfe_u32 v72, v0, 2, 1
    v_bfe_u32 v73, v0, 4, 1
    v_lshl_add_u32 v72, v73, 2, v72
    v_and_b32 v73, 8, v0
    v_add_u32 v72, v72, v73
    v_lshrrev_b32 v73, 5, v0
    v_lshl_add_u32 v72, v73, 4, v72
    v_lshlrev_b32 v72, 7, v72
    v_and_b32 v73, 3, v0
    v_lshl_add_u32 v72, v73, 3, v72
    v_and_b32 v73, 8, v0
    v_lshl_add_u32 v72, v73, 3, v72
    v_xor_b32 v72, s63, v72
    v_xor_b32 v73, 32, v72
    v_add_u32 v74, 40960, v72
    v_add_u32 v75, 40960, v73
    v_bfe_u32 v1, v0, 2, 2
    v_bfe_u32 v2, v0, 1, 1
    v_and_b32 v6, 1, v0
    v_lshlrev_b32 v7, 5, v3
    v_lshl_add_u32 v7, v6, 4, v7
    v_lshl_add_u32 v5, v2, 2, v1
    v_mul_u32_u24 v5, 1296, v5
    v_add_u32 v5, v5, v7
    v_add_u32 v5, 147456, v5
    v_bfe_u32 v87, v0, 0, 1
    v_mul_u32_u24 v87, 0xaaaa, v87
    v_add_u32 v87, 0x4444, v87
    ds_read_b64_tr_b16 v[88:89], v72 offset:0
    ds_read_b64_tr_b16 v[90:91], v73 offset:256
    ds_read_b64_tr_b16 v[92:93], v72 offset:4096
    ds_read_b64_tr_b16 v[94:95], v73 offset:4352
    ds_read_b64_tr_b16 v[96:97], v72 offset:8192
    ds_read_b64_tr_b16 v[98:99], v73 offset:8448
    ds_read_b64_tr_b16 v[100:101], v72 offset:12288
    ds_read_b64_tr_b16 v[102:103], v73 offset:12544
    ds_read_b64_tr_b16 v[104:105], v72 offset:16384
    ds_read_b64_tr_b16 v[106:107], v73 offset:16640
    ds_read_b64_tr_b16 v[108:109], v72 offset:20480
    ds_read_b64_tr_b16 v[110:111], v73 offset:20736
    ds_read_b64_tr_b16 v[112:113], v72 offset:24576
    ds_read_b64_tr_b16 v[114:115], v73 offset:24832
    ds_read_b64_tr_b16 v[116:117], v72 offset:28672
    ds_read_b64_tr_b16 v[118:119], v73 offset:28928
    ds_read_b64_tr_b16 v[120:121], v72 offset:32768
    ds_read_b64_tr_b16 v[122:123], v73 offset:33024
    ds_read_b64_tr_b16 v[124:125], v72 offset:36864
    ds_read_b64_tr_b16 v[126:127], v73 offset:37120
    ds_read_b64_tr_b16 v[128:129], v74 offset:0
    ds_read_b64_tr_b16 v[130:131], v75 offset:256
    ds_read_b64_tr_b16 v[132:133], v74 offset:4096
    ds_read_b64_tr_b16 v[134:135], v75 offset:4352
    ds_read_b64_tr_b16 v[136:137], v74 offset:8192
    ds_read_b64_tr_b16 v[138:139], v75 offset:8448
    ds_read_b64_tr_b16 v[140:141], v74 offset:12288
    ds_read_b64_tr_b16 v[142:143], v75 offset:12544
    ds_read_b64_tr_b16 v[144:145], v74 offset:16384
    ds_read_b64_tr_b16 v[146:147], v75 offset:16640
    ds_read_b64_tr_b16 v[148:149], v74 offset:20480
    ds_read_b64_tr_b16 v[150:151], v75 offset:20736
    ds_read_b64_tr_b16 v[152:153], v74 offset:24576
    ds_read_b64_tr_b16 v[154:155], v75 offset:24832
    ds_read_b64_tr_b16 v[156:157], v74 offset:28672
    ds_read_b64_tr_b16 v[158:159], v75 offset:28928
    ds_read_b64_tr_b16 v[160:161], v74 offset:32768
    ds_read_b64_tr_b16 v[162:163], v75 offset:33024
    ds_read_b64_tr_b16 v[164:165], v74 offset:36864
    ds_read_b64_tr_b16 v[166:167], v75 offset:37120
    ds_read_b128 v[8:11], v5 offset:0
    ds_read_b128 v[12:15], v5 offset:128
    ds_read_b128 v[16:19], v5 offset:256
    ds_read_b128 v[20:23], v5 offset:384
    ds_read_b128 v[24:27], v5 offset:512
    ds_read_b128 v[28:31], v5 offset:640
    ds_read_b128 v[32:35], v5 offset:768
    ds_read_b128 v[36:39], v5 offset:896
    ds_read_b128 v[40:43], v5 offset:1024
    ds_read_b128 v[44:47], v5 offset:1152
    v_mov_b32 v48, 0
    v_mov_b32 v49, 0
    v_mov_b32 v50, 0
    v_mov_b32 v51, 0
    v_mov_b32 v52, 0
    v_mov_b32 v53, 0
    v_mov_b32 v54, 0
    v_mov_b32 v55, 0
    v_mov_b32 v56, 0
    v_mov_b32 v57, 0
    v_mov_b32 v58, 0
    v_mov_b32 v59, 0
    s_waitcnt lgkmcnt(9)
    v_smfmac_f32_16x16x64_bf16 v[48:51], v[8:11], v[88:95], v87
    s_waitcnt lgkmcnt(8)
    v_smfmac_f32_16x16x64_bf16 v[48:51], v[12:15], v[96:103], v87
    s_waitcnt lgkmcnt(7)
    v_smfmac_f32_16x16x64_bf16 v[48:51], v[16:19], v[104:111], v87
    s_waitcnt lgkmcnt(6)
    v_smfmac_f32_16x16x64_bf16 v[48:51], v[20:23], v[112:119], v87
    s_waitcnt lgkmcnt(5)
    v_smfmac_f32_16x16x64_bf16 v[48:51], v[24:27], v[120:127], v87
    s_waitcnt lgkmcnt(4)
    v_smfmac_f32_16x16x64_bf16 v[48:51], v[28:31], v[128:135], v87
    s_waitcnt lgkmcnt(3)
    v_smfmac_f32_16x16x64_bf16 v[48:51], v[32:35], v[136:143], v87
    s_waitcnt lgkmcnt(2)
    v_smfmac_f32_16x16x64_bf16 v[48:51], v[36:39], v[144:151], v87
    s_waitcnt lgkmcnt(1)
    v_smfmac_f32_16x16x64_bf16 v[48:51], v[40:43], v[152:159], v87
    s_waitcnt lgkmcnt(0)
    v_smfmac_f32_16x16x64_bf16 v[48:51], v[44:47], v[160:167], v87
    v_mul_u32_u24 v79, 1296, v1
    v_lshl_add_u32 v79, v2, 7, v79
    v_add_u32 v79, v79, v7
    v_add_u32 v79, 82944, v79
    v_mul_u32_u24 v80, 144, v3
    v_add3_u32 v80, v80, v4, s63
    v_add_u32 v80, 90688, v80
    v_lshlrev_b32 v81, 3, v0
    v_add_u32 v81, 88128, v81
    v_add_f32 v84, v48, v49
    v_add_f32 v85, v50, v51
    s_mov_b32 s62, 0xbacccccd
    s_mov_b32 s63, 0xbdd2d3e8
    v_mov_b32 v86, 0xc0135761
    s_waitcnt vmcnt(0)
    v_lshlrev_b32 v82, 16, v82
    v_add_f32 v85, v85, v82
    s_branch L_ffn1
L_fin_prep:
    s_cmp_lg_u32 s3, 6
    s_cbranch_scc1 L_end
    s_cmp_ge_u32 s35, 20
    s_cbranch_scc1 L_end
    s_barrier
L_fin:
    s_mov_b32 s52, s28
    s_mov_b32 s53, s29
    s_mov_b32 s54, 5120
    s_mov_b32 s55, 0x20000
    s_mov_b64 s[4:5], -1
    s_mov_b64 s[6:7], -1
    s_mov_b64 s[8:9], -1
    s_mov_b64 s[10:11], 0xffffff
    s_barrier
    ds_read_b128 v[108:111], v77
    s_barrier
L_yg:
    s_mov_b64 exec, s[4:5]
    buffer_load_dwordx4 v[88:91], v72, s[40:43], 0 offen sc1
    s_mov_b64 exec, s[6:7]
    buffer_load_dwordx4 v[92:95], v73, s[40:43], 0 offen sc1
    s_mov_b64 exec, s[8:9]
    buffer_load_dwordx4 v[96:99], v74, s[40:43], 0 offen sc1
    s_mov_b64 exec, s[10:11]
    buffer_load_dwordx4 v[100:103], v75, s[40:43], 0 offen sc1
    s_mov_b64 exec, -1
    s_sub_u32 s60, s60, 1
    s_cbranch_scc1 L_ygt
    s_waitcnt vmcnt(3)
    v_max3_u32 v3, v88, v89, v90
    v_max_u32 v3, v3, v91
    v_cmp_eq_u32 s[4:5], -1, v3
    s_waitcnt vmcnt(2)
    v_max3_u32 v3, v92, v93, v94
    v_max_u32 v3, v3, v95
    v_cmp_eq_u32 s[6:7], -1, v3
    s_waitcnt vmcnt(1)
    v_max3_u32 v3, v96, v97, v98
    v_max_u32 v3, v3, v99
    v_cmp_eq_u32 s[8:9], -1, v3
    s_waitcnt vmcnt(0)
    v_max3_u32 v3, v100, v101, v102
    v_max_u32 v3, v3, v103
    v_cmp_eq_u32 s[10:11], -1, v3
    s_or_b64 s[16:17], s[4:5], s[6:7]
    s_or_b64 s[16:17], s[16:17], s[8:9]
    s_or_b64 s[16:17], s[16:17], s[10:11]
    s_cbranch_scc1 L_yg
L_ygd:
    v_mfma_f32_16x16x32_bf16 v[112:115], v[104:107], v[88:91], 0
    v_mfma_f32_16x16x32_bf16 v[112:115], v[104:107], v[92:95], v[112:115]
    v_mfma_f32_16x16x32_bf16 v[112:115], v[104:107], v[96:99], v[112:115]
    v_mfma_f32_16x16x32_bf16 v[112:115], v[104:107], v[100:103], v[112:115]
    s_waitcnt lgkmcnt(0)
    v_pk_fma_f32 v[108:109], v[78:79], v[82:83], v[108:109]
    v_pk_fma_f32 v[110:111], v[80:81], v[84:85], v[110:111]
    s_nop 4
    v_add_f32_dpp v112, v112, v112 row_ror:8 row_mask:0xf bank_mask:0xf
    v_add_f32_dpp v113, v113, v113 row_ror:8 row_mask:0xf bank_mask:0xf
    v_add_f32_dpp v114, v114, v114 row_ror:8 row_mask:0xf bank_mask:0xf
    v_add_f32_dpp v115, v115, v115 row_ror:8 row_mask:0xf bank_mask:0xf
    v_pk_fma_f32 v[112:113], v[112:113], v[82:83], v[108:109]
    v_pk_fma_f32 v[114:115], v[114:115], v[84:85], v[110:111]
    v_cvt_pk_bf16_f32 v112, v112, v113
    v_cvt_pk_bf16_f32 v113, v114, v115
    s_mov_b64 exec, 0x00ff00ff
    buffer_store_dwordx2 v[112:113], v76, s[52:55], s57 offen
    s_endpgm
L_t2gate:
    v_mov_b32 v8, 162048
L_lw_122:
    ds_read_b32 v9, v8
    s_waitcnt lgkmcnt(0)
    v_cmp_gt_u32 vcc, 8, v9
    s_cbranch_vccz L_lw_122e
    s_sleep 2
    s_sub_u32 s60, s60, 1
    s_cbranch_scc0 L_lw_122
    s_mov_b32 s60, 0
L_lw_122e:
    ds_read_b32 v9, v8 offset:24
    s_waitcnt lgkmcnt(0)
    v_readfirstlane_b32 s61, v9
    s_mov_b32 s58, 0x3f80
    s_mov_b32 s59, 0x3f800000
    s_mov_b32 s63, 0xff
L_prb:
    s_bcnt1_i32_b32 s62, s63
    s_mov_b32 s97, s63
    s_ff1_i32_b32 s12, s97
    s_bitset0_b32 s97, s12
    s_mul_i32 s4, s12, 5120
    s_add_u32 s4, s4, 155648
    s_cmp_eq_u32 s62, 1
    s_cbranch_scc1 L_pi1
    s_ff1_i32_b32 s13, s97
    s_bitset0_b32 s97, s13
    s_mul_i32 s5, s13, 5120
    s_add_u32 s5, s5, 155648
    s_cmp_eq_u32 s62, 2
    s_cbranch_scc1 L_pi2
    s_ff1_i32_b32 s14, s97
    s_bitset0_b32 s97, s14
    s_mul_i32 s6, s14, 5120
    s_add_u32 s6, s6, 155648
    s_cmp_eq_u32 s62, 3
    s_cbranch_scc1 L_pi3
    s_ff1_i32_b32 s15, s97
    s_bitset0_b32 s97, s15
    s_mul_i32 s7, s15, 5120
    s_add_u32 s7, s7, 155648
    s_cmp_eq_u32 s62, 4
    s_cbranch_scc1 L_pi4
    s_ff1_i32_b32 s16, s97
    s_bitset0_b32 s97, s16
    s_mul_i32 s8, s16, 5120
    s_add_u32 s8, s8, 155648
    s_cmp_eq_u32 s62, 5
    s_cbranch_scc1 L_pi5
    s_ff1_i32_b32 s17, s97
    s_bitset0_b32 s97, s17
    s_mul_i32 s9, s17, 5120
    s_add_u32 s9, s9, 155648
    s_cmp_eq_u32 s62, 6
    s_cbranch_scc1 L_pi6
    s_ff1_i32_b32 s18, s97
    s_bitset0_b32 s97, s18
    s_mul_i32 s10, s18, 5120
    s_add_u32 s10, s10, 155648
    s_cmp_eq_u32 s62, 7
    s_cbranch_scc1 L_pi7
    s_ff1_i32_b32 s19, s97
    s_bitset0_b32 s97, s19
    s_mul_i32 s11, s19, 5120
    s_add_u32 s11, s11, 155648
L_pi8:
    buffer_load_dwordx4 v[36:39], v5, s[40:43], s11 offen sc1
L_pi7:
    buffer_load_dwordx4 v[32:35], v5, s[40:43], s10 offen sc1
L_pi6:
    buffer_load_dwordx4 v[28:31], v5, s[40:43], s9 offen sc1
L_pi5:
    buffer_load_dwordx4 v[24:27], v5, s[40:43], s8 offen sc1
L_pi4:
    buffer_load_dwordx4 v[20:23], v5, s[40:43], s7 offen sc1
L_pi3:
    buffer_load_dwordx4 v[16:19], v5, s[40:43], s6 offen sc1
L_pi2:
    buffer_load_dwordx4 v[12:15], v5, s[40:43], s5 offen sc1
    buffer_load_dwordx4 v[8:11], v5, s[40:43], s4 offen sc1
    s_sub_u32 s60, s60, 1
    s_cbranch_scc1 L_pto
    s_waitcnt vmcnt(0)
    v_max3_u32 v3, v8, v9, v10
    v_max_u32 v3, v3, v11
    v_cmp_eq_u32 vcc, -1, v3
    s_cbranch_vccz L_pgot0
    v_max3_u32 v3, v12, v13, v14
    v_max_u32 v3, v3, v15
    v_cmp_eq_u32 vcc, -1, v3
    s_cbranch_vccz L_pgot1
    s_cmp_eq_u32 s62, 2
    s_cbranch_scc1 L_pi2
    v_max3_u32 v3, v16, v17, v18
    v_max_u32 v3, v3, v19
    v_cmp_eq_u32 vcc, -1, v3
    s_cbranch_vccz L_pgot2
    s_cmp_eq_u32 s62, 3
    s_cbranch_scc1 L_pi3
    v_max3_u32 v3, v20, v21, v22
    v_max_u32 v3, v3, v23
    v_cmp_eq_u32 vcc, -1, v3
    s_cbranch_vccz L_pgot3
    s_cmp_eq_u32 s62, 4
    s_cbranch_scc1 L_pi4
    v_max3_u32 v3, v24, v25, v26
    v_max_u32 v3, v3, v27
    v_cmp_eq_u32 vcc, -1, v3
    s_cbranch_vccz L_pgot4
    s_cmp_eq_u32 s62, 5
    s_cbranch_scc1 L_pi5
    v_max3_u32 v3, v28, v29, v30
    v_max_u32 v3, v3, v31
    v_cmp_eq_u32 vcc, -1, v3
    s_cbranch_vccz L_pgot5
    s_cmp_eq_u32 s62, 6
    s_cbranch_scc1 L_pi6
    v_max3_u32 v3, v32, v33, v34
    v_max_u32 v3, v3, v35
    v_cmp_eq_u32 vcc, -1, v3
    s_cbranch_vccz L_pgot6
    s_cmp_eq_u32 s62, 7
    s_cbranch_scc1 L_pi7
    v_max3_u32 v3, v36, v37, v38
    v_max_u32 v3, v3, v39
    v_cmp_eq_u32 vcc, -1, v3
    s_cbranch_vccz L_pgot7
    s_branch L_pi8
L_pgot0:
    v_dot2c_f32_bf16 v64, s58, v8
    v_dot2c_f32_bf16 v65, s59, v8
    v_dot2c_f32_bf16 v66, s58, v9
    v_dot2c_f32_bf16 v67, s59, v9
    v_dot2c_f32_bf16 v68, s58, v10
    v_dot2c_f32_bf16 v69, s59, v10
    v_dot2c_f32_bf16 v70, s58, v11
    v_dot2c_f32_bf16 v71, s59, v11
    s_bitset0_b32 s63, s12
    s_cmp_eq_u32 s63, 0
    s_cbranch_scc1 L_pgd
L_pn0:
    s_cmp_eq_u32 s62, 1
    s_cbranch_scc1 L_prb
    v_max3_u32 v3, v12, v13, v14
    v_max_u32 v3, v3, v15
    v_cmp_eq_u32 vcc, -1, v3
    s_cbranch_vccnz L_pn1
L_pgot1:
    v_dot2c_f32_bf16 v64, s58, v12
    v_dot2c_f32_bf16 v65, s59, v12
    v_dot2c_f32_bf16 v66, s58, v13
    v_dot2c_f32_bf16 v67, s59, v13
    v_dot2c_f32_bf16 v68, s58, v14
    v_dot2c_f32_bf16 v69, s59, v14
    v_dot2c_f32_bf16 v70, s58, v15
    v_dot2c_f32_bf16 v71, s59, v15
    s_bitset0_b32 s63, s13
    s_cmp_eq_u32 s63, 0
    s_cbranch_scc1 L_pgd
L_pn1:
    s_cmp_eq_u32 s62, 2
    s_cbranch_scc1 L_prb
    v_max3_u32 v3, v16, v17, v18
    v_max_u32 v3, v3, v19
    v_cmp_eq_u32 vcc, -1, v3
    s_cbranch_vccnz L_pn2
L_pgot2:
    v_dot2c_f32_bf16 v64, s58, v16
    v_dot2c_f32_bf16 v65, s59, v16
    v_dot2c_f32_bf16 v66, s58, v17
    v_dot2c_f32_bf16 v67, s59, v17
    v_dot2c_f32_bf16 v68, s58, v18
    v_dot2c_f32_bf16 v69, s59, v18
    v_dot2c_f32_bf16 v70, s58, v19
    v_dot2c_f32_bf16 v71, s59, v19
    s_bitset0_b32 s63, s14
    s_cmp_eq_u32 s63, 0
    s_cbranch_scc1 L_pgd
L_pn2:
    s_cmp_eq_u32 s62, 3
    s_cbranch_scc1 L_prb
    v_max3_u32 v3, v20, v21, v22
    v_max_u32 v3, v3, v23
    v_cmp_eq_u32 vcc, -1, v3
    s_cbranch_vccnz L_pn3
L_pgot3:
    v_dot2c_f32_bf16 v64, s58, v20
    v_dot2c_f32_bf16 v65, s59, v20
    v_dot2c_f32_bf16 v66, s58, v21
    v_dot2c_f32_bf16 v67, s59, v21
    v_dot2c_f32_bf16 v68, s58, v22
    v_dot2c_f32_bf16 v69, s59, v22
    v_dot2c_f32_bf16 v70, s58, v23
    v_dot2c_f32_bf16 v71, s59, v23
    s_bitset0_b32 s63, s15
    s_cmp_eq_u32 s63, 0
    s_cbranch_scc1 L_pgd
L_pn3:
    s_cmp_eq_u32 s62, 4
    s_cbranch_scc1 L_prb
    v_max3_u32 v3, v24, v25, v26
    v_max_u32 v3, v3, v27
    v_cmp_eq_u32 vcc, -1, v3
    s_cbranch_vccnz L_pn4
L_pgot4:
    v_dot2c_f32_bf16 v64, s58, v24
    v_dot2c_f32_bf16 v65, s59, v24
    v_dot2c_f32_bf16 v66, s58, v25
    v_dot2c_f32_bf16 v67, s59, v25
    v_dot2c_f32_bf16 v68, s58, v26
    v_dot2c_f32_bf16 v69, s59, v26
    v_dot2c_f32_bf16 v70, s58, v27
    v_dot2c_f32_bf16 v71, s59, v27
    s_bitset0_b32 s63, s16
    s_cmp_eq_u32 s63, 0
    s_cbranch_scc1 L_pgd
L_pn4:
    s_cmp_eq_u32 s62, 5
    s_cbranch_scc1 L_prb
    v_max3_u32 v3, v28, v29, v30
    v_max_u32 v3, v3, v31
    v_cmp_eq_u32 vcc, -1, v3
    s_cbranch_vccnz L_pn5
L_pgot5:
    v_dot2c_f32_bf16 v64, s58, v28
    v_dot2c_f32_bf16 v65, s59, v28
    v_dot2c_f32_bf16 v66, s58, v29
    v_dot2c_f32_bf16 v67, s59, v29
    v_dot2c_f32_bf16 v68, s58, v30
    v_dot2c_f32_bf16 v69, s59, v30
    v_dot2c_f32_bf16 v70, s58, v31
    v_dot2c_f32_bf16 v71, s59, v31
    s_bitset0_b32 s63, s17
    s_cmp_eq_u32 s63, 0
    s_cbranch_scc1 L_pgd
L_pn5:
    s_cmp_eq_u32 s62, 6
    s_cbranch_scc1 L_prb
    v_max3_u32 v3, v32, v33, v34
    v_max_u32 v3, v3, v35
    v_cmp_eq_u32 vcc, -1, v3
    s_cbranch_vccnz L_pn6
L_pgot6:
    v_dot2c_f32_bf16 v64, s58, v32
    v_dot2c_f32_bf16 v65, s59, v32
    v_dot2c_f32_bf16 v66, s58, v33
    v_dot2c_f32_bf16 v67, s59, v33
    v_dot2c_f32_bf16 v68, s58, v34
    v_dot2c_f32_bf16 v69, s59, v34
    v_dot2c_f32_bf16 v70, s58, v35
    v_dot2c_f32_bf16 v71, s59, v35
    s_bitset0_b32 s63, s18
    s_cmp_eq_u32 s63, 0
    s_cbranch_scc1 L_pgd
L_pn6:
    s_cmp_eq_u32 s62, 7
    s_cbranch_scc1 L_prb
    v_max3_u32 v3, v36, v37, v38
    v_max_u32 v3, v3, v39
    v_cmp_eq_u32 vcc, -1, v3
    s_cbranch_vccnz L_pn7
L_pgot7:
    v_dot2c_f32_bf16 v64, s58, v36
    v_dot2c_f32_bf16 v65, s59, v36
    v_dot2c_f32_bf16 v66, s58, v37
    v_dot2c_f32_bf16 v67, s59, v37
    v_dot2c_f32_bf16 v68, s58, v38
    v_dot2c_f32_bf16 v69, s59, v38
    v_dot2c_f32_bf16 v70, s58, v39
    v_dot2c_f32_bf16 v71, s59, v39
    s_bitset0_b32 s63, s19
    s_cmp_eq_u32 s63, 0
    s_cbranch_scc1 L_pgd
L_pn7:
    s_branch L_prb
L_pi1:
L_poll_123:
    buffer_load_dwordx4 v[8:11], v5, s[40:43], s4 offen sc1
    s_sub_u32 s60, s60, 1
    s_cbranch_scc1 L_poll_123t
    s_waitcnt vmcnt(0)
    v_max3_u32 v3, v8, v9, v10
    v_max_u32 v3, v3, v11
    v_cmp_eq_u32 vcc, -1, v3
    s_cbranch_vccnz L_poll_123
L_poll_123e:
    v_dot2c_f32_bf16 v64, s58, v8
    v_dot2c_f32_bf16 v65, s59, v8
    v_dot2c_f32_bf16 v66, s58, v9
    v_dot2c_f32_bf16 v67, s59, v9
    v_dot2c_f32_bf16 v68, s58, v10
    v_dot2c_f32_bf16 v69, s59, v10
    v_dot2c_f32_bf16 v70, s58, v11
    v_dot2c_f32_bf16 v71, s59, v11
L_pgd:
    v_pk_fma_f32 v[64:65], v[64:65], v[48:49], v[40:41]
    v_pk_fma_f32 v[66:67], v[66:67], v[50:51], v[42:43]
    v_pk_fma_f32 v[68:69], v[68:69], v[52:53], v[44:45]
    v_pk_fma_f32 v[70:71], v[70:71], v[54:55], v[46:47]
    v_pk_mul_f32 v[56:57], v[64:65], v[56:57]
    v_pk_mul_f32 v[58:59], v[66:67], v[58:59]
    v_pk_mul_f32 v[60:61], v[68:69], v[60:61]
    v_pk_mul_f32 v[62:63], v[70:71], v[62:63]
    v_cvt_pk_bf16_f32 v8, v56, v57
    v_cvt_pk_bf16_f32 v9, v58, v59
    v_cvt_pk_bf16_f32 v10, v60, v61
    v_cvt_pk_bf16_f32 v11, v62, v63
    ds_write_b128 v4, v[8:11]
    v_pk_add_f32 v[40:41], v[64:65], v[66:67]
    v_pk_add_f32 v[42:43], v[68:69], v[70:71]
    v_pk_mul_f32 v[44:45], v[64:65], v[64:65]
    v_pk_mul_f32 v[46:47], v[66:67], v[66:67]
    v_pk_add_f32 v[40:41], v[40:41], v[42:43]
    v_pk_fma_f32 v[44:45], v[68:69], v[68:69], v[44:45]
    v_pk_fma_f32 v[46:47], v[70:71], v[70:71], v[46:47]
    v_add_f32 v40, v40, v41
    v_pk_add_f32 v[44:45], v[44:45], v[46:47]
    v_add_f32 v41, v44, v45
    ds_write_b64 v7, v[40:41]
    s_waitcnt lgkmcnt(0)
    s_barrier
    ds_write_b128 v6, v[64:67]
    ds_write_b128 v6, v[68:71] offset:16
    s_waitcnt lgkmcnt(0)
    s_cmp_lg_u32 s3, 7
    s_cbranch_scc1 L_ffn2
    s_cmp_lt_u32 s35, 20
    s_cbranch_scc1 L_fin
    s_endpgm
L_ffn1:
    s_barrier
    ds_read_b128 v[8:11], v79
    ds_read_b64 v[30:31], v81 offset:0
    ds_read_b64 v[32:33], v81 offset:512
    ds_read_b64 v[34:35], v81 offset:1024
    ds_read_b64 v[36:37], v81 offset:1536
    ds_read_b64 v[38:39], v81 offset:2048
    ds_read_b128 v[12:15], v79 offset:256
    ds_read_b128 v[16:19], v79 offset:512
    ds_read_b128 v[20:23], v79 offset:768
    ds_read_b128 v[24:27], v79 offset:1024
    s_waitcnt lgkmcnt(9)
    v_smfmac_f32_16x16x64_bf16 v[52:55], v[8:11], v[88:95], v87
    v_smfmac_f32_16x16x64_bf16 v[56:59], v[8:11], v[96:103], v87
    s_waitcnt lgkmcnt(3)
    v_smfmac_f32_16x16x64_bf16 v[52:55], v[12:15], v[104:111], v87
    v_pk_add_f32 v[30:31], v[30:31], v[32:33]
    v_pk_add_f32 v[34:35], v[34:35], v[36:37]
    v_smfmac_f32_16x16x64_bf16 v[56:59], v[12:15], v[112:119], v87
    v_pk_add_f32 v[30:31], v[30:31], v[38:39]
    v_pk_add_f32 v[30:31], v[30:31], v[34:35]
    s_nop 0
    s_waitcnt lgkmcnt(2)
    v_smfmac_f32_16x16x64_bf16 v[52:55], v[16:19], v[120:127], v87
    v_add_f32_dpp v30, v30, v30 quad_perm:[1,0,3,2] row_mask:0xf bank_mask:0xf
    v_add_f32_dpp v31, v31, v31 quad_perm:[1,0,3,2] row_mask:0xf bank_mask:0xf
    v_smfmac_f32_16x16x64_bf16 v[56:59], v[16:19], v[128:135], v87
    v_add_f32_dpp v30, v30, v30 quad_perm:[2,3,0,1] row_mask:0xf bank_mask:0xf
    v_add_f32_dpp v31, v31, v31 quad_perm:[2,3,0,1] row_mask:0xf bank_mask:0xf
    s_waitcnt lgkmcnt(1)
    v_smfmac_f32_16x16x64_bf16 v[52:55], v[20:23], v[136:143], v87
    v_add_f32_dpp v30, v30, v30 row_ror:4 row_mask:0xf bank_mask:0xf
    v_add_f32_dpp v31, v31, v31 row_ror:4 row_mask:0xf bank_mask:0xf
    v_smfmac_f32_16x16x64_bf16 v[56:59], v[20:23], v[144:151], v87
    v_add_f32_dpp v30, v30, v30 row_ror:8 row_mask:0xf bank_mask:0xf
    v_add_f32_dpp v31, v31, v31 row_ror:8 row_mask:0xf bank_mask:0xf
    s_waitcnt lgkmcnt(0)
    v_smfmac_f32_16x16x64_bf16 v[52:55], v[24:27], v[152:159], v87
    v_mul_f32 v48, s62, v30
    v_mul_f32 v49, s62, v31
    v_smfmac_f32_16x16x64_bf16 v[56:59], v[24:27], v[160:167], v87
    v_mul_f32 v7, v84, v48
    v_fma_f32 v49, -v48, v48, -v49
    v_max_f32 v49, 0, v49
    v_add_f32 v49, 0x3727c5ac, v49
    v_rsq_f32 v49, v49
    v_add_f32 v4, v52, v53
    v_add_f32 v4, v4, v7
    s_nop 0
    v_add_f32 v5, v58, v59
    v_add_f32 v4, v4, v5
    v_fma_f32 v4, v4, v49, v85
    v_mul_f32 v5, v4, v4
    v_fma_f32 v5, v5, s63, v86
    v_mul_f32 v5, v5, v4
    v_exp_f32 v5, v5
    s_nop 0
    v_add_f32 v5, 1.0, v5
    v_rcp_f32 v5, v5
    s_nop 0
    v_mul_f32 v4, v4, v5
    v_cvt_pk_bf16_f32 v4, v4, v4
    ds_write_b16 v80, v4
    s_waitcnt lgkmcnt(0)
    s_barrier
    s_endpgm
L_h_t1:
    s_cmp_lg_u32 s3, 3
    s_cbranch_scc1 L_h_noclr
    s_sub_u32 s62, s56, 154
    s_cmp_lt_u32 s62, 30
    s_cbranch_scc0 L_h_noclr
    s_lshl_b32 s63, s62, 2
    s_mul_i32 s62, s62, 7168
    s_add_u32 s62, s62, 20480
    v_mov_b32 v4, -1
    v_mov_b32 v5, -1
    v_mov_b32 v6, -1
    v_mov_b32 v7, -1
    v_lshlrev_b32 v8, 4, v0
    buffer_store_dwordx4 v[4:7], v8, s[40:43], s62 offen offset:0 sc1
    buffer_store_dwordx4 v[4:7], v8, s[40:43], s62 offen offset:1024 sc1
    buffer_store_dwordx4 v[4:7], v8, s[40:43], s62 offen offset:2048 sc1
    buffer_store_dwordx4 v[4:7], v8, s[40:43], s62 offen offset:3072 sc1
    s_add_u32 s62, s62, 4096
    buffer_store_dwordx4 v[4:7], v8, s[40:43], s62 offen offset:0 sc1
    buffer_store_dwordx4 v[4:7], v8, s[40:43], s62 offen offset:1024 sc1
    buffer_store_dwordx4 v[4:7], v8, s[40:43], s62 offen offset:2048 sc1
    v_mov_b32 v8, s63
    s_waitcnt vmcnt(0)
    s_mov_b64 exec, 1
    buffer_store_dword v4, v8, s[44:47], 0 offen sc1
    s_mov_b64 exec, -1
L_h_noclr:
    v_lshrrev_b32 v1, 3, v0
    v_mul_u32_u24 v1, 1280, v1
    v_and_b32 v2, 7, v0
    v_lshl_add_u32 v1, v2, 4, v1
    s_lshl2_add_u32 s63, s34, s3
    s_mul_i32 s63, s63, 163840
    s_lshl_b32 s62, s35, 7
    s_add_u32 s63, s63, s62
    s_sub_u32 s63, s63, 2816
    s_lshl_b32 s62, s3, 14
    s_add_u32 s62, s62, 81920
    s_mov_b32 m0, s62
    s_mov_b32 s48, s12
    s_mov_b32 s49, s13
    s_mov_b32 s50, 5242880
    s_mov_b32 s51, 0x20000
    s_add_u32 s100, s39, 1
    s_mov_b32 s62, 8
L_dma_5:
    buffer_load_dwordx4 v1, s[48:51], s63 offen nt lds
    s_add_u32 m0, m0, 1024
    s_add_u32 s63, s63, 10240
    s_cmp_eq_u32 s100, 0
    s_cbranch_scc1 L_dma_5n0
    s_waitcnt vmcnt(7)
    s_cmp_eq_u32 s100, 2
    s_cbranch_scc1 L_dma_5n0
    s_waitcnt vmcnt(3)
L_dma_5n0:
    buffer_load_dwordx4 v1, s[48:51], s63 offen nt lds
    s_add_u32 m0, m0, 1024
    s_add_u32 s63, s63, 10240
    s_cmp_eq_u32 s100, 0
    s_cbranch_scc1 L_dma_5n1
    s_waitcnt vmcnt(7)
    s_cmp_eq_u32 s100, 2
    s_cbranch_scc1 L_dma_5n1
    s_waitcnt vmcnt(3)
L_dma_5n1:
    s_sub_u32 s62, s62, 1
    s_cmp_lg_u32 s62, 0
    s_cbranch_scc1 L_dma_5
    s_cmp_eq_u32 s39, 1
    s_cbranch_scc1 L_h_role
    s_waitcnt vmcnt(0)
    v_mov_b32 v4, 162060
    v_mov_b32 v5, 1
    s_mov_b64 exec, 1
    ds_add_u32 v4, v5
    s_mov_b64 exec, -1
    s_cmp_eq_u32 s3, 0
    s_cbranch_scc1 L_service
    s_endpgm
L_h_role:
    v_mov_b32 v72, 0
    v_mov_b32 v73, 0
    v_mov_b32 v74, 0
    v_mov_b32 v75, 0
    v_mov_b32 v76, 0
    v_lshrrev_b32 v3, 4, v0
    v_and_b32 v2, 3, v0
    v_bfe_u32 v1, v0, 2, 2
    v_mul_u32_u24 v160, 1280, v3
    v_and_b32 v4, 15, v0
    v_lshl_add_u32 v163, v4, 2, v160
    v_lshl_add_u32 v160, v4, 3, v160
    s_mul_i32 s57, s35, 5120
    s_mul_i32 s62, s3, 320
    s_add_u32 s57, s57, s62
    s_add_u32 s57, s57, 262144
    v_mov_b32 v4, -1
    v_mov_b32 v5, -1
    v_mov_b32 v6, -1
    v_mov_b32 v7, -1
    v_lshlrev_b32 v8, 4, v0
    s_mul_i32 s62, s3, 960
    s_add_u32 s62, s62, s57
    buffer_store_dwordx4 v[4:7], v8, s[40:43], s62 offen sc1
    s_mov_b64 exec, 0xffff
    buffer_store_dwordx4 v[4:7], v8, s[40:43], s62 offen offset:1024 sc1
    s_mov_b64 exec, -1
    v_add_u32 v8, 0, v0
    v_mul_u32_u24 v10, 0xccd, v8
    v_lshrrev_b32 v10, 16, v10
    v_mul_u32_u24 v9, 20, v10
    v_sub_u32 v8, v8, v9
    v_mul_u32_u24 v10, 1280, v10
    v_lshl_add_u32 v10, v8, 4, v10
    v_add_u32 v8, 64, v0
    v_mul_u32_u24 v11, 0xccd, v8
    v_lshrrev_b32 v11, 16, v11
    v_mul_u32_u24 v9, 20, v11
    v_sub_u32 v8, v8, v9
    v_mul_u32_u24 v11, 1280, v11
    v_lshl_add_u32 v11, v8, 4, v11
    v_add_u32 v8, 128, v0
    v_mul_u32_u24 v12, 0xccd, v8
    v_lshrrev_b32 v12, 16, v12
    v_mul_u32_u24 v9, 20, v12
    v_sub_u32 v8, v8, v9
    v_mul_u32_u24 v12, 1280, v12
    v_lshl_add_u32 v12, v8, 4, v12
    v_add_u32 v8, 192, v0
    v_mul_u32_u24 v13, 0xccd, v8
    v_lshrrev_b32 v13, 16, v13
    v_mul_u32_u24 v9, 20, v13
    v_sub_u32 v8, v8, v9
    v_mul_u32_u24 v13, 1280, v13
    v_lshl_add_u32 v13, v8, 4, v13
    v_add_u32 v8, 256, v0
    v_mul_u32_u24 v14, 0xccd, v8
    v_lshrrev_b32 v14, 16, v14
    v_mul_u32_u24 v9, 20, v14
    v_sub_u32 v8, v8, v9
    v_mul_u32_u24 v14, 1280, v14
    v_lshl_add_u32 v14, v8, 4, v14
    s_waitcnt vmcnt(0)
    v_mov_b32 v8, 162060
    v_mov_b32 v9, 1
    s_mov_b64 exec, 1
    ds_add_u32 v8, v9
    s_mov_b64 exec, -1
    s_mov_b32 s48, s20
    s_mov_b32 s49, s21
    s_mov_b32 s50, 2211840
    s_mov_b32 s51, 0x20000
    s_mul_i32 s63, s35, 81920
    s_mul_i32 s62, s3, 320
    s_add_u32 s63, s63, s62
    s_mov_b32 m0, s101
    s_mov_b32 s62, 4
L_w2dma:
    buffer_load_dwordx4 v10, s[48:51], s63 offen nt lds
    s_add_u32 m0, m0, 1024
    s_waitcnt vmcnt(7)
    s_cmp_ge_u32 s35, 22
    s_cbranch_scc1 L_w2n0
    s_waitcnt vmcnt(7)
L_w2n0:
    buffer_load_dwordx4 v11, s[48:51], s63 offen nt lds
    s_add_u32 m0, m0, 1024
    s_waitcnt vmcnt(7)
    s_cmp_ge_u32 s35, 22
    s_cbranch_scc1 L_w2n1
    s_waitcnt vmcnt(7)
L_w2n1:
    buffer_load_dwordx4 v12, s[48:51], s63 offen nt lds
    s_add_u32 m0, m0, 1024
    s_waitcnt vmcnt(7)
    s_cmp_ge_u32 s35, 22
    s_cbranch_scc1 L_w2n2
    s_waitcnt vmcnt(7)
L_w2n2:
    buffer_load_dwordx4 v13, s[48:51], s63 offen nt lds
    s_add_u32 m0, m0, 1024
    s_waitcnt vmcnt(7)
    s_cmp_ge_u32 s35, 22
    s_cbranch_scc1 L_w2n3
    s_waitcnt vmcnt(7)
L_w2n3:
    buffer_load_dwordx4 v14, s[48:51], s63 offen nt lds
    s_add_u32 m0, m0, 1024
    s_waitcnt vmcnt(7)
    s_cmp_ge_u32 s35, 22
    s_cbranch_scc1 L_w2n4
    s_waitcnt vmcnt(7)
L_w2n4:
    s_add_u32 s63, s63, 20480
    s_sub_u32 s62, s62, 1
    s_cmp_lg_u32 s62, 0
    s_cbranch_scc1 L_w2dma
    v_lshrrev_b32 v8, 5, v0
    v_lshlrev_b32 v8, 2, v8
    v_bfe_u32 v9, v0, 4, 1
    v_add_u32 v8, v8, v9
    v_mul_u32_u24 v8, 1280, v8
    v_add_u32 v8, s101, v8
    v_and_b32 v10, 15, v0
    v_lshl_add_u32 v9, v10, 2, v8
    v_lshl_add_u32 v8, v10, 3, v8
    s_mov_b32 s62, 0x05040100
    s_mov_b32 s63, 0x07060302
    s_waitcnt vmcnt(0)
    ds_read_b64 v[16:17], v8 offset:0
    ds_read_b64 v[18:19], v8 offset:320
    ds_read_b64 v[20:21], v8 offset:2560
    ds_read_b64 v[22:23], v8 offset:2880
    ds_read_b64 v[24:25], v8 offset:640
    ds_read_b64 v[26:27], v8 offset:960
    ds_read_b64 v[28:29], v8 offset:3200
    ds_read_b64 v[30:31], v8 offset:3520
    ds_read_b64 v[32:33], v8 offset:10240
    ds_read_b64 v[34:35], v8 offset:10560
    ds_read_b64 v[36:37], v8 offset:12800
    ds_read_b64 v[38:39], v8 offset:13120
    ds_read_b64 v[40:41], v8 offset:10880
    ds_read_b64 v[42:43], v8 offset:11200
    ds_read_b64 v[44:45], v8 offset:13440
    ds_read_b64 v[46:47], v8 offset:13760
    s_waitcnt lgkmcnt(0)
    v_perm_b32 v80, v18, v16, s62
    v_perm_b32 v88, v18, v16, s63
    v_perm_b32 v96, v19, v17, s62
    v_perm_b32 v104, v19, v17, s63
    v_perm_b32 v81, v22, v20, s62
    v_perm_b32 v89, v22, v20, s63
    v_perm_b32 v97, v23, v21, s62
    v_perm_b32 v105, v23, v21, s63
    v_perm_b32 v82, v26, v24, s62
    v_perm_b32 v90, v26, v24, s63
    v_perm_b32 v98, v27, v25, s62
    v_perm_b32 v106, v27, v25, s63
    v_perm_b32 v83, v30, v28, s62
    v_perm_b32 v91, v30, v28, s63
    v_perm_b32 v99, v31, v29, s62
    v_perm_b32 v107, v31, v29, s63
    v_perm_b32 v84, v34, v32, s62
    v_perm_b32 v92, v34, v32, s63
    v_perm_b32 v100, v35, v33, s62
    v_perm_b32 v108, v35, v33, s63
    v_perm_b32 v85, v38, v36, s62
    v_perm_b32 v93, v38, v36, s63
    v_perm_b32 v101, v39, v37, s62
    v_perm_b32 v109, v39, v37, s63
    v_perm_b32 v86, v42, v40, s62
    v_perm_b32 v94, v42, v40, s63
    v_perm_b32 v102, v43, v41, s62
    v_perm_b32 v110, v43, v41, s63
    v_perm_b32 v87, v46, v44, s62
    v_perm_b32 v95, v46, v44, s63
    v_perm_b32 v103, v47, v45, s62
    v_perm_b32 v111, v47, v45, s63
    ds_read_b64 v[16:17], v8 offset:128
    ds_read_b64 v[18:19], v8 offset:448
    ds_read_b64 v[20:21], v8 offset:2688
    ds_read_b64 v[22:23], v8 offset:3008
    ds_read_b64 v[24:25], v8 offset:768
    ds_read_b64 v[26:27], v8 offset:1088
    ds_read_b64 v[28:29], v8 offset:3328
    ds_read_b64 v[30:31], v8 offset:3648
    ds_read_b64 v[32:33], v8 offset:10368
    ds_read_b64 v[34:35], v8 offset:10688
    ds_read_b64 v[36:37], v8 offset:12928
    ds_read_b64 v[38:39], v8 offset:13248
    ds_read_b64 v[40:41], v8 offset:11008
    ds_read_b64 v[42:43], v8 offset:11328
    ds_read_b64 v[44:45], v8 offset:13568
    ds_read_b64 v[46:47], v8 offset:13888
    s_waitcnt lgkmcnt(0)
    v_perm_b32 v112, v18, v16, s62
    v_perm_b32 v120, v18, v16, s63
    v_perm_b32 v128, v19, v17, s62
    v_perm_b32 v136, v19, v17, s63
    v_perm_b32 v113, v22, v20, s62
    v_perm_b32 v121, v22, v20, s63
    v_perm_b32 v129, v23, v21, s62
    v_perm_b32 v137, v23, v21, s63
    v_perm_b32 v114, v26, v24, s62
    v_perm_b32 v122, v26, v24, s63
    v_perm_b32 v130, v27, v25, s62
    v_perm_b32 v138, v27, v25, s63
    v_perm_b32 v115, v30, v28, s62
    v_perm_b32 v123, v30, v28, s63
    v_perm_b32 v131, v31, v29, s62
    v_perm_b32 v139, v31, v29, s63
    v_perm_b32 v116, v34, v32, s62
    v_perm_b32 v124, v34, v32, s63
    v_perm_b32 v132, v35, v33, s62
    v_perm_b32 v140, v35, v33, s63
    v_perm_b32 v117, v38, v36, s62
    v_perm_b32 v125, v38, v36, s63
    v_perm_b32 v133, v39, v37, s62
    v_perm_b32 v141, v39, v37, s63
    v_perm_b32 v118, v42, v40, s62
    v_perm_b32 v126, v42, v40, s63
    v_perm_b32 v134, v43, v41, s62
    v_perm_b32 v142, v43, v41, s63
    v_perm_b32 v119, v46, v44, s62
    v_perm_b32 v127, v46, v44, s63
    v_perm_b32 v135, v47, v45, s62
    v_perm_b32 v143, v47, v45, s63
    ds_read_b32 v16, v9 offset:256
    ds_read_b32 v18, v9 offset:576
    ds_read_b32 v20, v9 offset:2816
    ds_read_b32 v22, v9 offset:3136
    ds_read_b32 v24, v9 offset:896
    ds_read_b32 v26, v9 offset:1216
    ds_read_b32 v28, v9 offset:3456
    ds_read_b32 v30, v9 offset:3776
    ds_read_b32 v32, v9 offset:10496
    ds_read_b32 v34, v9 offset:10816
    ds_read_b32 v36, v9 offset:13056
    ds_read_b32 v38, v9 offset:13376
    ds_read_b32 v40, v9 offset:11136
    ds_read_b32 v42, v9 offset:11456
    ds_read_b32 v44, v9 offset:13696
    ds_read_b32 v46, v9 offset:14016
    s_waitcnt lgkmcnt(0)
    v_perm_b32 v144, v18, v16, s62
    v_perm_b32 v152, v18, v16, s63
    v_perm_b32 v145, v22, v20, s62
    v_perm_b32 v153, v22, v20, s63
    v_perm_b32 v146, v26, v24, s62
    v_perm_b32 v154, v26, v24, s63
    v_perm_b32 v147, v30, v28, s62
    v_perm_b32 v155, v30, v28, s63
    v_perm_b32 v148, v34, v32, s62
    v_perm_b32 v156, v34, v32, s63
    v_perm_b32 v149, v38, v36, s62
    v_perm_b32 v157, v38, v36, s63
    v_perm_b32 v150, v42, v40, s62
    v_perm_b32 v158, v42, v40, s63
    v_perm_b32 v151, v46, v44, s62
    v_perm_b32 v159, v46, v44, s63
    s_mov_b32 s48, s16
    s_mov_b32 s49, s17
    s_mov_b32 s50, 2211840
    s_mov_b32 s51, 0x20000
    s_lshl_b32 s98, s35, 7
    s_mov_b32 s99, 3456
    v_lshrrev_b32 v9, 3, v0
    v_mul_lo_u32 v10, v9, s99
    v_and_b32 v9, 2, v9
    v_xor_b32 v9, v9, v0
    v_and_b32 v9, 7, v9
    v_lshl_add_u32 v10, v9, 4, v10
    v_add_u32 v10, s98, v10
    v_xor_b32 v11, 64, v10
    s_mul_i32 s63, s3, 552960
    s_mov_b32 m0, s101
    s_waitcnt lgkmcnt(0)
    s_cmp_ge_u32 s35, 22
    s_cselect_b32 s100, 2, 1
    s_mov_b32 s62, 10
L_dma_6:
    buffer_load_dwordx4 v10, s[48:51], s63 offen nt lds
    s_add_u32 m0, m0, 1024
    s_add_u32 s63, s63, 27648
    s_cmp_eq_u32 s100, 0
    s_cbranch_scc1 L_dma_6n0
    s_waitcnt vmcnt(7)
    s_cmp_eq_u32 s100, 2
    s_cbranch_scc1 L_dma_6n0
    s_waitcnt vmcnt(7)
L_dma_6n0:
    buffer_load_dwordx4 v11, s[48:51], s63 offen nt lds
    s_add_u32 m0, m0, 1024
    s_add_u32 s63, s63, 27648
    s_cmp_eq_u32 s100, 0
    s_cbranch_scc1 L_dma_6n1
    s_waitcnt vmcnt(7)
    s_cmp_eq_u32 s100, 2
    s_cbranch_scc1 L_dma_6n1
    s_waitcnt vmcnt(7)
L_dma_6n1:
    s_sub_u32 s62, s62, 1
    s_cmp_lg_u32 s62, 0
    s_cbranch_scc1 L_dma_6
    v_mov_b32 v8, 162068
L_lw_7:
    ds_read_b32 v9, v8
    s_waitcnt lgkmcnt(0)
    v_cmp_gt_u32 vcc, 1, v9
    s_cbranch_vccz L_lw_7e
    s_sleep 8
    s_sub_u32 s60, s60, 1
    s_cbranch_scc0 L_lw_7
    s_mov_b32 s60, 0
L_lw_7e:
    s_cmp_lg_u32 s3, 3
    s_cbranch_scc1 L_h_nomo
    v_and_b32 v4, 15, v0
    v_lshlrev_b32 v4, 4, v4
    v_mul_u32_u24 v5, 1280, v3
    v_add_u32 v5, v5, v4
    v_mul_u32_u24 v6, 1296, v3
    v_add_u32 v6, v6, v4
    v_add_u32 v6, 147456, v6
    s_mov_b32 s62, 30720
    s_mov_b32 s63, 25600
    s_branch L_poll_8
L_poll_8s:
    s_sleep 8
L_poll_8:
    buffer_load_dwordx4 v[40:43], v5, s[40:43], s62 offen offset:0 sc1
    buffer_load_dwordx4 v[44:47], v5, s[40:43], s62 offen offset:256 sc1
    buffer_load_dwordx4 v[48:51], v5, s[40:43], s62 offen offset:512 sc1
    buffer_load_dwordx4 v[52:55], v5, s[40:43], s62 offen offset:768 sc1
    buffer_load_dwordx4 v[56:59], v5, s[40:43], s62 offen offset:1024 sc1
    buffer_load_dwordx4 v[60:63], v5, s[40:43], s63 offen offset:0 sc1
    buffer_load_dwordx4 v[64:67], v5, s[40:43], s63 offen offset:256 sc1
    buffer_load_dwordx4 v[68:71], v5, s[40:43], s63 offen offset:512 sc1
    buffer_load_dwordx4 v[72:75], v5, s[40:43], s63 offen offset:768 sc1
    buffer_load_dwordx4 v[76:79], v5, s[40:43], s63 offen offset:1024 sc1
    s_sub_u32 s60, s60, 1
    s_cbranch_scc1 L_poll_8t
    s_waitcnt vmcnt(0)
    v_max3_u32 v7, v40, v41, v42
    v_max3_u32 v7, v7, v43, v44
    v_max3_u32 v7, v7, v45, v46
    v_max3_u32 v7, v7, v47, v48
    v_max3_u32 v7, v7, v49, v50
    v_max3_u32 v7, v7, v51, v52
    v_max3_u32 v7, v7, v53, v54
    v_max3_u32 v7, v7, v55, v56
    v_max3_u32 v7, v7, v57, v58
    v_max3_u32 v7, v7, v59, v60
    v_max3_u32 v7, v7, v61, v62
    v_max3_u32 v7, v7, v63, v64
    v_max3_u32 v7, v7, v65, v66
    v_max3_u32 v7, v7, v67, v68
    v_max3_u32 v7, v7, v69, v70
    v_max3_u32 v7, v7, v71, v72
    v_max3_u32 v7, v7, v73, v74
    v_max3_u32 v7, v7, v75, v76
    v_max3_u32 v7, v7, v77, v78
    v_max_u32 v7, v7, v79
    v_cmp_eq_u32 vcc, -1, v7
    s_cbranch_vccnz L_poll_8s
L_poll_8e:
    ds_write_b128 v6, v[40:43] offset:0
    ds_write_b128 v6, v[44:47] offset:256
    ds_write_b128 v6, v[48:51] offset:512
    ds_write_b128 v6, v[52:55] offset:768
    ds_write_b128 v6, v[56:59] offset:1024
    ds_write_b128 v6, v[60:63] offset:5184
    ds_write_b128 v6, v[64:67] offset:5440
    ds_write_b128 v6, v[68:71] offset:5696
    ds_write_b128 v6, v[72:75] offset:5952
    ds_write_b128 v6, v[76:79] offset:6208
L_h_nomo:
    v_mul_u32_u24 v4, 144, v1
    v_lshl_add_u32 v4, v3, 5, v4
    v_bfe_u32 v5, v0, 1, 1
    v_lshl_add_u32 v4, v5, 4, v4
    v_add_u32 v4, 90688, v4
    v_mov_b32 v5, 162112
    v_and_b32 v6, 1, v0
    v_cmp_eq_u32 vcc, 0, v6
    s_nop 1
    v_cndmask_b32 v161, v5, v4, vcc
    v_cndmask_b32 v162, v4, v5, vcc
    v_bfe_u32 v164, v0, 1, 1
    v_mul_u32_u24 v164, 0xaaaa, v164
    v_add_u32 v164, 0x4444, v164
    s_mov_b32 s100, s3
    s_lshl_b32 s63, s100, 8
    v_and_b32 v8, 15, v0
    v_lshl_add_u32 v8, v8, 4, s63
    v_lshrrev_b32 v9, 4, v0
    v_mul_u32_u24 v5, 1280, v9
    v_add_u32 v5, v5, v8
    v_mul_u32_u24 v4, 1296, v9
    v_add_u32 v4, v4, v8
    v_add_u32 v4, 82944, v4
    v_lshlrev_b32 v6, 1, v5
    v_add_u32 v6, 99328, v6
    s_lshl_b32 s62, s100, 9
    s_add_u32 s62, s62, 88128
    v_lshl_add_u32 v7, v0, 3, s62
    s_mov_b32 s48, s4
    s_mov_b32 s49, s5
    s_mov_b32 s50, 5120
    s_mov_b32 s51, 0x20000
    buffer_load_dwordx4 v[8:11], v5, s[48:51], 0 offen
    s_mov_b32 s62, 20480
    s_mov_b32 s63, 30720
    s_branch L_poll_9
L_poll_9s:
    s_sleep 8
L_poll_9:
    buffer_load_dwordx4 v[12:15], v5, s[40:43], s62 offen sc1
    buffer_load_dwordx4 v[16:19], v5, s[40:43], s63 offen sc1
    s_sub_u32 s60, s60, 1
    s_cbranch_scc1 L_poll_9t
    s_waitcnt vmcnt(0)
    v_max3_u32 v38, v12, v13, v14
    v_max3_u32 v38, v38, v15, v16
    v_max3_u32 v38, v38, v17, v18
    v_max_u32 v38, v38, v19
    v_cmp_eq_u32 vcc, -1, v38
    s_cbranch_vccnz L_poll_9s
L_poll_9e:
    v_lshlrev_b32 v40, 16, v8
    v_and_b32 v41, 0xffff0000, v8
    v_lshlrev_b32 v42, 16, v9
    v_and_b32 v43, 0xffff0000, v9
    v_lshlrev_b32 v44, 16, v10
    v_and_b32 v45, 0xffff0000, v10
    v_lshlrev_b32 v46, 16, v11
    v_and_b32 v47, 0xffff0000, v11
    v_lshlrev_b32 v48, 16, v12
    v_and_b32 v49, 0xffff0000, v12
    v_lshlrev_b32 v50, 16, v13
    v_and_b32 v51, 0xffff0000, v13
    v_lshlrev_b32 v52, 16, v14
    v_and_b32 v53, 0xffff0000, v14
    v_lshlrev_b32 v54, 16, v15
    v_and_b32 v55, 0xffff0000, v15
    v_lshlrev_b32 v56, 16, v16
    v_and_b32 v57, 0xffff0000, v16
    v_lshlrev_b32 v58, 16, v17
    v_and_b32 v59, 0xffff0000, v17
    v_lshlrev_b32 v60, 16, v18
    v_and_b32 v61, 0xffff0000, v18
    v_lshlrev_b32 v62, 16, v19
    v_and_b32 v63, 0xffff0000, v19
    v_mov_b32 v64, 0
    v_mov_b32 v65, 0
    v_mov_b32 v66, 0
    v_mov_b32 v67, 0
    v_mov_b32 v68, 0
    v_mov_b32 v69, 0
    v_mov_b32 v70, 0
    v_mov_b32 v71, 0
    v_bfe_u32 v5, v0, 2, 2
    v_lshlrev_b32 v5, 8, v5
    v_lshrrev_b32 v8, 4, v0
    v_lshl_add_u32 v5, v8, 6, v5
    v_and_b32 v8, 3, v0
    v_lshl_add_u32 v5, v8, 4, v5
    s_lshl_b32 s63, s100, 10
    v_add_u32 v5, s63, v5
    s_waitcnt vmcnt(0) lgkmcnt(0)
    v_mov_b32 v8, 162064
    v_mov_b32 v9, 1
    s_mov_b64 exec, 1
    ds_add_u32 v8, v9
    s_mov_b64 exec, -1
    s_branch L_t2gate
L_ffn2:
    v_mov_b32 v16, 0
    v_mov_b32 v17, 0
    v_mov_b32 v18, 0
    v_mov_b32 v19, 0
    v_mov_b32 v20, 0
    v_mov_b32 v21, 0
    v_mov_b32 v22, 0
    v_mov_b32 v23, 0
    v_mov_b32 v24, 0
    v_mov_b32 v25, 0
    v_mov_b32 v26, 0
    v_mov_b32 v27, 0
    v_mov_b32 v28, 0
    v_mov_b32 v29, 0
    v_mov_b32 v30, 0
    v_mov_b32 v31, 0
    v_mov_b32 v32, 0
    v_mov_b32 v33, 0
    v_mov_b32 v34, 0
    v_mov_b32 v35, 0
    s_barrier
    ds_read_b128 v[8:11], v161
    ds_read_b128 v[12:15], v162
    s_cmp_eq_u32 s61, 1
    s_cbranch_scc0 L_f2slow
    s_waitcnt lgkmcnt(1)
    v_smfmac_f32_16x16x64_bf16 v[16:19], v[8:11], v[80:87], v164
    v_smfmac_f32_16x16x64_bf16 v[20:23], v[8:11], v[96:103], v164
    s_waitcnt lgkmcnt(0)
    v_smfmac_f32_16x16x64_bf16 v[16:19], v[12:15], v[88:95], v164
    v_smfmac_f32_16x16x64_bf16 v[20:23], v[12:15], v[104:111], v164
    v_smfmac_f32_16x16x64_bf16 v[24:27], v[8:11], v[112:119], v164
    v_smfmac_f32_16x16x64_bf16 v[28:31], v[8:11], v[128:135], v164
    v_smfmac_f32_16x16x64_bf16 v[24:27], v[12:15], v[120:127], v164
    v_smfmac_f32_16x16x64_bf16 v[28:31], v[12:15], v[136:143], v164
    v_smfmac_f32_16x16x64_bf16 v[32:35], v[8:11], v[144:151], v164
    v_smfmac_f32_16x16x64_bf16 v[32:35], v[12:15], v[152:159], v164
    s_nop 0
    v_pk_add_f32 v[16:17], v[16:17], v[18:19]
    v_cvt_pk_bf16_f32 v40, v16, v17
    v_pk_add_f32 v[20:21], v[20:21], v[22:23]
    v_cvt_pk_bf16_f32 v41, v20, v21
    buffer_store_dwordx2 v[40:41], v160, s[40:43], s57 offen
    v_pk_add_f32 v[24:25], v[24:25], v[26:27]
    v_cvt_pk_bf16_f32 v42, v24, v25
    v_pk_add_f32 v[28:29], v[28:29], v[30:31]
    v_cvt_pk_bf16_f32 v43, v28, v29
    buffer_store_dwordx2 v[42:43], v160, s[40:43], s57 offen offset:128
    v_pk_add_f32 v[32:33], v[32:33], v[34:35]
    v_cvt_pk_bf16_f32 v44, v32, v33
    buffer_store_dword v44, v163, s[40:43], s57 offen offset:256
L_f2done:
    s_barrier
    s_endpgm
L_f2slow:
    s_waitcnt lgkmcnt(1)
    v_smfmac_f32_16x16x64_bf16 v[16:19], v[8:11], v[80:87], v164
    v_smfmac_f32_16x16x64_bf16 v[20:23], v[8:11], v[96:103], v164
    s_waitcnt lgkmcnt(0)
    v_smfmac_f32_16x16x64_bf16 v[16:19], v[12:15], v[88:95], v164
    v_smfmac_f32_16x16x64_bf16 v[20:23], v[12:15], v[104:111], v164
    v_smfmac_f32_16x16x64_bf16 v[24:27], v[8:11], v[112:119], v164
    v_smfmac_f32_16x16x64_bf16 v[28:31], v[8:11], v[128:135], v164
    v_smfmac_f32_16x16x64_bf16 v[24:27], v[12:15], v[120:127], v164
    v_smfmac_f32_16x16x64_bf16 v[28:31], v[12:15], v[136:143], v164
    v_smfmac_f32_16x16x64_bf16 v[32:35], v[8:11], v[144:151], v164
    v_smfmac_f32_16x16x64_bf16 v[32:35], v[12:15], v[152:159], v164
    s_nop 0
    v_pk_add_f32 v[16:17], v[16:17], v[18:19]
    v_cvt_pk_bf16_f32 v40, v16, v17
    v_pk_add_f32 v[20:21], v[20:21], v[22:23]
    v_cvt_pk_bf16_f32 v41, v20, v21
    buffer_store_dwordx2 v[40:41], v160, s[40:43], s57 offen sc1
    v_pk_add_f32 v[24:25], v[24:25], v[26:27]
    v_cvt_pk_bf16_f32 v42, v24, v25
    v_pk_add_f32 v[28:29], v[28:29], v[30:31]
    v_cvt_pk_bf16_f32 v43, v28, v29
    buffer_store_dwordx2 v[42:43], v160, s[40:43], s57 offen offset:128 sc1
    v_pk_add_f32 v[32:33], v[32:33], v[34:35]
    v_cvt_pk_bf16_f32 v44, v32, v33
    buffer_store_dword v44, v163, s[40:43], s57 offen offset:256 sc1
    s_branch L_f2done
L_poll_3t:
    s_mov_b32 s60, 0
    s_waitcnt vmcnt(0)
    s_branch L_poll_3e
L_poll_4t:
    s_mov_b32 s60, 0
    s_waitcnt vmcnt(0)
    s_branch L_poll_4e
L_poll_8t:
    s_mov_b32 s60, 0
    s_waitcnt vmcnt(0)
    s_branch L_poll_8e
L_poll_9t:
    s_mov_b32 s60, 0
    s_waitcnt vmcnt(0)
    s_branch L_poll_9e
L_poll_99t:
    s_mov_b32 s60, 0
    s_waitcnt vmcnt(0)
    s_branch L_poll_99e
L_pfast:
    buffer_store_dword v12, v108, s[40:43], s101 offen
    s_branch L_pdone
L_poll_101t:
    s_mov_b32 s60, 0
    s_waitcnt vmcnt(0)
    s_branch L_poll_101e
L_poll_104t:
    s_mov_b32 s60, 0
    s_waitcnt vmcnt(0)
    s_branch L_poll_104e
L_poll_106t:
    s_mov_b32 s60, 0
    s_waitcnt vmcnt(0)
    s_branch L_poll_106e
L_poll_110t:
    s_mov_b32 s60, 0
    s_waitcnt vmcnt(0)
    s_branch L_poll_110e
L_poll_112t:
    s_mov_b32 s60, 0
    s_waitcnt vmcnt(0)
    s_branch L_poll_112e
L_poll_117t:
    s_mov_b32 s60, 0
    s_waitcnt vmcnt(0)
    s_branch L_poll_117e
L_poll_119t:
    s_mov_b32 s60, 0
    s_waitcnt vmcnt(0)
    s_branch L_poll_119e
L_ygt:
    s_waitcnt vmcnt(0)
    s_branch L_ygd
L_pto:
    s_mov_b32 s60, 0
    s_waitcnt vmcnt(0)
    s_branch L_pgot0
L_poll_123t:
    s_mov_b32 s60, 0
    s_waitcnt vmcnt(0)
    s_branch L_poll_123e
L_end:
    s_endpgm
L_codeend:
.section .rodata,"a"
.p2align 6
.amdhsa_kernel adaLN_cond__sliding_block_cached__dense_activation_gelu__decode_kernel
  .amdhsa_next_free_vgpr 168
  .amdhsa_next_free_sgpr 102
  .amdhsa_accum_offset 168
  .amdhsa_group_segment_fixed_size 0
  .amdhsa_kernarg_size 120
  .amdhsa_user_sgpr_count 2
  .amdhsa_user_sgpr_kernarg_segment_ptr 1
  .amdhsa_system_sgpr_workgroup_id_x 1
.end_amdhsa_kernel
```

```asm
; @launch grid=(256,1,1) block=(768,1,1) lds=162176
.amdgcn_target "amdgcn-amd-amdhsa--gfx950"
.text
.globl adaLN_cond__sliding_block_cached__dense_activation_gelu__decode_kernel
.p2align 8
.type adaLN_cond__sliding_block_cached__dense_activation_gelu__decode_kernel,@function
adaLN_cond__sliding_block_cached__dense_activation_gelu__decode_kernel:
    s_load_dwordx16 s[4:19], s[0:1], 0
    s_load_dwordx8 s[20:27], s[0:1], 64
    s_load_dwordx4 s[28:31], s[0:1], 96
    s_load_dwordx2 s[32:33], s[0:1], 112
    s_cmp_ge_u32 s2, 256
    s_cbranch_scc1 L_end
    v_lshrrev_b32 v1, 6, v0
    v_lshlrev_b32 v2, 4, v0
    v_readfirstlane_b32 s3, v1
    v_and_b32 v0, 63, v0
    s_and_b32 s34, s2, 7
    s_lshr_b32 s35, s2, 3
    s_cmp_lg_u32 s35, 21
    s_cbranch_scc1 L_nopf
    s_getpc_b64 s[48:49]
    s_and_b32 s48, s48, 0xffffff00
    s_mov_b32 s50, L_codeend-adaLN_cond__sliding_block_cached__dense_activation_gelu__decode_kernel
    s_mov_b32 s51, 0x20000
    s_mov_b32 s52, 12288
    buffer_load_dwordx4 v[152:155], v2, s[48:51], 0 offen
    buffer_load_dwordx4 v[156:159], v2, s[48:51], s52 offen
L_nopf:
    s_lshr_b32 s36, s35, 3
    s_lshl2_add_u32 s36, s34, s36
    s_bfe_u32 s37, s35, 0x20001
    s_and_b32 s38, s35, 1
    s_cmp_lt_u32 s35, 27
    s_cselect_b32 s39, 1, 0
    s_cmp_eq_u32 s34, 2
    s_cselect_b32 s39, s39, 0
    s_sub_u32 s62, s34, 3
    s_and_b32 s62, s62, 7
    s_mul_i32 s56, s35, 7
    s_add_u32 s56, s56, s62
    s_cmp_eq_u32 s62, 7
    s_cselect_b32 s56, 255, s56
    s_mov_b32 s60, 400000
    s_mov_b32 s61, 0
    v_mov_b32 v36, 0
    s_cmp_lt_u32 s3, 4
    s_cbranch_scc1 L_helpers
    s_sub_u32 s3, s3, 4
    s_cmp_ge_u32 s35, 22
    s_cselect_b32 s59, 1, 0
    s_add_u32 s62, s3, s59
    s_cmp_ge_u32 s62, 6
    s_cselect_b32 s62, s39, 0
    s_cmp_eq_u32 s62, 1
    s_cbranch_scc1 L_proxy
    s_cmp_eq_u32 s59, 1
    s_cselect_b32 s100, 0, 81920
    s_lshl_b32 s62, s3, 13
    s_add_u32 s100, s100, s62
    s_and_b32 s62, s39, s59
    s_cselect_b32 s100, -1, s100
    s_mov_b32 s101, 0
L_stream:
    s_lshl_b32 s62, s37, 5
    s_add_u32 s62, s62, s36
    s_lshl_b32 s63, s62, 21
    s_lshl_b32 s96, s38, 18
    s_add_u32 s63, s63, s96
    s_add_u32 s63, s63, 1572864
    v_lshlrev_b32 v1, 4, v0
    s_lshl_b32 s96, s3, 12
    v_add_u32 v1, s96, v1
    s_mov_b32 s97, 0
    s_mov_b32 s50, 262144
    s_mov_b32 s51, 0x20000
    s_waitcnt lgkmcnt(0)
    s_add_u32 s48, s6, s63
    s_addc_u32 s49, s7, 0
    s_cmp_lt_u32 s56, 40
    s_cbranch_scc0 L_nob0
    s_barrier
L_nob0:
    buffer_load_dwordx4 v[40:43], v1, s[48:51], s97 offen offset:0 nt
    buffer_load_dwordx4 v[44:47], v1, s[48:51], s97 offen offset:1024 nt
    s_cmp_lt_u32 s56, 40
    s_cbranch_scc1 L_stream2
    s_barrier
    s_branch L_stream2
L_helpers:
    s_cmp_lg_u32 s3, 0
    s_cbranch_scc1 L_noinit
    v_lshlrev_b32 v1, 2, v0
    v_add_u32 v1, 161920, v1
    ds_write_b32 v1, v36
L_noinit:
    s_waitcnt lgkmcnt(0)
    s_mov_b32 s40, s32
    s_mov_b32 s41, s33
    s_mov_b32 s42, 589824
    s_mov_b32 s43, 0x20000
    s_mov_b32 s44, s30
    s_mov_b32 s45, s31
    s_mov_b32 s46, 256
    s_mov_b32 s47, 0x20000
    s_lshl2_add_u32 s62, s35, s3
    s_cmp_eq_u32 s62, 87
    s_cbranch_scc1 L_touch
L_notp:
    s_mul_i32 s101, s3, 20480
    s_mov_b32 s96, s56
    s_cmp_lt_u32 s56, 40
    s_cbranch_scc0 L_nothalf
    s_cmp_lt_u32 s3, 2
    s_cbranch_scc1 L_unit
    s_add_u32 s62, s56, 20
    s_cmp_eq_u32 s3, 2
    s_cbranch_scc1 L_job
    s_lshr_b32 s62, s56, 1
    s_lshl_b32 s63, s62, 11
    s_cmp_ge_u32 s62, 10
    s_cselect_b32 s62, -19968, 0
    s_add_u32 s63, s63, s62
    s_and_b32 s62, s56, 1
    s_lshl_b32 s62, s62, 8
    s_add_u32 s63, s63, s62
    v_lshrrev_b32 v1, 5, v0
    v_lshlrev_b32 v1, 10, v1
    v_and_b32 v2, 31, v0
    v_lshl_add_u32 v1, v2, 3, v1
    v_mov_b32 v4, -1
    v_mov_b32 v5, -1
    buffer_store_dwordx2 v[4:5], v1, s[40:43], s63 offen sc1
    s_lshl_b32 s62, s56, 1
    s_waitcnt vmcnt(0)
    s_mov_b64 exec, 1
    buffer_store_short v4, v36, s[44:47], s62 offen offset:128 sc1
    s_mov_b64 exec, -1
    s_barrier
    s_branch L_service
L_nothalf:
    s_cmp_lt_u32 s56, 104
    s_cbranch_scc1 L_unit
    s_sub_u32 s62, s56, 144
    s_cmp_lt_u32 s62, 10
    s_cbranch_scc0 L_nojob
    s_cmp_lt_u32 s3, 2
    s_cbranch_scc0 L_nojob
    s_mul_i32 s63, s3, 10
    s_add_u32 s62, s62, s63
L_job:
    s_cmp_lt_u32 s62, 59
    s_cbranch_scc0 L_end
    s_mov_b32 s100, s101
    s_lshl_b32 s101, s62, 9
    s_add_u32 s101, s101, 196608
    s_cmp_lt_u32 s62, 27
    s_cselect_b32 s63, 0, 27
    s_cselect_b32 s3, 7, 6
    s_cmp_lt_u32 s62, 54
    s_cselect_b32 s63, s63, 32
    s_cselect_b32 s3, s3, 5
    s_sub_u32 s35, s62, s63
    s_mov_b32 s34, 2
    s_lshr_b32 s36, s35, 3
    s_add_u32 s36, s36, 8
    s_bfe_u32 s37, s35, 0x20001
    s_and_b32 s38, s35, 1
    s_mov_b32 s59, 0
    s_branch L_stream
L_nojob:
    s_barrier
    s_cmp_ge_u32 s35, 22
    s_cbranch_scc1 L_h_t1
    s_cmp_eq_u32 s39, 1
    s_cbranch_scc1 L_h_role
    s_cmp_lt_u32 s96, 144
    s_cbranch_scc1 L_unit
    s_cmp_eq_u32 s3, 3
    s_cbranch_scc1 L_service
    s_endpgm
L_unit:
    v_lshrrev_b32 v3, 4, v0
    v_and_b32 v4, 3, v0
    v_bfe_u32 v7, v0, 2, 2
    s_mov_b32 s14, s3
    s_mov_b32 s15, 3
    s_sub_u32 s62, s96, 40
    s_cmp_lt_u32 s62, 64
    s_cbranch_scc1 L_u_q
    s_mov_b32 s100, 1
    s_sub_u32 s96, s96, 84
    s_cmp_lt_u32 s56, 40
    s_cbranch_scc0 L_u_full
    s_mov_b32 s100, 0
    s_lshr_b32 s96, s56, 1
    s_and_b32 s62, s56, 1
    s_lshl1_add_u32 s14, s62, s14
    s_mov_b32 s15, 1
L_u_full:
    s_mov_b32 s97, 0
    s_mov_b32 s99, 7680
    s_mov_b32 s48, s26
    s_mov_b32 s49, s27
    s_mov_b32 s50, 4915200
    s_mov_b32 s51, 0x20000
    s_mov_b32 s52, s24
    s_mov_b32 s53, s25
    s_mov_b32 s54, 5120
    s_mov_b32 s55, 0x20000
    v_and_b32 v6, 15, v0
    v_lshlrev_b32 v6, 4, v6
    v_mul_u32_u24 v5, 1280, v3
    v_add_u32 v5, v5, v6
    s_mul_i32 s62, s14, 320
    buffer_load_dwordx4 v[8:11], v5, s[52:55], s62 offen
    s_mov_b32 exec_lo, 0x000f000f
    s_mov_b32 exec_hi, 0x000f000f
    buffer_load_dwordx4 v[12:15], v5, s[52:55], s62 offen offset:256
    s_mov_b64 exec, -1
    s_lshl_b32 s98, s96, 7
    s_mul_i32 s13, s96, 0x199a
    s_lshr_b32 s13, s13, 16
    s_cmp_lg_u32 s13, 1
    s_cbranch_scc1 L_u_go
    s_mov_b32 s52, s4
    s_mov_b32 s53, s5
    s_mov_b32 s54, 5120
    s_mov_b32 s55, 0x20000
    v_mul_u32_u24 v5, 1280, v4
    v_lshlrev_b32 v64, 5, v7
    v_lshl_add_u32 v64, v3, 3, v64
    v_add_u32 v64, v64, v5
    v_lshrrev_b32 v6, 2, v0
    v_lshl_add_u32 v6, v6, 4, v5
    s_sub_u32 s62, s98, 1280
    buffer_load_dwordx4 v[16:19], v6, s[52:55], 0 offen offset:0
    buffer_load_dwordx4 v[20:23], v6, s[52:55], 0 offen offset:256
    buffer_load_dwordx4 v[24:27], v6, s[52:55], 0 offen offset:512
    buffer_load_dwordx4 v[28:31], v6, s[52:55], 0 offen offset:768
    buffer_load_dwordx4 v[32:35], v6, s[52:55], 0 offen offset:1024
    buffer_load_dwordx2 v[66:67], v64, s[52:55], s62 offen
    s_branch L_u_go
L_u_q:
    s_mov_b32 s97, 1
    s_mov_b32 s99, 8192
    s_mov_b32 s100, 0
    s_lshl_b32 s98, s62, 7
    s_mov_b32 s48, s10
    s_mov_b32 s49, s11
    s_mov_b32 s50, 5242880
    s_mov_b32 s51, 0x20000
L_u_go:
    v_lshrrev_b32 v6, 3, v0
    v_mul_lo_u32 v1, v6, s99
    v_and_b32 v6, 2, v6
    v_xor_b32 v6, v6, v0
    v_and_b32 v6, 7, v6
    v_lshl_add_u32 v1, v6, 4, v1
    v_add_u32 v1, s98, v1
    v_xor_b32 v2, 64, v1
    s_mul_i32 s63, s99, s14
    s_mul_i32 s63, s63, 160
    s_lshl_b32 s59, s99, 3
    s_mov_b32 m0, s101
    s_mov_b32 s62, 10
L_dma_1:
    buffer_load_dwordx4 v1, s[48:51], s63 offen nt lds
    s_add_u32 m0, m0, 1024
    s_add_u32 s63, s63, s59
    s_cmp_eq_u32 s100, 0
    s_cbranch_scc1 L_dma_1n0
    s_waitcnt vmcnt(3)
    s_cmp_eq_u32 s100, 2
    s_cbranch_scc1 L_dma_1n0
    s_waitcnt vmcnt(3)
L_dma_1n0:
    buffer_load_dwordx4 v2, s[48:51], s63 offen nt lds
    s_add_u32 m0, m0, 1024
    s_add_u32 s63, s63, s59
    s_cmp_eq_u32 s100, 0
    s_cbranch_scc1 L_dma_1n1
    s_waitcnt vmcnt(3)
    s_cmp_eq_u32 s100, 2
    s_cbranch_scc1 L_dma_1n1
    s_waitcnt vmcnt(3)
L_dma_1n1:
    s_sub_u32 s62, s62, 1
    s_cmp_lg_u32 s62, 0
    s_cbranch_scc1 L_dma_1
    v_min_u32 v65, 29, v0
    v_lshlrev_b32 v65, 2, v65
    s_cmp_lt_u32 s56, 104
    s_cselect_b32 s62, 32, 64
    v_min_u32 v6, 51, v0
    v_lshlrev_b32 v6, 2, v6
    v_cmp_le_u32 vcc, s62, v0
    s_nop 1
    v_cndmask_b32 v65, v65, v6, vcc
    v_mov_b32 v68, -1
    s_cmp_lt_u32 s56, 40
    s_cbranch_scc1 L_u_nofl
    buffer_load_dword v68, v65, s[44:47], 0 offen sc1
L_u_nofl:
    s_cmp_lt_u32 s56, 104
    s_cbranch_scc0 L_u_nob
    s_barrier
L_u_nob:
    v_lshrrev_b32 v60, 4, v0
    v_lshlrev_b32 v60, 10, v60
    v_bfe_u32 v6, v0, 2, 2
    v_lshl_add_u32 v60, v6, 7, v60
    v_and_b32 v6, 3, v0
    v_lshl_add_u32 v60, v6, 3, v60
    v_bfe_u32 v6, v0, 3, 2
    v_lshl_add_u32 v60, v6, 5, v60
    v_xor_b32 v61, 32, v60
    v_xor_b32 v62, 64, v60
    v_xor_b32 v63, 0x60, v60
    v_add_u32 v60, s101, v60
    v_add_u32 v61, s101, v61
    v_add_u32 v62, s101, v62
    v_add_u32 v63, s101, v63
    v_mov_b32 v56, 1.0
    v_mov_b32 v57, 1.0
    v_mov_b32 v58, 1.0
    v_mov_b32 v59, 1.0
    s_mov_b32 s58, 0
    v_lshl_add_u32 v69, v7, 2, v3
    v_lshl_add_u32 v69, v4, 4, v69
    v_and_b32 v64, 15, v0
    v_lshlrev_b32 v64, 3, v64
    s_cmp_eq_u32 s97, 1
    s_cbranch_scc1 L_u_q2
    v_mul_u32_u24 v6, 1280, v3
    v_add_u32 v64, v64, v6
    s_mul_i32 s63, s13, 3840
    s_add_u32 s57, s98, s63
    s_add_u32 s57, s57, 10240
    s_cmp_lt_u32 s56, 40
    s_cbranch_scc0 L_u_nat
    v_lshrrev_b32 v69, 1, v3
    v_lshlrev_b32 v69, 3, v69
    v_lshl_add_u32 v69, v7, 4, v69
    v_lshl_add_u32 v69, v4, 1, v69
    v_and_b32 v6, 1, v3
    v_add_u32 v69, v69, v6
    s_lshr_b32 s62, s56, 1
    s_lshl_b32 s57, s62, 11
    s_cmp_ge_u32 s62, 10
    s_cselect_b32 s62, -19968, 0
    s_add_u32 s57, s57, s62
    s_and_b32 s62, s56, 1
    s_lshl_b32 s62, s62, 8
    s_add_u32 s57, s57, s62
    v_lshrrev_b32 v64, 5, v0
    v_lshlrev_b32 v64, 10, v64
    v_and_b32 v6, 31, v0
    v_lshl_add_u32 v64, v6, 3, v64
L_u_nat:
    s_cmp_eq_u32 s13, 4
    s_cselect_b32 s58, 1.0, 0
    s_cmp_eq_u32 s13, 1
    s_cselect_b32 s58, 1.0, s58
    s_cselect_b32 s56, 1, 0
    s_cmp_eq_u32 s14, 0
    s_cselect_b32 s58, s58, 0
    s_waitcnt vmcnt(20)
    s_mov_b32 s62, 0xbfb8aa3b
    v_lshlrev_b32 v40, 16, v8
    v_and_b32 v41, 0xffff0000, v8
    v_lshlrev_b32 v42, 16, v9
    v_and_b32 v43, 0xffff0000, v9
    v_lshlrev_b32 v44, 16, v10
    v_and_b32 v45, 0xffff0000, v10
    v_lshlrev_b32 v46, 16, v11
    v_and_b32 v47, 0xffff0000, v11
    v_mul_f32 v48, s62, v40
    v_mul_f32 v49, s62, v41
    v_mul_f32 v50, s62, v42
    v_mul_f32 v51, s62, v43
    v_mul_f32 v52, s62, v44
    v_mul_f32 v53, s62, v45
    v_mul_f32 v54, s62, v46
    v_mul_f32 v55, s62, v47
    v_exp_f32 v48, v48
    v_exp_f32 v49, v49
    v_exp_f32 v50, v50
    v_exp_f32 v51, v51
    v_exp_f32 v52, v52
    v_exp_f32 v53, v53
    v_exp_f32 v54, v54
    v_exp_f32 v55, v55
    v_add_f32 v48, 1.0, v48
    v_add_f32 v49, 1.0, v49
    v_add_f32 v50, 1.0, v50
    v_add_f32 v51, 1.0, v51
    v_add_f32 v52, 1.0, v52
    v_add_f32 v53, 1.0, v53
    v_add_f32 v54, 1.0, v54
    v_add_f32 v55, 1.0, v55
    v_rcp_f32 v48, v48
    v_rcp_f32 v49, v49
    v_rcp_f32 v50, v50
    v_rcp_f32 v51, v51
    v_rcp_f32 v52, v52
    v_rcp_f32 v53, v53
    v_rcp_f32 v54, v54
    v_rcp_f32 v55, v55
    v_mul_f32 v40, v40, v48
    v_mul_f32 v41, v41, v49
    v_mul_f32 v42, v42, v50
    v_mul_f32 v43, v43, v51
    v_mul_f32 v44, v44, v52
    v_mul_f32 v45, v45, v53
    v_mul_f32 v46, v46, v54
    v_mul_f32 v47, v47, v55
    v_cvt_pk_bf16_f32 v8, v40, v41
    v_cvt_pk_bf16_f32 v9, v42, v43
    v_cvt_pk_bf16_f32 v10, v44, v45
    v_cvt_pk_bf16_f32 v11, v46, v47
    v_lshlrev_b32 v40, 16, v12
    v_and_b32 v41, 0xffff0000, v12
    v_lshlrev_b32 v42, 16, v13
    v_and_b32 v43, 0xffff0000, v13
    v_lshlrev_b32 v44, 16, v14
    v_and_b32 v45, 0xffff0000, v14
    v_lshlrev_b32 v46, 16, v15
    v_and_b32 v47, 0xffff0000, v15
    v_mul_f32 v48, s62, v40
    v_mul_f32 v49, s62, v41
    v_mul_f32 v50, s62, v42
    v_mul_f32 v51, s62, v43
    v_mul_f32 v52, s62, v44
    v_mul_f32 v53, s62, v45
    v_mul_f32 v54, s62, v46
    v_mul_f32 v55, s62, v47
    v_exp_f32 v48, v48
    v_exp_f32 v49, v49
    v_exp_f32 v50, v50
    v_exp_f32 v51, v51
    v_exp_f32 v52, v52
    v_exp_f32 v53, v53
    v_exp_f32 v54, v54
    v_exp_f32 v55, v55
    v_add_f32 v48, 1.0, v48
    v_add_f32 v49, 1.0, v49
    v_add_f32 v50, 1.0, v50
    v_add_f32 v51, 1.0, v51
    v_add_f32 v52, 1.0, v52
    v_add_f32 v53, 1.0, v53
    v_add_f32 v54, 1.0, v54
    v_add_f32 v55, 1.0, v55
    v_rcp_f32 v48, v48
    v_rcp_f32 v49, v49
    v_rcp_f32 v50, v50
    v_rcp_f32 v51, v51
    v_rcp_f32 v52, v52
    v_rcp_f32 v53, v53
    v_rcp_f32 v54, v54
    v_rcp_f32 v55, v55
    v_mul_f32 v40, v40, v48
    v_mul_f32 v41, v41, v49
    v_mul_f32 v42, v42, v50
    v_mul_f32 v43, v43, v51
    v_mul_f32 v44, v44, v52
    v_mul_f32 v45, v45, v53
    v_mul_f32 v46, v46, v54
    v_mul_f32 v47, v47, v55
    v_cvt_pk_bf16_f32 v12, v40, v41
    v_cvt_pk_bf16_f32 v13, v42, v43
    v_cvt_pk_bf16_f32 v14, v44, v45
    v_cvt_pk_bf16_f32 v15, v46, v47
    s_mul_i32 s62, s3, 1344
    s_add_u32 s62, s62, 151552
    v_mul_u32_u24 v5, 336, v3
    v_and_b32 v6, 15, v0
    v_lshl_add_u32 v5, v6, 4, v5
    v_add_u32 v5, s62, v5
    ds_write_b128 v5, v[8:11]
    s_mov_b32 exec_lo, 0x000f000f
    s_mov_b32 exec_hi, 0x000f000f
    ds_write_b128 v5, v[12:15] offset:256
    s_mov_b64 exec, -1
    v_mul_u32_u24 v5, 336, v4
    v_lshl_add_u32 v5, v3, 4, v5
    v_add_u32 v5, s62, v5
    s_mov_b32 s59, 0x3e800000
    s_cmp_eq_u32 s56, 0
    s_cbranch_scc1 L_u_nost
    v_mov_b32 v40, 0
    v_mov_b32 v41, 0
    s_mov_b32 s62, 0x3f803f80
    v_dot2c_f32_bf16 v40, s62, v16
    v_dot2c_f32_bf16 v41, v16, v16
    v_dot2c_f32_bf16 v40, s62, v17
    v_dot2c_f32_bf16 v41, v17, v17
    v_dot2c_f32_bf16 v40, s62, v18
    v_dot2c_f32_bf16 v41, v18, v18
    v_dot2c_f32_bf16 v40, s62, v19
    v_dot2c_f32_bf16 v41, v19, v19
    v_dot2c_f32_bf16 v40, s62, v20
    v_dot2c_f32_bf16 v41, v20, v20
    v_dot2c_f32_bf16 v40, s62, v21
    v_dot2c_f32_bf16 v41, v21, v21
    v_dot2c_f32_bf16 v40, s62, v22
    v_dot2c_f32_bf16 v41, v22, v22
    v_dot2c_f32_bf16 v40, s62, v23
    v_dot2c_f32_bf16 v41, v23, v23
    v_dot2c_f32_bf16 v40, s62, v24
    v_dot2c_f32_bf16 v41, v24, v24
    v_dot2c_f32_bf16 v40, s62, v25
    v_dot2c_f32_bf16 v41, v25, v25
    v_dot2c_f32_bf16 v40, s62, v26
    v_dot2c_f32_bf16 v41, v26, v26
    v_dot2c_f32_bf16 v40, s62, v27
    v_dot2c_f32_bf16 v41, v27, v27
    v_dot2c_f32_bf16 v40, s62, v28
    v_dot2c_f32_bf16 v41, v28, v28
    v_dot2c_f32_bf16 v40, s62, v29
    v_dot2c_f32_bf16 v41, v29, v29
    v_dot2c_f32_bf16 v40, s62, v30
    v_dot2c_f32_bf16 v41, v30, v30
    v_dot2c_f32_bf16 v40, s62, v31
    v_dot2c_f32_bf16 v41, v31, v31
    v_dot2c_f32_bf16 v40, s62, v32
    v_dot2c_f32_bf16 v41, v32, v32
    v_dot2c_f32_bf16 v40, s62, v33
    v_dot2c_f32_bf16 v41, v33, v33
    v_dot2c_f32_bf16 v40, s62, v34
    v_dot2c_f32_bf16 v41, v34, v34
    v_dot2c_f32_bf16 v40, s62, v35
    v_dot2c_f32_bf16 v41, v35, v35
    s_nop 1
    v_add_f32_dpp v40, v40, v40 row_ror:4 row_mask:0xf bank_mask:0xf
    v_add_f32_dpp v41, v41, v41 row_ror:4 row_mask:0xf bank_mask:0xf
    s_nop 0
    v_add_f32_dpp v40, v40, v40 row_ror:8 row_mask:0xf bank_mask:0xf
    v_add_f32_dpp v41, v41, v41 row_ror:8 row_mask:0xf bank_mask:0xf
    v_mov_b32 v42, v40
    v_mov_b32 v43, v41
    s_nop 0
    v_permlane16_swap_b32 v40, v42
    v_permlane16_swap_b32 v41, v43
    v_add_f32 v40, v40, v42
    v_add_f32 v41, v41, v43
    v_mov_b32 v42, v40
    v_mov_b32 v43, v41
    s_nop 0
    v_permlane32_swap_b32 v40, v42
    v_permlane32_swap_b32 v41, v43
    v_add_f32 v40, v40, v42
    v_add_f32 v41, v41, v43
    s_mov_b32 s62, 0x3acccccd
    v_mul_f32 v40, s62, v40
    v_mul_f32 v41, s62, v41
    v_fma_f32 v41, -v40, v40, v41
    v_max_f32 v41, 0, v41
    v_add_f32 v41, 0x3727c5ac, v41
    v_rsq_f32 v41, v41
    v_lshlrev_b32 v56, 16, v66
    v_and_b32 v57, 0xffff0000, v66
    v_lshlrev_b32 v58, 16, v67
    v_and_b32 v59, 0xffff0000, v67
    v_sub_f32 v56, v56, v40
    v_sub_f32 v57, v57, v40
    v_sub_f32 v58, v58, v40
    v_sub_f32 v59, v59, v40
    v_mul_f32 v56, v56, v41
    v_mul_f32 v57, v57, v41
    v_mul_f32 v58, v58, v41
    v_mul_f32 v59, v59, v41
L_u_nost:
    ds_read_b128 v[8:11], v5 offset:0
    ds_read_b128 v[12:15], v5 offset:64
    ds_read_b128 v[16:19], v5 offset:128
    ds_read_b128 v[20:23], v5 offset:192
    ds_read_b128 v[24:27], v5 offset:256
    s_branch L_u_frag
L_u_q2:
    v_lshl_add_u32 v64, v3, 13, v64
    s_add_u32 s57, s98, 40960
    v_lshlrev_b32 v5, 8, v7
    v_lshl_add_u32 v5, v3, 6, v5
    v_lshl_add_u32 v5, v4, 4, v5
    s_mul_i32 s63, s3, 5120
    s_add_u32 s63, s63, 0
    s_add_u32 s12, s63, 4096
    s_mov_b32 s59, 1.0
L_u_frag:
    s_waitcnt vmcnt(0)
    v_cmp_ne_u32 vcc, -1, v68
    s_cbranch_vccz L_u_yok
L_wy_2:
    buffer_load_dword v37, v65, s[44:47], 0 offen sc1
    s_waitcnt vmcnt(0)
    v_cmp_ne_u32 vcc, -1, v37
    s_cbranch_vccz L_wy_2e
    s_sleep 4
    s_sub_u32 s60, s60, 1
    s_cbranch_scc0 L_wy_2
    s_mov_b32 s60, 0
L_wy_2e:
L_u_yok:
    ds_read_b64_tr_b16 v[80:81], v60 offset:0
    ds_read_b64_tr_b16 v[82:83], v60 offset:512
    ds_read_b64_tr_b16 v[84:85], v61 offset:0
    ds_read_b64_tr_b16 v[86:87], v61 offset:512
    ds_read_b64_tr_b16 v[88:89], v62 offset:0
    ds_read_b64_tr_b16 v[90:91], v62 offset:512
    ds_read_b64_tr_b16 v[92:93], v63 offset:0
    ds_read_b64_tr_b16 v[94:95], v63 offset:512
    ds_read_b64_tr_b16 v[96:97], v60 offset:4096
    ds_read_b64_tr_b16 v[98:99], v60 offset:4608
    ds_read_b64_tr_b16 v[100:101], v61 offset:4096
    ds_read_b64_tr_b16 v[102:103], v61 offset:4608
    ds_read_b64_tr_b16 v[104:105], v62 offset:4096
    ds_read_b64_tr_b16 v[106:107], v62 offset:4608
    ds_read_b64_tr_b16 v[108:109], v63 offset:4096
    ds_read_b64_tr_b16 v[110:111], v63 offset:4608
    ds_read_b64_tr_b16 v[112:113], v60 offset:8192
    ds_read_b64_tr_b16 v[114:115], v60 offset:8704
    ds_read_b64_tr_b16 v[116:117], v61 offset:8192
    ds_read_b64_tr_b16 v[118:119], v61 offset:8704
    ds_read_b64_tr_b16 v[120:121], v62 offset:8192
    ds_read_b64_tr_b16 v[122:123], v62 offset:8704
    ds_read_b64_tr_b16 v[124:125], v63 offset:8192
    ds_read_b64_tr_b16 v[126:127], v63 offset:8704
    ds_read_b64_tr_b16 v[128:129], v60 offset:12288
    ds_read_b64_tr_b16 v[130:131], v60 offset:12800
    ds_read_b64_tr_b16 v[132:133], v61 offset:12288
    ds_read_b64_tr_b16 v[134:135], v61 offset:12800
    ds_read_b64_tr_b16 v[136:137], v62 offset:12288
    ds_read_b64_tr_b16 v[138:139], v62 offset:12800
    ds_read_b64_tr_b16 v[140:141], v63 offset:12288
    ds_read_b64_tr_b16 v[142:143], v63 offset:12800
    ds_read_b64_tr_b16 v[144:145], v60 offset:16384
    ds_read_b64_tr_b16 v[146:147], v60 offset:16896
    ds_read_b64_tr_b16 v[148:149], v61 offset:16384
    ds_read_b64_tr_b16 v[150:151], v61 offset:16896
    ds_read_b64_tr_b16 v[152:153], v62 offset:16384
    ds_read_b64_tr_b16 v[154:155], v62 offset:16896
    ds_read_b64_tr_b16 v[156:157], v63 offset:16384
    ds_read_b64_tr_b16 v[158:159], v63 offset:16896
    s_cmp_eq_u32 s97, 0
    s_cbranch_scc1 L_u_mm
    s_branch L_poll_3
L_poll_3s:
    s_sleep 8
L_poll_3:
    buffer_load_dwordx4 v[8:11], v5, s[40:43], s63 offen offset:0 sc1
    buffer_load_dwordx4 v[12:15], v5, s[40:43], s63 offen offset:1024 sc1
    buffer_load_dwordx4 v[16:19], v5, s[40:43], s63 offen offset:2048 sc1
    buffer_load_dwordx4 v[20:23], v5, s[40:43], s63 offen offset:3072 sc1
    buffer_load_dwordx4 v[24:27], v5, s[40:43], s12 offen offset:0 sc1
    s_sub_u32 s60, s60, 1
    s_cbranch_scc1 L_poll_3t
    s_waitcnt vmcnt(0)
    v_max3_u32 v37, v8, v9, v10
    v_max3_u32 v37, v37, v11, v12
    v_max3_u32 v37, v37, v13, v14
    v_max3_u32 v37, v37, v15, v16
    v_max3_u32 v37, v37, v17, v18
    v_max3_u32 v37, v37, v19, v20
    v_max3_u32 v37, v37, v21, v22
    v_max3_u32 v37, v37, v23, v24
    v_max3_u32 v37, v37, v25, v26
    v_max_u32 v37, v37, v27
    v_cmp_eq_u32 vcc, -1, v37
    s_cbranch_vccnz L_poll_3s
L_poll_3e:
L_u_got:
L_u_mm:
    s_waitcnt lgkmcnt(0)
    v_mfma_f32_16x16x32_bf16 v[40:43], v[80:83], v[8:11], 0
    v_mfma_f32_16x16x32_bf16 v[44:47], v[84:87], v[8:11], 0
    v_mfma_f32_16x16x32_bf16 v[48:51], v[88:91], v[8:11], 0
    v_mfma_f32_16x16x32_bf16 v[52:55], v[92:95], v[8:11], 0
    v_mfma_f32_16x16x32_bf16 v[40:43], v[96:99], v[12:15], v[40:43]
    v_mfma_f32_16x16x32_bf16 v[44:47], v[100:103], v[12:15], v[44:47]
    v_mfma_f32_16x16x32_bf16 v[48:51], v[104:107], v[12:15], v[48:51]
    v_mfma_f32_16x16x32_bf16 v[52:55], v[108:111], v[12:15], v[52:55]
    v_mfma_f32_16x16x32_bf16 v[40:43], v[112:115], v[16:19], v[40:43]
    v_mfma_f32_16x16x32_bf16 v[44:47], v[116:119], v[16:19], v[44:47]
    v_mfma_f32_16x16x32_bf16 v[48:51], v[120:123], v[16:19], v[48:51]
    v_mfma_f32_16x16x32_bf16 v[52:55], v[124:127], v[16:19], v[52:55]
    v_mfma_f32_16x16x32_bf16 v[40:43], v[128:131], v[20:23], v[40:43]
    v_mfma_f32_16x16x32_bf16 v[44:47], v[132:135], v[20:23], v[44:47]
    v_mfma_f32_16x16x32_bf16 v[48:51], v[136:139], v[20:23], v[48:51]
    v_mfma_f32_16x16x32_bf16 v[52:55], v[140:143], v[20:23], v[52:55]
    v_mfma_f32_16x16x32_bf16 v[40:43], v[144:147], v[24:27], v[40:43]
    v_mfma_f32_16x16x32_bf16 v[44:47], v[148:151], v[24:27], v[44:47]
    v_mfma_f32_16x16x32_bf16 v[48:51], v[152:155], v[24:27], v[48:51]
    v_mfma_f32_16x16x32_bf16 v[52:55], v[156:159], v[24:27], v[52:55]
    v_lshlrev_b32 v5, 4, v0
    v_add_u32 v5, 147456, v5
    s_lshl_b32 s62, s3, 10
    s_add_u32 s62, s62, 147456
    v_lshl_add_u32 v6, v69, 4, s62
    v_mov_b32 v24, s58
    v_mov_b32 v32, 162056
    v_mov_b32 v33, 1
    v_add_f32_dpp v40, v40, v40 row_ror:8 row_mask:0xf bank_mask:0xf
    v_add_f32_dpp v41, v41, v41 row_ror:8 row_mask:0xf bank_mask:0xf
    v_add_f32_dpp v42, v42, v42 row_ror:8 row_mask:0xf bank_mask:0xf
    v_add_f32_dpp v43, v43, v43 row_ror:8 row_mask:0xf bank_mask:0xf
    v_add_f32_dpp v44, v44, v44 row_ror:8 row_mask:0xf bank_mask:0xf
    v_add_f32_dpp v45, v45, v45 row_ror:8 row_mask:0xf bank_mask:0xf
    v_add_f32_dpp v46, v46, v46 row_ror:8 row_mask:0xf bank_mask:0xf
    v_add_f32_dpp v47, v47, v47 row_ror:8 row_mask:0xf bank_mask:0xf
    v_add_f32_dpp v48, v48, v48 row_ror:8 row_mask:0xf bank_mask:0xf
    v_add_f32_dpp v49, v49, v49 row_ror:8 row_mask:0xf bank_mask:0xf
    v_add_f32_dpp v50, v50, v50 row_ror:8 row_mask:0xf bank_mask:0xf
    v_add_f32_dpp v51, v51, v51 row_ror:8 row_mask:0xf bank_mask:0xf
    v_add_f32_dpp v52, v52, v52 row_ror:8 row_mask:0xf bank_mask:0xf
    v_add_f32_dpp v53, v53, v53 row_ror:8 row_mask:0xf bank_mask:0xf
    v_add_f32_dpp v54, v54, v54 row_ror:8 row_mask:0xf bank_mask:0xf
    v_add_f32_dpp v55, v55, v55 row_ror:8 row_mask:0xf bank_mask:0xf
    v_add_f32_dpp v28, v40, v40 row_ror:4 row_mask:0xf bank_mask:0x1
    v_add_f32_dpp v29, v41, v41 row_ror:4 row_mask:0xf bank_mask:0x1
    v_add_f32_dpp v30, v42, v42 row_ror:4 row_mask:0xf bank_mask:0x1
    v_add_f32_dpp v31, v43, v43 row_ror:4 row_mask:0xf bank_mask:0x1
    v_add_f32_dpp v28, v44, v44 row_ror:4 row_mask:0xf bank_mask:0x2
    v_add_f32_dpp v29, v45, v45 row_ror:4 row_mask:0xf bank_mask:0x2
    v_add_f32_dpp v30, v46, v46 row_ror:4 row_mask:0xf bank_mask:0x2
    v_add_f32_dpp v31, v47, v47 row_ror:4 row_mask:0xf bank_mask:0x2
    v_add_f32_dpp v28, v48, v48 row_ror:4 row_mask:0xf bank_mask:0x4
    v_add_f32_dpp v29, v49, v49 row_ror:4 row_mask:0xf bank_mask:0x4
    v_add_f32_dpp v30, v50, v50 row_ror:4 row_mask:0xf bank_mask:0x4
    v_add_f32_dpp v31, v51, v51 row_ror:4 row_mask:0xf bank_mask:0x4
    v_add_f32_dpp v28, v52, v52 row_ror:4 row_mask:0xf bank_mask:0x8
    v_add_f32_dpp v29, v53, v53 row_ror:4 row_mask:0xf bank_mask:0x8
    v_add_f32_dpp v30, v54, v54 row_ror:4 row_mask:0xf bank_mask:0x8
    v_add_f32_dpp v31, v55, v55 row_ror:4 row_mask:0xf bank_mask:0x8
    v_fma_f32 v28, v28, s59, v24
    v_fma_f32 v29, v29, s59, v24
    v_fma_f32 v30, v30, s59, v24
    v_fma_f32 v31, v31, s59, v24
    v_mul_f32 v28, v28, v56
    v_mul_f32 v29, v29, v57
    v_mul_f32 v30, v30, v58
    v_mul_f32 v31, v31, v59
    ds_write_b128 v6, v[28:31]
    s_mov_b64 exec, 1
    ds_add_rtn_u32 v34, v32, v33
    s_mov_b64 exec, -1
    ds_read_b128 v[8:11], v5
    ds_read_b128 v[12:15], v5 offset:1024
    ds_read_b128 v[16:19], v5 offset:2048
    ds_read_b128 v[20:23], v5 offset:3072
    s_waitcnt lgkmcnt(0)
    v_readfirstlane_b32 s62, v34
    s_nop 0
    s_cmp_eq_u32 s62, s15
    s_cbranch_scc1 L_u_last
    s_cmp_eq_u32 s62, 1
    s_cbranch_scc1 L_service
    s_endpgm
L_u_last:
    v_add_f32 v8, v8, v12
    v_add_f32 v9, v9, v13
    v_add_f32 v10, v10, v14
    v_add_f32 v11, v11, v15
    s_cmp_eq_u32 s15, 1
    s_cbranch_scc1 L_u_two
    v_add_f32 v16, v16, v20
    v_add_f32 v17, v17, v21
    v_add_f32 v18, v18, v22
    v_add_f32 v19, v19, v23
    v_add_f32 v8, v8, v16
    v_add_f32 v9, v9, v17
    v_add_f32 v10, v10, v18
    v_add_f32 v11, v11, v19
L_u_two:
    v_cvt_pk_bf16_f32 v8, v8, v9
    v_cvt_pk_bf16_f32 v9, v10, v11
    buffer_store_dwordx2 v[8:9], v64, s[40:43], s57 offen sc1
    s_endpgm
L_touch:
    s_load_dword s0, s[32:33], 0
    s_load_dword s0, s[30:31], 0
    s_cmp_eq_u32 s39, 1
    s_cbranch_scc1 L_tpr
    s_mov_b32 s62, 16777216
    s_load_dword s0, s[8:9], s62
    s_mov_b32 s62, 83886080
    s_load_dword s0, s[8:9], s62
    s_mov_b32 s62, 150994944
    s_load_dword s0, s[8:9], s62
    s_mov_b32 s62, 218103808
    s_load_dword s0, s[8:9], s62
    s_branch L_tpv
L_tpr:
    s_load_dword s0, s[20:21], 0
    s_mov_b32 s62, 2211836
    s_load_dword s0, s[20:21], s62
    s_load_dword s0, s[16:17], 0
    s_mov_b32 s62, 2211836
    s_load_dword s0, s[16:17], s62
    s_load_dword s0, s[18:19], 0
    s_load_dword s0, s[22:23], 0
    s_load_dword s0, s[28:29], 0
    s_load_dword s0, s[4:5], 0
L_tpv:
    s_lshl_b32 s62, s34, 23
    s_load_dword s0, s[8:9], s62
    s_add_u32 s62, s62, 67108864
    s_load_dword s0, s[8:9], s62
    s_add_u32 s62, s62, 67108864
    s_load_dword s0, s[8:9], s62
    s_add_u32 s62, s62, 67108864
    s_load_dword s0, s[8:9], s62
    s_add_u32 s62, s62, 67108864
    s_branch L_notp
L_stream2:
    s_mov_b32 s12, s100
    s_mov_b32 s13, s101
    s_mov_b32 s40, s32
    s_mov_b32 s41, s33
    s_mov_b32 s42, 589824
    s_mov_b32 s43, 0x20000
    s_mov_b32 s44, s30
    s_mov_b32 s45, s31
    s_mov_b32 s46, 256
    s_mov_b32 s47, 0x20000
    s_bitcmp1_b32 s3, 0
    s_mov_b32 s57, 0xffffffff
    s_mov_b32 s58, 0xffff
    s_mov_b32 s14, 0xffffffff
    s_mov_b32 s15, 0x0
L_pm_9:
    s_cmp_lt_u32 s56, 104
    s_cbranch_scc0 L_pm_10
    s_bitcmp1_b32 s3, 0
    s_mov_b32 s57, 0xffff
    s_mov_b32 s58, 0x0
    s_mov_b32 s14, 0xffffffff
    s_mov_b32 s15, 0x0
L_pm_10:
    s_sub_u32 s96, s56, 43
    s_and_b32 s96, s96, 0xffffffc7
    s_cmp_eq_u32 s96, 0
    s_cbranch_scc0 L_pm_11
    s_bitcmp1_b32 s3, 0
    s_mov_b32 s57, 0x0
    s_mov_b32 s58, 0x0
    s_mov_b32 s14, 0x0
    s_mov_b32 s15, 0x0
L_pm_11:
    s_cmp_lt_u32 s56, 40
    s_cbranch_scc0 L_pm_12
    s_bitcmp1_b32 s3, 0
    s_mov_b32 s57, 0xffffffff
    s_mov_b32 s58, 0xf
    s_mov_b32 s14, 0xffffffff
    s_mov_b32 s15, 0x0
L_pm_12:
    s_cmp_eq_u32 s39, 1
    s_cbranch_scc0 L_pm_13
    s_bitcmp1_b32 s3, 0
    s_mov_b32 s57, 0xff0fff
    s_cselect_b32 s57, 0xff00ffff, s57
    s_mov_b32 s58, 0xfff
    s_mov_b32 s14, 0xff00ff
    s_cselect_b32 s14, 0xff00ff00, s14
    s_mov_b32 s15, 0x0
L_pm_13:
    s_cmp_lg_u32 s13, 0
    s_cbranch_scc0 L_pm_14
    s_bitcmp1_b32 s3, 0
    s_mov_b32 s57, 0xff00ff
    s_cselect_b32 s57, 0xff00ff00, s57
    s_mov_b32 s58, 0x0
    s_mov_b32 s14, 0x0
    s_mov_b32 s15, 0x0
L_pm_14:
    s_and_b32 s96, s39, s59
    s_cbranch_scc0 L_pm_15
    s_bitcmp1_b32 s3, 0
    s_mov_b32 s57, 0xffff
    s_mov_b32 s58, 0xffff
    s_mov_b32 s14, 0x0
    s_mov_b32 s15, 0x0
L_pm_15:
    s_add_u32 s52, s8, s63
    s_addc_u32 s53, s9, 0
    s_mov_b32 s54, 262144
    s_mov_b32 s55, 0x20000
    v_and_b32 v2, 15, v0
    v_lshrrev_b32 v3, 1, v2
    v_and_b32 v37, 1, v2
    v_lshlrev_b32 v37, 4, v37
    v_mov_b32 v38, 0xffff
    v_lshlrev_b32 v37, v37, v38
    v_cmp_eq_u32 vcc, 0, v3
    v_mov_b32 v32, 0
    s_nop 0
    v_cndmask_b32 v20, 0, v37, vcc
    v_cmp_eq_u32 vcc, 1, v3
    v_mov_b32 v33, 0
    s_nop 0
    v_cndmask_b32 v21, 0, v37, vcc
    v_cmp_eq_u32 vcc, 2, v3
    v_mov_b32 v34, 0
    s_nop 0
    v_cndmask_b32 v22, 0, v37, vcc
    v_cmp_eq_u32 vcc, 3, v3
    v_mov_b32 v35, 0
    s_nop 0
    v_cndmask_b32 v23, 0, v37, vcc
    v_lshlrev_b32 v2, 4, v2
    s_lshl_b32 s98, s62, 8
    s_add_u32 s98, s98, 40960
    s_lshl_b32 s99, s62, 7
    s_add_u32 s99, s99, 73728
    s_bitcmp0_b32 s57, 2
    s_cbranch_scc1 L_sf_16
    s_bitcmp0_b32 s58, 2
    s_cbranch_scc1 L_sf_16
    s_waitcnt vmcnt(1)
L_sf_16:
    buffer_load_dwordx4 v[48:51], v1, s[48:51], s97 offen offset:2048 nt
    s_bitcmp0_b32 s57, 3
    s_cbranch_scc1 L_sf_17
    s_waitcnt vmcnt(2)
    s_bitcmp0_b32 s58, 3
    s_cbranch_scc1 L_sf_17
    s_waitcnt vmcnt(1)
L_sf_17:
    buffer_load_dwordx4 v[52:55], v1, s[48:51], s97 offen offset:3072 nt
    s_add_u32 s97, s97, 32768
    v_add_u32 v1, 4096, v1
    v_and_b32 v1, 0x7fff, v1
    s_waitcnt vmcnt(3)
    s_bitcmp0_b32 s57, 4
    s_cbranch_scc1 L_sf_18
    s_waitcnt vmcnt(2)
    s_bitcmp0_b32 s58, 4
    s_cbranch_scc1 L_sf_18
    s_waitcnt vmcnt(1)
L_sf_18:
    buffer_load_dwordx4 v[56:59], v1, s[48:51], s97 offen offset:0 nt
    s_waitcnt vmcnt(3)
    s_bitcmp0_b32 s57, 5
    s_cbranch_scc1 L_sf_19
    s_waitcnt vmcnt(2)
    s_bitcmp0_b32 s58, 5
    s_cbranch_scc1 L_sf_19
    s_waitcnt vmcnt(1)
L_sf_19:
    buffer_load_dwordx4 v[60:63], v1, s[48:51], s97 offen offset:1024 nt
    s_waitcnt vmcnt(3)
    s_bitcmp0_b32 s57, 6
    s_cbranch_scc1 L_sf_20
    s_waitcnt vmcnt(2)
    s_bitcmp0_b32 s58, 6
    s_cbranch_scc1 L_sf_20
    s_waitcnt vmcnt(1)
L_sf_20:
    buffer_load_dwordx4 v[64:67], v1, s[48:51], s97 offen offset:2048 nt
    s_waitcnt vmcnt(3)
    s_bitcmp0_b32 s57, 7
    s_cbranch_scc1 L_sf_21
    s_waitcnt vmcnt(2)
    s_bitcmp0_b32 s58, 7
    s_cbranch_scc1 L_sf_21
    s_waitcnt vmcnt(1)
L_sf_21:
    buffer_load_dwordx4 v[68:71], v1, s[48:51], s97 offen offset:3072 nt
    s_add_u32 s97, s97, 32768
    v_add_u32 v1, 4096, v1
    v_and_b32 v1, 0x7fff, v1
    s_waitcnt vmcnt(3)
    s_bitcmp0_b32 s57, 8
    s_cbranch_scc1 L_sf_22
    s_waitcnt vmcnt(2)
    s_bitcmp0_b32 s58, 8
    s_cbranch_scc1 L_sf_22
    s_waitcnt vmcnt(1)
L_sf_22:
    buffer_load_dwordx4 v[72:75], v1, s[48:51], s97 offen offset:0 nt
    s_waitcnt vmcnt(3)
    s_bitcmp0_b32 s57, 9
    s_cbranch_scc1 L_sf_23
    s_waitcnt vmcnt(2)
    s_bitcmp0_b32 s58, 9
    s_cbranch_scc1 L_sf_23
    s_waitcnt vmcnt(1)
L_sf_23:
    buffer_load_dwordx4 v[76:79], v1, s[48:51], s97 offen offset:1024 nt
    s_waitcnt vmcnt(3)
    s_bitcmp0_b32 s57, 10
    s_cbranch_scc1 L_sf_24
    s_waitcnt vmcnt(2)
    s_bitcmp0_b32 s58, 10
    s_cbranch_scc1 L_sf_24
    s_waitcnt vmcnt(1)
L_sf_24:
    buffer_load_dwordx4 v[80:83], v1, s[48:51], s97 offen offset:2048 nt
    s_waitcnt vmcnt(3)
    s_bitcmp0_b32 s57, 11
    s_cbranch_scc1 L_sf_25
    s_waitcnt vmcnt(2)
    s_bitcmp0_b32 s58, 11
    s_cbranch_scc1 L_sf_25
    s_waitcnt vmcnt(1)
L_sf_25:
    buffer_load_dwordx4 v[84:87], v1, s[48:51], s97 offen offset:3072 nt
    s_add_u32 s97, s97, 32768
    v_add_u32 v1, 4096, v1
    v_and_b32 v1, 0x7fff, v1
    s_waitcnt vmcnt(3)
    s_bitcmp0_b32 s57, 12
    s_cbranch_scc1 L_sf_26
    s_waitcnt vmcnt(2)
    s_bitcmp0_b32 s58, 12
    s_cbranch_scc1 L_sf_26
    s_waitcnt vmcnt(1)
L_sf_26:
    buffer_load_dwordx4 v[88:91], v1, s[48:51], s97 offen offset:0 nt
    s_waitcnt vmcnt(3)
    s_bitcmp0_b32 s57, 13
    s_cbranch_scc1 L_sf_27
    s_waitcnt vmcnt(2)
    s_bitcmp0_b32 s58, 13
    s_cbranch_scc1 L_sf_27
    s_waitcnt vmcnt(1)
L_sf_27:
    buffer_load_dwordx4 v[92:95], v1, s[48:51], s97 offen offset:1024 nt
    s_waitcnt vmcnt(3)
    s_bitcmp0_b32 s57, 14
    s_cbranch_scc1 L_sf_28
    s_waitcnt vmcnt(2)
    s_bitcmp0_b32 s58, 14
    s_cbranch_scc1 L_sf_28
    s_waitcnt vmcnt(1)
L_sf_28:
    buffer_load_dwordx4 v[96:99], v1, s[48:51], s97 offen offset:2048 nt
    s_waitcnt vmcnt(3)
    s_bitcmp0_b32 s57, 15
    s_cbranch_scc1 L_sf_29
    s_waitcnt vmcnt(2)
    s_bitcmp0_b32 s58, 15
    s_cbranch_scc1 L_sf_29
    s_waitcnt vmcnt(1)
L_sf_29:
    buffer_load_dwordx4 v[100:103], v1, s[48:51], s97 offen offset:3072 nt
    s_add_u32 s97, s97, 32768
    v_add_u32 v1, 4096, v1
    v_and_b32 v1, 0x7fff, v1
    s_waitcnt vmcnt(3)
    s_bitcmp0_b32 s57, 16
    s_cbranch_scc1 L_sf_30
    s_waitcnt vmcnt(2)
    s_bitcmp0_b32 s58, 16
    s_cbranch_scc1 L_sf_30
    s_waitcnt vmcnt(1)
L_sf_30:
    buffer_load_dwordx4 v[104:107], v1, s[48:51], s97 offen offset:0 nt
    s_waitcnt vmcnt(3)
    s_bitcmp0_b32 s57, 17
    s_cbranch_scc1 L_sf_31
    s_waitcnt vmcnt(2)
    s_bitcmp0_b32 s58, 17
    s_cbranch_scc1 L_sf_31
    s_waitcnt vmcnt(1)
L_sf_31:
    buffer_load_dwordx4 v[108:111], v1, s[48:51], s97 offen offset:1024 nt
    s_waitcnt vmcnt(3)
    s_bitcmp0_b32 s57, 18
    s_cbranch_scc1 L_sf_32
    s_waitcnt vmcnt(2)
    s_bitcmp0_b32 s58, 18
    s_cbranch_scc1 L_sf_32
    s_waitcnt vmcnt(1)
L_sf_32:
    buffer_load_dwordx4 v[112:115], v1, s[48:51], s97 offen offset:2048 nt
    s_waitcnt vmcnt(3)
    s_bitcmp0_b32 s57, 19
    s_cbranch_scc1 L_sf_33
    s_waitcnt vmcnt(2)
    s_bitcmp0_b32 s58, 19
    s_cbranch_scc1 L_sf_33
    s_waitcnt vmcnt(1)
L_sf_33:
    buffer_load_dwordx4 v[116:119], v1, s[48:51], s97 offen offset:3072 nt
    s_add_u32 s97, s97, 32768
    v_add_u32 v1, 4096, v1
    v_and_b32 v1, 0x7fff, v1
    s_waitcnt vmcnt(3)
    s_bitcmp0_b32 s57, 20
    s_cbranch_scc1 L_sf_34
    s_waitcnt vmcnt(2)
    s_bitcmp0_b32 s58, 20
    s_cbranch_scc1 L_sf_34
    s_waitcnt vmcnt(1)
L_sf_34:
    buffer_load_dwordx4 v[120:123], v1, s[48:51], s97 offen offset:0 nt
    s_waitcnt vmcnt(3)
    s_bitcmp0_b32 s57, 21
    s_cbranch_scc1 L_sf_35
    s_waitcnt vmcnt(2)
    s_bitcmp0_b32 s58, 21
    s_cbranch_scc1 L_sf_35
    s_waitcnt vmcnt(1)
L_sf_35:
    buffer_load_dwordx4 v[124:127], v1, s[48:51], s97 offen offset:1024 nt
    s_cmp_eq_u32 s12, -1
    s_cbranch_scc1 L_k_nopf
    s_waitcnt vmcnt(3)
    s_bitcmp0_b32 s57, 22
    s_cbranch_scc1 L_sf_36
    s_waitcnt vmcnt(2)
    s_bitcmp0_b32 s58, 22
    s_cbranch_scc1 L_sf_36
    s_waitcnt vmcnt(1)
L_sf_36:
    buffer_load_dwordx4 v[128:131], v1, s[48:51], s97 offen offset:2048 nt
    s_waitcnt vmcnt(3)
    s_bitcmp0_b32 s57, 23
    s_cbranch_scc1 L_sf_37
    s_waitcnt vmcnt(2)
    s_bitcmp0_b32 s58, 23
    s_cbranch_scc1 L_sf_37
    s_waitcnt vmcnt(1)
L_sf_37:
    buffer_load_dwordx4 v[132:135], v1, s[48:51], s97 offen offset:3072 nt
    s_add_u32 s97, s97, 32768
    v_add_u32 v1, 4096, v1
    v_and_b32 v1, 0x7fff, v1
    s_waitcnt vmcnt(3)
    s_bitcmp0_b32 s57, 24
    s_cbranch_scc1 L_sf_38
    s_waitcnt vmcnt(2)
    s_bitcmp0_b32 s58, 24
    s_cbranch_scc1 L_sf_38
    s_waitcnt vmcnt(1)
L_sf_38:
    buffer_load_dwordx4 v[136:139], v1, s[48:51], s97 offen offset:0 nt
    s_waitcnt vmcnt(3)
    s_bitcmp0_b32 s57, 25
    s_cbranch_scc1 L_sf_39
    s_waitcnt vmcnt(2)
    s_bitcmp0_b32 s58, 25
    s_cbranch_scc1 L_sf_39
    s_waitcnt vmcnt(1)
L_sf_39:
    buffer_load_dwordx4 v[140:143], v1, s[48:51], s97 offen offset:1024 nt
    s_waitcnt vmcnt(3)
    s_bitcmp0_b32 s57, 26
    s_cbranch_scc1 L_sf_40
    s_waitcnt vmcnt(2)
    s_bitcmp0_b32 s58, 26
    s_cbranch_scc1 L_sf_40
    s_waitcnt vmcnt(1)
L_sf_40:
    buffer_load_dwordx4 v[144:147], v1, s[48:51], s97 offen offset:2048 nt
    s_waitcnt vmcnt(3)
    s_bitcmp0_b32 s57, 27
    s_cbranch_scc1 L_sf_41
    s_waitcnt vmcnt(2)
    s_bitcmp0_b32 s58, 27
    s_cbranch_scc1 L_sf_41
    s_waitcnt vmcnt(1)
L_sf_41:
    buffer_load_dwordx4 v[148:151], v1, s[48:51], s97 offen offset:3072 nt
    s_add_u32 s97, s97, 32768
    v_add_u32 v1, 4096, v1
    v_and_b32 v1, 0x7fff, v1
    s_waitcnt vmcnt(3)
    s_bitcmp0_b32 s57, 28
    s_cbranch_scc1 L_sf_42
    s_waitcnt vmcnt(2)
    s_bitcmp0_b32 s58, 28
    s_cbranch_scc1 L_sf_42
    s_waitcnt vmcnt(1)
L_sf_42:
    buffer_load_dwordx4 v[152:155], v1, s[48:51], s97 offen offset:0 nt
    s_waitcnt vmcnt(3)
    s_bitcmp0_b32 s57, 29
    s_cbranch_scc1 L_sf_43
    s_waitcnt vmcnt(2)
    s_bitcmp0_b32 s58, 29
    s_cbranch_scc1 L_sf_43
    s_waitcnt vmcnt(1)
L_sf_43:
    buffer_load_dwordx4 v[156:159], v1, s[48:51], s97 offen offset:1024 nt
    s_waitcnt vmcnt(3)
    s_bitcmp0_b32 s57, 30
    s_cbranch_scc1 L_sf_44
    s_waitcnt vmcnt(2)
    s_bitcmp0_b32 s58, 30
    s_cbranch_scc1 L_sf_44
    s_waitcnt vmcnt(1)
L_sf_44:
    buffer_load_dwordx4 v[160:163], v1, s[48:51], s97 offen offset:2048 nt
    v_min_u32 v39, 29, v0
    v_lshlrev_b32 v39, 2, v39
    buffer_load_dword v37, v39, s[44:47], 0 offen sc1
    s_waitcnt vmcnt(4)
    s_bitcmp0_b32 s57, 31
    s_cbranch_scc1 L_sf_45
    s_waitcnt vmcnt(3)
    s_bitcmp0_b32 s58, 31
    s_cbranch_scc1 L_sf_45
    s_waitcnt vmcnt(2)
L_sf_45:
    buffer_load_dwordx4 v[164:167], v1, s[48:51], s97 offen offset:3072 nt
    s_mov_b32 s97, 0
    v_add_u32 v1, 4096, v1
    v_and_b32 v1, 0x7fff, v1
    s_waitcnt vmcnt(4)
    s_bitcmp0_b32 s14, 0
    s_cbranch_scc1 L_sf_46
    s_waitcnt vmcnt(3)
    s_bitcmp0_b32 s15, 0
    s_cbranch_scc1 L_sf_46
    s_waitcnt vmcnt(2)
L_sf_46:
    s_add_u32 m0, s12, 0
    s_nop 0
    buffer_load_dwordx4 v1, s[52:55], s97 offen offset:0 nt lds
    s_waitcnt vmcnt(4)
    s_bitcmp0_b32 s14, 1
    s_cbranch_scc1 L_sf_47
    s_waitcnt vmcnt(3)
    s_bitcmp0_b32 s15, 1
    s_cbranch_scc1 L_sf_47
    s_waitcnt vmcnt(1)
L_sf_47:
    buffer_load_dwordx4 v1, s[52:55], s97 offen offset:1024 nt lds
    s_waitcnt vmcnt(4)
    s_bitcmp0_b32 s14, 2
    s_cbranch_scc1 L_sf_48
    s_waitcnt vmcnt(2)
    s_bitcmp0_b32 s15, 2
    s_cbranch_scc1 L_sf_48
    s_waitcnt vmcnt(1)
L_sf_48:
    buffer_load_dwordx4 v1, s[52:55], s97 offen offset:2048 nt lds
    s_waitcnt vmcnt(3)
    s_bitcmp0_b32 s14, 3
    s_cbranch_scc1 L_sf_49
    s_waitcnt vmcnt(2)
    s_bitcmp0_b32 s15, 3
    s_cbranch_scc1 L_sf_49
    s_waitcnt vmcnt(1)
L_sf_49:
    buffer_load_dwordx4 v1, s[52:55], s97 offen offset:3072 nt lds
    s_add_u32 s97, s97, 32768
    v_add_u32 v1, 4096, v1
    v_and_b32 v1, 0x7fff, v1
    v_cmp_eq_u32 vcc, 0, v37
    s_nop 0
    s_or_b32 s96, vcc_lo, vcc_hi
    buffer_load_dwordx4 v[4:7], v2, s[40:43], s98 offen sc1
    s_waitcnt vmcnt(4)
    s_bitcmp0_b32 s14, 4
    s_cbranch_scc1 L_sf_50
    s_waitcnt vmcnt(3)
    s_bitcmp0_b32 s15, 4
    s_cbranch_scc1 L_sf_50
    s_waitcnt vmcnt(2)
L_sf_50:
    s_add_u32 m0, s12, 4096
    s_nop 0
    buffer_load_dwordx4 v1, s[52:55], s97 offen offset:0 nt lds
    s_waitcnt vmcnt(4)
    s_bitcmp0_b32 s14, 5
    s_cbranch_scc1 L_sf_51
    s_waitcnt vmcnt(3)
    s_bitcmp0_b32 s15, 5
    s_cbranch_scc1 L_sf_51
    s_waitcnt vmcnt(2)
L_sf_51:
    buffer_load_dwordx4 v1, s[52:55], s97 offen offset:1024 nt lds
    s_waitcnt vmcnt(4)
    s_bitcmp0_b32 s14, 6
    s_cbranch_scc1 L_sf_52
    s_waitcnt vmcnt(3)
    s_bitcmp0_b32 s15, 6
    s_cbranch_scc1 L_sf_52
    s_waitcnt vmcnt(1)
L_sf_52:
    buffer_load_dwordx4 v1, s[52:55], s97 offen offset:2048 nt lds
    s_waitcnt vmcnt(4)
    s_bitcmp0_b32 s14, 7
    s_cbranch_scc1 L_sf_53
    s_waitcnt vmcnt(2)
    s_bitcmp0_b32 s15, 7
    s_cbranch_scc1 L_sf_53
    s_waitcnt vmcnt(1)
L_sf_53:
    buffer_load_dwordx4 v1, s[52:55], s97 offen offset:3072 nt lds
    s_add_u32 s97, s97, 32768
    v_add_u32 v1, 4096, v1
    v_and_b32 v1, 0x7fff, v1
L_k_join:
    s_waitcnt vmcnt(4)
    v_max3_u32 v38, v4, v5, v6
    v_max_u32 v38, v38, v7
    v_cmp_eq_u32 vcc, -1, v38
    s_cmp_lg_u32 s96, 0
    s_cbranch_scc1 L_qslow
    s_cbranch_vccnz L_qslow2
L_qok:
    v_dot2_f32_bf16 v8, v72, v4, 0
    v_dot2_f32_bf16 v9, v76, v4, 0
    v_dot2_f32_bf16 v10, v80, v4, 0
    v_dot2_f32_bf16 v11, v84, v4, 0
    v_dot2_f32_bf16 v24, v88, v4, 0
    v_dot2_f32_bf16 v25, v92, v4, 0
    v_dot2_f32_bf16 v26, v96, v4, 0
    v_dot2_f32_bf16 v27, v100, v4, 0
    v_dot2_f32_bf16 v8, v73, v5, v8
    v_dot2_f32_bf16 v9, v77, v5, v9
    v_dot2_f32_bf16 v10, v81, v5, v10
    v_dot2_f32_bf16 v11, v85, v5, v11
    v_dot2_f32_bf16 v24, v89, v5, v24
    v_dot2_f32_bf16 v25, v93, v5, v25
    v_dot2_f32_bf16 v26, v97, v5, v26
    v_dot2_f32_bf16 v27, v101, v5, v27
    v_dot2_f32_bf16 v8, v74, v6, v8
    v_dot2_f32_bf16 v9, v78, v6, v9
    v_dot2_f32_bf16 v10, v82, v6, v10
    v_dot2_f32_bf16 v11, v86, v6, v11
    v_dot2_f32_bf16 v24, v90, v6, v24
    v_dot2_f32_bf16 v25, v94, v6, v25
    v_dot2_f32_bf16 v26, v98, v6, v26
    v_dot2_f32_bf16 v27, v102, v6, v27
    v_dot2_f32_bf16 v8, v75, v7, v8
    v_dot2_f32_bf16 v9, v79, v7, v9
    v_dot2_f32_bf16 v10, v83, v7, v10
    v_dot2_f32_bf16 v11, v87, v7, v11
    v_dot2_f32_bf16 v24, v91, v7, v24
    v_dot2_f32_bf16 v25, v95, v7, v25
    v_dot2_f32_bf16 v26, v99, v7, v26
    v_dot2_f32_bf16 v27, v103, v7, v27
    v_add_f32_dpp v8, v8, v8 row_ror:8 row_mask:0xf bank_mask:0x3
    v_add_f32_dpp v10, v10, v10 row_ror:8 row_mask:0xf bank_mask:0x3
    v_add_f32_dpp v24, v24, v24 row_ror:8 row_mask:0xf bank_mask:0x3
    v_add_f32_dpp v26, v26, v26 row_ror:8 row_mask:0xf bank_mask:0x3
    v_add_f32_dpp v8, v9, v9 row_ror:8 row_mask:0xf bank_mask:0xc
    v_add_f32_dpp v10, v11, v11 row_ror:8 row_mask:0xf bank_mask:0xc
    v_add_f32_dpp v24, v25, v25 row_ror:8 row_mask:0xf bank_mask:0xc
    v_add_f32_dpp v26, v27, v27 row_ror:8 row_mask:0xf bank_mask:0xc
    v_add_f32_dpp v14, v8, v8 row_half_mirror row_mask:0xf bank_mask:0x5
    v_add_f32_dpp v15, v24, v24 row_half_mirror row_mask:0xf bank_mask:0x5
    v_add_f32_dpp v14, v10, v10 row_half_mirror row_mask:0xf bank_mask:0xa
    v_add_f32_dpp v15, v26, v26 row_half_mirror row_mask:0xf bank_mask:0xa
    s_nop 0
    v_add_f32_dpp v14, v14, v14 quad_perm:[1,0,3,2] row_mask:0xf bank_mask:0xf
    v_add_f32_dpp v15, v15, v15 quad_perm:[1,0,3,2] row_mask:0xf bank_mask:0xf
    s_nop 0
    v_add_f32_dpp v14, v14, v14 quad_perm:[2,3,0,1] row_mask:0xf bank_mask:0xf
    v_add_f32_dpp v15, v15, v15 quad_perm:[2,3,0,1] row_mask:0xf bank_mask:0xf
    s_waitcnt vmcnt(3)
    s_bitcmp0_b32 s14, 8
    s_cbranch_scc1 L_sf_64
    s_waitcnt vmcnt(2)
    s_bitcmp0_b32 s15, 8
    s_cbranch_scc1 L_sf_64
    s_waitcnt vmcnt(1)
L_sf_64:
    buffer_load_dwordx4 v[72:75], v1, s[52:55], s97 offen offset:0 nt
    v_dot2_f32_bf16 v8, v40, v4, 0
    v_dot2_f32_bf16 v9, v44, v4, 0
    v_dot2_f32_bf16 v10, v48, v4, 0
    v_dot2_f32_bf16 v11, v52, v4, 0
    v_dot2_f32_bf16 v24, v56, v4, 0
    v_dot2_f32_bf16 v25, v60, v4, 0
    v_dot2_f32_bf16 v26, v64, v4, 0
    v_dot2_f32_bf16 v27, v68, v4, 0
    v_dot2_f32_bf16 v28, v104, v4, 0
    v_dot2_f32_bf16 v29, v108, v4, 0
    v_dot2_f32_bf16 v30, v112, v4, 0
    v_dot2_f32_bf16 v31, v116, v4, 0
    v_dot2_f32_bf16 v8, v41, v5, v8
    v_dot2_f32_bf16 v9, v45, v5, v9
    v_dot2_f32_bf16 v10, v49, v5, v10
    v_dot2_f32_bf16 v11, v53, v5, v11
    v_dot2_f32_bf16 v24, v57, v5, v24
    v_dot2_f32_bf16 v25, v61, v5, v25
    v_dot2_f32_bf16 v26, v65, v5, v26
    v_dot2_f32_bf16 v27, v69, v5, v27
    v_dot2_f32_bf16 v28, v105, v5, v28
    v_dot2_f32_bf16 v29, v109, v5, v29
    v_dot2_f32_bf16 v30, v113, v5, v30
    v_dot2_f32_bf16 v31, v117, v5, v31
    v_dot2_f32_bf16 v8, v42, v6, v8
    v_dot2_f32_bf16 v9, v46, v6, v9
    v_dot2_f32_bf16 v10, v50, v6, v10
    v_dot2_f32_bf16 v11, v54, v6, v11
    v_dot2_f32_bf16 v24, v58, v6, v24
    v_dot2_f32_bf16 v25, v62, v6, v25
    v_dot2_f32_bf16 v26, v66, v6, v26
    v_dot2_f32_bf16 v27, v70, v6, v27
    v_dot2_f32_bf16 v28, v106, v6, v28
    v_dot2_f32_bf16 v29, v110, v6, v29
    v_dot2_f32_bf16 v30, v114, v6, v30
    v_dot2_f32_bf16 v31, v118, v6, v31
    v_dot2_f32_bf16 v8, v43, v7, v8
    v_dot2_f32_bf16 v9, v47, v7, v9
    v_dot2_f32_bf16 v10, v51, v7, v10
    v_dot2_f32_bf16 v11, v55, v7, v11
    v_dot2_f32_bf16 v24, v59, v7, v24
    v_dot2_f32_bf16 v25, v63, v7, v25
    v_dot2_f32_bf16 v26, v67, v7, v26
    v_dot2_f32_bf16 v27, v71, v7, v27
    v_dot2_f32_bf16 v28, v107, v7, v28
    v_dot2_f32_bf16 v29, v111, v7, v29
    v_dot2_f32_bf16 v30, v115, v7, v30
    v_dot2_f32_bf16 v31, v119, v7, v31
    v_add_f32_dpp v8, v8, v8 row_ror:8 row_mask:0xf bank_mask:0x3
    v_add_f32_dpp v10, v10, v10 row_ror:8 row_mask:0xf bank_mask:0x3
    v_add_f32_dpp v24, v24, v24 row_ror:8 row_mask:0xf bank_mask:0x3
    v_add_f32_dpp v26, v26, v26 row_ror:8 row_mask:0xf bank_mask:0x3
    v_add_f32_dpp v28, v28, v28 row_ror:8 row_mask:0xf bank_mask:0x3
    v_add_f32_dpp v30, v30, v30 row_ror:8 row_mask:0xf bank_mask:0x3
    v_add_f32_dpp v8, v9, v9 row_ror:8 row_mask:0xf bank_mask:0xc
    v_add_f32_dpp v10, v11, v11 row_ror:8 row_mask:0xf bank_mask:0xc
    v_add_f32_dpp v24, v25, v25 row_ror:8 row_mask:0xf bank_mask:0xc
    v_add_f32_dpp v26, v27, v27 row_ror:8 row_mask:0xf bank_mask:0xc
    v_add_f32_dpp v28, v29, v29 row_ror:8 row_mask:0xf bank_mask:0xc
    v_add_f32_dpp v30, v31, v31 row_ror:8 row_mask:0xf bank_mask:0xc
    v_add_f32_dpp v12, v8, v8 row_half_mirror row_mask:0xf bank_mask:0x5
    v_add_f32_dpp v13, v24, v24 row_half_mirror row_mask:0xf bank_mask:0x5
    v_add_f32_dpp v16, v28, v28 row_half_mirror row_mask:0xf bank_mask:0x5
    v_add_f32_dpp v12, v10, v10 row_half_mirror row_mask:0xf bank_mask:0xa
    v_add_f32_dpp v13, v26, v26 row_half_mirror row_mask:0xf bank_mask:0xa
    v_add_f32_dpp v16, v30, v30 row_half_mirror row_mask:0xf bank_mask:0xa
    v_add_f32_dpp v12, v12, v12 quad_perm:[1,0,3,2] row_mask:0xf bank_mask:0xf
    v_add_f32_dpp v13, v13, v13 quad_perm:[1,0,3,2] row_mask:0xf bank_mask:0xf
    v_add_f32_dpp v16, v16, v16 quad_perm:[1,0,3,2] row_mask:0xf bank_mask:0xf
    v_add_f32_dpp v12, v12, v12 quad_perm:[2,3,0,1] row_mask:0xf bank_mask:0xf
    v_add_f32_dpp v13, v13, v13 quad_perm:[2,3,0,1] row_mask:0xf bank_mask:0xf
    v_add_f32_dpp v16, v16, v16 quad_perm:[2,3,0,1] row_mask:0xf bank_mask:0xf
    s_waitcnt vmcnt(3)
    s_bitcmp0_b32 s14, 9
    s_cbranch_scc1 L_sf_65
    s_waitcnt vmcnt(2)
    s_bitcmp0_b32 s15, 9
    s_cbranch_scc1 L_sf_65
    s_waitcnt vmcnt(1)
L_sf_65:
    buffer_load_dwordx4 v[76:79], v1, s[52:55], s97 offen offset:1024 nt
    v_dot2_f32_bf16 v8, v120, v4, 0
    v_dot2_f32_bf16 v9, v124, v4, 0
    v_dot2_f32_bf16 v10, v128, v4, 0
    v_dot2_f32_bf16 v11, v132, v4, 0
    v_dot2_f32_bf16 v24, v136, v4, 0
    v_dot2_f32_bf16 v25, v140, v4, 0
    v_dot2_f32_bf16 v26, v144, v4, 0
    v_dot2_f32_bf16 v27, v148, v4, 0
    v_dot2_f32_bf16 v8, v121, v5, v8
    v_dot2_f32_bf16 v9, v125, v5, v9
    v_dot2_f32_bf16 v10, v129, v5, v10
    v_dot2_f32_bf16 v11, v133, v5, v11
    v_dot2_f32_bf16 v24, v137, v5, v24
    v_dot2_f32_bf16 v25, v141, v5, v25
    v_dot2_f32_bf16 v26, v145, v5, v26
    v_dot2_f32_bf16 v27, v149, v5, v27
    v_dot2_f32_bf16 v8, v122, v6, v8
    v_dot2_f32_bf16 v9, v126, v6, v9
    v_dot2_f32_bf16 v10, v130, v6, v10
    v_dot2_f32_bf16 v11, v134, v6, v11
    v_dot2_f32_bf16 v24, v138, v6, v24
    v_dot2_f32_bf16 v25, v142, v6, v25
    v_dot2_f32_bf16 v26, v146, v6, v26
    v_dot2_f32_bf16 v27, v150, v6, v27
    v_dot2_f32_bf16 v8, v123, v7, v8
    v_dot2_f32_bf16 v9, v127, v7, v9
    v_dot2_f32_bf16 v10, v131, v7, v10
    v_dot2_f32_bf16 v11, v135, v7, v11
    v_dot2_f32_bf16 v24, v139, v7, v24
    v_dot2_f32_bf16 v25, v143, v7, v25
    v_dot2_f32_bf16 v26, v147, v7, v26
    v_dot2_f32_bf16 v27, v151, v7, v27
    v_add_f32_dpp v8, v8, v8 row_ror:8 row_mask:0xf bank_mask:0x3
    v_add_f32_dpp v10, v10, v10 row_ror:8 row_mask:0xf bank_mask:0x3
    v_add_f32_dpp v24, v24, v24 row_ror:8 row_mask:0xf bank_mask:0x3
    v_add_f32_dpp v26, v26, v26 row_ror:8 row_mask:0xf bank_mask:0x3
    v_add_f32_dpp v8, v9, v9 row_ror:8 row_mask:0xf bank_mask:0xc
    v_add_f32_dpp v10, v11, v11 row_ror:8 row_mask:0xf bank_mask:0xc
    v_add_f32_dpp v24, v25, v25 row_ror:8 row_mask:0xf bank_mask:0xc
    v_add_f32_dpp v26, v27, v27 row_ror:8 row_mask:0xf bank_mask:0xc
    v_add_f32_dpp v17, v8, v8 row_half_mirror row_mask:0xf bank_mask:0x5
    v_add_f32_dpp v18, v24, v24 row_half_mirror row_mask:0xf bank_mask:0x5
    v_add_f32_dpp v17, v10, v10 row_half_mirror row_mask:0xf bank_mask:0xa
    v_add_f32_dpp v18, v26, v26 row_half_mirror row_mask:0xf bank_mask:0xa
    s_nop 0
    v_add_f32_dpp v17, v17, v17 quad_perm:[1,0,3,2] row_mask:0xf bank_mask:0xf
    v_add_f32_dpp v18, v18, v18 quad_perm:[1,0,3,2] row_mask:0xf bank_mask:0xf
    s_nop 0
    v_add_f32_dpp v17, v17, v17 quad_perm:[2,3,0,1] row_mask:0xf bank_mask:0xf
    v_add_f32_dpp v18, v18, v18 quad_perm:[2,3,0,1] row_mask:0xf bank_mask:0xf
    s_waitcnt vmcnt(3)
    s_bitcmp0_b32 s14, 10
    s_cbranch_scc1 L_sf_66
    s_waitcnt vmcnt(2)
    s_bitcmp0_b32 s15, 10
    s_cbranch_scc1 L_sf_66
    s_waitcnt vmcnt(1)
L_sf_66:
    buffer_load_dwordx4 v[80:83], v1, s[52:55], s97 offen offset:2048 nt
    s_waitcnt vmcnt(3)
    s_bitcmp0_b32 s14, 11
    s_cbranch_scc1 L_sf_67
    s_waitcnt vmcnt(2)
    s_bitcmp0_b32 s15, 11
    s_cbranch_scc1 L_sf_67
    s_waitcnt vmcnt(1)
L_sf_67:
    buffer_load_dwordx4 v[84:87], v1, s[52:55], s97 offen offset:3072 nt
    s_add_u32 s97, s97, 32768
    v_add_u32 v1, 4096, v1
    v_and_b32 v1, 0x7fff, v1
    s_cmp_eq_u32 s12, -1
    s_cbranch_scc1 L_nopfrd
    v_lshl_add_u32 v38, v0, 4, s12
    ds_read_b128 v[40:43], v38 offset:0
    ds_read_b128 v[44:47], v38 offset:1024
    ds_read_b128 v[48:51], v38 offset:2048
    ds_read_b128 v[52:55], v38 offset:3072
    ds_read_b128 v[56:59], v38 offset:4096
    ds_read_b128 v[60:63], v38 offset:5120
    ds_read_b128 v[64:67], v38 offset:6144
    ds_read_b128 v[68:71], v38 offset:7168
L_nopfrd:
    v_dot2_f32_bf16 v8, v152, v4, 0
    v_dot2_f32_bf16 v9, v156, v4, 0
    v_dot2_f32_bf16 v10, v160, v4, 0
    v_dot2_f32_bf16 v11, v164, v4, 0
    v_dot2_f32_bf16 v8, v153, v5, v8
    v_dot2_f32_bf16 v9, v157, v5, v9
    v_dot2_f32_bf16 v10, v161, v5, v10
    v_dot2_f32_bf16 v11, v165, v5, v11
    v_dot2_f32_bf16 v8, v154, v6, v8
    v_dot2_f32_bf16 v9, v158, v6, v9
    v_dot2_f32_bf16 v10, v162, v6, v10
    v_dot2_f32_bf16 v11, v166, v6, v11
    v_dot2_f32_bf16 v8, v155, v7, v8
    v_dot2_f32_bf16 v9, v159, v7, v9
    v_dot2_f32_bf16 v10, v163, v7, v10
    v_dot2_f32_bf16 v11, v167, v7, v11
    v_add_f32_dpp v8, v8, v8 row_ror:8 row_mask:0xf bank_mask:0x3
    s_nop 0
    v_add_f32_dpp v10, v10, v10 row_ror:8 row_mask:0xf bank_mask:0x3
    v_add_f32_dpp v8, v9, v9 row_ror:8 row_mask:0xf bank_mask:0xc
    v_add_f32_dpp v10, v11, v11 row_ror:8 row_mask:0xf bank_mask:0xc
    s_nop 0
    v_add_f32_dpp v19, v8, v8 row_half_mirror row_mask:0xf bank_mask:0x5
    v_add_f32_dpp v19, v10, v10 row_half_mirror row_mask:0xf bank_mask:0xa
    s_nop 1
    v_add_f32_dpp v19, v19, v19 quad_perm:[1,0,3,2] row_mask:0xf bank_mask:0xf
    s_nop 1
    v_add_f32_dpp v19, v19, v19 quad_perm:[2,3,0,1] row_mask:0xf bank_mask:0xf
    v_max3_f32 v3, v12, v13, v14
    v_max3_f32 v8, v15, v16, v17
    v_max3_f32 v3, v3, v18, v19
    v_max_f32 v3, v3, v8
    s_nop 1
    v_max_f32_dpp v3, v3, v3 row_ror:4 row_mask:0xf bank_mask:0xf
    s_nop 1
    v_max_f32_dpp v3, v3, v3 row_ror:8 row_mask:0xf bank_mask:0xf
    v_mov_b32 v8, v3
    s_nop 1
    v_permlane16_swap_b32 v3, v8
    v_max_f32 v3, v3, v8
    v_mov_b32 v8, v3
    s_nop 1
    v_permlane32_swap_b32 v3, v8
    v_max_f32 v3, v3, v8
    s_mov_b32 s96, 0x3e0293ee
    v_mul_f32 v8, s96, v3
    v_fma_f32 v12, v12, s96, -v8
    v_fma_f32 v13, v13, s96, -v8
    v_fma_f32 v14, v14, s96, -v8
    v_fma_f32 v15, v15, s96, -v8
    v_fma_f32 v16, v16, s96, -v8
    v_fma_f32 v17, v17, s96, -v8
    v_fma_f32 v18, v18, s96, -v8
    v_fma_f32 v19, v19, s96, -v8
    v_exp_f32 v12, v12
    v_exp_f32 v13, v13
    v_exp_f32 v14, v14
    v_exp_f32 v15, v15
    v_exp_f32 v16, v16
    v_exp_f32 v17, v17
    v_exp_f32 v18, v18
    v_exp_f32 v19, v19
    v_add_f32 v9, v12, v13
    v_add_f32 v10, v14, v15
    v_add_f32 v11, v16, v17
    v_add_f32 v3, v18, v19
    v_add_f32 v9, v9, v10
    v_add_f32 v3, v3, v11
    v_add_f32 v9, v9, v3
    v_cvt_pk_bf16_f32 v12, v12, v12
    v_cvt_pk_bf16_f32 v13, v13, v13
    v_cvt_pk_bf16_f32 v14, v14, v14
    v_cvt_pk_bf16_f32 v15, v15, v15
    v_cvt_pk_bf16_f32 v16, v16, v16
    v_cvt_pk_bf16_f32 v17, v17, v17
    v_cvt_pk_bf16_f32 v18, v18, v18
    v_cvt_pk_bf16_f32 v19, v19, v19
    v_add_f32_dpp v9, v9, v9 row_ror:4 row_mask:0xf bank_mask:0xf
    s_nop 1
    v_add_f32_dpp v9, v9, v9 row_ror:8 row_mask:0xf bank_mask:0xf
    v_mov_b32 v10, v9
    s_nop 1
    v_permlane16_swap_b32 v9, v10
    v_add_f32 v9, v9, v10
    v_mov_b32 v10, v9
    s_nop 1
    v_permlane32_swap_b32 v9, v10
    v_add_f32 v9, v9, v10
    s_mov_b64 exec, 1
    s_cmp_lg_u32 s13, 0
    s_cbranch_scc1 L_mljob
    s_lshl_b32 s96, s3, 3
    s_add_u32 s96, s96, 161920
    v_mov_b32 v10, s96
    v_mov_b32 v11, 162068
    v_mov_b32 v3, 1
    ds_write_b64 v10, v[8:9]
    ds_add_u32 v11, v3
L_mldone:
    s_mov_b64 exec, -1
    v_lshrrev_b32 v2, 1, v2
    v_and_b32_dpp v24, v14, v20 row_newbcast:0 row_mask:0xf bank_mask:0xf
    v_and_b32_dpp v25, v14, v21 row_newbcast:0 row_mask:0xf bank_mask:0xf
    v_and_b32_dpp v26, v14, v22 row_newbcast:0 row_mask:0xf bank_mask:0xf
    v_and_b32_dpp v27, v14, v23 row_newbcast:0 row_mask:0xf bank_mask:0xf
    s_waitcnt vmcnt(3)
    s_bitcmp0_b32 s14, 12
    s_cbranch_scc1 L_sf_68
    s_waitcnt vmcnt(2)
    s_bitcmp0_b32 s15, 12
    s_cbranch_scc1 L_sf_68
    s_waitcnt vmcnt(1)
L_sf_68:
    buffer_load_dwordx4 v[88:91], v1, s[52:55], s97 offen offset:0 nt
    v_mfma_f32_16x16x32_bf16 v[32:35], v[24:27], v[72:75], v[32:35]
    s_cmp_eq_u32 s12, -1
    s_cbranch_scc1 L_nopfpv8
    s_waitcnt lgkmcnt(0)
    v_and_b32_dpp v24, v12, v20 row_newbcast:0 row_mask:0xf bank_mask:0xf
    v_and_b32_dpp v25, v12, v21 row_newbcast:0 row_mask:0xf bank_mask:0xf
    v_and_b32_dpp v26, v12, v22 row_newbcast:0 row_mask:0xf bank_mask:0xf
    v_and_b32_dpp v27, v12, v23 row_newbcast:0 row_mask:0xf bank_mask:0xf
    s_nop 1
    v_mfma_f32_16x16x32_bf16 v[32:35], v[24:27], v[40:43], v[32:35]
    v_and_b32_dpp v28, v12, v20 row_newbcast:8 row_mask:0xf bank_mask:0xf
    v_and_b32_dpp v29, v12, v21 row_newbcast:8 row_mask:0xf bank_mask:0xf
    v_and_b32_dpp v30, v12, v22 row_newbcast:8 row_mask:0xf bank_mask:0xf
    v_and_b32_dpp v31, v12, v23 row_newbcast:8 row_mask:0xf bank_mask:0xf
    s_nop 1
    v_mfma_f32_16x16x32_bf16 v[32:35], v[28:31], v[44:47], v[32:35]
    v_and_b32_dpp v24, v12, v20 row_newbcast:4 row_mask:0xf bank_mask:0xf
    v_and_b32_dpp v25, v12, v21 row_newbcast:4 row_mask:0xf bank_mask:0xf
    v_and_b32_dpp v26, v12, v22 row_newbcast:4 row_mask:0xf bank_mask:0xf
    v_and_b32_dpp v27, v12, v23 row_newbcast:4 row_mask:0xf bank_mask:0xf
    s_nop 1
    v_mfma_f32_16x16x32_bf16 v[32:35], v[24:27], v[48:51], v[32:35]
    v_and_b32_dpp v28, v12, v20 row_newbcast:12 row_mask:0xf bank_mask:0xf
    v_and_b32_dpp v29, v12, v21 row_newbcast:12 row_mask:0xf bank_mask:0xf
    v_and_b32_dpp v30, v12, v22 row_newbcast:12 row_mask:0xf bank_mask:0xf
    v_and_b32_dpp v31, v12, v23 row_newbcast:12 row_mask:0xf bank_mask:0xf
    s_nop 1
    v_mfma_f32_16x16x32_bf16 v[32:35], v[28:31], v[52:55], v[32:35]
L_nopfpv8:
    v_and_b32_dpp v28, v14, v20 row_newbcast:8 row_mask:0xf bank_mask:0xf
    v_and_b32_dpp v29, v14, v21 row_newbcast:8 row_mask:0xf bank_mask:0xf
    v_and_b32_dpp v30, v14, v22 row_newbcast:8 row_mask:0xf bank_mask:0xf
    v_and_b32_dpp v31, v14, v23 row_newbcast:8 row_mask:0xf bank_mask:0xf
    s_waitcnt vmcnt(3)
    s_bitcmp0_b32 s14, 13
    s_cbranch_scc1 L_sf_69
    s_waitcnt vmcnt(2)
    s_bitcmp0_b32 s15, 13
    s_cbranch_scc1 L_sf_69
    s_waitcnt vmcnt(1)
L_sf_69:
    buffer_load_dwordx4 v[92:95], v1, s[52:55], s97 offen offset:1024 nt
    v_mfma_f32_16x16x32_bf16 v[32:35], v[28:31], v[76:79], v[32:35]
    s_cmp_eq_u32 s12, -1
    s_cbranch_scc1 L_nopfpv9
    s_waitcnt lgkmcnt(0)
    v_and_b32_dpp v24, v13, v20 row_newbcast:0 row_mask:0xf bank_mask:0xf
    v_and_b32_dpp v25, v13, v21 row_newbcast:0 row_mask:0xf bank_mask:0xf
    v_and_b32_dpp v26, v13, v22 row_newbcast:0 row_mask:0xf bank_mask:0xf
    v_and_b32_dpp v27, v13, v23 row_newbcast:0 row_mask:0xf bank_mask:0xf
    s_nop 1
    v_mfma_f32_16x16x32_bf16 v[32:35], v[24:27], v[56:59], v[32:35]
    v_and_b32_dpp v28, v13, v20 row_newbcast:8 row_mask:0xf bank_mask:0xf
    v_and_b32_dpp v29, v13, v21 row_newbcast:8 row_mask:0xf bank_mask:0xf
    v_and_b32_dpp v30, v13, v22 row_newbcast:8 row_mask:0xf bank_mask:0xf
    v_and_b32_dpp v31, v13, v23 row_newbcast:8 row_mask:0xf bank_mask:0xf
    s_nop 1
    v_mfma_f32_16x16x32_bf16 v[32:35], v[28:31], v[60:63], v[32:35]
    v_and_b32_dpp v24, v13, v20 row_newbcast:4 row_mask:0xf bank_mask:0xf
    v_and_b32_dpp v25, v13, v21 row_newbcast:4 row_mask:0xf bank_mask:0xf
    v_and_b32_dpp v26, v13, v22 row_newbcast:4 row_mask:0xf bank_mask:0xf
    v_and_b32_dpp v27, v13, v23 row_newbcast:4 row_mask:0xf bank_mask:0xf
    s_nop 1
    v_mfma_f32_16x16x32_bf16 v[32:35], v[24:27], v[64:67], v[32:35]
    v_and_b32_dpp v28, v13, v20 row_newbcast:12 row_mask:0xf bank_mask:0xf
    v_and_b32_dpp v29, v13, v21 row_newbcast:12 row_mask:0xf bank_mask:0xf
    v_and_b32_dpp v30, v13, v22 row_newbcast:12 row_mask:0xf bank_mask:0xf
    v_and_b32_dpp v31, v13, v23 row_newbcast:12 row_mask:0xf bank_mask:0xf
    s_nop 1
    v_mfma_f32_16x16x32_bf16 v[32:35], v[28:31], v[68:71], v[32:35]
L_nopfpv9:
    v_and_b32_dpp v24, v14, v20 row_newbcast:4 row_mask:0xf bank_mask:0xf
    v_and_b32_dpp v25, v14, v21 row_newbcast:4 row_mask:0xf bank_mask:0xf
    v_and_b32_dpp v26, v14, v22 row_newbcast:4 row_mask:0xf bank_mask:0xf
    v_and_b32_dpp v27, v14, v23 row_newbcast:4 row_mask:0xf bank_mask:0xf
    s_waitcnt vmcnt(3)
    s_bitcmp0_b32 s14, 14
    s_cbranch_scc1 L_sf_70
    s_waitcnt vmcnt(2)
    s_bitcmp0_b32 s15, 14
    s_cbranch_scc1 L_sf_70
    s_waitcnt vmcnt(1)
L_sf_70:
    buffer_load_dwordx4 v[96:99], v1, s[52:55], s97 offen offset:2048 nt
    v_mfma_f32_16x16x32_bf16 v[32:35], v[24:27], v[80:83], v[32:35]
    v_and_b32_dpp v28, v14, v20 row_newbcast:12 row_mask:0xf bank_mask:0xf
    v_and_b32_dpp v29, v14, v21 row_newbcast:12 row_mask:0xf bank_mask:0xf
    v_and_b32_dpp v30, v14, v22 row_newbcast:12 row_mask:0xf bank_mask:0xf
    v_and_b32_dpp v31, v14, v23 row_newbcast:12 row_mask:0xf bank_mask:0xf
    s_waitcnt vmcnt(3)
    s_bitcmp0_b32 s14, 15
    s_cbranch_scc1 L_sf_71
    s_waitcnt vmcnt(2)
    s_bitcmp0_b32 s15, 15
    s_cbranch_scc1 L_sf_71
    s_waitcnt vmcnt(1)
L_sf_71:
    buffer_load_dwordx4 v[100:103], v1, s[52:55], s97 offen offset:3072 nt
    s_add_u32 s97, s97, 32768
    v_add_u32 v1, 4096, v1
    v_and_b32 v1, 0x7fff, v1
    v_mfma_f32_16x16x32_bf16 v[32:35], v[28:31], v[84:87], v[32:35]
    v_and_b32_dpp v24, v15, v20 row_newbcast:0 row_mask:0xf bank_mask:0xf
    v_and_b32_dpp v25, v15, v21 row_newbcast:0 row_mask:0xf bank_mask:0xf
    v_and_b32_dpp v26, v15, v22 row_newbcast:0 row_mask:0xf bank_mask:0xf
    v_and_b32_dpp v27, v15, v23 row_newbcast:0 row_mask:0xf bank_mask:0xf
    s_waitcnt vmcnt(3)
    s_bitcmp0_b32 s14, 16
    s_cbranch_scc1 L_sf_72
    s_waitcnt vmcnt(2)
    s_bitcmp0_b32 s15, 16
    s_cbranch_scc1 L_sf_72
    s_waitcnt vmcnt(1)
L_sf_72:
    buffer_load_dwordx4 v[104:107], v1, s[52:55], s97 offen offset:0 nt
    v_mfma_f32_16x16x32_bf16 v[32:35], v[24:27], v[88:91], v[32:35]
    v_and_b32_dpp v28, v15, v20 row_newbcast:8 row_mask:0xf bank_mask:0xf
    v_and_b32_dpp v29, v15, v21 row_newbcast:8 row_mask:0xf bank_mask:0xf
    v_and_b32_dpp v30, v15, v22 row_newbcast:8 row_mask:0xf bank_mask:0xf
    v_and_b32_dpp v31, v15, v23 row_newbcast:8 row_mask:0xf bank_mask:0xf
    s_waitcnt vmcnt(3)
    s_bitcmp0_b32 s14, 17
    s_cbranch_scc1 L_sf_73
    s_waitcnt vmcnt(2)
    s_bitcmp0_b32 s15, 17
    s_cbranch_scc1 L_sf_73
    s_waitcnt vmcnt(1)
L_sf_73:
    buffer_load_dwordx4 v[108:111], v1, s[52:55], s97 offen offset:1024 nt
    v_mfma_f32_16x16x32_bf16 v[32:35], v[28:31], v[92:95], v[32:35]
    v_and_b32_dpp v24, v15, v20 row_newbcast:4 row_mask:0xf bank_mask:0xf
    v_and_b32_dpp v25, v15, v21 row_newbcast:4 row_mask:0xf bank_mask:0xf
    v_and_b32_dpp v26, v15, v22 row_newbcast:4 row_mask:0xf bank_mask:0xf
    v_and_b32_dpp v27, v15, v23 row_newbcast:4 row_mask:0xf bank_mask:0xf
    s_waitcnt vmcnt(3)
    s_bitcmp0_b32 s14, 18
    s_cbranch_scc1 L_sf_74
    s_waitcnt vmcnt(2)
    s_bitcmp0_b32 s15, 18
    s_cbranch_scc1 L_sf_74
    s_waitcnt vmcnt(1)
L_sf_74:
    buffer_load_dwordx4 v[112:115], v1, s[52:55], s97 offen offset:2048 nt
    v_mfma_f32_16x16x32_bf16 v[32:35], v[24:27], v[96:99], v[32:35]
    v_and_b32_dpp v28, v15, v20 row_newbcast:12 row_mask:0xf bank_mask:0xf
    v_and_b32_dpp v29, v15, v21 row_newbcast:12 row_mask:0xf bank_mask:0xf
    v_and_b32_dpp v30, v15, v22 row_newbcast:12 row_mask:0xf bank_mask:0xf
    v_and_b32_dpp v31, v15, v23 row_newbcast:12 row_mask:0xf bank_mask:0xf
    s_waitcnt vmcnt(3)
    s_bitcmp0_b32 s14, 19
    s_cbranch_scc1 L_sf_75
    s_waitcnt vmcnt(2)
    s_bitcmp0_b32 s15, 19
    s_cbranch_scc1 L_sf_75
    s_waitcnt vmcnt(1)
L_sf_75:
    buffer_load_dwordx4 v[116:119], v1, s[52:55], s97 offen offset:3072 nt
    s_add_u32 s97, s97, 32768
    v_add_u32 v1, 4096, v1
    v_and_b32 v1, 0x7fff, v1
    v_mfma_f32_16x16x32_bf16 v[32:35], v[28:31], v[100:103], v[32:35]
    v_and_b32_dpp v24, v16, v20 row_newbcast:0 row_mask:0xf bank_mask:0xf
    v_and_b32_dpp v25, v16, v21 row_newbcast:0 row_mask:0xf bank_mask:0xf
    v_and_b32_dpp v26, v16, v22 row_newbcast:0 row_mask:0xf bank_mask:0xf
    v_and_b32_dpp v27, v16, v23 row_newbcast:0 row_mask:0xf bank_mask:0xf
    s_waitcnt vmcnt(3)
    s_bitcmp0_b32 s14, 20
    s_cbranch_scc1 L_sf_76
    s_waitcnt vmcnt(2)
    s_bitcmp0_b32 s15, 20
    s_cbranch_scc1 L_sf_76
    s_waitcnt vmcnt(1)
L_sf_76:
    buffer_load_dwordx4 v[120:123], v1, s[52:55], s97 offen offset:0 nt
    v_mfma_f32_16x16x32_bf16 v[32:35], v[24:27], v[104:107], v[32:35]
    v_and_b32_dpp v28, v16, v20 row_newbcast:8 row_mask:0xf bank_mask:0xf
    v_and_b32_dpp v29, v16, v21 row_newbcast:8 row_mask:0xf bank_mask:0xf
    v_and_b32_dpp v30, v16, v22 row_newbcast:8 row_mask:0xf bank_mask:0xf
    v_and_b32_dpp v31, v16, v23 row_newbcast:8 row_mask:0xf bank_mask:0xf
    s_waitcnt vmcnt(3)
    s_bitcmp0_b32 s14, 21
    s_cbranch_scc1 L_sf_77
    s_waitcnt vmcnt(2)
    s_bitcmp0_b32 s15, 21
    s_cbranch_scc1 L_sf_77
    s_waitcnt vmcnt(1)
L_sf_77:
    buffer_load_dwordx4 v[124:127], v1, s[52:55], s97 offen offset:1024 nt
    v_mfma_f32_16x16x32_bf16 v[32:35], v[28:31], v[108:111], v[32:35]
    v_and_b32_dpp v24, v16, v20 row_newbcast:4 row_mask:0xf bank_mask:0xf
    v_and_b32_dpp v25, v16, v21 row_newbcast:4 row_mask:0xf bank_mask:0xf
    v_and_b32_dpp v26, v16, v22 row_newbcast:4 row_mask:0xf bank_mask:0xf
    v_and_b32_dpp v27, v16, v23 row_newbcast:4 row_mask:0xf bank_mask:0xf
    s_waitcnt vmcnt(3)
    s_bitcmp0_b32 s14, 22
    s_cbranch_scc1 L_sf_78
    s_waitcnt vmcnt(2)
    s_bitcmp0_b32 s15, 22
    s_cbranch_scc1 L_sf_78
    s_waitcnt vmcnt(1)
L_sf_78:
    buffer_load_dwordx4 v[128:131], v1, s[52:55], s97 offen offset:2048 nt
    v_mfma_f32_16x16x32_bf16 v[32:35], v[24:27], v[112:115], v[32:35]
    v_and_b32_dpp v28, v16, v20 row_newbcast:12 row_mask:0xf bank_mask:0xf
    v_and_b32_dpp v29, v16, v21 row_newbcast:12 row_mask:0xf bank_mask:0xf
    v_and_b32_dpp v30, v16, v22 row_newbcast:12 row_mask:0xf bank_mask:0xf
    v_and_b32_dpp v31, v16, v23 row_newbcast:12 row_mask:0xf bank_mask:0xf
    s_waitcnt vmcnt(3)
    s_bitcmp0_b32 s14, 23
    s_cbranch_scc1 L_sf_79
    s_waitcnt vmcnt(2)
    s_bitcmp0_b32 s15, 23
    s_cbranch_scc1 L_sf_79
    s_waitcnt vmcnt(1)
L_sf_79:
    buffer_load_dwordx4 v[132:135], v1, s[52:55], s97 offen offset:3072 nt
    s_add_u32 s97, s97, 32768
    v_add_u32 v1, 4096, v1
    v_and_b32 v1, 0x7fff, v1
    v_mfma_f32_16x16x32_bf16 v[32:35], v[28:31], v[116:119], v[32:35]
    v_and_b32_dpp v24, v17, v20 row_newbcast:0 row_mask:0xf bank_mask:0xf
    v_and_b32_dpp v25, v17, v21 row_newbcast:0 row_mask:0xf bank_mask:0xf
    v_and_b32_dpp v26, v17, v22 row_newbcast:0 row_mask:0xf bank_mask:0xf
    v_and_b32_dpp v27, v17, v23 row_newbcast:0 row_mask:0xf bank_mask:0xf
    s_waitcnt vmcnt(3)
    s_bitcmp0_b32 s14, 24
    s_cbranch_scc1 L_sf_80
    s_waitcnt vmcnt(2)
    s_bitcmp0_b32 s15, 24
    s_cbranch_scc1 L_sf_80
    s_waitcnt vmcnt(1)
L_sf_80:
    buffer_load_dwordx4 v[136:139], v1, s[52:55], s97 offen offset:0 nt
    v_mfma_f32_16x16x32_bf16 v[32:35], v[24:27], v[120:123], v[32:35]
    s_or_b32 s96, s59, s39
    s_cbranch_scc0 L_nofrag_81
    v_mov_b32 v104, 162060
L_lw_82:
    ds_read_b32 v105, v104
    s_waitcnt lgkmcnt(0)
    v_cmp_gt_u32 vcc, 4, v105
    s_cbranch_vccz L_lw_82e
    s_sleep 2
    s_sub_u32 s60, s60, 1
    s_cbranch_scc0 L_lw_82
    s_mov_b32 s60, 0
L_lw_82e:
    s_cmp_eq_u32 s59, 0
    s_cbranch_scc1 L_nofrag_81
    v_bfe_u32 v104, v0, 2, 1
    v_bfe_u32 v110, v0, 4, 1
    v_lshl_add_u32 v104, v110, 2, v104
    v_and_b32 v110, 8, v0
    v_add_u32 v104, v104, v110
    v_lshrrev_b32 v110, 5, v0
    v_lshl_add_u32 v104, v110, 4, v104
    v_bfe_u32 v111, v0, 0, 1
    v_mul_u32_u24 v111, 0xaaaa, v111
    v_add_u32 v111, 0x4444, v111
    v_mov_b32 v112, 0
    v_mov_b32 v113, 0
    v_mov_b32 v114, 0
    v_mov_b32 v115, 0
    v_mov_b32 v116, 0
    v_mov_b32 v117, 0
    v_mov_b32 v118, 0
    v_mov_b32 v119, 0
    v_lshlrev_b32 v104, 7, v104
    v_and_b32 v110, 3, v0
    v_lshl_add_u32 v104, v110, 3, v104
    v_lshrrev_b32 v109, 4, v0
    v_and_b32 v110, 1, v0
    s_lshr_b32 s63, s3, 1
    s_and_b32 s62, s3, 1
    s_lshl_b32 s96, s63, 14
    s_lshl_b32 s100, s62, 6
    s_add_u32 s100, s100, 81920
    s_add_u32 s96, s96, s100
    v_add_u32 v104, s96, v104
    ds_read_b64_tr_b16 v[72:73], v104 offset:0
    ds_read_b64_tr_b16 v[74:75], v104 offset:256
    ds_read_b64_tr_b16 v[76:77], v104 offset:4096
    ds_read_b64_tr_b16 v[78:79], v104 offset:4352
    ds_read_b64_tr_b16 v[80:81], v104 offset:32
    ds_read_b64_tr_b16 v[82:83], v104 offset:288
    ds_read_b64_tr_b16 v[84:85], v104 offset:4128
    ds_read_b64_tr_b16 v[86:87], v104 offset:4384
    ds_read_b64_tr_b16 v[88:89], v104 offset:8192
    ds_read_b64_tr_b16 v[90:91], v104 offset:8448
    ds_read_b64_tr_b16 v[92:93], v104 offset:12288
    ds_read_b64_tr_b16 v[94:95], v104 offset:12544
    ds_read_b64_tr_b16 v[96:97], v104 offset:8224
    ds_read_b64_tr_b16 v[98:99], v104 offset:8480
    ds_read_b64_tr_b16 v[100:101], v104 offset:12320
    ds_read_b64_tr_b16 v[102:103], v104 offset:12576
    v_bfe_u32 v105, v0, 1, 3
    v_lshlrev_b32 v105, 8, v105
    v_lshl_add_u32 v105, v109, 5, v105
    v_lshl_add_u32 v105, v110, 4, v105
    v_lshrrev_b32 v106, 3, v0
    v_lshlrev_b32 v106, 7, v106
    v_and_b32 v110, 7, v0
    v_lshl_add_u32 v107, v110, 3, v106
    v_add_u32 v107, s100, v107
    v_lshlrev_b32 v106, 8, v109
    v_and_b32 v110, 15, v0
    v_lshl_add_u32 v106, v110, 2, v106
    v_add_u32 v106, s96, v106
    v_lshlrev_b32 v108, 2, v0
    s_lshl_b32 s96, s62, 2
    s_add_u32 s96, s96, 162088
    v_mov_b32 v109, s96
    s_lshl_b32 s100, s63, 11
    s_lshl_b32 s96, s34, 13
    s_add_u32 s100, s100, s96
    s_add_u32 s100, s100, 90112
    s_mul_i32 s101, s34, 5120
    s_lshl_b32 s96, s35, 9
    s_add_u32 s101, s101, s96
    s_lshl_b32 s96, s62, 8
    s_add_u32 s101, s101, s96
    s_add_u32 s101, s101, 144384
L_nofrag_81:
    v_and_b32_dpp v28, v17, v20 row_newbcast:8 row_mask:0xf bank_mask:0xf
    v_and_b32_dpp v29, v17, v21 row_newbcast:8 row_mask:0xf bank_mask:0xf
    v_and_b32_dpp v30, v17, v22 row_newbcast:8 row_mask:0xf bank_mask:0xf
    v_and_b32_dpp v31, v17, v23 row_newbcast:8 row_mask:0xf bank_mask:0xf
    s_waitcnt vmcnt(3)
    s_bitcmp0_b32 s14, 25
    s_cbranch_scc1 L_sf_83
    s_waitcnt vmcnt(2)
    s_bitcmp0_b32 s15, 25
    s_cbranch_scc1 L_sf_83
    s_waitcnt vmcnt(1)
L_sf_83:
    buffer_load_dwordx4 v[140:143], v1, s[52:55], s97 offen offset:1024 nt
    v_mfma_f32_16x16x32_bf16 v[32:35], v[28:31], v[124:127], v[32:35]
    v_and_b32_dpp v24, v17, v20 row_newbcast:4 row_mask:0xf bank_mask:0xf
    v_and_b32_dpp v25, v17, v21 row_newbcast:4 row_mask:0xf bank_mask:0xf
    v_and_b32_dpp v26, v17, v22 row_newbcast:4 row_mask:0xf bank_mask:0xf
    v_and_b32_dpp v27, v17, v23 row_newbcast:4 row_mask:0xf bank_mask:0xf
    s_waitcnt vmcnt(3)
    s_bitcmp0_b32 s14, 26
    s_cbranch_scc1 L_sf_84
    s_waitcnt vmcnt(2)
    s_bitcmp0_b32 s15, 26
    s_cbranch_scc1 L_sf_84
    s_waitcnt vmcnt(1)
L_sf_84:
    buffer_load_dwordx4 v[144:147], v1, s[52:55], s97 offen offset:2048 nt
    v_mfma_f32_16x16x32_bf16 v[32:35], v[24:27], v[128:131], v[32:35]
    v_mov_b32 v10, 162076
    v_mov_b32 v11, 1
    s_mov_b64 exec, 1
    ds_add_u32 v10, v11
    s_mov_b64 exec, -1
    v_and_b32_dpp v28, v17, v20 row_newbcast:12 row_mask:0xf bank_mask:0xf
    v_and_b32_dpp v29, v17, v21 row_newbcast:12 row_mask:0xf bank_mask:0xf
    v_and_b32_dpp v30, v17, v22 row_newbcast:12 row_mask:0xf bank_mask:0xf
    v_and_b32_dpp v31, v17, v23 row_newbcast:12 row_mask:0xf bank_mask:0xf
    s_waitcnt vmcnt(3)
    s_bitcmp0_b32 s14, 27
    s_cbranch_scc1 L_sf_85
    s_waitcnt vmcnt(2)
    s_bitcmp0_b32 s15, 27
    s_cbranch_scc1 L_sf_85
    s_waitcnt vmcnt(1)
L_sf_85:
    buffer_load_dwordx4 v[148:151], v1, s[52:55], s97 offen offset:3072 nt
    s_add_u32 s97, s97, 32768
    v_add_u32 v1, 4096, v1
    v_and_b32 v1, 0x7fff, v1
    v_mfma_f32_16x16x32_bf16 v[32:35], v[28:31], v[132:135], v[32:35]
    v_and_b32_dpp v24, v18, v20 row_newbcast:0 row_mask:0xf bank_mask:0xf
    v_and_b32_dpp v25, v18, v21 row_newbcast:0 row_mask:0xf bank_mask:0xf
    v_and_b32_dpp v26, v18, v22 row_newbcast:0 row_mask:0xf bank_mask:0xf
    v_and_b32_dpp v27, v18, v23 row_newbcast:0 row_mask:0xf bank_mask:0xf
    s_waitcnt vmcnt(3)
    s_bitcmp0_b32 s14, 28
    s_cbranch_scc1 L_sf_86
    s_waitcnt vmcnt(2)
    s_bitcmp0_b32 s15, 28
    s_cbranch_scc1 L_sf_86
    s_waitcnt vmcnt(1)
L_sf_86:
    buffer_load_dwordx4 v[152:155], v1, s[52:55], s97 offen offset:0 nt
    v_mfma_f32_16x16x32_bf16 v[32:35], v[24:27], v[136:139], v[32:35]
    v_and_b32_dpp v28, v18, v20 row_newbcast:8 row_mask:0xf bank_mask:0xf
    v_and_b32_dpp v29, v18, v21 row_newbcast:8 row_mask:0xf bank_mask:0xf
    v_and_b32_dpp v30, v18, v22 row_newbcast:8 row_mask:0xf bank_mask:0xf
    v_and_b32_dpp v31, v18, v23 row_newbcast:8 row_mask:0xf bank_mask:0xf
    s_waitcnt vmcnt(3)
    s_bitcmp0_b32 s14, 29
    s_cbranch_scc1 L_sf_87
    s_waitcnt vmcnt(2)
    s_bitcmp0_b32 s15, 29
    s_cbranch_scc1 L_sf_87
    s_waitcnt vmcnt(1)
L_sf_87:
    buffer_load_dwordx4 v[156:159], v1, s[52:55], s97 offen offset:1024 nt
    v_mfma_f32_16x16x32_bf16 v[32:35], v[28:31], v[140:143], v[32:35]
    v_and_b32_dpp v24, v18, v20 row_newbcast:4 row_mask:0xf bank_mask:0xf
    v_and_b32_dpp v25, v18, v21 row_newbcast:4 row_mask:0xf bank_mask:0xf
    v_and_b32_dpp v26, v18, v22 row_newbcast:4 row_mask:0xf bank_mask:0xf
    v_and_b32_dpp v27, v18, v23 row_newbcast:4 row_mask:0xf bank_mask:0xf
    s_waitcnt vmcnt(3)
    s_bitcmp0_b32 s14, 30
    s_cbranch_scc1 L_sf_88
    s_waitcnt vmcnt(2)
    s_bitcmp0_b32 s15, 30
    s_cbranch_scc1 L_sf_88
    s_waitcnt vmcnt(1)
L_sf_88:
    buffer_load_dwordx4 v[160:163], v1, s[52:55], s97 offen offset:2048 nt
    v_mfma_f32_16x16x32_bf16 v[32:35], v[24:27], v[144:147], v[32:35]
    v_lshrrev_b32 v9, 4, v0
    v_lshl_add_u32 v8, v9, 2, v2
    s_lshl_b32 s96, s3, 9
    s_add_u32 s96, s96, 157824
    v_lshl_add_u32 v8, v8, 2, s96
    v_lshlrev_b32 v9, 3, v0
    v_add_u32 v9, 157824, v9
    v_mov_b32 v10, 162048
    v_mov_b32 v11, 1
    s_lshl_b32 s96, s38, 5
    s_add_u32 s96, s96, 161984
    v_mov_b32 v3, s96
    s_sub_u32 s62, 8, s39
    s_lshl_b32 s98, s34, 5
    s_add_u32 s98, s98, s35
    s_lshl_b32 s98, s98, 8
    s_add_u32 s98, s98, 90112
    v_lshlrev_b32 v39, 2, v0
    v_and_b32_dpp v28, v18, v20 row_newbcast:12 row_mask:0xf bank_mask:0xf
    v_and_b32_dpp v29, v18, v21 row_newbcast:12 row_mask:0xf bank_mask:0xf
    v_and_b32_dpp v30, v18, v22 row_newbcast:12 row_mask:0xf bank_mask:0xf
    v_and_b32_dpp v31, v18, v23 row_newbcast:12 row_mask:0xf bank_mask:0xf
    s_waitcnt vmcnt(3)
    s_bitcmp0_b32 s14, 31
    s_cbranch_scc1 L_sf_89
    s_waitcnt vmcnt(2)
    s_bitcmp0_b32 s15, 31
    s_cbranch_scc1 L_sf_89
    s_waitcnt vmcnt(1)
L_sf_89:
    buffer_load_dwordx4 v[164:167], v1, s[52:55], s97 offen offset:3072 nt
    s_mov_b32 s97, 0
    v_add_u32 v1, 4096, v1
    v_and_b32 v1, 0x7fff, v1
    v_mfma_f32_16x16x32_bf16 v[32:35], v[28:31], v[148:151], v[32:35]
    s_cmp_eq_u32 s12, -1
    s_cbranch_scc1 L_v_nopf
    v_and_b32_dpp v24, v19, v20 row_newbcast:0 row_mask:0xf bank_mask:0xf
    v_and_b32_dpp v25, v19, v21 row_newbcast:0 row_mask:0xf bank_mask:0xf
    v_and_b32_dpp v26, v19, v22 row_newbcast:0 row_mask:0xf bank_mask:0xf
    v_and_b32_dpp v27, v19, v23 row_newbcast:0 row_mask:0xf bank_mask:0xf
    s_waitcnt vmcnt(3)
    s_nop 0
    v_mfma_f32_16x16x32_bf16 v[32:35], v[24:27], v[152:155], v[32:35]
    v_and_b32_dpp v28, v19, v20 row_newbcast:8 row_mask:0xf bank_mask:0xf
    v_and_b32_dpp v29, v19, v21 row_newbcast:8 row_mask:0xf bank_mask:0xf
    v_and_b32_dpp v30, v19, v22 row_newbcast:8 row_mask:0xf bank_mask:0xf
    v_and_b32_dpp v31, v19, v23 row_newbcast:8 row_mask:0xf bank_mask:0xf
    s_waitcnt vmcnt(2)
    s_nop 0
    v_mfma_f32_16x16x32_bf16 v[32:35], v[28:31], v[156:159], v[32:35]
    v_and_b32_dpp v24, v19, v20 row_newbcast:4 row_mask:0xf bank_mask:0xf
    v_and_b32_dpp v25, v19, v21 row_newbcast:4 row_mask:0xf bank_mask:0xf
    v_and_b32_dpp v26, v19, v22 row_newbcast:4 row_mask:0xf bank_mask:0xf
    v_and_b32_dpp v27, v19, v23 row_newbcast:4 row_mask:0xf bank_mask:0xf
    s_waitcnt vmcnt(1)
    s_nop 0
    v_mfma_f32_16x16x32_bf16 v[32:35], v[24:27], v[160:163], v[32:35]
    v_and_b32_dpp v28, v19, v20 row_newbcast:12 row_mask:0xf bank_mask:0xf
    v_and_b32_dpp v29, v19, v21 row_newbcast:12 row_mask:0xf bank_mask:0xf
    v_and_b32_dpp v30, v19, v22 row_newbcast:12 row_mask:0xf bank_mask:0xf
    v_and_b32_dpp v31, v19, v23 row_newbcast:12 row_mask:0xf bank_mask:0xf
    s_waitcnt vmcnt(0)
    s_nop 0
    v_mfma_f32_16x16x32_bf16 v[32:35], v[28:31], v[164:167], v[32:35]
L_v_join:
    s_cmp_lg_u32 s13, 0
    s_cbranch_scc1 L_jobend
L_t0:
    s_mov_b32 exec_hi, 0
    s_nop 4
    ds_write_b128 v8, v[32:35]
L_t0b:
    s_mov_b64 exec, 1
    ds_add_rtn_u32 v37, v10, v11
    s_mov_b64 exec, -1
    ds_read_b32 v38, v10 offset:24
    ds_read_b128 v[24:27], v3
    ds_read_b128 v[28:31], v3 offset:16
    ds_read_b64 v[144:145], v9 offset:0
    ds_read_b64 v[146:147], v9 offset:512
    ds_read_b64 v[148:149], v9 offset:1024
    ds_read_b64 v[150:151], v9 offset:1536
    ds_read_b64 v[152:153], v9 offset:2048
    ds_read_b64 v[154:155], v9 offset:2560
    ds_read_b64 v[156:157], v9 offset:3072
    ds_read_b64 v[158:159], v9 offset:3584
    s_waitcnt lgkmcnt(10)
    v_readfirstlane_b32 s96, v37
    v_readfirstlane_b32 s61, v38
    s_cmp_lg_u32 s96, s62
    s_cbranch_scc1 L_nopub
    s_waitcnt lgkmcnt(6)
    v_pk_mul_f32 v[144:145], v[144:145], v[24:25] op_sel:[0,0] op_sel_hi:[1,0]
    v_pk_mul_f32 v[146:147], v[146:147], v[24:25] op_sel:[0,1] op_sel_hi:[1,1]
    s_waitcnt lgkmcnt(4)
    v_pk_fma_f32 v[144:145], v[148:149], v[26:27], v[144:145] op_sel:[0,0,0] op_sel_hi:[1,0,1]
    v_pk_fma_f32 v[146:147], v[150:151], v[26:27], v[146:147] op_sel:[0,1,0] op_sel_hi:[1,1,1]
    s_waitcnt lgkmcnt(2)
    v_pk_fma_f32 v[144:145], v[152:153], v[28:29], v[144:145] op_sel:[0,0,0] op_sel_hi:[1,0,1]
    v_pk_fma_f32 v[146:147], v[154:155], v[28:29], v[146:147] op_sel:[0,1,0] op_sel_hi:[1,1,1]
    s_waitcnt lgkmcnt(0)
    v_pk_fma_f32 v[144:145], v[156:157], v[30:31], v[144:145] op_sel:[0,0,0] op_sel_hi:[1,0,1]
    v_pk_fma_f32 v[146:147], v[158:159], v[30:31], v[146:147] op_sel:[0,1,0] op_sel_hi:[1,1,1]
    s_cmp_eq_u32 s61, 1
    v_pk_add_f32 v[144:145], v[144:145], v[146:147]
    v_cvt_pk_bf16_f32 v32, v144, v145
    s_cbranch_scc0 L_oslow
    buffer_store_dword v32, v39, s[40:43], s98 offen
L_odone:
L_nopub:
    s_cmp_eq_u32 s59, 0
    s_cbranch_scc1 L_not1
L_poll_98:
    buffer_load_dwordx4 v[16:19], v105, s[40:43], s100 offen sc1
    buffer_load_dwordx4 v[20:23], v105, s[40:43], s100 offen offset:128 sc1
    s_sub_u32 s60, s60, 1
    s_cbranch_scc1 L_poll_98t
    s_waitcnt vmcnt(0)
    v_max3_u32 v38, v16, v17, v18
    v_max3_u32 v38, v38, v19, v20
    v_max3_u32 v38, v38, v21, v22
    v_max_u32 v38, v38, v23
    v_cmp_eq_u32 vcc, -1, v38
    s_cbranch_vccnz L_poll_98
L_poll_98e:
    v_smfmac_f32_16x16x64_bf16 v[112:115], v[16:19], v[72:79], v111
    v_smfmac_f32_16x16x64_bf16 v[116:119], v[16:19], v[80:87], v111
    v_smfmac_f32_16x16x64_bf16 v[112:115], v[20:23], v[88:95], v111
    v_smfmac_f32_16x16x64_bf16 v[116:119], v[20:23], v[96:103], v111
    s_nop 6
    v_pk_add_f32 v[112:113], v[112:113], v[114:115]
    v_pk_add_f32 v[116:117], v[116:117], v[118:119]
    v_add_f32 v12, v112, v113
    v_add_f32 v13, v116, v117
    ds_write2_b32 v106, v12, v13 offset0:0 offset1:32
    s_mov_b64 exec, 1
    ds_add_rtn_u32 v37, v109, v11
    s_mov_b64 exec, -1
    ds_read_b64 v[72:73], v107 offset:0
    ds_read_b64 v[74:75], v107 offset:16384
    ds_read_b64 v[76:77], v107 offset:32768
    ds_read_b64 v[78:79], v107 offset:49152
    s_cmp_eq_u32 s34, 2
    s_cselect_b32 s97, s61, 0
    s_waitcnt lgkmcnt(4)
    v_readfirstlane_b32 s96, v37
    s_waitcnt lgkmcnt(2)
    v_pk_add_f32 v[72:73], v[72:73], v[74:75]
    s_cmp_lg_u32 s96, 3
    s_cbranch_scc1 L_not1
    s_cmp_eq_u32 s97, 1
    s_waitcnt lgkmcnt(0)
    v_pk_add_f32 v[76:77], v[76:77], v[78:79]
    v_pk_add_f32 v[72:73], v[72:73], v[76:77]
    v_cvt_pk_bf16_f32 v12, v72, v73
    s_cbranch_scc1 L_pfast
    buffer_store_dword v12, v108, s[40:43], s101 offen sc1
L_pdone:
L_not1:
    s_waitcnt lgkmcnt(0)
    s_cmp_eq_u32 s39, 1
    s_cbranch_scc1 L_s_role
    s_endpgm
L_k_nopf:
    s_waitcnt vmcnt(3)
    s_bitcmp0_b32 s57, 22
    s_cbranch_scc1 L_sf_54
    s_waitcnt vmcnt(2)
    s_bitcmp0_b32 s58, 22
    s_cbranch_scc1 L_sf_54
    s_waitcnt vmcnt(1)
L_sf_54:
    buffer_load_dwordx4 v[128:131], v1, s[48:51], s97 offen offset:2048 nt
    v_min_u32 v39, 29, v0
    v_lshlrev_b32 v39, 2, v39
    buffer_load_dword v37, v39, s[44:47], 0 offen sc1
    s_waitcnt vmcnt(4)
    s_bitcmp0_b32 s57, 23
    s_cbranch_scc1 L_sf_55
    s_waitcnt vmcnt(3)
    s_bitcmp0_b32 s58, 23
    s_cbranch_scc1 L_sf_55
    s_waitcnt vmcnt(2)
L_sf_55:
    buffer_load_dwordx4 v[132:135], v1, s[48:51], s97 offen offset:3072 nt
    s_add_u32 s97, s97, 32768
    v_add_u32 v1, 4096, v1
    v_and_b32 v1, 0x7fff, v1
    s_waitcnt vmcnt(4)
    s_bitcmp0_b32 s57, 24
    s_cbranch_scc1 L_sf_56
    s_waitcnt vmcnt(3)
    s_bitcmp0_b32 s58, 24
    s_cbranch_scc1 L_sf_56
    s_waitcnt vmcnt(2)
L_sf_56:
    buffer_load_dwordx4 v[136:139], v1, s[48:51], s97 offen offset:0 nt
    s_waitcnt vmcnt(4)
    s_bitcmp0_b32 s57, 25
    s_cbranch_scc1 L_sf_57
    s_waitcnt vmcnt(3)
    s_bitcmp0_b32 s58, 25
    s_cbranch_scc1 L_sf_57
    s_waitcnt vmcnt(1)
L_sf_57:
    buffer_load_dwordx4 v[140:143], v1, s[48:51], s97 offen offset:1024 nt
    s_waitcnt vmcnt(4)
    s_bitcmp0_b32 s57, 26
    s_cbranch_scc1 L_sf_58
    s_waitcnt vmcnt(2)
    s_bitcmp0_b32 s58, 26
    s_cbranch_scc1 L_sf_58
    s_waitcnt vmcnt(1)
L_sf_58:
    buffer_load_dwordx4 v[144:147], v1, s[48:51], s97 offen offset:2048 nt
    s_waitcnt vmcnt(3)
    s_bitcmp0_b32 s57, 27
    s_cbranch_scc1 L_sf_59
    s_waitcnt vmcnt(2)
    s_bitcmp0_b32 s58, 27
    s_cbranch_scc1 L_sf_59
    s_waitcnt vmcnt(1)
L_sf_59:
    buffer_load_dwordx4 v[148:151], v1, s[48:51], s97 offen offset:3072 nt
    s_add_u32 s97, s97, 32768
    v_add_u32 v1, 4096, v1
    v_and_b32 v1, 0x7fff, v1
    v_cmp_eq_u32 vcc, 0, v37
    s_nop 0
    s_or_b32 s96, vcc_lo, vcc_hi
    buffer_load_dwordx4 v[4:7], v2, s[40:43], s98 offen sc1
    s_waitcnt vmcnt(4)
    s_bitcmp0_b32 s57, 28
    s_cbranch_scc1 L_sf_60
    s_waitcnt vmcnt(3)
    s_bitcmp0_b32 s58, 28
    s_cbranch_scc1 L_sf_60
    s_waitcnt vmcnt(2)
L_sf_60:
    buffer_load_dwordx4 v[152:155], v1, s[48:51], s97 offen offset:0 nt
    s_waitcnt vmcnt(4)
    s_bitcmp0_b32 s57, 29
    s_cbranch_scc1 L_sf_61
    s_waitcnt vmcnt(3)
    s_bitcmp0_b32 s58, 29
    s_cbranch_scc1 L_sf_61
    s_waitcnt vmcnt(2)
L_sf_61:
    buffer_load_dwordx4 v[156:159], v1, s[48:51], s97 offen offset:1024 nt
    s_waitcnt vmcnt(4)
    s_bitcmp0_b32 s57, 30
    s_cbranch_scc1 L_sf_62
    s_waitcnt vmcnt(3)
    s_bitcmp0_b32 s58, 30
    s_cbranch_scc1 L_sf_62
    s_waitcnt vmcnt(1)
L_sf_62:
    buffer_load_dwordx4 v[160:163], v1, s[48:51], s97 offen offset:2048 nt
    s_waitcnt vmcnt(4)
    s_bitcmp0_b32 s57, 31
    s_cbranch_scc1 L_sf_63
    s_waitcnt vmcnt(2)
    s_bitcmp0_b32 s58, 31
    s_cbranch_scc1 L_sf_63
    s_waitcnt vmcnt(1)
L_sf_63:
    buffer_load_dwordx4 v[164:167], v1, s[48:51], s97 offen offset:3072 nt
    s_mov_b32 s97, 0
    v_add_u32 v1, 4096, v1
    v_and_b32 v1, 0x7fff, v1
    v_add_u32 v1, 8192, v1
    v_and_b32 v1, 0x7fff, v1
    s_mov_b32 s97, 65536
    s_branch L_k_join
L_v_nopf:
    v_and_b32_dpp v24, v19, v20 row_newbcast:0 row_mask:0xf bank_mask:0xf
    v_and_b32_dpp v25, v19, v21 row_newbcast:0 row_mask:0xf bank_mask:0xf
    v_and_b32_dpp v26, v19, v22 row_newbcast:0 row_mask:0xf bank_mask:0xf
    v_and_b32_dpp v27, v19, v23 row_newbcast:0 row_mask:0xf bank_mask:0xf
    s_waitcnt vmcnt(3)
    s_bitcmp0_b32 s14, 0
    s_cbranch_scc1 L_sf_90
    s_waitcnt vmcnt(2)
    s_bitcmp0_b32 s15, 0
    s_cbranch_scc1 L_sf_90
    s_waitcnt vmcnt(1)
L_sf_90:
    buffer_load_dwordx4 v[40:43], v1, s[52:55], s97 offen offset:0 nt
    v_mfma_f32_16x16x32_bf16 v[32:35], v[24:27], v[152:155], v[32:35]
    v_and_b32_dpp v28, v19, v20 row_newbcast:8 row_mask:0xf bank_mask:0xf
    v_and_b32_dpp v29, v19, v21 row_newbcast:8 row_mask:0xf bank_mask:0xf
    v_and_b32_dpp v30, v19, v22 row_newbcast:8 row_mask:0xf bank_mask:0xf
    v_and_b32_dpp v31, v19, v23 row_newbcast:8 row_mask:0xf bank_mask:0xf
    s_waitcnt vmcnt(3)
    s_bitcmp0_b32 s14, 1
    s_cbranch_scc1 L_sf_91
    s_waitcnt vmcnt(2)
    s_bitcmp0_b32 s15, 1
    s_cbranch_scc1 L_sf_91
    s_waitcnt vmcnt(1)
L_sf_91:
    buffer_load_dwordx4 v[44:47], v1, s[52:55], s97 offen offset:1024 nt
    v_mfma_f32_16x16x32_bf16 v[32:35], v[28:31], v[156:159], v[32:35]
    v_and_b32_dpp v24, v19, v20 row_newbcast:4 row_mask:0xf bank_mask:0xf
    v_and_b32_dpp v25, v19, v21 row_newbcast:4 row_mask:0xf bank_mask:0xf
    v_and_b32_dpp v26, v19, v22 row_newbcast:4 row_mask:0xf bank_mask:0xf
    v_and_b32_dpp v27, v19, v23 row_newbcast:4 row_mask:0xf bank_mask:0xf
    s_waitcnt vmcnt(3)
    s_bitcmp0_b32 s14, 2
    s_cbranch_scc1 L_sf_92
    s_waitcnt vmcnt(2)
    s_bitcmp0_b32 s15, 2
    s_cbranch_scc1 L_sf_92
    s_waitcnt vmcnt(1)
L_sf_92:
    buffer_load_dwordx4 v[48:51], v1, s[52:55], s97 offen offset:2048 nt
    v_mfma_f32_16x16x32_bf16 v[32:35], v[24:27], v[160:163], v[32:35]
    v_and_b32_dpp v28, v19, v20 row_newbcast:12 row_mask:0xf bank_mask:0xf
    v_and_b32_dpp v29, v19, v21 row_newbcast:12 row_mask:0xf bank_mask:0xf
    v_and_b32_dpp v30, v19, v22 row_newbcast:12 row_mask:0xf bank_mask:0xf
    v_and_b32_dpp v31, v19, v23 row_newbcast:12 row_mask:0xf bank_mask:0xf
    s_waitcnt vmcnt(3)
    s_bitcmp0_b32 s14, 3
    s_cbranch_scc1 L_sf_93
    s_waitcnt vmcnt(2)
    s_bitcmp0_b32 s15, 3
    s_cbranch_scc1 L_sf_93
    s_waitcnt vmcnt(1)
L_sf_93:
    buffer_load_dwordx4 v[52:55], v1, s[52:55], s97 offen offset:3072 nt
    s_add_u32 s97, s97, 32768
    v_add_u32 v1, 4096, v1
    v_and_b32 v1, 0x7fff, v1
    v_mfma_f32_16x16x32_bf16 v[32:35], v[28:31], v[164:167], v[32:35]
    v_and_b32_dpp v24, v12, v20 row_newbcast:0 row_mask:0xf bank_mask:0xf
    v_and_b32_dpp v25, v12, v21 row_newbcast:0 row_mask:0xf bank_mask:0xf
    v_and_b32_dpp v26, v12, v22 row_newbcast:0 row_mask:0xf bank_mask:0xf
    v_and_b32_dpp v27, v12, v23 row_newbcast:0 row_mask:0xf bank_mask:0xf
    s_waitcnt vmcnt(3)
    s_bitcmp0_b32 s14, 4
    s_cbranch_scc1 L_sf_94
    s_waitcnt vmcnt(2)
    s_bitcmp0_b32 s15, 4
    s_cbranch_scc1 L_sf_94
    s_waitcnt vmcnt(1)
L_sf_94:
    buffer_load_dwordx4 v[56:59], v1, s[52:55], s97 offen offset:0 nt
    v_mfma_f32_16x16x32_bf16 v[32:35], v[24:27], v[40:43], v[32:35]
    v_and_b32_dpp v28, v12, v20 row_newbcast:8 row_mask:0xf bank_mask:0xf
    v_and_b32_dpp v29, v12, v21 row_newbcast:8 row_mask:0xf bank_mask:0xf
    v_and_b32_dpp v30, v12, v22 row_newbcast:8 row_mask:0xf bank_mask:0xf
    v_and_b32_dpp v31, v12, v23 row_newbcast:8 row_mask:0xf bank_mask:0xf
    s_waitcnt vmcnt(3)
    s_bitcmp0_b32 s14, 5
    s_cbranch_scc1 L_sf_95
    s_waitcnt vmcnt(2)
    s_bitcmp0_b32 s15, 5
    s_cbranch_scc1 L_sf_95
    s_waitcnt vmcnt(1)
L_sf_95:
    buffer_load_dwordx4 v[60:63], v1, s[52:55], s97 offen offset:1024 nt
    v_mfma_f32_16x16x32_bf16 v[32:35], v[28:31], v[44:47], v[32:35]
    v_and_b32_dpp v24, v12, v20 row_newbcast:4 row_mask:0xf bank_mask:0xf
    v_and_b32_dpp v25, v12, v21 row_newbcast:4 row_mask:0xf bank_mask:0xf
    v_and_b32_dpp v26, v12, v22 row_newbcast:4 row_mask:0xf bank_mask:0xf
    v_and_b32_dpp v27, v12, v23 row_newbcast:4 row_mask:0xf bank_mask:0xf
    s_waitcnt vmcnt(3)
    s_bitcmp0_b32 s14, 6
    s_cbranch_scc1 L_sf_96
    s_waitcnt vmcnt(2)
    s_bitcmp0_b32 s15, 6
    s_cbranch_scc1 L_sf_96
    s_waitcnt vmcnt(1)
L_sf_96:
    buffer_load_dwordx4 v[64:67], v1, s[52:55], s97 offen offset:2048 nt
    v_mfma_f32_16x16x32_bf16 v[32:35], v[24:27], v[48:51], v[32:35]
    v_and_b32_dpp v28, v12, v20 row_newbcast:12 row_mask:0xf bank_mask:0xf
    v_and_b32_dpp v29, v12, v21 row_newbcast:12 row_mask:0xf bank_mask:0xf
    v_and_b32_dpp v30, v12, v22 row_newbcast:12 row_mask:0xf bank_mask:0xf
    v_and_b32_dpp v31, v12, v23 row_newbcast:12 row_mask:0xf bank_mask:0xf
    s_waitcnt vmcnt(3)
    s_bitcmp0_b32 s14, 7
    s_cbranch_scc1 L_sf_97
    s_waitcnt vmcnt(2)
    s_bitcmp0_b32 s15, 7
    s_cbranch_scc1 L_sf_97
    s_waitcnt vmcnt(1)
L_sf_97:
    buffer_load_dwordx4 v[68:71], v1, s[52:55], s97 offen offset:3072 nt
    s_add_u32 s97, s97, 32768
    v_add_u32 v1, 4096, v1
    v_and_b32 v1, 0x7fff, v1
    v_mfma_f32_16x16x32_bf16 v[32:35], v[28:31], v[52:55], v[32:35]
    v_and_b32_dpp v24, v13, v20 row_newbcast:0 row_mask:0xf bank_mask:0xf
    v_and_b32_dpp v25, v13, v21 row_newbcast:0 row_mask:0xf bank_mask:0xf
    v_and_b32_dpp v26, v13, v22 row_newbcast:0 row_mask:0xf bank_mask:0xf
    v_and_b32_dpp v27, v13, v23 row_newbcast:0 row_mask:0xf bank_mask:0xf
    s_waitcnt vmcnt(3)
    s_nop 0
    v_mfma_f32_16x16x32_bf16 v[32:35], v[24:27], v[56:59], v[32:35]
    v_and_b32_dpp v28, v13, v20 row_newbcast:8 row_mask:0xf bank_mask:0xf
    v_and_b32_dpp v29, v13, v21 row_newbcast:8 row_mask:0xf bank_mask:0xf
    v_and_b32_dpp v30, v13, v22 row_newbcast:8 row_mask:0xf bank_mask:0xf
    v_and_b32_dpp v31, v13, v23 row_newbcast:8 row_mask:0xf bank_mask:0xf
    s_waitcnt vmcnt(2)
    s_nop 0
    v_mfma_f32_16x16x32_bf16 v[32:35], v[28:31], v[60:63], v[32:35]
    v_and_b32_dpp v24, v13, v20 row_newbcast:4 row_mask:0xf bank_mask:0xf
    v_and_b32_dpp v25, v13, v21 row_newbcast:4 row_mask:0xf bank_mask:0xf
    v_and_b32_dpp v26, v13, v22 row_newbcast:4 row_mask:0xf bank_mask:0xf
    v_and_b32_dpp v27, v13, v23 row_newbcast:4 row_mask:0xf bank_mask:0xf
    s_waitcnt vmcnt(1)
    s_nop 0
    v_mfma_f32_16x16x32_bf16 v[32:35], v[24:27], v[64:67], v[32:35]
    v_and_b32_dpp v28, v13, v20 row_newbcast:12 row_mask:0xf bank_mask:0xf
    v_and_b32_dpp v29, v13, v21 row_newbcast:12 row_mask:0xf bank_mask:0xf
    v_and_b32_dpp v30, v13, v22 row_newbcast:12 row_mask:0xf bank_mask:0xf
    v_and_b32_dpp v31, v13, v23 row_newbcast:12 row_mask:0xf bank_mask:0xf
    s_waitcnt vmcnt(0)
    s_nop 0
    v_mfma_f32_16x16x32_bf16 v[32:35], v[28:31], v[68:71], v[32:35]
    s_branch L_v_join
L_oslow:
    buffer_store_dword v32, v39, s[40:43], s98 offen sc1
    s_branch L_odone
L_qslow:
L_wy_99:
    buffer_load_dword v37, v39, s[44:47], 0 offen sc1
    s_waitcnt vmcnt(0)
    v_cmp_ne_u32 vcc, -1, v37
    s_cbranch_vccz L_wy_99e
    s_sleep 4
    s_sub_u32 s60, s60, 1
    s_cbranch_scc0 L_wy_99
    s_mov_b32 s60, 0
L_wy_99e:
L_qslow2:
    s_branch L_poll_100
L_poll_100s:
    s_sleep 2
L_poll_100:
    buffer_load_dwordx4 v[4:7], v2, s[40:43], s98 offen sc1
    s_sub_u32 s60, s60, 1
    s_cbranch_scc1 L_poll_100t
    s_waitcnt vmcnt(0)
    v_max3_u32 v38, v4, v5, v6
    v_max_u32 v38, v38, v7
    v_cmp_eq_u32 vcc, -1, v38
    s_cbranch_vccnz L_poll_100s
L_poll_100e:
    s_branch L_qok
L_mljob:
    s_lshl_b32 s96, s38, 3
    s_add_u32 s96, s96, s3
    s_lshl3_add_u32 s96, s96, s99
    buffer_store_dwordx2 v[8:9], v36, s[40:43], s96 offen sc1
    s_branch L_mldone
L_service:
    v_mov_b32 v72, 0
    v_mov_b32 v73, 0
    v_mov_b32 v74, 0
    v_mov_b32 v75, 0
    v_mov_b32 v76, 0
    s_mov_b32 s59, 0
    v_mov_b32 v5, 0
    v_mov_b32 v105, 0
    v_mov_b32 v108, 0
    v_mov_b32 v160, 0
    v_mov_b32 v163, 0
    v_mov_b32 v8, 162068
L_lw_101:
    ds_read_b32 v9, v8
    s_waitcnt lgkmcnt(0)
    v_cmp_gt_u32 vcc, 8, v9
    s_cbranch_vccz L_lw_101e
    s_sleep 8
    s_sub_u32 s60, s60, 1
    s_cbranch_scc0 L_lw_101
    s_mov_b32 s60, 0
L_lw_101e:
    v_and_b32 v2, 15, v0
    v_lshlrev_b32 v2, 3, v2
    v_add_u32 v3, 161920, v2
    ds_read_b64 v[8:9], v3
    s_lshl_b32 s99, s37, 5
    s_add_u32 s99, s99, s36
    s_lshl_b32 s99, s99, 7
    s_add_u32 s99, s99, 73728
    s_lshl_b32 s62, s38, 6
    s_add_u32 s62, s62, s99
    s_getreg_b32 s58, hwreg(HW_REG_XCC_ID, 0, 4)
    v_mov_b32 v10, s58
    s_lshl_b32 s98, s34, 5
    s_add_u32 s98, s98, s35
    s_lshl_b32 s63, s98, 2
    s_add_u32 s63, s63, 229376
    s_lshl_b32 s98, s98, 8
    s_add_u32 s98, s98, 90112
    v_lshlrev_b32 v39, 2, v0
    s_bfm_b64 exec, 8, 0
    s_waitcnt lgkmcnt(0)
    buffer_store_dwordx2 v[8:9], v2, s[40:43], s62 offen sc1
    s_mov_b64 exec, 1
    buffer_store_dword v10, v36, s[40:43], s63 offen sc1
    s_mov_b64 exec, -1
    v_mov_b32 v12, 162076
L_lw_102:
    ds_read_b32 v13, v12
    s_waitcnt lgkmcnt(0)
    v_cmp_gt_u32 vcc, 4, v13
    s_cbranch_vccz L_lw_102e
    s_sleep 4
    s_sub_u32 s60, s60, 1
    s_cbranch_scc0 L_lw_102
    s_mov_b32 s60, 0
L_lw_102e:
    v_and_b32 v11, 31, v0
    v_lshlrev_b32 v11, 2, v11
    s_lshl_b32 s63, s34, 7
    s_add_u32 s63, s63, 229376
    buffer_load_dword v12, v39, s[40:43], s98 offen sc1
    s_branch L_poll_103
L_poll_103s:
    s_sleep 16
L_poll_103:
    buffer_load_dwordx2 v[8:9], v2, s[40:43], s99 offen sc1
    buffer_load_dword v10, v11, s[40:43], s63 offen sc1
    s_sub_u32 s60, s60, 1
    s_cbranch_scc1 L_poll_103t
    s_waitcnt vmcnt(0)
    v_max3_u32 v38, v8, v9, v10
    v_cmp_eq_u32 vcc, -1, v38
    s_cbranch_vccnz L_poll_103s
L_poll_103e:
    v_mov_b32 v37, v8
    s_nop 1
    v_max_f32_dpp v37, v37, v37 quad_perm:[1,0,3,2] row_mask:0xf bank_mask:0xf
    s_nop 1
    v_max_f32_dpp v37, v37, v37 quad_perm:[2,3,0,1] row_mask:0xf bank_mask:0xf
    s_nop 1
    v_max_f32_dpp v37, v37, v37 row_ror:4 row_mask:0xf bank_mask:0xf
    s_nop 1
    v_max_f32_dpp v37, v37, v37 row_ror:8 row_mask:0xf bank_mask:0xf
    v_sub_f32 v8, v8, v37
    v_exp_f32 v8, v8
    s_nop 0
    v_mul_f32 v9, v8, v9
    s_nop 1
    v_add_f32_dpp v9, v9, v9 quad_perm:[1,0,3,2] row_mask:0xf bank_mask:0xf
    s_nop 1
    v_add_f32_dpp v9, v9, v9 quad_perm:[2,3,0,1] row_mask:0xf bank_mask:0xf
    s_nop 1
    v_add_f32_dpp v9, v9, v9 row_ror:4 row_mask:0xf bank_mask:0xf
    s_nop 1
    v_add_f32_dpp v9, v9, v9 row_ror:8 row_mask:0xf bank_mask:0xf
    s_getreg_b32 s62, hwreg(HW_REG_XCC_ID, 0, 4)
    v_cmp_ne_u32 vcc, s62, v10
    s_nop 0
    s_cmp_eq_u64 vcc, 0
    s_cselect_b32 s61, 1, 0
    v_rcp_f32 v9, v9
    v_lshrrev_b32 v3, 1, v2
    v_add_u32 v3, 161984, v3
    v_mul_f32 v8, v8, v9
    v_mov_b32 v10, 162072
    v_mov_b32 v11, s61
    ds_write_b32 v3, v8
    ds_write_b32 v10, v11
    s_mov_b32 s3, 1
    v_lshrrev_b32 v9, 4, v0
    v_lshl_add_u32 v8, v9, 2, v2
    s_lshl_b32 s96, s3, 9
    s_add_u32 s96, s96, 157824
    v_lshl_add_u32 v8, v8, 2, s96
    v_lshlrev_b32 v9, 3, v0
    v_add_u32 v9, 157824, v9
    v_mov_b32 v10, 162048
    v_mov_b32 v11, 1
    s_lshl_b32 s96, s38, 5
    s_add_u32 s96, s96, 161984
    v_mov_b32 v3, s96
    s_sub_u32 s62, 8, s39
    s_lshl_b32 s98, s34, 5
    s_add_u32 s98, s98, s35
    s_lshl_b32 s98, s98, 8
    s_add_u32 s98, s98, 90112
    v_lshlrev_b32 v39, 2, v0
    s_branch L_t0b
L_jobend:
    v_lshlrev_b32 v9, 4, v0
    s_mov_b32 exec_hi, 0
    s_nop 3
    buffer_store_dwordx4 v[32:35], v9, s[40:43], s13 offen sc1
    s_endpgm
L_proxy:
    v_mov_b32 v72, 0
    v_mov_b32 v73, 0
    v_mov_b32 v74, 0
    v_mov_b32 v75, 0
    v_mov_b32 v76, 0
    v_mov_b32 v5, 0
    v_mov_b32 v105, 0
    v_mov_b32 v108, 0
    v_mov_b32 v160, 0
    v_mov_b32 v163, 0
    s_barrier
    s_waitcnt lgkmcnt(0)
    s_mov_b32 s40, s32
    s_mov_b32 s41, s33
    s_mov_b32 s42, 589824
    s_mov_b32 s43, 0x20000
    s_mov_b32 s44, s30
    s_mov_b32 s45, s31
    s_mov_b32 s46, 256
    s_mov_b32 s47, 0x20000
    s_sub_u32 s97, 7, s3
    s_mul_i32 s97, s97, 27
    s_cmp_eq_u32 s3, 5
    s_cselect_b32 s97, 32, s97
    s_add_u32 s97, s97, s35
    s_lshl_b32 s97, s97, 9
    s_add_u32 s97, s97, 196608
    v_and_b32 v2, 15, v0
    v_lshlrev_b32 v2, 3, v2
    v_and_b32 v20, 31, v0
    v_lshlrev_b32 v20, 4, v20
    s_cmp_lg_u32 s3, 7
    s_cbranch_scc1 L_px6
    s_sub_u32 s96, 6, s59
    v_mov_b32 v8, 162068
L_lw_104:
    ds_read_b32 v9, v8
    s_waitcnt lgkmcnt(0)
    v_cmp_gt_u32 vcc, s96, v9
    s_cbranch_vccz L_lw_104e
    s_sleep 8
    s_sub_u32 s60, s60, 1
    s_cbranch_scc0 L_lw_104
    s_mov_b32 s60, 0
L_lw_104e:
    v_and_b32 v2, 15, v0
    v_lshlrev_b32 v2, 3, v2
    v_add_u32 v3, 161920, v2
    ds_read_b64 v[8:9], v3
    s_lshl_b32 s99, s37, 5
    s_add_u32 s99, s99, s36
    s_lshl_b32 s99, s99, 7
    s_add_u32 s99, s99, 73728
    s_lshl_b32 s62, s38, 6
    s_add_u32 s62, s62, s99
    s_getreg_b32 s58, hwreg(HW_REG_XCC_ID, 0, 4)
    v_mov_b32 v10, s58
    s_lshl_b32 s98, s34, 5
    s_add_u32 s98, s98, s35
    s_lshl_b32 s63, s98, 2
    s_add_u32 s63, s63, 229376
    s_lshl_b32 s98, s98, 8
    s_add_u32 s98, s98, 90112
    v_lshlrev_b32 v39, 2, v0
    s_bfm_b64 exec, s96, 0
    s_waitcnt lgkmcnt(0)
    buffer_store_dwordx2 v[8:9], v2, s[40:43], s62 offen sc1
    s_mov_b64 exec, 1
    buffer_store_dword v10, v36, s[40:43], s63 offen sc1
    s_mov_b64 exec, -1
    s_mov_b32 s100, 4
    s_lshl_b32 s63, s100, 8
    v_and_b32 v8, 15, v0
    v_lshl_add_u32 v8, v8, 4, s63
    v_lshrrev_b32 v9, 4, v0
    v_mul_u32_u24 v5, 1280, v9
    v_add_u32 v5, v5, v8
    v_mul_u32_u24 v4, 1296, v9
    v_add_u32 v4, v4, v8
    v_add_u32 v4, 82944, v4
    v_lshlrev_b32 v6, 1, v5
    v_add_u32 v6, 99328, v6
    s_lshl_b32 s62, s100, 9
    s_add_u32 s62, s62, 88128
    v_lshl_add_u32 v7, v0, 3, s62
    s_mov_b32 s48, s4
    s_mov_b32 s49, s5
    s_mov_b32 s50, 5120
    s_mov_b32 s51, 0x20000
    buffer_load_dwordx4 v[8:11], v5, s[48:51], 0 offen
    s_mov_b32 s62, 20480
    s_mov_b32 s63, 30720
    s_branch L_poll_105
L_poll_105s:
    s_sleep 32
L_poll_105:
    buffer_load_dwordx4 v[12:15], v5, s[40:43], s62 offen sc1
    buffer_load_dwordx4 v[16:19], v5, s[40:43], s63 offen sc1
    s_sub_u32 s60, s60, 1
    s_cbranch_scc1 L_poll_105t
    s_waitcnt vmcnt(0)
    v_max3_u32 v38, v12, v13, v14
    v_max3_u32 v38, v38, v15, v16
    v_max3_u32 v38, v38, v17, v18
    v_max_u32 v38, v38, v19
    v_cmp_eq_u32 vcc, -1, v38
    s_cbranch_vccnz L_poll_105s
L_poll_105e:
    v_lshlrev_b32 v40, 16, v8
    v_and_b32 v41, 0xffff0000, v8
    v_lshlrev_b32 v42, 16, v9
    v_and_b32 v43, 0xffff0000, v9
    v_lshlrev_b32 v44, 16, v10
    v_and_b32 v45, 0xffff0000, v10
    v_lshlrev_b32 v46, 16, v11
    v_and_b32 v47, 0xffff0000, v11
    v_lshlrev_b32 v48, 16, v12
    v_and_b32 v49, 0xffff0000, v12
    v_lshlrev_b32 v50, 16, v13
    v_and_b32 v51, 0xffff0000, v13
    v_lshlrev_b32 v52, 16, v14
    v_and_b32 v53, 0xffff0000, v14
    v_lshlrev_b32 v54, 16, v15
    v_and_b32 v55, 0xffff0000, v15
    v_lshlrev_b32 v56, 16, v16
    v_and_b32 v57, 0xffff0000, v16
    v_lshlrev_b32 v58, 16, v17
    v_and_b32 v59, 0xffff0000, v17
    v_lshlrev_b32 v60, 16, v18
    v_and_b32 v61, 0xffff0000, v18
    v_lshlrev_b32 v62, 16, v19
    v_and_b32 v63, 0xffff0000, v19
    v_mov_b32 v64, 0
    v_mov_b32 v65, 0
    v_mov_b32 v66, 0
    v_mov_b32 v67, 0
    v_mov_b32 v68, 0
    v_mov_b32 v69, 0
    v_mov_b32 v70, 0
    v_mov_b32 v71, 0
    v_bfe_u32 v5, v0, 2, 2
    v_lshlrev_b32 v5, 8, v5
    v_lshrrev_b32 v8, 4, v0
    v_lshl_add_u32 v5, v8, 6, v5
    v_and_b32 v8, 3, v0
    v_lshl_add_u32 v5, v8, 4, v5
    s_lshl_b32 s63, s100, 10
    v_add_u32 v5, s63, v5
    s_or_b32 s96, s59, s39
    s_cbranch_scc0 L_nofrag_106
    v_mov_b32 v104, 162060
L_lw_107:
    ds_read_b32 v105, v104
    s_waitcnt lgkmcnt(0)
    v_cmp_gt_u32 vcc, 4, v105
    s_cbranch_vccz L_lw_107e
    s_sleep 2
    s_sub_u32 s60, s60, 1
    s_cbranch_scc0 L_lw_107
    s_mov_b32 s60, 0
L_lw_107e:
    s_cmp_eq_u32 s59, 0
    s_cbranch_scc1 L_nofrag_106
    v_bfe_u32 v104, v0, 2, 1
    v_bfe_u32 v110, v0, 4, 1
    v_lshl_add_u32 v104, v110, 2, v104
    v_and_b32 v110, 8, v0
    v_add_u32 v104, v104, v110
    v_lshrrev_b32 v110, 5, v0
    v_lshl_add_u32 v104, v110, 4, v104
    v_bfe_u32 v111, v0, 0, 1
    v_mul_u32_u24 v111, 0xaaaa, v111
    v_add_u32 v111, 0x4444, v111
    v_mov_b32 v112, 0
    v_mov_b32 v113, 0
    v_mov_b32 v114, 0
    v_mov_b32 v115, 0
    v_mov_b32 v116, 0
    v_mov_b32 v117, 0
    v_mov_b32 v118, 0
    v_mov_b32 v119, 0
    v_lshlrev_b32 v104, 7, v104
    v_and_b32 v110, 3, v0
    v_lshl_add_u32 v104, v110, 3, v104
    v_lshrrev_b32 v109, 4, v0
    v_and_b32 v110, 1, v0
    s_lshr_b32 s63, s3, 1
    s_and_b32 s62, s3, 1
    s_lshl_b32 s96, s63, 14
    s_lshl_b32 s100, s62, 6
    s_add_u32 s100, s100, 81920
    s_add_u32 s96, s96, s100
    v_add_u32 v104, s96, v104
    ds_read_b64_tr_b16 v[72:73], v104 offset:0
    ds_read_b64_tr_b16 v[74:75], v104 offset:256
    ds_read_b64_tr_b16 v[76:77], v104 offset:4096
    ds_read_b64_tr_b16 v[78:79], v104 offset:4352
    ds_read_b64_tr_b16 v[80:81], v104 offset:32
    ds_read_b64_tr_b16 v[82:83], v104 offset:288
    ds_read_b64_tr_b16 v[84:85], v104 offset:4128
    ds_read_b64_tr_b16 v[86:87], v104 offset:4384
    ds_read_b64_tr_b16 v[88:89], v104 offset:8192
    ds_read_b64_tr_b16 v[90:91], v104 offset:8448
    ds_read_b64_tr_b16 v[92:93], v104 offset:12288
    ds_read_b64_tr_b16 v[94:95], v104 offset:12544
    ds_read_b64_tr_b16 v[96:97], v104 offset:8224
    ds_read_b64_tr_b16 v[98:99], v104 offset:8480
    ds_read_b64_tr_b16 v[100:101], v104 offset:12320
    ds_read_b64_tr_b16 v[102:103], v104 offset:12576
    v_bfe_u32 v105, v0, 1, 3
    v_lshlrev_b32 v105, 8, v105
    v_lshl_add_u32 v105, v109, 5, v105
    v_lshl_add_u32 v105, v110, 4, v105
    v_lshrrev_b32 v106, 3, v0
    v_lshlrev_b32 v106, 7, v106
    v_and_b32 v110, 7, v0
    v_lshl_add_u32 v107, v110, 3, v106
    v_add_u32 v107, s100, v107
    v_lshlrev_b32 v106, 8, v109
    v_and_b32 v110, 15, v0
    v_lshl_add_u32 v106, v110, 2, v106
    v_add_u32 v106, s96, v106
    v_lshlrev_b32 v108, 2, v0
    s_lshl_b32 s96, s62, 2
    s_add_u32 s96, s96, 162088
    v_mov_b32 v109, s96
    s_lshl_b32 s100, s63, 11
    s_lshl_b32 s96, s34, 13
    s_add_u32 s100, s100, s96
    s_add_u32 s100, s100, 90112
    s_mul_i32 s101, s34, 5120
    s_lshl_b32 s96, s35, 9
    s_add_u32 s101, s101, s96
    s_lshl_b32 s96, s62, 8
    s_add_u32 s101, s101, s96
    s_add_u32 s101, s101, 144384
L_nofrag_106:
    s_cmp_ge_u32 s35, 20
    s_cbranch_scc1 L_nofin_108
    s_lshl1_add_u32 s62, s35, s3
    s_sub_u32 s62, s62, 6
    s_lshl_b32 s57, s62, 7
    s_mul_i32 s63, s62, 0x199a
    s_lshr_b32 s63, s63, 16
    s_mul_i32 s63, s63, 1280
    s_sub_u32 s63, s57, s63
    v_lshrrev_b32 v72, 3, v0
    v_mul_u32_u24 v72, 5120, v72
    v_and_b32 v8, 7, v0
    v_lshl_add_u32 v72, v8, 4, v72
    s_add_u32 s62, s57, 262144
    v_add_u32 v72, s62, v72
    v_add_u32 v73, 40960, v72
    v_add_u32 v74, 81920, v72
    v_add_u32 v75, 122880, v72
    v_bfe_u32 v9, v0, 4, 1
    v_lshlrev_b32 v76, 4, v8
    v_lshl_add_u32 v76, v9, 3, v76
    s_lshl_b32 s62, s57, 1
    s_add_u32 s62, s62, 99328
    v_lshl_add_u32 v77, v76, 1, s62
    s_mov_b32 s48, s22
    s_mov_b32 s49, s23
    s_mov_b32 s50, 1280
    s_mov_b32 s51, 0x20000
    buffer_load_dwordx2 v[86:87], v76, s[48:51], s63 offen
    s_add_u32 s62, s57, 35840
    s_branch L_poll_109
L_poll_109s:
    s_sleep 32
L_poll_109:
    buffer_load_dwordx2 v[8:9], v76, s[40:43], s62 offen sc1
    s_sub_u32 s60, s60, 1
    s_cbranch_scc1 L_poll_109t
    s_waitcnt vmcnt(0)
    v_max_u32 v38, v8, v9
    v_cmp_eq_u32 vcc, -1, v38
    s_cbranch_vccnz L_poll_109s
L_poll_109e:
    v_lshlrev_b32 v78, 16, v86
    v_and_b32 v79, 0xffff0000, v86
    v_lshlrev_b32 v82, 16, v8
    v_and_b32 v83, 0xffff0000, v8
    v_lshlrev_b32 v80, 16, v87
    v_and_b32 v81, 0xffff0000, v87
    v_lshlrev_b32 v84, 16, v9
    v_and_b32 v85, 0xffff0000, v9
    v_bfe_u32 v8, v0, 1, 3
    v_and_b32 v9, 1, v0
    v_lshlrev_b32 v9, 4, v9
    v_mov_b32 v10, 0x3f80
    v_lshlrev_b32 v9, v9, v10
    v_cmp_eq_u32 vcc, 0, v8
    v_mov_b32 v100, 0
    s_nop 0
    v_cndmask_b32 v104, 0, v9, vcc
    v_cmp_eq_u32 vcc, 1, v8
    v_mov_b32 v101, 0
    s_nop 0
    v_cndmask_b32 v105, 0, v9, vcc
    v_cmp_eq_u32 vcc, 2, v8
    v_mov_b32 v102, 0
    s_nop 0
    v_cndmask_b32 v106, 0, v9, vcc
    v_cmp_eq_u32 vcc, 3, v8
    v_mov_b32 v103, 0
    s_nop 0
    v_cndmask_b32 v107, 0, v9, vcc
L_nofin_108:
    v_mov_b32 v12, 162076
L_lw_110:
    ds_read_b32 v13, v12
    s_waitcnt lgkmcnt(0)
    v_cmp_gt_u32 vcc, 4, v13
    s_cbranch_vccz L_lw_110e
    s_sleep 4
    s_sub_u32 s60, s60, 1
    s_cbranch_scc0 L_lw_110
    s_mov_b32 s60, 0
L_lw_110e:
    v_and_b32 v11, 31, v0
    v_lshlrev_b32 v11, 2, v11
    s_lshl_b32 s63, s34, 7
    s_add_u32 s63, s63, 229376
    buffer_load_dword v12, v39, s[40:43], s98 offen sc1
    s_branch L_poll_111
L_poll_111s:
    s_sleep 4
L_poll_111:
    buffer_load_dwordx2 v[8:9], v2, s[40:43], s99 offen sc1
    buffer_load_dword v10, v11, s[40:43], s63 offen sc1
    buffer_load_dwordx4 v[32:35], v20, s[40:43], s97 offen sc1
    s_sub_u32 s60, s60, 1
    s_cbranch_scc1 L_poll_111t
    s_waitcnt vmcnt(0)
    v_max3_u32 v38, v8, v9, v10
    v_max3_u32 v38, v38, v32, v33
    v_max3_u32 v38, v38, v34, v35
    v_cmp_eq_u32 vcc, -1, v38
    s_cbranch_vccnz L_poll_111s
L_poll_111e:
    v_mov_b32 v37, v8
    s_nop 1
    v_max_f32_dpp v37, v37, v37 quad_perm:[1,0,3,2] row_mask:0xf bank_mask:0xf
    s_nop 1
    v_max_f32_dpp v37, v37, v37 quad_perm:[2,3,0,1] row_mask:0xf bank_mask:0xf
    s_nop 1
    v_max_f32_dpp v37, v37, v37 row_ror:4 row_mask:0xf bank_mask:0xf
    s_nop 1
    v_max_f32_dpp v37, v37, v37 row_ror:8 row_mask:0xf bank_mask:0xf
    v_sub_f32 v8, v8, v37
    v_exp_f32 v8, v8
    s_nop 0
    v_mul_f32 v9, v8, v9
    s_nop 1
    v_add_f32_dpp v9, v9, v9 quad_perm:[1,0,3,2] row_mask:0xf bank_mask:0xf
    s_nop 1
    v_add_f32_dpp v9, v9, v9 quad_perm:[2,3,0,1] row_mask:0xf bank_mask:0xf
    s_nop 1
    v_add_f32_dpp v9, v9, v9 row_ror:4 row_mask:0xf bank_mask:0xf
    s_nop 1
    v_add_f32_dpp v9, v9, v9 row_ror:8 row_mask:0xf bank_mask:0xf
    s_getreg_b32 s62, hwreg(HW_REG_XCC_ID, 0, 4)
    v_cmp_ne_u32 vcc, s62, v10
    s_nop 0
    s_cmp_eq_u64 vcc, 0
    s_cselect_b32 s61, 1, 0
    v_rcp_f32 v9, v9
    v_lshrrev_b32 v3, 1, v2
    v_add_u32 v3, 161984, v3
    v_mul_f32 v8, v8, v9
    v_mov_b32 v10, 162072
    v_mov_b32 v11, s61
    ds_write_b32 v3, v8
    ds_write_b32 v10, v11
    s_branch L_pxj
L_px6:
    s_or_b32 s96, s59, s39
    s_cbranch_scc0 L_nofrag_112
    v_mov_b32 v104, 162060
L_lw_113:
    ds_read_b32 v105, v104
    s_waitcnt lgkmcnt(0)
    v_cmp_gt_u32 vcc, 4, v105
    s_cbranch_vccz L_lw_113e
    s_sleep 2
    s_sub_u32 s60, s60, 1
    s_cbranch_scc0 L_lw_113
    s_mov_b32 s60, 0
L_lw_113e:
    s_cmp_eq_u32 s59, 0
    s_cbranch_scc1 L_nofrag_112
    v_bfe_u32 v104, v0, 2, 1
    v_bfe_u32 v110, v0, 4, 1
    v_lshl_add_u32 v104, v110, 2, v104
    v_and_b32 v110, 8, v0
    v_add_u32 v104, v104, v110
    v_lshrrev_b32 v110, 5, v0
    v_lshl_add_u32 v104, v110, 4, v104
    v_bfe_u32 v111, v0, 0, 1
    v_mul_u32_u24 v111, 0xaaaa, v111
    v_add_u32 v111, 0x4444, v111
    v_mov_b32 v112, 0
    v_mov_b32 v113, 0
    v_mov_b32 v114, 0
    v_mov_b32 v115, 0
    v_mov_b32 v116, 0
    v_mov_b32 v117, 0
    v_mov_b32 v118, 0
    v_mov_b32 v119, 0
    v_lshlrev_b32 v104, 7, v104
    v_and_b32 v110, 3, v0
    v_lshl_add_u32 v104, v110, 3, v104
    v_lshrrev_b32 v109, 4, v0
    v_and_b32 v110, 1, v0
    s_lshr_b32 s63, s3, 1
    s_and_b32 s62, s3, 1
    s_lshl_b32 s96, s63, 14
    s_lshl_b32 s100, s62, 6
    s_add_u32 s100, s100, 81920
    s_add_u32 s96, s96, s100
    v_add_u32 v104, s96, v104
    ds_read_b64_tr_b16 v[72:73], v104 offset:0
    ds_read_b64_tr_b16 v[74:75], v104 offset:256
    ds_read_b64_tr_b16 v[76:77], v104 offset:4096
    ds_read_b64_tr_b16 v[78:79], v104 offset:4352
    ds_read_b64_tr_b16 v[80:81], v104 offset:32
    ds_read_b64_tr_b16 v[82:83], v104 offset:288
    ds_read_b64_tr_b16 v[84:85], v104 offset:4128
    ds_read_b64_tr_b16 v[86:87], v104 offset:4384
    ds_read_b64_tr_b16 v[88:89], v104 offset:8192
    ds_read_b64_tr_b16 v[90:91], v104 offset:8448
    ds_read_b64_tr_b16 v[92:93], v104 offset:12288
    ds_read_b64_tr_b16 v[94:95], v104 offset:12544
    ds_read_b64_tr_b16 v[96:97], v104 offset:8224
    ds_read_b64_tr_b16 v[98:99], v104 offset:8480
    ds_read_b64_tr_b16 v[100:101], v104 offset:12320
    ds_read_b64_tr_b16 v[102:103], v104 offset:12576
    v_bfe_u32 v105, v0, 1, 3
    v_lshlrev_b32 v105, 8, v105
    v_lshl_add_u32 v105, v109, 5, v105
    v_lshl_add_u32 v105, v110, 4, v105
    v_lshrrev_b32 v106, 3, v0
    v_lshlrev_b32 v106, 7, v106
    v_and_b32 v110, 7, v0
    v_lshl_add_u32 v107, v110, 3, v106
    v_add_u32 v107, s100, v107
    v_lshlrev_b32 v106, 8, v109
    v_and_b32 v110, 15, v0
    v_lshl_add_u32 v106, v110, 2, v106
    v_add_u32 v106, s96, v106
    v_lshlrev_b32 v108, 2, v0
    s_lshl_b32 s96, s62, 2
    s_add_u32 s96, s96, 162088
    v_mov_b32 v109, s96
    s_lshl_b32 s100, s63, 11
    s_lshl_b32 s96, s34, 13
    s_add_u32 s100, s100, s96
    s_add_u32 s100, s100, 90112
    s_mul_i32 s101, s34, 5120
    s_lshl_b32 s96, s35, 9
    s_add_u32 s101, s101, s96
    s_lshl_b32 s96, s62, 8
    s_add_u32 s101, s101, s96
    s_add_u32 s101, s101, 144384
L_nofrag_112:
    v_mov_b32 v8, 162068
L_lw_114:
    ds_read_b32 v9, v8
    s_waitcnt lgkmcnt(0)
    v_cmp_gt_u32 vcc, 1, v9
    s_cbranch_vccz L_lw_114e
    s_sleep 32
    s_sub_u32 s60, s60, 1
    s_cbranch_scc0 L_lw_114
    s_mov_b32 s60, 0
L_lw_114e:
    s_cmp_ge_u32 s35, 20
    s_cbranch_scc1 L_nofin_115
    s_lshl1_add_u32 s62, s35, s3
    s_sub_u32 s62, s62, 6
    s_lshl_b32 s57, s62, 7
    s_mul_i32 s63, s62, 0x199a
    s_lshr_b32 s63, s63, 16
    s_mul_i32 s63, s63, 1280
    s_sub_u32 s63, s57, s63
    v_lshrrev_b32 v72, 3, v0
    v_mul_u32_u24 v72, 5120, v72
    v_and_b32 v8, 7, v0
    v_lshl_add_u32 v72, v8, 4, v72
    s_add_u32 s62, s57, 262144
    v_add_u32 v72, s62, v72
    v_add_u32 v73, 40960, v72
    v_add_u32 v74, 81920, v72
    v_add_u32 v75, 122880, v72
    v_bfe_u32 v9, v0, 4, 1
    v_lshlrev_b32 v76, 4, v8
    v_lshl_add_u32 v76, v9, 3, v76
    s_lshl_b32 s62, s57, 1
    s_add_u32 s62, s62, 99328
    v_lshl_add_u32 v77, v76, 1, s62
    s_mov_b32 s48, s22
    s_mov_b32 s49, s23
    s_mov_b32 s50, 1280
    s_mov_b32 s51, 0x20000
    buffer_load_dwordx2 v[86:87], v76, s[48:51], s63 offen
    s_add_u32 s62, s57, 35840
    s_branch L_poll_116
L_poll_116s:
    s_sleep 32
L_poll_116:
    buffer_load_dwordx2 v[8:9], v76, s[40:43], s62 offen sc1
    s_sub_u32 s60, s60, 1
    s_cbranch_scc1 L_poll_116t
    s_waitcnt vmcnt(0)
    v_max_u32 v38, v8, v9
    v_cmp_eq_u32 vcc, -1, v38
    s_cbranch_vccnz L_poll_116s
L_poll_116e:
    v_lshlrev_b32 v78, 16, v86
    v_and_b32 v79, 0xffff0000, v86
    v_lshlrev_b32 v82, 16, v8
    v_and_b32 v83, 0xffff0000, v8
    v_lshlrev_b32 v80, 16, v87
    v_and_b32 v81, 0xffff0000, v87
    v_lshlrev_b32 v84, 16, v9
    v_and_b32 v85, 0xffff0000, v9
    v_bfe_u32 v8, v0, 1, 3
    v_and_b32 v9, 1, v0
    v_lshlrev_b32 v9, 4, v9
    v_mov_b32 v10, 0x3f80
    v_lshlrev_b32 v9, v9, v10
    v_cmp_eq_u32 vcc, 0, v8
    v_mov_b32 v100, 0
    s_nop 0
    v_cndmask_b32 v104, 0, v9, vcc
    v_cmp_eq_u32 vcc, 1, v8
    v_mov_b32 v101, 0
    s_nop 0
    v_cndmask_b32 v105, 0, v9, vcc
    v_cmp_eq_u32 vcc, 2, v8
    v_mov_b32 v102, 0
    s_nop 0
    v_cndmask_b32 v106, 0, v9, vcc
    v_cmp_eq_u32 vcc, 3, v8
    v_mov_b32 v103, 0
    s_nop 0
    v_cndmask_b32 v107, 0, v9, vcc
L_nofin_115:
    v_mov_b32 v8, 162076
L_lw_117:
    ds_read_b32 v9, v8
    s_waitcnt lgkmcnt(0)
    v_cmp_gt_u32 vcc, 4, v9
    s_cbranch_vccz L_lw_117e
    s_sleep 16
    s_sub_u32 s60, s60, 1
    s_cbranch_scc0 L_lw_117
    s_mov_b32 s60, 0
L_lw_117e:
    s_branch L_poll_118
L_poll_118s:
    s_sleep 4
L_poll_118:
    buffer_load_dwordx4 v[32:35], v20, s[40:43], s97 offen sc1
    s_sub_u32 s60, s60, 1
    s_cbranch_scc1 L_poll_118t
    s_waitcnt vmcnt(0)
    v_max3_u32 v38, v32, v33, v34
    v_max_u32 v38, v38, v35
    v_cmp_eq_u32 vcc, -1, v38
    s_cbranch_vccnz L_poll_118s
L_poll_118e:
L_pxj:
    s_cmp_ge_u32 s35, 20
    s_cbranch_scc1 L_pxk
    buffer_load_dwordx4 v[88:91], v72, s[40:43], 0 offen sc1
    buffer_load_dwordx4 v[92:95], v73, s[40:43], 0 offen sc1
    buffer_load_dwordx4 v[96:99], v74, s[40:43], 0 offen sc1
    s_mov_b64 exec, 0xffffff
    buffer_load_dwordx4 v[100:103], v75, s[40:43], 0 offen sc1
    s_mov_b64 exec, -1
L_pxk:
    v_mov_b32 v8, 162048
L_lw_119:
    ds_read_b32 v9, v8
    s_waitcnt lgkmcnt(0)
    v_cmp_gt_u32 vcc, 3, v9
    s_cbranch_vccz L_lw_119e
    s_sleep 2
    s_sub_u32 s60, s60, 1
    s_cbranch_scc0 L_lw_119
    s_mov_b32 s60, 0
L_lw_119e:
    v_lshrrev_b32 v9, 4, v0
    v_lshl_add_u32 v8, v9, 2, v2
    s_lshl_b32 s96, s3, 9
    s_add_u32 s96, s96, 157824
    v_lshl_add_u32 v8, v8, 2, s96
    v_lshlrev_b32 v9, 3, v0
    v_add_u32 v9, 157824, v9
    v_mov_b32 v10, 162048
    v_mov_b32 v11, 1
    s_lshl_b32 s96, s38, 5
    s_add_u32 s96, s96, 161984
    v_mov_b32 v3, s96
    s_sub_u32 s62, 8, s39
    s_lshl_b32 s98, s34, 5
    s_add_u32 s98, s98, s35
    s_lshl_b32 s98, s98, 8
    s_add_u32 s98, s98, 90112
    v_lshlrev_b32 v39, 2, v0
    s_branch L_t0
L_s_role:
    s_cmp_eq_u32 s3, 7
    s_cbranch_scc1 L_t2gate
    s_cmp_gt_u32 s3, 3
    s_cbranch_scc1 L_fin_prep
    s_mov_b32 s48, s18
    s_mov_b32 s49, s19
    s_mov_b32 s50, 3456
    s_mov_b32 s51, 0x20000
    v_lshrrev_b32 v3, 4, v0
    v_and_b32 v4, 15, v0
    v_lshlrev_b32 v4, 1, v4
    s_lshl_b32 s62, s35, 7
    s_lshl_b32 s63, s3, 5
    s_add_u32 s62, s62, s63
    buffer_load_ushort v82, v4, s[48:51], s62 offen
    v_mov_b32 v72, 162064
L_lw_120:
    ds_read_b32 v73, v72
    s_waitcnt lgkmcnt(0)
    v_cmp_gt_u32 vcc, 4, v73
    s_cbranch_vccz L_lw_120e
    s_sleep 2
    s_sub_u32 s60, s60, 1
    s_cbranch_scc0 L_lw_120
    s_mov_b32 s60, 0
L_lw_120e:
    v_bfe_u32 v72, v0, 2, 1
    v_bfe_u32 v73, v0, 4, 1
    v_lshl_add_u32 v72, v73, 2, v72
    v_and_b32 v73, 8, v0
    v_add_u32 v72, v72, v73
    v_lshrrev_b32 v73, 5, v0
    v_lshl_add_u32 v72, v73, 4, v72
    v_lshlrev_b32 v72, 7, v72
    v_and_b32 v73, 3, v0
    v_lshl_add_u32 v72, v73, 3, v72
    v_and_b32 v73, 8, v0
    v_lshl_add_u32 v72, v73, 3, v72
    v_xor_b32 v72, s63, v72
    v_xor_b32 v73, 32, v72
    v_add_u32 v74, 40960, v72
    v_add_u32 v75, 40960, v73
    v_bfe_u32 v1, v0, 2, 2
    v_bfe_u32 v2, v0, 1, 1
    v_and_b32 v6, 1, v0
    v_lshlrev_b32 v7, 5, v3
    v_lshl_add_u32 v7, v6, 4, v7
    v_lshl_add_u32 v5, v2, 2, v1
    v_mul_u32_u24 v5, 1296, v5
    v_add_u32 v5, v5, v7
    v_add_u32 v5, 147456, v5
    v_bfe_u32 v87, v0, 0, 1
    v_mul_u32_u24 v87, 0xaaaa, v87
    v_add_u32 v87, 0x4444, v87
    ds_read_b64_tr_b16 v[88:89], v72 offset:0
    ds_read_b64_tr_b16 v[90:91], v73 offset:256
    ds_read_b64_tr_b16 v[92:93], v72 offset:4096
    ds_read_b64_tr_b16 v[94:95], v73 offset:4352
    ds_read_b64_tr_b16 v[96:97], v72 offset:8192
    ds_read_b64_tr_b16 v[98:99], v73 offset:8448
    ds_read_b64_tr_b16 v[100:101], v72 offset:12288
    ds_read_b64_tr_b16 v[102:103], v73 offset:12544
    ds_read_b64_tr_b16 v[104:105], v72 offset:16384
    ds_read_b64_tr_b16 v[106:107], v73 offset:16640
    ds_read_b64_tr_b16 v[108:109], v72 offset:20480
    ds_read_b64_tr_b16 v[110:111], v73 offset:20736
    ds_read_b64_tr_b16 v[112:113], v72 offset:24576
    ds_read_b64_tr_b16 v[114:115], v73 offset:24832
    ds_read_b64_tr_b16 v[116:117], v72 offset:28672
    ds_read_b64_tr_b16 v[118:119], v73 offset:28928
    ds_read_b64_tr_b16 v[120:121], v72 offset:32768
    ds_read_b64_tr_b16 v[122:123], v73 offset:33024
    ds_read_b64_tr_b16 v[124:125], v72 offset:36864
    ds_read_b64_tr_b16 v[126:127], v73 offset:37120
    ds_read_b64_tr_b16 v[128:129], v74 offset:0
    ds_read_b64_tr_b16 v[130:131], v75 offset:256
    ds_read_b64_tr_b16 v[132:133], v74 offset:4096
    ds_read_b64_tr_b16 v[134:135], v75 offset:4352
    ds_read_b64_tr_b16 v[136:137], v74 offset:8192
    ds_read_b64_tr_b16 v[138:139], v75 offset:8448
    ds_read_b64_tr_b16 v[140:141], v74 offset:12288
    ds_read_b64_tr_b16 v[142:143], v75 offset:12544
    ds_read_b64_tr_b16 v[144:145], v74 offset:16384
    ds_read_b64_tr_b16 v[146:147], v75 offset:16640
    ds_read_b64_tr_b16 v[148:149], v74 offset:20480
    ds_read_b64_tr_b16 v[150:151], v75 offset:20736
    ds_read_b64_tr_b16 v[152:153], v74 offset:24576
    ds_read_b64_tr_b16 v[154:155], v75 offset:24832
    ds_read_b64_tr_b16 v[156:157], v74 offset:28672
    ds_read_b64_tr_b16 v[158:159], v75 offset:28928
    ds_read_b64_tr_b16 v[160:161], v74 offset:32768
    ds_read_b64_tr_b16 v[162:163], v75 offset:33024
    ds_read_b64_tr_b16 v[164:165], v74 offset:36864
    ds_read_b64_tr_b16 v[166:167], v75 offset:37120
    ds_read_b128 v[8:11], v5 offset:0
    ds_read_b128 v[12:15], v5 offset:128
    ds_read_b128 v[16:19], v5 offset:256
    ds_read_b128 v[20:23], v5 offset:384
    ds_read_b128 v[24:27], v5 offset:512
    ds_read_b128 v[28:31], v5 offset:640
    ds_read_b128 v[32:35], v5 offset:768
    ds_read_b128 v[36:39], v5 offset:896
    ds_read_b128 v[40:43], v5 offset:1024
    ds_read_b128 v[44:47], v5 offset:1152
    v_mov_b32 v48, 0
    v_mov_b32 v49, 0
    v_mov_b32 v50, 0
    v_mov_b32 v51, 0
    v_mov_b32 v52, 0
    v_mov_b32 v53, 0
    v_mov_b32 v54, 0
    v_mov_b32 v55, 0
    v_mov_b32 v56, 0
    v_mov_b32 v57, 0
    v_mov_b32 v58, 0
    v_mov_b32 v59, 0
    s_waitcnt lgkmcnt(9)
    v_smfmac_f32_16x16x64_bf16 v[48:51], v[8:11], v[88:95], v87
    s_waitcnt lgkmcnt(8)
    v_smfmac_f32_16x16x64_bf16 v[48:51], v[12:15], v[96:103], v87
    s_waitcnt lgkmcnt(7)
    v_smfmac_f32_16x16x64_bf16 v[48:51], v[16:19], v[104:111], v87
    s_waitcnt lgkmcnt(6)
    v_smfmac_f32_16x16x64_bf16 v[48:51], v[20:23], v[112:119], v87
    s_waitcnt lgkmcnt(5)
    v_smfmac_f32_16x16x64_bf16 v[48:51], v[24:27], v[120:127], v87
    s_waitcnt lgkmcnt(4)
    v_smfmac_f32_16x16x64_bf16 v[48:51], v[28:31], v[128:135], v87
    s_waitcnt lgkmcnt(3)
    v_smfmac_f32_16x16x64_bf16 v[48:51], v[32:35], v[136:143], v87
    s_waitcnt lgkmcnt(2)
    v_smfmac_f32_16x16x64_bf16 v[48:51], v[36:39], v[144:151], v87
    s_waitcnt lgkmcnt(1)
    v_smfmac_f32_16x16x64_bf16 v[48:51], v[40:43], v[152:159], v87
    s_waitcnt lgkmcnt(0)
    v_smfmac_f32_16x16x64_bf16 v[48:51], v[44:47], v[160:167], v87
    v_mul_u32_u24 v79, 1296, v1
    v_lshl_add_u32 v79, v2, 7, v79
    v_add_u32 v79, v79, v7
    v_add_u32 v79, 82944, v79
    v_mul_u32_u24 v80, 144, v3
    v_add3_u32 v80, v80, v4, s63
    v_add_u32 v80, 90688, v80
    v_lshlrev_b32 v81, 3, v0
    v_add_u32 v81, 88128, v81
    v_add_f32 v84, v48, v49
    v_add_f32 v85, v50, v51
    s_mov_b32 s62, 0xbacccccd
    s_mov_b32 s63, 0xbdd2d3e8
    v_mov_b32 v86, 0xc0135761
    s_waitcnt vmcnt(0)
    v_lshlrev_b32 v82, 16, v82
    v_add_f32 v85, v85, v82
    s_branch L_ffn1
L_fin_prep:
    s_cmp_lg_u32 s3, 6
    s_cbranch_scc1 L_end
    s_cmp_ge_u32 s35, 20
    s_cbranch_scc1 L_end
    s_barrier
L_fin:
    s_mov_b32 s52, s28
    s_mov_b32 s53, s29
    s_mov_b32 s54, 5120
    s_mov_b32 s55, 0x20000
    s_mov_b64 s[4:5], -1
    s_mov_b64 s[6:7], -1
    s_mov_b64 s[8:9], -1
    s_mov_b64 s[10:11], 0xffffff
    s_barrier
    ds_read_b128 v[108:111], v77
    s_barrier
L_yg:
    s_mov_b64 exec, s[4:5]
    buffer_load_dwordx4 v[88:91], v72, s[40:43], 0 offen sc1
    s_mov_b64 exec, s[6:7]
    buffer_load_dwordx4 v[92:95], v73, s[40:43], 0 offen sc1
    s_mov_b64 exec, s[8:9]
    buffer_load_dwordx4 v[96:99], v74, s[40:43], 0 offen sc1
    s_mov_b64 exec, s[10:11]
    buffer_load_dwordx4 v[100:103], v75, s[40:43], 0 offen sc1
    s_mov_b64 exec, -1
    s_sub_u32 s60, s60, 1
    s_cbranch_scc1 L_ygt
    s_waitcnt vmcnt(3)
    v_max3_u32 v3, v88, v89, v90
    v_max_u32 v3, v3, v91
    v_cmp_eq_u32 s[4:5], -1, v3
    s_waitcnt vmcnt(2)
    v_max3_u32 v3, v92, v93, v94
    v_max_u32 v3, v3, v95
    v_cmp_eq_u32 s[6:7], -1, v3
    s_waitcnt vmcnt(1)
    v_max3_u32 v3, v96, v97, v98
    v_max_u32 v3, v3, v99
    v_cmp_eq_u32 s[8:9], -1, v3
    s_waitcnt vmcnt(0)
    v_max3_u32 v3, v100, v101, v102
    v_max_u32 v3, v3, v103
    v_cmp_eq_u32 s[10:11], -1, v3
    s_or_b64 s[16:17], s[4:5], s[6:7]
    s_or_b64 s[16:17], s[16:17], s[8:9]
    s_or_b64 s[16:17], s[16:17], s[10:11]
    s_cbranch_scc1 L_yg
L_ygd:
    v_mfma_f32_16x16x32_bf16 v[112:115], v[104:107], v[88:91], 0
    v_mfma_f32_16x16x32_bf16 v[112:115], v[104:107], v[92:95], v[112:115]
    v_mfma_f32_16x16x32_bf16 v[112:115], v[104:107], v[96:99], v[112:115]
    v_mfma_f32_16x16x32_bf16 v[112:115], v[104:107], v[100:103], v[112:115]
    s_waitcnt lgkmcnt(0)
    v_pk_fma_f32 v[108:109], v[78:79], v[82:83], v[108:109]
    v_pk_fma_f32 v[110:111], v[80:81], v[84:85], v[110:111]
    s_nop 4
    v_add_f32_dpp v112, v112, v112 row_ror:8 row_mask:0xf bank_mask:0xf
    v_add_f32_dpp v113, v113, v113 row_ror:8 row_mask:0xf bank_mask:0xf
    v_add_f32_dpp v114, v114, v114 row_ror:8 row_mask:0xf bank_mask:0xf
    v_add_f32_dpp v115, v115, v115 row_ror:8 row_mask:0xf bank_mask:0xf
    v_pk_fma_f32 v[112:113], v[112:113], v[82:83], v[108:109]
    v_pk_fma_f32 v[114:115], v[114:115], v[84:85], v[110:111]
    v_cvt_pk_bf16_f32 v112, v112, v113
    v_cvt_pk_bf16_f32 v113, v114, v115
    s_mov_b64 exec, 0x00ff00ff
    buffer_store_dwordx2 v[112:113], v76, s[52:55], s57 offen
    s_endpgm
L_t2gate:
    v_mov_b32 v8, 162048
L_lw_121:
    ds_read_b32 v9, v8
    s_waitcnt lgkmcnt(0)
    v_cmp_gt_u32 vcc, 8, v9
    s_cbranch_vccz L_lw_121e
    s_sleep 2
    s_sub_u32 s60, s60, 1
    s_cbranch_scc0 L_lw_121
    s_mov_b32 s60, 0
L_lw_121e:
    ds_read_b32 v9, v8 offset:24
    s_waitcnt lgkmcnt(0)
    v_readfirstlane_b32 s61, v9
    s_mov_b32 s58, 0x3f80
    s_mov_b32 s59, 0x3f800000
    s_mov_b32 s63, 0xff
L_prb:
    s_bcnt1_i32_b32 s62, s63
    s_mov_b32 s97, s63
    s_ff1_i32_b32 s12, s97
    s_bitset0_b32 s97, s12
    s_mul_i32 s4, s12, 5120
    s_add_u32 s4, s4, 155648
    s_cmp_eq_u32 s62, 1
    s_cbranch_scc1 L_pi1
    s_ff1_i32_b32 s13, s97
    s_bitset0_b32 s97, s13
    s_mul_i32 s5, s13, 5120
    s_add_u32 s5, s5, 155648
    s_cmp_eq_u32 s62, 2
    s_cbranch_scc1 L_pi2
    s_ff1_i32_b32 s14, s97
    s_bitset0_b32 s97, s14
    s_mul_i32 s6, s14, 5120
    s_add_u32 s6, s6, 155648
    s_cmp_eq_u32 s62, 3
    s_cbranch_scc1 L_pi3
    s_ff1_i32_b32 s15, s97
    s_bitset0_b32 s97, s15
    s_mul_i32 s7, s15, 5120
    s_add_u32 s7, s7, 155648
    s_cmp_eq_u32 s62, 4
    s_cbranch_scc1 L_pi4
    s_ff1_i32_b32 s16, s97
    s_bitset0_b32 s97, s16
    s_mul_i32 s8, s16, 5120
    s_add_u32 s8, s8, 155648
    s_cmp_eq_u32 s62, 5
    s_cbranch_scc1 L_pi5
    s_ff1_i32_b32 s17, s97
    s_bitset0_b32 s97, s17
    s_mul_i32 s9, s17, 5120
    s_add_u32 s9, s9, 155648
    s_cmp_eq_u32 s62, 6
    s_cbranch_scc1 L_pi6
    s_ff1_i32_b32 s18, s97
    s_bitset0_b32 s97, s18
    s_mul_i32 s10, s18, 5120
    s_add_u32 s10, s10, 155648
    s_cmp_eq_u32 s62, 7
    s_cbranch_scc1 L_pi7
    s_ff1_i32_b32 s19, s97
    s_bitset0_b32 s97, s19
    s_mul_i32 s11, s19, 5120
    s_add_u32 s11, s11, 155648
L_pi8:
    buffer_load_dwordx4 v[36:39], v5, s[40:43], s11 offen sc1
L_pi7:
    buffer_load_dwordx4 v[32:35], v5, s[40:43], s10 offen sc1
L_pi6:
    buffer_load_dwordx4 v[28:31], v5, s[40:43], s9 offen sc1
L_pi5:
    buffer_load_dwordx4 v[24:27], v5, s[40:43], s8 offen sc1
L_pi4:
    buffer_load_dwordx4 v[20:23], v5, s[40:43], s7 offen sc1
L_pi3:
    buffer_load_dwordx4 v[16:19], v5, s[40:43], s6 offen sc1
L_pi2:
    buffer_load_dwordx4 v[12:15], v5, s[40:43], s5 offen sc1
    buffer_load_dwordx4 v[8:11], v5, s[40:43], s4 offen sc1
    s_sub_u32 s60, s60, 1
    s_cbranch_scc1 L_pto
    s_waitcnt vmcnt(0)
    v_max3_u32 v3, v8, v9, v10
    v_max_u32 v3, v3, v11
    v_cmp_eq_u32 vcc, -1, v3
    s_cbranch_vccz L_pgot0
    v_max3_u32 v3, v12, v13, v14
    v_max_u32 v3, v3, v15
    v_cmp_eq_u32 vcc, -1, v3
    s_cbranch_vccz L_pgot1
    s_cmp_eq_u32 s62, 2
    s_cbranch_scc1 L_pi2
    v_max3_u32 v3, v16, v17, v18
    v_max_u32 v3, v3, v19
    v_cmp_eq_u32 vcc, -1, v3
    s_cbranch_vccz L_pgot2
    s_cmp_eq_u32 s62, 3
    s_cbranch_scc1 L_pi3
    v_max3_u32 v3, v20, v21, v22
    v_max_u32 v3, v3, v23
    v_cmp_eq_u32 vcc, -1, v3
    s_cbranch_vccz L_pgot3
    s_cmp_eq_u32 s62, 4
    s_cbranch_scc1 L_pi4
    v_max3_u32 v3, v24, v25, v26
    v_max_u32 v3, v3, v27
    v_cmp_eq_u32 vcc, -1, v3
    s_cbranch_vccz L_pgot4
    s_cmp_eq_u32 s62, 5
    s_cbranch_scc1 L_pi5
    v_max3_u32 v3, v28, v29, v30
    v_max_u32 v3, v3, v31
    v_cmp_eq_u32 vcc, -1, v3
    s_cbranch_vccz L_pgot5
    s_cmp_eq_u32 s62, 6
    s_cbranch_scc1 L_pi6
    v_max3_u32 v3, v32, v33, v34
    v_max_u32 v3, v3, v35
    v_cmp_eq_u32 vcc, -1, v3
    s_cbranch_vccz L_pgot6
    s_cmp_eq_u32 s62, 7
    s_cbranch_scc1 L_pi7
    v_max3_u32 v3, v36, v37, v38
    v_max_u32 v3, v3, v39
    v_cmp_eq_u32 vcc, -1, v3
    s_cbranch_vccz L_pgot7
    s_branch L_pi8
L_pgot0:
    v_dot2c_f32_bf16 v64, s58, v8
    v_dot2c_f32_bf16 v65, s59, v8
    v_dot2c_f32_bf16 v66, s58, v9
    v_dot2c_f32_bf16 v67, s59, v9
    v_dot2c_f32_bf16 v68, s58, v10
    v_dot2c_f32_bf16 v69, s59, v10
    v_dot2c_f32_bf16 v70, s58, v11
    v_dot2c_f32_bf16 v71, s59, v11
    s_bitset0_b32 s63, s12
    s_cmp_eq_u32 s63, 0
    s_cbranch_scc1 L_pgd
L_pn0:
    s_cmp_eq_u32 s62, 1
    s_cbranch_scc1 L_prb
    v_max3_u32 v3, v12, v13, v14
    v_max_u32 v3, v3, v15
    v_cmp_eq_u32 vcc, -1, v3
    s_cbranch_vccnz L_pn1
L_pgot1:
    v_dot2c_f32_bf16 v64, s58, v12
    v_dot2c_f32_bf16 v65, s59, v12
    v_dot2c_f32_bf16 v66, s58, v13
    v_dot2c_f32_bf16 v67, s59, v13
    v_dot2c_f32_bf16 v68, s58, v14
    v_dot2c_f32_bf16 v69, s59, v14
    v_dot2c_f32_bf16 v70, s58, v15
    v_dot2c_f32_bf16 v71, s59, v15
    s_bitset0_b32 s63, s13
    s_cmp_eq_u32 s63, 0
    s_cbranch_scc1 L_pgd
L_pn1:
    s_cmp_eq_u32 s62, 2
    s_cbranch_scc1 L_prb
    v_max3_u32 v3, v16, v17, v18
    v_max_u32 v3, v3, v19
    v_cmp_eq_u32 vcc, -1, v3
    s_cbranch_vccnz L_pn2
L_pgot2:
    v_dot2c_f32_bf16 v64, s58, v16
    v_dot2c_f32_bf16 v65, s59, v16
    v_dot2c_f32_bf16 v66, s58, v17
    v_dot2c_f32_bf16 v67, s59, v17
    v_dot2c_f32_bf16 v68, s58, v18
    v_dot2c_f32_bf16 v69, s59, v18
    v_dot2c_f32_bf16 v70, s58, v19
    v_dot2c_f32_bf16 v71, s59, v19
    s_bitset0_b32 s63, s14
    s_cmp_eq_u32 s63, 0
    s_cbranch_scc1 L_pgd
L_pn2:
    s_cmp_eq_u32 s62, 3
    s_cbranch_scc1 L_prb
    v_max3_u32 v3, v20, v21, v22
    v_max_u32 v3, v3, v23
    v_cmp_eq_u32 vcc, -1, v3
    s_cbranch_vccnz L_pn3
L_pgot3:
    v_dot2c_f32_bf16 v64, s58, v20
    v_dot2c_f32_bf16 v65, s59, v20
    v_dot2c_f32_bf16 v66, s58, v21
    v_dot2c_f32_bf16 v67, s59, v21
    v_dot2c_f32_bf16 v68, s58, v22
    v_dot2c_f32_bf16 v69, s59, v22
    v_dot2c_f32_bf16 v70, s58, v23
    v_dot2c_f32_bf16 v71, s59, v23
    s_bitset0_b32 s63, s15
    s_cmp_eq_u32 s63, 0
    s_cbranch_scc1 L_pgd
L_pn3:
    s_cmp_eq_u32 s62, 4
    s_cbranch_scc1 L_prb
    v_max3_u32 v3, v24, v25, v26
    v_max_u32 v3, v3, v27
    v_cmp_eq_u32 vcc, -1, v3
    s_cbranch_vccnz L_pn4
L_pgot4:
    v_dot2c_f32_bf16 v64, s58, v24
    v_dot2c_f32_bf16 v65, s59, v24
    v_dot2c_f32_bf16 v66, s58, v25
    v_dot2c_f32_bf16 v67, s59, v25
    v_dot2c_f32_bf16 v68, s58, v26
    v_dot2c_f32_bf16 v69, s59, v26
    v_dot2c_f32_bf16 v70, s58, v27
    v_dot2c_f32_bf16 v71, s59, v27
    s_bitset0_b32 s63, s16
    s_cmp_eq_u32 s63, 0
    s_cbranch_scc1 L_pgd
L_pn4:
    s_cmp_eq_u32 s62, 5
    s_cbranch_scc1 L_prb
    v_max3_u32 v3, v28, v29, v30
    v_max_u32 v3, v3, v31
    v_cmp_eq_u32 vcc, -1, v3
    s_cbranch_vccnz L_pn5
L_pgot5:
    v_dot2c_f32_bf16 v64, s58, v28
    v_dot2c_f32_bf16 v65, s59, v28
    v_dot2c_f32_bf16 v66, s58, v29
    v_dot2c_f32_bf16 v67, s59, v29
    v_dot2c_f32_bf16 v68, s58, v30
    v_dot2c_f32_bf16 v69, s59, v30
    v_dot2c_f32_bf16 v70, s58, v31
    v_dot2c_f32_bf16 v71, s59, v31
    s_bitset0_b32 s63, s17
    s_cmp_eq_u32 s63, 0
    s_cbranch_scc1 L_pgd
L_pn5:
    s_cmp_eq_u32 s62, 6
    s_cbranch_scc1 L_prb
    v_max3_u32 v3, v32, v33, v34
    v_max_u32 v3, v3, v35
    v_cmp_eq_u32 vcc, -1, v3
    s_cbranch_vccnz L_pn6
L_pgot6:
    v_dot2c_f32_bf16 v64, s58, v32
    v_dot2c_f32_bf16 v65, s59, v32
    v_dot2c_f32_bf16 v66, s58, v33
    v_dot2c_f32_bf16 v67, s59, v33
    v_dot2c_f32_bf16 v68, s58, v34
    v_dot2c_f32_bf16 v69, s59, v34
    v_dot2c_f32_bf16 v70, s58, v35
    v_dot2c_f32_bf16 v71, s59, v35
    s_bitset0_b32 s63, s18
    s_cmp_eq_u32 s63, 0
    s_cbranch_scc1 L_pgd
L_pn6:
    s_cmp_eq_u32 s62, 7
    s_cbranch_scc1 L_prb
    v_max3_u32 v3, v36, v37, v38
    v_max_u32 v3, v3, v39
    v_cmp_eq_u32 vcc, -1, v3
    s_cbranch_vccnz L_pn7
L_pgot7:
    v_dot2c_f32_bf16 v64, s58, v36
    v_dot2c_f32_bf16 v65, s59, v36
    v_dot2c_f32_bf16 v66, s58, v37
    v_dot2c_f32_bf16 v67, s59, v37
    v_dot2c_f32_bf16 v68, s58, v38
    v_dot2c_f32_bf16 v69, s59, v38
    v_dot2c_f32_bf16 v70, s58, v39
    v_dot2c_f32_bf16 v71, s59, v39
    s_bitset0_b32 s63, s19
    s_cmp_eq_u32 s63, 0
    s_cbranch_scc1 L_pgd
L_pn7:
    s_branch L_prb
L_pi1:
L_poll_122:
    buffer_load_dwordx4 v[8:11], v5, s[40:43], s4 offen sc1
    s_sub_u32 s60, s60, 1
    s_cbranch_scc1 L_poll_122t
    s_waitcnt vmcnt(0)
    v_max3_u32 v3, v8, v9, v10
    v_max_u32 v3, v3, v11
    v_cmp_eq_u32 vcc, -1, v3
    s_cbranch_vccnz L_poll_122
L_poll_122e:
    v_dot2c_f32_bf16 v64, s58, v8
    v_dot2c_f32_bf16 v65, s59, v8
    v_dot2c_f32_bf16 v66, s58, v9
    v_dot2c_f32_bf16 v67, s59, v9
    v_dot2c_f32_bf16 v68, s58, v10
    v_dot2c_f32_bf16 v69, s59, v10
    v_dot2c_f32_bf16 v70, s58, v11
    v_dot2c_f32_bf16 v71, s59, v11
L_pgd:
    v_pk_fma_f32 v[64:65], v[64:65], v[48:49], v[40:41]
    v_pk_fma_f32 v[66:67], v[66:67], v[50:51], v[42:43]
    v_pk_fma_f32 v[68:69], v[68:69], v[52:53], v[44:45]
    v_pk_fma_f32 v[70:71], v[70:71], v[54:55], v[46:47]
    v_pk_mul_f32 v[56:57], v[64:65], v[56:57]
    v_pk_mul_f32 v[58:59], v[66:67], v[58:59]
    v_pk_mul_f32 v[60:61], v[68:69], v[60:61]
    v_pk_mul_f32 v[62:63], v[70:71], v[62:63]
    v_cvt_pk_bf16_f32 v8, v56, v57
    v_cvt_pk_bf16_f32 v9, v58, v59
    v_cvt_pk_bf16_f32 v10, v60, v61
    v_cvt_pk_bf16_f32 v11, v62, v63
    ds_write_b128 v4, v[8:11]
    v_pk_add_f32 v[40:41], v[64:65], v[66:67]
    v_pk_add_f32 v[42:43], v[68:69], v[70:71]
    v_pk_mul_f32 v[44:45], v[64:65], v[64:65]
    v_pk_mul_f32 v[46:47], v[66:67], v[66:67]
    v_pk_add_f32 v[40:41], v[40:41], v[42:43]
    v_pk_fma_f32 v[44:45], v[68:69], v[68:69], v[44:45]
    v_pk_fma_f32 v[46:47], v[70:71], v[70:71], v[46:47]
    v_add_f32 v40, v40, v41
    v_pk_add_f32 v[44:45], v[44:45], v[46:47]
    v_add_f32 v41, v44, v45
    ds_write_b64 v7, v[40:41]
    s_waitcnt lgkmcnt(0)
    s_barrier
    v_mov_b32 v16, 0
    v_mov_b32 v17, 0
    v_mov_b32 v18, 0
    v_mov_b32 v19, 0
    v_mov_b32 v20, 0
    v_mov_b32 v21, 0
    v_mov_b32 v22, 0
    v_mov_b32 v23, 0
    v_mov_b32 v24, 0
    v_mov_b32 v25, 0
    v_mov_b32 v26, 0
    v_mov_b32 v27, 0
    v_mov_b32 v28, 0
    v_mov_b32 v29, 0
    v_mov_b32 v30, 0
    v_mov_b32 v31, 0
    v_mov_b32 v32, 0
    v_mov_b32 v33, 0
    v_mov_b32 v34, 0
    v_mov_b32 v35, 0
    ds_write_b128 v6, v[64:67]
    ds_write_b128 v6, v[68:71] offset:16
    s_waitcnt lgkmcnt(0)
    s_cmp_lg_u32 s3, 7
    s_cbranch_scc1 L_ffn2
    s_cmp_lt_u32 s35, 20
    s_cbranch_scc1 L_fin
    s_endpgm
L_ffn1:
    s_barrier
L_ffn1b:
    ds_read_b128 v[8:11], v79
    ds_read_b64 v[30:31], v81 offset:0
    ds_read_b64 v[32:33], v81 offset:512
    ds_read_b64 v[34:35], v81 offset:1024
    ds_read_b64 v[36:37], v81 offset:1536
    ds_read_b64 v[38:39], v81 offset:2048
    ds_read_b128 v[12:15], v79 offset:256
    ds_read_b128 v[16:19], v79 offset:512
    ds_read_b128 v[20:23], v79 offset:768
    ds_read_b128 v[24:27], v79 offset:1024
    s_waitcnt lgkmcnt(9)
    v_smfmac_f32_16x16x64_bf16 v[52:55], v[8:11], v[88:95], v87
    v_smfmac_f32_16x16x64_bf16 v[56:59], v[8:11], v[96:103], v87
    s_waitcnt lgkmcnt(3)
    v_smfmac_f32_16x16x64_bf16 v[52:55], v[12:15], v[104:111], v87
    v_pk_add_f32 v[30:31], v[30:31], v[32:33]
    v_pk_add_f32 v[34:35], v[34:35], v[36:37]
    v_smfmac_f32_16x16x64_bf16 v[56:59], v[12:15], v[112:119], v87
    v_pk_add_f32 v[30:31], v[30:31], v[38:39]
    v_pk_add_f32 v[30:31], v[30:31], v[34:35]
    s_nop 0
    s_waitcnt lgkmcnt(2)
    v_smfmac_f32_16x16x64_bf16 v[52:55], v[16:19], v[120:127], v87
    v_add_f32_dpp v30, v30, v30 quad_perm:[1,0,3,2] row_mask:0xf bank_mask:0xf
    v_add_f32_dpp v31, v31, v31 quad_perm:[1,0,3,2] row_mask:0xf bank_mask:0xf
    v_smfmac_f32_16x16x64_bf16 v[56:59], v[16:19], v[128:135], v87
    v_add_f32_dpp v30, v30, v30 quad_perm:[2,3,0,1] row_mask:0xf bank_mask:0xf
    v_add_f32_dpp v31, v31, v31 quad_perm:[2,3,0,1] row_mask:0xf bank_mask:0xf
    s_waitcnt lgkmcnt(1)
    v_smfmac_f32_16x16x64_bf16 v[52:55], v[20:23], v[136:143], v87
    v_add_f32_dpp v30, v30, v30 row_ror:4 row_mask:0xf bank_mask:0xf
    v_add_f32_dpp v31, v31, v31 row_ror:4 row_mask:0xf bank_mask:0xf
    v_smfmac_f32_16x16x64_bf16 v[56:59], v[20:23], v[144:151], v87
    v_add_f32_dpp v30, v30, v30 row_ror:8 row_mask:0xf bank_mask:0xf
    v_add_f32_dpp v31, v31, v31 row_ror:8 row_mask:0xf bank_mask:0xf
    s_waitcnt lgkmcnt(0)
    v_smfmac_f32_16x16x64_bf16 v[52:55], v[24:27], v[152:159], v87
    v_mul_f32 v48, s62, v30
    v_mul_f32 v49, s62, v31
    v_smfmac_f32_16x16x64_bf16 v[56:59], v[24:27], v[160:167], v87
    v_mul_f32 v7, v84, v48
    v_fma_f32 v49, -v48, v48, -v49
    v_max_f32 v49, 0, v49
    v_add_f32 v49, 0x3727c5ac, v49
    v_rsq_f32 v49, v49
    v_add_f32 v4, v52, v53
    v_add_f32 v4, v4, v7
    s_nop 0
    v_add_f32 v5, v58, v59
    v_add_f32 v4, v4, v5
    v_fma_f32 v4, v4, v49, v85
    v_mul_f32 v5, v4, v4
    v_fma_f32 v5, v5, s63, v86
    v_mul_f32 v5, v5, v4
    v_exp_f32 v5, v5
    s_nop 0
    v_add_f32 v5, 1.0, v5
    v_rcp_f32 v5, v5
    s_nop 0
    v_mul_f32 v4, v4, v5
    v_cvt_pk_bf16_f32 v4, v4, v4
    ds_write_b16 v80, v4
    s_waitcnt lgkmcnt(0)
    s_barrier
    s_endpgm
L_h_t1:
    s_cmp_lg_u32 s3, 3
    s_cbranch_scc1 L_h_noclr
    s_sub_u32 s62, s56, 154
    s_cmp_lt_u32 s62, 30
    s_cbranch_scc0 L_h_noclr
    s_lshl_b32 s63, s62, 2
    s_mul_i32 s62, s62, 7168
    s_add_u32 s62, s62, 20480
    v_mov_b32 v4, -1
    v_mov_b32 v5, -1
    v_mov_b32 v6, -1
    v_mov_b32 v7, -1
    v_lshlrev_b32 v8, 4, v0
    buffer_store_dwordx4 v[4:7], v8, s[40:43], s62 offen offset:0 sc1
    buffer_store_dwordx4 v[4:7], v8, s[40:43], s62 offen offset:1024 sc1
    buffer_store_dwordx4 v[4:7], v8, s[40:43], s62 offen offset:2048 sc1
    buffer_store_dwordx4 v[4:7], v8, s[40:43], s62 offen offset:3072 sc1
    s_add_u32 s62, s62, 4096
    buffer_store_dwordx4 v[4:7], v8, s[40:43], s62 offen offset:0 sc1
    buffer_store_dwordx4 v[4:7], v8, s[40:43], s62 offen offset:1024 sc1
    buffer_store_dwordx4 v[4:7], v8, s[40:43], s62 offen offset:2048 sc1
    v_mov_b32 v8, s63
    s_waitcnt vmcnt(0)
    s_mov_b64 exec, 1
    buffer_store_dword v4, v8, s[44:47], 0 offen sc1
    s_mov_b64 exec, -1
L_h_noclr:
    v_lshrrev_b32 v1, 3, v0
    v_mul_u32_u24 v1, 1280, v1
    v_and_b32 v2, 7, v0
    v_lshl_add_u32 v1, v2, 4, v1
    s_lshl2_add_u32 s63, s34, s3
    s_mul_i32 s63, s63, 163840
    s_lshl_b32 s62, s35, 7
    s_add_u32 s63, s63, s62
    s_sub_u32 s63, s63, 2816
    s_lshl_b32 s62, s3, 14
    s_add_u32 s62, s62, 81920
    s_mov_b32 m0, s62
    s_mov_b32 s48, s12
    s_mov_b32 s49, s13
    s_mov_b32 s50, 5242880
    s_mov_b32 s51, 0x20000
    s_add_u32 s100, s39, 1
    s_mov_b32 s62, 8
L_dma_4:
    buffer_load_dwordx4 v1, s[48:51], s63 offen nt lds
    s_add_u32 m0, m0, 1024
    s_add_u32 s63, s63, 10240
    s_cmp_eq_u32 s100, 0
    s_cbranch_scc1 L_dma_4n0
    s_waitcnt vmcnt(7)
    s_cmp_eq_u32 s100, 2
    s_cbranch_scc1 L_dma_4n0
    s_waitcnt vmcnt(3)
L_dma_4n0:
    buffer_load_dwordx4 v1, s[48:51], s63 offen nt lds
    s_add_u32 m0, m0, 1024
    s_add_u32 s63, s63, 10240
    s_cmp_eq_u32 s100, 0
    s_cbranch_scc1 L_dma_4n1
    s_waitcnt vmcnt(7)
    s_cmp_eq_u32 s100, 2
    s_cbranch_scc1 L_dma_4n1
    s_waitcnt vmcnt(3)
L_dma_4n1:
    s_sub_u32 s62, s62, 1
    s_cmp_lg_u32 s62, 0
    s_cbranch_scc1 L_dma_4
    s_cmp_eq_u32 s39, 1
    s_cbranch_scc1 L_h_role
    s_waitcnt vmcnt(0)
    v_mov_b32 v4, 162060
    v_mov_b32 v5, 1
    s_mov_b64 exec, 1
    ds_add_u32 v4, v5
    s_mov_b64 exec, -1
    s_cmp_eq_u32 s3, 0
    s_cbranch_scc1 L_service
    s_endpgm
L_h_role:
    v_mov_b32 v72, 0
    v_mov_b32 v73, 0
    v_mov_b32 v74, 0
    v_mov_b32 v75, 0
    v_mov_b32 v76, 0
    v_lshrrev_b32 v3, 4, v0
    v_and_b32 v2, 3, v0
    v_bfe_u32 v1, v0, 2, 2
    v_mul_u32_u24 v160, 1280, v3
    v_and_b32 v4, 15, v0
    v_lshl_add_u32 v163, v4, 2, v160
    v_lshl_add_u32 v160, v4, 3, v160
    s_mul_i32 s57, s35, 5120
    s_mul_i32 s62, s3, 320
    s_add_u32 s57, s57, s62
    s_add_u32 s57, s57, 262144
    v_mov_b32 v4, -1
    v_mov_b32 v5, -1
    v_mov_b32 v6, -1
    v_mov_b32 v7, -1
    v_lshlrev_b32 v8, 4, v0
    s_mul_i32 s62, s3, 960
    s_add_u32 s62, s62, s57
    buffer_store_dwordx4 v[4:7], v8, s[40:43], s62 offen sc1
    s_mov_b64 exec, 0xffff
    buffer_store_dwordx4 v[4:7], v8, s[40:43], s62 offen offset:1024 sc1
    s_mov_b64 exec, -1
    v_add_u32 v8, 0, v0
    v_mul_u32_u24 v10, 0xccd, v8
    v_lshrrev_b32 v10, 16, v10
    v_mul_u32_u24 v9, 20, v10
    v_sub_u32 v8, v8, v9
    v_mul_u32_u24 v10, 1280, v10
    v_lshl_add_u32 v10, v8, 4, v10
    v_add_u32 v8, 64, v0
    v_mul_u32_u24 v11, 0xccd, v8
    v_lshrrev_b32 v11, 16, v11
    v_mul_u32_u24 v9, 20, v11
    v_sub_u32 v8, v8, v9
    v_mul_u32_u24 v11, 1280, v11
    v_lshl_add_u32 v11, v8, 4, v11
    v_add_u32 v8, 128, v0
    v_mul_u32_u24 v12, 0xccd, v8
    v_lshrrev_b32 v12, 16, v12
    v_mul_u32_u24 v9, 20, v12
    v_sub_u32 v8, v8, v9
    v_mul_u32_u24 v12, 1280, v12
    v_lshl_add_u32 v12, v8, 4, v12
    v_add_u32 v8, 192, v0
    v_mul_u32_u24 v13, 0xccd, v8
    v_lshrrev_b32 v13, 16, v13
    v_mul_u32_u24 v9, 20, v13
    v_sub_u32 v8, v8, v9
    v_mul_u32_u24 v13, 1280, v13
    v_lshl_add_u32 v13, v8, 4, v13
    v_add_u32 v8, 256, v0
    v_mul_u32_u24 v14, 0xccd, v8
    v_lshrrev_b32 v14, 16, v14
    v_mul_u32_u24 v9, 20, v14
    v_sub_u32 v8, v8, v9
    v_mul_u32_u24 v14, 1280, v14
    v_lshl_add_u32 v14, v8, 4, v14
    s_waitcnt vmcnt(0)
    v_mov_b32 v8, 162060
    v_mov_b32 v9, 1
    s_mov_b64 exec, 1
    ds_add_u32 v8, v9
    s_mov_b64 exec, -1
    s_mov_b32 s48, s20
    s_mov_b32 s49, s21
    s_mov_b32 s50, 2211840
    s_mov_b32 s51, 0x20000
    s_mul_i32 s63, s35, 81920
    s_mul_i32 s62, s3, 320
    s_add_u32 s63, s63, s62
    s_mov_b32 m0, s101
    s_mov_b32 s62, 4
L_w2dma:
    buffer_load_dwordx4 v10, s[48:51], s63 offen nt lds
    s_add_u32 m0, m0, 1024
    s_waitcnt vmcnt(7)
    s_cmp_ge_u32 s35, 22
    s_cbranch_scc1 L_w2n0
    s_waitcnt vmcnt(7)
L_w2n0:
    buffer_load_dwordx4 v11, s[48:51], s63 offen nt lds
    s_add_u32 m0, m0, 1024
    s_waitcnt vmcnt(7)
    s_cmp_ge_u32 s35, 22
    s_cbranch_scc1 L_w2n1
    s_waitcnt vmcnt(7)
L_w2n1:
    buffer_load_dwordx4 v12, s[48:51], s63 offen nt lds
    s_add_u32 m0, m0, 1024
    s_waitcnt vmcnt(7)
    s_cmp_ge_u32 s35, 22
    s_cbranch_scc1 L_w2n2
    s_waitcnt vmcnt(7)
L_w2n2:
    buffer_load_dwordx4 v13, s[48:51], s63 offen nt lds
    s_add_u32 m0, m0, 1024
    s_waitcnt vmcnt(7)
    s_cmp_ge_u32 s35, 22
    s_cbranch_scc1 L_w2n3
    s_waitcnt vmcnt(7)
L_w2n3:
    buffer_load_dwordx4 v14, s[48:51], s63 offen nt lds
    s_add_u32 m0, m0, 1024
    s_waitcnt vmcnt(7)
    s_cmp_ge_u32 s35, 22
    s_cbranch_scc1 L_w2n4
    s_waitcnt vmcnt(7)
L_w2n4:
    s_add_u32 s63, s63, 20480
    s_sub_u32 s62, s62, 1
    s_cmp_lg_u32 s62, 0
    s_cbranch_scc1 L_w2dma
    v_lshrrev_b32 v8, 5, v0
    v_lshlrev_b32 v8, 2, v8
    v_bfe_u32 v9, v0, 4, 1
    v_add_u32 v8, v8, v9
    v_mul_u32_u24 v8, 1280, v8
    v_add_u32 v8, s101, v8
    v_and_b32 v10, 15, v0
    v_lshl_add_u32 v9, v10, 2, v8
    v_lshl_add_u32 v8, v10, 3, v8
    s_mov_b32 s62, 0x05040100
    s_mov_b32 s63, 0x07060302
    s_waitcnt vmcnt(0)
    ds_read_b64 v[16:17], v8 offset:0
    ds_read_b64 v[18:19], v8 offset:320
    ds_read_b64 v[20:21], v8 offset:2560
    ds_read_b64 v[22:23], v8 offset:2880
    ds_read_b64 v[24:25], v8 offset:640
    ds_read_b64 v[26:27], v8 offset:960
    ds_read_b64 v[28:29], v8 offset:3200
    ds_read_b64 v[30:31], v8 offset:3520
    ds_read_b64 v[32:33], v8 offset:10240
    ds_read_b64 v[34:35], v8 offset:10560
    ds_read_b64 v[36:37], v8 offset:12800
    ds_read_b64 v[38:39], v8 offset:13120
    ds_read_b64 v[40:41], v8 offset:10880
    ds_read_b64 v[42:43], v8 offset:11200
    ds_read_b64 v[44:45], v8 offset:13440
    ds_read_b64 v[46:47], v8 offset:13760
    s_waitcnt lgkmcnt(0)
    v_perm_b32 v80, v18, v16, s62
    v_perm_b32 v88, v18, v16, s63
    v_perm_b32 v96, v19, v17, s62
    v_perm_b32 v104, v19, v17, s63
    v_perm_b32 v81, v22, v20, s62
    v_perm_b32 v89, v22, v20, s63
    v_perm_b32 v97, v23, v21, s62
    v_perm_b32 v105, v23, v21, s63
    v_perm_b32 v82, v26, v24, s62
    v_perm_b32 v90, v26, v24, s63
    v_perm_b32 v98, v27, v25, s62
    v_perm_b32 v106, v27, v25, s63
    v_perm_b32 v83, v30, v28, s62
    v_perm_b32 v91, v30, v28, s63
    v_perm_b32 v99, v31, v29, s62
    v_perm_b32 v107, v31, v29, s63
    v_perm_b32 v84, v34, v32, s62
    v_perm_b32 v92, v34, v32, s63
    v_perm_b32 v100, v35, v33, s62
    v_perm_b32 v108, v35, v33, s63
    v_perm_b32 v85, v38, v36, s62
    v_perm_b32 v93, v38, v36, s63
    v_perm_b32 v101, v39, v37, s62
    v_perm_b32 v109, v39, v37, s63
    v_perm_b32 v86, v42, v40, s62
    v_perm_b32 v94, v42, v40, s63
    v_perm_b32 v102, v43, v41, s62
    v_perm_b32 v110, v43, v41, s63
    v_perm_b32 v87, v46, v44, s62
    v_perm_b32 v95, v46, v44, s63
    v_perm_b32 v103, v47, v45, s62
    v_perm_b32 v111, v47, v45, s63
    ds_read_b64 v[16:17], v8 offset:128
    ds_read_b64 v[18:19], v8 offset:448
    ds_read_b64 v[20:21], v8 offset:2688
    ds_read_b64 v[22:23], v8 offset:3008
    ds_read_b64 v[24:25], v8 offset:768
    ds_read_b64 v[26:27], v8 offset:1088
    ds_read_b64 v[28:29], v8 offset:3328
    ds_read_b64 v[30:31], v8 offset:3648
    ds_read_b64 v[32:33], v8 offset:10368
    ds_read_b64 v[34:35], v8 offset:10688
    ds_read_b64 v[36:37], v8 offset:12928
    ds_read_b64 v[38:39], v8 offset:13248
    ds_read_b64 v[40:41], v8 offset:11008
    ds_read_b64 v[42:43], v8 offset:11328
    ds_read_b64 v[44:45], v8 offset:13568
    ds_read_b64 v[46:47], v8 offset:13888
    s_waitcnt lgkmcnt(0)
    v_perm_b32 v112, v18, v16, s62
    v_perm_b32 v120, v18, v16, s63
    v_perm_b32 v128, v19, v17, s62
    v_perm_b32 v136, v19, v17, s63
    v_perm_b32 v113, v22, v20, s62
    v_perm_b32 v121, v22, v20, s63
    v_perm_b32 v129, v23, v21, s62
    v_perm_b32 v137, v23, v21, s63
    v_perm_b32 v114, v26, v24, s62
    v_perm_b32 v122, v26, v24, s63
    v_perm_b32 v130, v27, v25, s62
    v_perm_b32 v138, v27, v25, s63
    v_perm_b32 v115, v30, v28, s62
    v_perm_b32 v123, v30, v28, s63
    v_perm_b32 v131, v31, v29, s62
    v_perm_b32 v139, v31, v29, s63
    v_perm_b32 v116, v34, v32, s62
    v_perm_b32 v124, v34, v32, s63
    v_perm_b32 v132, v35, v33, s62
    v_perm_b32 v140, v35, v33, s63
    v_perm_b32 v117, v38, v36, s62
    v_perm_b32 v125, v38, v36, s63
    v_perm_b32 v133, v39, v37, s62
    v_perm_b32 v141, v39, v37, s63
    v_perm_b32 v118, v42, v40, s62
    v_perm_b32 v126, v42, v40, s63
    v_perm_b32 v134, v43, v41, s62
    v_perm_b32 v142, v43, v41, s63
    v_perm_b32 v119, v46, v44, s62
    v_perm_b32 v127, v46, v44, s63
    v_perm_b32 v135, v47, v45, s62
    v_perm_b32 v143, v47, v45, s63
    ds_read_b32 v16, v9 offset:256
    ds_read_b32 v18, v9 offset:576
    ds_read_b32 v20, v9 offset:2816
    ds_read_b32 v22, v9 offset:3136
    ds_read_b32 v24, v9 offset:896
    ds_read_b32 v26, v9 offset:1216
    ds_read_b32 v28, v9 offset:3456
    ds_read_b32 v30, v9 offset:3776
    ds_read_b32 v32, v9 offset:10496
    ds_read_b32 v34, v9 offset:10816
    ds_read_b32 v36, v9 offset:13056
    ds_read_b32 v38, v9 offset:13376
    ds_read_b32 v40, v9 offset:11136
    ds_read_b32 v42, v9 offset:11456
    ds_read_b32 v44, v9 offset:13696
    ds_read_b32 v46, v9 offset:14016
    s_waitcnt lgkmcnt(0)
    v_perm_b32 v144, v18, v16, s62
    v_perm_b32 v152, v18, v16, s63
    v_perm_b32 v145, v22, v20, s62
    v_perm_b32 v153, v22, v20, s63
    v_perm_b32 v146, v26, v24, s62
    v_perm_b32 v154, v26, v24, s63
    v_perm_b32 v147, v30, v28, s62
    v_perm_b32 v155, v30, v28, s63
    v_perm_b32 v148, v34, v32, s62
    v_perm_b32 v156, v34, v32, s63
    v_perm_b32 v149, v38, v36, s62
    v_perm_b32 v157, v38, v36, s63
    v_perm_b32 v150, v42, v40, s62
    v_perm_b32 v158, v42, v40, s63
    v_perm_b32 v151, v46, v44, s62
    v_perm_b32 v159, v46, v44, s63
    s_mov_b32 s48, s16
    s_mov_b32 s49, s17
    s_mov_b32 s50, 2211840
    s_mov_b32 s51, 0x20000
    s_lshl_b32 s98, s35, 7
    s_mov_b32 s99, 3456
    v_lshrrev_b32 v9, 3, v0
    v_mul_lo_u32 v10, v9, s99
    v_and_b32 v9, 2, v9
    v_xor_b32 v9, v9, v0
    v_and_b32 v9, 7, v9
    v_lshl_add_u32 v10, v9, 4, v10
    v_add_u32 v10, s98, v10
    v_xor_b32 v11, 64, v10
    s_mul_i32 s63, s3, 552960
    s_mov_b32 m0, s101
    s_waitcnt lgkmcnt(0)
    s_cmp_ge_u32 s35, 22
    s_cselect_b32 s100, 2, 1
    s_mov_b32 s62, 10
L_dma_5:
    buffer_load_dwordx4 v10, s[48:51], s63 offen nt lds
    s_add_u32 m0, m0, 1024
    s_add_u32 s63, s63, 27648
    s_cmp_eq_u32 s100, 0
    s_cbranch_scc1 L_dma_5n0
    s_waitcnt vmcnt(7)
    s_cmp_eq_u32 s100, 2
    s_cbranch_scc1 L_dma_5n0
    s_waitcnt vmcnt(7)
L_dma_5n0:
    buffer_load_dwordx4 v11, s[48:51], s63 offen nt lds
    s_add_u32 m0, m0, 1024
    s_add_u32 s63, s63, 27648
    s_cmp_eq_u32 s100, 0
    s_cbranch_scc1 L_dma_5n1
    s_waitcnt vmcnt(7)
    s_cmp_eq_u32 s100, 2
    s_cbranch_scc1 L_dma_5n1
    s_waitcnt vmcnt(7)
L_dma_5n1:
    s_sub_u32 s62, s62, 1
    s_cmp_lg_u32 s62, 0
    s_cbranch_scc1 L_dma_5
    v_mov_b32 v8, 162068
L_lw_6:
    ds_read_b32 v9, v8
    s_waitcnt lgkmcnt(0)
    v_cmp_gt_u32 vcc, 1, v9
    s_cbranch_vccz L_lw_6e
    s_sleep 8
    s_sub_u32 s60, s60, 1
    s_cbranch_scc0 L_lw_6
    s_mov_b32 s60, 0
L_lw_6e:
    s_cmp_lg_u32 s3, 3
    s_cbranch_scc1 L_h_nomo
    v_and_b32 v4, 15, v0
    v_lshlrev_b32 v4, 4, v4
    v_mul_u32_u24 v5, 1280, v3
    v_add_u32 v5, v5, v4
    v_mul_u32_u24 v6, 1296, v3
    v_add_u32 v6, v6, v4
    v_add_u32 v6, 147456, v6
    s_mov_b32 s62, 30720
    s_mov_b32 s63, 25600
    s_branch L_poll_7
L_poll_7s:
    s_sleep 8
L_poll_7:
    buffer_load_dwordx4 v[40:43], v5, s[40:43], s62 offen offset:0 sc1
    buffer_load_dwordx4 v[44:47], v5, s[40:43], s62 offen offset:256 sc1
    buffer_load_dwordx4 v[48:51], v5, s[40:43], s62 offen offset:512 sc1
    buffer_load_dwordx4 v[52:55], v5, s[40:43], s62 offen offset:768 sc1
    buffer_load_dwordx4 v[56:59], v5, s[40:43], s62 offen offset:1024 sc1
    buffer_load_dwordx4 v[60:63], v5, s[40:43], s63 offen offset:0 sc1
    buffer_load_dwordx4 v[64:67], v5, s[40:43], s63 offen offset:256 sc1
    buffer_load_dwordx4 v[68:71], v5, s[40:43], s63 offen offset:512 sc1
    buffer_load_dwordx4 v[72:75], v5, s[40:43], s63 offen offset:768 sc1
    buffer_load_dwordx4 v[76:79], v5, s[40:43], s63 offen offset:1024 sc1
    s_sub_u32 s60, s60, 1
    s_cbranch_scc1 L_poll_7t
    s_waitcnt vmcnt(0)
    v_max3_u32 v7, v40, v41, v42
    v_max3_u32 v7, v7, v43, v44
    v_max3_u32 v7, v7, v45, v46
    v_max3_u32 v7, v7, v47, v48
    v_max3_u32 v7, v7, v49, v50
    v_max3_u32 v7, v7, v51, v52
    v_max3_u32 v7, v7, v53, v54
    v_max3_u32 v7, v7, v55, v56
    v_max3_u32 v7, v7, v57, v58
    v_max3_u32 v7, v7, v59, v60
    v_max3_u32 v7, v7, v61, v62
    v_max3_u32 v7, v7, v63, v64
    v_max3_u32 v7, v7, v65, v66
    v_max3_u32 v7, v7, v67, v68
    v_max3_u32 v7, v7, v69, v70
    v_max3_u32 v7, v7, v71, v72
    v_max3_u32 v7, v7, v73, v74
    v_max3_u32 v7, v7, v75, v76
    v_max3_u32 v7, v7, v77, v78
    v_max_u32 v7, v7, v79
    v_cmp_eq_u32 vcc, -1, v7
    s_cbranch_vccnz L_poll_7s
L_poll_7e:
    ds_write_b128 v6, v[40:43] offset:0
    ds_write_b128 v6, v[44:47] offset:256
    ds_write_b128 v6, v[48:51] offset:512
    ds_write_b128 v6, v[52:55] offset:768
    ds_write_b128 v6, v[56:59] offset:1024
    ds_write_b128 v6, v[60:63] offset:5184
    ds_write_b128 v6, v[64:67] offset:5440
    ds_write_b128 v6, v[68:71] offset:5696
    ds_write_b128 v6, v[72:75] offset:5952
    ds_write_b128 v6, v[76:79] offset:6208
L_h_nomo:
    v_mul_u32_u24 v4, 144, v1
    v_lshl_add_u32 v4, v3, 5, v4
    v_bfe_u32 v5, v0, 1, 1
    v_lshl_add_u32 v4, v5, 4, v4
    v_add_u32 v4, 90688, v4
    v_mov_b32 v5, 162112
    v_and_b32 v6, 1, v0
    v_cmp_eq_u32 vcc, 0, v6
    s_nop 1
    v_cndmask_b32 v161, v5, v4, vcc
    v_cndmask_b32 v162, v4, v5, vcc
    v_bfe_u32 v164, v0, 1, 1
    v_mul_u32_u24 v164, 0xaaaa, v164
    v_add_u32 v164, 0x4444, v164
    s_mov_b32 s100, s3
    s_lshl_b32 s63, s100, 8
    v_and_b32 v8, 15, v0
    v_lshl_add_u32 v8, v8, 4, s63
    v_lshrrev_b32 v9, 4, v0
    v_mul_u32_u24 v5, 1280, v9
    v_add_u32 v5, v5, v8
    v_mul_u32_u24 v4, 1296, v9
    v_add_u32 v4, v4, v8
    v_add_u32 v4, 82944, v4
    v_lshlrev_b32 v6, 1, v5
    v_add_u32 v6, 99328, v6
    s_lshl_b32 s62, s100, 9
    s_add_u32 s62, s62, 88128
    v_lshl_add_u32 v7, v0, 3, s62
    s_mov_b32 s48, s4
    s_mov_b32 s49, s5
    s_mov_b32 s50, 5120
    s_mov_b32 s51, 0x20000
    buffer_load_dwordx4 v[8:11], v5, s[48:51], 0 offen
    s_mov_b32 s62, 20480
    s_mov_b32 s63, 30720
    s_branch L_poll_8
L_poll_8s:
    s_sleep 8
L_poll_8:
    buffer_load_dwordx4 v[12:15], v5, s[40:43], s62 offen sc1
    buffer_load_dwordx4 v[16:19], v5, s[40:43], s63 offen sc1
    s_sub_u32 s60, s60, 1
    s_cbranch_scc1 L_poll_8t
    s_waitcnt vmcnt(0)
    v_max3_u32 v38, v12, v13, v14
    v_max3_u32 v38, v38, v15, v16
    v_max3_u32 v38, v38, v17, v18
    v_max_u32 v38, v38, v19
    v_cmp_eq_u32 vcc, -1, v38
    s_cbranch_vccnz L_poll_8s
L_poll_8e:
    v_lshlrev_b32 v40, 16, v8
    v_and_b32 v41, 0xffff0000, v8
    v_lshlrev_b32 v42, 16, v9
    v_and_b32 v43, 0xffff0000, v9
    v_lshlrev_b32 v44, 16, v10
    v_and_b32 v45, 0xffff0000, v10
    v_lshlrev_b32 v46, 16, v11
    v_and_b32 v47, 0xffff0000, v11
    v_lshlrev_b32 v48, 16, v12
    v_and_b32 v49, 0xffff0000, v12
    v_lshlrev_b32 v50, 16, v13
    v_and_b32 v51, 0xffff0000, v13
    v_lshlrev_b32 v52, 16, v14
    v_and_b32 v53, 0xffff0000, v14
    v_lshlrev_b32 v54, 16, v15
    v_and_b32 v55, 0xffff0000, v15
    v_lshlrev_b32 v56, 16, v16
    v_and_b32 v57, 0xffff0000, v16
    v_lshlrev_b32 v58, 16, v17
    v_and_b32 v59, 0xffff0000, v17
    v_lshlrev_b32 v60, 16, v18
    v_and_b32 v61, 0xffff0000, v18
    v_lshlrev_b32 v62, 16, v19
    v_and_b32 v63, 0xffff0000, v19
    v_mov_b32 v64, 0
    v_mov_b32 v65, 0
    v_mov_b32 v66, 0
    v_mov_b32 v67, 0
    v_mov_b32 v68, 0
    v_mov_b32 v69, 0
    v_mov_b32 v70, 0
    v_mov_b32 v71, 0
    v_bfe_u32 v5, v0, 2, 2
    v_lshlrev_b32 v5, 8, v5
    v_lshrrev_b32 v8, 4, v0
    v_lshl_add_u32 v5, v8, 6, v5
    v_and_b32 v8, 3, v0
    v_lshl_add_u32 v5, v8, 4, v5
    s_lshl_b32 s63, s100, 10
    v_add_u32 v5, s63, v5
    s_waitcnt vmcnt(0) lgkmcnt(0)
    v_mov_b32 v8, 162064
    v_mov_b32 v9, 1
    s_mov_b64 exec, 1
    ds_add_u32 v8, v9
    s_mov_b64 exec, -1
    s_branch L_t2gate
L_ffn2:
    s_barrier
L_ffn2b:
    ds_read_b128 v[8:11], v161
    ds_read_b128 v[12:15], v162
    s_cmp_eq_u32 s61, 1
    s_cbranch_scc0 L_f2slow
    s_waitcnt lgkmcnt(1)
    v_smfmac_f32_16x16x64_bf16 v[16:19], v[8:11], v[80:87], v164
    v_smfmac_f32_16x16x64_bf16 v[20:23], v[8:11], v[96:103], v164
    s_waitcnt lgkmcnt(0)
    v_smfmac_f32_16x16x64_bf16 v[16:19], v[12:15], v[88:95], v164
    v_smfmac_f32_16x16x64_bf16 v[20:23], v[12:15], v[104:111], v164
    v_smfmac_f32_16x16x64_bf16 v[24:27], v[8:11], v[112:119], v164
    v_smfmac_f32_16x16x64_bf16 v[28:31], v[8:11], v[128:135], v164
    v_smfmac_f32_16x16x64_bf16 v[24:27], v[12:15], v[120:127], v164
    v_smfmac_f32_16x16x64_bf16 v[28:31], v[12:15], v[136:143], v164
    v_smfmac_f32_16x16x64_bf16 v[32:35], v[8:11], v[144:151], v164
    v_smfmac_f32_16x16x64_bf16 v[32:35], v[12:15], v[152:159], v164
    s_nop 0
    v_pk_add_f32 v[16:17], v[16:17], v[18:19]
    v_cvt_pk_bf16_f32 v40, v16, v17
    v_pk_add_f32 v[20:21], v[20:21], v[22:23]
    v_cvt_pk_bf16_f32 v41, v20, v21
    buffer_store_dwordx2 v[40:41], v160, s[40:43], s57 offen
    v_pk_add_f32 v[24:25], v[24:25], v[26:27]
    v_cvt_pk_bf16_f32 v42, v24, v25
    v_pk_add_f32 v[28:29], v[28:29], v[30:31]
    v_cvt_pk_bf16_f32 v43, v28, v29
    buffer_store_dwordx2 v[42:43], v160, s[40:43], s57 offen offset:128
    v_pk_add_f32 v[32:33], v[32:33], v[34:35]
    v_cvt_pk_bf16_f32 v44, v32, v33
    buffer_store_dword v44, v163, s[40:43], s57 offen offset:256
L_f2done:
    s_barrier
    s_endpgm
L_f2slow:
    s_waitcnt lgkmcnt(1)
    v_smfmac_f32_16x16x64_bf16 v[16:19], v[8:11], v[80:87], v164
    v_smfmac_f32_16x16x64_bf16 v[20:23], v[8:11], v[96:103], v164
    s_waitcnt lgkmcnt(0)
    v_smfmac_f32_16x16x64_bf16 v[16:19], v[12:15], v[88:95], v164
    v_smfmac_f32_16x16x64_bf16 v[20:23], v[12:15], v[104:111], v164
    v_smfmac_f32_16x16x64_bf16 v[24:27], v[8:11], v[112:119], v164
    v_smfmac_f32_16x16x64_bf16 v[28:31], v[8:11], v[128:135], v164
    v_smfmac_f32_16x16x64_bf16 v[24:27], v[12:15], v[120:127], v164
    v_smfmac_f32_16x16x64_bf16 v[28:31], v[12:15], v[136:143], v164
    v_smfmac_f32_16x16x64_bf16 v[32:35], v[8:11], v[144:151], v164
    v_smfmac_f32_16x16x64_bf16 v[32:35], v[12:15], v[152:159], v164
    s_nop 0
    v_pk_add_f32 v[16:17], v[16:17], v[18:19]
    v_cvt_pk_bf16_f32 v40, v16, v17
    v_pk_add_f32 v[20:21], v[20:21], v[22:23]
    v_cvt_pk_bf16_f32 v41, v20, v21
    buffer_store_dwordx2 v[40:41], v160, s[40:43], s57 offen sc1
    v_pk_add_f32 v[24:25], v[24:25], v[26:27]
    v_cvt_pk_bf16_f32 v42, v24, v25
    v_pk_add_f32 v[28:29], v[28:29], v[30:31]
    v_cvt_pk_bf16_f32 v43, v28, v29
    buffer_store_dwordx2 v[42:43], v160, s[40:43], s57 offen offset:128 sc1
    v_pk_add_f32 v[32:33], v[32:33], v[34:35]
    v_cvt_pk_bf16_f32 v44, v32, v33
    buffer_store_dword v44, v163, s[40:43], s57 offen offset:256 sc1
    s_branch L_f2done
L_poll_3t:
    s_mov_b32 s60, 0
    s_waitcnt vmcnt(0)
    s_branch L_poll_3e
L_poll_7t:
    s_mov_b32 s60, 0
    s_waitcnt vmcnt(0)
    s_branch L_poll_7e
L_poll_8t:
    s_mov_b32 s60, 0
    s_waitcnt vmcnt(0)
    s_branch L_poll_8e
L_poll_98t:
    s_mov_b32 s60, 0
    s_waitcnt vmcnt(0)
    s_branch L_poll_98e
L_pfast:
    buffer_store_dword v12, v108, s[40:43], s101 offen
    s_branch L_pdone
L_poll_100t:
    s_mov_b32 s60, 0
    s_waitcnt vmcnt(0)
    s_branch L_poll_100e
L_poll_103t:
    s_mov_b32 s60, 0
    s_waitcnt vmcnt(0)
    s_branch L_poll_103e
L_poll_105t:
    s_mov_b32 s60, 0
    s_waitcnt vmcnt(0)
    s_branch L_poll_105e
L_poll_109t:
    s_mov_b32 s60, 0
    s_waitcnt vmcnt(0)
    s_branch L_poll_109e
L_poll_111t:
    s_mov_b32 s60, 0
    s_waitcnt vmcnt(0)
    s_branch L_poll_111e
L_poll_116t:
    s_mov_b32 s60, 0
    s_waitcnt vmcnt(0)
    s_branch L_poll_116e
L_poll_118t:
    s_mov_b32 s60, 0
    s_waitcnt vmcnt(0)
    s_branch L_poll_118e
L_ygt:
    s_waitcnt vmcnt(0)
    s_branch L_ygd
L_pto:
    s_mov_b32 s60, 0
    s_waitcnt vmcnt(0)
    s_branch L_pgot0
L_poll_122t:
    s_mov_b32 s60, 0
    s_waitcnt vmcnt(0)
    s_branch L_poll_122e
L_end:
    s_endpgm
L_codeend:
.section .rodata,"a"
.p2align 6
.amdhsa_kernel adaLN_cond__sliding_block_cached__dense_activation_gelu__decode_kernel
  .amdhsa_next_free_vgpr 168
  .amdhsa_next_free_sgpr 102
  .amdhsa_accum_offset 168
  .amdhsa_group_segment_fixed_size 0
  .amdhsa_kernarg_size 120
  .amdhsa_user_sgpr_count 2
  .amdhsa_user_sgpr_kernarg_segment_ptr 1
  .amdhsa_system_sgpr_workgroup_id_x 1
.end_amdhsa_kernel
```

```asm
; @launch grid=(256,1,1) block=(768,1,1) lds=162176
.amdgcn_target "amdgcn-amd-amdhsa--gfx950"
.text
.globl adaLN_cond__sliding_block_cached__dense_activation_gelu__decode_kernel
.p2align 8
.type adaLN_cond__sliding_block_cached__dense_activation_gelu__decode_kernel,@function
adaLN_cond__sliding_block_cached__dense_activation_gelu__decode_kernel:
    s_load_dwordx16 s[4:19], s[0:1], 0
    s_load_dwordx8 s[20:27], s[0:1], 64
    s_load_dwordx4 s[28:31], s[0:1], 96
    s_load_dwordx2 s[32:33], s[0:1], 112
    s_cmp_ge_u32 s2, 256
    s_cbranch_scc1 L_end
    v_lshrrev_b32 v1, 6, v0
    v_lshlrev_b32 v2, 4, v0
    v_readfirstlane_b32 s3, v1
    v_and_b32 v0, 63, v0
    s_and_b32 s34, s2, 7
    s_lshr_b32 s35, s2, 3
    s_cmp_lg_u32 s35, 21
    s_cbranch_scc1 L_nopf
    s_getpc_b64 s[48:49]
    s_and_b32 s48, s48, 0xffffff00
    s_mov_b32 s50, L_codeend-adaLN_cond__sliding_block_cached__dense_activation_gelu__decode_kernel
    s_mov_b32 s51, 0x20000
    s_mov_b32 s52, 12288
    buffer_load_dwordx4 v[152:155], v2, s[48:51], 0 offen
    buffer_load_dwordx4 v[156:159], v2, s[48:51], s52 offen
L_nopf:
    s_lshr_b32 s36, s35, 3
    s_lshl2_add_u32 s36, s34, s36
    s_bfe_u32 s37, s35, 0x20001
    s_and_b32 s38, s35, 1
    s_cmp_lt_u32 s35, 27
    s_cselect_b32 s39, 1, 0
    s_cmp_eq_u32 s34, 2
    s_cselect_b32 s39, s39, 0
    s_sub_u32 s62, s34, 3
    s_and_b32 s62, s62, 7
    s_mul_i32 s56, s35, 7
    s_add_u32 s56, s56, s62
    s_cmp_eq_u32 s62, 7
    s_cselect_b32 s56, 255, s56
    s_mov_b32 s60, 400000
    s_mov_b32 s61, 0
    v_mov_b32 v36, 0
    s_cmp_lt_u32 s3, 4
    s_cbranch_scc1 L_helpers
    s_sub_u32 s3, s3, 4
    s_cmp_ge_u32 s35, 22
    s_cselect_b32 s59, 1, 0
    s_add_u32 s62, s3, s59
    s_cmp_ge_u32 s62, 6
    s_cselect_b32 s62, s39, 0
    s_cmp_eq_u32 s62, 1
    s_cbranch_scc1 L_proxy
    s_cmp_eq_u32 s59, 1
    s_cselect_b32 s100, 0, 81920
    s_lshl_b32 s62, s3, 13
    s_add_u32 s100, s100, s62
    s_and_b32 s62, s39, s59
    s_cselect_b32 s100, -1, s100
    s_mov_b32 s101, 0
L_stream:
    s_lshl_b32 s62, s37, 5
    s_add_u32 s62, s62, s36
    s_lshl_b32 s63, s62, 21
    s_lshl_b32 s96, s38, 18
    s_add_u32 s63, s63, s96
    s_add_u32 s63, s63, 1572864
    v_lshlrev_b32 v1, 4, v0
    s_lshl_b32 s96, s3, 12
    v_add_u32 v1, s96, v1
    s_mov_b32 s97, 0
    s_mov_b32 s50, 262144
    s_mov_b32 s51, 0x20000
    s_waitcnt lgkmcnt(0)
    s_add_u32 s48, s6, s63
    s_addc_u32 s49, s7, 0
    s_cmp_lt_u32 s56, 40
    s_cbranch_scc0 L_nob0
    s_barrier
L_nob0:
    buffer_load_dwordx4 v[40:43], v1, s[48:51], s97 offen offset:0 nt
    buffer_load_dwordx4 v[44:47], v1, s[48:51], s97 offen offset:1024 nt
    s_cmp_lt_u32 s56, 40
    s_cbranch_scc1 L_stream2
    s_barrier
    s_branch L_stream2
L_helpers:
    s_cmp_lg_u32 s3, 0
    s_cbranch_scc1 L_noinit
    v_lshlrev_b32 v1, 2, v0
    v_add_u32 v1, 161920, v1
    ds_write_b32 v1, v36
L_noinit:
    s_waitcnt lgkmcnt(0)
    s_mov_b32 s40, s32
    s_mov_b32 s41, s33
    s_mov_b32 s42, 589824
    s_mov_b32 s43, 0x20000
    s_mov_b32 s44, s30
    s_mov_b32 s45, s31
    s_mov_b32 s46, 256
    s_mov_b32 s47, 0x20000
    s_lshl2_add_u32 s62, s35, s3
    s_cmp_eq_u32 s62, 87
    s_cbranch_scc1 L_touch
L_notp:
    s_mul_i32 s101, s3, 20480
    s_mov_b32 s96, s56
    s_cmp_lt_u32 s56, 40
    s_cbranch_scc0 L_nothalf
    s_cmp_lt_u32 s3, 2
    s_cbranch_scc1 L_unit
    s_add_u32 s62, s56, 20
    s_cmp_eq_u32 s3, 2
    s_cbranch_scc1 L_job
    s_lshr_b32 s62, s56, 1
    s_lshl_b32 s63, s62, 11
    s_cmp_ge_u32 s62, 10
    s_cselect_b32 s62, -19968, 0
    s_add_u32 s63, s63, s62
    s_and_b32 s62, s56, 1
    s_lshl_b32 s62, s62, 8
    s_add_u32 s63, s63, s62
    v_lshrrev_b32 v1, 5, v0
    v_lshlrev_b32 v1, 10, v1
    v_and_b32 v2, 31, v0
    v_lshl_add_u32 v1, v2, 3, v1
    v_mov_b32 v4, -1
    v_mov_b32 v5, -1
    buffer_store_dwordx2 v[4:5], v1, s[40:43], s63 offen sc1
    s_lshl_b32 s62, s56, 1
    s_waitcnt vmcnt(0)
    s_mov_b64 exec, 1
    buffer_store_short v4, v36, s[44:47], s62 offen offset:128 sc1
    s_mov_b64 exec, -1
    s_barrier
    s_branch L_service
L_nothalf:
    s_cmp_lt_u32 s56, 104
    s_cbranch_scc1 L_unit
    s_sub_u32 s62, s56, 144
    s_cmp_lt_u32 s62, 10
    s_cbranch_scc0 L_nojob
    s_cmp_lt_u32 s3, 2
    s_cbranch_scc0 L_nojob
    s_mul_i32 s63, s3, 10
    s_add_u32 s62, s62, s63
L_job:
    s_cmp_lt_u32 s62, 59
    s_cbranch_scc0 L_end
    s_mov_b32 s100, s101
    s_lshl_b32 s101, s62, 9
    s_add_u32 s101, s101, 155648
    s_cmp_lt_u32 s62, 27
    s_cselect_b32 s63, 0, 27
    s_cselect_b32 s3, 7, 6
    s_cmp_lt_u32 s62, 54
    s_cselect_b32 s63, s63, 32
    s_cselect_b32 s3, s3, 5
    s_sub_u32 s35, s62, s63
    s_mov_b32 s34, 2
    s_lshr_b32 s36, s35, 3
    s_add_u32 s36, s36, 8
    s_bfe_u32 s37, s35, 0x20001
    s_and_b32 s38, s35, 1
    s_mov_b32 s59, 0
    s_branch L_stream
L_nojob:
    s_barrier
    s_cmp_ge_u32 s35, 22
    s_cbranch_scc1 L_h_t1
    s_cmp_eq_u32 s39, 1
    s_cbranch_scc1 L_h_role
    s_cmp_lt_u32 s96, 144
    s_cbranch_scc1 L_unit
    s_cmp_eq_u32 s3, 3
    s_cbranch_scc1 L_service
    s_endpgm
L_unit:
    v_lshrrev_b32 v3, 4, v0
    v_and_b32 v4, 3, v0
    v_bfe_u32 v7, v0, 2, 2
    s_mov_b32 s14, s3
    s_mov_b32 s15, 3
    s_sub_u32 s62, s96, 40
    s_cmp_lt_u32 s62, 64
    s_cbranch_scc1 L_u_q
    s_mov_b32 s100, 1
    s_sub_u32 s96, s96, 84
    s_cmp_lt_u32 s56, 40
    s_cbranch_scc0 L_u_full
    s_mov_b32 s100, 0
    s_lshr_b32 s96, s56, 1
    s_and_b32 s62, s56, 1
    s_lshl1_add_u32 s14, s62, s14
    s_mov_b32 s15, 1
L_u_full:
    s_mov_b32 s97, 0
    s_mov_b32 s99, 7680
    s_mov_b32 s48, s26
    s_mov_b32 s49, s27
    s_mov_b32 s50, 4915200
    s_mov_b32 s51, 0x20000
    s_mov_b32 s52, s24
    s_mov_b32 s53, s25
    s_mov_b32 s54, 5120
    s_mov_b32 s55, 0x20000
    v_and_b32 v6, 15, v0
    v_lshlrev_b32 v6, 4, v6
    v_mul_u32_u24 v5, 1280, v3
    v_add_u32 v5, v5, v6
    s_mul_i32 s62, s14, 320
    buffer_load_dwordx4 v[8:11], v5, s[52:55], s62 offen
    s_mov_b32 exec_lo, 0x000f000f
    s_mov_b32 exec_hi, 0x000f000f
    buffer_load_dwordx4 v[12:15], v5, s[52:55], s62 offen offset:256
    s_mov_b64 exec, -1
    s_lshl_b32 s98, s96, 7
    s_mul_i32 s13, s96, 0x199a
    s_lshr_b32 s13, s13, 16
    s_cmp_lg_u32 s13, 1
    s_cbranch_scc1 L_u_go
    s_mov_b32 s52, s4
    s_mov_b32 s53, s5
    s_mov_b32 s54, 5120
    s_mov_b32 s55, 0x20000
    v_mul_u32_u24 v5, 1280, v4
    v_lshlrev_b32 v64, 5, v7
    v_lshl_add_u32 v64, v3, 3, v64
    v_add_u32 v64, v64, v5
    v_lshrrev_b32 v6, 2, v0
    v_lshl_add_u32 v6, v6, 4, v5
    s_sub_u32 s62, s98, 1280
    buffer_load_dwordx4 v[16:19], v6, s[52:55], 0 offen offset:0
    buffer_load_dwordx4 v[20:23], v6, s[52:55], 0 offen offset:256
    buffer_load_dwordx4 v[24:27], v6, s[52:55], 0 offen offset:512
    buffer_load_dwordx4 v[28:31], v6, s[52:55], 0 offen offset:768
    buffer_load_dwordx4 v[32:35], v6, s[52:55], 0 offen offset:1024
    buffer_load_dwordx2 v[66:67], v64, s[52:55], s62 offen
    s_branch L_u_go
L_u_q:
    s_mov_b32 s97, 1
    s_mov_b32 s99, 8192
    s_mov_b32 s100, 0
    s_lshl_b32 s98, s62, 7
    s_mov_b32 s48, s10
    s_mov_b32 s49, s11
    s_mov_b32 s50, 5242880
    s_mov_b32 s51, 0x20000
L_u_go:
    v_lshrrev_b32 v6, 3, v0
    v_mul_lo_u32 v1, v6, s99
    v_and_b32 v6, 2, v6
    v_xor_b32 v6, v6, v0
    v_and_b32 v6, 7, v6
    v_lshl_add_u32 v1, v6, 4, v1
    v_add_u32 v1, s98, v1
    v_xor_b32 v2, 64, v1
    s_mul_i32 s63, s99, s14
    s_mul_i32 s63, s63, 160
    s_lshl_b32 s59, s99, 3
    s_mov_b32 m0, s101
    s_mov_b32 s62, 10
L_dma_1:
    buffer_load_dwordx4 v1, s[48:51], s63 offen nt lds
    s_add_u32 m0, m0, 1024
    s_add_u32 s63, s63, s59
    s_cmp_eq_u32 s100, 0
    s_cbranch_scc1 L_dma_1n0
    s_waitcnt vmcnt(3)
    s_cmp_eq_u32 s100, 2
    s_cbranch_scc1 L_dma_1n0
    s_waitcnt vmcnt(3)
L_dma_1n0:
    buffer_load_dwordx4 v2, s[48:51], s63 offen nt lds
    s_add_u32 m0, m0, 1024
    s_add_u32 s63, s63, s59
    s_cmp_eq_u32 s100, 0
    s_cbranch_scc1 L_dma_1n1
    s_waitcnt vmcnt(3)
    s_cmp_eq_u32 s100, 2
    s_cbranch_scc1 L_dma_1n1
    s_waitcnt vmcnt(3)
L_dma_1n1:
    s_sub_u32 s62, s62, 1
    s_cmp_lg_u32 s62, 0
    s_cbranch_scc1 L_dma_1
    v_and_b32 v65, 31, v0
    v_lshlrev_b32 v65, 2, v65
    s_cmp_lt_u32 s56, 104
    s_cselect_b32 s62, 32, 64
    v_min_u32 v6, 51, v0
    v_lshlrev_b32 v6, 2, v6
    v_cmp_le_u32 vcc, s62, v0
    s_nop 1
    v_cndmask_b32 v65, v65, v6, vcc
    v_mov_b32 v68, -1
    s_cmp_lt_u32 s56, 40
    s_cbranch_scc1 L_u_nofl
    buffer_load_dword v68, v65, s[44:47], 0 offen sc1
L_u_nofl:
    s_cmp_lt_u32 s56, 104
    s_cbranch_scc0 L_u_nob
    s_barrier
L_u_nob:
    v_lshrrev_b32 v60, 4, v0
    v_lshlrev_b32 v60, 10, v60
    v_bfe_u32 v6, v0, 2, 2
    v_lshl_add_u32 v60, v6, 7, v60
    v_and_b32 v6, 3, v0
    v_lshl_add_u32 v60, v6, 3, v60
    v_bfe_u32 v6, v0, 3, 2
    v_lshl_add_u32 v60, v6, 5, v60
    v_xor_b32 v61, 32, v60
    v_xor_b32 v62, 64, v60
    v_xor_b32 v63, 0x60, v60
    v_add_u32 v60, s101, v60
    v_add_u32 v61, s101, v61
    v_add_u32 v62, s101, v62
    v_add_u32 v63, s101, v63
    v_mov_b32 v56, 1.0
    v_mov_b32 v57, 1.0
    v_mov_b32 v58, 1.0
    v_mov_b32 v59, 1.0
    s_mov_b32 s58, 0
    v_lshl_add_u32 v69, v7, 2, v3
    v_lshl_add_u32 v69, v4, 4, v69
    v_and_b32 v64, 15, v0
    v_lshlrev_b32 v64, 3, v64
    s_cmp_eq_u32 s97, 1
    s_cbranch_scc1 L_u_q2
    v_mul_u32_u24 v6, 1280, v3
    v_add_u32 v64, v64, v6
    s_mul_i32 s63, s13, 3840
    s_add_u32 s57, s98, s63
    s_add_u32 s57, s57, 10240
    s_cmp_lt_u32 s56, 40
    s_cbranch_scc0 L_u_nat
    v_lshrrev_b32 v69, 1, v3
    v_lshlrev_b32 v69, 3, v69
    v_lshl_add_u32 v69, v7, 4, v69
    v_lshl_add_u32 v69, v4, 1, v69
    v_and_b32 v6, 1, v3
    v_add_u32 v69, v69, v6
    s_lshr_b32 s62, s56, 1
    s_lshl_b32 s57, s62, 11
    s_cmp_ge_u32 s62, 10
    s_cselect_b32 s62, -19968, 0
    s_add_u32 s57, s57, s62
    s_and_b32 s62, s56, 1
    s_lshl_b32 s62, s62, 8
    s_add_u32 s57, s57, s62
    v_lshrrev_b32 v64, 5, v0
    v_lshlrev_b32 v64, 10, v64
    v_and_b32 v6, 31, v0
    v_lshl_add_u32 v64, v6, 3, v64
L_u_nat:
    s_cmp_eq_u32 s13, 4
    s_cselect_b32 s58, 1.0, 0
    s_cmp_eq_u32 s13, 1
    s_cselect_b32 s58, 1.0, s58
    s_cselect_b32 s56, 1, 0
    s_cmp_eq_u32 s14, 0
    s_cselect_b32 s58, s58, 0
    s_waitcnt vmcnt(20)
    s_mov_b32 s62, 0xbfb8aa3b
    v_lshlrev_b32 v40, 16, v8
    v_and_b32 v41, 0xffff0000, v8
    v_lshlrev_b32 v42, 16, v9
    v_and_b32 v43, 0xffff0000, v9
    v_lshlrev_b32 v44, 16, v10
    v_and_b32 v45, 0xffff0000, v10
    v_lshlrev_b32 v46, 16, v11
    v_and_b32 v47, 0xffff0000, v11
    v_mul_f32 v48, s62, v40
    v_mul_f32 v49, s62, v41
    v_mul_f32 v50, s62, v42
    v_mul_f32 v51, s62, v43
    v_mul_f32 v52, s62, v44
    v_mul_f32 v53, s62, v45
    v_mul_f32 v54, s62, v46
    v_mul_f32 v55, s62, v47
    v_exp_f32 v48, v48
    v_exp_f32 v49, v49
    v_exp_f32 v50, v50
    v_exp_f32 v51, v51
    v_exp_f32 v52, v52
    v_exp_f32 v53, v53
    v_exp_f32 v54, v54
    v_exp_f32 v55, v55
    v_add_f32 v48, 1.0, v48
    v_add_f32 v49, 1.0, v49
    v_add_f32 v50, 1.0, v50
    v_add_f32 v51, 1.0, v51
    v_add_f32 v52, 1.0, v52
    v_add_f32 v53, 1.0, v53
    v_add_f32 v54, 1.0, v54
    v_add_f32 v55, 1.0, v55
    v_rcp_f32 v48, v48
    v_rcp_f32 v49, v49
    v_rcp_f32 v50, v50
    v_rcp_f32 v51, v51
    v_rcp_f32 v52, v52
    v_rcp_f32 v53, v53
    v_rcp_f32 v54, v54
    v_rcp_f32 v55, v55
    v_mul_f32 v40, v40, v48
    v_mul_f32 v41, v41, v49
    v_mul_f32 v42, v42, v50
    v_mul_f32 v43, v43, v51
    v_mul_f32 v44, v44, v52
    v_mul_f32 v45, v45, v53
    v_mul_f32 v46, v46, v54
    v_mul_f32 v47, v47, v55
    v_cvt_pk_bf16_f32 v8, v40, v41
    v_cvt_pk_bf16_f32 v9, v42, v43
    v_cvt_pk_bf16_f32 v10, v44, v45
    v_cvt_pk_bf16_f32 v11, v46, v47
    v_lshlrev_b32 v40, 16, v12
    v_and_b32 v41, 0xffff0000, v12
    v_lshlrev_b32 v42, 16, v13
    v_and_b32 v43, 0xffff0000, v13
    v_lshlrev_b32 v44, 16, v14
    v_and_b32 v45, 0xffff0000, v14
    v_lshlrev_b32 v46, 16, v15
    v_and_b32 v47, 0xffff0000, v15
    v_mul_f32 v48, s62, v40
    v_mul_f32 v49, s62, v41
    v_mul_f32 v50, s62, v42
    v_mul_f32 v51, s62, v43
    v_mul_f32 v52, s62, v44
    v_mul_f32 v53, s62, v45
    v_mul_f32 v54, s62, v46
    v_mul_f32 v55, s62, v47
    v_exp_f32 v48, v48
    v_exp_f32 v49, v49
    v_exp_f32 v50, v50
    v_exp_f32 v51, v51
    v_exp_f32 v52, v52
    v_exp_f32 v53, v53
    v_exp_f32 v54, v54
    v_exp_f32 v55, v55
    v_add_f32 v48, 1.0, v48
    v_add_f32 v49, 1.0, v49
    v_add_f32 v50, 1.0, v50
    v_add_f32 v51, 1.0, v51
    v_add_f32 v52, 1.0, v52
    v_add_f32 v53, 1.0, v53
    v_add_f32 v54, 1.0, v54
    v_add_f32 v55, 1.0, v55
    v_rcp_f32 v48, v48
    v_rcp_f32 v49, v49
    v_rcp_f32 v50, v50
    v_rcp_f32 v51, v51
    v_rcp_f32 v52, v52
    v_rcp_f32 v53, v53
    v_rcp_f32 v54, v54
    v_rcp_f32 v55, v55
    v_mul_f32 v40, v40, v48
    v_mul_f32 v41, v41, v49
    v_mul_f32 v42, v42, v50
    v_mul_f32 v43, v43, v51
    v_mul_f32 v44, v44, v52
    v_mul_f32 v45, v45, v53
    v_mul_f32 v46, v46, v54
    v_mul_f32 v47, v47, v55
    v_cvt_pk_bf16_f32 v12, v40, v41
    v_cvt_pk_bf16_f32 v13, v42, v43
    v_cvt_pk_bf16_f32 v14, v44, v45
    v_cvt_pk_bf16_f32 v15, v46, v47
    s_mul_i32 s62, s3, 1344
    s_add_u32 s62, s62, 151552
    v_mul_u32_u24 v5, 336, v3
    v_and_b32 v6, 15, v0
    v_lshl_add_u32 v5, v6, 4, v5
    v_add_u32 v5, s62, v5
    ds_write_b128 v5, v[8:11]
    s_mov_b32 exec_lo, 0x000f000f
    s_mov_b32 exec_hi, 0x000f000f
    ds_write_b128 v5, v[12:15] offset:256
    s_mov_b64 exec, -1
    v_mul_u32_u24 v5, 336, v4
    v_lshl_add_u32 v5, v3, 4, v5
    v_add_u32 v5, s62, v5
    s_mov_b32 s59, 0x3e800000
    s_cmp_eq_u32 s56, 0
    s_cbranch_scc1 L_u_nost
    v_mov_b32 v40, 0
    v_mov_b32 v41, 0
    s_mov_b32 s62, 0x3f803f80
    v_dot2c_f32_bf16 v40, s62, v16
    v_dot2c_f32_bf16 v41, v16, v16
    v_dot2c_f32_bf16 v40, s62, v17
    v_dot2c_f32_bf16 v41, v17, v17
    v_dot2c_f32_bf16 v40, s62, v18
    v_dot2c_f32_bf16 v41, v18, v18
    v_dot2c_f32_bf16 v40, s62, v19
    v_dot2c_f32_bf16 v41, v19, v19
    v_dot2c_f32_bf16 v40, s62, v20
    v_dot2c_f32_bf16 v41, v20, v20
    v_dot2c_f32_bf16 v40, s62, v21
    v_dot2c_f32_bf16 v41, v21, v21
    v_dot2c_f32_bf16 v40, s62, v22
    v_dot2c_f32_bf16 v41, v22, v22
    v_dot2c_f32_bf16 v40, s62, v23
    v_dot2c_f32_bf16 v41, v23, v23
    v_dot2c_f32_bf16 v40, s62, v24
    v_dot2c_f32_bf16 v41, v24, v24
    v_dot2c_f32_bf16 v40, s62, v25
    v_dot2c_f32_bf16 v41, v25, v25
    v_dot2c_f32_bf16 v40, s62, v26
    v_dot2c_f32_bf16 v41, v26, v26
    v_dot2c_f32_bf16 v40, s62, v27
    v_dot2c_f32_bf16 v41, v27, v27
    v_dot2c_f32_bf16 v40, s62, v28
    v_dot2c_f32_bf16 v41, v28, v28
    v_dot2c_f32_bf16 v40, s62, v29
    v_dot2c_f32_bf16 v41, v29, v29
    v_dot2c_f32_bf16 v40, s62, v30
    v_dot2c_f32_bf16 v41, v30, v30
    v_dot2c_f32_bf16 v40, s62, v31
    v_dot2c_f32_bf16 v41, v31, v31
    v_dot2c_f32_bf16 v40, s62, v32
    v_dot2c_f32_bf16 v41, v32, v32
    v_dot2c_f32_bf16 v40, s62, v33
    v_dot2c_f32_bf16 v41, v33, v33
    v_dot2c_f32_bf16 v40, s62, v34
    v_dot2c_f32_bf16 v41, v34, v34
    v_dot2c_f32_bf16 v40, s62, v35
    v_dot2c_f32_bf16 v41, v35, v35
    s_nop 1
    v_add_f32_dpp v40, v40, v40 row_ror:4 row_mask:0xf bank_mask:0xf
    v_add_f32_dpp v41, v41, v41 row_ror:4 row_mask:0xf bank_mask:0xf
    s_nop 0
    v_add_f32_dpp v40, v40, v40 row_ror:8 row_mask:0xf bank_mask:0xf
    v_add_f32_dpp v41, v41, v41 row_ror:8 row_mask:0xf bank_mask:0xf
    v_mov_b32 v42, v40
    v_mov_b32 v43, v41
    s_nop 0
    v_permlane16_swap_b32 v40, v42
    v_permlane16_swap_b32 v41, v43
    v_add_f32 v40, v40, v42
    v_add_f32 v41, v41, v43
    v_mov_b32 v42, v40
    v_mov_b32 v43, v41
    s_nop 0
    v_permlane32_swap_b32 v40, v42
    v_permlane32_swap_b32 v41, v43
    v_add_f32 v40, v40, v42
    v_add_f32 v41, v41, v43
    s_mov_b32 s62, 0x3acccccd
    v_mul_f32 v40, s62, v40
    v_mul_f32 v41, s62, v41
    v_fma_f32 v41, -v40, v40, v41
    v_max_f32 v41, 0, v41
    v_add_f32 v41, 0x3727c5ac, v41
    v_rsq_f32 v41, v41
    v_lshlrev_b32 v56, 16, v66
    v_and_b32 v57, 0xffff0000, v66
    v_lshlrev_b32 v58, 16, v67
    v_and_b32 v59, 0xffff0000, v67
    v_sub_f32 v56, v56, v40
    v_sub_f32 v57, v57, v40
    v_sub_f32 v58, v58, v40
    v_sub_f32 v59, v59, v40
    v_mul_f32 v56, v56, v41
    v_mul_f32 v57, v57, v41
    v_mul_f32 v58, v58, v41
    v_mul_f32 v59, v59, v41
L_u_nost:
    ds_read_b128 v[8:11], v5 offset:0
    ds_read_b128 v[12:15], v5 offset:64
    ds_read_b128 v[16:19], v5 offset:128
    ds_read_b128 v[20:23], v5 offset:192
    ds_read_b128 v[24:27], v5 offset:256
    s_branch L_u_frag
L_u_q2:
    v_lshl_add_u32 v64, v3, 13, v64
    s_add_u32 s57, s98, 40960
    v_lshlrev_b32 v5, 8, v7
    v_lshl_add_u32 v5, v3, 6, v5
    v_lshl_add_u32 v5, v4, 4, v5
    s_mul_i32 s63, s3, 5120
    s_add_u32 s63, s63, 0
    s_add_u32 s12, s63, 4096
    s_mov_b32 s59, 1.0
L_u_frag:
    s_waitcnt vmcnt(0)
    v_cmp_ne_u32 vcc, -1, v68
    s_cbranch_vccz L_u_yok
L_wy_2:
    buffer_load_dword v37, v65, s[44:47], 0 offen sc1
    s_waitcnt vmcnt(0)
    v_cmp_ne_u32 vcc, -1, v37
    s_cbranch_vccz L_wy_2e
    s_sleep 4
    s_sub_u32 s60, s60, 1
    s_cbranch_scc0 L_wy_2
    s_mov_b32 s60, 0
L_wy_2e:
L_u_yok:
    ds_read_b64_tr_b16 v[80:81], v60 offset:0
    ds_read_b64_tr_b16 v[82:83], v60 offset:512
    ds_read_b64_tr_b16 v[84:85], v61 offset:0
    ds_read_b64_tr_b16 v[86:87], v61 offset:512
    ds_read_b64_tr_b16 v[88:89], v62 offset:0
    ds_read_b64_tr_b16 v[90:91], v62 offset:512
    ds_read_b64_tr_b16 v[92:93], v63 offset:0
    ds_read_b64_tr_b16 v[94:95], v63 offset:512
    ds_read_b64_tr_b16 v[96:97], v60 offset:4096
    ds_read_b64_tr_b16 v[98:99], v60 offset:4608
    ds_read_b64_tr_b16 v[100:101], v61 offset:4096
    ds_read_b64_tr_b16 v[102:103], v61 offset:4608
    ds_read_b64_tr_b16 v[104:105], v62 offset:4096
    ds_read_b64_tr_b16 v[106:107], v62 offset:4608
    ds_read_b64_tr_b16 v[108:109], v63 offset:4096
    ds_read_b64_tr_b16 v[110:111], v63 offset:4608
    ds_read_b64_tr_b16 v[112:113], v60 offset:8192
    ds_read_b64_tr_b16 v[114:115], v60 offset:8704
    ds_read_b64_tr_b16 v[116:117], v61 offset:8192
    ds_read_b64_tr_b16 v[118:119], v61 offset:8704
    ds_read_b64_tr_b16 v[120:121], v62 offset:8192
    ds_read_b64_tr_b16 v[122:123], v62 offset:8704
    ds_read_b64_tr_b16 v[124:125], v63 offset:8192
    ds_read_b64_tr_b16 v[126:127], v63 offset:8704
    ds_read_b64_tr_b16 v[128:129], v60 offset:12288
    ds_read_b64_tr_b16 v[130:131], v60 offset:12800
    ds_read_b64_tr_b16 v[132:133], v61 offset:12288
    ds_read_b64_tr_b16 v[134:135], v61 offset:12800
    ds_read_b64_tr_b16 v[136:137], v62 offset:12288
    ds_read_b64_tr_b16 v[138:139], v62 offset:12800
    ds_read_b64_tr_b16 v[140:141], v63 offset:12288
    ds_read_b64_tr_b16 v[142:143], v63 offset:12800
    ds_read_b64_tr_b16 v[144:145], v60 offset:16384
    ds_read_b64_tr_b16 v[146:147], v60 offset:16896
    ds_read_b64_tr_b16 v[148:149], v61 offset:16384
    ds_read_b64_tr_b16 v[150:151], v61 offset:16896
    ds_read_b64_tr_b16 v[152:153], v62 offset:16384
    ds_read_b64_tr_b16 v[154:155], v62 offset:16896
    ds_read_b64_tr_b16 v[156:157], v63 offset:16384
    ds_read_b64_tr_b16 v[158:159], v63 offset:16896
    s_cmp_eq_u32 s97, 0
    s_cbranch_scc1 L_u_mm
    s_branch L_poll_3
L_poll_3s:
    s_sleep 8
L_poll_3:
    buffer_load_dwordx4 v[8:11], v5, s[40:43], s63 offen offset:0 sc1
    buffer_load_dwordx4 v[12:15], v5, s[40:43], s63 offen offset:1024 sc1
    buffer_load_dwordx4 v[16:19], v5, s[40:43], s63 offen offset:2048 sc1
    buffer_load_dwordx4 v[20:23], v5, s[40:43], s63 offen offset:3072 sc1
    buffer_load_dwordx4 v[24:27], v5, s[40:43], s12 offen offset:0 sc1
    s_sub_u32 s60, s60, 1
    s_cbranch_scc1 L_poll_3t
    s_waitcnt vmcnt(0)
    v_max3_u32 v37, v8, v9, v10
    v_max3_u32 v37, v37, v11, v12
    v_max3_u32 v37, v37, v13, v14
    v_max3_u32 v37, v37, v15, v16
    v_max3_u32 v37, v37, v17, v18
    v_max3_u32 v37, v37, v19, v20
    v_max3_u32 v37, v37, v21, v22
    v_max3_u32 v37, v37, v23, v24
    v_max3_u32 v37, v37, v25, v26
    v_max_u32 v37, v37, v27
    v_cmp_eq_u32 vcc, -1, v37
    s_cbranch_vccnz L_poll_3s
L_poll_3e:
L_u_got:
L_u_mm:
    s_waitcnt lgkmcnt(0)
    v_mfma_f32_16x16x32_bf16 v[40:43], v[80:83], v[8:11], 0
    v_mfma_f32_16x16x32_bf16 v[44:47], v[84:87], v[8:11], 0
    v_mfma_f32_16x16x32_bf16 v[48:51], v[88:91], v[8:11], 0
    v_mfma_f32_16x16x32_bf16 v[52:55], v[92:95], v[8:11], 0
    v_mfma_f32_16x16x32_bf16 v[40:43], v[96:99], v[12:15], v[40:43]
    v_mfma_f32_16x16x32_bf16 v[44:47], v[100:103], v[12:15], v[44:47]
    v_mfma_f32_16x16x32_bf16 v[48:51], v[104:107], v[12:15], v[48:51]
    v_mfma_f32_16x16x32_bf16 v[52:55], v[108:111], v[12:15], v[52:55]
    v_mfma_f32_16x16x32_bf16 v[40:43], v[112:115], v[16:19], v[40:43]
    v_mfma_f32_16x16x32_bf16 v[44:47], v[116:119], v[16:19], v[44:47]
    v_mfma_f32_16x16x32_bf16 v[48:51], v[120:123], v[16:19], v[48:51]
    v_mfma_f32_16x16x32_bf16 v[52:55], v[124:127], v[16:19], v[52:55]
    v_mfma_f32_16x16x32_bf16 v[40:43], v[128:131], v[20:23], v[40:43]
    v_mfma_f32_16x16x32_bf16 v[44:47], v[132:135], v[20:23], v[44:47]
    v_mfma_f32_16x16x32_bf16 v[48:51], v[136:139], v[20:23], v[48:51]
    v_mfma_f32_16x16x32_bf16 v[52:55], v[140:143], v[20:23], v[52:55]
    v_mfma_f32_16x16x32_bf16 v[40:43], v[144:147], v[24:27], v[40:43]
    v_mfma_f32_16x16x32_bf16 v[44:47], v[148:151], v[24:27], v[44:47]
    v_mfma_f32_16x16x32_bf16 v[48:51], v[152:155], v[24:27], v[48:51]
    v_mfma_f32_16x16x32_bf16 v[52:55], v[156:159], v[24:27], v[52:55]
    v_lshlrev_b32 v5, 4, v0
    v_add_u32 v5, 147456, v5
    s_lshl_b32 s62, s3, 10
    s_add_u32 s62, s62, 147456
    v_lshl_add_u32 v6, v69, 4, s62
    v_mov_b32 v24, s58
    v_mov_b32 v32, 162056
    v_mov_b32 v33, 1
    v_add_f32_dpp v40, v40, v40 row_ror:8 row_mask:0xf bank_mask:0xf
    v_add_f32_dpp v41, v41, v41 row_ror:8 row_mask:0xf bank_mask:0xf
    v_add_f32_dpp v42, v42, v42 row_ror:8 row_mask:0xf bank_mask:0xf
    v_add_f32_dpp v43, v43, v43 row_ror:8 row_mask:0xf bank_mask:0xf
    v_add_f32_dpp v44, v44, v44 row_ror:8 row_mask:0xf bank_mask:0xf
    v_add_f32_dpp v45, v45, v45 row_ror:8 row_mask:0xf bank_mask:0xf
    v_add_f32_dpp v46, v46, v46 row_ror:8 row_mask:0xf bank_mask:0xf
    v_add_f32_dpp v47, v47, v47 row_ror:8 row_mask:0xf bank_mask:0xf
    v_add_f32_dpp v48, v48, v48 row_ror:8 row_mask:0xf bank_mask:0xf
    v_add_f32_dpp v49, v49, v49 row_ror:8 row_mask:0xf bank_mask:0xf
    v_add_f32_dpp v50, v50, v50 row_ror:8 row_mask:0xf bank_mask:0xf
    v_add_f32_dpp v51, v51, v51 row_ror:8 row_mask:0xf bank_mask:0xf
    v_add_f32_dpp v52, v52, v52 row_ror:8 row_mask:0xf bank_mask:0xf
    v_add_f32_dpp v53, v53, v53 row_ror:8 row_mask:0xf bank_mask:0xf
    v_add_f32_dpp v54, v54, v54 row_ror:8 row_mask:0xf bank_mask:0xf
    v_add_f32_dpp v55, v55, v55 row_ror:8 row_mask:0xf bank_mask:0xf
    v_add_f32_dpp v28, v40, v40 row_ror:4 row_mask:0xf bank_mask:0x1
    v_add_f32_dpp v29, v41, v41 row_ror:4 row_mask:0xf bank_mask:0x1
    v_add_f32_dpp v30, v42, v42 row_ror:4 row_mask:0xf bank_mask:0x1
    v_add_f32_dpp v31, v43, v43 row_ror:4 row_mask:0xf bank_mask:0x1
    v_add_f32_dpp v28, v44, v44 row_ror:4 row_mask:0xf bank_mask:0x2
    v_add_f32_dpp v29, v45, v45 row_ror:4 row_mask:0xf bank_mask:0x2
    v_add_f32_dpp v30, v46, v46 row_ror:4 row_mask:0xf bank_mask:0x2
    v_add_f32_dpp v31, v47, v47 row_ror:4 row_mask:0xf bank_mask:0x2
    v_add_f32_dpp v28, v48, v48 row_ror:4 row_mask:0xf bank_mask:0x4
    v_add_f32_dpp v29, v49, v49 row_ror:4 row_mask:0xf bank_mask:0x4
    v_add_f32_dpp v30, v50, v50 row_ror:4 row_mask:0xf bank_mask:0x4
    v_add_f32_dpp v31, v51, v51 row_ror:4 row_mask:0xf bank_mask:0x4
    v_add_f32_dpp v28, v52, v52 row_ror:4 row_mask:0xf bank_mask:0x8
    v_add_f32_dpp v29, v53, v53 row_ror:4 row_mask:0xf bank_mask:0x8
    v_add_f32_dpp v30, v54, v54 row_ror:4 row_mask:0xf bank_mask:0x8
    v_add_f32_dpp v31, v55, v55 row_ror:4 row_mask:0xf bank_mask:0x8
    v_fma_f32 v28, v28, s59, v24
    v_fma_f32 v29, v29, s59, v24
    v_fma_f32 v30, v30, s59, v24
    v_fma_f32 v31, v31, s59, v24
    v_mul_f32 v28, v28, v56
    v_mul_f32 v29, v29, v57
    v_mul_f32 v30, v30, v58
    v_mul_f32 v31, v31, v59
    ds_write_b128 v6, v[28:31]
    s_mov_b64 exec, 1
    ds_add_rtn_u32 v34, v32, v33
    s_mov_b64 exec, -1
    ds_read_b128 v[8:11], v5
    ds_read_b128 v[12:15], v5 offset:1024
    ds_read_b128 v[16:19], v5 offset:2048
    ds_read_b128 v[20:23], v5 offset:3072
    s_waitcnt lgkmcnt(0)
    v_readfirstlane_b32 s62, v34
    s_nop 0
    s_cmp_eq_u32 s62, s15
    s_cbranch_scc1 L_u_last
    s_cmp_eq_u32 s62, 1
    s_cbranch_scc1 L_service
    s_endpgm
L_u_last:
    v_add_f32 v8, v8, v12
    v_add_f32 v9, v9, v13
    v_add_f32 v10, v10, v14
    v_add_f32 v11, v11, v15
    s_cmp_eq_u32 s15, 1
    s_cbranch_scc1 L_u_two
    v_add_f32 v16, v16, v20
    v_add_f32 v17, v17, v21
    v_add_f32 v18, v18, v22
    v_add_f32 v19, v19, v23
    v_add_f32 v8, v8, v16
    v_add_f32 v9, v9, v17
    v_add_f32 v10, v10, v18
    v_add_f32 v11, v11, v19
L_u_two:
    v_cvt_pk_bf16_f32 v8, v8, v9
    v_cvt_pk_bf16_f32 v9, v10, v11
    buffer_store_dwordx2 v[8:9], v64, s[40:43], s57 offen sc1
    s_endpgm
L_touch:
    s_load_dword s0, s[32:33], 0
    s_load_dword s0, s[30:31], 0
    s_cmp_eq_u32 s39, 1
    s_cbranch_scc1 L_tpr
    s_mov_b32 s62, 16777216
    s_load_dword s0, s[8:9], s62
    s_mov_b32 s62, 83886080
    s_load_dword s0, s[8:9], s62
    s_mov_b32 s62, 150994944
    s_load_dword s0, s[8:9], s62
    s_mov_b32 s62, 218103808
    s_load_dword s0, s[8:9], s62
    s_branch L_tpv
L_tpr:
    s_load_dword s0, s[20:21], 0
    s_mov_b32 s62, 2211836
    s_load_dword s0, s[20:21], s62
    s_load_dword s0, s[16:17], 0
    s_mov_b32 s62, 2211836
    s_load_dword s0, s[16:17], s62
    s_load_dword s0, s[18:19], 0
    s_load_dword s0, s[22:23], 0
    s_load_dword s0, s[28:29], 0
    s_load_dword s0, s[4:5], 0
L_tpv:
    s_lshl_b32 s62, s34, 23
    s_load_dword s0, s[8:9], s62
    s_add_u32 s62, s62, 67108864
    s_load_dword s0, s[8:9], s62
    s_add_u32 s62, s62, 67108864
    s_load_dword s0, s[8:9], s62
    s_add_u32 s62, s62, 67108864
    s_load_dword s0, s[8:9], s62
    s_add_u32 s62, s62, 67108864
    s_branch L_notp
L_stream2:
    s_mov_b32 s12, s100
    s_mov_b32 s13, s101
    s_mov_b32 s40, s32
    s_mov_b32 s41, s33
    s_mov_b32 s42, 589824
    s_mov_b32 s43, 0x20000
    s_mov_b32 s44, s30
    s_mov_b32 s45, s31
    s_mov_b32 s46, 256
    s_mov_b32 s47, 0x20000
    s_bitcmp1_b32 s3, 0
    s_mov_b32 s57, 0xffffffff
    s_mov_b32 s58, 0xffff
    s_mov_b32 s14, 0xffffffff
    s_mov_b32 s15, 0x0
L_pm_9:
    s_cmp_lt_u32 s56, 104
    s_cbranch_scc0 L_pm_10
    s_bitcmp1_b32 s3, 0
    s_mov_b32 s57, 0xffff
    s_mov_b32 s58, 0x0
    s_mov_b32 s14, 0xffffffff
    s_mov_b32 s15, 0x0
L_pm_10:
    s_sub_u32 s96, s56, 43
    s_and_b32 s96, s96, 0xffffffc7
    s_cmp_eq_u32 s96, 0
    s_cbranch_scc0 L_pm_11
    s_bitcmp1_b32 s3, 0
    s_mov_b32 s57, 0x0
    s_mov_b32 s58, 0x0
    s_mov_b32 s14, 0x0
    s_mov_b32 s15, 0x0
L_pm_11:
    s_cmp_lt_u32 s56, 40
    s_cbranch_scc0 L_pm_12
    s_bitcmp1_b32 s3, 0
    s_mov_b32 s57, 0xffffffff
    s_mov_b32 s58, 0xf
    s_mov_b32 s14, 0xffffffff
    s_mov_b32 s15, 0x0
L_pm_12:
    s_cmp_eq_u32 s39, 1
    s_cbranch_scc0 L_pm_13
    s_bitcmp1_b32 s3, 0
    s_mov_b32 s57, 0xff0fff
    s_cselect_b32 s57, 0xff00ffff, s57
    s_mov_b32 s58, 0xfff
    s_mov_b32 s14, 0xff00ff
    s_cselect_b32 s14, 0xff00ff00, s14
    s_mov_b32 s15, 0x0
L_pm_13:
    s_cmp_lg_u32 s13, 0
    s_cbranch_scc0 L_pm_14
    s_bitcmp1_b32 s3, 0
    s_mov_b32 s57, 0xff00ff
    s_cselect_b32 s57, 0xff00ff00, s57
    s_mov_b32 s58, 0x0
    s_mov_b32 s14, 0x0
    s_mov_b32 s15, 0x0
L_pm_14:
    s_and_b32 s96, s39, s59
    s_cbranch_scc0 L_pm_15
    s_bitcmp1_b32 s3, 0
    s_mov_b32 s57, 0xffff
    s_mov_b32 s58, 0xffff
    s_mov_b32 s14, 0x0
    s_mov_b32 s15, 0x0
L_pm_15:
    s_add_u32 s52, s8, s63
    s_addc_u32 s53, s9, 0
    s_mov_b32 s54, 262144
    s_mov_b32 s55, 0x20000
    v_and_b32 v2, 15, v0
    v_lshrrev_b32 v3, 1, v2
    v_and_b32 v37, 1, v2
    v_lshlrev_b32 v37, 4, v37
    v_mov_b32 v38, 0xffff
    v_lshlrev_b32 v37, v37, v38
    v_cmp_eq_u32 vcc, 0, v3
    v_mov_b32 v32, 0
    s_nop 0
    v_cndmask_b32 v20, 0, v37, vcc
    v_cmp_eq_u32 vcc, 1, v3
    v_mov_b32 v33, 0
    s_nop 0
    v_cndmask_b32 v21, 0, v37, vcc
    v_cmp_eq_u32 vcc, 2, v3
    v_mov_b32 v34, 0
    s_nop 0
    v_cndmask_b32 v22, 0, v37, vcc
    v_cmp_eq_u32 vcc, 3, v3
    v_mov_b32 v35, 0
    s_nop 0
    v_cndmask_b32 v23, 0, v37, vcc
    v_lshlrev_b32 v2, 4, v2
    s_lshl_b32 s98, s62, 8
    s_add_u32 s98, s98, 40960
    s_lshl_b32 s99, s62, 7
    s_add_u32 s99, s99, 73728
    s_bitcmp0_b32 s57, 2
    s_cbranch_scc1 L_sf_16
    s_bitcmp0_b32 s58, 2
    s_cbranch_scc1 L_sf_16
    s_waitcnt vmcnt(1)
L_sf_16:
    buffer_load_dwordx4 v[48:51], v1, s[48:51], s97 offen offset:2048 nt
    s_bitcmp0_b32 s57, 3
    s_cbranch_scc1 L_sf_17
    s_waitcnt vmcnt(2)
    s_bitcmp0_b32 s58, 3
    s_cbranch_scc1 L_sf_17
    s_waitcnt vmcnt(1)
L_sf_17:
    buffer_load_dwordx4 v[52:55], v1, s[48:51], s97 offen offset:3072 nt
    s_add_u32 s97, s97, 32768
    v_add_u32 v1, 4096, v1
    v_and_b32 v1, 0x7fff, v1
    s_waitcnt vmcnt(3)
    s_bitcmp0_b32 s57, 4
    s_cbranch_scc1 L_sf_18
    s_waitcnt vmcnt(2)
    s_bitcmp0_b32 s58, 4
    s_cbranch_scc1 L_sf_18
    s_waitcnt vmcnt(1)
L_sf_18:
    buffer_load_dwordx4 v[56:59], v1, s[48:51], s97 offen offset:0 nt
    s_waitcnt vmcnt(3)
    s_bitcmp0_b32 s57, 5
    s_cbranch_scc1 L_sf_19
    s_waitcnt vmcnt(2)
    s_bitcmp0_b32 s58, 5
    s_cbranch_scc1 L_sf_19
    s_waitcnt vmcnt(1)
L_sf_19:
    buffer_load_dwordx4 v[60:63], v1, s[48:51], s97 offen offset:1024 nt
    s_waitcnt vmcnt(3)
    s_bitcmp0_b32 s57, 6
    s_cbranch_scc1 L_sf_20
    s_waitcnt vmcnt(2)
    s_bitcmp0_b32 s58, 6
    s_cbranch_scc1 L_sf_20
    s_waitcnt vmcnt(1)
L_sf_20:
    buffer_load_dwordx4 v[64:67], v1, s[48:51], s97 offen offset:2048 nt
    s_waitcnt vmcnt(3)
    s_bitcmp0_b32 s57, 7
    s_cbranch_scc1 L_sf_21
    s_waitcnt vmcnt(2)
    s_bitcmp0_b32 s58, 7
    s_cbranch_scc1 L_sf_21
    s_waitcnt vmcnt(1)
L_sf_21:
    buffer_load_dwordx4 v[68:71], v1, s[48:51], s97 offen offset:3072 nt
    s_add_u32 s97, s97, 32768
    v_add_u32 v1, 4096, v1
    v_and_b32 v1, 0x7fff, v1
    s_waitcnt vmcnt(3)
    s_bitcmp0_b32 s57, 8
    s_cbranch_scc1 L_sf_22
    s_waitcnt vmcnt(2)
    s_bitcmp0_b32 s58, 8
    s_cbranch_scc1 L_sf_22
    s_waitcnt vmcnt(1)
L_sf_22:
    buffer_load_dwordx4 v[72:75], v1, s[48:51], s97 offen offset:0 nt
    s_waitcnt vmcnt(3)
    s_bitcmp0_b32 s57, 9
    s_cbranch_scc1 L_sf_23
    s_waitcnt vmcnt(2)
    s_bitcmp0_b32 s58, 9
    s_cbranch_scc1 L_sf_23
    s_waitcnt vmcnt(1)
L_sf_23:
    buffer_load_dwordx4 v[76:79], v1, s[48:51], s97 offen offset:1024 nt
    s_waitcnt vmcnt(3)
    s_bitcmp0_b32 s57, 10
    s_cbranch_scc1 L_sf_24
    s_waitcnt vmcnt(2)
    s_bitcmp0_b32 s58, 10
    s_cbranch_scc1 L_sf_24
    s_waitcnt vmcnt(1)
L_sf_24:
    buffer_load_dwordx4 v[80:83], v1, s[48:51], s97 offen offset:2048 nt
    s_waitcnt vmcnt(3)
    s_bitcmp0_b32 s57, 11
    s_cbranch_scc1 L_sf_25
    s_waitcnt vmcnt(2)
    s_bitcmp0_b32 s58, 11
    s_cbranch_scc1 L_sf_25
    s_waitcnt vmcnt(1)
L_sf_25:
    buffer_load_dwordx4 v[84:87], v1, s[48:51], s97 offen offset:3072 nt
    s_add_u32 s97, s97, 32768
    v_add_u32 v1, 4096, v1
    v_and_b32 v1, 0x7fff, v1
    s_waitcnt vmcnt(3)
    s_bitcmp0_b32 s57, 12
    s_cbranch_scc1 L_sf_26
    s_waitcnt vmcnt(2)
    s_bitcmp0_b32 s58, 12
    s_cbranch_scc1 L_sf_26
    s_waitcnt vmcnt(1)
L_sf_26:
    buffer_load_dwordx4 v[88:91], v1, s[48:51], s97 offen offset:0 nt
    s_waitcnt vmcnt(3)
    s_bitcmp0_b32 s57, 13
    s_cbranch_scc1 L_sf_27
    s_waitcnt vmcnt(2)
    s_bitcmp0_b32 s58, 13
    s_cbranch_scc1 L_sf_27
    s_waitcnt vmcnt(1)
L_sf_27:
    buffer_load_dwordx4 v[92:95], v1, s[48:51], s97 offen offset:1024 nt
    s_waitcnt vmcnt(3)
    s_bitcmp0_b32 s57, 14
    s_cbranch_scc1 L_sf_28
    s_waitcnt vmcnt(2)
    s_bitcmp0_b32 s58, 14
    s_cbranch_scc1 L_sf_28
    s_waitcnt vmcnt(1)
L_sf_28:
    buffer_load_dwordx4 v[96:99], v1, s[48:51], s97 offen offset:2048 nt
    s_waitcnt vmcnt(3)
    s_bitcmp0_b32 s57, 15
    s_cbranch_scc1 L_sf_29
    s_waitcnt vmcnt(2)
    s_bitcmp0_b32 s58, 15
    s_cbranch_scc1 L_sf_29
    s_waitcnt vmcnt(1)
L_sf_29:
    buffer_load_dwordx4 v[100:103], v1, s[48:51], s97 offen offset:3072 nt
    s_add_u32 s97, s97, 32768
    v_add_u32 v1, 4096, v1
    v_and_b32 v1, 0x7fff, v1
    s_waitcnt vmcnt(3)
    s_bitcmp0_b32 s57, 16
    s_cbranch_scc1 L_sf_30
    s_waitcnt vmcnt(2)
    s_bitcmp0_b32 s58, 16
    s_cbranch_scc1 L_sf_30
    s_waitcnt vmcnt(1)
L_sf_30:
    buffer_load_dwordx4 v[104:107], v1, s[48:51], s97 offen offset:0 nt
    s_waitcnt vmcnt(3)
    s_bitcmp0_b32 s57, 17
    s_cbranch_scc1 L_sf_31
    s_waitcnt vmcnt(2)
    s_bitcmp0_b32 s58, 17
    s_cbranch_scc1 L_sf_31
    s_waitcnt vmcnt(1)
L_sf_31:
    buffer_load_dwordx4 v[108:111], v1, s[48:51], s97 offen offset:1024 nt
    s_waitcnt vmcnt(3)
    s_bitcmp0_b32 s57, 18
    s_cbranch_scc1 L_sf_32
    s_waitcnt vmcnt(2)
    s_bitcmp0_b32 s58, 18
    s_cbranch_scc1 L_sf_32
    s_waitcnt vmcnt(1)
L_sf_32:
    buffer_load_dwordx4 v[112:115], v1, s[48:51], s97 offen offset:2048 nt
    s_waitcnt vmcnt(3)
    s_bitcmp0_b32 s57, 19
    s_cbranch_scc1 L_sf_33
    s_waitcnt vmcnt(2)
    s_bitcmp0_b32 s58, 19
    s_cbranch_scc1 L_sf_33
    s_waitcnt vmcnt(1)
L_sf_33:
    buffer_load_dwordx4 v[116:119], v1, s[48:51], s97 offen offset:3072 nt
    s_add_u32 s97, s97, 32768
    v_add_u32 v1, 4096, v1
    v_and_b32 v1, 0x7fff, v1
    s_waitcnt vmcnt(3)
    s_bitcmp0_b32 s57, 20
    s_cbranch_scc1 L_sf_34
    s_waitcnt vmcnt(2)
    s_bitcmp0_b32 s58, 20
    s_cbranch_scc1 L_sf_34
    s_waitcnt vmcnt(1)
L_sf_34:
    buffer_load_dwordx4 v[120:123], v1, s[48:51], s97 offen offset:0 nt
    s_waitcnt vmcnt(3)
    s_bitcmp0_b32 s57, 21
    s_cbranch_scc1 L_sf_35
    s_waitcnt vmcnt(2)
    s_bitcmp0_b32 s58, 21
    s_cbranch_scc1 L_sf_35
    s_waitcnt vmcnt(1)
L_sf_35:
    buffer_load_dwordx4 v[124:127], v1, s[48:51], s97 offen offset:1024 nt
    s_cmp_eq_u32 s12, -1
    s_cbranch_scc1 L_k_nopf
    s_waitcnt vmcnt(3)
    s_bitcmp0_b32 s57, 22
    s_cbranch_scc1 L_sf_36
    s_waitcnt vmcnt(2)
    s_bitcmp0_b32 s58, 22
    s_cbranch_scc1 L_sf_36
    s_waitcnt vmcnt(1)
L_sf_36:
    buffer_load_dwordx4 v[128:131], v1, s[48:51], s97 offen offset:2048 nt
    s_waitcnt vmcnt(3)
    s_bitcmp0_b32 s57, 23
    s_cbranch_scc1 L_sf_37
    s_waitcnt vmcnt(2)
    s_bitcmp0_b32 s58, 23
    s_cbranch_scc1 L_sf_37
    s_waitcnt vmcnt(1)
L_sf_37:
    buffer_load_dwordx4 v[132:135], v1, s[48:51], s97 offen offset:3072 nt
    s_add_u32 s97, s97, 32768
    v_add_u32 v1, 4096, v1
    v_and_b32 v1, 0x7fff, v1
    s_waitcnt vmcnt(3)
    s_bitcmp0_b32 s57, 24
    s_cbranch_scc1 L_sf_38
    s_waitcnt vmcnt(2)
    s_bitcmp0_b32 s58, 24
    s_cbranch_scc1 L_sf_38
    s_waitcnt vmcnt(1)
L_sf_38:
    buffer_load_dwordx4 v[136:139], v1, s[48:51], s97 offen offset:0 nt
    s_waitcnt vmcnt(3)
    s_bitcmp0_b32 s57, 25
    s_cbranch_scc1 L_sf_39
    s_waitcnt vmcnt(2)
    s_bitcmp0_b32 s58, 25
    s_cbranch_scc1 L_sf_39
    s_waitcnt vmcnt(1)
L_sf_39:
    buffer_load_dwordx4 v[140:143], v1, s[48:51], s97 offen offset:1024 nt
    s_waitcnt vmcnt(3)
    s_bitcmp0_b32 s57, 26
    s_cbranch_scc1 L_sf_40
    s_waitcnt vmcnt(2)
    s_bitcmp0_b32 s58, 26
    s_cbranch_scc1 L_sf_40
    s_waitcnt vmcnt(1)
L_sf_40:
    buffer_load_dwordx4 v[144:147], v1, s[48:51], s97 offen offset:2048 nt
    s_waitcnt vmcnt(3)
    s_bitcmp0_b32 s57, 27
    s_cbranch_scc1 L_sf_41
    s_waitcnt vmcnt(2)
    s_bitcmp0_b32 s58, 27
    s_cbranch_scc1 L_sf_41
    s_waitcnt vmcnt(1)
L_sf_41:
    buffer_load_dwordx4 v[148:151], v1, s[48:51], s97 offen offset:3072 nt
    s_add_u32 s97, s97, 32768
    v_add_u32 v1, 4096, v1
    v_and_b32 v1, 0x7fff, v1
    s_waitcnt vmcnt(3)
    s_bitcmp0_b32 s57, 28
    s_cbranch_scc1 L_sf_42
    s_waitcnt vmcnt(2)
    s_bitcmp0_b32 s58, 28
    s_cbranch_scc1 L_sf_42
    s_waitcnt vmcnt(1)
L_sf_42:
    buffer_load_dwordx4 v[152:155], v1, s[48:51], s97 offen offset:0 nt
    s_waitcnt vmcnt(3)
    s_bitcmp0_b32 s57, 29
    s_cbranch_scc1 L_sf_43
    s_waitcnt vmcnt(2)
    s_bitcmp0_b32 s58, 29
    s_cbranch_scc1 L_sf_43
    s_waitcnt vmcnt(1)
L_sf_43:
    buffer_load_dwordx4 v[156:159], v1, s[48:51], s97 offen offset:1024 nt
    s_waitcnt vmcnt(3)
    s_bitcmp0_b32 s57, 30
    s_cbranch_scc1 L_sf_44
    s_waitcnt vmcnt(2)
    s_bitcmp0_b32 s58, 30
    s_cbranch_scc1 L_sf_44
    s_waitcnt vmcnt(1)
L_sf_44:
    buffer_load_dwordx4 v[160:163], v1, s[48:51], s97 offen offset:2048 nt
    v_and_b32 v39, 31, v0
    v_lshlrev_b32 v39, 2, v39
    buffer_load_dword v37, v39, s[44:47], 0 offen sc1
    s_waitcnt vmcnt(4)
    s_bitcmp0_b32 s57, 31
    s_cbranch_scc1 L_sf_45
    s_waitcnt vmcnt(3)
    s_bitcmp0_b32 s58, 31
    s_cbranch_scc1 L_sf_45
    s_waitcnt vmcnt(2)
L_sf_45:
    buffer_load_dwordx4 v[164:167], v1, s[48:51], s97 offen offset:3072 nt
    s_mov_b32 s97, 0
    v_add_u32 v1, 4096, v1
    v_and_b32 v1, 0x7fff, v1
    s_waitcnt vmcnt(4)
    s_bitcmp0_b32 s14, 0
    s_cbranch_scc1 L_sf_46
    s_waitcnt vmcnt(3)
    s_bitcmp0_b32 s15, 0
    s_cbranch_scc1 L_sf_46
    s_waitcnt vmcnt(2)
L_sf_46:
    s_add_u32 m0, s12, 0
    s_nop 0
    buffer_load_dwordx4 v1, s[52:55], s97 offen offset:0 nt lds
    s_waitcnt vmcnt(4)
    s_bitcmp0_b32 s14, 1
    s_cbranch_scc1 L_sf_47
    s_waitcnt vmcnt(3)
    s_bitcmp0_b32 s15, 1
    s_cbranch_scc1 L_sf_47
    s_waitcnt vmcnt(1)
L_sf_47:
    buffer_load_dwordx4 v1, s[52:55], s97 offen offset:1024 nt lds
    s_waitcnt vmcnt(4)
    s_bitcmp0_b32 s14, 2
    s_cbranch_scc1 L_sf_48
    s_waitcnt vmcnt(2)
    s_bitcmp0_b32 s15, 2
    s_cbranch_scc1 L_sf_48
    s_waitcnt vmcnt(1)
L_sf_48:
    buffer_load_dwordx4 v1, s[52:55], s97 offen offset:2048 nt lds
    s_waitcnt vmcnt(3)
    s_bitcmp0_b32 s14, 3
    s_cbranch_scc1 L_sf_49
    s_waitcnt vmcnt(2)
    s_bitcmp0_b32 s15, 3
    s_cbranch_scc1 L_sf_49
    s_waitcnt vmcnt(1)
L_sf_49:
    buffer_load_dwordx4 v1, s[52:55], s97 offen offset:3072 nt lds
    s_add_u32 s97, s97, 32768
    v_add_u32 v1, 4096, v1
    v_and_b32 v1, 0x7fff, v1
    v_cmp_eq_u32 vcc, 0, v37
    s_nop 0
    s_or_b32 s96, vcc_lo, vcc_hi
    buffer_load_dwordx4 v[4:7], v2, s[40:43], s98 offen sc1
    s_waitcnt vmcnt(4)
    s_bitcmp0_b32 s14, 4
    s_cbranch_scc1 L_sf_50
    s_waitcnt vmcnt(3)
    s_bitcmp0_b32 s15, 4
    s_cbranch_scc1 L_sf_50
    s_waitcnt vmcnt(2)
L_sf_50:
    s_add_u32 m0, s12, 4096
    s_nop 0
    buffer_load_dwordx4 v1, s[52:55], s97 offen offset:0 nt lds
    s_waitcnt vmcnt(4)
    s_bitcmp0_b32 s14, 5
    s_cbranch_scc1 L_sf_51
    s_waitcnt vmcnt(3)
    s_bitcmp0_b32 s15, 5
    s_cbranch_scc1 L_sf_51
    s_waitcnt vmcnt(2)
L_sf_51:
    buffer_load_dwordx4 v1, s[52:55], s97 offen offset:1024 nt lds
    s_waitcnt vmcnt(4)
    s_bitcmp0_b32 s14, 6
    s_cbranch_scc1 L_sf_52
    s_waitcnt vmcnt(3)
    s_bitcmp0_b32 s15, 6
    s_cbranch_scc1 L_sf_52
    s_waitcnt vmcnt(1)
L_sf_52:
    buffer_load_dwordx4 v1, s[52:55], s97 offen offset:2048 nt lds
    s_waitcnt vmcnt(4)
    s_bitcmp0_b32 s14, 7
    s_cbranch_scc1 L_sf_53
    s_waitcnt vmcnt(2)
    s_bitcmp0_b32 s15, 7
    s_cbranch_scc1 L_sf_53
    s_waitcnt vmcnt(1)
L_sf_53:
    buffer_load_dwordx4 v1, s[52:55], s97 offen offset:3072 nt lds
    s_add_u32 s97, s97, 32768
    v_add_u32 v1, 4096, v1
    v_and_b32 v1, 0x7fff, v1
L_k_join:
    s_waitcnt vmcnt(4)
    v_max3_u32 v38, v4, v5, v6
    v_max_u32 v38, v38, v7
    v_cmp_eq_u32 vcc, -1, v38
    s_cmp_lg_u32 s96, 0
    s_cbranch_scc1 L_qslow
    s_cbranch_vccnz L_qslow2
L_qok:
    v_dot2_f32_bf16 v8, v72, v4, 0
    v_dot2_f32_bf16 v9, v76, v4, 0
    v_dot2_f32_bf16 v10, v80, v4, 0
    v_dot2_f32_bf16 v11, v84, v4, 0
    v_dot2_f32_bf16 v24, v88, v4, 0
    v_dot2_f32_bf16 v25, v92, v4, 0
    v_dot2_f32_bf16 v26, v96, v4, 0
    v_dot2_f32_bf16 v27, v100, v4, 0
    v_dot2_f32_bf16 v8, v73, v5, v8
    v_dot2_f32_bf16 v9, v77, v5, v9
    v_dot2_f32_bf16 v10, v81, v5, v10
    v_dot2_f32_bf16 v11, v85, v5, v11
    v_dot2_f32_bf16 v24, v89, v5, v24
    v_dot2_f32_bf16 v25, v93, v5, v25
    v_dot2_f32_bf16 v26, v97, v5, v26
    v_dot2_f32_bf16 v27, v101, v5, v27
    v_dot2_f32_bf16 v8, v74, v6, v8
    v_dot2_f32_bf16 v9, v78, v6, v9
    v_dot2_f32_bf16 v10, v82, v6, v10
    v_dot2_f32_bf16 v11, v86, v6, v11
    v_dot2_f32_bf16 v24, v90, v6, v24
    v_dot2_f32_bf16 v25, v94, v6, v25
    v_dot2_f32_bf16 v26, v98, v6, v26
    v_dot2_f32_bf16 v27, v102, v6, v27
    v_dot2_f32_bf16 v8, v75, v7, v8
    v_dot2_f32_bf16 v9, v79, v7, v9
    v_dot2_f32_bf16 v10, v83, v7, v10
    v_dot2_f32_bf16 v11, v87, v7, v11
    v_dot2_f32_bf16 v24, v91, v7, v24
    v_dot2_f32_bf16 v25, v95, v7, v25
    v_dot2_f32_bf16 v26, v99, v7, v26
    v_dot2_f32_bf16 v27, v103, v7, v27
    v_add_f32_dpp v8, v8, v8 row_ror:8 row_mask:0xf bank_mask:0x3
    v_add_f32_dpp v10, v10, v10 row_ror:8 row_mask:0xf bank_mask:0x3
    v_add_f32_dpp v24, v24, v24 row_ror:8 row_mask:0xf bank_mask:0x3
    v_add_f32_dpp v26, v26, v26 row_ror:8 row_mask:0xf bank_mask:0x3
    v_add_f32_dpp v8, v9, v9 row_ror:8 row_mask:0xf bank_mask:0xc
    v_add_f32_dpp v10, v11, v11 row_ror:8 row_mask:0xf bank_mask:0xc
    v_add_f32_dpp v24, v25, v25 row_ror:8 row_mask:0xf bank_mask:0xc
    v_add_f32_dpp v26, v27, v27 row_ror:8 row_mask:0xf bank_mask:0xc
    v_add_f32_dpp v14, v8, v8 row_half_mirror row_mask:0xf bank_mask:0x5
    v_add_f32_dpp v15, v24, v24 row_half_mirror row_mask:0xf bank_mask:0x5
    v_add_f32_dpp v14, v10, v10 row_half_mirror row_mask:0xf bank_mask:0xa
    v_add_f32_dpp v15, v26, v26 row_half_mirror row_mask:0xf bank_mask:0xa
    s_nop 0
    v_add_f32_dpp v14, v14, v14 quad_perm:[1,0,3,2] row_mask:0xf bank_mask:0xf
    v_add_f32_dpp v15, v15, v15 quad_perm:[1,0,3,2] row_mask:0xf bank_mask:0xf
    s_nop 0
    v_add_f32_dpp v14, v14, v14 quad_perm:[2,3,0,1] row_mask:0xf bank_mask:0xf
    v_add_f32_dpp v15, v15, v15 quad_perm:[2,3,0,1] row_mask:0xf bank_mask:0xf
    s_waitcnt vmcnt(3)
    s_bitcmp0_b32 s14, 8
    s_cbranch_scc1 L_sf_64
    s_waitcnt vmcnt(2)
    s_bitcmp0_b32 s15, 8
    s_cbranch_scc1 L_sf_64
    s_waitcnt vmcnt(1)
L_sf_64:
    buffer_load_dwordx4 v[72:75], v1, s[52:55], s97 offen offset:0 nt
    v_dot2_f32_bf16 v8, v40, v4, 0
    v_dot2_f32_bf16 v9, v44, v4, 0
    v_dot2_f32_bf16 v10, v48, v4, 0
    v_dot2_f32_bf16 v11, v52, v4, 0
    v_dot2_f32_bf16 v24, v56, v4, 0
    v_dot2_f32_bf16 v25, v60, v4, 0
    v_dot2_f32_bf16 v26, v64, v4, 0
    v_dot2_f32_bf16 v27, v68, v4, 0
    v_dot2_f32_bf16 v28, v104, v4, 0
    v_dot2_f32_bf16 v29, v108, v4, 0
    v_dot2_f32_bf16 v30, v112, v4, 0
    v_dot2_f32_bf16 v31, v116, v4, 0
    v_dot2_f32_bf16 v8, v41, v5, v8
    v_dot2_f32_bf16 v9, v45, v5, v9
    v_dot2_f32_bf16 v10, v49, v5, v10
    v_dot2_f32_bf16 v11, v53, v5, v11
    v_dot2_f32_bf16 v24, v57, v5, v24
    v_dot2_f32_bf16 v25, v61, v5, v25
    v_dot2_f32_bf16 v26, v65, v5, v26
    v_dot2_f32_bf16 v27, v69, v5, v27
    v_dot2_f32_bf16 v28, v105, v5, v28
    v_dot2_f32_bf16 v29, v109, v5, v29
    v_dot2_f32_bf16 v30, v113, v5, v30
    v_dot2_f32_bf16 v31, v117, v5, v31
    v_dot2_f32_bf16 v8, v42, v6, v8
    v_dot2_f32_bf16 v9, v46, v6, v9
    v_dot2_f32_bf16 v10, v50, v6, v10
    v_dot2_f32_bf16 v11, v54, v6, v11
    v_dot2_f32_bf16 v24, v58, v6, v24
    v_dot2_f32_bf16 v25, v62, v6, v25
    v_dot2_f32_bf16 v26, v66, v6, v26
    v_dot2_f32_bf16 v27, v70, v6, v27
    v_dot2_f32_bf16 v28, v106, v6, v28
    v_dot2_f32_bf16 v29, v110, v6, v29
    v_dot2_f32_bf16 v30, v114, v6, v30
    v_dot2_f32_bf16 v31, v118, v6, v31
    v_dot2_f32_bf16 v8, v43, v7, v8
    v_dot2_f32_bf16 v9, v47, v7, v9
    v_dot2_f32_bf16 v10, v51, v7, v10
    v_dot2_f32_bf16 v11, v55, v7, v11
    v_dot2_f32_bf16 v24, v59, v7, v24
    v_dot2_f32_bf16 v25, v63, v7, v25
    v_dot2_f32_bf16 v26, v67, v7, v26
    v_dot2_f32_bf16 v27, v71, v7, v27
    v_dot2_f32_bf16 v28, v107, v7, v28
    v_dot2_f32_bf16 v29, v111, v7, v29
    v_dot2_f32_bf16 v30, v115, v7, v30
    v_dot2_f32_bf16 v31, v119, v7, v31
    v_add_f32_dpp v8, v8, v8 row_ror:8 row_mask:0xf bank_mask:0x3
    v_add_f32_dpp v10, v10, v10 row_ror:8 row_mask:0xf bank_mask:0x3
    v_add_f32_dpp v24, v24, v24 row_ror:8 row_mask:0xf bank_mask:0x3
    v_add_f32_dpp v26, v26, v26 row_ror:8 row_mask:0xf bank_mask:0x3
    v_add_f32_dpp v28, v28, v28 row_ror:8 row_mask:0xf bank_mask:0x3
    v_add_f32_dpp v30, v30, v30 row_ror:8 row_mask:0xf bank_mask:0x3
    v_add_f32_dpp v8, v9, v9 row_ror:8 row_mask:0xf bank_mask:0xc
    v_add_f32_dpp v10, v11, v11 row_ror:8 row_mask:0xf bank_mask:0xc
    v_add_f32_dpp v24, v25, v25 row_ror:8 row_mask:0xf bank_mask:0xc
    v_add_f32_dpp v26, v27, v27 row_ror:8 row_mask:0xf bank_mask:0xc
    v_add_f32_dpp v28, v29, v29 row_ror:8 row_mask:0xf bank_mask:0xc
    v_add_f32_dpp v30, v31, v31 row_ror:8 row_mask:0xf bank_mask:0xc
    v_add_f32_dpp v12, v8, v8 row_half_mirror row_mask:0xf bank_mask:0x5
    v_add_f32_dpp v13, v24, v24 row_half_mirror row_mask:0xf bank_mask:0x5
    v_add_f32_dpp v16, v28, v28 row_half_mirror row_mask:0xf bank_mask:0x5
    v_add_f32_dpp v12, v10, v10 row_half_mirror row_mask:0xf bank_mask:0xa
    v_add_f32_dpp v13, v26, v26 row_half_mirror row_mask:0xf bank_mask:0xa
    v_add_f32_dpp v16, v30, v30 row_half_mirror row_mask:0xf bank_mask:0xa
    v_add_f32_dpp v12, v12, v12 quad_perm:[1,0,3,2] row_mask:0xf bank_mask:0xf
    v_add_f32_dpp v13, v13, v13 quad_perm:[1,0,3,2] row_mask:0xf bank_mask:0xf
    v_add_f32_dpp v16, v16, v16 quad_perm:[1,0,3,2] row_mask:0xf bank_mask:0xf
    v_add_f32_dpp v12, v12, v12 quad_perm:[2,3,0,1] row_mask:0xf bank_mask:0xf
    v_add_f32_dpp v13, v13, v13 quad_perm:[2,3,0,1] row_mask:0xf bank_mask:0xf
    v_add_f32_dpp v16, v16, v16 quad_perm:[2,3,0,1] row_mask:0xf bank_mask:0xf
    s_waitcnt vmcnt(3)
    s_bitcmp0_b32 s14, 9
    s_cbranch_scc1 L_sf_65
    s_waitcnt vmcnt(2)
    s_bitcmp0_b32 s15, 9
    s_cbranch_scc1 L_sf_65
    s_waitcnt vmcnt(1)
L_sf_65:
    buffer_load_dwordx4 v[76:79], v1, s[52:55], s97 offen offset:1024 nt
    v_dot2_f32_bf16 v8, v120, v4, 0
    v_dot2_f32_bf16 v9, v124, v4, 0
    v_dot2_f32_bf16 v10, v128, v4, 0
    v_dot2_f32_bf16 v11, v132, v4, 0
    v_dot2_f32_bf16 v24, v136, v4, 0
    v_dot2_f32_bf16 v25, v140, v4, 0
    v_dot2_f32_bf16 v26, v144, v4, 0
    v_dot2_f32_bf16 v27, v148, v4, 0
    v_dot2_f32_bf16 v8, v121, v5, v8
    v_dot2_f32_bf16 v9, v125, v5, v9
    v_dot2_f32_bf16 v10, v129, v5, v10
    v_dot2_f32_bf16 v11, v133, v5, v11
    v_dot2_f32_bf16 v24, v137, v5, v24
    v_dot2_f32_bf16 v25, v141, v5, v25
    v_dot2_f32_bf16 v26, v145, v5, v26
    v_dot2_f32_bf16 v27, v149, v5, v27
    v_dot2_f32_bf16 v8, v122, v6, v8
    v_dot2_f32_bf16 v9, v126, v6, v9
    v_dot2_f32_bf16 v10, v130, v6, v10
    v_dot2_f32_bf16 v11, v134, v6, v11
    v_dot2_f32_bf16 v24, v138, v6, v24
    v_dot2_f32_bf16 v25, v142, v6, v25
    v_dot2_f32_bf16 v26, v146, v6, v26
    v_dot2_f32_bf16 v27, v150, v6, v27
    v_dot2_f32_bf16 v8, v123, v7, v8
    v_dot2_f32_bf16 v9, v127, v7, v9
    v_dot2_f32_bf16 v10, v131, v7, v10
    v_dot2_f32_bf16 v11, v135, v7, v11
    v_dot2_f32_bf16 v24, v139, v7, v24
    v_dot2_f32_bf16 v25, v143, v7, v25
    v_dot2_f32_bf16 v26, v147, v7, v26
    v_dot2_f32_bf16 v27, v151, v7, v27
    v_add_f32_dpp v8, v8, v8 row_ror:8 row_mask:0xf bank_mask:0x3
    v_add_f32_dpp v10, v10, v10 row_ror:8 row_mask:0xf bank_mask:0x3
    v_add_f32_dpp v24, v24, v24 row_ror:8 row_mask:0xf bank_mask:0x3
    v_add_f32_dpp v26, v26, v26 row_ror:8 row_mask:0xf bank_mask:0x3
    v_add_f32_dpp v8, v9, v9 row_ror:8 row_mask:0xf bank_mask:0xc
    v_add_f32_dpp v10, v11, v11 row_ror:8 row_mask:0xf bank_mask:0xc
    v_add_f32_dpp v24, v25, v25 row_ror:8 row_mask:0xf bank_mask:0xc
    v_add_f32_dpp v26, v27, v27 row_ror:8 row_mask:0xf bank_mask:0xc
    v_add_f32_dpp v17, v8, v8 row_half_mirror row_mask:0xf bank_mask:0x5
    v_add_f32_dpp v18, v24, v24 row_half_mirror row_mask:0xf bank_mask:0x5
    v_add_f32_dpp v17, v10, v10 row_half_mirror row_mask:0xf bank_mask:0xa
    v_add_f32_dpp v18, v26, v26 row_half_mirror row_mask:0xf bank_mask:0xa
    s_nop 0
    v_add_f32_dpp v17, v17, v17 quad_perm:[1,0,3,2] row_mask:0xf bank_mask:0xf
    v_add_f32_dpp v18, v18, v18 quad_perm:[1,0,3,2] row_mask:0xf bank_mask:0xf
    s_nop 0
    v_add_f32_dpp v17, v17, v17 quad_perm:[2,3,0,1] row_mask:0xf bank_mask:0xf
    v_add_f32_dpp v18, v18, v18 quad_perm:[2,3,0,1] row_mask:0xf bank_mask:0xf
    s_waitcnt vmcnt(3)
    s_bitcmp0_b32 s14, 10
    s_cbranch_scc1 L_sf_66
    s_waitcnt vmcnt(2)
    s_bitcmp0_b32 s15, 10
    s_cbranch_scc1 L_sf_66
    s_waitcnt vmcnt(1)
L_sf_66:
    buffer_load_dwordx4 v[80:83], v1, s[52:55], s97 offen offset:2048 nt
    s_waitcnt vmcnt(3)
    s_bitcmp0_b32 s14, 11
    s_cbranch_scc1 L_sf_67
    s_waitcnt vmcnt(2)
    s_bitcmp0_b32 s15, 11
    s_cbranch_scc1 L_sf_67
    s_waitcnt vmcnt(1)
L_sf_67:
    buffer_load_dwordx4 v[84:87], v1, s[52:55], s97 offen offset:3072 nt
    s_add_u32 s97, s97, 32768
    v_add_u32 v1, 4096, v1
    v_and_b32 v1, 0x7fff, v1
    s_cmp_eq_u32 s12, -1
    s_cbranch_scc1 L_nopfrd
    v_lshl_add_u32 v38, v0, 4, s12
    ds_read_b128 v[40:43], v38 offset:0
    ds_read_b128 v[44:47], v38 offset:1024
    ds_read_b128 v[48:51], v38 offset:2048
    ds_read_b128 v[52:55], v38 offset:3072
    ds_read_b128 v[56:59], v38 offset:4096
    ds_read_b128 v[60:63], v38 offset:5120
    ds_read_b128 v[64:67], v38 offset:6144
    ds_read_b128 v[68:71], v38 offset:7168
L_nopfrd:
    v_dot2_f32_bf16 v8, v152, v4, 0
    v_dot2_f32_bf16 v9, v156, v4, 0
    v_dot2_f32_bf16 v10, v160, v4, 0
    v_dot2_f32_bf16 v11, v164, v4, 0
    v_dot2_f32_bf16 v8, v153, v5, v8
    v_dot2_f32_bf16 v9, v157, v5, v9
    v_dot2_f32_bf16 v10, v161, v5, v10
    v_dot2_f32_bf16 v11, v165, v5, v11
    v_dot2_f32_bf16 v8, v154, v6, v8
    v_dot2_f32_bf16 v9, v158, v6, v9
    v_dot2_f32_bf16 v10, v162, v6, v10
    v_dot2_f32_bf16 v11, v166, v6, v11
    v_dot2_f32_bf16 v8, v155, v7, v8
    v_dot2_f32_bf16 v9, v159, v7, v9
    v_dot2_f32_bf16 v10, v163, v7, v10
    v_dot2_f32_bf16 v11, v167, v7, v11
    v_add_f32_dpp v8, v8, v8 row_ror:8 row_mask:0xf bank_mask:0x3
    s_nop 0
    v_add_f32_dpp v10, v10, v10 row_ror:8 row_mask:0xf bank_mask:0x3
    v_add_f32_dpp v8, v9, v9 row_ror:8 row_mask:0xf bank_mask:0xc
    v_add_f32_dpp v10, v11, v11 row_ror:8 row_mask:0xf bank_mask:0xc
    s_nop 0
    v_add_f32_dpp v19, v8, v8 row_half_mirror row_mask:0xf bank_mask:0x5
    v_add_f32_dpp v19, v10, v10 row_half_mirror row_mask:0xf bank_mask:0xa
    s_nop 1
    v_add_f32_dpp v19, v19, v19 quad_perm:[1,0,3,2] row_mask:0xf bank_mask:0xf
    s_nop 1
    v_add_f32_dpp v19, v19, v19 quad_perm:[2,3,0,1] row_mask:0xf bank_mask:0xf
    v_max3_f32 v3, v12, v13, v14
    v_max3_f32 v8, v15, v16, v17
    v_max3_f32 v3, v3, v18, v19
    v_max_f32 v3, v3, v8
    s_nop 1
    v_max_f32_dpp v3, v3, v3 row_ror:4 row_mask:0xf bank_mask:0xf
    s_nop 1
    v_max_f32_dpp v3, v3, v3 row_ror:8 row_mask:0xf bank_mask:0xf
    v_mov_b32 v8, v3
    s_nop 1
    v_permlane16_swap_b32 v3, v8
    v_max_f32 v3, v3, v8
    v_mov_b32 v8, v3
    s_nop 1
    v_permlane32_swap_b32 v3, v8
    v_max_f32 v3, v3, v8
    s_mov_b32 s96, 0x3e0293ee
    v_mul_f32 v8, s96, v3
    v_fma_f32 v12, v12, s96, -v8
    v_fma_f32 v13, v13, s96, -v8
    v_fma_f32 v14, v14, s96, -v8
    v_fma_f32 v15, v15, s96, -v8
    v_fma_f32 v16, v16, s96, -v8
    v_fma_f32 v17, v17, s96, -v8
    v_fma_f32 v18, v18, s96, -v8
    v_fma_f32 v19, v19, s96, -v8
    v_exp_f32 v12, v12
    v_exp_f32 v13, v13
    v_exp_f32 v14, v14
    v_exp_f32 v15, v15
    v_exp_f32 v16, v16
    v_exp_f32 v17, v17
    v_exp_f32 v18, v18
    v_exp_f32 v19, v19
    v_add_f32 v9, v12, v13
    v_add_f32 v10, v14, v15
    v_add_f32 v11, v16, v17
    v_add_f32 v3, v18, v19
    v_add_f32 v9, v9, v10
    v_add_f32 v3, v3, v11
    v_add_f32 v9, v9, v3
    v_cvt_pk_bf16_f32 v12, v12, v12
    v_cvt_pk_bf16_f32 v13, v13, v13
    v_cvt_pk_bf16_f32 v14, v14, v14
    v_cvt_pk_bf16_f32 v15, v15, v15
    v_cvt_pk_bf16_f32 v16, v16, v16
    v_cvt_pk_bf16_f32 v17, v17, v17
    v_cvt_pk_bf16_f32 v18, v18, v18
    v_cvt_pk_bf16_f32 v19, v19, v19
    v_add_f32_dpp v9, v9, v9 row_ror:4 row_mask:0xf bank_mask:0xf
    s_nop 1
    v_add_f32_dpp v9, v9, v9 row_ror:8 row_mask:0xf bank_mask:0xf
    v_mov_b32 v10, v9
    s_nop 1
    v_permlane16_swap_b32 v9, v10
    v_add_f32 v9, v9, v10
    v_mov_b32 v10, v9
    s_nop 1
    v_permlane32_swap_b32 v9, v10
    v_add_f32 v9, v9, v10
    s_mov_b64 exec, 1
    s_cmp_lg_u32 s13, 0
    s_cbranch_scc1 L_mljob
    s_lshl_b32 s96, s3, 3
    s_add_u32 s96, s96, 161920
    v_mov_b32 v10, s96
    v_mov_b32 v11, 162068
    v_mov_b32 v3, 1
    ds_write_b64 v10, v[8:9]
    ds_add_u32 v11, v3
L_mldone:
    s_mov_b64 exec, -1
    v_lshrrev_b32 v2, 1, v2
    v_and_b32_dpp v24, v14, v20 row_newbcast:0 row_mask:0xf bank_mask:0xf
    v_and_b32_dpp v25, v14, v21 row_newbcast:0 row_mask:0xf bank_mask:0xf
    v_and_b32_dpp v26, v14, v22 row_newbcast:0 row_mask:0xf bank_mask:0xf
    v_and_b32_dpp v27, v14, v23 row_newbcast:0 row_mask:0xf bank_mask:0xf
    s_waitcnt vmcnt(3)
    s_bitcmp0_b32 s14, 12
    s_cbranch_scc1 L_sf_68
    s_waitcnt vmcnt(2)
    s_bitcmp0_b32 s15, 12
    s_cbranch_scc1 L_sf_68
    s_waitcnt vmcnt(1)
L_sf_68:
    buffer_load_dwordx4 v[88:91], v1, s[52:55], s97 offen offset:0 nt
    v_mfma_f32_16x16x32_bf16 v[32:35], v[24:27], v[72:75], v[32:35]
    s_cmp_eq_u32 s12, -1
    s_cbranch_scc1 L_nopfpv8
    s_waitcnt lgkmcnt(0)
    v_and_b32_dpp v24, v12, v20 row_newbcast:0 row_mask:0xf bank_mask:0xf
    v_and_b32_dpp v25, v12, v21 row_newbcast:0 row_mask:0xf bank_mask:0xf
    v_and_b32_dpp v26, v12, v22 row_newbcast:0 row_mask:0xf bank_mask:0xf
    v_and_b32_dpp v27, v12, v23 row_newbcast:0 row_mask:0xf bank_mask:0xf
    s_nop 1
    v_mfma_f32_16x16x32_bf16 v[32:35], v[24:27], v[40:43], v[32:35]
    v_and_b32_dpp v28, v12, v20 row_newbcast:8 row_mask:0xf bank_mask:0xf
    v_and_b32_dpp v29, v12, v21 row_newbcast:8 row_mask:0xf bank_mask:0xf
    v_and_b32_dpp v30, v12, v22 row_newbcast:8 row_mask:0xf bank_mask:0xf
    v_and_b32_dpp v31, v12, v23 row_newbcast:8 row_mask:0xf bank_mask:0xf
    s_nop 1
    v_mfma_f32_16x16x32_bf16 v[32:35], v[28:31], v[44:47], v[32:35]
    v_and_b32_dpp v24, v12, v20 row_newbcast:4 row_mask:0xf bank_mask:0xf
    v_and_b32_dpp v25, v12, v21 row_newbcast:4 row_mask:0xf bank_mask:0xf
    v_and_b32_dpp v26, v12, v22 row_newbcast:4 row_mask:0xf bank_mask:0xf
    v_and_b32_dpp v27, v12, v23 row_newbcast:4 row_mask:0xf bank_mask:0xf
    s_nop 1
    v_mfma_f32_16x16x32_bf16 v[32:35], v[24:27], v[48:51], v[32:35]
    v_and_b32_dpp v28, v12, v20 row_newbcast:12 row_mask:0xf bank_mask:0xf
    v_and_b32_dpp v29, v12, v21 row_newbcast:12 row_mask:0xf bank_mask:0xf
    v_and_b32_dpp v30, v12, v22 row_newbcast:12 row_mask:0xf bank_mask:0xf
    v_and_b32_dpp v31, v12, v23 row_newbcast:12 row_mask:0xf bank_mask:0xf
    s_nop 1
    v_mfma_f32_16x16x32_bf16 v[32:35], v[28:31], v[52:55], v[32:35]
L_nopfpv8:
    v_and_b32_dpp v28, v14, v20 row_newbcast:8 row_mask:0xf bank_mask:0xf
    v_and_b32_dpp v29, v14, v21 row_newbcast:8 row_mask:0xf bank_mask:0xf
    v_and_b32_dpp v30, v14, v22 row_newbcast:8 row_mask:0xf bank_mask:0xf
    v_and_b32_dpp v31, v14, v23 row_newbcast:8 row_mask:0xf bank_mask:0xf
    s_waitcnt vmcnt(3)
    s_bitcmp0_b32 s14, 13
    s_cbranch_scc1 L_sf_69
    s_waitcnt vmcnt(2)
    s_bitcmp0_b32 s15, 13
    s_cbranch_scc1 L_sf_69
    s_waitcnt vmcnt(1)
L_sf_69:
    buffer_load_dwordx4 v[92:95], v1, s[52:55], s97 offen offset:1024 nt
    v_mfma_f32_16x16x32_bf16 v[32:35], v[28:31], v[76:79], v[32:35]
    s_cmp_eq_u32 s12, -1
    s_cbranch_scc1 L_nopfpv9
    s_waitcnt lgkmcnt(0)
    v_and_b32_dpp v24, v13, v20 row_newbcast:0 row_mask:0xf bank_mask:0xf
    v_and_b32_dpp v25, v13, v21 row_newbcast:0 row_mask:0xf bank_mask:0xf
    v_and_b32_dpp v26, v13, v22 row_newbcast:0 row_mask:0xf bank_mask:0xf
    v_and_b32_dpp v27, v13, v23 row_newbcast:0 row_mask:0xf bank_mask:0xf
    s_nop 1
    v_mfma_f32_16x16x32_bf16 v[32:35], v[24:27], v[56:59], v[32:35]
    v_and_b32_dpp v28, v13, v20 row_newbcast:8 row_mask:0xf bank_mask:0xf
    v_and_b32_dpp v29, v13, v21 row_newbcast:8 row_mask:0xf bank_mask:0xf
    v_and_b32_dpp v30, v13, v22 row_newbcast:8 row_mask:0xf bank_mask:0xf
    v_and_b32_dpp v31, v13, v23 row_newbcast:8 row_mask:0xf bank_mask:0xf
    s_nop 1
    v_mfma_f32_16x16x32_bf16 v[32:35], v[28:31], v[60:63], v[32:35]
    v_and_b32_dpp v24, v13, v20 row_newbcast:4 row_mask:0xf bank_mask:0xf
    v_and_b32_dpp v25, v13, v21 row_newbcast:4 row_mask:0xf bank_mask:0xf
    v_and_b32_dpp v26, v13, v22 row_newbcast:4 row_mask:0xf bank_mask:0xf
    v_and_b32_dpp v27, v13, v23 row_newbcast:4 row_mask:0xf bank_mask:0xf
    s_nop 1
    v_mfma_f32_16x16x32_bf16 v[32:35], v[24:27], v[64:67], v[32:35]
    v_and_b32_dpp v28, v13, v20 row_newbcast:12 row_mask:0xf bank_mask:0xf
    v_and_b32_dpp v29, v13, v21 row_newbcast:12 row_mask:0xf bank_mask:0xf
    v_and_b32_dpp v30, v13, v22 row_newbcast:12 row_mask:0xf bank_mask:0xf
    v_and_b32_dpp v31, v13, v23 row_newbcast:12 row_mask:0xf bank_mask:0xf
    s_nop 1
    v_mfma_f32_16x16x32_bf16 v[32:35], v[28:31], v[68:71], v[32:35]
L_nopfpv9:
    v_and_b32_dpp v24, v14, v20 row_newbcast:4 row_mask:0xf bank_mask:0xf
    v_and_b32_dpp v25, v14, v21 row_newbcast:4 row_mask:0xf bank_mask:0xf
    v_and_b32_dpp v26, v14, v22 row_newbcast:4 row_mask:0xf bank_mask:0xf
    v_and_b32_dpp v27, v14, v23 row_newbcast:4 row_mask:0xf bank_mask:0xf
    s_waitcnt vmcnt(3)
    s_bitcmp0_b32 s14, 14
    s_cbranch_scc1 L_sf_70
    s_waitcnt vmcnt(2)
    s_bitcmp0_b32 s15, 14
    s_cbranch_scc1 L_sf_70
    s_waitcnt vmcnt(1)
L_sf_70:
    buffer_load_dwordx4 v[96:99], v1, s[52:55], s97 offen offset:2048 nt
    v_mfma_f32_16x16x32_bf16 v[32:35], v[24:27], v[80:83], v[32:35]
    v_and_b32_dpp v28, v14, v20 row_newbcast:12 row_mask:0xf bank_mask:0xf
    v_and_b32_dpp v29, v14, v21 row_newbcast:12 row_mask:0xf bank_mask:0xf
    v_and_b32_dpp v30, v14, v22 row_newbcast:12 row_mask:0xf bank_mask:0xf
    v_and_b32_dpp v31, v14, v23 row_newbcast:12 row_mask:0xf bank_mask:0xf
    s_waitcnt vmcnt(3)
    s_bitcmp0_b32 s14, 15
    s_cbranch_scc1 L_sf_71
    s_waitcnt vmcnt(2)
    s_bitcmp0_b32 s15, 15
    s_cbranch_scc1 L_sf_71
    s_waitcnt vmcnt(1)
L_sf_71:
    buffer_load_dwordx4 v[100:103], v1, s[52:55], s97 offen offset:3072 nt
    s_add_u32 s97, s97, 32768
    v_add_u32 v1, 4096, v1
    v_and_b32 v1, 0x7fff, v1
    v_mfma_f32_16x16x32_bf16 v[32:35], v[28:31], v[84:87], v[32:35]
    v_and_b32_dpp v24, v15, v20 row_newbcast:0 row_mask:0xf bank_mask:0xf
    v_and_b32_dpp v25, v15, v21 row_newbcast:0 row_mask:0xf bank_mask:0xf
    v_and_b32_dpp v26, v15, v22 row_newbcast:0 row_mask:0xf bank_mask:0xf
    v_and_b32_dpp v27, v15, v23 row_newbcast:0 row_mask:0xf bank_mask:0xf
    s_waitcnt vmcnt(3)
    s_bitcmp0_b32 s14, 16
    s_cbranch_scc1 L_sf_72
    s_waitcnt vmcnt(2)
    s_bitcmp0_b32 s15, 16
    s_cbranch_scc1 L_sf_72
    s_waitcnt vmcnt(1)
L_sf_72:
    buffer_load_dwordx4 v[104:107], v1, s[52:55], s97 offen offset:0 nt
    v_mfma_f32_16x16x32_bf16 v[32:35], v[24:27], v[88:91], v[32:35]
    v_and_b32_dpp v28, v15, v20 row_newbcast:8 row_mask:0xf bank_mask:0xf
    v_and_b32_dpp v29, v15, v21 row_newbcast:8 row_mask:0xf bank_mask:0xf
    v_and_b32_dpp v30, v15, v22 row_newbcast:8 row_mask:0xf bank_mask:0xf
    v_and_b32_dpp v31, v15, v23 row_newbcast:8 row_mask:0xf bank_mask:0xf
    s_waitcnt vmcnt(3)
    s_bitcmp0_b32 s14, 17
    s_cbranch_scc1 L_sf_73
    s_waitcnt vmcnt(2)
    s_bitcmp0_b32 s15, 17
    s_cbranch_scc1 L_sf_73
    s_waitcnt vmcnt(1)
L_sf_73:
    buffer_load_dwordx4 v[108:111], v1, s[52:55], s97 offen offset:1024 nt
    v_mfma_f32_16x16x32_bf16 v[32:35], v[28:31], v[92:95], v[32:35]
    v_and_b32_dpp v24, v15, v20 row_newbcast:4 row_mask:0xf bank_mask:0xf
    v_and_b32_dpp v25, v15, v21 row_newbcast:4 row_mask:0xf bank_mask:0xf
    v_and_b32_dpp v26, v15, v22 row_newbcast:4 row_mask:0xf bank_mask:0xf
    v_and_b32_dpp v27, v15, v23 row_newbcast:4 row_mask:0xf bank_mask:0xf
    s_waitcnt vmcnt(3)
    s_bitcmp0_b32 s14, 18
    s_cbranch_scc1 L_sf_74
    s_waitcnt vmcnt(2)
    s_bitcmp0_b32 s15, 18
    s_cbranch_scc1 L_sf_74
    s_waitcnt vmcnt(1)
L_sf_74:
    buffer_load_dwordx4 v[112:115], v1, s[52:55], s97 offen offset:2048 nt
    v_mfma_f32_16x16x32_bf16 v[32:35], v[24:27], v[96:99], v[32:35]
    v_and_b32_dpp v28, v15, v20 row_newbcast:12 row_mask:0xf bank_mask:0xf
    v_and_b32_dpp v29, v15, v21 row_newbcast:12 row_mask:0xf bank_mask:0xf
    v_and_b32_dpp v30, v15, v22 row_newbcast:12 row_mask:0xf bank_mask:0xf
    v_and_b32_dpp v31, v15, v23 row_newbcast:12 row_mask:0xf bank_mask:0xf
    s_waitcnt vmcnt(3)
    s_bitcmp0_b32 s14, 19
    s_cbranch_scc1 L_sf_75
    s_waitcnt vmcnt(2)
    s_bitcmp0_b32 s15, 19
    s_cbranch_scc1 L_sf_75
    s_waitcnt vmcnt(1)
L_sf_75:
    buffer_load_dwordx4 v[116:119], v1, s[52:55], s97 offen offset:3072 nt
    s_add_u32 s97, s97, 32768
    v_add_u32 v1, 4096, v1
    v_and_b32 v1, 0x7fff, v1
    v_mfma_f32_16x16x32_bf16 v[32:35], v[28:31], v[100:103], v[32:35]
    v_and_b32_dpp v24, v16, v20 row_newbcast:0 row_mask:0xf bank_mask:0xf
    v_and_b32_dpp v25, v16, v21 row_newbcast:0 row_mask:0xf bank_mask:0xf
    v_and_b32_dpp v26, v16, v22 row_newbcast:0 row_mask:0xf bank_mask:0xf
    v_and_b32_dpp v27, v16, v23 row_newbcast:0 row_mask:0xf bank_mask:0xf
    s_waitcnt vmcnt(3)
    s_bitcmp0_b32 s14, 20
    s_cbranch_scc1 L_sf_76
    s_waitcnt vmcnt(2)
    s_bitcmp0_b32 s15, 20
    s_cbranch_scc1 L_sf_76
    s_waitcnt vmcnt(1)
L_sf_76:
    buffer_load_dwordx4 v[120:123], v1, s[52:55], s97 offen offset:0 nt
    v_mfma_f32_16x16x32_bf16 v[32:35], v[24:27], v[104:107], v[32:35]
    v_and_b32_dpp v28, v16, v20 row_newbcast:8 row_mask:0xf bank_mask:0xf
    v_and_b32_dpp v29, v16, v21 row_newbcast:8 row_mask:0xf bank_mask:0xf
    v_and_b32_dpp v30, v16, v22 row_newbcast:8 row_mask:0xf bank_mask:0xf
    v_and_b32_dpp v31, v16, v23 row_newbcast:8 row_mask:0xf bank_mask:0xf
    s_waitcnt vmcnt(3)
    s_bitcmp0_b32 s14, 21
    s_cbranch_scc1 L_sf_77
    s_waitcnt vmcnt(2)
    s_bitcmp0_b32 s15, 21
    s_cbranch_scc1 L_sf_77
    s_waitcnt vmcnt(1)
L_sf_77:
    buffer_load_dwordx4 v[124:127], v1, s[52:55], s97 offen offset:1024 nt
    v_mfma_f32_16x16x32_bf16 v[32:35], v[28:31], v[108:111], v[32:35]
    v_and_b32_dpp v24, v16, v20 row_newbcast:4 row_mask:0xf bank_mask:0xf
    v_and_b32_dpp v25, v16, v21 row_newbcast:4 row_mask:0xf bank_mask:0xf
    v_and_b32_dpp v26, v16, v22 row_newbcast:4 row_mask:0xf bank_mask:0xf
    v_and_b32_dpp v27, v16, v23 row_newbcast:4 row_mask:0xf bank_mask:0xf
    s_waitcnt vmcnt(3)
    s_bitcmp0_b32 s14, 22
    s_cbranch_scc1 L_sf_78
    s_waitcnt vmcnt(2)
    s_bitcmp0_b32 s15, 22
    s_cbranch_scc1 L_sf_78
    s_waitcnt vmcnt(1)
L_sf_78:
    buffer_load_dwordx4 v[128:131], v1, s[52:55], s97 offen offset:2048 nt
    v_mfma_f32_16x16x32_bf16 v[32:35], v[24:27], v[112:115], v[32:35]
    v_and_b32_dpp v28, v16, v20 row_newbcast:12 row_mask:0xf bank_mask:0xf
    v_and_b32_dpp v29, v16, v21 row_newbcast:12 row_mask:0xf bank_mask:0xf
    v_and_b32_dpp v30, v16, v22 row_newbcast:12 row_mask:0xf bank_mask:0xf
    v_and_b32_dpp v31, v16, v23 row_newbcast:12 row_mask:0xf bank_mask:0xf
    s_waitcnt vmcnt(3)
    s_bitcmp0_b32 s14, 23
    s_cbranch_scc1 L_sf_79
    s_waitcnt vmcnt(2)
    s_bitcmp0_b32 s15, 23
    s_cbranch_scc1 L_sf_79
    s_waitcnt vmcnt(1)
L_sf_79:
    buffer_load_dwordx4 v[132:135], v1, s[52:55], s97 offen offset:3072 nt
    s_add_u32 s97, s97, 32768
    v_add_u32 v1, 4096, v1
    v_and_b32 v1, 0x7fff, v1
    v_mfma_f32_16x16x32_bf16 v[32:35], v[28:31], v[116:119], v[32:35]
    v_and_b32_dpp v24, v17, v20 row_newbcast:0 row_mask:0xf bank_mask:0xf
    v_and_b32_dpp v25, v17, v21 row_newbcast:0 row_mask:0xf bank_mask:0xf
    v_and_b32_dpp v26, v17, v22 row_newbcast:0 row_mask:0xf bank_mask:0xf
    v_and_b32_dpp v27, v17, v23 row_newbcast:0 row_mask:0xf bank_mask:0xf
    s_waitcnt vmcnt(3)
    s_bitcmp0_b32 s14, 24
    s_cbranch_scc1 L_sf_80
    s_waitcnt vmcnt(2)
    s_bitcmp0_b32 s15, 24
    s_cbranch_scc1 L_sf_80
    s_waitcnt vmcnt(1)
L_sf_80:
    buffer_load_dwordx4 v[136:139], v1, s[52:55], s97 offen offset:0 nt
    v_mfma_f32_16x16x32_bf16 v[32:35], v[24:27], v[120:123], v[32:35]
    s_or_b32 s96, s59, s39
    s_cbranch_scc0 L_nofrag_81
    v_mov_b32 v104, 162060
L_lw_82:
    ds_read_b32 v105, v104
    s_waitcnt lgkmcnt(0)
    v_cmp_gt_u32 vcc, 4, v105
    s_cbranch_vccz L_lw_82e
    s_sleep 2
    s_sub_u32 s60, s60, 1
    s_cbranch_scc0 L_lw_82
    s_mov_b32 s60, 0
L_lw_82e:
    s_cmp_eq_u32 s59, 0
    s_cbranch_scc1 L_nofrag_81
    v_bfe_u32 v104, v0, 2, 1
    v_bfe_u32 v110, v0, 4, 1
    v_lshl_add_u32 v104, v110, 2, v104
    v_and_b32 v110, 8, v0
    v_add_u32 v104, v104, v110
    v_lshrrev_b32 v110, 5, v0
    v_lshl_add_u32 v104, v110, 4, v104
    v_bfe_u32 v111, v0, 0, 1
    v_mul_u32_u24 v111, 0xaaaa, v111
    v_add_u32 v111, 0x4444, v111
    v_mov_b32 v112, 0
    v_mov_b32 v113, 0
    v_mov_b32 v114, 0
    v_mov_b32 v115, 0
    v_mov_b32 v116, 0
    v_mov_b32 v117, 0
    v_mov_b32 v118, 0
    v_mov_b32 v119, 0
    v_lshlrev_b32 v104, 7, v104
    v_and_b32 v110, 3, v0
    v_lshl_add_u32 v104, v110, 3, v104
    v_lshrrev_b32 v109, 4, v0
    v_and_b32 v110, 1, v0
    s_lshr_b32 s63, s3, 1
    s_and_b32 s62, s3, 1
    s_lshl_b32 s96, s63, 14
    s_lshl_b32 s100, s62, 6
    s_add_u32 s100, s100, 81920
    s_add_u32 s96, s96, s100
    v_add_u32 v104, s96, v104
    ds_read_b64_tr_b16 v[72:73], v104 offset:0
    ds_read_b64_tr_b16 v[74:75], v104 offset:256
    ds_read_b64_tr_b16 v[76:77], v104 offset:4096
    ds_read_b64_tr_b16 v[78:79], v104 offset:4352
    ds_read_b64_tr_b16 v[80:81], v104 offset:32
    ds_read_b64_tr_b16 v[82:83], v104 offset:288
    ds_read_b64_tr_b16 v[84:85], v104 offset:4128
    ds_read_b64_tr_b16 v[86:87], v104 offset:4384
    ds_read_b64_tr_b16 v[88:89], v104 offset:8192
    ds_read_b64_tr_b16 v[90:91], v104 offset:8448
    ds_read_b64_tr_b16 v[92:93], v104 offset:12288
    ds_read_b64_tr_b16 v[94:95], v104 offset:12544
    ds_read_b64_tr_b16 v[96:97], v104 offset:8224
    ds_read_b64_tr_b16 v[98:99], v104 offset:8480
    ds_read_b64_tr_b16 v[100:101], v104 offset:12320
    ds_read_b64_tr_b16 v[102:103], v104 offset:12576
    v_bfe_u32 v105, v0, 1, 3
    v_lshlrev_b32 v105, 8, v105
    v_lshl_add_u32 v105, v109, 5, v105
    v_lshl_add_u32 v105, v110, 4, v105
    v_lshrrev_b32 v106, 3, v0
    v_lshlrev_b32 v106, 7, v106
    v_and_b32 v110, 7, v0
    v_lshl_add_u32 v107, v110, 3, v106
    v_add_u32 v107, s100, v107
    v_lshlrev_b32 v106, 8, v109
    v_and_b32 v110, 15, v0
    v_lshl_add_u32 v106, v110, 2, v106
    v_add_u32 v106, s96, v106
    v_lshlrev_b32 v108, 2, v0
    s_lshl_b32 s96, s62, 2
    s_add_u32 s96, s96, 162088
    v_mov_b32 v109, s96
    s_lshl_b32 s100, s63, 11
    s_lshl_b32 s96, s34, 13
    s_add_u32 s100, s100, s96
    s_add_u32 s100, s100, 90112
    s_mul_i32 s101, s34, 5120
    s_lshl_b32 s96, s35, 9
    s_add_u32 s101, s101, s96
    s_lshl_b32 s96, s62, 8
    s_add_u32 s101, s101, s96
    s_sub_u32 s101, s101, 11264
    s_and_b32 s96, s101, 0xffffe000
    s_add_u32 s101, s101, s96
    s_add_u32 s101, s101, 196608
    v_add_u32 v110, 8192, v108
L_nofrag_81:
    v_and_b32_dpp v28, v17, v20 row_newbcast:8 row_mask:0xf bank_mask:0xf
    v_and_b32_dpp v29, v17, v21 row_newbcast:8 row_mask:0xf bank_mask:0xf
    v_and_b32_dpp v30, v17, v22 row_newbcast:8 row_mask:0xf bank_mask:0xf
    v_and_b32_dpp v31, v17, v23 row_newbcast:8 row_mask:0xf bank_mask:0xf
    s_waitcnt vmcnt(3)
    s_bitcmp0_b32 s14, 25
    s_cbranch_scc1 L_sf_83
    s_waitcnt vmcnt(2)
    s_bitcmp0_b32 s15, 25
    s_cbranch_scc1 L_sf_83
    s_waitcnt vmcnt(1)
L_sf_83:
    buffer_load_dwordx4 v[140:143], v1, s[52:55], s97 offen offset:1024 nt
    v_mfma_f32_16x16x32_bf16 v[32:35], v[28:31], v[124:127], v[32:35]
    v_and_b32_dpp v24, v17, v20 row_newbcast:4 row_mask:0xf bank_mask:0xf
    v_and_b32_dpp v25, v17, v21 row_newbcast:4 row_mask:0xf bank_mask:0xf
    v_and_b32_dpp v26, v17, v22 row_newbcast:4 row_mask:0xf bank_mask:0xf
    v_and_b32_dpp v27, v17, v23 row_newbcast:4 row_mask:0xf bank_mask:0xf
    s_waitcnt vmcnt(3)
    s_bitcmp0_b32 s14, 26
    s_cbranch_scc1 L_sf_84
    s_waitcnt vmcnt(2)
    s_bitcmp0_b32 s15, 26
    s_cbranch_scc1 L_sf_84
    s_waitcnt vmcnt(1)
L_sf_84:
    buffer_load_dwordx4 v[144:147], v1, s[52:55], s97 offen offset:2048 nt
    v_mfma_f32_16x16x32_bf16 v[32:35], v[24:27], v[128:131], v[32:35]
    v_mov_b32 v10, 162076
    v_mov_b32 v11, 1
    s_mov_b64 exec, 1
    ds_add_u32 v10, v11
    s_mov_b64 exec, -1
    v_and_b32_dpp v28, v17, v20 row_newbcast:12 row_mask:0xf bank_mask:0xf
    v_and_b32_dpp v29, v17, v21 row_newbcast:12 row_mask:0xf bank_mask:0xf
    v_and_b32_dpp v30, v17, v22 row_newbcast:12 row_mask:0xf bank_mask:0xf
    v_and_b32_dpp v31, v17, v23 row_newbcast:12 row_mask:0xf bank_mask:0xf
    s_waitcnt vmcnt(3)
    s_bitcmp0_b32 s14, 27
    s_cbranch_scc1 L_sf_85
    s_waitcnt vmcnt(2)
    s_bitcmp0_b32 s15, 27
    s_cbranch_scc1 L_sf_85
    s_waitcnt vmcnt(1)
L_sf_85:
    buffer_load_dwordx4 v[148:151], v1, s[52:55], s97 offen offset:3072 nt
    s_add_u32 s97, s97, 32768
    v_add_u32 v1, 4096, v1
    v_and_b32 v1, 0x7fff, v1
    v_mfma_f32_16x16x32_bf16 v[32:35], v[28:31], v[132:135], v[32:35]
    v_and_b32_dpp v24, v18, v20 row_newbcast:0 row_mask:0xf bank_mask:0xf
    v_and_b32_dpp v25, v18, v21 row_newbcast:0 row_mask:0xf bank_mask:0xf
    v_and_b32_dpp v26, v18, v22 row_newbcast:0 row_mask:0xf bank_mask:0xf
    v_and_b32_dpp v27, v18, v23 row_newbcast:0 row_mask:0xf bank_mask:0xf
    s_waitcnt vmcnt(3)
    s_bitcmp0_b32 s14, 28
    s_cbranch_scc1 L_sf_86
    s_waitcnt vmcnt(2)
    s_bitcmp0_b32 s15, 28
    s_cbranch_scc1 L_sf_86
    s_waitcnt vmcnt(1)
L_sf_86:
    buffer_load_dwordx4 v[152:155], v1, s[52:55], s97 offen offset:0 nt
    v_mfma_f32_16x16x32_bf16 v[32:35], v[24:27], v[136:139], v[32:35]
    v_and_b32_dpp v28, v18, v20 row_newbcast:8 row_mask:0xf bank_mask:0xf
    v_and_b32_dpp v29, v18, v21 row_newbcast:8 row_mask:0xf bank_mask:0xf
    v_and_b32_dpp v30, v18, v22 row_newbcast:8 row_mask:0xf bank_mask:0xf
    v_and_b32_dpp v31, v18, v23 row_newbcast:8 row_mask:0xf bank_mask:0xf
    s_waitcnt vmcnt(3)
    s_bitcmp0_b32 s14, 29
    s_cbranch_scc1 L_sf_87
    s_waitcnt vmcnt(2)
    s_bitcmp0_b32 s15, 29
    s_cbranch_scc1 L_sf_87
    s_waitcnt vmcnt(1)
L_sf_87:
    buffer_load_dwordx4 v[156:159], v1, s[52:55], s97 offen offset:1024 nt
    v_mfma_f32_16x16x32_bf16 v[32:35], v[28:31], v[140:143], v[32:35]
    v_and_b32_dpp v24, v18, v20 row_newbcast:4 row_mask:0xf bank_mask:0xf
    v_and_b32_dpp v25, v18, v21 row_newbcast:4 row_mask:0xf bank_mask:0xf
    v_and_b32_dpp v26, v18, v22 row_newbcast:4 row_mask:0xf bank_mask:0xf
    v_and_b32_dpp v27, v18, v23 row_newbcast:4 row_mask:0xf bank_mask:0xf
    s_waitcnt vmcnt(3)
    s_bitcmp0_b32 s14, 30
    s_cbranch_scc1 L_sf_88
    s_waitcnt vmcnt(2)
    s_bitcmp0_b32 s15, 30
    s_cbranch_scc1 L_sf_88
    s_waitcnt vmcnt(1)
L_sf_88:
    buffer_load_dwordx4 v[160:163], v1, s[52:55], s97 offen offset:2048 nt
    v_mfma_f32_16x16x32_bf16 v[32:35], v[24:27], v[144:147], v[32:35]
    v_lshrrev_b32 v9, 4, v0
    v_lshl_add_u32 v8, v9, 2, v2
    s_lshl_b32 s96, s3, 9
    s_add_u32 s96, s96, 157824
    v_lshl_add_u32 v8, v8, 2, s96
    v_lshlrev_b32 v9, 3, v0
    v_add_u32 v9, 157824, v9
    v_mov_b32 v10, 162048
    v_mov_b32 v11, 1
    s_lshl_b32 s96, s38, 5
    s_add_u32 s96, s96, 161984
    v_mov_b32 v3, s96
    s_sub_u32 s62, 8, s39
    s_lshl_b32 s98, s34, 5
    s_add_u32 s98, s98, s35
    s_lshl_b32 s98, s98, 8
    s_add_u32 s98, s98, 90112
    v_lshlrev_b32 v39, 2, v0
    v_and_b32_dpp v28, v18, v20 row_newbcast:12 row_mask:0xf bank_mask:0xf
    v_and_b32_dpp v29, v18, v21 row_newbcast:12 row_mask:0xf bank_mask:0xf
    v_and_b32_dpp v30, v18, v22 row_newbcast:12 row_mask:0xf bank_mask:0xf
    v_and_b32_dpp v31, v18, v23 row_newbcast:12 row_mask:0xf bank_mask:0xf
    s_waitcnt vmcnt(3)
    s_bitcmp0_b32 s14, 31
    s_cbranch_scc1 L_sf_89
    s_waitcnt vmcnt(2)
    s_bitcmp0_b32 s15, 31
    s_cbranch_scc1 L_sf_89
    s_waitcnt vmcnt(1)
L_sf_89:
    buffer_load_dwordx4 v[164:167], v1, s[52:55], s97 offen offset:3072 nt
    s_mov_b32 s97, 0
    v_add_u32 v1, 4096, v1
    v_and_b32 v1, 0x7fff, v1
    v_mfma_f32_16x16x32_bf16 v[32:35], v[28:31], v[148:151], v[32:35]
    s_cmp_eq_u32 s12, -1
    s_cbranch_scc1 L_v_nopf
    v_and_b32_dpp v24, v19, v20 row_newbcast:0 row_mask:0xf bank_mask:0xf
    v_and_b32_dpp v25, v19, v21 row_newbcast:0 row_mask:0xf bank_mask:0xf
    v_and_b32_dpp v26, v19, v22 row_newbcast:0 row_mask:0xf bank_mask:0xf
    v_and_b32_dpp v27, v19, v23 row_newbcast:0 row_mask:0xf bank_mask:0xf
    s_waitcnt vmcnt(3)
    s_nop 0
    v_mfma_f32_16x16x32_bf16 v[32:35], v[24:27], v[152:155], v[32:35]
    v_and_b32_dpp v28, v19, v20 row_newbcast:8 row_mask:0xf bank_mask:0xf
    v_and_b32_dpp v29, v19, v21 row_newbcast:8 row_mask:0xf bank_mask:0xf
    v_and_b32_dpp v30, v19, v22 row_newbcast:8 row_mask:0xf bank_mask:0xf
    v_and_b32_dpp v31, v19, v23 row_newbcast:8 row_mask:0xf bank_mask:0xf
    s_waitcnt vmcnt(2)
    s_nop 0
    v_mfma_f32_16x16x32_bf16 v[32:35], v[28:31], v[156:159], v[32:35]
    v_and_b32_dpp v24, v19, v20 row_newbcast:4 row_mask:0xf bank_mask:0xf
    v_and_b32_dpp v25, v19, v21 row_newbcast:4 row_mask:0xf bank_mask:0xf
    v_and_b32_dpp v26, v19, v22 row_newbcast:4 row_mask:0xf bank_mask:0xf
    v_and_b32_dpp v27, v19, v23 row_newbcast:4 row_mask:0xf bank_mask:0xf
    s_waitcnt vmcnt(1)
    s_nop 0
    v_mfma_f32_16x16x32_bf16 v[32:35], v[24:27], v[160:163], v[32:35]
    v_and_b32_dpp v28, v19, v20 row_newbcast:12 row_mask:0xf bank_mask:0xf
    v_and_b32_dpp v29, v19, v21 row_newbcast:12 row_mask:0xf bank_mask:0xf
    v_and_b32_dpp v30, v19, v22 row_newbcast:12 row_mask:0xf bank_mask:0xf
    v_and_b32_dpp v31, v19, v23 row_newbcast:12 row_mask:0xf bank_mask:0xf
    s_waitcnt vmcnt(0)
    s_nop 0
    v_mfma_f32_16x16x32_bf16 v[32:35], v[28:31], v[164:167], v[32:35]
L_v_join:
    s_cmp_lg_u32 s13, 0
    s_cbranch_scc1 L_jobend
L_t0:
    s_mov_b32 exec_hi, 0
    s_nop 4
    ds_write_b128 v8, v[32:35]
L_t0b:
    s_mov_b64 exec, 1
    ds_add_rtn_u32 v37, v10, v11
    s_mov_b64 exec, -1
    ds_read_b32 v38, v10 offset:24
    ds_read_b128 v[24:27], v3
    ds_read_b128 v[28:31], v3 offset:16
    ds_read_b64 v[144:145], v9 offset:0
    ds_read_b64 v[146:147], v9 offset:512
    ds_read_b64 v[148:149], v9 offset:1024
    ds_read_b64 v[150:151], v9 offset:1536
    ds_read_b64 v[152:153], v9 offset:2048
    ds_read_b64 v[154:155], v9 offset:2560
    ds_read_b64 v[156:157], v9 offset:3072
    ds_read_b64 v[158:159], v9 offset:3584
    s_waitcnt lgkmcnt(10)
    v_readfirstlane_b32 s96, v37
    v_readfirstlane_b32 s61, v38
    s_cmp_lg_u32 s96, s62
    s_cbranch_scc1 L_nopub
    s_waitcnt lgkmcnt(6)
    v_pk_mul_f32 v[144:145], v[144:145], v[24:25] op_sel:[0,0] op_sel_hi:[1,0]
    v_pk_mul_f32 v[146:147], v[146:147], v[24:25] op_sel:[0,1] op_sel_hi:[1,1]
    s_waitcnt lgkmcnt(4)
    v_pk_fma_f32 v[144:145], v[148:149], v[26:27], v[144:145] op_sel:[0,0,0] op_sel_hi:[1,0,1]
    v_pk_fma_f32 v[146:147], v[150:151], v[26:27], v[146:147] op_sel:[0,1,0] op_sel_hi:[1,1,1]
    s_waitcnt lgkmcnt(2)
    v_pk_fma_f32 v[144:145], v[152:153], v[28:29], v[144:145] op_sel:[0,0,0] op_sel_hi:[1,0,1]
    v_pk_fma_f32 v[146:147], v[154:155], v[28:29], v[146:147] op_sel:[0,1,0] op_sel_hi:[1,1,1]
    s_waitcnt lgkmcnt(0)
    v_pk_fma_f32 v[144:145], v[156:157], v[30:31], v[144:145] op_sel:[0,0,0] op_sel_hi:[1,0,1]
    v_pk_fma_f32 v[146:147], v[158:159], v[30:31], v[146:147] op_sel:[0,1,0] op_sel_hi:[1,1,1]
    s_cmp_eq_u32 s61, 1
    v_pk_add_f32 v[144:145], v[144:145], v[146:147]
    v_cvt_pk_bf16_f32 v32, v144, v145
    s_cbranch_scc0 L_oslow
    buffer_store_dword v32, v39, s[40:43], s98 offen
L_odone:
L_nopub:
    s_cmp_eq_u32 s59, 0
    s_cbranch_scc1 L_not1
L_poll_98:
    buffer_load_dwordx4 v[16:19], v105, s[40:43], s100 offen sc1
    buffer_load_dwordx4 v[20:23], v105, s[40:43], s100 offen offset:128 sc1
    s_sub_u32 s60, s60, 1
    s_cbranch_scc1 L_poll_98t
    s_waitcnt vmcnt(0)
    v_max3_u32 v38, v16, v17, v18
    v_max3_u32 v38, v38, v19, v20
    v_max3_u32 v38, v38, v21, v22
    v_max_u32 v38, v38, v23
    v_cmp_eq_u32 vcc, -1, v38
    s_cbranch_vccnz L_poll_98
L_poll_98e:
    v_smfmac_f32_16x16x64_bf16 v[112:115], v[16:19], v[72:79], v111
    v_smfmac_f32_16x16x64_bf16 v[116:119], v[16:19], v[80:87], v111
    v_smfmac_f32_16x16x64_bf16 v[112:115], v[20:23], v[88:95], v111
    v_smfmac_f32_16x16x64_bf16 v[116:119], v[20:23], v[96:103], v111
    s_nop 6
    v_pk_add_f32 v[112:113], v[112:113], v[114:115]
    v_pk_add_f32 v[116:117], v[116:117], v[118:119]
    v_add_f32 v12, v112, v113
    v_add_f32 v13, v116, v117
    ds_write2_b32 v106, v12, v13 offset0:0 offset1:32
    s_mov_b64 exec, 1
    ds_add_rtn_u32 v37, v109, v11
    s_mov_b64 exec, -1
    ds_read_b64 v[72:73], v107 offset:0
    ds_read_b64 v[74:75], v107 offset:16384
    ds_read_b64 v[76:77], v107 offset:32768
    ds_read_b64 v[78:79], v107 offset:49152
    s_cmp_eq_u32 s34, 2
    s_cselect_b32 s97, s61, 0
    s_waitcnt lgkmcnt(4)
    v_readfirstlane_b32 s96, v37
    s_waitcnt lgkmcnt(2)
    v_pk_add_f32 v[72:73], v[72:73], v[74:75]
    s_cmp_lg_u32 s96, 3
    s_cbranch_scc1 L_not1
    s_cmp_eq_u32 s97, 1
    s_waitcnt lgkmcnt(0)
    v_pk_add_f32 v[76:77], v[76:77], v[78:79]
    v_pk_add_f32 v[72:73], v[72:73], v[76:77]
    v_cvt_pk_bf16_f32 v12, v72, v73
    s_cbranch_scc1 L_pfast
    buffer_store_dword v12, v108, s[40:43], s101 offen sc1
    buffer_store_dword v12, v110, s[40:43], s101 offen sc1
L_pdone:
L_not1:
    s_waitcnt lgkmcnt(0)
    s_cmp_eq_u32 s39, 1
    s_cbranch_scc1 L_s_role
    s_endpgm
L_k_nopf:
    s_waitcnt vmcnt(3)
    s_bitcmp0_b32 s57, 22
    s_cbranch_scc1 L_sf_54
    s_waitcnt vmcnt(2)
    s_bitcmp0_b32 s58, 22
    s_cbranch_scc1 L_sf_54
    s_waitcnt vmcnt(1)
L_sf_54:
    buffer_load_dwordx4 v[128:131], v1, s[48:51], s97 offen offset:2048 nt
    v_and_b32 v39, 31, v0
    v_lshlrev_b32 v39, 2, v39
    buffer_load_dword v37, v39, s[44:47], 0 offen sc1
    s_waitcnt vmcnt(4)
    s_bitcmp0_b32 s57, 23
    s_cbranch_scc1 L_sf_55
    s_waitcnt vmcnt(3)
    s_bitcmp0_b32 s58, 23
    s_cbranch_scc1 L_sf_55
    s_waitcnt vmcnt(2)
L_sf_55:
    buffer_load_dwordx4 v[132:135], v1, s[48:51], s97 offen offset:3072 nt
    s_add_u32 s97, s97, 32768
    v_add_u32 v1, 4096, v1
    v_and_b32 v1, 0x7fff, v1
    s_waitcnt vmcnt(4)
    s_bitcmp0_b32 s57, 24
    s_cbranch_scc1 L_sf_56
    s_waitcnt vmcnt(3)
    s_bitcmp0_b32 s58, 24
    s_cbranch_scc1 L_sf_56
    s_waitcnt vmcnt(2)
L_sf_56:
    buffer_load_dwordx4 v[136:139], v1, s[48:51], s97 offen offset:0 nt
    s_waitcnt vmcnt(4)
    s_bitcmp0_b32 s57, 25
    s_cbranch_scc1 L_sf_57
    s_waitcnt vmcnt(3)
    s_bitcmp0_b32 s58, 25
    s_cbranch_scc1 L_sf_57
    s_waitcnt vmcnt(1)
L_sf_57:
    buffer_load_dwordx4 v[140:143], v1, s[48:51], s97 offen offset:1024 nt
    s_waitcnt vmcnt(4)
    s_bitcmp0_b32 s57, 26
    s_cbranch_scc1 L_sf_58
    s_waitcnt vmcnt(2)
    s_bitcmp0_b32 s58, 26
    s_cbranch_scc1 L_sf_58
    s_waitcnt vmcnt(1)
L_sf_58:
    buffer_load_dwordx4 v[144:147], v1, s[48:51], s97 offen offset:2048 nt
    s_waitcnt vmcnt(3)
    s_bitcmp0_b32 s57, 27
    s_cbranch_scc1 L_sf_59
    s_waitcnt vmcnt(2)
    s_bitcmp0_b32 s58, 27
    s_cbranch_scc1 L_sf_59
    s_waitcnt vmcnt(1)
L_sf_59:
    buffer_load_dwordx4 v[148:151], v1, s[48:51], s97 offen offset:3072 nt
    s_add_u32 s97, s97, 32768
    v_add_u32 v1, 4096, v1
    v_and_b32 v1, 0x7fff, v1
    v_cmp_eq_u32 vcc, 0, v37
    s_nop 0
    s_or_b32 s96, vcc_lo, vcc_hi
    buffer_load_dwordx4 v[4:7], v2, s[40:43], s98 offen sc1
    s_waitcnt vmcnt(4)
    s_bitcmp0_b32 s57, 28
    s_cbranch_scc1 L_sf_60
    s_waitcnt vmcnt(3)
    s_bitcmp0_b32 s58, 28
    s_cbranch_scc1 L_sf_60
    s_waitcnt vmcnt(2)
L_sf_60:
    buffer_load_dwordx4 v[152:155], v1, s[48:51], s97 offen offset:0 nt
    s_waitcnt vmcnt(4)
    s_bitcmp0_b32 s57, 29
    s_cbranch_scc1 L_sf_61
    s_waitcnt vmcnt(3)
    s_bitcmp0_b32 s58, 29
    s_cbranch_scc1 L_sf_61
    s_waitcnt vmcnt(2)
L_sf_61:
    buffer_load_dwordx4 v[156:159], v1, s[48:51], s97 offen offset:1024 nt
    s_waitcnt vmcnt(4)
    s_bitcmp0_b32 s57, 30
    s_cbranch_scc1 L_sf_62
    s_waitcnt vmcnt(3)
    s_bitcmp0_b32 s58, 30
    s_cbranch_scc1 L_sf_62
    s_waitcnt vmcnt(1)
L_sf_62:
    buffer_load_dwordx4 v[160:163], v1, s[48:51], s97 offen offset:2048 nt
    s_waitcnt vmcnt(4)
    s_bitcmp0_b32 s57, 31
    s_cbranch_scc1 L_sf_63
    s_waitcnt vmcnt(2)
    s_bitcmp0_b32 s58, 31
    s_cbranch_scc1 L_sf_63
    s_waitcnt vmcnt(1)
L_sf_63:
    buffer_load_dwordx4 v[164:167], v1, s[48:51], s97 offen offset:3072 nt
    s_mov_b32 s97, 0
    v_add_u32 v1, 4096, v1
    v_and_b32 v1, 0x7fff, v1
    v_add_u32 v1, 8192, v1
    v_and_b32 v1, 0x7fff, v1
    s_mov_b32 s97, 65536
    s_branch L_k_join
L_v_nopf:
    v_and_b32_dpp v24, v19, v20 row_newbcast:0 row_mask:0xf bank_mask:0xf
    v_and_b32_dpp v25, v19, v21 row_newbcast:0 row_mask:0xf bank_mask:0xf
    v_and_b32_dpp v26, v19, v22 row_newbcast:0 row_mask:0xf bank_mask:0xf
    v_and_b32_dpp v27, v19, v23 row_newbcast:0 row_mask:0xf bank_mask:0xf
    s_waitcnt vmcnt(3)
    s_bitcmp0_b32 s14, 0
    s_cbranch_scc1 L_sf_90
    s_waitcnt vmcnt(2)
    s_bitcmp0_b32 s15, 0
    s_cbranch_scc1 L_sf_90
    s_waitcnt vmcnt(1)
L_sf_90:
    buffer_load_dwordx4 v[40:43], v1, s[52:55], s97 offen offset:0 nt
    v_mfma_f32_16x16x32_bf16 v[32:35], v[24:27], v[152:155], v[32:35]
    v_and_b32_dpp v28, v19, v20 row_newbcast:8 row_mask:0xf bank_mask:0xf
    v_and_b32_dpp v29, v19, v21 row_newbcast:8 row_mask:0xf bank_mask:0xf
    v_and_b32_dpp v30, v19, v22 row_newbcast:8 row_mask:0xf bank_mask:0xf
    v_and_b32_dpp v31, v19, v23 row_newbcast:8 row_mask:0xf bank_mask:0xf
    s_waitcnt vmcnt(3)
    s_bitcmp0_b32 s14, 1
    s_cbranch_scc1 L_sf_91
    s_waitcnt vmcnt(2)
    s_bitcmp0_b32 s15, 1
    s_cbranch_scc1 L_sf_91
    s_waitcnt vmcnt(1)
L_sf_91:
    buffer_load_dwordx4 v[44:47], v1, s[52:55], s97 offen offset:1024 nt
    v_mfma_f32_16x16x32_bf16 v[32:35], v[28:31], v[156:159], v[32:35]
    v_and_b32_dpp v24, v19, v20 row_newbcast:4 row_mask:0xf bank_mask:0xf
    v_and_b32_dpp v25, v19, v21 row_newbcast:4 row_mask:0xf bank_mask:0xf
    v_and_b32_dpp v26, v19, v22 row_newbcast:4 row_mask:0xf bank_mask:0xf
    v_and_b32_dpp v27, v19, v23 row_newbcast:4 row_mask:0xf bank_mask:0xf
    s_waitcnt vmcnt(3)
    s_bitcmp0_b32 s14, 2
    s_cbranch_scc1 L_sf_92
    s_waitcnt vmcnt(2)
    s_bitcmp0_b32 s15, 2
    s_cbranch_scc1 L_sf_92
    s_waitcnt vmcnt(1)
L_sf_92:
    buffer_load_dwordx4 v[48:51], v1, s[52:55], s97 offen offset:2048 nt
    v_mfma_f32_16x16x32_bf16 v[32:35], v[24:27], v[160:163], v[32:35]
    v_and_b32_dpp v28, v19, v20 row_newbcast:12 row_mask:0xf bank_mask:0xf
    v_and_b32_dpp v29, v19, v21 row_newbcast:12 row_mask:0xf bank_mask:0xf
    v_and_b32_dpp v30, v19, v22 row_newbcast:12 row_mask:0xf bank_mask:0xf
    v_and_b32_dpp v31, v19, v23 row_newbcast:12 row_mask:0xf bank_mask:0xf
    s_waitcnt vmcnt(3)
    s_bitcmp0_b32 s14, 3
    s_cbranch_scc1 L_sf_93
    s_waitcnt vmcnt(2)
    s_bitcmp0_b32 s15, 3
    s_cbranch_scc1 L_sf_93
    s_waitcnt vmcnt(1)
L_sf_93:
    buffer_load_dwordx4 v[52:55], v1, s[52:55], s97 offen offset:3072 nt
    s_add_u32 s97, s97, 32768
    v_add_u32 v1, 4096, v1
    v_and_b32 v1, 0x7fff, v1
    v_mfma_f32_16x16x32_bf16 v[32:35], v[28:31], v[164:167], v[32:35]
    v_and_b32_dpp v24, v12, v20 row_newbcast:0 row_mask:0xf bank_mask:0xf
    v_and_b32_dpp v25, v12, v21 row_newbcast:0 row_mask:0xf bank_mask:0xf
    v_and_b32_dpp v26, v12, v22 row_newbcast:0 row_mask:0xf bank_mask:0xf
    v_and_b32_dpp v27, v12, v23 row_newbcast:0 row_mask:0xf bank_mask:0xf
    s_waitcnt vmcnt(3)
    s_bitcmp0_b32 s14, 4
    s_cbranch_scc1 L_sf_94
    s_waitcnt vmcnt(2)
    s_bitcmp0_b32 s15, 4
    s_cbranch_scc1 L_sf_94
    s_waitcnt vmcnt(1)
L_sf_94:
    buffer_load_dwordx4 v[56:59], v1, s[52:55], s97 offen offset:0 nt
    v_mfma_f32_16x16x32_bf16 v[32:35], v[24:27], v[40:43], v[32:35]
    v_and_b32_dpp v28, v12, v20 row_newbcast:8 row_mask:0xf bank_mask:0xf
    v_and_b32_dpp v29, v12, v21 row_newbcast:8 row_mask:0xf bank_mask:0xf
    v_and_b32_dpp v30, v12, v22 row_newbcast:8 row_mask:0xf bank_mask:0xf
    v_and_b32_dpp v31, v12, v23 row_newbcast:8 row_mask:0xf bank_mask:0xf
    s_waitcnt vmcnt(3)
    s_bitcmp0_b32 s14, 5
    s_cbranch_scc1 L_sf_95
    s_waitcnt vmcnt(2)
    s_bitcmp0_b32 s15, 5
    s_cbranch_scc1 L_sf_95
    s_waitcnt vmcnt(1)
L_sf_95:
    buffer_load_dwordx4 v[60:63], v1, s[52:55], s97 offen offset:1024 nt
    v_mfma_f32_16x16x32_bf16 v[32:35], v[28:31], v[44:47], v[32:35]
    v_and_b32_dpp v24, v12, v20 row_newbcast:4 row_mask:0xf bank_mask:0xf
    v_and_b32_dpp v25, v12, v21 row_newbcast:4 row_mask:0xf bank_mask:0xf
    v_and_b32_dpp v26, v12, v22 row_newbcast:4 row_mask:0xf bank_mask:0xf
    v_and_b32_dpp v27, v12, v23 row_newbcast:4 row_mask:0xf bank_mask:0xf
    s_waitcnt vmcnt(3)
    s_bitcmp0_b32 s14, 6
    s_cbranch_scc1 L_sf_96
    s_waitcnt vmcnt(2)
    s_bitcmp0_b32 s15, 6
    s_cbranch_scc1 L_sf_96
    s_waitcnt vmcnt(1)
L_sf_96:
    buffer_load_dwordx4 v[64:67], v1, s[52:55], s97 offen offset:2048 nt
    v_mfma_f32_16x16x32_bf16 v[32:35], v[24:27], v[48:51], v[32:35]
    v_and_b32_dpp v28, v12, v20 row_newbcast:12 row_mask:0xf bank_mask:0xf
    v_and_b32_dpp v29, v12, v21 row_newbcast:12 row_mask:0xf bank_mask:0xf
    v_and_b32_dpp v30, v12, v22 row_newbcast:12 row_mask:0xf bank_mask:0xf
    v_and_b32_dpp v31, v12, v23 row_newbcast:12 row_mask:0xf bank_mask:0xf
    s_waitcnt vmcnt(3)
    s_bitcmp0_b32 s14, 7
    s_cbranch_scc1 L_sf_97
    s_waitcnt vmcnt(2)
    s_bitcmp0_b32 s15, 7
    s_cbranch_scc1 L_sf_97
    s_waitcnt vmcnt(1)
L_sf_97:
    buffer_load_dwordx4 v[68:71], v1, s[52:55], s97 offen offset:3072 nt
    s_add_u32 s97, s97, 32768
    v_add_u32 v1, 4096, v1
    v_and_b32 v1, 0x7fff, v1
    v_mfma_f32_16x16x32_bf16 v[32:35], v[28:31], v[52:55], v[32:35]
    v_and_b32_dpp v24, v13, v20 row_newbcast:0 row_mask:0xf bank_mask:0xf
    v_and_b32_dpp v25, v13, v21 row_newbcast:0 row_mask:0xf bank_mask:0xf
    v_and_b32_dpp v26, v13, v22 row_newbcast:0 row_mask:0xf bank_mask:0xf
    v_and_b32_dpp v27, v13, v23 row_newbcast:0 row_mask:0xf bank_mask:0xf
    s_waitcnt vmcnt(3)
    s_nop 0
    v_mfma_f32_16x16x32_bf16 v[32:35], v[24:27], v[56:59], v[32:35]
    v_and_b32_dpp v28, v13, v20 row_newbcast:8 row_mask:0xf bank_mask:0xf
    v_and_b32_dpp v29, v13, v21 row_newbcast:8 row_mask:0xf bank_mask:0xf
    v_and_b32_dpp v30, v13, v22 row_newbcast:8 row_mask:0xf bank_mask:0xf
    v_and_b32_dpp v31, v13, v23 row_newbcast:8 row_mask:0xf bank_mask:0xf
    s_waitcnt vmcnt(2)
    s_nop 0
    v_mfma_f32_16x16x32_bf16 v[32:35], v[28:31], v[60:63], v[32:35]
    v_and_b32_dpp v24, v13, v20 row_newbcast:4 row_mask:0xf bank_mask:0xf
    v_and_b32_dpp v25, v13, v21 row_newbcast:4 row_mask:0xf bank_mask:0xf
    v_and_b32_dpp v26, v13, v22 row_newbcast:4 row_mask:0xf bank_mask:0xf
    v_and_b32_dpp v27, v13, v23 row_newbcast:4 row_mask:0xf bank_mask:0xf
    s_waitcnt vmcnt(1)
    s_nop 0
    v_mfma_f32_16x16x32_bf16 v[32:35], v[24:27], v[64:67], v[32:35]
    v_and_b32_dpp v28, v13, v20 row_newbcast:12 row_mask:0xf bank_mask:0xf
    v_and_b32_dpp v29, v13, v21 row_newbcast:12 row_mask:0xf bank_mask:0xf
    v_and_b32_dpp v30, v13, v22 row_newbcast:12 row_mask:0xf bank_mask:0xf
    v_and_b32_dpp v31, v13, v23 row_newbcast:12 row_mask:0xf bank_mask:0xf
    s_waitcnt vmcnt(0)
    s_nop 0
    v_mfma_f32_16x16x32_bf16 v[32:35], v[28:31], v[68:71], v[32:35]
    s_branch L_v_join
L_oslow:
    buffer_store_dword v32, v39, s[40:43], s98 offen sc1
    s_branch L_odone
L_qslow:
L_wy_99:
    buffer_load_dword v37, v39, s[44:47], 0 offen sc1
    s_waitcnt vmcnt(0)
    v_cmp_ne_u32 vcc, -1, v37
    s_cbranch_vccz L_wy_99e
    s_sleep 4
    s_sub_u32 s60, s60, 1
    s_cbranch_scc0 L_wy_99
    s_mov_b32 s60, 0
L_wy_99e:
L_qslow2:
    s_branch L_poll_100
L_poll_100s:
    s_sleep 2
L_poll_100:
    buffer_load_dwordx4 v[4:7], v2, s[40:43], s98 offen sc1
    s_sub_u32 s60, s60, 1
    s_cbranch_scc1 L_poll_100t
    s_waitcnt vmcnt(0)
    v_max3_u32 v38, v4, v5, v6
    v_max_u32 v38, v38, v7
    v_cmp_eq_u32 vcc, -1, v38
    s_cbranch_vccnz L_poll_100s
L_poll_100e:
    s_branch L_qok
L_mljob:
    s_lshl_b32 s96, s38, 3
    s_add_u32 s96, s96, s3
    s_lshl3_add_u32 s96, s96, s99
    buffer_store_dwordx2 v[8:9], v36, s[40:43], s96 offen sc1
    s_branch L_mldone
L_service:
    v_mov_b32 v72, 0
    v_mov_b32 v73, 0
    v_mov_b32 v74, 0
    v_mov_b32 v75, 0
    v_mov_b32 v76, 0
    s_mov_b32 s59, 0
    v_mov_b32 v5, 0
    v_mov_b32 v105, 0
    v_mov_b32 v108, 0
    v_mov_b32 v110, 0
    v_mov_b32 v160, 0
    v_mov_b32 v163, 0
    v_mov_b32 v8, 162068
L_lw_101:
    ds_read_b32 v9, v8
    s_waitcnt lgkmcnt(0)
    v_cmp_gt_u32 vcc, 8, v9
    s_cbranch_vccz L_lw_101e
    s_sleep 8
    s_sub_u32 s60, s60, 1
    s_cbranch_scc0 L_lw_101
    s_mov_b32 s60, 0
L_lw_101e:
    v_and_b32 v2, 15, v0
    v_lshlrev_b32 v2, 3, v2
    v_add_u32 v3, 161920, v2
    ds_read_b64 v[8:9], v3
    v_mov_b32 v11, 162096
    ds_read_b32 v11, v11
    s_lshl_b32 s99, s37, 5
    s_add_u32 s99, s99, s36
    s_lshl_b32 s99, s99, 7
    s_add_u32 s99, s99, 73728
    s_lshl_b32 s62, s38, 6
    s_add_u32 s62, s62, s99
    s_getreg_b32 s58, hwreg(HW_REG_XCC_ID, 0, 4)
    s_lshl_b32 s98, s34, 5
    s_add_u32 s98, s98, s35
    s_lshl_b32 s63, s98, 2
    s_add_u32 s63, s63, 188416
    s_lshl_b32 s98, s98, 8
    s_add_u32 s98, s98, 90112
    v_lshlrev_b32 v39, 2, v0
    s_bfm_b64 exec, 8, 0
    s_waitcnt lgkmcnt(0)
    v_lshl_add_u32 v10, v11, 8, s58
    buffer_store_dwordx2 v[8:9], v2, s[40:43], s62 offen sc1
    s_mov_b64 exec, 1
    buffer_store_dword v10, v36, s[40:43], s63 offen sc1
    s_mov_b64 exec, -1
    v_mov_b32 v12, 162076
L_lw_102:
    ds_read_b32 v13, v12
    s_waitcnt lgkmcnt(0)
    v_cmp_gt_u32 vcc, 4, v13
    s_cbranch_vccz L_lw_102e
    s_sleep 4
    s_sub_u32 s60, s60, 1
    s_cbranch_scc0 L_lw_102
    s_mov_b32 s60, 0
L_lw_102e:
    v_and_b32 v11, 31, v0
    v_lshlrev_b32 v11, 2, v11
    s_lshl_b32 s63, s34, 7
    s_add_u32 s63, s63, 188416
    buffer_load_dword v12, v39, s[40:43], s98 offen sc1
    s_branch L_poll_103
L_poll_103s:
    s_sleep 16
L_poll_103:
    buffer_load_dwordx2 v[8:9], v2, s[40:43], s99 offen sc1
    buffer_load_dword v10, v11, s[40:43], s63 offen sc1
    s_sub_u32 s60, s60, 1
    s_cbranch_scc1 L_poll_103t
    s_waitcnt vmcnt(0)
    v_max3_u32 v38, v8, v9, v10
    v_cmp_eq_u32 vcc, -1, v38
    s_cbranch_vccnz L_poll_103s
L_poll_103e:
    v_mov_b32 v37, v8
    s_nop 1
    v_max_f32_dpp v37, v37, v37 quad_perm:[1,0,3,2] row_mask:0xf bank_mask:0xf
    s_nop 1
    v_max_f32_dpp v37, v37, v37 quad_perm:[2,3,0,1] row_mask:0xf bank_mask:0xf
    s_nop 1
    v_max_f32_dpp v37, v37, v37 row_ror:4 row_mask:0xf bank_mask:0xf
    s_nop 1
    v_max_f32_dpp v37, v37, v37 row_ror:8 row_mask:0xf bank_mask:0xf
    v_sub_f32 v8, v8, v37
    v_exp_f32 v8, v8
    s_nop 0
    v_mul_f32 v9, v8, v9
    s_nop 1
    v_add_f32_dpp v9, v9, v9 quad_perm:[1,0,3,2] row_mask:0xf bank_mask:0xf
    s_nop 1
    v_add_f32_dpp v9, v9, v9 quad_perm:[2,3,0,1] row_mask:0xf bank_mask:0xf
    s_nop 1
    v_add_f32_dpp v9, v9, v9 row_ror:4 row_mask:0xf bank_mask:0xf
    s_nop 1
    v_add_f32_dpp v9, v9, v9 row_ror:8 row_mask:0xf bank_mask:0xf
    v_and_b32 v10, 0xff, v10
    s_getreg_b32 s62, hwreg(HW_REG_XCC_ID, 0, 4)
    v_cmp_ne_u32 vcc, s62, v10
    s_nop 0
    s_cmp_eq_u64 vcc, 0
    s_cselect_b32 s61, 1, 0
    v_rcp_f32 v9, v9
    v_lshrrev_b32 v3, 1, v2
    v_add_u32 v3, 161984, v3
    v_mul_f32 v8, v8, v9
    v_mov_b32 v10, 162072
    v_mov_b32 v11, s61
    ds_write_b32 v3, v8
    ds_write_b32 v10, v11
    s_mov_b32 s3, 1
    v_lshrrev_b32 v9, 4, v0
    v_lshl_add_u32 v8, v9, 2, v2
    s_lshl_b32 s96, s3, 9
    s_add_u32 s96, s96, 157824
    v_lshl_add_u32 v8, v8, 2, s96
    v_lshlrev_b32 v9, 3, v0
    v_add_u32 v9, 157824, v9
    v_mov_b32 v10, 162048
    v_mov_b32 v11, 1
    s_lshl_b32 s96, s38, 5
    s_add_u32 s96, s96, 161984
    v_mov_b32 v3, s96
    s_sub_u32 s62, 8, s39
    s_lshl_b32 s98, s34, 5
    s_add_u32 s98, s98, s35
    s_lshl_b32 s98, s98, 8
    s_add_u32 s98, s98, 90112
    v_lshlrev_b32 v39, 2, v0
    s_branch L_t0b
L_jobend:
    v_lshlrev_b32 v9, 4, v0
    s_mov_b32 exec_hi, 0
    s_nop 3
    buffer_store_dwordx4 v[32:35], v9, s[40:43], s13 offen sc1
    s_endpgm
L_proxy:
    v_mov_b32 v72, 0
    v_mov_b32 v73, 0
    v_mov_b32 v74, 0
    v_mov_b32 v75, 0
    v_mov_b32 v76, 0
    v_mov_b32 v5, 0
    v_mov_b32 v105, 0
    v_mov_b32 v108, 0
    v_mov_b32 v110, 0
    v_mov_b32 v160, 0
    v_mov_b32 v163, 0
    s_barrier
    s_waitcnt lgkmcnt(0)
    s_mov_b32 s40, s32
    s_mov_b32 s41, s33
    s_mov_b32 s42, 589824
    s_mov_b32 s43, 0x20000
    s_mov_b32 s44, s30
    s_mov_b32 s45, s31
    s_mov_b32 s46, 256
    s_mov_b32 s47, 0x20000
    s_sub_u32 s97, 7, s3
    s_mul_i32 s97, s97, 27
    s_cmp_eq_u32 s3, 5
    s_cselect_b32 s97, 32, s97
    s_add_u32 s97, s97, s35
    s_lshl_b32 s97, s97, 9
    s_add_u32 s97, s97, 155648
    v_and_b32 v2, 15, v0
    v_lshlrev_b32 v2, 3, v2
    v_and_b32 v20, 31, v0
    v_lshlrev_b32 v20, 4, v20
    s_cmp_lg_u32 s3, 7
    s_cbranch_scc1 L_px6
    s_sub_u32 s96, 6, s59
    v_mov_b32 v8, 162068
L_lw_104:
    ds_read_b32 v9, v8
    s_waitcnt lgkmcnt(0)
    v_cmp_gt_u32 vcc, s96, v9
    s_cbranch_vccz L_lw_104e
    s_sleep 8
    s_sub_u32 s60, s60, 1
    s_cbranch_scc0 L_lw_104
    s_mov_b32 s60, 0
L_lw_104e:
    v_and_b32 v2, 15, v0
    v_lshlrev_b32 v2, 3, v2
    v_add_u32 v3, 161920, v2
    ds_read_b64 v[8:9], v3
    v_mov_b32 v11, 162096
    ds_read_b32 v11, v11
    s_lshl_b32 s99, s37, 5
    s_add_u32 s99, s99, s36
    s_lshl_b32 s99, s99, 7
    s_add_u32 s99, s99, 73728
    s_lshl_b32 s62, s38, 6
    s_add_u32 s62, s62, s99
    s_getreg_b32 s58, hwreg(HW_REG_XCC_ID, 0, 4)
    s_lshl_b32 s98, s34, 5
    s_add_u32 s98, s98, s35
    s_lshl_b32 s63, s98, 2
    s_add_u32 s63, s63, 188416
    s_lshl_b32 s98, s98, 8
    s_add_u32 s98, s98, 90112
    v_lshlrev_b32 v39, 2, v0
    s_bfm_b64 exec, s96, 0
    s_waitcnt lgkmcnt(0)
    v_lshl_add_u32 v10, v11, 8, s58
    buffer_store_dwordx2 v[8:9], v2, s[40:43], s62 offen sc1
    s_mov_b64 exec, 1
    buffer_store_dword v10, v36, s[40:43], s63 offen sc1
    s_mov_b64 exec, -1
    s_mov_b32 s100, 4
    s_lshl_b32 s63, s100, 8
    v_and_b32 v8, 15, v0
    v_lshl_add_u32 v8, v8, 4, s63
    v_lshrrev_b32 v9, 4, v0
    v_mul_u32_u24 v5, 1280, v9
    v_add_u32 v5, v5, v8
    v_mul_u32_u24 v4, 1296, v9
    v_add_u32 v4, v4, v8
    v_add_u32 v4, 82944, v4
    v_lshlrev_b32 v6, 1, v5
    v_add_u32 v6, 99328, v6
    s_lshl_b32 s62, s100, 9
    s_add_u32 s62, s62, 88128
    v_lshl_add_u32 v7, v0, 3, s62
    s_mov_b32 s48, s4
    s_mov_b32 s49, s5
    s_mov_b32 s50, 5120
    s_mov_b32 s51, 0x20000
    buffer_load_dwordx4 v[8:11], v5, s[48:51], 0 offen
    s_mov_b32 s62, 20480
    s_mov_b32 s63, 30720
    s_branch L_poll_105
L_poll_105s:
    s_sleep 32
L_poll_105:
    buffer_load_dwordx4 v[12:15], v5, s[40:43], s62 offen sc1
    buffer_load_dwordx4 v[16:19], v5, s[40:43], s63 offen sc1
    s_sub_u32 s60, s60, 1
    s_cbranch_scc1 L_poll_105t
    s_waitcnt vmcnt(0)
    v_max3_u32 v38, v12, v13, v14
    v_max3_u32 v38, v38, v15, v16
    v_max3_u32 v38, v38, v17, v18
    v_max_u32 v38, v38, v19
    v_cmp_eq_u32 vcc, -1, v38
    s_cbranch_vccnz L_poll_105s
L_poll_105e:
    v_lshlrev_b32 v40, 16, v8
    v_and_b32 v41, 0xffff0000, v8
    v_lshlrev_b32 v42, 16, v9
    v_and_b32 v43, 0xffff0000, v9
    v_lshlrev_b32 v44, 16, v10
    v_and_b32 v45, 0xffff0000, v10
    v_lshlrev_b32 v46, 16, v11
    v_and_b32 v47, 0xffff0000, v11
    v_lshlrev_b32 v48, 16, v12
    v_and_b32 v49, 0xffff0000, v12
    v_lshlrev_b32 v50, 16, v13
    v_and_b32 v51, 0xffff0000, v13
    v_lshlrev_b32 v52, 16, v14
    v_and_b32 v53, 0xffff0000, v14
    v_lshlrev_b32 v54, 16, v15
    v_and_b32 v55, 0xffff0000, v15
    v_lshlrev_b32 v56, 16, v16
    v_and_b32 v57, 0xffff0000, v16
    v_lshlrev_b32 v58, 16, v17
    v_and_b32 v59, 0xffff0000, v17
    v_lshlrev_b32 v60, 16, v18
    v_and_b32 v61, 0xffff0000, v18
    v_lshlrev_b32 v62, 16, v19
    v_and_b32 v63, 0xffff0000, v19
    v_mov_b32 v64, 0
    v_mov_b32 v65, 0
    v_mov_b32 v66, 0
    v_mov_b32 v67, 0
    v_mov_b32 v68, 0
    v_mov_b32 v69, 0
    v_mov_b32 v70, 0
    v_mov_b32 v71, 0
    v_bfe_u32 v5, v0, 2, 2
    v_lshlrev_b32 v5, 8, v5
    v_lshrrev_b32 v8, 4, v0
    v_lshl_add_u32 v5, v8, 6, v5
    v_and_b32 v8, 3, v0
    v_lshl_add_u32 v5, v8, 4, v5
    s_lshl_b32 s56, s100, 10
    s_or_b32 s96, s59, s39
    s_cbranch_scc0 L_nofrag_106
    v_mov_b32 v104, 162060
L_lw_107:
    ds_read_b32 v105, v104
    s_waitcnt lgkmcnt(0)
    v_cmp_gt_u32 vcc, 4, v105
    s_cbranch_vccz L_lw_107e
    s_sleep 2
    s_sub_u32 s60, s60, 1
    s_cbranch_scc0 L_lw_107
    s_mov_b32 s60, 0
L_lw_107e:
    s_cmp_eq_u32 s59, 0
    s_cbranch_scc1 L_nofrag_106
    v_bfe_u32 v104, v0, 2, 1
    v_bfe_u32 v110, v0, 4, 1
    v_lshl_add_u32 v104, v110, 2, v104
    v_and_b32 v110, 8, v0
    v_add_u32 v104, v104, v110
    v_lshrrev_b32 v110, 5, v0
    v_lshl_add_u32 v104, v110, 4, v104
    v_bfe_u32 v111, v0, 0, 1
    v_mul_u32_u24 v111, 0xaaaa, v111
    v_add_u32 v111, 0x4444, v111
    v_mov_b32 v112, 0
    v_mov_b32 v113, 0
    v_mov_b32 v114, 0
    v_mov_b32 v115, 0
    v_mov_b32 v116, 0
    v_mov_b32 v117, 0
    v_mov_b32 v118, 0
    v_mov_b32 v119, 0
    v_lshlrev_b32 v104, 7, v104
    v_and_b32 v110, 3, v0
    v_lshl_add_u32 v104, v110, 3, v104
    v_lshrrev_b32 v109, 4, v0
    v_and_b32 v110, 1, v0
    s_lshr_b32 s63, s3, 1
    s_and_b32 s62, s3, 1
    s_lshl_b32 s96, s63, 14
    s_lshl_b32 s100, s62, 6
    s_add_u32 s100, s100, 81920
    s_add_u32 s96, s96, s100
    v_add_u32 v104, s96, v104
    ds_read_b64_tr_b16 v[72:73], v104 offset:0
    ds_read_b64_tr_b16 v[74:75], v104 offset:256
    ds_read_b64_tr_b16 v[76:77], v104 offset:4096
    ds_read_b64_tr_b16 v[78:79], v104 offset:4352
    ds_read_b64_tr_b16 v[80:81], v104 offset:32
    ds_read_b64_tr_b16 v[82:83], v104 offset:288
    ds_read_b64_tr_b16 v[84:85], v104 offset:4128
    ds_read_b64_tr_b16 v[86:87], v104 offset:4384
    ds_read_b64_tr_b16 v[88:89], v104 offset:8192
    ds_read_b64_tr_b16 v[90:91], v104 offset:8448
    ds_read_b64_tr_b16 v[92:93], v104 offset:12288
    ds_read_b64_tr_b16 v[94:95], v104 offset:12544
    ds_read_b64_tr_b16 v[96:97], v104 offset:8224
    ds_read_b64_tr_b16 v[98:99], v104 offset:8480
    ds_read_b64_tr_b16 v[100:101], v104 offset:12320
    ds_read_b64_tr_b16 v[102:103], v104 offset:12576
    v_bfe_u32 v105, v0, 1, 3
    v_lshlrev_b32 v105, 8, v105
    v_lshl_add_u32 v105, v109, 5, v105
    v_lshl_add_u32 v105, v110, 4, v105
    v_lshrrev_b32 v106, 3, v0
    v_lshlrev_b32 v106, 7, v106
    v_and_b32 v110, 7, v0
    v_lshl_add_u32 v107, v110, 3, v106
    v_add_u32 v107, s100, v107
    v_lshlrev_b32 v106, 8, v109
    v_and_b32 v110, 15, v0
    v_lshl_add_u32 v106, v110, 2, v106
    v_add_u32 v106, s96, v106
    v_lshlrev_b32 v108, 2, v0
    s_lshl_b32 s96, s62, 2
    s_add_u32 s96, s96, 162088
    v_mov_b32 v109, s96
    s_lshl_b32 s100, s63, 11
    s_lshl_b32 s96, s34, 13
    s_add_u32 s100, s100, s96
    s_add_u32 s100, s100, 90112
    s_mul_i32 s101, s34, 5120
    s_lshl_b32 s96, s35, 9
    s_add_u32 s101, s101, s96
    s_lshl_b32 s96, s62, 8
    s_add_u32 s101, s101, s96
    s_sub_u32 s101, s101, 11264
    s_and_b32 s96, s101, 0xffffe000
    s_add_u32 s101, s101, s96
    s_add_u32 s101, s101, 196608
    v_add_u32 v110, 8192, v108
L_nofrag_106:
    s_cmp_ge_u32 s35, 20
    s_cbranch_scc1 L_nofin_108
    s_lshl1_add_u32 s62, s35, s3
    s_sub_u32 s62, s62, 6
    s_lshl_b32 s57, s62, 7
    s_mul_i32 s63, s62, 0x199a
    s_lshr_b32 s63, s63, 16
    s_mul_i32 s63, s63, 1280
    s_sub_u32 s63, s57, s63
    v_lshrrev_b32 v72, 3, v0
    v_mul_u32_u24 v72, 5120, v72
    v_and_b32 v8, 7, v0
    v_lshl_add_u32 v72, v8, 4, v72
    s_add_u32 s62, s57, 294912
    v_add_u32 v72, s62, v72
    v_add_u32 v73, 40960, v72
    v_add_u32 v74, 81920, v72
    v_add_u32 v75, 122880, v72
    v_bfe_u32 v9, v0, 4, 1
    v_lshlrev_b32 v76, 4, v8
    v_lshl_add_u32 v76, v9, 3, v76
    s_lshl_b32 s62, s57, 1
    s_add_u32 s62, s62, 99328
    v_lshl_add_u32 v77, v76, 1, s62
    s_mov_b32 s48, s22
    s_mov_b32 s49, s23
    s_mov_b32 s50, 1280
    s_mov_b32 s51, 0x20000
    buffer_load_dwordx2 v[86:87], v76, s[48:51], s63 offen
    s_add_u32 s62, s57, 35840
    s_branch L_poll_109
L_poll_109s:
    s_sleep 32
L_poll_109:
    buffer_load_dwordx2 v[8:9], v76, s[40:43], s62 offen sc1
    s_sub_u32 s60, s60, 1
    s_cbranch_scc1 L_poll_109t
    s_waitcnt vmcnt(0)
    v_max_u32 v38, v8, v9
    v_cmp_eq_u32 vcc, -1, v38
    s_cbranch_vccnz L_poll_109s
L_poll_109e:
    v_lshlrev_b32 v78, 16, v86
    v_and_b32 v79, 0xffff0000, v86
    v_lshlrev_b32 v82, 16, v8
    v_and_b32 v83, 0xffff0000, v8
    v_lshlrev_b32 v80, 16, v87
    v_and_b32 v81, 0xffff0000, v87
    v_lshlrev_b32 v84, 16, v9
    v_and_b32 v85, 0xffff0000, v9
    v_bfe_u32 v8, v0, 1, 3
    v_and_b32 v9, 1, v0
    v_lshlrev_b32 v9, 4, v9
    v_mov_b32 v10, 0x3f80
    v_lshlrev_b32 v9, v9, v10
    v_cmp_eq_u32 vcc, 0, v8
    v_mov_b32 v100, 0
    s_nop 0
    v_cndmask_b32 v104, 0, v9, vcc
    v_cmp_eq_u32 vcc, 1, v8
    v_mov_b32 v101, 0
    s_nop 0
    v_cndmask_b32 v105, 0, v9, vcc
    v_cmp_eq_u32 vcc, 2, v8
    v_mov_b32 v102, 0
    s_nop 0
    v_cndmask_b32 v106, 0, v9, vcc
    v_cmp_eq_u32 vcc, 3, v8
    v_mov_b32 v103, 0
    s_nop 0
    v_cndmask_b32 v107, 0, v9, vcc
L_nofin_108:
    v_mov_b32 v12, 162076
L_lw_110:
    ds_read_b32 v13, v12
    s_waitcnt lgkmcnt(0)
    v_cmp_gt_u32 vcc, 4, v13
    s_cbranch_vccz L_lw_110e
    s_sleep 4
    s_sub_u32 s60, s60, 1
    s_cbranch_scc0 L_lw_110
    s_mov_b32 s60, 0
L_lw_110e:
    v_and_b32 v11, 31, v0
    v_lshlrev_b32 v11, 2, v11
    s_lshl_b32 s63, s34, 7
    s_add_u32 s63, s63, 188416
    buffer_load_dword v12, v39, s[40:43], s98 offen sc1
    s_branch L_poll_111
L_poll_111s:
    s_sleep 4
L_poll_111:
    buffer_load_dwordx2 v[8:9], v2, s[40:43], s99 offen sc1
    buffer_load_dword v10, v11, s[40:43], s63 offen sc1
    buffer_load_dwordx4 v[32:35], v20, s[40:43], s97 offen sc1
    s_sub_u32 s60, s60, 1
    s_cbranch_scc1 L_poll_111t
    s_waitcnt vmcnt(0)
    v_max3_u32 v38, v8, v9, v10
    v_max3_u32 v38, v38, v32, v33
    v_max3_u32 v38, v38, v34, v35
    v_cmp_eq_u32 vcc, -1, v38
    s_cbranch_vccnz L_poll_111s
L_poll_111e:
    v_mov_b32 v37, v8
    s_nop 1
    v_max_f32_dpp v37, v37, v37 quad_perm:[1,0,3,2] row_mask:0xf bank_mask:0xf
    s_nop 1
    v_max_f32_dpp v37, v37, v37 quad_perm:[2,3,0,1] row_mask:0xf bank_mask:0xf
    s_nop 1
    v_max_f32_dpp v37, v37, v37 row_ror:4 row_mask:0xf bank_mask:0xf
    s_nop 1
    v_max_f32_dpp v37, v37, v37 row_ror:8 row_mask:0xf bank_mask:0xf
    v_sub_f32 v8, v8, v37
    v_exp_f32 v8, v8
    s_nop 0
    v_mul_f32 v9, v8, v9
    s_nop 1
    v_add_f32_dpp v9, v9, v9 quad_perm:[1,0,3,2] row_mask:0xf bank_mask:0xf
    s_nop 1
    v_add_f32_dpp v9, v9, v9 quad_perm:[2,3,0,1] row_mask:0xf bank_mask:0xf
    s_nop 1
    v_add_f32_dpp v9, v9, v9 row_ror:4 row_mask:0xf bank_mask:0xf
    s_nop 1
    v_add_f32_dpp v9, v9, v9 row_ror:8 row_mask:0xf bank_mask:0xf
    v_ashrrev_i32 v12, 8, v10
    s_nop 1
    v_add_u32_dpp v12, v12, v12 quad_perm:[1,0,3,2] row_mask:0xf bank_mask:0xf
    s_nop 1
    v_add_u32_dpp v12, v12, v12 quad_perm:[2,3,0,1] row_mask:0xf bank_mask:0xf
    s_nop 1
    v_add_u32_dpp v12, v12, v12 row_ror:4 row_mask:0xf bank_mask:0xf
    s_nop 1
    v_add_u32_dpp v12, v12, v12 row_ror:8 row_mask:0xf bank_mask:0xf
    v_mov_b32 v13, v12
    s_nop 1
    v_permlane16_swap_b32 v12, v13
    v_add_u32 v12, v12, v13
    v_mov_b32 v13, v12
    s_nop 1
    v_permlane32_swap_b32 v12, v13
    v_add_u32 v12, v12, v13
    v_ashrrev_i32 v12, 31, v12
    v_and_b32 v12, 8192, v12
    v_mov_b32 v13, 162084
    ds_write_b32 v13, v12
    v_and_b32 v10, 0xff, v10
    s_getreg_b32 s62, hwreg(HW_REG_XCC_ID, 0, 4)
    v_cmp_ne_u32 vcc, s62, v10
    s_nop 0
    s_cmp_eq_u64 vcc, 0
    s_cselect_b32 s61, 1, 0
    v_rcp_f32 v9, v9
    v_lshrrev_b32 v3, 1, v2
    v_add_u32 v3, 161984, v3
    v_mul_f32 v8, v8, v9
    v_mov_b32 v10, 162072
    v_mov_b32 v11, s61
    ds_write_b32 v3, v8
    ds_write_b32 v10, v11
    s_branch L_pxj
L_px6:
    s_mov_b32 s62, 3
    s_lshl1_add_u32 s96, s35, s3
    s_and_b32 s63, s96, 7
    s_lshl_b32 s63, s63, 14
    s_lshl_b32 s96, s96, 7
    s_add_u32 s96, s96, s63
    s_add_u32 s96, s96, 458752
    s_add_u32 s98, s32, s96
    s_addc_u32 s99, s33, 0
    s_load_dword s4, s[98:99], 0 glc
    s_load_dword s5, s[98:99], 8192 glc
    s_mov_b32 s63, 0
    s_waitcnt lgkmcnt(0)
L_np:
    s_not_b32 s4, s4
    s_mov_b32 s6, s4
    s_mov_b32 s7, 0
    s_load_dword s4, s[98:99], 0 glc
L_npc0:
    s_add_u32 s7, s7, 1
    s_cmp_eq_u32 s4, s6
    s_cselect_b32 s8, s7, 1000
    s_cmp_lt_u32 s8, 60
    s_cbranch_scc1 L_npc0
    s_waitcnt lgkmcnt(0)
    s_sub_u32 s63, s63, s7
    s_not_b32 s5, s5
    s_mov_b32 s6, s5
    s_mov_b32 s7, 0
    s_load_dword s5, s[98:99], 8192 glc
L_npc1:
    s_add_u32 s7, s7, 1
    s_cmp_eq_u32 s5, s6
    s_cselect_b32 s8, s7, 1000
    s_cmp_lt_u32 s8, 60
    s_cbranch_scc1 L_npc1
    s_waitcnt lgkmcnt(0)
    s_add_u32 s63, s63, s7
    s_sub_u32 s62, s62, 1
    s_cmp_lg_u32 s62, 0
    s_cbranch_scc1 L_np
    v_mov_b32 v8, 162096
    v_mov_b32 v9, s63
    s_mov_b64 exec, 1
    ds_add_u32 v8, v9
    s_mov_b64 exec, -1
    s_or_b32 s96, s59, s39
    s_cbranch_scc0 L_nofrag_112
    v_mov_b32 v104, 162060
L_lw_113:
    ds_read_b32 v105, v104
    s_waitcnt lgkmcnt(0)
    v_cmp_gt_u32 vcc, 4, v105
    s_cbranch_vccz L_lw_113e
    s_sleep 2
    s_sub_u32 s60, s60, 1
    s_cbranch_scc0 L_lw_113
    s_mov_b32 s60, 0
L_lw_113e:
    s_cmp_eq_u32 s59, 0
    s_cbranch_scc1 L_nofrag_112
    v_bfe_u32 v104, v0, 2, 1
    v_bfe_u32 v110, v0, 4, 1
    v_lshl_add_u32 v104, v110, 2, v104
    v_and_b32 v110, 8, v0
    v_add_u32 v104, v104, v110
    v_lshrrev_b32 v110, 5, v0
    v_lshl_add_u32 v104, v110, 4, v104
    v_bfe_u32 v111, v0, 0, 1
    v_mul_u32_u24 v111, 0xaaaa, v111
    v_add_u32 v111, 0x4444, v111
    v_mov_b32 v112, 0
    v_mov_b32 v113, 0
    v_mov_b32 v114, 0
    v_mov_b32 v115, 0
    v_mov_b32 v116, 0
    v_mov_b32 v117, 0
    v_mov_b32 v118, 0
    v_mov_b32 v119, 0
    v_lshlrev_b32 v104, 7, v104
    v_and_b32 v110, 3, v0
    v_lshl_add_u32 v104, v110, 3, v104
    v_lshrrev_b32 v109, 4, v0
    v_and_b32 v110, 1, v0
    s_lshr_b32 s63, s3, 1
    s_and_b32 s62, s3, 1
    s_lshl_b32 s96, s63, 14
    s_lshl_b32 s100, s62, 6
    s_add_u32 s100, s100, 81920
    s_add_u32 s96, s96, s100
    v_add_u32 v104, s96, v104
    ds_read_b64_tr_b16 v[72:73], v104 offset:0
    ds_read_b64_tr_b16 v[74:75], v104 offset:256
    ds_read_b64_tr_b16 v[76:77], v104 offset:4096
    ds_read_b64_tr_b16 v[78:79], v104 offset:4352
    ds_read_b64_tr_b16 v[80:81], v104 offset:32
    ds_read_b64_tr_b16 v[82:83], v104 offset:288
    ds_read_b64_tr_b16 v[84:85], v104 offset:4128
    ds_read_b64_tr_b16 v[86:87], v104 offset:4384
    ds_read_b64_tr_b16 v[88:89], v104 offset:8192
    ds_read_b64_tr_b16 v[90:91], v104 offset:8448
    ds_read_b64_tr_b16 v[92:93], v104 offset:12288
    ds_read_b64_tr_b16 v[94:95], v104 offset:12544
    ds_read_b64_tr_b16 v[96:97], v104 offset:8224
    ds_read_b64_tr_b16 v[98:99], v104 offset:8480
    ds_read_b64_tr_b16 v[100:101], v104 offset:12320
    ds_read_b64_tr_b16 v[102:103], v104 offset:12576
    v_bfe_u32 v105, v0, 1, 3
    v_lshlrev_b32 v105, 8, v105
    v_lshl_add_u32 v105, v109, 5, v105
    v_lshl_add_u32 v105, v110, 4, v105
    v_lshrrev_b32 v106, 3, v0
    v_lshlrev_b32 v106, 7, v106
    v_and_b32 v110, 7, v0
    v_lshl_add_u32 v107, v110, 3, v106
    v_add_u32 v107, s100, v107
    v_lshlrev_b32 v106, 8, v109
    v_and_b32 v110, 15, v0
    v_lshl_add_u32 v106, v110, 2, v106
    v_add_u32 v106, s96, v106
    v_lshlrev_b32 v108, 2, v0
    s_lshl_b32 s96, s62, 2
    s_add_u32 s96, s96, 162088
    v_mov_b32 v109, s96
    s_lshl_b32 s100, s63, 11
    s_lshl_b32 s96, s34, 13
    s_add_u32 s100, s100, s96
    s_add_u32 s100, s100, 90112
    s_mul_i32 s101, s34, 5120
    s_lshl_b32 s96, s35, 9
    s_add_u32 s101, s101, s96
    s_lshl_b32 s96, s62, 8
    s_add_u32 s101, s101, s96
    s_sub_u32 s101, s101, 11264
    s_and_b32 s96, s101, 0xffffe000
    s_add_u32 s101, s101, s96
    s_add_u32 s101, s101, 196608
    v_add_u32 v110, 8192, v108
L_nofrag_112:
    v_mov_b32 v8, 162068
L_lw_114:
    ds_read_b32 v9, v8
    s_waitcnt lgkmcnt(0)
    v_cmp_gt_u32 vcc, 1, v9
    s_cbranch_vccz L_lw_114e
    s_sleep 32
    s_sub_u32 s60, s60, 1
    s_cbranch_scc0 L_lw_114
    s_mov_b32 s60, 0
L_lw_114e:
    s_cmp_ge_u32 s35, 20
    s_cbranch_scc1 L_nofin_115
    s_lshl1_add_u32 s62, s35, s3
    s_sub_u32 s62, s62, 6
    s_lshl_b32 s57, s62, 7
    s_mul_i32 s63, s62, 0x199a
    s_lshr_b32 s63, s63, 16
    s_mul_i32 s63, s63, 1280
    s_sub_u32 s63, s57, s63
    v_lshrrev_b32 v72, 3, v0
    v_mul_u32_u24 v72, 5120, v72
    v_and_b32 v8, 7, v0
    v_lshl_add_u32 v72, v8, 4, v72
    s_add_u32 s62, s57, 294912
    v_add_u32 v72, s62, v72
    v_add_u32 v73, 40960, v72
    v_add_u32 v74, 81920, v72
    v_add_u32 v75, 122880, v72
    v_bfe_u32 v9, v0, 4, 1
    v_lshlrev_b32 v76, 4, v8
    v_lshl_add_u32 v76, v9, 3, v76
    s_lshl_b32 s62, s57, 1
    s_add_u32 s62, s62, 99328
    v_lshl_add_u32 v77, v76, 1, s62
    s_mov_b32 s48, s22
    s_mov_b32 s49, s23
    s_mov_b32 s50, 1280
    s_mov_b32 s51, 0x20000
    buffer_load_dwordx2 v[86:87], v76, s[48:51], s63 offen
    s_add_u32 s62, s57, 35840
    s_branch L_poll_116
L_poll_116s:
    s_sleep 32
L_poll_116:
    buffer_load_dwordx2 v[8:9], v76, s[40:43], s62 offen sc1
    s_sub_u32 s60, s60, 1
    s_cbranch_scc1 L_poll_116t
    s_waitcnt vmcnt(0)
    v_max_u32 v38, v8, v9
    v_cmp_eq_u32 vcc, -1, v38
    s_cbranch_vccnz L_poll_116s
L_poll_116e:
    v_lshlrev_b32 v78, 16, v86
    v_and_b32 v79, 0xffff0000, v86
    v_lshlrev_b32 v82, 16, v8
    v_and_b32 v83, 0xffff0000, v8
    v_lshlrev_b32 v80, 16, v87
    v_and_b32 v81, 0xffff0000, v87
    v_lshlrev_b32 v84, 16, v9
    v_and_b32 v85, 0xffff0000, v9
    v_bfe_u32 v8, v0, 1, 3
    v_and_b32 v9, 1, v0
    v_lshlrev_b32 v9, 4, v9
    v_mov_b32 v10, 0x3f80
    v_lshlrev_b32 v9, v9, v10
    v_cmp_eq_u32 vcc, 0, v8
    v_mov_b32 v100, 0
    s_nop 0
    v_cndmask_b32 v104, 0, v9, vcc
    v_cmp_eq_u32 vcc, 1, v8
    v_mov_b32 v101, 0
    s_nop 0
    v_cndmask_b32 v105, 0, v9, vcc
    v_cmp_eq_u32 vcc, 2, v8
    v_mov_b32 v102, 0
    s_nop 0
    v_cndmask_b32 v106, 0, v9, vcc
    v_cmp_eq_u32 vcc, 3, v8
    v_mov_b32 v103, 0
    s_nop 0
    v_cndmask_b32 v107, 0, v9, vcc
L_nofin_115:
    v_mov_b32 v8, 162076
L_lw_117:
    ds_read_b32 v9, v8
    s_waitcnt lgkmcnt(0)
    v_cmp_gt_u32 vcc, 4, v9
    s_cbranch_vccz L_lw_117e
    s_sleep 16
    s_sub_u32 s60, s60, 1
    s_cbranch_scc0 L_lw_117
    s_mov_b32 s60, 0
L_lw_117e:
    s_branch L_poll_118
L_poll_118s:
    s_sleep 4
L_poll_118:
    buffer_load_dwordx4 v[32:35], v20, s[40:43], s97 offen sc1
    s_sub_u32 s60, s60, 1
    s_cbranch_scc1 L_poll_118t
    s_waitcnt vmcnt(0)
    v_max3_u32 v38, v32, v33, v34
    v_max_u32 v38, v38, v35
    v_cmp_eq_u32 vcc, -1, v38
    s_cbranch_vccnz L_poll_118s
L_poll_118e:
L_pxj:
    s_cmp_ge_u32 s35, 20
    s_cbranch_scc1 L_pxk
    buffer_load_dwordx4 v[88:91], v72, s[40:43], 0 offen sc1
    buffer_load_dwordx4 v[92:95], v73, s[40:43], 0 offen sc1
    buffer_load_dwordx4 v[96:99], v74, s[40:43], 0 offen sc1
    s_mov_b64 exec, 0xffffff
    buffer_load_dwordx4 v[100:103], v75, s[40:43], 0 offen sc1
    s_mov_b64 exec, -1
L_pxk:
    v_mov_b32 v8, 162048
L_lw_119:
    ds_read_b32 v9, v8
    s_waitcnt lgkmcnt(0)
    v_cmp_gt_u32 vcc, 3, v9
    s_cbranch_vccz L_lw_119e
    s_sleep 2
    s_sub_u32 s60, s60, 1
    s_cbranch_scc0 L_lw_119
    s_mov_b32 s60, 0
L_lw_119e:
    v_lshrrev_b32 v9, 4, v0
    v_lshl_add_u32 v8, v9, 2, v2
    s_lshl_b32 s96, s3, 9
    s_add_u32 s96, s96, 157824
    v_lshl_add_u32 v8, v8, 2, s96
    v_lshlrev_b32 v9, 3, v0
    v_add_u32 v9, 157824, v9
    v_mov_b32 v10, 162048
    v_mov_b32 v11, 1
    s_lshl_b32 s96, s38, 5
    s_add_u32 s96, s96, 161984
    v_mov_b32 v3, s96
    s_sub_u32 s62, 8, s39
    s_lshl_b32 s98, s34, 5
    s_add_u32 s98, s98, s35
    s_lshl_b32 s98, s98, 8
    s_add_u32 s98, s98, 90112
    v_lshlrev_b32 v39, 2, v0
    s_branch L_t0
L_s_role:
    s_cmp_eq_u32 s3, 7
    s_cbranch_scc1 L_t2gate
    s_cmp_gt_u32 s3, 3
    s_cbranch_scc1 L_fin_prep
    s_mov_b32 s48, s18
    s_mov_b32 s49, s19
    s_mov_b32 s50, 3456
    s_mov_b32 s51, 0x20000
    v_lshrrev_b32 v3, 4, v0
    v_and_b32 v4, 15, v0
    v_lshlrev_b32 v4, 1, v4
    s_lshl_b32 s62, s35, 7
    s_lshl_b32 s63, s3, 5
    s_add_u32 s62, s62, s63
    buffer_load_ushort v82, v4, s[48:51], s62 offen
    v_mov_b32 v72, 162064
L_lw_120:
    ds_read_b32 v73, v72
    s_waitcnt lgkmcnt(0)
    v_cmp_gt_u32 vcc, 4, v73
    s_cbranch_vccz L_lw_120e
    s_sleep 2
    s_sub_u32 s60, s60, 1
    s_cbranch_scc0 L_lw_120
    s_mov_b32 s60, 0
L_lw_120e:
    v_bfe_u32 v72, v0, 2, 1
    v_bfe_u32 v73, v0, 4, 1
    v_lshl_add_u32 v72, v73, 2, v72
    v_and_b32 v73, 8, v0
    v_add_u32 v72, v72, v73
    v_lshrrev_b32 v73, 5, v0
    v_lshl_add_u32 v72, v73, 4, v72
    v_lshlrev_b32 v72, 7, v72
    v_and_b32 v73, 3, v0
    v_lshl_add_u32 v72, v73, 3, v72
    v_and_b32 v73, 8, v0
    v_lshl_add_u32 v72, v73, 3, v72
    v_xor_b32 v72, s63, v72
    v_xor_b32 v73, 32, v72
    v_add_u32 v74, 40960, v72
    v_add_u32 v75, 40960, v73
    v_bfe_u32 v1, v0, 2, 2
    v_bfe_u32 v2, v0, 1, 1
    v_and_b32 v6, 1, v0
    v_lshlrev_b32 v7, 5, v3
    v_lshl_add_u32 v7, v6, 4, v7
    v_lshl_add_u32 v5, v2, 2, v1
    v_mul_u32_u24 v5, 1296, v5
    v_add_u32 v5, v5, v7
    v_add_u32 v5, 147456, v5
    v_bfe_u32 v87, v0, 0, 1
    v_mul_u32_u24 v87, 0xaaaa, v87
    v_add_u32 v87, 0x4444, v87
    ds_read_b64_tr_b16 v[88:89], v72 offset:0
    ds_read_b64_tr_b16 v[90:91], v73 offset:256
    ds_read_b64_tr_b16 v[92:93], v72 offset:4096
    ds_read_b64_tr_b16 v[94:95], v73 offset:4352
    ds_read_b64_tr_b16 v[96:97], v72 offset:8192
    ds_read_b64_tr_b16 v[98:99], v73 offset:8448
    ds_read_b64_tr_b16 v[100:101], v72 offset:12288
    ds_read_b64_tr_b16 v[102:103], v73 offset:12544
    ds_read_b64_tr_b16 v[104:105], v72 offset:16384
    ds_read_b64_tr_b16 v[106:107], v73 offset:16640
    ds_read_b64_tr_b16 v[108:109], v72 offset:20480
    ds_read_b64_tr_b16 v[110:111], v73 offset:20736
    ds_read_b64_tr_b16 v[112:113], v72 offset:24576
    ds_read_b64_tr_b16 v[114:115], v73 offset:24832
    ds_read_b64_tr_b16 v[116:117], v72 offset:28672
    ds_read_b64_tr_b16 v[118:119], v73 offset:28928
    ds_read_b64_tr_b16 v[120:121], v72 offset:32768
    ds_read_b64_tr_b16 v[122:123], v73 offset:33024
    ds_read_b64_tr_b16 v[124:125], v72 offset:36864
    ds_read_b64_tr_b16 v[126:127], v73 offset:37120
    ds_read_b64_tr_b16 v[128:129], v74 offset:0
    ds_read_b64_tr_b16 v[130:131], v75 offset:256
    ds_read_b64_tr_b16 v[132:133], v74 offset:4096
    ds_read_b64_tr_b16 v[134:135], v75 offset:4352
    ds_read_b64_tr_b16 v[136:137], v74 offset:8192
    ds_read_b64_tr_b16 v[138:139], v75 offset:8448
    ds_read_b64_tr_b16 v[140:141], v74 offset:12288
    ds_read_b64_tr_b16 v[142:143], v75 offset:12544
    ds_read_b64_tr_b16 v[144:145], v74 offset:16384
    ds_read_b64_tr_b16 v[146:147], v75 offset:16640
    ds_read_b64_tr_b16 v[148:149], v74 offset:20480
    ds_read_b64_tr_b16 v[150:151], v75 offset:20736
    ds_read_b64_tr_b16 v[152:153], v74 offset:24576
    ds_read_b64_tr_b16 v[154:155], v75 offset:24832
    ds_read_b64_tr_b16 v[156:157], v74 offset:28672
    ds_read_b64_tr_b16 v[158:159], v75 offset:28928
    ds_read_b64_tr_b16 v[160:161], v74 offset:32768
    ds_read_b64_tr_b16 v[162:163], v75 offset:33024
    ds_read_b64_tr_b16 v[164:165], v74 offset:36864
    ds_read_b64_tr_b16 v[166:167], v75 offset:37120
    ds_read_b128 v[8:11], v5 offset:0
    ds_read_b128 v[12:15], v5 offset:128
    ds_read_b128 v[16:19], v5 offset:256
    ds_read_b128 v[20:23], v5 offset:384
    ds_read_b128 v[24:27], v5 offset:512
    ds_read_b128 v[28:31], v5 offset:640
    ds_read_b128 v[32:35], v5 offset:768
    ds_read_b128 v[36:39], v5 offset:896
    ds_read_b128 v[40:43], v5 offset:1024
    ds_read_b128 v[44:47], v5 offset:1152
    v_mov_b32 v48, 0
    v_mov_b32 v49, 0
    v_mov_b32 v50, 0
    v_mov_b32 v51, 0
    v_mov_b32 v52, 0
    v_mov_b32 v53, 0
    v_mov_b32 v54, 0
    v_mov_b32 v55, 0
    v_mov_b32 v56, 0
    v_mov_b32 v57, 0
    v_mov_b32 v58, 0
    v_mov_b32 v59, 0
    s_waitcnt lgkmcnt(9)
    v_smfmac_f32_16x16x64_bf16 v[48:51], v[8:11], v[88:95], v87
    s_waitcnt lgkmcnt(8)
    v_smfmac_f32_16x16x64_bf16 v[48:51], v[12:15], v[96:103], v87
    s_waitcnt lgkmcnt(7)
    v_smfmac_f32_16x16x64_bf16 v[48:51], v[16:19], v[104:111], v87
    s_waitcnt lgkmcnt(6)
    v_smfmac_f32_16x16x64_bf16 v[48:51], v[20:23], v[112:119], v87
    s_waitcnt lgkmcnt(5)
    v_smfmac_f32_16x16x64_bf16 v[48:51], v[24:27], v[120:127], v87
    s_waitcnt lgkmcnt(4)
    v_smfmac_f32_16x16x64_bf16 v[48:51], v[28:31], v[128:135], v87
    s_waitcnt lgkmcnt(3)
    v_smfmac_f32_16x16x64_bf16 v[48:51], v[32:35], v[136:143], v87
    s_waitcnt lgkmcnt(2)
    v_smfmac_f32_16x16x64_bf16 v[48:51], v[36:39], v[144:151], v87
    s_waitcnt lgkmcnt(1)
    v_smfmac_f32_16x16x64_bf16 v[48:51], v[40:43], v[152:159], v87
    s_waitcnt lgkmcnt(0)
    v_smfmac_f32_16x16x64_bf16 v[48:51], v[44:47], v[160:167], v87
    v_mul_u32_u24 v79, 1296, v1
    v_lshl_add_u32 v79, v2, 7, v79
    v_add_u32 v79, v79, v7
    v_add_u32 v79, 82944, v79
    v_mul_u32_u24 v80, 144, v3
    v_add3_u32 v80, v80, v4, s63
    v_add_u32 v80, 90688, v80
    v_lshlrev_b32 v81, 3, v0
    v_add_u32 v81, 88128, v81
    v_add_f32 v84, v48, v49
    v_add_f32 v85, v50, v51
    s_mov_b32 s62, 0xbacccccd
    s_mov_b32 s63, 0xbdd2d3e8
    v_mov_b32 v86, 0xc0135761
    s_waitcnt vmcnt(0)
    v_lshlrev_b32 v82, 16, v82
    v_add_f32 v85, v85, v82
    s_branch L_ffn1
L_fin_prep:
    s_cmp_lg_u32 s3, 6
    s_cbranch_scc1 L_end
    s_cmp_ge_u32 s35, 20
    s_cbranch_scc1 L_end
    s_barrier
L_fin:
    s_mov_b32 s52, s28
    s_mov_b32 s53, s29
    s_mov_b32 s54, 5120
    s_mov_b32 s55, 0x20000
    s_mov_b64 s[4:5], -1
    s_mov_b64 s[6:7], -1
    s_mov_b64 s[8:9], -1
    s_mov_b64 s[10:11], 0xffffff
    s_barrier
    ds_read_b128 v[108:111], v77
    s_barrier
L_yg:
    s_mov_b64 exec, s[4:5]
    buffer_load_dwordx4 v[88:91], v72, s[40:43], 0 offen sc1
    s_mov_b64 exec, s[6:7]
    buffer_load_dwordx4 v[92:95], v73, s[40:43], 0 offen sc1
    s_mov_b64 exec, s[8:9]
    buffer_load_dwordx4 v[96:99], v74, s[40:43], 0 offen sc1
    s_mov_b64 exec, s[10:11]
    buffer_load_dwordx4 v[100:103], v75, s[40:43], 0 offen sc1
    s_mov_b64 exec, -1
    s_sub_u32 s60, s60, 1
    s_cbranch_scc1 L_ygt
    s_waitcnt vmcnt(3)
    v_max3_u32 v3, v88, v89, v90
    v_max_u32 v3, v3, v91
    v_cmp_eq_u32 s[4:5], -1, v3
    s_waitcnt vmcnt(2)
    v_max3_u32 v3, v92, v93, v94
    v_max_u32 v3, v3, v95
    v_cmp_eq_u32 s[6:7], -1, v3
    s_waitcnt vmcnt(1)
    v_max3_u32 v3, v96, v97, v98
    v_max_u32 v3, v3, v99
    v_cmp_eq_u32 s[8:9], -1, v3
    s_waitcnt vmcnt(0)
    v_max3_u32 v3, v100, v101, v102
    v_max_u32 v3, v3, v103
    v_cmp_eq_u32 s[10:11], -1, v3
    s_or_b64 s[16:17], s[4:5], s[6:7]
    s_or_b64 s[16:17], s[16:17], s[8:9]
    s_or_b64 s[16:17], s[16:17], s[10:11]
    s_cbranch_scc1 L_yg
L_ygd:
    v_mfma_f32_16x16x32_bf16 v[112:115], v[104:107], v[88:91], 0
    v_mfma_f32_16x16x32_bf16 v[112:115], v[104:107], v[92:95], v[112:115]
    v_mfma_f32_16x16x32_bf16 v[112:115], v[104:107], v[96:99], v[112:115]
    v_mfma_f32_16x16x32_bf16 v[112:115], v[104:107], v[100:103], v[112:115]
    s_waitcnt lgkmcnt(0)
    v_pk_fma_f32 v[108:109], v[78:79], v[82:83], v[108:109]
    v_pk_fma_f32 v[110:111], v[80:81], v[84:85], v[110:111]
    s_nop 4
    v_add_f32_dpp v112, v112, v112 row_ror:8 row_mask:0xf bank_mask:0xf
    v_add_f32_dpp v113, v113, v113 row_ror:8 row_mask:0xf bank_mask:0xf
    v_add_f32_dpp v114, v114, v114 row_ror:8 row_mask:0xf bank_mask:0xf
    v_add_f32_dpp v115, v115, v115 row_ror:8 row_mask:0xf bank_mask:0xf
    v_pk_fma_f32 v[112:113], v[112:113], v[82:83], v[108:109]
    v_pk_fma_f32 v[114:115], v[114:115], v[84:85], v[110:111]
    v_cvt_pk_bf16_f32 v112, v112, v113
    v_cvt_pk_bf16_f32 v113, v114, v115
    s_mov_b64 exec, 0x00ff00ff
    buffer_store_dwordx2 v[112:113], v76, s[52:55], s57 offen
    s_endpgm
L_t2gate:
    v_mov_b32 v8, 162048
L_lw_121:
    ds_read_b32 v9, v8
    s_waitcnt lgkmcnt(0)
    v_cmp_gt_u32 vcc, 8, v9
    s_cbranch_vccz L_lw_121e
    s_sleep 2
    s_sub_u32 s60, s60, 1
    s_cbranch_scc0 L_lw_121
    s_mov_b32 s60, 0
L_lw_121e:
    ds_read_b32 v9, v8 offset:24
    ds_read_b32 v10, v8 offset:36
    v_add_u32 v5, 196608, v5
    s_waitcnt lgkmcnt(0)
    v_readfirstlane_b32 s61, v9
    v_add_u32 v5, v5, v10
    s_mov_b32 s58, 0x3f80
    s_mov_b32 s59, 0x3f800000
    s_mov_b32 s63, 0xff
L_prb:
    s_bcnt1_i32_b32 s62, s63
    s_mov_b32 s97, s63
    s_ff1_i32_b32 s12, s97
    s_bitset0_b32 s97, s12
    s_mul_i32 s4, s12, 5120
    s_add_u32 s4, s4, s56
    s_and_b32 s96, s4, 0xffffe000
    s_add_u32 s4, s4, s96
    s_cmp_eq_u32 s62, 1
    s_cbranch_scc1 L_pi1
    s_ff1_i32_b32 s13, s97
    s_bitset0_b32 s97, s13
    s_mul_i32 s5, s13, 5120
    s_add_u32 s5, s5, s56
    s_and_b32 s96, s5, 0xffffe000
    s_add_u32 s5, s5, s96
    s_cmp_eq_u32 s62, 2
    s_cbranch_scc1 L_pi2
    s_ff1_i32_b32 s14, s97
    s_bitset0_b32 s97, s14
    s_mul_i32 s6, s14, 5120
    s_add_u32 s6, s6, s56
    s_and_b32 s96, s6, 0xffffe000
    s_add_u32 s6, s6, s96
    s_cmp_eq_u32 s62, 3
    s_cbranch_scc1 L_pi3
    s_ff1_i32_b32 s15, s97
    s_bitset0_b32 s97, s15
    s_mul_i32 s7, s15, 5120
    s_add_u32 s7, s7, s56
    s_and_b32 s96, s7, 0xffffe000
    s_add_u32 s7, s7, s96
    s_cmp_eq_u32 s62, 4
    s_cbranch_scc1 L_pi4
    s_ff1_i32_b32 s16, s97
    s_bitset0_b32 s97, s16
    s_mul_i32 s8, s16, 5120
    s_add_u32 s8, s8, s56
    s_and_b32 s96, s8, 0xffffe000
    s_add_u32 s8, s8, s96
    s_cmp_eq_u32 s62, 5
    s_cbranch_scc1 L_pi5
    s_ff1_i32_b32 s17, s97
    s_bitset0_b32 s97, s17
    s_mul_i32 s9, s17, 5120
    s_add_u32 s9, s9, s56
    s_and_b32 s96, s9, 0xffffe000
    s_add_u32 s9, s9, s96
    s_cmp_eq_u32 s62, 6
    s_cbranch_scc1 L_pi6
    s_ff1_i32_b32 s18, s97
    s_bitset0_b32 s97, s18
    s_mul_i32 s10, s18, 5120
    s_add_u32 s10, s10, s56
    s_and_b32 s96, s10, 0xffffe000
    s_add_u32 s10, s10, s96
    s_cmp_eq_u32 s62, 7
    s_cbranch_scc1 L_pi7
    s_ff1_i32_b32 s19, s97
    s_bitset0_b32 s97, s19
    s_mul_i32 s11, s19, 5120
    s_add_u32 s11, s11, s56
    s_and_b32 s96, s11, 0xffffe000
    s_add_u32 s11, s11, s96
L_pi8:
    buffer_load_dwordx4 v[36:39], v5, s[40:43], s11 offen sc1
L_pi7:
    buffer_load_dwordx4 v[32:35], v5, s[40:43], s10 offen sc1
L_pi6:
    buffer_load_dwordx4 v[28:31], v5, s[40:43], s9 offen sc1
L_pi5:
    buffer_load_dwordx4 v[24:27], v5, s[40:43], s8 offen sc1
L_pi4:
    buffer_load_dwordx4 v[20:23], v5, s[40:43], s7 offen sc1
L_pi3:
    buffer_load_dwordx4 v[16:19], v5, s[40:43], s6 offen sc1
L_pi2:
    buffer_load_dwordx4 v[12:15], v5, s[40:43], s5 offen sc1
    buffer_load_dwordx4 v[8:11], v5, s[40:43], s4 offen sc1
    s_sub_u32 s60, s60, 1
    s_cbranch_scc1 L_pto
    s_waitcnt vmcnt(0)
    v_max3_u32 v3, v8, v9, v10
    v_max_u32 v3, v3, v11
    v_cmp_eq_u32 vcc, -1, v3
    s_cbranch_vccz L_pgot0
    v_max3_u32 v3, v12, v13, v14
    v_max_u32 v3, v3, v15
    v_cmp_eq_u32 vcc, -1, v3
    s_cbranch_vccz L_pgot1
    s_cmp_eq_u32 s62, 2
    s_cbranch_scc1 L_pi2
    v_max3_u32 v3, v16, v17, v18
    v_max_u32 v3, v3, v19
    v_cmp_eq_u32 vcc, -1, v3
    s_cbranch_vccz L_pgot2
    s_cmp_eq_u32 s62, 3
    s_cbranch_scc1 L_pi3
    v_max3_u32 v3, v20, v21, v22
    v_max_u32 v3, v3, v23
    v_cmp_eq_u32 vcc, -1, v3
    s_cbranch_vccz L_pgot3
    s_cmp_eq_u32 s62, 4
    s_cbranch_scc1 L_pi4
    v_max3_u32 v3, v24, v25, v26
    v_max_u32 v3, v3, v27
    v_cmp_eq_u32 vcc, -1, v3
    s_cbranch_vccz L_pgot4
    s_cmp_eq_u32 s62, 5
    s_cbranch_scc1 L_pi5
    v_max3_u32 v3, v28, v29, v30
    v_max_u32 v3, v3, v31
    v_cmp_eq_u32 vcc, -1, v3
    s_cbranch_vccz L_pgot5
    s_cmp_eq_u32 s62, 6
    s_cbranch_scc1 L_pi6
    v_max3_u32 v3, v32, v33, v34
    v_max_u32 v3, v3, v35
    v_cmp_eq_u32 vcc, -1, v3
    s_cbranch_vccz L_pgot6
    s_cmp_eq_u32 s62, 7
    s_cbranch_scc1 L_pi7
    v_max3_u32 v3, v36, v37, v38
    v_max_u32 v3, v3, v39
    v_cmp_eq_u32 vcc, -1, v3
    s_cbranch_vccz L_pgot7
    s_branch L_pi8
L_pgot0:
    v_dot2c_f32_bf16 v64, s58, v8
    v_dot2c_f32_bf16 v65, s59, v8
    v_dot2c_f32_bf16 v66, s58, v9
    v_dot2c_f32_bf16 v67, s59, v9
    v_dot2c_f32_bf16 v68, s58, v10
    v_dot2c_f32_bf16 v69, s59, v10
    v_dot2c_f32_bf16 v70, s58, v11
    v_dot2c_f32_bf16 v71, s59, v11
    s_bitset0_b32 s63, s12
    s_cmp_eq_u32 s63, 0
    s_cbranch_scc1 L_pgd
L_pn0:
    s_cmp_eq_u32 s62, 1
    s_cbranch_scc1 L_prb
    v_max3_u32 v3, v12, v13, v14
    v_max_u32 v3, v3, v15
    v_cmp_eq_u32 vcc, -1, v3
    s_cbranch_vccnz L_pn1
L_pgot1:
    v_dot2c_f32_bf16 v64, s58, v12
    v_dot2c_f32_bf16 v65, s59, v12
    v_dot2c_f32_bf16 v66, s58, v13
    v_dot2c_f32_bf16 v67, s59, v13
    v_dot2c_f32_bf16 v68, s58, v14
    v_dot2c_f32_bf16 v69, s59, v14
    v_dot2c_f32_bf16 v70, s58, v15
    v_dot2c_f32_bf16 v71, s59, v15
    s_bitset0_b32 s63, s13
    s_cmp_eq_u32 s63, 0
    s_cbranch_scc1 L_pgd
L_pn1:
    s_cmp_eq_u32 s62, 2
    s_cbranch_scc1 L_prb
    v_max3_u32 v3, v16, v17, v18
    v_max_u32 v3, v3, v19
    v_cmp_eq_u32 vcc, -1, v3
    s_cbranch_vccnz L_pn2
L_pgot2:
    v_dot2c_f32_bf16 v64, s58, v16
    v_dot2c_f32_bf16 v65, s59, v16
    v_dot2c_f32_bf16 v66, s58, v17
    v_dot2c_f32_bf16 v67, s59, v17
    v_dot2c_f32_bf16 v68, s58, v18
    v_dot2c_f32_bf16 v69, s59, v18
    v_dot2c_f32_bf16 v70, s58, v19
    v_dot2c_f32_bf16 v71, s59, v19
    s_bitset0_b32 s63, s14
    s_cmp_eq_u32 s63, 0
    s_cbranch_scc1 L_pgd
L_pn2:
    s_cmp_eq_u32 s62, 3
    s_cbranch_scc1 L_prb
    v_max3_u32 v3, v20, v21, v22
    v_max_u32 v3, v3, v23
    v_cmp_eq_u32 vcc, -1, v3
    s_cbranch_vccnz L_pn3
L_pgot3:
    v_dot2c_f32_bf16 v64, s58, v20
    v_dot2c_f32_bf16 v65, s59, v20
    v_dot2c_f32_bf16 v66, s58, v21
    v_dot2c_f32_bf16 v67, s59, v21
    v_dot2c_f32_bf16 v68, s58, v22
    v_dot2c_f32_bf16 v69, s59, v22
    v_dot2c_f32_bf16 v70, s58, v23
    v_dot2c_f32_bf16 v71, s59, v23
    s_bitset0_b32 s63, s15
    s_cmp_eq_u32 s63, 0
    s_cbranch_scc1 L_pgd
L_pn3:
    s_cmp_eq_u32 s62, 4
    s_cbranch_scc1 L_prb
    v_max3_u32 v3, v24, v25, v26
    v_max_u32 v3, v3, v27
    v_cmp_eq_u32 vcc, -1, v3
    s_cbranch_vccnz L_pn4
L_pgot4:
    v_dot2c_f32_bf16 v64, s58, v24
    v_dot2c_f32_bf16 v65, s59, v24
    v_dot2c_f32_bf16 v66, s58, v25
    v_dot2c_f32_bf16 v67, s59, v25
    v_dot2c_f32_bf16 v68, s58, v26
    v_dot2c_f32_bf16 v69, s59, v26
    v_dot2c_f32_bf16 v70, s58, v27
    v_dot2c_f32_bf16 v71, s59, v27
    s_bitset0_b32 s63, s16
    s_cmp_eq_u32 s63, 0
    s_cbranch_scc1 L_pgd
L_pn4:
    s_cmp_eq_u32 s62, 5
    s_cbranch_scc1 L_prb
    v_max3_u32 v3, v28, v29, v30
    v_max_u32 v3, v3, v31
    v_cmp_eq_u32 vcc, -1, v3
    s_cbranch_vccnz L_pn5
L_pgot5:
    v_dot2c_f32_bf16 v64, s58, v28
    v_dot2c_f32_bf16 v65, s59, v28
    v_dot2c_f32_bf16 v66, s58, v29
    v_dot2c_f32_bf16 v67, s59, v29
    v_dot2c_f32_bf16 v68, s58, v30
    v_dot2c_f32_bf16 v69, s59, v30
    v_dot2c_f32_bf16 v70, s58, v31
    v_dot2c_f32_bf16 v71, s59, v31
    s_bitset0_b32 s63, s17
    s_cmp_eq_u32 s63, 0
    s_cbranch_scc1 L_pgd
L_pn5:
    s_cmp_eq_u32 s62, 6
    s_cbranch_scc1 L_prb
    v_max3_u32 v3, v32, v33, v34
    v_max_u32 v3, v3, v35
    v_cmp_eq_u32 vcc, -1, v3
    s_cbranch_vccnz L_pn6
L_pgot6:
    v_dot2c_f32_bf16 v64, s58, v32
    v_dot2c_f32_bf16 v65, s59, v32
    v_dot2c_f32_bf16 v66, s58, v33
    v_dot2c_f32_bf16 v67, s59, v33
    v_dot2c_f32_bf16 v68, s58, v34
    v_dot2c_f32_bf16 v69, s59, v34
    v_dot2c_f32_bf16 v70, s58, v35
    v_dot2c_f32_bf16 v71, s59, v35
    s_bitset0_b32 s63, s18
    s_cmp_eq_u32 s63, 0
    s_cbranch_scc1 L_pgd
L_pn6:
    s_cmp_eq_u32 s62, 7
    s_cbranch_scc1 L_prb
    v_max3_u32 v3, v36, v37, v38
    v_max_u32 v3, v3, v39
    v_cmp_eq_u32 vcc, -1, v3
    s_cbranch_vccnz L_pn7
L_pgot7:
    v_dot2c_f32_bf16 v64, s58, v36
    v_dot2c_f32_bf16 v65, s59, v36
    v_dot2c_f32_bf16 v66, s58, v37
    v_dot2c_f32_bf16 v67, s59, v37
    v_dot2c_f32_bf16 v68, s58, v38
    v_dot2c_f32_bf16 v69, s59, v38
    v_dot2c_f32_bf16 v70, s58, v39
    v_dot2c_f32_bf16 v71, s59, v39
    s_bitset0_b32 s63, s19
    s_cmp_eq_u32 s63, 0
    s_cbranch_scc1 L_pgd
L_pn7:
    s_branch L_prb
L_pi1:
L_poll_122:
    buffer_load_dwordx4 v[8:11], v5, s[40:43], s4 offen sc1
    s_sub_u32 s60, s60, 1
    s_cbranch_scc1 L_poll_122t
    s_waitcnt vmcnt(0)
    v_max3_u32 v3, v8, v9, v10
    v_max_u32 v3, v3, v11
    v_cmp_eq_u32 vcc, -1, v3
    s_cbranch_vccnz L_poll_122
L_poll_122e:
    v_dot2c_f32_bf16 v64, s58, v8
    v_dot2c_f32_bf16 v65, s59, v8
    v_dot2c_f32_bf16 v66, s58, v9
    v_dot2c_f32_bf16 v67, s59, v9
    v_dot2c_f32_bf16 v68, s58, v10
    v_dot2c_f32_bf16 v69, s59, v10
    v_dot2c_f32_bf16 v70, s58, v11
    v_dot2c_f32_bf16 v71, s59, v11
L_pgd:
    v_pk_fma_f32 v[64:65], v[64:65], v[48:49], v[40:41]
    v_pk_fma_f32 v[66:67], v[66:67], v[50:51], v[42:43]
    v_pk_fma_f32 v[68:69], v[68:69], v[52:53], v[44:45]
    v_pk_fma_f32 v[70:71], v[70:71], v[54:55], v[46:47]
    v_pk_mul_f32 v[56:57], v[64:65], v[56:57]
    v_pk_mul_f32 v[58:59], v[66:67], v[58:59]
    v_pk_mul_f32 v[60:61], v[68:69], v[60:61]
    v_pk_mul_f32 v[62:63], v[70:71], v[62:63]
    v_cvt_pk_bf16_f32 v8, v56, v57
    v_cvt_pk_bf16_f32 v9, v58, v59
    v_cvt_pk_bf16_f32 v10, v60, v61
    v_cvt_pk_bf16_f32 v11, v62, v63
    ds_write_b128 v4, v[8:11]
    v_pk_add_f32 v[40:41], v[64:65], v[66:67]
    v_pk_add_f32 v[42:43], v[68:69], v[70:71]
    v_pk_mul_f32 v[44:45], v[64:65], v[64:65]
    v_pk_mul_f32 v[46:47], v[66:67], v[66:67]
    v_pk_add_f32 v[40:41], v[40:41], v[42:43]
    v_pk_fma_f32 v[44:45], v[68:69], v[68:69], v[44:45]
    v_pk_fma_f32 v[46:47], v[70:71], v[70:71], v[46:47]
    v_add_f32 v40, v40, v41
    v_pk_add_f32 v[44:45], v[44:45], v[46:47]
    v_add_f32 v41, v44, v45
    ds_write_b64 v7, v[40:41]
    s_waitcnt lgkmcnt(0)
    s_barrier
    v_mov_b32 v16, 0
    v_mov_b32 v17, 0
    v_mov_b32 v18, 0
    v_mov_b32 v19, 0
    v_mov_b32 v20, 0
    v_mov_b32 v21, 0
    v_mov_b32 v22, 0
    v_mov_b32 v23, 0
    v_mov_b32 v24, 0
    v_mov_b32 v25, 0
    v_mov_b32 v26, 0
    v_mov_b32 v27, 0
    v_mov_b32 v28, 0
    v_mov_b32 v29, 0
    v_mov_b32 v30, 0
    v_mov_b32 v31, 0
    v_mov_b32 v32, 0
    v_mov_b32 v33, 0
    v_mov_b32 v34, 0
    v_mov_b32 v35, 0
    ds_write_b128 v6, v[64:67]
    ds_write_b128 v6, v[68:71] offset:16
    s_waitcnt lgkmcnt(0)
    s_cmp_lg_u32 s3, 7
    s_cbranch_scc1 L_ffn2
    s_cmp_lt_u32 s35, 20
    s_cbranch_scc1 L_fin
    s_endpgm
L_ffn1:
    s_barrier
L_ffn1b:
    ds_read_b128 v[8:11], v79
    ds_read_b64 v[30:31], v81 offset:0
    ds_read_b64 v[32:33], v81 offset:512
    ds_read_b64 v[34:35], v81 offset:1024
    ds_read_b64 v[36:37], v81 offset:1536
    ds_read_b64 v[38:39], v81 offset:2048
    ds_read_b128 v[12:15], v79 offset:256
    ds_read_b128 v[16:19], v79 offset:512
    ds_read_b128 v[20:23], v79 offset:768
    ds_read_b128 v[24:27], v79 offset:1024
    s_waitcnt lgkmcnt(9)
    v_smfmac_f32_16x16x64_bf16 v[52:55], v[8:11], v[88:95], v87
    v_smfmac_f32_16x16x64_bf16 v[56:59], v[8:11], v[96:103], v87
    s_waitcnt lgkmcnt(3)
    v_smfmac_f32_16x16x64_bf16 v[52:55], v[12:15], v[104:111], v87
    v_pk_add_f32 v[30:31], v[30:31], v[32:33]
    v_pk_add_f32 v[34:35], v[34:35], v[36:37]
    v_smfmac_f32_16x16x64_bf16 v[56:59], v[12:15], v[112:119], v87
    v_pk_add_f32 v[30:31], v[30:31], v[38:39]
    v_pk_add_f32 v[30:31], v[30:31], v[34:35]
    s_nop 0
    s_waitcnt lgkmcnt(2)
    v_smfmac_f32_16x16x64_bf16 v[52:55], v[16:19], v[120:127], v87
    v_add_f32_dpp v30, v30, v30 quad_perm:[1,0,3,2] row_mask:0xf bank_mask:0xf
    v_add_f32_dpp v31, v31, v31 quad_perm:[1,0,3,2] row_mask:0xf bank_mask:0xf
    v_smfmac_f32_16x16x64_bf16 v[56:59], v[16:19], v[128:135], v87
    v_add_f32_dpp v30, v30, v30 quad_perm:[2,3,0,1] row_mask:0xf bank_mask:0xf
    v_add_f32_dpp v31, v31, v31 quad_perm:[2,3,0,1] row_mask:0xf bank_mask:0xf
    s_waitcnt lgkmcnt(1)
    v_smfmac_f32_16x16x64_bf16 v[52:55], v[20:23], v[136:143], v87
    v_add_f32_dpp v30, v30, v30 row_ror:4 row_mask:0xf bank_mask:0xf
    v_add_f32_dpp v31, v31, v31 row_ror:4 row_mask:0xf bank_mask:0xf
    v_smfmac_f32_16x16x64_bf16 v[56:59], v[20:23], v[144:151], v87
    v_add_f32_dpp v30, v30, v30 row_ror:8 row_mask:0xf bank_mask:0xf
    v_add_f32_dpp v31, v31, v31 row_ror:8 row_mask:0xf bank_mask:0xf
    s_waitcnt lgkmcnt(0)
    v_smfmac_f32_16x16x64_bf16 v[52:55], v[24:27], v[152:159], v87
    v_mul_f32 v48, s62, v30
    v_mul_f32 v49, s62, v31
    v_smfmac_f32_16x16x64_bf16 v[56:59], v[24:27], v[160:167], v87
    v_mul_f32 v7, v84, v48
    v_fma_f32 v49, -v48, v48, -v49
    v_max_f32 v49, 0, v49
    v_add_f32 v49, 0x3727c5ac, v49
    v_rsq_f32 v49, v49
    v_add_f32 v4, v52, v53
    v_add_f32 v4, v4, v7
    s_nop 0
    v_add_f32 v5, v58, v59
    v_add_f32 v4, v4, v5
    v_fma_f32 v4, v4, v49, v85
    v_mul_f32 v5, v4, v4
    v_fma_f32 v5, v5, s63, v86
    v_mul_f32 v5, v5, v4
    v_exp_f32 v5, v5
    s_nop 0
    v_add_f32 v5, 1.0, v5
    v_rcp_f32 v5, v5
    s_nop 0
    v_mul_f32 v4, v4, v5
    v_cvt_pk_bf16_f32 v4, v4, v4
    ds_write_b16 v80, v4
    s_waitcnt lgkmcnt(0)
    s_barrier
    s_endpgm
L_h_t1:
    s_cmp_lg_u32 s3, 3
    s_cbranch_scc1 L_h_noclr
    s_sub_u32 s62, s56, 154
    s_cmp_lt_u32 s62, 32
    s_cbranch_scc0 L_h_noclr
    s_lshl_b32 s63, s62, 2
    s_lshl_b32 s62, s62, 13
    s_add_u32 s62, s62, 20480
    v_mov_b32 v4, -1
    v_mov_b32 v5, -1
    v_mov_b32 v6, -1
    v_mov_b32 v7, -1
    v_lshlrev_b32 v8, 4, v0
    buffer_store_dwordx4 v[4:7], v8, s[40:43], s62 offen offset:0 sc1
    buffer_store_dwordx4 v[4:7], v8, s[40:43], s62 offen offset:1024 sc1
    buffer_store_dwordx4 v[4:7], v8, s[40:43], s62 offen offset:2048 sc1
    buffer_store_dwordx4 v[4:7], v8, s[40:43], s62 offen offset:3072 sc1
    s_add_u32 s62, s62, 4096
    buffer_store_dwordx4 v[4:7], v8, s[40:43], s62 offen offset:0 sc1
    buffer_store_dwordx4 v[4:7], v8, s[40:43], s62 offen offset:1024 sc1
    buffer_store_dwordx4 v[4:7], v8, s[40:43], s62 offen offset:2048 sc1
    buffer_store_dwordx4 v[4:7], v8, s[40:43], s62 offen offset:3072 sc1
    s_add_u32 s62, s62, 4096
    v_mov_b32 v8, s63
    s_waitcnt vmcnt(0)
    s_mov_b64 exec, 1
    buffer_store_dword v4, v8, s[44:47], 0 offen sc1
    s_mov_b64 exec, -1
L_h_noclr:
    v_lshrrev_b32 v1, 3, v0
    v_mul_u32_u24 v1, 1280, v1
    v_and_b32 v2, 7, v0
    v_lshl_add_u32 v1, v2, 4, v1
    s_lshl2_add_u32 s63, s34, s3
    s_mul_i32 s63, s63, 163840
    s_lshl_b32 s62, s35, 7
    s_add_u32 s63, s63, s62
    s_sub_u32 s63, s63, 2816
    s_lshl_b32 s62, s3, 14
    s_add_u32 s62, s62, 81920
    s_mov_b32 m0, s62
    s_mov_b32 s48, s12
    s_mov_b32 s49, s13
    s_mov_b32 s50, 5242880
    s_mov_b32 s51, 0x20000
    s_add_u32 s100, s39, 1
    s_mov_b32 s62, 8
L_dma_4:
    buffer_load_dwordx4 v1, s[48:51], s63 offen nt lds
    s_add_u32 m0, m0, 1024
    s_add_u32 s63, s63, 10240
    s_cmp_eq_u32 s100, 0
    s_cbranch_scc1 L_dma_4n0
    s_waitcnt vmcnt(7)
    s_cmp_eq_u32 s100, 2
    s_cbranch_scc1 L_dma_4n0
    s_waitcnt vmcnt(3)
L_dma_4n0:
    buffer_load_dwordx4 v1, s[48:51], s63 offen nt lds
    s_add_u32 m0, m0, 1024
    s_add_u32 s63, s63, 10240
    s_cmp_eq_u32 s100, 0
    s_cbranch_scc1 L_dma_4n1
    s_waitcnt vmcnt(7)
    s_cmp_eq_u32 s100, 2
    s_cbranch_scc1 L_dma_4n1
    s_waitcnt vmcnt(3)
L_dma_4n1:
    s_sub_u32 s62, s62, 1
    s_cmp_lg_u32 s62, 0
    s_cbranch_scc1 L_dma_4
    s_cmp_eq_u32 s39, 1
    s_cbranch_scc1 L_h_role
    s_waitcnt vmcnt(0)
    v_mov_b32 v4, 162060
    v_mov_b32 v5, 1
    s_mov_b64 exec, 1
    ds_add_u32 v4, v5
    s_mov_b64 exec, -1
    s_cmp_eq_u32 s3, 0
    s_cbranch_scc1 L_service
    s_endpgm
L_h_role:
    v_mov_b32 v72, 0
    v_mov_b32 v73, 0
    v_mov_b32 v74, 0
    v_mov_b32 v75, 0
    v_mov_b32 v76, 0
    v_lshrrev_b32 v3, 4, v0
    v_and_b32 v2, 3, v0
    v_bfe_u32 v1, v0, 2, 2
    v_mul_u32_u24 v160, 1280, v3
    v_and_b32 v4, 15, v0
    v_lshl_add_u32 v163, v4, 2, v160
    v_lshl_add_u32 v160, v4, 3, v160
    s_mul_i32 s57, s35, 5120
    s_mul_i32 s62, s3, 320
    s_add_u32 s57, s57, s62
    s_add_u32 s57, s57, 294912
    v_mov_b32 v4, -1
    v_mov_b32 v5, -1
    v_mov_b32 v6, -1
    v_mov_b32 v7, -1
    v_lshlrev_b32 v8, 4, v0
    s_mul_i32 s62, s3, 960
    s_add_u32 s62, s62, s57
    buffer_store_dwordx4 v[4:7], v8, s[40:43], s62 offen sc1
    s_mov_b64 exec, 0xffff
    buffer_store_dwordx4 v[4:7], v8, s[40:43], s62 offen offset:1024 sc1
    s_mov_b64 exec, -1
    v_add_u32 v8, 0, v0
    v_mul_u32_u24 v10, 0xccd, v8
    v_lshrrev_b32 v10, 16, v10
    v_mul_u32_u24 v9, 20, v10
    v_sub_u32 v8, v8, v9
    v_mul_u32_u24 v10, 1280, v10
    v_lshl_add_u32 v10, v8, 4, v10
    v_add_u32 v8, 64, v0
    v_mul_u32_u24 v11, 0xccd, v8
    v_lshrrev_b32 v11, 16, v11
    v_mul_u32_u24 v9, 20, v11
    v_sub_u32 v8, v8, v9
    v_mul_u32_u24 v11, 1280, v11
    v_lshl_add_u32 v11, v8, 4, v11
    v_add_u32 v8, 128, v0
    v_mul_u32_u24 v12, 0xccd, v8
    v_lshrrev_b32 v12, 16, v12
    v_mul_u32_u24 v9, 20, v12
    v_sub_u32 v8, v8, v9
    v_mul_u32_u24 v12, 1280, v12
    v_lshl_add_u32 v12, v8, 4, v12
    v_add_u32 v8, 192, v0
    v_mul_u32_u24 v13, 0xccd, v8
    v_lshrrev_b32 v13, 16, v13
    v_mul_u32_u24 v9, 20, v13
    v_sub_u32 v8, v8, v9
    v_mul_u32_u24 v13, 1280, v13
    v_lshl_add_u32 v13, v8, 4, v13
    v_add_u32 v8, 256, v0
    v_mul_u32_u24 v14, 0xccd, v8
    v_lshrrev_b32 v14, 16, v14
    v_mul_u32_u24 v9, 20, v14
    v_sub_u32 v8, v8, v9
    v_mul_u32_u24 v14, 1280, v14
    v_lshl_add_u32 v14, v8, 4, v14
    s_waitcnt vmcnt(0)
    v_mov_b32 v8, 162060
    v_mov_b32 v9, 1
    s_mov_b64 exec, 1
    ds_add_u32 v8, v9
    s_mov_b64 exec, -1
    s_mov_b32 s48, s20
    s_mov_b32 s49, s21
    s_mov_b32 s50, 2211840
    s_mov_b32 s51, 0x20000
    s_mul_i32 s63, s35, 81920
    s_mul_i32 s62, s3, 320
    s_add_u32 s63, s63, s62
    s_mov_b32 m0, s101
    s_mov_b32 s62, 4
L_w2dma:
    buffer_load_dwordx4 v10, s[48:51], s63 offen nt lds
    s_add_u32 m0, m0, 1024
    s_waitcnt vmcnt(7)
    s_cmp_ge_u32 s35, 22
    s_cbranch_scc1 L_w2n0
    s_waitcnt vmcnt(7)
L_w2n0:
    buffer_load_dwordx4 v11, s[48:51], s63 offen nt lds
    s_add_u32 m0, m0, 1024
    s_waitcnt vmcnt(7)
    s_cmp_ge_u32 s35, 22
    s_cbranch_scc1 L_w2n1
    s_waitcnt vmcnt(7)
L_w2n1:
    buffer_load_dwordx4 v12, s[48:51], s63 offen nt lds
    s_add_u32 m0, m0, 1024
    s_waitcnt vmcnt(7)
    s_cmp_ge_u32 s35, 22
    s_cbranch_scc1 L_w2n2
    s_waitcnt vmcnt(7)
L_w2n2:
    buffer_load_dwordx4 v13, s[48:51], s63 offen nt lds
    s_add_u32 m0, m0, 1024
    s_waitcnt vmcnt(7)
    s_cmp_ge_u32 s35, 22
    s_cbranch_scc1 L_w2n3
    s_waitcnt vmcnt(7)
L_w2n3:
    buffer_load_dwordx4 v14, s[48:51], s63 offen nt lds
    s_add_u32 m0, m0, 1024
    s_waitcnt vmcnt(7)
    s_cmp_ge_u32 s35, 22
    s_cbranch_scc1 L_w2n4
    s_waitcnt vmcnt(7)
L_w2n4:
    s_add_u32 s63, s63, 20480
    s_sub_u32 s62, s62, 1
    s_cmp_lg_u32 s62, 0
    s_cbranch_scc1 L_w2dma
    v_lshrrev_b32 v8, 5, v0
    v_lshlrev_b32 v8, 2, v8
    v_bfe_u32 v9, v0, 4, 1
    v_add_u32 v8, v8, v9
    v_mul_u32_u24 v8, 1280, v8
    v_add_u32 v8, s101, v8
    v_and_b32 v10, 15, v0
    v_lshl_add_u32 v9, v10, 2, v8
    v_lshl_add_u32 v8, v10, 3, v8
    s_mov_b32 s62, 0x05040100
    s_mov_b32 s63, 0x07060302
    s_waitcnt vmcnt(0)
    ds_read_b64 v[16:17], v8 offset:0
    ds_read_b64 v[18:19], v8 offset:320
    ds_read_b64 v[20:21], v8 offset:2560
    ds_read_b64 v[22:23], v8 offset:2880
    ds_read_b64 v[24:25], v8 offset:640
    ds_read_b64 v[26:27], v8 offset:960
    ds_read_b64 v[28:29], v8 offset:3200
    ds_read_b64 v[30:31], v8 offset:3520
    ds_read_b64 v[32:33], v8 offset:10240
    ds_read_b64 v[34:35], v8 offset:10560
    ds_read_b64 v[36:37], v8 offset:12800
    ds_read_b64 v[38:39], v8 offset:13120
    ds_read_b64 v[40:41], v8 offset:10880
    ds_read_b64 v[42:43], v8 offset:11200
    ds_read_b64 v[44:45], v8 offset:13440
    ds_read_b64 v[46:47], v8 offset:13760
    s_waitcnt lgkmcnt(0)
    v_perm_b32 v80, v18, v16, s62
    v_perm_b32 v88, v18, v16, s63
    v_perm_b32 v96, v19, v17, s62
    v_perm_b32 v104, v19, v17, s63
    v_perm_b32 v81, v22, v20, s62
    v_perm_b32 v89, v22, v20, s63
    v_perm_b32 v97, v23, v21, s62
    v_perm_b32 v105, v23, v21, s63
    v_perm_b32 v82, v26, v24, s62
    v_perm_b32 v90, v26, v24, s63
    v_perm_b32 v98, v27, v25, s62
    v_perm_b32 v106, v27, v25, s63
    v_perm_b32 v83, v30, v28, s62
    v_perm_b32 v91, v30, v28, s63
    v_perm_b32 v99, v31, v29, s62
    v_perm_b32 v107, v31, v29, s63
    v_perm_b32 v84, v34, v32, s62
    v_perm_b32 v92, v34, v32, s63
    v_perm_b32 v100, v35, v33, s62
    v_perm_b32 v108, v35, v33, s63
    v_perm_b32 v85, v38, v36, s62
    v_perm_b32 v93, v38, v36, s63
    v_perm_b32 v101, v39, v37, s62
    v_perm_b32 v109, v39, v37, s63
    v_perm_b32 v86, v42, v40, s62
    v_perm_b32 v94, v42, v40, s63
    v_perm_b32 v102, v43, v41, s62
    v_perm_b32 v110, v43, v41, s63
    v_perm_b32 v87, v46, v44, s62
    v_perm_b32 v95, v46, v44, s63
    v_perm_b32 v103, v47, v45, s62
    v_perm_b32 v111, v47, v45, s63
    ds_read_b64 v[16:17], v8 offset:128
    ds_read_b64 v[18:19], v8 offset:448
    ds_read_b64 v[20:21], v8 offset:2688
    ds_read_b64 v[22:23], v8 offset:3008
    ds_read_b64 v[24:25], v8 offset:768
    ds_read_b64 v[26:27], v8 offset:1088
    ds_read_b64 v[28:29], v8 offset:3328
    ds_read_b64 v[30:31], v8 offset:3648
    ds_read_b64 v[32:33], v8 offset:10368
    ds_read_b64 v[34:35], v8 offset:10688
    ds_read_b64 v[36:37], v8 offset:12928
    ds_read_b64 v[38:39], v8 offset:13248
    ds_read_b64 v[40:41], v8 offset:11008
    ds_read_b64 v[42:43], v8 offset:11328
    ds_read_b64 v[44:45], v8 offset:13568
    ds_read_b64 v[46:47], v8 offset:13888
    s_waitcnt lgkmcnt(0)
    v_perm_b32 v112, v18, v16, s62
    v_perm_b32 v120, v18, v16, s63
    v_perm_b32 v128, v19, v17, s62
    v_perm_b32 v136, v19, v17, s63
    v_perm_b32 v113, v22, v20, s62
    v_perm_b32 v121, v22, v20, s63
    v_perm_b32 v129, v23, v21, s62
    v_perm_b32 v137, v23, v21, s63
    v_perm_b32 v114, v26, v24, s62
    v_perm_b32 v122, v26, v24, s63
    v_perm_b32 v130, v27, v25, s62
    v_perm_b32 v138, v27, v25, s63
    v_perm_b32 v115, v30, v28, s62
    v_perm_b32 v123, v30, v28, s63
    v_perm_b32 v131, v31, v29, s62
    v_perm_b32 v139, v31, v29, s63
    v_perm_b32 v116, v34, v32, s62
    v_perm_b32 v124, v34, v32, s63
    v_perm_b32 v132, v35, v33, s62
    v_perm_b32 v140, v35, v33, s63
    v_perm_b32 v117, v38, v36, s62
    v_perm_b32 v125, v38, v36, s63
    v_perm_b32 v133, v39, v37, s62
    v_perm_b32 v141, v39, v37, s63
    v_perm_b32 v118, v42, v40, s62
    v_perm_b32 v126, v42, v40, s63
    v_perm_b32 v134, v43, v41, s62
    v_perm_b32 v142, v43, v41, s63
    v_perm_b32 v119, v46, v44, s62
    v_perm_b32 v127, v46, v44, s63
    v_perm_b32 v135, v47, v45, s62
    v_perm_b32 v143, v47, v45, s63
    ds_read_b32 v16, v9 offset:256
    ds_read_b32 v18, v9 offset:576
    ds_read_b32 v20, v9 offset:2816
    ds_read_b32 v22, v9 offset:3136
    ds_read_b32 v24, v9 offset:896
    ds_read_b32 v26, v9 offset:1216
    ds_read_b32 v28, v9 offset:3456
    ds_read_b32 v30, v9 offset:3776
    ds_read_b32 v32, v9 offset:10496
    ds_read_b32 v34, v9 offset:10816
    ds_read_b32 v36, v9 offset:13056
    ds_read_b32 v38, v9 offset:13376
    ds_read_b32 v40, v9 offset:11136
    ds_read_b32 v42, v9 offset:11456
    ds_read_b32 v44, v9 offset:13696
    ds_read_b32 v46, v9 offset:14016
    s_waitcnt lgkmcnt(0)
    v_perm_b32 v144, v18, v16, s62
    v_perm_b32 v152, v18, v16, s63
    v_perm_b32 v145, v22, v20, s62
    v_perm_b32 v153, v22, v20, s63
    v_perm_b32 v146, v26, v24, s62
    v_perm_b32 v154, v26, v24, s63
    v_perm_b32 v147, v30, v28, s62
    v_perm_b32 v155, v30, v28, s63
    v_perm_b32 v148, v34, v32, s62
    v_perm_b32 v156, v34, v32, s63
    v_perm_b32 v149, v38, v36, s62
    v_perm_b32 v157, v38, v36, s63
    v_perm_b32 v150, v42, v40, s62
    v_perm_b32 v158, v42, v40, s63
    v_perm_b32 v151, v46, v44, s62
    v_perm_b32 v159, v46, v44, s63
    s_mov_b32 s48, s16
    s_mov_b32 s49, s17
    s_mov_b32 s50, 2211840
    s_mov_b32 s51, 0x20000
    s_lshl_b32 s98, s35, 7
    s_mov_b32 s99, 3456
    v_lshrrev_b32 v9, 3, v0
    v_mul_lo_u32 v10, v9, s99
    v_and_b32 v9, 2, v9
    v_xor_b32 v9, v9, v0
    v_and_b32 v9, 7, v9
    v_lshl_add_u32 v10, v9, 4, v10
    v_add_u32 v10, s98, v10
    v_xor_b32 v11, 64, v10
    s_mul_i32 s63, s3, 552960
    s_mov_b32 m0, s101
    s_waitcnt lgkmcnt(0)
    s_cmp_ge_u32 s35, 22
    s_cselect_b32 s100, 2, 1
    s_mov_b32 s62, 10
L_dma_5:
    buffer_load_dwordx4 v10, s[48:51], s63 offen nt lds
    s_add_u32 m0, m0, 1024
    s_add_u32 s63, s63, 27648
    s_cmp_eq_u32 s100, 0
    s_cbranch_scc1 L_dma_5n0
    s_waitcnt vmcnt(7)
    s_cmp_eq_u32 s100, 2
    s_cbranch_scc1 L_dma_5n0
    s_waitcnt vmcnt(7)
L_dma_5n0:
    buffer_load_dwordx4 v11, s[48:51], s63 offen nt lds
    s_add_u32 m0, m0, 1024
    s_add_u32 s63, s63, 27648
    s_cmp_eq_u32 s100, 0
    s_cbranch_scc1 L_dma_5n1
    s_waitcnt vmcnt(7)
    s_cmp_eq_u32 s100, 2
    s_cbranch_scc1 L_dma_5n1
    s_waitcnt vmcnt(7)
L_dma_5n1:
    s_sub_u32 s62, s62, 1
    s_cmp_lg_u32 s62, 0
    s_cbranch_scc1 L_dma_5
    v_mov_b32 v8, 162068
L_lw_6:
    ds_read_b32 v9, v8
    s_waitcnt lgkmcnt(0)
    v_cmp_gt_u32 vcc, 1, v9
    s_cbranch_vccz L_lw_6e
    s_sleep 8
    s_sub_u32 s60, s60, 1
    s_cbranch_scc0 L_lw_6
    s_mov_b32 s60, 0
L_lw_6e:
    s_cmp_lg_u32 s3, 3
    s_cbranch_scc1 L_h_nomo
    v_and_b32 v4, 15, v0
    v_lshlrev_b32 v4, 4, v4
    v_mul_u32_u24 v5, 1280, v3
    v_add_u32 v5, v5, v4
    v_mul_u32_u24 v6, 1296, v3
    v_add_u32 v6, v6, v4
    v_add_u32 v6, 147456, v6
    s_mov_b32 s62, 30720
    s_mov_b32 s63, 25600
    s_branch L_poll_7
L_poll_7s:
    s_sleep 8
L_poll_7:
    buffer_load_dwordx4 v[40:43], v5, s[40:43], s62 offen offset:0 sc1
    buffer_load_dwordx4 v[44:47], v5, s[40:43], s62 offen offset:256 sc1
    buffer_load_dwordx4 v[48:51], v5, s[40:43], s62 offen offset:512 sc1
    buffer_load_dwordx4 v[52:55], v5, s[40:43], s62 offen offset:768 sc1
    buffer_load_dwordx4 v[56:59], v5, s[40:43], s62 offen offset:1024 sc1
    buffer_load_dwordx4 v[60:63], v5, s[40:43], s63 offen offset:0 sc1
    buffer_load_dwordx4 v[64:67], v5, s[40:43], s63 offen offset:256 sc1
    buffer_load_dwordx4 v[68:71], v5, s[40:43], s63 offen offset:512 sc1
    buffer_load_dwordx4 v[72:75], v5, s[40:43], s63 offen offset:768 sc1
    buffer_load_dwordx4 v[76:79], v5, s[40:43], s63 offen offset:1024 sc1
    s_sub_u32 s60, s60, 1
    s_cbranch_scc1 L_poll_7t
    s_waitcnt vmcnt(0)
    v_max3_u32 v7, v40, v41, v42
    v_max3_u32 v7, v7, v43, v44
    v_max3_u32 v7, v7, v45, v46
    v_max3_u32 v7, v7, v47, v48
    v_max3_u32 v7, v7, v49, v50
    v_max3_u32 v7, v7, v51, v52
    v_max3_u32 v7, v7, v53, v54
    v_max3_u32 v7, v7, v55, v56
    v_max3_u32 v7, v7, v57, v58
    v_max3_u32 v7, v7, v59, v60
    v_max3_u32 v7, v7, v61, v62
    v_max3_u32 v7, v7, v63, v64
    v_max3_u32 v7, v7, v65, v66
    v_max3_u32 v7, v7, v67, v68
    v_max3_u32 v7, v7, v69, v70
    v_max3_u32 v7, v7, v71, v72
    v_max3_u32 v7, v7, v73, v74
    v_max3_u32 v7, v7, v75, v76
    v_max3_u32 v7, v7, v77, v78
    v_max_u32 v7, v7, v79
    v_cmp_eq_u32 vcc, -1, v7
    s_cbranch_vccnz L_poll_7s
L_poll_7e:
    ds_write_b128 v6, v[40:43] offset:0
    ds_write_b128 v6, v[44:47] offset:256
    ds_write_b128 v6, v[48:51] offset:512
    ds_write_b128 v6, v[52:55] offset:768
    ds_write_b128 v6, v[56:59] offset:1024
    ds_write_b128 v6, v[60:63] offset:5184
    ds_write_b128 v6, v[64:67] offset:5440
    ds_write_b128 v6, v[68:71] offset:5696
    ds_write_b128 v6, v[72:75] offset:5952
    ds_write_b128 v6, v[76:79] offset:6208
L_h_nomo:
    v_mul_u32_u24 v4, 144, v1
    v_lshl_add_u32 v4, v3, 5, v4
    v_bfe_u32 v5, v0, 1, 1
    v_lshl_add_u32 v4, v5, 4, v4
    v_add_u32 v4, 90688, v4
    v_mov_b32 v5, 162112
    v_and_b32 v6, 1, v0
    v_cmp_eq_u32 vcc, 0, v6
    s_nop 1
    v_cndmask_b32 v161, v5, v4, vcc
    v_cndmask_b32 v162, v4, v5, vcc
    v_bfe_u32 v164, v0, 1, 1
    v_mul_u32_u24 v164, 0xaaaa, v164
    v_add_u32 v164, 0x4444, v164
    s_mov_b32 s100, s3
    s_lshl_b32 s63, s100, 8
    v_and_b32 v8, 15, v0
    v_lshl_add_u32 v8, v8, 4, s63
    v_lshrrev_b32 v9, 4, v0
    v_mul_u32_u24 v5, 1280, v9
    v_add_u32 v5, v5, v8
    v_mul_u32_u24 v4, 1296, v9
    v_add_u32 v4, v4, v8
    v_add_u32 v4, 82944, v4
    v_lshlrev_b32 v6, 1, v5
    v_add_u32 v6, 99328, v6
    s_lshl_b32 s62, s100, 9
    s_add_u32 s62, s62, 88128
    v_lshl_add_u32 v7, v0, 3, s62
    s_mov_b32 s48, s4
    s_mov_b32 s49, s5
    s_mov_b32 s50, 5120
    s_mov_b32 s51, 0x20000
    buffer_load_dwordx4 v[8:11], v5, s[48:51], 0 offen
    s_mov_b32 s62, 20480
    s_mov_b32 s63, 30720
    s_branch L_poll_8
L_poll_8s:
    s_sleep 8
L_poll_8:
    buffer_load_dwordx4 v[12:15], v5, s[40:43], s62 offen sc1
    buffer_load_dwordx4 v[16:19], v5, s[40:43], s63 offen sc1
    s_sub_u32 s60, s60, 1
    s_cbranch_scc1 L_poll_8t
    s_waitcnt vmcnt(0)
    v_max3_u32 v38, v12, v13, v14
    v_max3_u32 v38, v38, v15, v16
    v_max3_u32 v38, v38, v17, v18
    v_max_u32 v38, v38, v19
    v_cmp_eq_u32 vcc, -1, v38
    s_cbranch_vccnz L_poll_8s
L_poll_8e:
    v_lshlrev_b32 v40, 16, v8
    v_and_b32 v41, 0xffff0000, v8
    v_lshlrev_b32 v42, 16, v9
    v_and_b32 v43, 0xffff0000, v9
    v_lshlrev_b32 v44, 16, v10
    v_and_b32 v45, 0xffff0000, v10
    v_lshlrev_b32 v46, 16, v11
    v_and_b32 v47, 0xffff0000, v11
    v_lshlrev_b32 v48, 16, v12
    v_and_b32 v49, 0xffff0000, v12
    v_lshlrev_b32 v50, 16, v13
    v_and_b32 v51, 0xffff0000, v13
    v_lshlrev_b32 v52, 16, v14
    v_and_b32 v53, 0xffff0000, v14
    v_lshlrev_b32 v54, 16, v15
    v_and_b32 v55, 0xffff0000, v15
    v_lshlrev_b32 v56, 16, v16
    v_and_b32 v57, 0xffff0000, v16
    v_lshlrev_b32 v58, 16, v17
    v_and_b32 v59, 0xffff0000, v17
    v_lshlrev_b32 v60, 16, v18
    v_and_b32 v61, 0xffff0000, v18
    v_lshlrev_b32 v62, 16, v19
    v_and_b32 v63, 0xffff0000, v19
    v_mov_b32 v64, 0
    v_mov_b32 v65, 0
    v_mov_b32 v66, 0
    v_mov_b32 v67, 0
    v_mov_b32 v68, 0
    v_mov_b32 v69, 0
    v_mov_b32 v70, 0
    v_mov_b32 v71, 0
    v_bfe_u32 v5, v0, 2, 2
    v_lshlrev_b32 v5, 8, v5
    v_lshrrev_b32 v8, 4, v0
    v_lshl_add_u32 v5, v8, 6, v5
    v_and_b32 v8, 3, v0
    v_lshl_add_u32 v5, v8, 4, v5
    s_lshl_b32 s56, s100, 10
    s_waitcnt vmcnt(0) lgkmcnt(0)
    v_mov_b32 v8, 162064
    v_mov_b32 v9, 1
    s_mov_b64 exec, 1
    ds_add_u32 v8, v9
    s_mov_b64 exec, -1
    s_branch L_t2gate
L_ffn2:
    s_barrier
L_ffn2b:
    ds_read_b128 v[8:11], v161
    ds_read_b128 v[12:15], v162
    s_cmp_eq_u32 s61, 1
    s_cbranch_scc0 L_f2slow
    s_waitcnt lgkmcnt(1)
    v_smfmac_f32_16x16x64_bf16 v[16:19], v[8:11], v[80:87], v164
    v_smfmac_f32_16x16x64_bf16 v[20:23], v[8:11], v[96:103], v164
    s_waitcnt lgkmcnt(0)
    v_smfmac_f32_16x16x64_bf16 v[16:19], v[12:15], v[88:95], v164
    v_smfmac_f32_16x16x64_bf16 v[20:23], v[12:15], v[104:111], v164
    v_smfmac_f32_16x16x64_bf16 v[24:27], v[8:11], v[112:119], v164
    v_smfmac_f32_16x16x64_bf16 v[28:31], v[8:11], v[128:135], v164
    v_smfmac_f32_16x16x64_bf16 v[24:27], v[12:15], v[120:127], v164
    v_smfmac_f32_16x16x64_bf16 v[28:31], v[12:15], v[136:143], v164
    v_smfmac_f32_16x16x64_bf16 v[32:35], v[8:11], v[144:151], v164
    v_smfmac_f32_16x16x64_bf16 v[32:35], v[12:15], v[152:159], v164
    s_nop 0
    v_pk_add_f32 v[16:17], v[16:17], v[18:19]
    v_cvt_pk_bf16_f32 v40, v16, v17
    v_pk_add_f32 v[20:21], v[20:21], v[22:23]
    v_cvt_pk_bf16_f32 v41, v20, v21
    buffer_store_dwordx2 v[40:41], v160, s[40:43], s57 offen
    v_pk_add_f32 v[24:25], v[24:25], v[26:27]
    v_cvt_pk_bf16_f32 v42, v24, v25
    v_pk_add_f32 v[28:29], v[28:29], v[30:31]
    v_cvt_pk_bf16_f32 v43, v28, v29
    buffer_store_dwordx2 v[42:43], v160, s[40:43], s57 offen offset:128
    v_pk_add_f32 v[32:33], v[32:33], v[34:35]
    v_cvt_pk_bf16_f32 v44, v32, v33
    buffer_store_dword v44, v163, s[40:43], s57 offen offset:256
L_f2done:
    s_barrier
    s_endpgm
L_f2slow:
    s_waitcnt lgkmcnt(1)
    v_smfmac_f32_16x16x64_bf16 v[16:19], v[8:11], v[80:87], v164
    v_smfmac_f32_16x16x64_bf16 v[20:23], v[8:11], v[96:103], v164
    s_waitcnt lgkmcnt(0)
    v_smfmac_f32_16x16x64_bf16 v[16:19], v[12:15], v[88:95], v164
    v_smfmac_f32_16x16x64_bf16 v[20:23], v[12:15], v[104:111], v164
    v_smfmac_f32_16x16x64_bf16 v[24:27], v[8:11], v[112:119], v164
    v_smfmac_f32_16x16x64_bf16 v[28:31], v[8:11], v[128:135], v164
    v_smfmac_f32_16x16x64_bf16 v[24:27], v[12:15], v[120:127], v164
    v_smfmac_f32_16x16x64_bf16 v[28:31], v[12:15], v[136:143], v164
    v_smfmac_f32_16x16x64_bf16 v[32:35], v[8:11], v[144:151], v164
    v_smfmac_f32_16x16x64_bf16 v[32:35], v[12:15], v[152:159], v164
    s_nop 0
    v_pk_add_f32 v[16:17], v[16:17], v[18:19]
    v_cvt_pk_bf16_f32 v40, v16, v17
    v_pk_add_f32 v[20:21], v[20:21], v[22:23]
    v_cvt_pk_bf16_f32 v41, v20, v21
    buffer_store_dwordx2 v[40:41], v160, s[40:43], s57 offen sc1
    v_pk_add_f32 v[24:25], v[24:25], v[26:27]
    v_cvt_pk_bf16_f32 v42, v24, v25
    v_pk_add_f32 v[28:29], v[28:29], v[30:31]
    v_cvt_pk_bf16_f32 v43, v28, v29
    buffer_store_dwordx2 v[42:43], v160, s[40:43], s57 offen offset:128 sc1
    v_pk_add_f32 v[32:33], v[32:33], v[34:35]
    v_cvt_pk_bf16_f32 v44, v32, v33
    buffer_store_dword v44, v163, s[40:43], s57 offen offset:256 sc1
    s_branch L_f2done
L_poll_3t:
    s_mov_b32 s60, 0
    s_waitcnt vmcnt(0)
    s_branch L_poll_3e
L_poll_7t:
    s_mov_b32 s60, 0
    s_waitcnt vmcnt(0)
    s_branch L_poll_7e
L_poll_8t:
    s_mov_b32 s60, 0
    s_waitcnt vmcnt(0)
    s_branch L_poll_8e
L_poll_98t:
    s_mov_b32 s60, 0
    s_waitcnt vmcnt(0)
    s_branch L_poll_98e
L_pfast:
    buffer_store_dword v12, v108, s[40:43], s101 offen
    buffer_store_dword v12, v110, s[40:43], s101 offen
    s_branch L_pdone
L_poll_100t:
    s_mov_b32 s60, 0
    s_waitcnt vmcnt(0)
    s_branch L_poll_100e
L_poll_103t:
    s_mov_b32 s60, 0
    s_waitcnt vmcnt(0)
    s_branch L_poll_103e
L_poll_105t:
    s_mov_b32 s60, 0
    s_waitcnt vmcnt(0)
    s_branch L_poll_105e
L_poll_109t:
    s_mov_b32 s60, 0
    s_waitcnt vmcnt(0)
    s_branch L_poll_109e
L_poll_111t:
    s_mov_b32 s60, 0
    s_waitcnt vmcnt(0)
    s_branch L_poll_111e
L_poll_116t:
    s_mov_b32 s60, 0
    s_waitcnt vmcnt(0)
    s_branch L_poll_116e
L_poll_118t:
    s_mov_b32 s60, 0
    s_waitcnt vmcnt(0)
    s_branch L_poll_118e
L_ygt:
    s_waitcnt vmcnt(0)
    s_branch L_ygd
L_pto:
    s_mov_b32 s60, 0
    s_waitcnt vmcnt(0)
    s_branch L_pgot0
L_poll_122t:
    s_mov_b32 s60, 0
    s_waitcnt vmcnt(0)
    s_branch L_poll_122e
L_end:
    s_endpgm
L_codeend:
.section .rodata,"a"
.p2align 6
.amdhsa_kernel adaLN_cond__sliding_block_cached__dense_activation_gelu__decode_kernel
  .amdhsa_next_free_vgpr 168
  .amdhsa_next_free_sgpr 102
  .amdhsa_accum_offset 168
  .amdhsa_group_segment_fixed_size 0
  .amdhsa_kernarg_size 120
  .amdhsa_user_sgpr_count 2
  .amdhsa_user_sgpr_kernarg_segment_ptr 1
  .amdhsa_system_sgpr_workgroup_id_x 1
.end_amdhsa_kernel
```

```asm
; @launch grid=(256,1,1) block=(768,1,1) lds=162176
.amdgcn_target "amdgcn-amd-amdhsa--gfx950"
.text
.globl adaLN_cond__sliding_block_cached__dense_activation_gelu__decode_kernel
.p2align 8
.type adaLN_cond__sliding_block_cached__dense_activation_gelu__decode_kernel,@function
adaLN_cond__sliding_block_cached__dense_activation_gelu__decode_kernel:
    s_load_dwordx16 s[4:19], s[0:1], 0
    s_load_dwordx8 s[20:27], s[0:1], 64
    s_load_dwordx4 s[28:31], s[0:1], 96
    s_load_dwordx2 s[32:33], s[0:1], 112
    s_cmp_ge_u32 s2, 256
    s_cbranch_scc1 L_end
    v_lshrrev_b32 v1, 6, v0
    v_mul_u32_u24 v2, 36, v0
    v_readfirstlane_b32 s3, v1
    v_and_b32 v0, 63, v0
    s_and_b32 s34, s2, 7
    s_lshr_b32 s35, s2, 3
    s_cmp_lg_u32 s35, 21
    s_cbranch_scc1 L_nopf
    s_getpc_b64 s[48:49]
L_pc:
    v_min_u32 v2, L_codeend-L_pc-4, v2
    v_mov_b32 v3, s49
    v_add_co_u32 v2, vcc, s48, v2
    s_nop 1
    v_addc_co_u32 v3, vcc, 0, v3, vcc
    global_load_dword v152, v[2:3], off
L_nopf:
    s_lshr_b32 s36, s35, 3
    s_lshl2_add_u32 s36, s34, s36
    s_bfe_u32 s37, s35, 0x20001
    s_and_b32 s38, s35, 1
    s_cmp_lt_u32 s35, 27
    s_cselect_b32 s39, 1, 0
    s_cmp_eq_u32 s34, 2
    s_cselect_b32 s39, s39, 0
    s_sub_u32 s62, s34, 3
    s_and_b32 s62, s62, 7
    s_mul_i32 s56, s35, 7
    s_add_u32 s56, s56, s62
    s_cmp_eq_u32 s62, 7
    s_cselect_b32 s56, 255, s56
    s_mov_b32 s60, 1000000
    s_mov_b32 s61, 0
    v_mov_b32 v36, 0
    s_cmp_lt_u32 s3, 4
    s_cbranch_scc1 L_helpers
    s_sub_u32 s3, s3, 4
    s_cmp_ge_u32 s35, 22
    s_cselect_b32 s59, 1, 0
    s_add_u32 s62, s3, s59
    s_cmp_ge_u32 s62, 6
    s_cselect_b32 s62, s39, 0
    s_cmp_eq_u32 s62, 1
    s_cbranch_scc1 L_proxy
    s_cmp_eq_u32 s59, 1
    s_cselect_b32 s100, 0, 81920
    s_lshl_b32 s62, s3, 13
    s_add_u32 s100, s100, s62
    s_and_b32 s62, s39, s59
    s_cselect_b32 s100, -1, s100
    s_mov_b32 s101, 0
L_stream:
    s_lshl_b32 s62, s37, 5
    s_add_u32 s62, s62, s36
    s_lshl_b32 s63, s62, 21
    s_lshl_b32 s96, s38, 18
    s_add_u32 s63, s63, s96
    s_add_u32 s63, s63, 1572864
    v_lshlrev_b32 v1, 4, v0
    s_lshl_b32 s96, s3, 12
    v_add_u32 v1, s96, v1
    s_mov_b32 s97, 0
    s_mov_b32 s50, 262144
    s_mov_b32 s51, 0x20000
    s_waitcnt lgkmcnt(0)
    s_add_u32 s48, s6, s63
    s_addc_u32 s49, s7, 0
    s_cmp_lt_u32 s56, 40
    s_cbranch_scc0 L_nob0
    s_barrier
L_nob0:
    buffer_load_dwordx4 v[40:43], v1, s[48:51], s97 offen offset:0 nt
    buffer_load_dwordx4 v[44:47], v1, s[48:51], s97 offen offset:1024 nt
    s_cmp_lt_u32 s56, 40
    s_cbranch_scc1 L_stream2
    s_barrier
    s_branch L_stream2
L_helpers:
    s_cmp_lg_u32 s3, 0
    s_cbranch_scc1 L_noinit
    v_lshlrev_b32 v1, 2, v0
    v_add_u32 v1, 161920, v1
    ds_write_b32 v1, v36
L_noinit:
    s_waitcnt lgkmcnt(0)
    s_mov_b32 s40, s32
    s_mov_b32 s41, s33
    s_mov_b32 s42, 589824
    s_mov_b32 s43, 0x20000
    s_mov_b32 s44, s30
    s_mov_b32 s45, s31
    s_mov_b32 s46, 256
    s_mov_b32 s47, 0x20000
    s_lshl2_add_u32 s62, s35, s3
    s_cmp_eq_u32 s62, 87
    s_cbranch_scc1 L_touch
L_notp:
    s_mul_i32 s101, s3, 20480
    s_mov_b32 s96, s56
    s_cmp_lt_u32 s56, 40
    s_cbranch_scc0 L_nothalf
    s_cmp_lt_u32 s3, 2
    s_cbranch_scc1 L_unit
    s_add_u32 s62, s56, 20
    s_cmp_eq_u32 s3, 2
    s_cbranch_scc1 L_job
    s_lshr_b32 s62, s56, 1
    s_lshl_b32 s63, s62, 11
    s_cmp_ge_u32 s62, 10
    s_cselect_b32 s62, -19968, 0
    s_add_u32 s63, s63, s62
    s_and_b32 s62, s56, 1
    s_lshl_b32 s62, s62, 8
    s_add_u32 s63, s63, s62
    v_lshrrev_b32 v1, 5, v0
    v_lshlrev_b32 v1, 10, v1
    v_and_b32 v2, 31, v0
    v_lshl_add_u32 v1, v2, 3, v1
    v_mov_b32 v4, -1
    v_mov_b32 v5, -1
    buffer_store_dwordx2 v[4:5], v1, s[40:43], s63 offen sc1
    s_lshl_b32 s62, s56, 1
    s_waitcnt vmcnt(0)
    s_mov_b64 exec, 1
    buffer_store_short v4, v36, s[44:47], s62 offen offset:128 sc1
    s_mov_b64 exec, -1
    s_barrier
    s_branch L_service
L_nothalf:
    s_cmp_lt_u32 s56, 104
    s_cbranch_scc1 L_unit
    s_sub_u32 s62, s56, 144
    s_cmp_lt_u32 s62, 10
    s_cbranch_scc0 L_nojob
    s_cmp_lt_u32 s3, 2
    s_cbranch_scc0 L_nojob
    s_mul_i32 s63, s3, 10
    s_add_u32 s62, s62, s63
L_job:
    s_cmp_lt_u32 s62, 59
    s_cbranch_scc0 L_end
    s_mov_b32 s100, s101
    s_lshl_b32 s101, s62, 9
    s_add_u32 s101, s101, 155648
    s_cmp_lt_u32 s62, 27
    s_cselect_b32 s63, 0, 27
    s_cselect_b32 s3, 7, 6
    s_cmp_lt_u32 s62, 54
    s_cselect_b32 s63, s63, 32
    s_cselect_b32 s3, s3, 5
    s_sub_u32 s35, s62, s63
    s_mov_b32 s34, 2
    s_lshr_b32 s36, s35, 3
    s_add_u32 s36, s36, 8
    s_bfe_u32 s37, s35, 0x20001
    s_and_b32 s38, s35, 1
    s_mov_b32 s59, 0
    s_branch L_stream
L_nojob:
    s_barrier
    s_cmp_ge_u32 s35, 22
    s_cbranch_scc1 L_h_t1
    s_cmp_eq_u32 s39, 1
    s_cbranch_scc1 L_h_role
    s_cmp_lt_u32 s96, 144
    s_cbranch_scc1 L_unit
    s_cmp_eq_u32 s3, 3
    s_cbranch_scc1 L_service
    s_endpgm
L_unit:
    v_lshrrev_b32 v3, 4, v0
    v_and_b32 v4, 3, v0
    v_bfe_u32 v7, v0, 2, 2
    s_mov_b32 s14, s3
    s_mov_b32 s15, 3
    s_sub_u32 s62, s96, 40
    s_cmp_lt_u32 s62, 64
    s_cbranch_scc1 L_u_q
    s_mov_b32 s100, 1
    s_sub_u32 s96, s96, 84
    s_cmp_lt_u32 s56, 40
    s_cbranch_scc0 L_u_full
    s_mov_b32 s100, 0
    s_lshr_b32 s96, s56, 1
    s_and_b32 s62, s56, 1
    s_lshl1_add_u32 s14, s62, s14
    s_mov_b32 s15, 1
L_u_full:
    s_mov_b32 s97, 0
    s_mov_b32 s99, 7680
    s_mov_b32 s48, s26
    s_mov_b32 s49, s27
    s_mov_b32 s50, 4915200
    s_mov_b32 s51, 0x20000
    s_mov_b32 s52, s24
    s_mov_b32 s53, s25
    s_mov_b32 s54, 5120
    s_mov_b32 s55, 0x20000
    v_and_b32 v6, 15, v0
    v_lshlrev_b32 v6, 4, v6
    v_mul_u32_u24 v5, 1280, v3
    v_add_u32 v5, v5, v6
    s_mul_i32 s62, s14, 320
    buffer_load_dwordx4 v[8:11], v5, s[52:55], s62 offen
    s_mov_b32 exec_lo, 0x000f000f
    s_mov_b32 exec_hi, 0x000f000f
    buffer_load_dwordx4 v[12:15], v5, s[52:55], s62 offen offset:256
    s_mov_b64 exec, -1
    s_lshl_b32 s98, s96, 7
    s_mul_i32 s13, s96, 0x199a
    s_lshr_b32 s13, s13, 16
    s_cmp_lg_u32 s13, 1
    s_cbranch_scc1 L_u_go
    s_mov_b32 s52, s4
    s_mov_b32 s53, s5
    s_mov_b32 s54, 5120
    s_mov_b32 s55, 0x20000
    v_mul_u32_u24 v5, 1280, v4
    v_lshlrev_b32 v64, 5, v7
    v_lshl_add_u32 v64, v3, 3, v64
    v_add_u32 v64, v64, v5
    v_lshrrev_b32 v6, 2, v0
    v_lshl_add_u32 v6, v6, 4, v5
    s_sub_u32 s62, s98, 1280
    buffer_load_dwordx4 v[16:19], v6, s[52:55], 0 offen offset:0
    buffer_load_dwordx4 v[20:23], v6, s[52:55], 0 offen offset:256
    buffer_load_dwordx4 v[24:27], v6, s[52:55], 0 offen offset:512
    buffer_load_dwordx4 v[28:31], v6, s[52:55], 0 offen offset:768
    buffer_load_dwordx4 v[32:35], v6, s[52:55], 0 offen offset:1024
    buffer_load_dwordx2 v[66:67], v64, s[52:55], s62 offen
    s_branch L_u_go
L_u_q:
    s_mov_b32 s97, 1
    s_mov_b32 s99, 8192
    s_mov_b32 s100, 0
    s_lshl_b32 s98, s62, 7
    s_mov_b32 s48, s10
    s_mov_b32 s49, s11
    s_mov_b32 s50, 5242880
    s_mov_b32 s51, 0x20000
L_u_go:
    v_lshrrev_b32 v6, 3, v0
    v_mul_lo_u32 v1, v6, s99
    v_and_b32 v6, 2, v6
    v_xor_b32 v6, v6, v0
    v_and_b32 v6, 7, v6
    v_lshl_add_u32 v1, v6, 4, v1
    v_add_u32 v1, s98, v1
    v_xor_b32 v2, 64, v1
    s_mul_i32 s63, s99, s14
    s_mul_i32 s63, s63, 160
    s_lshl_b32 s59, s99, 3
    s_mov_b32 m0, s101
    s_mov_b32 s62, 10
L_dma_1:
    buffer_load_dwordx4 v1, s[48:51], s63 offen nt lds
    s_add_u32 m0, m0, 1024
    s_add_u32 s63, s63, s59
    s_cmp_eq_u32 s100, 0
    s_cbranch_scc1 L_dma_1n0
    s_waitcnt vmcnt(3)
    s_cmp_eq_u32 s100, 2
    s_cbranch_scc1 L_dma_1n0
    s_waitcnt vmcnt(3)
L_dma_1n0:
    buffer_load_dwordx4 v2, s[48:51], s63 offen nt lds
    s_add_u32 m0, m0, 1024
    s_add_u32 s63, s63, s59
    s_cmp_eq_u32 s100, 0
    s_cbranch_scc1 L_dma_1n1
    s_waitcnt vmcnt(3)
    s_cmp_eq_u32 s100, 2
    s_cbranch_scc1 L_dma_1n1
    s_waitcnt vmcnt(3)
L_dma_1n1:
    s_sub_u32 s62, s62, 1
    s_cmp_lg_u32 s62, 0
    s_cbranch_scc1 L_dma_1
    v_and_b32 v65, 31, v0
    v_lshlrev_b32 v65, 2, v65
    s_cmp_lt_u32 s56, 104
    s_cselect_b32 s62, 32, 64
    v_min_u32 v6, 51, v0
    v_lshlrev_b32 v6, 2, v6
    v_cmp_le_u32 vcc, s62, v0
    s_nop 1
    v_cndmask_b32 v65, v65, v6, vcc
    v_mov_b32 v68, -1
    s_cmp_lt_u32 s56, 40
    s_cbranch_scc1 L_u_nofl
    buffer_load_dword v68, v65, s[44:47], 0 offen sc1
L_u_nofl:
    s_cmp_lt_u32 s56, 104
    s_cbranch_scc0 L_u_nob
    s_barrier
L_u_nob:
    v_lshrrev_b32 v60, 4, v0
    v_lshlrev_b32 v60, 10, v60
    v_bfe_u32 v6, v0, 2, 2
    v_lshl_add_u32 v60, v6, 7, v60
    v_and_b32 v6, 3, v0
    v_lshl_add_u32 v60, v6, 3, v60
    v_bfe_u32 v6, v0, 3, 2
    v_lshl_add_u32 v60, v6, 5, v60
    v_xor_b32 v61, 32, v60
    v_xor_b32 v62, 64, v60
    v_xor_b32 v63, 0x60, v60
    v_add_u32 v60, s101, v60
    v_add_u32 v61, s101, v61
    v_add_u32 v62, s101, v62
    v_add_u32 v63, s101, v63
    v_mov_b32 v56, 1.0
    v_mov_b32 v57, 1.0
    v_mov_b32 v58, 1.0
    v_mov_b32 v59, 1.0
    s_mov_b32 s58, 0
    v_lshl_add_u32 v69, v7, 2, v3
    v_lshl_add_u32 v69, v4, 4, v69
    v_and_b32 v64, 15, v0
    v_lshlrev_b32 v64, 3, v64
    s_cmp_eq_u32 s97, 1
    s_cbranch_scc1 L_u_q2
    v_mul_u32_u24 v6, 1280, v3
    v_add_u32 v64, v64, v6
    s_mul_i32 s63, s13, 3840
    s_add_u32 s57, s98, s63
    s_add_u32 s57, s57, 10240
    s_cmp_lt_u32 s56, 40
    s_cbranch_scc0 L_u_nat
    v_lshrrev_b32 v69, 1, v3
    v_lshlrev_b32 v69, 3, v69
    v_lshl_add_u32 v69, v7, 4, v69
    v_lshl_add_u32 v69, v4, 1, v69
    v_and_b32 v6, 1, v3
    v_add_u32 v69, v69, v6
    s_lshr_b32 s62, s56, 1
    s_lshl_b32 s57, s62, 11
    s_cmp_ge_u32 s62, 10
    s_cselect_b32 s62, -19968, 0
    s_add_u32 s57, s57, s62
    s_and_b32 s62, s56, 1
    s_lshl_b32 s62, s62, 8
    s_add_u32 s57, s57, s62
    v_lshrrev_b32 v64, 5, v0
    v_lshlrev_b32 v64, 10, v64
    v_and_b32 v6, 31, v0
    v_lshl_add_u32 v64, v6, 3, v64
L_u_nat:
    s_cmp_eq_u32 s13, 4
    s_cselect_b32 s58, 1.0, 0
    s_cmp_eq_u32 s13, 1
    s_cselect_b32 s58, 1.0, s58
    s_cselect_b32 s56, 1, 0
    s_cmp_eq_u32 s14, 0
    s_cselect_b32 s58, s58, 0
    s_waitcnt vmcnt(20)
    s_mov_b32 s62, 0xbfb8aa3b
    v_lshlrev_b32 v40, 16, v8
    v_and_b32 v41, 0xffff0000, v8
    v_lshlrev_b32 v42, 16, v9
    v_and_b32 v43, 0xffff0000, v9
    v_lshlrev_b32 v44, 16, v10
    v_and_b32 v45, 0xffff0000, v10
    v_lshlrev_b32 v46, 16, v11
    v_and_b32 v47, 0xffff0000, v11
    v_mul_f32 v48, s62, v40
    v_mul_f32 v49, s62, v41
    v_mul_f32 v50, s62, v42
    v_mul_f32 v51, s62, v43
    v_mul_f32 v52, s62, v44
    v_mul_f32 v53, s62, v45
    v_mul_f32 v54, s62, v46
    v_mul_f32 v55, s62, v47
    v_exp_f32 v48, v48
    v_exp_f32 v49, v49
    v_exp_f32 v50, v50
    v_exp_f32 v51, v51
    v_exp_f32 v52, v52
    v_exp_f32 v53, v53
    v_exp_f32 v54, v54
    v_exp_f32 v55, v55
    v_add_f32 v48, 1.0, v48
    v_add_f32 v49, 1.0, v49
    v_add_f32 v50, 1.0, v50
    v_add_f32 v51, 1.0, v51
    v_add_f32 v52, 1.0, v52
    v_add_f32 v53, 1.0, v53
    v_add_f32 v54, 1.0, v54
    v_add_f32 v55, 1.0, v55
    v_rcp_f32 v48, v48
    v_rcp_f32 v49, v49
    v_rcp_f32 v50, v50
    v_rcp_f32 v51, v51
    v_rcp_f32 v52, v52
    v_rcp_f32 v53, v53
    v_rcp_f32 v54, v54
    v_rcp_f32 v55, v55
    v_mul_f32 v40, v40, v48
    v_mul_f32 v41, v41, v49
    v_mul_f32 v42, v42, v50
    v_mul_f32 v43, v43, v51
    v_mul_f32 v44, v44, v52
    v_mul_f32 v45, v45, v53
    v_mul_f32 v46, v46, v54
    v_mul_f32 v47, v47, v55
    v_cvt_pk_bf16_f32 v8, v40, v41
    v_cvt_pk_bf16_f32 v9, v42, v43
    v_cvt_pk_bf16_f32 v10, v44, v45
    v_cvt_pk_bf16_f32 v11, v46, v47
    v_lshlrev_b32 v40, 16, v12
    v_and_b32 v41, 0xffff0000, v12
    v_lshlrev_b32 v42, 16, v13
    v_and_b32 v43, 0xffff0000, v13
    v_lshlrev_b32 v44, 16, v14
    v_and_b32 v45, 0xffff0000, v14
    v_lshlrev_b32 v46, 16, v15
    v_and_b32 v47, 0xffff0000, v15
    v_mul_f32 v48, s62, v40
    v_mul_f32 v49, s62, v41
    v_mul_f32 v50, s62, v42
    v_mul_f32 v51, s62, v43
    v_mul_f32 v52, s62, v44
    v_mul_f32 v53, s62, v45
    v_mul_f32 v54, s62, v46
    v_mul_f32 v55, s62, v47
    v_exp_f32 v48, v48
    v_exp_f32 v49, v49
    v_exp_f32 v50, v50
    v_exp_f32 v51, v51
    v_exp_f32 v52, v52
    v_exp_f32 v53, v53
    v_exp_f32 v54, v54
    v_exp_f32 v55, v55
    v_add_f32 v48, 1.0, v48
    v_add_f32 v49, 1.0, v49
    v_add_f32 v50, 1.0, v50
    v_add_f32 v51, 1.0, v51
    v_add_f32 v52, 1.0, v52
    v_add_f32 v53, 1.0, v53
    v_add_f32 v54, 1.0, v54
    v_add_f32 v55, 1.0, v55
    v_rcp_f32 v48, v48
    v_rcp_f32 v49, v49
    v_rcp_f32 v50, v50
    v_rcp_f32 v51, v51
    v_rcp_f32 v52, v52
    v_rcp_f32 v53, v53
    v_rcp_f32 v54, v54
    v_rcp_f32 v55, v55
    v_mul_f32 v40, v40, v48
    v_mul_f32 v41, v41, v49
    v_mul_f32 v42, v42, v50
    v_mul_f32 v43, v43, v51
    v_mul_f32 v44, v44, v52
    v_mul_f32 v45, v45, v53
    v_mul_f32 v46, v46, v54
    v_mul_f32 v47, v47, v55
    v_cvt_pk_bf16_f32 v12, v40, v41
    v_cvt_pk_bf16_f32 v13, v42, v43
    v_cvt_pk_bf16_f32 v14, v44, v45
    v_cvt_pk_bf16_f32 v15, v46, v47
    s_mul_i32 s62, s3, 1344
    s_add_u32 s62, s62, 151552
    v_mul_u32_u24 v5, 336, v3
    v_and_b32 v6, 15, v0
    v_lshl_add_u32 v5, v6, 4, v5
    v_add_u32 v5, s62, v5
    ds_write_b128 v5, v[8:11]
    s_mov_b32 exec_lo, 0x000f000f
    s_mov_b32 exec_hi, 0x000f000f
    ds_write_b128 v5, v[12:15] offset:256
    s_mov_b64 exec, -1
    v_mul_u32_u24 v5, 336, v4
    v_lshl_add_u32 v5, v3, 4, v5
    v_add_u32 v5, s62, v5
    s_mov_b32 s59, 0x3e800000
    s_cmp_eq_u32 s56, 0
    s_cbranch_scc1 L_u_nost
    v_mov_b32 v40, 0
    v_mov_b32 v41, 0
    s_mov_b32 s62, 0x3f803f80
    v_dot2c_f32_bf16 v40, s62, v16
    v_dot2c_f32_bf16 v41, v16, v16
    v_dot2c_f32_bf16 v40, s62, v17
    v_dot2c_f32_bf16 v41, v17, v17
    v_dot2c_f32_bf16 v40, s62, v18
    v_dot2c_f32_bf16 v41, v18, v18
    v_dot2c_f32_bf16 v40, s62, v19
    v_dot2c_f32_bf16 v41, v19, v19
    v_dot2c_f32_bf16 v40, s62, v20
    v_dot2c_f32_bf16 v41, v20, v20
    v_dot2c_f32_bf16 v40, s62, v21
    v_dot2c_f32_bf16 v41, v21, v21
    v_dot2c_f32_bf16 v40, s62, v22
    v_dot2c_f32_bf16 v41, v22, v22
    v_dot2c_f32_bf16 v40, s62, v23
    v_dot2c_f32_bf16 v41, v23, v23
    v_dot2c_f32_bf16 v40, s62, v24
    v_dot2c_f32_bf16 v41, v24, v24
    v_dot2c_f32_bf16 v40, s62, v25
    v_dot2c_f32_bf16 v41, v25, v25
    v_dot2c_f32_bf16 v40, s62, v26
    v_dot2c_f32_bf16 v41, v26, v26
    v_dot2c_f32_bf16 v40, s62, v27
    v_dot2c_f32_bf16 v41, v27, v27
    v_dot2c_f32_bf16 v40, s62, v28
    v_dot2c_f32_bf16 v41, v28, v28
    v_dot2c_f32_bf16 v40, s62, v29
    v_dot2c_f32_bf16 v41, v29, v29
    v_dot2c_f32_bf16 v40, s62, v30
    v_dot2c_f32_bf16 v41, v30, v30
    v_dot2c_f32_bf16 v40, s62, v31
    v_dot2c_f32_bf16 v41, v31, v31
    v_dot2c_f32_bf16 v40, s62, v32
    v_dot2c_f32_bf16 v41, v32, v32
    v_dot2c_f32_bf16 v40, s62, v33
    v_dot2c_f32_bf16 v41, v33, v33
    v_dot2c_f32_bf16 v40, s62, v34
    v_dot2c_f32_bf16 v41, v34, v34
    v_dot2c_f32_bf16 v40, s62, v35
    v_dot2c_f32_bf16 v41, v35, v35
    s_nop 1
    v_add_f32_dpp v40, v40, v40 row_ror:4 row_mask:0xf bank_mask:0xf
    v_add_f32_dpp v41, v41, v41 row_ror:4 row_mask:0xf bank_mask:0xf
    s_nop 0
    v_add_f32_dpp v40, v40, v40 row_ror:8 row_mask:0xf bank_mask:0xf
    v_add_f32_dpp v41, v41, v41 row_ror:8 row_mask:0xf bank_mask:0xf
    v_mov_b32 v42, v40
    v_mov_b32 v43, v41
    s_nop 0
    v_permlane16_swap_b32 v40, v42
    v_permlane16_swap_b32 v41, v43
    v_add_f32 v40, v40, v42
    v_add_f32 v41, v41, v43
    v_mov_b32 v42, v40
    v_mov_b32 v43, v41
    s_nop 0
    v_permlane32_swap_b32 v40, v42
    v_permlane32_swap_b32 v41, v43
    v_add_f32 v40, v40, v42
    v_add_f32 v41, v41, v43
    s_mov_b32 s62, 0x3acccccd
    v_mul_f32 v40, s62, v40
    v_mul_f32 v41, s62, v41
    v_fma_f32 v41, -v40, v40, v41
    v_max_f32 v41, 0, v41
    v_add_f32 v41, 0x3727c5ac, v41
    v_rsq_f32 v41, v41
    v_lshlrev_b32 v56, 16, v66
    v_and_b32 v57, 0xffff0000, v66
    v_lshlrev_b32 v58, 16, v67
    v_and_b32 v59, 0xffff0000, v67
    v_sub_f32 v56, v56, v40
    v_sub_f32 v57, v57, v40
    v_sub_f32 v58, v58, v40
    v_sub_f32 v59, v59, v40
    v_mul_f32 v56, v56, v41
    v_mul_f32 v57, v57, v41
    v_mul_f32 v58, v58, v41
    v_mul_f32 v59, v59, v41
L_u_nost:
    ds_read_b128 v[8:11], v5 offset:0
    ds_read_b128 v[12:15], v5 offset:64
    ds_read_b128 v[16:19], v5 offset:128
    ds_read_b128 v[20:23], v5 offset:192
    ds_read_b128 v[24:27], v5 offset:256
    s_branch L_u_frag
L_u_q2:
    v_lshl_add_u32 v64, v3, 13, v64
    s_add_u32 s57, s98, 40960
    v_lshlrev_b32 v5, 8, v7
    v_lshl_add_u32 v5, v3, 6, v5
    v_lshl_add_u32 v5, v4, 4, v5
    s_mul_i32 s63, s3, 5120
    s_add_u32 s63, s63, 0
    s_add_u32 s12, s63, 4096
    s_mov_b32 s59, 1.0
L_u_frag:
    s_waitcnt vmcnt(0)
    v_cmp_ne_u32 vcc, -1, v68
    s_cbranch_vccz L_u_yok
L_wy_2:
    buffer_load_dword v37, v65, s[44:47], 0 offen sc1
    s_waitcnt vmcnt(0)
    v_cmp_ne_u32 vcc, -1, v37
    s_cbranch_vccz L_wy_2e
    s_sleep 4
    s_sub_u32 s60, s60, 1
    s_cbranch_scc0 L_wy_2
    s_mov_b32 s60, 0
L_wy_2e:
L_u_yok:
    ds_read_b64_tr_b16 v[80:81], v60 offset:0
    ds_read_b64_tr_b16 v[82:83], v60 offset:512
    ds_read_b64_tr_b16 v[84:85], v61 offset:0
    ds_read_b64_tr_b16 v[86:87], v61 offset:512
    ds_read_b64_tr_b16 v[88:89], v62 offset:0
    ds_read_b64_tr_b16 v[90:91], v62 offset:512
    ds_read_b64_tr_b16 v[92:93], v63 offset:0
    ds_read_b64_tr_b16 v[94:95], v63 offset:512
    ds_read_b64_tr_b16 v[96:97], v60 offset:4096
    ds_read_b64_tr_b16 v[98:99], v60 offset:4608
    ds_read_b64_tr_b16 v[100:101], v61 offset:4096
    ds_read_b64_tr_b16 v[102:103], v61 offset:4608
    ds_read_b64_tr_b16 v[104:105], v62 offset:4096
    ds_read_b64_tr_b16 v[106:107], v62 offset:4608
    ds_read_b64_tr_b16 v[108:109], v63 offset:4096
    ds_read_b64_tr_b16 v[110:111], v63 offset:4608
    ds_read_b64_tr_b16 v[112:113], v60 offset:8192
    ds_read_b64_tr_b16 v[114:115], v60 offset:8704
    ds_read_b64_tr_b16 v[116:117], v61 offset:8192
    ds_read_b64_tr_b16 v[118:119], v61 offset:8704
    ds_read_b64_tr_b16 v[120:121], v62 offset:8192
    ds_read_b64_tr_b16 v[122:123], v62 offset:8704
    ds_read_b64_tr_b16 v[124:125], v63 offset:8192
    ds_read_b64_tr_b16 v[126:127], v63 offset:8704
    ds_read_b64_tr_b16 v[128:129], v60 offset:12288
    ds_read_b64_tr_b16 v[130:131], v60 offset:12800
    ds_read_b64_tr_b16 v[132:133], v61 offset:12288
    ds_read_b64_tr_b16 v[134:135], v61 offset:12800
    ds_read_b64_tr_b16 v[136:137], v62 offset:12288
    ds_read_b64_tr_b16 v[138:139], v62 offset:12800
    ds_read_b64_tr_b16 v[140:141], v63 offset:12288
    ds_read_b64_tr_b16 v[142:143], v63 offset:12800
    ds_read_b64_tr_b16 v[144:145], v60 offset:16384
    ds_read_b64_tr_b16 v[146:147], v60 offset:16896
    ds_read_b64_tr_b16 v[148:149], v61 offset:16384
    ds_read_b64_tr_b16 v[150:151], v61 offset:16896
    ds_read_b64_tr_b16 v[152:153], v62 offset:16384
    ds_read_b64_tr_b16 v[154:155], v62 offset:16896
    ds_read_b64_tr_b16 v[156:157], v63 offset:16384
    ds_read_b64_tr_b16 v[158:159], v63 offset:16896
    s_cmp_eq_u32 s97, 0
    s_cbranch_scc1 L_u_mm
    s_branch L_poll_3
L_poll_3s:
    s_sleep 8
L_poll_3:
    buffer_load_dwordx4 v[8:11], v5, s[40:43], s63 offen offset:0 sc1
    buffer_load_dwordx4 v[12:15], v5, s[40:43], s63 offen offset:1024 sc1
    buffer_load_dwordx4 v[16:19], v5, s[40:43], s63 offen offset:2048 sc1
    buffer_load_dwordx4 v[20:23], v5, s[40:43], s63 offen offset:3072 sc1
    buffer_load_dwordx4 v[24:27], v5, s[40:43], s12 offen offset:0 sc1
    s_sub_u32 s60, s60, 1
    s_cbranch_scc1 L_poll_3t
    s_waitcnt vmcnt(0)
    v_max3_u32 v37, v8, v9, v10
    v_max3_u32 v37, v37, v11, v12
    v_max3_u32 v37, v37, v13, v14
    v_max3_u32 v37, v37, v15, v16
    v_max3_u32 v37, v37, v17, v18
    v_max3_u32 v37, v37, v19, v20
    v_max3_u32 v37, v37, v21, v22
    v_max3_u32 v37, v37, v23, v24
    v_max3_u32 v37, v37, v25, v26
    v_max_u32 v37, v37, v27
    v_cmp_eq_u32 vcc, -1, v37
    s_cbranch_vccnz L_poll_3s
L_poll_3e:
L_u_got:
L_u_mm:
    s_waitcnt lgkmcnt(0)
    v_mfma_f32_16x16x32_bf16 v[40:43], v[80:83], v[8:11], 0
    v_mfma_f32_16x16x32_bf16 v[44:47], v[84:87], v[8:11], 0
    v_mfma_f32_16x16x32_bf16 v[48:51], v[88:91], v[8:11], 0
    v_mfma_f32_16x16x32_bf16 v[52:55], v[92:95], v[8:11], 0
    v_mfma_f32_16x16x32_bf16 v[40:43], v[96:99], v[12:15], v[40:43]
    v_mfma_f32_16x16x32_bf16 v[44:47], v[100:103], v[12:15], v[44:47]
    v_mfma_f32_16x16x32_bf16 v[48:51], v[104:107], v[12:15], v[48:51]
    v_mfma_f32_16x16x32_bf16 v[52:55], v[108:111], v[12:15], v[52:55]
    v_mfma_f32_16x16x32_bf16 v[40:43], v[112:115], v[16:19], v[40:43]
    v_mfma_f32_16x16x32_bf16 v[44:47], v[116:119], v[16:19], v[44:47]
    v_mfma_f32_16x16x32_bf16 v[48:51], v[120:123], v[16:19], v[48:51]
    v_mfma_f32_16x16x32_bf16 v[52:55], v[124:127], v[16:19], v[52:55]
    v_mfma_f32_16x16x32_bf16 v[40:43], v[128:131], v[20:23], v[40:43]
    v_mfma_f32_16x16x32_bf16 v[44:47], v[132:135], v[20:23], v[44:47]
    v_mfma_f32_16x16x32_bf16 v[48:51], v[136:139], v[20:23], v[48:51]
    v_mfma_f32_16x16x32_bf16 v[52:55], v[140:143], v[20:23], v[52:55]
    v_mfma_f32_16x16x32_bf16 v[40:43], v[144:147], v[24:27], v[40:43]
    v_mfma_f32_16x16x32_bf16 v[44:47], v[148:151], v[24:27], v[44:47]
    v_mfma_f32_16x16x32_bf16 v[48:51], v[152:155], v[24:27], v[48:51]
    v_mfma_f32_16x16x32_bf16 v[52:55], v[156:159], v[24:27], v[52:55]
    v_lshlrev_b32 v5, 4, v0
    v_add_u32 v5, 147456, v5
    s_lshl_b32 s62, s3, 10
    s_add_u32 s62, s62, 147456
    v_lshl_add_u32 v6, v69, 4, s62
    v_mov_b32 v24, s58
    v_mov_b32 v32, 162056
    v_mov_b32 v33, 1
    v_add_f32_dpp v40, v40, v40 row_ror:8 row_mask:0xf bank_mask:0xf
    v_add_f32_dpp v41, v41, v41 row_ror:8 row_mask:0xf bank_mask:0xf
    v_add_f32_dpp v42, v42, v42 row_ror:8 row_mask:0xf bank_mask:0xf
    v_add_f32_dpp v43, v43, v43 row_ror:8 row_mask:0xf bank_mask:0xf
    v_add_f32_dpp v44, v44, v44 row_ror:8 row_mask:0xf bank_mask:0xf
    v_add_f32_dpp v45, v45, v45 row_ror:8 row_mask:0xf bank_mask:0xf
    v_add_f32_dpp v46, v46, v46 row_ror:8 row_mask:0xf bank_mask:0xf
    v_add_f32_dpp v47, v47, v47 row_ror:8 row_mask:0xf bank_mask:0xf
    v_add_f32_dpp v48, v48, v48 row_ror:8 row_mask:0xf bank_mask:0xf
    v_add_f32_dpp v49, v49, v49 row_ror:8 row_mask:0xf bank_mask:0xf
    v_add_f32_dpp v50, v50, v50 row_ror:8 row_mask:0xf bank_mask:0xf
    v_add_f32_dpp v51, v51, v51 row_ror:8 row_mask:0xf bank_mask:0xf
    v_add_f32_dpp v52, v52, v52 row_ror:8 row_mask:0xf bank_mask:0xf
    v_add_f32_dpp v53, v53, v53 row_ror:8 row_mask:0xf bank_mask:0xf
    v_add_f32_dpp v54, v54, v54 row_ror:8 row_mask:0xf bank_mask:0xf
    v_add_f32_dpp v55, v55, v55 row_ror:8 row_mask:0xf bank_mask:0xf
    v_add_f32_dpp v28, v40, v40 row_ror:4 row_mask:0xf bank_mask:0x1
    v_add_f32_dpp v29, v41, v41 row_ror:4 row_mask:0xf bank_mask:0x1
    v_add_f32_dpp v30, v42, v42 row_ror:4 row_mask:0xf bank_mask:0x1
    v_add_f32_dpp v31, v43, v43 row_ror:4 row_mask:0xf bank_mask:0x1
    v_add_f32_dpp v28, v44, v44 row_ror:4 row_mask:0xf bank_mask:0x2
    v_add_f32_dpp v29, v45, v45 row_ror:4 row_mask:0xf bank_mask:0x2
    v_add_f32_dpp v30, v46, v46 row_ror:4 row_mask:0xf bank_mask:0x2
    v_add_f32_dpp v31, v47, v47 row_ror:4 row_mask:0xf bank_mask:0x2
    v_add_f32_dpp v28, v48, v48 row_ror:4 row_mask:0xf bank_mask:0x4
    v_add_f32_dpp v29, v49, v49 row_ror:4 row_mask:0xf bank_mask:0x4
    v_add_f32_dpp v30, v50, v50 row_ror:4 row_mask:0xf bank_mask:0x4
    v_add_f32_dpp v31, v51, v51 row_ror:4 row_mask:0xf bank_mask:0x4
    v_add_f32_dpp v28, v52, v52 row_ror:4 row_mask:0xf bank_mask:0x8
    v_add_f32_dpp v29, v53, v53 row_ror:4 row_mask:0xf bank_mask:0x8
    v_add_f32_dpp v30, v54, v54 row_ror:4 row_mask:0xf bank_mask:0x8
    v_add_f32_dpp v31, v55, v55 row_ror:4 row_mask:0xf bank_mask:0x8
    v_fma_f32 v28, v28, s59, v24
    v_fma_f32 v29, v29, s59, v24
    v_fma_f32 v30, v30, s59, v24
    v_fma_f32 v31, v31, s59, v24
    v_mul_f32 v28, v28, v56
    v_mul_f32 v29, v29, v57
    v_mul_f32 v30, v30, v58
    v_mul_f32 v31, v31, v59
    ds_write_b128 v6, v[28:31]
    s_mov_b64 exec, 1
    ds_add_rtn_u32 v34, v32, v33
    s_mov_b64 exec, -1
    ds_read_b128 v[8:11], v5
    ds_read_b128 v[12:15], v5 offset:1024
    ds_read_b128 v[16:19], v5 offset:2048
    ds_read_b128 v[20:23], v5 offset:3072
    s_waitcnt lgkmcnt(0)
    v_readfirstlane_b32 s62, v34
    s_nop 0
    s_cmp_eq_u32 s62, s15
    s_cbranch_scc1 L_u_last
    s_cmp_eq_u32 s62, 1
    s_cbranch_scc1 L_service
    s_endpgm
L_u_last:
    v_add_f32 v8, v8, v12
    v_add_f32 v9, v9, v13
    v_add_f32 v10, v10, v14
    v_add_f32 v11, v11, v15
    s_cmp_eq_u32 s15, 1
    s_cbranch_scc1 L_u_two
    v_add_f32 v16, v16, v20
    v_add_f32 v17, v17, v21
    v_add_f32 v18, v18, v22
    v_add_f32 v19, v19, v23
    v_add_f32 v8, v8, v16
    v_add_f32 v9, v9, v17
    v_add_f32 v10, v10, v18
    v_add_f32 v11, v11, v19
L_u_two:
    v_cvt_pk_bf16_f32 v8, v8, v9
    v_cvt_pk_bf16_f32 v9, v10, v11
    buffer_store_dwordx2 v[8:9], v64, s[40:43], s57 offen sc1
    s_endpgm
L_touch:
    s_load_dword s0, s[32:33], 0
    s_load_dword s0, s[30:31], 0
    s_cmp_eq_u32 s39, 1
    s_cbranch_scc1 L_tpr
    s_mov_b32 s62, 16777216
    s_load_dword s0, s[8:9], s62
    s_mov_b32 s62, 83886080
    s_load_dword s0, s[8:9], s62
    s_mov_b32 s62, 150994944
    s_load_dword s0, s[8:9], s62
    s_mov_b32 s62, 218103808
    s_load_dword s0, s[8:9], s62
    s_branch L_tpv
L_tpr:
    s_load_dword s0, s[20:21], 0
    s_mov_b32 s62, 2211836
    s_load_dword s0, s[20:21], s62
    s_load_dword s0, s[16:17], 0
    s_mov_b32 s62, 2211836
    s_load_dword s0, s[16:17], s62
    s_load_dword s0, s[18:19], 0
    s_load_dword s0, s[22:23], 0
    s_load_dword s0, s[28:29], 0
    s_load_dword s0, s[4:5], 0
L_tpv:
    s_lshl_b32 s62, s34, 23
    s_load_dword s0, s[8:9], s62
    s_add_u32 s62, s62, 67108864
    s_load_dword s0, s[8:9], s62
    s_add_u32 s62, s62, 67108864
    s_load_dword s0, s[8:9], s62
    s_add_u32 s62, s62, 67108864
    s_load_dword s0, s[8:9], s62
    s_add_u32 s62, s62, 67108864
    s_branch L_notp
L_stream2:
    s_mov_b32 s12, s100
    s_mov_b32 s13, s101
    s_mov_b32 s40, s32
    s_mov_b32 s41, s33
    s_mov_b32 s42, 589824
    s_mov_b32 s43, 0x20000
    s_mov_b32 s44, s30
    s_mov_b32 s45, s31
    s_mov_b32 s46, 256
    s_mov_b32 s47, 0x20000
    s_bitcmp1_b32 s3, 0
    s_mov_b32 s57, 0xffffffff
    s_mov_b32 s58, 0xffff
    s_mov_b32 s14, 0xffffffff
    s_mov_b32 s15, 0x0
L_pm_9:
    s_cmp_lt_u32 s56, 104
    s_cbranch_scc0 L_pm_10
    s_bitcmp1_b32 s3, 0
    s_mov_b32 s57, 0xffff
    s_mov_b32 s58, 0x0
    s_mov_b32 s14, 0xffffffff
    s_mov_b32 s15, 0x0
L_pm_10:
    s_sub_u32 s96, s56, 43
    s_and_b32 s96, s96, 0xffffffc7
    s_cmp_eq_u32 s96, 0
    s_cbranch_scc0 L_pm_11
    s_bitcmp1_b32 s3, 0
    s_mov_b32 s57, 0x0
    s_mov_b32 s58, 0x0
    s_mov_b32 s14, 0x0
    s_mov_b32 s15, 0x0
L_pm_11:
    s_cmp_lt_u32 s56, 40
    s_cbranch_scc0 L_pm_12
    s_bitcmp1_b32 s3, 0
    s_mov_b32 s57, 0xffffffff
    s_mov_b32 s58, 0xf
    s_mov_b32 s14, 0xffffffff
    s_mov_b32 s15, 0x0
L_pm_12:
    s_cmp_eq_u32 s39, 1
    s_cbranch_scc0 L_pm_13
    s_bitcmp1_b32 s3, 0
    s_mov_b32 s57, 0xff
    s_mov_b32 s58, 0xff
    s_mov_b32 s14, 0xff00ff
    s_cselect_b32 s14, 0xff00ff00, s14
    s_mov_b32 s15, 0x0
L_pm_13:
    s_cmp_lg_u32 s13, 0
    s_cbranch_scc0 L_pm_14
    s_bitcmp1_b32 s3, 0
    s_mov_b32 s57, 0xff00ff
    s_cselect_b32 s57, 0xff00ff00, s57
    s_mov_b32 s58, 0x0
    s_mov_b32 s14, 0x0
    s_mov_b32 s15, 0x0
L_pm_14:
    s_and_b32 s96, s39, s59
    s_cbranch_scc0 L_pm_15
    s_bitcmp1_b32 s3, 0
    s_mov_b32 s57, 0x3ff
    s_mov_b32 s58, 0x3ff
    s_mov_b32 s14, 0x0
    s_mov_b32 s15, 0x0
L_pm_15:
    s_add_u32 s52, s8, s63
    s_addc_u32 s53, s9, 0
    s_mov_b32 s54, 262144
    s_mov_b32 s55, 0x20000
    v_and_b32 v2, 15, v0
    v_lshrrev_b32 v3, 1, v2
    v_and_b32 v37, 1, v2
    v_lshlrev_b32 v37, 4, v37
    v_mov_b32 v38, 0xffff
    v_lshlrev_b32 v37, v37, v38
    v_cmp_eq_u32 vcc, 0, v3
    v_mov_b32 v32, 0
    s_nop 0
    v_cndmask_b32 v20, 0, v37, vcc
    v_cmp_eq_u32 vcc, 1, v3
    v_mov_b32 v33, 0
    s_nop 0
    v_cndmask_b32 v21, 0, v37, vcc
    v_cmp_eq_u32 vcc, 2, v3
    v_mov_b32 v34, 0
    s_nop 0
    v_cndmask_b32 v22, 0, v37, vcc
    v_cmp_eq_u32 vcc, 3, v3
    v_mov_b32 v35, 0
    s_nop 0
    v_cndmask_b32 v23, 0, v37, vcc
    v_lshlrev_b32 v2, 4, v2
    s_lshl_b32 s98, s62, 8
    s_add_u32 s98, s98, 40960
    s_lshl_b32 s99, s62, 7
    s_add_u32 s99, s99, 73728
    s_bitcmp0_b32 s57, 2
    s_cbranch_scc1 L_sf_16
    s_bitcmp0_b32 s58, 2
    s_cbranch_scc1 L_sf_16
    s_waitcnt vmcnt(1)
L_sf_16:
    buffer_load_dwordx4 v[48:51], v1, s[48:51], s97 offen offset:2048 nt
    s_bitcmp0_b32 s57, 3
    s_cbranch_scc1 L_sf_17
    s_waitcnt vmcnt(2)
    s_bitcmp0_b32 s58, 3
    s_cbranch_scc1 L_sf_17
    s_waitcnt vmcnt(1)
L_sf_17:
    buffer_load_dwordx4 v[52:55], v1, s[48:51], s97 offen offset:3072 nt
    s_add_u32 s97, s97, 32768
    v_add_u32 v1, 4096, v1
    v_and_b32 v1, 0x7fff, v1
    s_waitcnt vmcnt(3)
    s_bitcmp0_b32 s57, 4
    s_cbranch_scc1 L_sf_18
    s_waitcnt vmcnt(2)
    s_bitcmp0_b32 s58, 4
    s_cbranch_scc1 L_sf_18
    s_waitcnt vmcnt(1)
L_sf_18:
    buffer_load_dwordx4 v[56:59], v1, s[48:51], s97 offen offset:0 nt
    s_waitcnt vmcnt(3)
    s_bitcmp0_b32 s57, 5
    s_cbranch_scc1 L_sf_19
    s_waitcnt vmcnt(2)
    s_bitcmp0_b32 s58, 5
    s_cbranch_scc1 L_sf_19
    s_waitcnt vmcnt(1)
L_sf_19:
    buffer_load_dwordx4 v[60:63], v1, s[48:51], s97 offen offset:1024 nt
    s_waitcnt vmcnt(3)
    s_bitcmp0_b32 s57, 6
    s_cbranch_scc1 L_sf_20
    s_waitcnt vmcnt(2)
    s_bitcmp0_b32 s58, 6
    s_cbranch_scc1 L_sf_20
    s_waitcnt vmcnt(1)
L_sf_20:
    buffer_load_dwordx4 v[64:67], v1, s[48:51], s97 offen offset:2048 nt
    s_waitcnt vmcnt(3)
    s_bitcmp0_b32 s57, 7
    s_cbranch_scc1 L_sf_21
    s_waitcnt vmcnt(2)
    s_bitcmp0_b32 s58, 7
    s_cbranch_scc1 L_sf_21
    s_waitcnt vmcnt(1)
L_sf_21:
    buffer_load_dwordx4 v[68:71], v1, s[48:51], s97 offen offset:3072 nt
    s_add_u32 s97, s97, 32768
    v_add_u32 v1, 4096, v1
    v_and_b32 v1, 0x7fff, v1
    s_waitcnt vmcnt(3)
    s_bitcmp0_b32 s57, 8
    s_cbranch_scc1 L_sf_22
    s_waitcnt vmcnt(2)
    s_bitcmp0_b32 s58, 8
    s_cbranch_scc1 L_sf_22
    s_waitcnt vmcnt(1)
L_sf_22:
    buffer_load_dwordx4 v[72:75], v1, s[48:51], s97 offen offset:0 nt
    s_waitcnt vmcnt(3)
    s_bitcmp0_b32 s57, 9
    s_cbranch_scc1 L_sf_23
    s_waitcnt vmcnt(2)
    s_bitcmp0_b32 s58, 9
    s_cbranch_scc1 L_sf_23
    s_waitcnt vmcnt(1)
L_sf_23:
    buffer_load_dwordx4 v[76:79], v1, s[48:51], s97 offen offset:1024 nt
    s_waitcnt vmcnt(3)
    s_bitcmp0_b32 s57, 10
    s_cbranch_scc1 L_sf_24
    s_waitcnt vmcnt(2)
    s_bitcmp0_b32 s58, 10
    s_cbranch_scc1 L_sf_24
    s_waitcnt vmcnt(1)
L_sf_24:
    buffer_load_dwordx4 v[80:83], v1, s[48:51], s97 offen offset:2048 nt
    s_waitcnt vmcnt(3)
    s_bitcmp0_b32 s57, 11
    s_cbranch_scc1 L_sf_25
    s_waitcnt vmcnt(2)
    s_bitcmp0_b32 s58, 11
    s_cbranch_scc1 L_sf_25
    s_waitcnt vmcnt(1)
L_sf_25:
    buffer_load_dwordx4 v[84:87], v1, s[48:51], s97 offen offset:3072 nt
    s_add_u32 s97, s97, 32768
    v_add_u32 v1, 4096, v1
    v_and_b32 v1, 0x7fff, v1
    s_waitcnt vmcnt(3)
    s_bitcmp0_b32 s57, 12
    s_cbranch_scc1 L_sf_26
    s_waitcnt vmcnt(2)
    s_bitcmp0_b32 s58, 12
    s_cbranch_scc1 L_sf_26
    s_waitcnt vmcnt(1)
L_sf_26:
    buffer_load_dwordx4 v[88:91], v1, s[48:51], s97 offen offset:0 nt
    s_waitcnt vmcnt(3)
    s_bitcmp0_b32 s57, 13
    s_cbranch_scc1 L_sf_27
    s_waitcnt vmcnt(2)
    s_bitcmp0_b32 s58, 13
    s_cbranch_scc1 L_sf_27
    s_waitcnt vmcnt(1)
L_sf_27:
    buffer_load_dwordx4 v[92:95], v1, s[48:51], s97 offen offset:1024 nt
    s_waitcnt vmcnt(3)
    s_bitcmp0_b32 s57, 14
    s_cbranch_scc1 L_sf_28
    s_waitcnt vmcnt(2)
    s_bitcmp0_b32 s58, 14
    s_cbranch_scc1 L_sf_28
    s_waitcnt vmcnt(1)
L_sf_28:
    buffer_load_dwordx4 v[96:99], v1, s[48:51], s97 offen offset:2048 nt
    s_waitcnt vmcnt(3)
    s_bitcmp0_b32 s57, 15
    s_cbranch_scc1 L_sf_29
    s_waitcnt vmcnt(2)
    s_bitcmp0_b32 s58, 15
    s_cbranch_scc1 L_sf_29
    s_waitcnt vmcnt(1)
L_sf_29:
    buffer_load_dwordx4 v[100:103], v1, s[48:51], s97 offen offset:3072 nt
    s_add_u32 s97, s97, 32768
    v_add_u32 v1, 4096, v1
    v_and_b32 v1, 0x7fff, v1
    s_waitcnt vmcnt(3)
    s_bitcmp0_b32 s57, 16
    s_cbranch_scc1 L_sf_30
    s_waitcnt vmcnt(2)
    s_bitcmp0_b32 s58, 16
    s_cbranch_scc1 L_sf_30
    s_waitcnt vmcnt(1)
L_sf_30:
    buffer_load_dwordx4 v[104:107], v1, s[48:51], s97 offen offset:0 nt
    s_waitcnt vmcnt(3)
    s_bitcmp0_b32 s57, 17
    s_cbranch_scc1 L_sf_31
    s_waitcnt vmcnt(2)
    s_bitcmp0_b32 s58, 17
    s_cbranch_scc1 L_sf_31
    s_waitcnt vmcnt(1)
L_sf_31:
    buffer_load_dwordx4 v[108:111], v1, s[48:51], s97 offen offset:1024 nt
    s_waitcnt vmcnt(3)
    s_bitcmp0_b32 s57, 18
    s_cbranch_scc1 L_sf_32
    s_waitcnt vmcnt(2)
    s_bitcmp0_b32 s58, 18
    s_cbranch_scc1 L_sf_32
    s_waitcnt vmcnt(1)
L_sf_32:
    buffer_load_dwordx4 v[112:115], v1, s[48:51], s97 offen offset:2048 nt
    s_waitcnt vmcnt(3)
    s_bitcmp0_b32 s57, 19
    s_cbranch_scc1 L_sf_33
    s_waitcnt vmcnt(2)
    s_bitcmp0_b32 s58, 19
    s_cbranch_scc1 L_sf_33
    s_waitcnt vmcnt(1)
L_sf_33:
    buffer_load_dwordx4 v[116:119], v1, s[48:51], s97 offen offset:3072 nt
    s_add_u32 s97, s97, 32768
    v_add_u32 v1, 4096, v1
    v_and_b32 v1, 0x7fff, v1
    s_waitcnt vmcnt(3)
    s_bitcmp0_b32 s57, 20
    s_cbranch_scc1 L_sf_34
    s_waitcnt vmcnt(2)
    s_bitcmp0_b32 s58, 20
    s_cbranch_scc1 L_sf_34
    s_waitcnt vmcnt(1)
L_sf_34:
    buffer_load_dwordx4 v[120:123], v1, s[48:51], s97 offen offset:0 nt
    s_waitcnt vmcnt(3)
    s_bitcmp0_b32 s57, 21
    s_cbranch_scc1 L_sf_35
    s_waitcnt vmcnt(2)
    s_bitcmp0_b32 s58, 21
    s_cbranch_scc1 L_sf_35
    s_waitcnt vmcnt(1)
L_sf_35:
    buffer_load_dwordx4 v[124:127], v1, s[48:51], s97 offen offset:1024 nt
    s_cmp_eq_u32 s12, -1
    s_cbranch_scc1 L_k_nopf
    s_waitcnt vmcnt(3)
    s_bitcmp0_b32 s57, 22
    s_cbranch_scc1 L_sf_36
    s_waitcnt vmcnt(2)
    s_bitcmp0_b32 s58, 22
    s_cbranch_scc1 L_sf_36
    s_waitcnt vmcnt(1)
L_sf_36:
    buffer_load_dwordx4 v[128:131], v1, s[48:51], s97 offen offset:2048 nt
    s_waitcnt vmcnt(3)
    s_bitcmp0_b32 s57, 23
    s_cbranch_scc1 L_sf_37
    s_waitcnt vmcnt(2)
    s_bitcmp0_b32 s58, 23
    s_cbranch_scc1 L_sf_37
    s_waitcnt vmcnt(1)
L_sf_37:
    buffer_load_dwordx4 v[132:135], v1, s[48:51], s97 offen offset:3072 nt
    s_add_u32 s97, s97, 32768
    v_add_u32 v1, 4096, v1
    v_and_b32 v1, 0x7fff, v1
    s_waitcnt vmcnt(3)
    s_bitcmp0_b32 s57, 24
    s_cbranch_scc1 L_sf_38
    s_waitcnt vmcnt(2)
    s_bitcmp0_b32 s58, 24
    s_cbranch_scc1 L_sf_38
    s_waitcnt vmcnt(1)
L_sf_38:
    buffer_load_dwordx4 v[136:139], v1, s[48:51], s97 offen offset:0 nt
    s_waitcnt vmcnt(3)
    s_bitcmp0_b32 s57, 25
    s_cbranch_scc1 L_sf_39
    s_waitcnt vmcnt(2)
    s_bitcmp0_b32 s58, 25
    s_cbranch_scc1 L_sf_39
    s_waitcnt vmcnt(1)
L_sf_39:
    buffer_load_dwordx4 v[140:143], v1, s[48:51], s97 offen offset:1024 nt
    s_waitcnt vmcnt(3)
    s_bitcmp0_b32 s57, 26
    s_cbranch_scc1 L_sf_40
    s_waitcnt vmcnt(2)
    s_bitcmp0_b32 s58, 26
    s_cbranch_scc1 L_sf_40
    s_waitcnt vmcnt(1)
L_sf_40:
    buffer_load_dwordx4 v[144:147], v1, s[48:51], s97 offen offset:2048 nt
    s_waitcnt vmcnt(3)
    s_bitcmp0_b32 s57, 27
    s_cbranch_scc1 L_sf_41
    s_waitcnt vmcnt(2)
    s_bitcmp0_b32 s58, 27
    s_cbranch_scc1 L_sf_41
    s_waitcnt vmcnt(1)
L_sf_41:
    buffer_load_dwordx4 v[148:151], v1, s[48:51], s97 offen offset:3072 nt
    s_add_u32 s97, s97, 32768
    v_add_u32 v1, 4096, v1
    v_and_b32 v1, 0x7fff, v1
    s_waitcnt vmcnt(3)
    s_bitcmp0_b32 s57, 28
    s_cbranch_scc1 L_sf_42
    s_waitcnt vmcnt(2)
    s_bitcmp0_b32 s58, 28
    s_cbranch_scc1 L_sf_42
    s_waitcnt vmcnt(1)
L_sf_42:
    buffer_load_dwordx4 v[152:155], v1, s[48:51], s97 offen offset:0 nt
    s_waitcnt vmcnt(3)
    s_bitcmp0_b32 s57, 29
    s_cbranch_scc1 L_sf_43
    s_waitcnt vmcnt(2)
    s_bitcmp0_b32 s58, 29
    s_cbranch_scc1 L_sf_43
    s_waitcnt vmcnt(1)
L_sf_43:
    buffer_load_dwordx4 v[156:159], v1, s[48:51], s97 offen offset:1024 nt
    s_waitcnt vmcnt(3)
    s_bitcmp0_b32 s57, 30
    s_cbranch_scc1 L_sf_44
    s_waitcnt vmcnt(2)
    s_bitcmp0_b32 s58, 30
    s_cbranch_scc1 L_sf_44
    s_waitcnt vmcnt(1)
L_sf_44:
    buffer_load_dwordx4 v[160:163], v1, s[48:51], s97 offen offset:2048 nt
    v_and_b32 v39, 31, v0
    v_lshlrev_b32 v39, 2, v39
    buffer_load_dword v37, v39, s[44:47], 0 offen sc1
    s_waitcnt vmcnt(4)
    s_bitcmp0_b32 s57, 31
    s_cbranch_scc1 L_sf_45
    s_waitcnt vmcnt(3)
    s_bitcmp0_b32 s58, 31
    s_cbranch_scc1 L_sf_45
    s_waitcnt vmcnt(2)
L_sf_45:
    buffer_load_dwordx4 v[164:167], v1, s[48:51], s97 offen offset:3072 nt
    s_mov_b32 s97, 0
    v_add_u32 v1, 4096, v1
    v_and_b32 v1, 0x7fff, v1
    s_waitcnt vmcnt(4)
    s_bitcmp0_b32 s14, 0
    s_cbranch_scc1 L_sf_46
    s_waitcnt vmcnt(3)
    s_bitcmp0_b32 s15, 0
    s_cbranch_scc1 L_sf_46
    s_waitcnt vmcnt(2)
L_sf_46:
    s_add_u32 m0, s12, 0
    s_nop 0
    buffer_load_dwordx4 v1, s[52:55], s97 offen offset:0 nt lds
    s_waitcnt vmcnt(4)
    s_bitcmp0_b32 s14, 1
    s_cbranch_scc1 L_sf_47
    s_waitcnt vmcnt(3)
    s_bitcmp0_b32 s15, 1
    s_cbranch_scc1 L_sf_47
    s_waitcnt vmcnt(1)
L_sf_47:
    buffer_load_dwordx4 v1, s[52:55], s97 offen offset:1024 nt lds
    s_waitcnt vmcnt(4)
    s_bitcmp0_b32 s14, 2
    s_cbranch_scc1 L_sf_48
    s_waitcnt vmcnt(2)
    s_bitcmp0_b32 s15, 2
    s_cbranch_scc1 L_sf_48
    s_waitcnt vmcnt(1)
L_sf_48:
    buffer_load_dwordx4 v1, s[52:55], s97 offen offset:2048 nt lds
    s_waitcnt vmcnt(3)
    s_bitcmp0_b32 s14, 3
    s_cbranch_scc1 L_sf_49
    s_waitcnt vmcnt(2)
    s_bitcmp0_b32 s15, 3
    s_cbranch_scc1 L_sf_49
    s_waitcnt vmcnt(1)
L_sf_49:
    buffer_load_dwordx4 v1, s[52:55], s97 offen offset:3072 nt lds
    s_add_u32 s97, s97, 32768
    v_add_u32 v1, 4096, v1
    v_and_b32 v1, 0x7fff, v1
    v_cmp_eq_u32 vcc, 0, v37
    s_nop 0
    s_or_b32 s96, vcc_lo, vcc_hi
    buffer_load_dwordx4 v[4:7], v2, s[40:43], s98 offen sc1
    s_waitcnt vmcnt(4)
    s_bitcmp0_b32 s14, 4
    s_cbranch_scc1 L_sf_50
    s_waitcnt vmcnt(3)
    s_bitcmp0_b32 s15, 4
    s_cbranch_scc1 L_sf_50
    s_waitcnt vmcnt(2)
L_sf_50:
    s_add_u32 m0, s12, 4096
    s_nop 0
    buffer_load_dwordx4 v1, s[52:55], s97 offen offset:0 nt lds
    s_waitcnt vmcnt(4)
    s_bitcmp0_b32 s14, 5
    s_cbranch_scc1 L_sf_51
    s_waitcnt vmcnt(3)
    s_bitcmp0_b32 s15, 5
    s_cbranch_scc1 L_sf_51
    s_waitcnt vmcnt(2)
L_sf_51:
    buffer_load_dwordx4 v1, s[52:55], s97 offen offset:1024 nt lds
    s_waitcnt vmcnt(4)
    s_bitcmp0_b32 s14, 6
    s_cbranch_scc1 L_sf_52
    s_waitcnt vmcnt(3)
    s_bitcmp0_b32 s15, 6
    s_cbranch_scc1 L_sf_52
    s_waitcnt vmcnt(1)
L_sf_52:
    buffer_load_dwordx4 v1, s[52:55], s97 offen offset:2048 nt lds
    s_waitcnt vmcnt(4)
    s_bitcmp0_b32 s14, 7
    s_cbranch_scc1 L_sf_53
    s_waitcnt vmcnt(2)
    s_bitcmp0_b32 s15, 7
    s_cbranch_scc1 L_sf_53
    s_waitcnt vmcnt(1)
L_sf_53:
    buffer_load_dwordx4 v1, s[52:55], s97 offen offset:3072 nt lds
    s_add_u32 s97, s97, 32768
    v_add_u32 v1, 4096, v1
    v_and_b32 v1, 0x7fff, v1
L_k_join:
    s_waitcnt vmcnt(4)
    v_max3_u32 v38, v4, v5, v6
    v_max_u32 v38, v38, v7
    v_cmp_eq_u32 vcc, -1, v38
    s_cmp_lg_u32 s96, 0
    s_cbranch_scc1 L_qslow
    s_cbranch_vccnz L_qslow2
L_qok:
    v_dot2_f32_bf16 v8, v72, v4, 0
    v_dot2_f32_bf16 v9, v76, v4, 0
    v_dot2_f32_bf16 v10, v80, v4, 0
    v_dot2_f32_bf16 v11, v84, v4, 0
    v_dot2_f32_bf16 v24, v88, v4, 0
    v_dot2_f32_bf16 v25, v92, v4, 0
    v_dot2_f32_bf16 v26, v96, v4, 0
    v_dot2_f32_bf16 v27, v100, v4, 0
    v_dot2_f32_bf16 v8, v73, v5, v8
    v_dot2_f32_bf16 v9, v77, v5, v9
    v_dot2_f32_bf16 v10, v81, v5, v10
    v_dot2_f32_bf16 v11, v85, v5, v11
    v_dot2_f32_bf16 v24, v89, v5, v24
    v_dot2_f32_bf16 v25, v93, v5, v25
    v_dot2_f32_bf16 v26, v97, v5, v26
    v_dot2_f32_bf16 v27, v101, v5, v27
    v_dot2_f32_bf16 v8, v74, v6, v8
    v_dot2_f32_bf16 v9, v78, v6, v9
    v_dot2_f32_bf16 v10, v82, v6, v10
    v_dot2_f32_bf16 v11, v86, v6, v11
    v_dot2_f32_bf16 v24, v90, v6, v24
    v_dot2_f32_bf16 v25, v94, v6, v25
    v_dot2_f32_bf16 v26, v98, v6, v26
    v_dot2_f32_bf16 v27, v102, v6, v27
    v_dot2_f32_bf16 v8, v75, v7, v8
    v_dot2_f32_bf16 v9, v79, v7, v9
    v_dot2_f32_bf16 v10, v83, v7, v10
    v_dot2_f32_bf16 v11, v87, v7, v11
    v_dot2_f32_bf16 v24, v91, v7, v24
    v_dot2_f32_bf16 v25, v95, v7, v25
    v_dot2_f32_bf16 v26, v99, v7, v26
    v_dot2_f32_bf16 v27, v103, v7, v27
    v_add_f32_dpp v8, v8, v8 row_ror:8 row_mask:0xf bank_mask:0x3
    v_add_f32_dpp v10, v10, v10 row_ror:8 row_mask:0xf bank_mask:0x3
    v_add_f32_dpp v24, v24, v24 row_ror:8 row_mask:0xf bank_mask:0x3
    v_add_f32_dpp v26, v26, v26 row_ror:8 row_mask:0xf bank_mask:0x3
    v_add_f32_dpp v8, v9, v9 row_ror:8 row_mask:0xf bank_mask:0xc
    v_add_f32_dpp v10, v11, v11 row_ror:8 row_mask:0xf bank_mask:0xc
    v_add_f32_dpp v24, v25, v25 row_ror:8 row_mask:0xf bank_mask:0xc
    v_add_f32_dpp v26, v27, v27 row_ror:8 row_mask:0xf bank_mask:0xc
    v_add_f32_dpp v14, v8, v8 row_half_mirror row_mask:0xf bank_mask:0x5
    v_add_f32_dpp v15, v24, v24 row_half_mirror row_mask:0xf bank_mask:0x5
    v_add_f32_dpp v14, v10, v10 row_half_mirror row_mask:0xf bank_mask:0xa
    v_add_f32_dpp v15, v26, v26 row_half_mirror row_mask:0xf bank_mask:0xa
    s_nop 0
    v_add_f32_dpp v14, v14, v14 quad_perm:[1,0,3,2] row_mask:0xf bank_mask:0xf
    v_add_f32_dpp v15, v15, v15 quad_perm:[1,0,3,2] row_mask:0xf bank_mask:0xf
    s_nop 0
    v_add_f32_dpp v14, v14, v14 quad_perm:[2,3,0,1] row_mask:0xf bank_mask:0xf
    v_add_f32_dpp v15, v15, v15 quad_perm:[2,3,0,1] row_mask:0xf bank_mask:0xf
    s_waitcnt vmcnt(3)
    s_bitcmp0_b32 s14, 8
    s_cbranch_scc1 L_sf_64
    s_waitcnt vmcnt(2)
    s_bitcmp0_b32 s15, 8
    s_cbranch_scc1 L_sf_64
    s_waitcnt vmcnt(1)
L_sf_64:
    buffer_load_dwordx4 v[72:75], v1, s[52:55], s97 offen offset:0 nt
    v_dot2_f32_bf16 v8, v40, v4, 0
    v_dot2_f32_bf16 v9, v44, v4, 0
    v_dot2_f32_bf16 v10, v48, v4, 0
    v_dot2_f32_bf16 v11, v52, v4, 0
    v_dot2_f32_bf16 v24, v56, v4, 0
    v_dot2_f32_bf16 v25, v60, v4, 0
    v_dot2_f32_bf16 v26, v64, v4, 0
    v_dot2_f32_bf16 v27, v68, v4, 0
    v_dot2_f32_bf16 v28, v104, v4, 0
    v_dot2_f32_bf16 v29, v108, v4, 0
    v_dot2_f32_bf16 v30, v112, v4, 0
    v_dot2_f32_bf16 v31, v116, v4, 0
    v_dot2_f32_bf16 v8, v41, v5, v8
    v_dot2_f32_bf16 v9, v45, v5, v9
    v_dot2_f32_bf16 v10, v49, v5, v10
    v_dot2_f32_bf16 v11, v53, v5, v11
    v_dot2_f32_bf16 v24, v57, v5, v24
    v_dot2_f32_bf16 v25, v61, v5, v25
    v_dot2_f32_bf16 v26, v65, v5, v26
    v_dot2_f32_bf16 v27, v69, v5, v27
    v_dot2_f32_bf16 v28, v105, v5, v28
    v_dot2_f32_bf16 v29, v109, v5, v29
    v_dot2_f32_bf16 v30, v113, v5, v30
    v_dot2_f32_bf16 v31, v117, v5, v31
    v_dot2_f32_bf16 v8, v42, v6, v8
    v_dot2_f32_bf16 v9, v46, v6, v9
    v_dot2_f32_bf16 v10, v50, v6, v10
    v_dot2_f32_bf16 v11, v54, v6, v11
    v_dot2_f32_bf16 v24, v58, v6, v24
    v_dot2_f32_bf16 v25, v62, v6, v25
    v_dot2_f32_bf16 v26, v66, v6, v26
    v_dot2_f32_bf16 v27, v70, v6, v27
    v_dot2_f32_bf16 v28, v106, v6, v28
    v_dot2_f32_bf16 v29, v110, v6, v29
    v_dot2_f32_bf16 v30, v114, v6, v30
    v_dot2_f32_bf16 v31, v118, v6, v31
    v_dot2_f32_bf16 v8, v43, v7, v8
    v_dot2_f32_bf16 v9, v47, v7, v9
    v_dot2_f32_bf16 v10, v51, v7, v10
    v_dot2_f32_bf16 v11, v55, v7, v11
    v_dot2_f32_bf16 v24, v59, v7, v24
    v_dot2_f32_bf16 v25, v63, v7, v25
    v_dot2_f32_bf16 v26, v67, v7, v26
    v_dot2_f32_bf16 v27, v71, v7, v27
    v_dot2_f32_bf16 v28, v107, v7, v28
    v_dot2_f32_bf16 v29, v111, v7, v29
    v_dot2_f32_bf16 v30, v115, v7, v30
    v_dot2_f32_bf16 v31, v119, v7, v31
    v_add_f32_dpp v8, v8, v8 row_ror:8 row_mask:0xf bank_mask:0x3
    v_add_f32_dpp v10, v10, v10 row_ror:8 row_mask:0xf bank_mask:0x3
    v_add_f32_dpp v24, v24, v24 row_ror:8 row_mask:0xf bank_mask:0x3
    v_add_f32_dpp v26, v26, v26 row_ror:8 row_mask:0xf bank_mask:0x3
    v_add_f32_dpp v28, v28, v28 row_ror:8 row_mask:0xf bank_mask:0x3
    v_add_f32_dpp v30, v30, v30 row_ror:8 row_mask:0xf bank_mask:0x3
    v_add_f32_dpp v8, v9, v9 row_ror:8 row_mask:0xf bank_mask:0xc
    v_add_f32_dpp v10, v11, v11 row_ror:8 row_mask:0xf bank_mask:0xc
    v_add_f32_dpp v24, v25, v25 row_ror:8 row_mask:0xf bank_mask:0xc
    v_add_f32_dpp v26, v27, v27 row_ror:8 row_mask:0xf bank_mask:0xc
    v_add_f32_dpp v28, v29, v29 row_ror:8 row_mask:0xf bank_mask:0xc
    v_add_f32_dpp v30, v31, v31 row_ror:8 row_mask:0xf bank_mask:0xc
    v_add_f32_dpp v12, v8, v8 row_half_mirror row_mask:0xf bank_mask:0x5
    v_add_f32_dpp v13, v24, v24 row_half_mirror row_mask:0xf bank_mask:0x5
    v_add_f32_dpp v16, v28, v28 row_half_mirror row_mask:0xf bank_mask:0x5
    v_add_f32_dpp v12, v10, v10 row_half_mirror row_mask:0xf bank_mask:0xa
    v_add_f32_dpp v13, v26, v26 row_half_mirror row_mask:0xf bank_mask:0xa
    v_add_f32_dpp v16, v30, v30 row_half_mirror row_mask:0xf bank_mask:0xa
    v_add_f32_dpp v12, v12, v12 quad_perm:[1,0,3,2] row_mask:0xf bank_mask:0xf
    v_add_f32_dpp v13, v13, v13 quad_perm:[1,0,3,2] row_mask:0xf bank_mask:0xf
    v_add_f32_dpp v16, v16, v16 quad_perm:[1,0,3,2] row_mask:0xf bank_mask:0xf
    v_add_f32_dpp v12, v12, v12 quad_perm:[2,3,0,1] row_mask:0xf bank_mask:0xf
    v_add_f32_dpp v13, v13, v13 quad_perm:[2,3,0,1] row_mask:0xf bank_mask:0xf
    v_add_f32_dpp v16, v16, v16 quad_perm:[2,3,0,1] row_mask:0xf bank_mask:0xf
    s_waitcnt vmcnt(3)
    s_bitcmp0_b32 s14, 9
    s_cbranch_scc1 L_sf_65
    s_waitcnt vmcnt(2)
    s_bitcmp0_b32 s15, 9
    s_cbranch_scc1 L_sf_65
    s_waitcnt vmcnt(1)
L_sf_65:
    buffer_load_dwordx4 v[76:79], v1, s[52:55], s97 offen offset:1024 nt
    v_dot2_f32_bf16 v8, v120, v4, 0
    v_dot2_f32_bf16 v9, v124, v4, 0
    v_dot2_f32_bf16 v10, v128, v4, 0
    v_dot2_f32_bf16 v11, v132, v4, 0
    v_dot2_f32_bf16 v24, v136, v4, 0
    v_dot2_f32_bf16 v25, v140, v4, 0
    v_dot2_f32_bf16 v26, v144, v4, 0
    v_dot2_f32_bf16 v27, v148, v4, 0
    v_dot2_f32_bf16 v8, v121, v5, v8
    v_dot2_f32_bf16 v9, v125, v5, v9
    v_dot2_f32_bf16 v10, v129, v5, v10
    v_dot2_f32_bf16 v11, v133, v5, v11
    v_dot2_f32_bf16 v24, v137, v5, v24
    v_dot2_f32_bf16 v25, v141, v5, v25
    v_dot2_f32_bf16 v26, v145, v5, v26
    v_dot2_f32_bf16 v27, v149, v5, v27
    v_dot2_f32_bf16 v8, v122, v6, v8
    v_dot2_f32_bf16 v9, v126, v6, v9
    v_dot2_f32_bf16 v10, v130, v6, v10
    v_dot2_f32_bf16 v11, v134, v6, v11
    v_dot2_f32_bf16 v24, v138, v6, v24
    v_dot2_f32_bf16 v25, v142, v6, v25
    v_dot2_f32_bf16 v26, v146, v6, v26
    v_dot2_f32_bf16 v27, v150, v6, v27
    v_dot2_f32_bf16 v8, v123, v7, v8
    v_dot2_f32_bf16 v9, v127, v7, v9
    v_dot2_f32_bf16 v10, v131, v7, v10
    v_dot2_f32_bf16 v11, v135, v7, v11
    v_dot2_f32_bf16 v24, v139, v7, v24
    v_dot2_f32_bf16 v25, v143, v7, v25
    v_dot2_f32_bf16 v26, v147, v7, v26
    v_dot2_f32_bf16 v27, v151, v7, v27
    v_add_f32_dpp v8, v8, v8 row_ror:8 row_mask:0xf bank_mask:0x3
    v_add_f32_dpp v10, v10, v10 row_ror:8 row_mask:0xf bank_mask:0x3
    v_add_f32_dpp v24, v24, v24 row_ror:8 row_mask:0xf bank_mask:0x3
    v_add_f32_dpp v26, v26, v26 row_ror:8 row_mask:0xf bank_mask:0x3
    v_add_f32_dpp v8, v9, v9 row_ror:8 row_mask:0xf bank_mask:0xc
    v_add_f32_dpp v10, v11, v11 row_ror:8 row_mask:0xf bank_mask:0xc
    v_add_f32_dpp v24, v25, v25 row_ror:8 row_mask:0xf bank_mask:0xc
    v_add_f32_dpp v26, v27, v27 row_ror:8 row_mask:0xf bank_mask:0xc
    v_add_f32_dpp v17, v8, v8 row_half_mirror row_mask:0xf bank_mask:0x5
    v_add_f32_dpp v18, v24, v24 row_half_mirror row_mask:0xf bank_mask:0x5
    v_add_f32_dpp v17, v10, v10 row_half_mirror row_mask:0xf bank_mask:0xa
    v_add_f32_dpp v18, v26, v26 row_half_mirror row_mask:0xf bank_mask:0xa
    s_nop 0
    v_add_f32_dpp v17, v17, v17 quad_perm:[1,0,3,2] row_mask:0xf bank_mask:0xf
    v_add_f32_dpp v18, v18, v18 quad_perm:[1,0,3,2] row_mask:0xf bank_mask:0xf
    s_nop 0
    v_add_f32_dpp v17, v17, v17 quad_perm:[2,3,0,1] row_mask:0xf bank_mask:0xf
    v_add_f32_dpp v18, v18, v18 quad_perm:[2,3,0,1] row_mask:0xf bank_mask:0xf
    s_waitcnt vmcnt(3)
    s_bitcmp0_b32 s14, 10
    s_cbranch_scc1 L_sf_66
    s_waitcnt vmcnt(2)
    s_bitcmp0_b32 s15, 10
    s_cbranch_scc1 L_sf_66
    s_waitcnt vmcnt(1)
L_sf_66:
    buffer_load_dwordx4 v[80:83], v1, s[52:55], s97 offen offset:2048 nt
    s_waitcnt vmcnt(3)
    s_bitcmp0_b32 s14, 11
    s_cbranch_scc1 L_sf_67
    s_waitcnt vmcnt(2)
    s_bitcmp0_b32 s15, 11
    s_cbranch_scc1 L_sf_67
    s_waitcnt vmcnt(1)
L_sf_67:
    buffer_load_dwordx4 v[84:87], v1, s[52:55], s97 offen offset:3072 nt
    s_add_u32 s97, s97, 32768
    v_add_u32 v1, 4096, v1
    v_and_b32 v1, 0x7fff, v1
    s_cmp_eq_u32 s12, -1
    s_cbranch_scc1 L_nopfrd
    v_lshl_add_u32 v38, v0, 4, s12
    ds_read_b128 v[40:43], v38 offset:0
    ds_read_b128 v[44:47], v38 offset:1024
    ds_read_b128 v[48:51], v38 offset:2048
    ds_read_b128 v[52:55], v38 offset:3072
    ds_read_b128 v[56:59], v38 offset:4096
    ds_read_b128 v[60:63], v38 offset:5120
    ds_read_b128 v[64:67], v38 offset:6144
    ds_read_b128 v[68:71], v38 offset:7168
L_nopfrd:
    v_dot2_f32_bf16 v8, v152, v4, 0
    v_dot2_f32_bf16 v9, v156, v4, 0
    v_dot2_f32_bf16 v10, v160, v4, 0
    v_dot2_f32_bf16 v11, v164, v4, 0
    v_dot2_f32_bf16 v8, v153, v5, v8
    v_dot2_f32_bf16 v9, v157, v5, v9
    v_dot2_f32_bf16 v10, v161, v5, v10
    v_dot2_f32_bf16 v11, v165, v5, v11
    v_dot2_f32_bf16 v8, v154, v6, v8
    v_dot2_f32_bf16 v9, v158, v6, v9
    v_dot2_f32_bf16 v10, v162, v6, v10
    v_dot2_f32_bf16 v11, v166, v6, v11
    v_dot2_f32_bf16 v8, v155, v7, v8
    v_dot2_f32_bf16 v9, v159, v7, v9
    v_dot2_f32_bf16 v10, v163, v7, v10
    v_dot2_f32_bf16 v11, v167, v7, v11
    v_add_f32_dpp v8, v8, v8 row_ror:8 row_mask:0xf bank_mask:0x3
    s_nop 0
    v_add_f32_dpp v10, v10, v10 row_ror:8 row_mask:0xf bank_mask:0x3
    v_add_f32_dpp v8, v9, v9 row_ror:8 row_mask:0xf bank_mask:0xc
    v_add_f32_dpp v10, v11, v11 row_ror:8 row_mask:0xf bank_mask:0xc
    s_nop 0
    v_add_f32_dpp v19, v8, v8 row_half_mirror row_mask:0xf bank_mask:0x5
    v_add_f32_dpp v19, v10, v10 row_half_mirror row_mask:0xf bank_mask:0xa
    s_nop 1
    v_add_f32_dpp v19, v19, v19 quad_perm:[1,0,3,2] row_mask:0xf bank_mask:0xf
    s_nop 1
    v_add_f32_dpp v19, v19, v19 quad_perm:[2,3,0,1] row_mask:0xf bank_mask:0xf
    v_max3_f32 v3, v12, v13, v14
    v_max3_f32 v8, v15, v16, v17
    v_max3_f32 v3, v3, v18, v19
    v_max_f32 v3, v3, v8
    s_nop 1
    v_max_f32_dpp v3, v3, v3 row_ror:4 row_mask:0xf bank_mask:0xf
    s_nop 1
    v_max_f32_dpp v3, v3, v3 row_ror:8 row_mask:0xf bank_mask:0xf
    v_mov_b32 v8, v3
    s_nop 1
    v_permlane16_swap_b32 v3, v8
    v_max_f32 v3, v3, v8
    v_mov_b32 v8, v3
    s_nop 1
    v_permlane32_swap_b32 v3, v8
    v_max_f32 v3, v3, v8
    s_mov_b32 s96, 0x3e0293ee
    v_mul_f32 v8, s96, v3
    v_fma_f32 v12, v12, s96, -v8
    v_fma_f32 v13, v13, s96, -v8
    v_fma_f32 v14, v14, s96, -v8
    v_fma_f32 v15, v15, s96, -v8
    v_fma_f32 v16, v16, s96, -v8
    v_fma_f32 v17, v17, s96, -v8
    v_fma_f32 v18, v18, s96, -v8
    v_fma_f32 v19, v19, s96, -v8
    v_exp_f32 v12, v12
    v_exp_f32 v13, v13
    v_exp_f32 v14, v14
    v_exp_f32 v15, v15
    v_exp_f32 v16, v16
    v_exp_f32 v17, v17
    v_exp_f32 v18, v18
    v_exp_f32 v19, v19
    v_add_f32 v9, v12, v13
    v_add_f32 v10, v14, v15
    v_add_f32 v11, v16, v17
    v_add_f32 v3, v18, v19
    v_add_f32 v9, v9, v10
    v_add_f32 v3, v3, v11
    v_add_f32 v9, v9, v3
    v_cvt_pk_bf16_f32 v12, v12, v12
    v_cvt_pk_bf16_f32 v13, v13, v13
    v_cvt_pk_bf16_f32 v14, v14, v14
    v_cvt_pk_bf16_f32 v15, v15, v15
    v_cvt_pk_bf16_f32 v16, v16, v16
    v_cvt_pk_bf16_f32 v17, v17, v17
    v_cvt_pk_bf16_f32 v18, v18, v18
    v_cvt_pk_bf16_f32 v19, v19, v19
    v_add_f32_dpp v9, v9, v9 row_ror:4 row_mask:0xf bank_mask:0xf
    s_nop 1
    v_add_f32_dpp v9, v9, v9 row_ror:8 row_mask:0xf bank_mask:0xf
    v_mov_b32 v10, v9
    s_nop 1
    v_permlane16_swap_b32 v9, v10
    v_add_f32 v9, v9, v10
    v_mov_b32 v10, v9
    s_nop 1
    v_permlane32_swap_b32 v9, v10
    v_add_f32 v9, v9, v10
    s_mov_b64 exec, 1
    s_cmp_lg_u32 s13, 0
    s_cbranch_scc1 L_mljob
    s_lshl_b32 s96, s3, 3
    s_add_u32 s96, s96, 161920
    v_mov_b32 v10, s96
    v_mov_b32 v11, 162068
    v_mov_b32 v3, 1
    ds_write_b64 v10, v[8:9]
    ds_add_u32 v11, v3
L_mldone:
    s_mov_b64 exec, -1
    v_lshrrev_b32 v2, 1, v2
    v_and_b32_dpp v24, v14, v20 row_newbcast:0 row_mask:0xf bank_mask:0xf
    v_and_b32_dpp v25, v14, v21 row_newbcast:0 row_mask:0xf bank_mask:0xf
    v_and_b32_dpp v26, v14, v22 row_newbcast:0 row_mask:0xf bank_mask:0xf
    v_and_b32_dpp v27, v14, v23 row_newbcast:0 row_mask:0xf bank_mask:0xf
    s_waitcnt vmcnt(3)
    s_bitcmp0_b32 s14, 12
    s_cbranch_scc1 L_sf_68
    s_waitcnt vmcnt(2)
    s_bitcmp0_b32 s15, 12
    s_cbranch_scc1 L_sf_68
    s_waitcnt vmcnt(1)
L_sf_68:
    buffer_load_dwordx4 v[88:91], v1, s[52:55], s97 offen offset:0 nt
    v_mfma_f32_16x16x32_bf16 v[32:35], v[24:27], v[72:75], v[32:35]
    s_cmp_eq_u32 s12, -1
    s_cbranch_scc1 L_nopfpv8
    s_waitcnt lgkmcnt(0)
    v_and_b32_dpp v24, v12, v20 row_newbcast:0 row_mask:0xf bank_mask:0xf
    v_and_b32_dpp v25, v12, v21 row_newbcast:0 row_mask:0xf bank_mask:0xf
    v_and_b32_dpp v26, v12, v22 row_newbcast:0 row_mask:0xf bank_mask:0xf
    v_and_b32_dpp v27, v12, v23 row_newbcast:0 row_mask:0xf bank_mask:0xf
    s_nop 1
    v_mfma_f32_16x16x32_bf16 v[32:35], v[24:27], v[40:43], v[32:35]
    v_and_b32_dpp v28, v12, v20 row_newbcast:8 row_mask:0xf bank_mask:0xf
    v_and_b32_dpp v29, v12, v21 row_newbcast:8 row_mask:0xf bank_mask:0xf
    v_and_b32_dpp v30, v12, v22 row_newbcast:8 row_mask:0xf bank_mask:0xf
    v_and_b32_dpp v31, v12, v23 row_newbcast:8 row_mask:0xf bank_mask:0xf
    s_nop 1
    v_mfma_f32_16x16x32_bf16 v[32:35], v[28:31], v[44:47], v[32:35]
    v_and_b32_dpp v24, v12, v20 row_newbcast:4 row_mask:0xf bank_mask:0xf
    v_and_b32_dpp v25, v12, v21 row_newbcast:4 row_mask:0xf bank_mask:0xf
    v_and_b32_dpp v26, v12, v22 row_newbcast:4 row_mask:0xf bank_mask:0xf
    v_and_b32_dpp v27, v12, v23 row_newbcast:4 row_mask:0xf bank_mask:0xf
    s_nop 1
    v_mfma_f32_16x16x32_bf16 v[32:35], v[24:27], v[48:51], v[32:35]
    v_and_b32_dpp v28, v12, v20 row_newbcast:12 row_mask:0xf bank_mask:0xf
    v_and_b32_dpp v29, v12, v21 row_newbcast:12 row_mask:0xf bank_mask:0xf
    v_and_b32_dpp v30, v12, v22 row_newbcast:12 row_mask:0xf bank_mask:0xf
    v_and_b32_dpp v31, v12, v23 row_newbcast:12 row_mask:0xf bank_mask:0xf
    s_nop 1
    v_mfma_f32_16x16x32_bf16 v[32:35], v[28:31], v[52:55], v[32:35]
L_nopfpv8:
    v_and_b32_dpp v28, v14, v20 row_newbcast:8 row_mask:0xf bank_mask:0xf
    v_and_b32_dpp v29, v14, v21 row_newbcast:8 row_mask:0xf bank_mask:0xf
    v_and_b32_dpp v30, v14, v22 row_newbcast:8 row_mask:0xf bank_mask:0xf
    v_and_b32_dpp v31, v14, v23 row_newbcast:8 row_mask:0xf bank_mask:0xf
    s_waitcnt vmcnt(3)
    s_bitcmp0_b32 s14, 13
    s_cbranch_scc1 L_sf_69
    s_waitcnt vmcnt(2)
    s_bitcmp0_b32 s15, 13
    s_cbranch_scc1 L_sf_69
    s_waitcnt vmcnt(1)
L_sf_69:
    buffer_load_dwordx4 v[92:95], v1, s[52:55], s97 offen offset:1024 nt
    v_mfma_f32_16x16x32_bf16 v[32:35], v[28:31], v[76:79], v[32:35]
    s_cmp_eq_u32 s12, -1
    s_cbranch_scc1 L_nopfpv9
    s_waitcnt lgkmcnt(0)
    v_and_b32_dpp v24, v13, v20 row_newbcast:0 row_mask:0xf bank_mask:0xf
    v_and_b32_dpp v25, v13, v21 row_newbcast:0 row_mask:0xf bank_mask:0xf
    v_and_b32_dpp v26, v13, v22 row_newbcast:0 row_mask:0xf bank_mask:0xf
    v_and_b32_dpp v27, v13, v23 row_newbcast:0 row_mask:0xf bank_mask:0xf
    s_nop 1
    v_mfma_f32_16x16x32_bf16 v[32:35], v[24:27], v[56:59], v[32:35]
    v_and_b32_dpp v28, v13, v20 row_newbcast:8 row_mask:0xf bank_mask:0xf
    v_and_b32_dpp v29, v13, v21 row_newbcast:8 row_mask:0xf bank_mask:0xf
    v_and_b32_dpp v30, v13, v22 row_newbcast:8 row_mask:0xf bank_mask:0xf
    v_and_b32_dpp v31, v13, v23 row_newbcast:8 row_mask:0xf bank_mask:0xf
    s_nop 1
    v_mfma_f32_16x16x32_bf16 v[32:35], v[28:31], v[60:63], v[32:35]
    v_and_b32_dpp v24, v13, v20 row_newbcast:4 row_mask:0xf bank_mask:0xf
    v_and_b32_dpp v25, v13, v21 row_newbcast:4 row_mask:0xf bank_mask:0xf
    v_and_b32_dpp v26, v13, v22 row_newbcast:4 row_mask:0xf bank_mask:0xf
    v_and_b32_dpp v27, v13, v23 row_newbcast:4 row_mask:0xf bank_mask:0xf
    s_nop 1
    v_mfma_f32_16x16x32_bf16 v[32:35], v[24:27], v[64:67], v[32:35]
    v_and_b32_dpp v28, v13, v20 row_newbcast:12 row_mask:0xf bank_mask:0xf
    v_and_b32_dpp v29, v13, v21 row_newbcast:12 row_mask:0xf bank_mask:0xf
    v_and_b32_dpp v30, v13, v22 row_newbcast:12 row_mask:0xf bank_mask:0xf
    v_and_b32_dpp v31, v13, v23 row_newbcast:12 row_mask:0xf bank_mask:0xf
    s_nop 1
    v_mfma_f32_16x16x32_bf16 v[32:35], v[28:31], v[68:71], v[32:35]
L_nopfpv9:
    v_and_b32_dpp v24, v14, v20 row_newbcast:4 row_mask:0xf bank_mask:0xf
    v_and_b32_dpp v25, v14, v21 row_newbcast:4 row_mask:0xf bank_mask:0xf
    v_and_b32_dpp v26, v14, v22 row_newbcast:4 row_mask:0xf bank_mask:0xf
    v_and_b32_dpp v27, v14, v23 row_newbcast:4 row_mask:0xf bank_mask:0xf
    s_waitcnt vmcnt(3)
    s_bitcmp0_b32 s14, 14
    s_cbranch_scc1 L_sf_70
    s_waitcnt vmcnt(2)
    s_bitcmp0_b32 s15, 14
    s_cbranch_scc1 L_sf_70
    s_waitcnt vmcnt(1)
L_sf_70:
    buffer_load_dwordx4 v[96:99], v1, s[52:55], s97 offen offset:2048 nt
    v_mfma_f32_16x16x32_bf16 v[32:35], v[24:27], v[80:83], v[32:35]
    v_and_b32_dpp v28, v14, v20 row_newbcast:12 row_mask:0xf bank_mask:0xf
    v_and_b32_dpp v29, v14, v21 row_newbcast:12 row_mask:0xf bank_mask:0xf
    v_and_b32_dpp v30, v14, v22 row_newbcast:12 row_mask:0xf bank_mask:0xf
    v_and_b32_dpp v31, v14, v23 row_newbcast:12 row_mask:0xf bank_mask:0xf
    s_waitcnt vmcnt(3)
    s_bitcmp0_b32 s14, 15
    s_cbranch_scc1 L_sf_71
    s_waitcnt vmcnt(2)
    s_bitcmp0_b32 s15, 15
    s_cbranch_scc1 L_sf_71
    s_waitcnt vmcnt(1)
L_sf_71:
    buffer_load_dwordx4 v[100:103], v1, s[52:55], s97 offen offset:3072 nt
    s_add_u32 s97, s97, 32768
    v_add_u32 v1, 4096, v1
    v_and_b32 v1, 0x7fff, v1
    v_mfma_f32_16x16x32_bf16 v[32:35], v[28:31], v[84:87], v[32:35]
    v_and_b32_dpp v24, v15, v20 row_newbcast:0 row_mask:0xf bank_mask:0xf
    v_and_b32_dpp v25, v15, v21 row_newbcast:0 row_mask:0xf bank_mask:0xf
    v_and_b32_dpp v26, v15, v22 row_newbcast:0 row_mask:0xf bank_mask:0xf
    v_and_b32_dpp v27, v15, v23 row_newbcast:0 row_mask:0xf bank_mask:0xf
    s_waitcnt vmcnt(3)
    s_bitcmp0_b32 s14, 16
    s_cbranch_scc1 L_sf_72
    s_waitcnt vmcnt(2)
    s_bitcmp0_b32 s15, 16
    s_cbranch_scc1 L_sf_72
    s_waitcnt vmcnt(1)
L_sf_72:
    buffer_load_dwordx4 v[104:107], v1, s[52:55], s97 offen offset:0 nt
    v_mfma_f32_16x16x32_bf16 v[32:35], v[24:27], v[88:91], v[32:35]
    v_and_b32_dpp v28, v15, v20 row_newbcast:8 row_mask:0xf bank_mask:0xf
    v_and_b32_dpp v29, v15, v21 row_newbcast:8 row_mask:0xf bank_mask:0xf
    v_and_b32_dpp v30, v15, v22 row_newbcast:8 row_mask:0xf bank_mask:0xf
    v_and_b32_dpp v31, v15, v23 row_newbcast:8 row_mask:0xf bank_mask:0xf
    s_waitcnt vmcnt(3)
    s_bitcmp0_b32 s14, 17
    s_cbranch_scc1 L_sf_73
    s_waitcnt vmcnt(2)
    s_bitcmp0_b32 s15, 17
    s_cbranch_scc1 L_sf_73
    s_waitcnt vmcnt(1)
L_sf_73:
    buffer_load_dwordx4 v[108:111], v1, s[52:55], s97 offen offset:1024 nt
    v_mfma_f32_16x16x32_bf16 v[32:35], v[28:31], v[92:95], v[32:35]
    v_and_b32_dpp v24, v15, v20 row_newbcast:4 row_mask:0xf bank_mask:0xf
    v_and_b32_dpp v25, v15, v21 row_newbcast:4 row_mask:0xf bank_mask:0xf
    v_and_b32_dpp v26, v15, v22 row_newbcast:4 row_mask:0xf bank_mask:0xf
    v_and_b32_dpp v27, v15, v23 row_newbcast:4 row_mask:0xf bank_mask:0xf
    s_waitcnt vmcnt(3)
    s_bitcmp0_b32 s14, 18
    s_cbranch_scc1 L_sf_74
    s_waitcnt vmcnt(2)
    s_bitcmp0_b32 s15, 18
    s_cbranch_scc1 L_sf_74
    s_waitcnt vmcnt(1)
L_sf_74:
    buffer_load_dwordx4 v[112:115], v1, s[52:55], s97 offen offset:2048 nt
    v_mfma_f32_16x16x32_bf16 v[32:35], v[24:27], v[96:99], v[32:35]
    v_and_b32_dpp v28, v15, v20 row_newbcast:12 row_mask:0xf bank_mask:0xf
    v_and_b32_dpp v29, v15, v21 row_newbcast:12 row_mask:0xf bank_mask:0xf
    v_and_b32_dpp v30, v15, v22 row_newbcast:12 row_mask:0xf bank_mask:0xf
    v_and_b32_dpp v31, v15, v23 row_newbcast:12 row_mask:0xf bank_mask:0xf
    s_waitcnt vmcnt(3)
    s_bitcmp0_b32 s14, 19
    s_cbranch_scc1 L_sf_75
    s_waitcnt vmcnt(2)
    s_bitcmp0_b32 s15, 19
    s_cbranch_scc1 L_sf_75
    s_waitcnt vmcnt(1)
L_sf_75:
    buffer_load_dwordx4 v[116:119], v1, s[52:55], s97 offen offset:3072 nt
    s_add_u32 s97, s97, 32768
    v_add_u32 v1, 4096, v1
    v_and_b32 v1, 0x7fff, v1
    v_mfma_f32_16x16x32_bf16 v[32:35], v[28:31], v[100:103], v[32:35]
    v_and_b32_dpp v24, v16, v20 row_newbcast:0 row_mask:0xf bank_mask:0xf
    v_and_b32_dpp v25, v16, v21 row_newbcast:0 row_mask:0xf bank_mask:0xf
    v_and_b32_dpp v26, v16, v22 row_newbcast:0 row_mask:0xf bank_mask:0xf
    v_and_b32_dpp v27, v16, v23 row_newbcast:0 row_mask:0xf bank_mask:0xf
    s_waitcnt vmcnt(3)
    s_bitcmp0_b32 s14, 20
    s_cbranch_scc1 L_sf_76
    s_waitcnt vmcnt(2)
    s_bitcmp0_b32 s15, 20
    s_cbranch_scc1 L_sf_76
    s_waitcnt vmcnt(1)
L_sf_76:
    buffer_load_dwordx4 v[120:123], v1, s[52:55], s97 offen offset:0 nt
    v_mfma_f32_16x16x32_bf16 v[32:35], v[24:27], v[104:107], v[32:35]
    v_and_b32_dpp v28, v16, v20 row_newbcast:8 row_mask:0xf bank_mask:0xf
    v_and_b32_dpp v29, v16, v21 row_newbcast:8 row_mask:0xf bank_mask:0xf
    v_and_b32_dpp v30, v16, v22 row_newbcast:8 row_mask:0xf bank_mask:0xf
    v_and_b32_dpp v31, v16, v23 row_newbcast:8 row_mask:0xf bank_mask:0xf
    s_waitcnt vmcnt(3)
    s_bitcmp0_b32 s14, 21
    s_cbranch_scc1 L_sf_77
    s_waitcnt vmcnt(2)
    s_bitcmp0_b32 s15, 21
    s_cbranch_scc1 L_sf_77
    s_waitcnt vmcnt(1)
L_sf_77:
    buffer_load_dwordx4 v[124:127], v1, s[52:55], s97 offen offset:1024 nt
    v_mfma_f32_16x16x32_bf16 v[32:35], v[28:31], v[108:111], v[32:35]
    v_and_b32_dpp v24, v16, v20 row_newbcast:4 row_mask:0xf bank_mask:0xf
    v_and_b32_dpp v25, v16, v21 row_newbcast:4 row_mask:0xf bank_mask:0xf
    v_and_b32_dpp v26, v16, v22 row_newbcast:4 row_mask:0xf bank_mask:0xf
    v_and_b32_dpp v27, v16, v23 row_newbcast:4 row_mask:0xf bank_mask:0xf
    s_waitcnt vmcnt(3)
    s_bitcmp0_b32 s14, 22
    s_cbranch_scc1 L_sf_78
    s_waitcnt vmcnt(2)
    s_bitcmp0_b32 s15, 22
    s_cbranch_scc1 L_sf_78
    s_waitcnt vmcnt(1)
L_sf_78:
    buffer_load_dwordx4 v[128:131], v1, s[52:55], s97 offen offset:2048 nt
    v_mfma_f32_16x16x32_bf16 v[32:35], v[24:27], v[112:115], v[32:35]
    v_and_b32_dpp v28, v16, v20 row_newbcast:12 row_mask:0xf bank_mask:0xf
    v_and_b32_dpp v29, v16, v21 row_newbcast:12 row_mask:0xf bank_mask:0xf
    v_and_b32_dpp v30, v16, v22 row_newbcast:12 row_mask:0xf bank_mask:0xf
    v_and_b32_dpp v31, v16, v23 row_newbcast:12 row_mask:0xf bank_mask:0xf
    s_waitcnt vmcnt(3)
    s_bitcmp0_b32 s14, 23
    s_cbranch_scc1 L_sf_79
    s_waitcnt vmcnt(2)
    s_bitcmp0_b32 s15, 23
    s_cbranch_scc1 L_sf_79
    s_waitcnt vmcnt(1)
L_sf_79:
    buffer_load_dwordx4 v[132:135], v1, s[52:55], s97 offen offset:3072 nt
    s_add_u32 s97, s97, 32768
    v_add_u32 v1, 4096, v1
    v_and_b32 v1, 0x7fff, v1
    v_mfma_f32_16x16x32_bf16 v[32:35], v[28:31], v[116:119], v[32:35]
    v_and_b32_dpp v24, v17, v20 row_newbcast:0 row_mask:0xf bank_mask:0xf
    v_and_b32_dpp v25, v17, v21 row_newbcast:0 row_mask:0xf bank_mask:0xf
    v_and_b32_dpp v26, v17, v22 row_newbcast:0 row_mask:0xf bank_mask:0xf
    v_and_b32_dpp v27, v17, v23 row_newbcast:0 row_mask:0xf bank_mask:0xf
    s_waitcnt vmcnt(3)
    s_bitcmp0_b32 s14, 24
    s_cbranch_scc1 L_sf_80
    s_waitcnt vmcnt(2)
    s_bitcmp0_b32 s15, 24
    s_cbranch_scc1 L_sf_80
    s_waitcnt vmcnt(1)
L_sf_80:
    buffer_load_dwordx4 v[136:139], v1, s[52:55], s97 offen offset:0 nt
    v_mfma_f32_16x16x32_bf16 v[32:35], v[24:27], v[120:123], v[32:35]
    s_or_b32 s96, s59, s39
    s_cbranch_scc0 L_nofrag_81
    v_mov_b32 v104, 162060
L_lw_82:
    ds_read_b32 v105, v104
    s_waitcnt lgkmcnt(0)
    v_cmp_gt_u32 vcc, 4, v105
    s_cbranch_vccz L_lw_82e
    s_sleep 2
    s_sub_u32 s60, s60, 1
    s_cbranch_scc0 L_lw_82
    s_mov_b32 s60, 0
L_lw_82e:
    s_cmp_eq_u32 s59, 0
    s_cbranch_scc1 L_nofrag_81
    v_bfe_u32 v104, v0, 2, 1
    v_bfe_u32 v110, v0, 4, 1
    v_lshl_add_u32 v104, v110, 2, v104
    v_and_b32 v110, 8, v0
    v_add_u32 v104, v104, v110
    v_lshrrev_b32 v110, 5, v0
    v_lshl_add_u32 v104, v110, 4, v104
    v_bfe_u32 v111, v0, 0, 1
    v_mul_u32_u24 v111, 0xaaaa, v111
    v_add_u32 v111, 0x4444, v111
    v_mov_b32 v112, 0
    v_mov_b32 v113, 0
    v_mov_b32 v114, 0
    v_mov_b32 v115, 0
    v_mov_b32 v116, 0
    v_mov_b32 v117, 0
    v_mov_b32 v118, 0
    v_mov_b32 v119, 0
    v_lshlrev_b32 v104, 7, v104
    v_and_b32 v110, 3, v0
    v_lshl_add_u32 v104, v110, 3, v104
    v_lshrrev_b32 v109, 4, v0
    v_and_b32 v110, 1, v0
    s_lshr_b32 s63, s3, 1
    s_and_b32 s62, s3, 1
    s_lshl_b32 s96, s63, 14
    s_lshl_b32 s100, s62, 6
    s_add_u32 s100, s100, 81920
    s_add_u32 s96, s96, s100
    v_add_u32 v104, s96, v104
    ds_read_b64_tr_b16 v[72:73], v104 offset:0
    ds_read_b64_tr_b16 v[74:75], v104 offset:256
    ds_read_b64_tr_b16 v[76:77], v104 offset:4096
    ds_read_b64_tr_b16 v[78:79], v104 offset:4352
    ds_read_b64_tr_b16 v[80:81], v104 offset:32
    ds_read_b64_tr_b16 v[82:83], v104 offset:288
    ds_read_b64_tr_b16 v[84:85], v104 offset:4128
    ds_read_b64_tr_b16 v[86:87], v104 offset:4384
    ds_read_b64_tr_b16 v[88:89], v104 offset:8192
    ds_read_b64_tr_b16 v[90:91], v104 offset:8448
    ds_read_b64_tr_b16 v[92:93], v104 offset:12288
    ds_read_b64_tr_b16 v[94:95], v104 offset:12544
    ds_read_b64_tr_b16 v[96:97], v104 offset:8224
    ds_read_b64_tr_b16 v[98:99], v104 offset:8480
    ds_read_b64_tr_b16 v[100:101], v104 offset:12320
    ds_read_b64_tr_b16 v[102:103], v104 offset:12576
    v_bfe_u32 v105, v0, 1, 3
    v_lshlrev_b32 v105, 8, v105
    v_lshl_add_u32 v105, v109, 5, v105
    v_lshl_add_u32 v105, v110, 4, v105
    v_lshrrev_b32 v106, 3, v0
    v_lshlrev_b32 v106, 7, v106
    v_and_b32 v110, 7, v0
    v_lshl_add_u32 v107, v110, 3, v106
    v_add_u32 v107, s100, v107
    v_lshlrev_b32 v106, 8, v109
    v_and_b32 v110, 15, v0
    v_lshl_add_u32 v106, v110, 2, v106
    v_add_u32 v106, s96, v106
    v_lshlrev_b32 v108, 2, v0
    s_lshl_b32 s96, s62, 2
    s_add_u32 s96, s96, 162088
    v_mov_b32 v109, s96
    s_lshl_b32 s100, s63, 11
    s_lshl_b32 s96, s34, 13
    s_add_u32 s100, s100, s96
    s_add_u32 s100, s100, 90112
    s_mul_i32 s101, s34, 5120
    s_lshl_b32 s96, s35, 9
    s_add_u32 s101, s101, s96
    s_lshl_b32 s96, s62, 8
    s_add_u32 s101, s101, s96
    s_sub_u32 s101, s101, 11264
    s_and_b32 s96, s101, 0xffffe000
    s_add_u32 s101, s101, s96
    s_add_u32 s101, s101, 196608
    v_add_u32 v110, 8192, v108
L_nofrag_81:
    v_and_b32_dpp v28, v17, v20 row_newbcast:8 row_mask:0xf bank_mask:0xf
    v_and_b32_dpp v29, v17, v21 row_newbcast:8 row_mask:0xf bank_mask:0xf
    v_and_b32_dpp v30, v17, v22 row_newbcast:8 row_mask:0xf bank_mask:0xf
    v_and_b32_dpp v31, v17, v23 row_newbcast:8 row_mask:0xf bank_mask:0xf
    s_waitcnt vmcnt(3)
    s_bitcmp0_b32 s14, 25
    s_cbranch_scc1 L_sf_83
    s_waitcnt vmcnt(2)
    s_bitcmp0_b32 s15, 25
    s_cbranch_scc1 L_sf_83
    s_waitcnt vmcnt(1)
L_sf_83:
    buffer_load_dwordx4 v[140:143], v1, s[52:55], s97 offen offset:1024 nt
    v_mfma_f32_16x16x32_bf16 v[32:35], v[28:31], v[124:127], v[32:35]
    v_and_b32_dpp v24, v17, v20 row_newbcast:4 row_mask:0xf bank_mask:0xf
    v_and_b32_dpp v25, v17, v21 row_newbcast:4 row_mask:0xf bank_mask:0xf
    v_and_b32_dpp v26, v17, v22 row_newbcast:4 row_mask:0xf bank_mask:0xf
    v_and_b32_dpp v27, v17, v23 row_newbcast:4 row_mask:0xf bank_mask:0xf
    s_waitcnt vmcnt(3)
    s_bitcmp0_b32 s14, 26
    s_cbranch_scc1 L_sf_84
    s_waitcnt vmcnt(2)
    s_bitcmp0_b32 s15, 26
    s_cbranch_scc1 L_sf_84
    s_waitcnt vmcnt(1)
L_sf_84:
    buffer_load_dwordx4 v[144:147], v1, s[52:55], s97 offen offset:2048 nt
    v_mfma_f32_16x16x32_bf16 v[32:35], v[24:27], v[128:131], v[32:35]
    v_mov_b32 v10, 162076
    v_mov_b32 v11, 1
    s_mov_b64 exec, 1
    ds_add_u32 v10, v11
    s_mov_b64 exec, -1
    v_and_b32_dpp v28, v17, v20 row_newbcast:12 row_mask:0xf bank_mask:0xf
    v_and_b32_dpp v29, v17, v21 row_newbcast:12 row_mask:0xf bank_mask:0xf
    v_and_b32_dpp v30, v17, v22 row_newbcast:12 row_mask:0xf bank_mask:0xf
    v_and_b32_dpp v31, v17, v23 row_newbcast:12 row_mask:0xf bank_mask:0xf
    s_waitcnt vmcnt(3)
    s_bitcmp0_b32 s14, 27
    s_cbranch_scc1 L_sf_85
    s_waitcnt vmcnt(2)
    s_bitcmp0_b32 s15, 27
    s_cbranch_scc1 L_sf_85
    s_waitcnt vmcnt(1)
L_sf_85:
    buffer_load_dwordx4 v[148:151], v1, s[52:55], s97 offen offset:3072 nt
    s_add_u32 s97, s97, 32768
    v_add_u32 v1, 4096, v1
    v_and_b32 v1, 0x7fff, v1
    v_mfma_f32_16x16x32_bf16 v[32:35], v[28:31], v[132:135], v[32:35]
    v_and_b32_dpp v24, v18, v20 row_newbcast:0 row_mask:0xf bank_mask:0xf
    v_and_b32_dpp v25, v18, v21 row_newbcast:0 row_mask:0xf bank_mask:0xf
    v_and_b32_dpp v26, v18, v22 row_newbcast:0 row_mask:0xf bank_mask:0xf
    v_and_b32_dpp v27, v18, v23 row_newbcast:0 row_mask:0xf bank_mask:0xf
    s_waitcnt vmcnt(3)
    s_bitcmp0_b32 s14, 28
    s_cbranch_scc1 L_sf_86
    s_waitcnt vmcnt(2)
    s_bitcmp0_b32 s15, 28
    s_cbranch_scc1 L_sf_86
    s_waitcnt vmcnt(1)
L_sf_86:
    buffer_load_dwordx4 v[152:155], v1, s[52:55], s97 offen offset:0 nt
    v_mfma_f32_16x16x32_bf16 v[32:35], v[24:27], v[136:139], v[32:35]
    v_and_b32_dpp v28, v18, v20 row_newbcast:8 row_mask:0xf bank_mask:0xf
    v_and_b32_dpp v29, v18, v21 row_newbcast:8 row_mask:0xf bank_mask:0xf
    v_and_b32_dpp v30, v18, v22 row_newbcast:8 row_mask:0xf bank_mask:0xf
    v_and_b32_dpp v31, v18, v23 row_newbcast:8 row_mask:0xf bank_mask:0xf
    s_waitcnt vmcnt(3)
    s_bitcmp0_b32 s14, 29
    s_cbranch_scc1 L_sf_87
    s_waitcnt vmcnt(2)
    s_bitcmp0_b32 s15, 29
    s_cbranch_scc1 L_sf_87
    s_waitcnt vmcnt(1)
L_sf_87:
    buffer_load_dwordx4 v[156:159], v1, s[52:55], s97 offen offset:1024 nt
    v_mfma_f32_16x16x32_bf16 v[32:35], v[28:31], v[140:143], v[32:35]
    v_and_b32_dpp v24, v18, v20 row_newbcast:4 row_mask:0xf bank_mask:0xf
    v_and_b32_dpp v25, v18, v21 row_newbcast:4 row_mask:0xf bank_mask:0xf
    v_and_b32_dpp v26, v18, v22 row_newbcast:4 row_mask:0xf bank_mask:0xf
    v_and_b32_dpp v27, v18, v23 row_newbcast:4 row_mask:0xf bank_mask:0xf
    s_waitcnt vmcnt(3)
    s_bitcmp0_b32 s14, 30
    s_cbranch_scc1 L_sf_88
    s_waitcnt vmcnt(2)
    s_bitcmp0_b32 s15, 30
    s_cbranch_scc1 L_sf_88
    s_waitcnt vmcnt(1)
L_sf_88:
    buffer_load_dwordx4 v[160:163], v1, s[52:55], s97 offen offset:2048 nt
    v_mfma_f32_16x16x32_bf16 v[32:35], v[24:27], v[144:147], v[32:35]
    v_lshrrev_b32 v9, 4, v0
    v_lshl_add_u32 v8, v9, 2, v2
    s_lshl_b32 s96, s3, 9
    s_add_u32 s96, s96, 157824
    v_lshl_add_u32 v8, v8, 2, s96
    v_lshlrev_b32 v9, 3, v0
    v_add_u32 v9, 157824, v9
    v_mov_b32 v10, 162048
    v_mov_b32 v11, 1
    s_lshl_b32 s96, s38, 5
    s_add_u32 s96, s96, 161984
    v_mov_b32 v3, s96
    s_sub_u32 s62, 8, s39
    s_lshl_b32 s98, s34, 5
    s_add_u32 s98, s98, s35
    s_lshl_b32 s98, s98, 8
    s_add_u32 s98, s98, 90112
    v_lshlrev_b32 v39, 2, v0
    v_and_b32_dpp v28, v18, v20 row_newbcast:12 row_mask:0xf bank_mask:0xf
    v_and_b32_dpp v29, v18, v21 row_newbcast:12 row_mask:0xf bank_mask:0xf
    v_and_b32_dpp v30, v18, v22 row_newbcast:12 row_mask:0xf bank_mask:0xf
    v_and_b32_dpp v31, v18, v23 row_newbcast:12 row_mask:0xf bank_mask:0xf
    s_waitcnt vmcnt(3)
    s_bitcmp0_b32 s14, 31
    s_cbranch_scc1 L_sf_89
    s_waitcnt vmcnt(2)
    s_bitcmp0_b32 s15, 31
    s_cbranch_scc1 L_sf_89
    s_waitcnt vmcnt(1)
L_sf_89:
    buffer_load_dwordx4 v[164:167], v1, s[52:55], s97 offen offset:3072 nt
    s_mov_b32 s97, 0
    v_add_u32 v1, 4096, v1
    v_and_b32 v1, 0x7fff, v1
    v_mfma_f32_16x16x32_bf16 v[32:35], v[28:31], v[148:151], v[32:35]
    s_cmp_eq_u32 s12, -1
    s_cbranch_scc1 L_v_nopf
    v_and_b32_dpp v24, v19, v20 row_newbcast:0 row_mask:0xf bank_mask:0xf
    v_and_b32_dpp v25, v19, v21 row_newbcast:0 row_mask:0xf bank_mask:0xf
    v_and_b32_dpp v26, v19, v22 row_newbcast:0 row_mask:0xf bank_mask:0xf
    v_and_b32_dpp v27, v19, v23 row_newbcast:0 row_mask:0xf bank_mask:0xf
    s_waitcnt vmcnt(3)
    s_nop 0
    v_mfma_f32_16x16x32_bf16 v[32:35], v[24:27], v[152:155], v[32:35]
    v_and_b32_dpp v28, v19, v20 row_newbcast:8 row_mask:0xf bank_mask:0xf
    v_and_b32_dpp v29, v19, v21 row_newbcast:8 row_mask:0xf bank_mask:0xf
    v_and_b32_dpp v30, v19, v22 row_newbcast:8 row_mask:0xf bank_mask:0xf
    v_and_b32_dpp v31, v19, v23 row_newbcast:8 row_mask:0xf bank_mask:0xf
    s_waitcnt vmcnt(2)
    s_nop 0
    v_mfma_f32_16x16x32_bf16 v[32:35], v[28:31], v[156:159], v[32:35]
    v_and_b32_dpp v24, v19, v20 row_newbcast:4 row_mask:0xf bank_mask:0xf
    v_and_b32_dpp v25, v19, v21 row_newbcast:4 row_mask:0xf bank_mask:0xf
    v_and_b32_dpp v26, v19, v22 row_newbcast:4 row_mask:0xf bank_mask:0xf
    v_and_b32_dpp v27, v19, v23 row_newbcast:4 row_mask:0xf bank_mask:0xf
    s_waitcnt vmcnt(1)
    s_nop 0
    v_mfma_f32_16x16x32_bf16 v[32:35], v[24:27], v[160:163], v[32:35]
    v_and_b32_dpp v28, v19, v20 row_newbcast:12 row_mask:0xf bank_mask:0xf
    v_and_b32_dpp v29, v19, v21 row_newbcast:12 row_mask:0xf bank_mask:0xf
    v_and_b32_dpp v30, v19, v22 row_newbcast:12 row_mask:0xf bank_mask:0xf
    v_and_b32_dpp v31, v19, v23 row_newbcast:12 row_mask:0xf bank_mask:0xf
    s_waitcnt vmcnt(0)
    s_nop 0
    v_mfma_f32_16x16x32_bf16 v[32:35], v[28:31], v[164:167], v[32:35]
L_v_join:
    s_cmp_lg_u32 s13, 0
    s_cbranch_scc1 L_jobend
L_t0:
    s_mov_b32 exec_hi, 0
    s_nop 4
    ds_write_b128 v8, v[32:35]
L_t0b:
    s_mov_b64 exec, 1
    ds_add_rtn_u32 v37, v10, v11
    s_mov_b64 exec, -1
    ds_read_b32 v38, v10 offset:24
    ds_read_b128 v[24:27], v3
    ds_read_b128 v[28:31], v3 offset:16
    ds_read_b64 v[144:145], v9 offset:0
    ds_read_b64 v[146:147], v9 offset:512
    ds_read_b64 v[148:149], v9 offset:1024
    ds_read_b64 v[150:151], v9 offset:1536
    ds_read_b64 v[152:153], v9 offset:2048
    ds_read_b64 v[154:155], v9 offset:2560
    ds_read_b64 v[156:157], v9 offset:3072
    ds_read_b64 v[158:159], v9 offset:3584
    s_waitcnt lgkmcnt(10)
    v_readfirstlane_b32 s96, v37
    v_readfirstlane_b32 s61, v38
    s_cmp_lg_u32 s96, s62
    s_cbranch_scc1 L_nopub
    s_waitcnt lgkmcnt(6)
    v_pk_mul_f32 v[144:145], v[144:145], v[24:25] op_sel:[0,0] op_sel_hi:[1,0]
    v_pk_mul_f32 v[146:147], v[146:147], v[24:25] op_sel:[0,1] op_sel_hi:[1,1]
    s_waitcnt lgkmcnt(4)
    v_pk_fma_f32 v[144:145], v[148:149], v[26:27], v[144:145] op_sel:[0,0,0] op_sel_hi:[1,0,1]
    v_pk_fma_f32 v[146:147], v[150:151], v[26:27], v[146:147] op_sel:[0,1,0] op_sel_hi:[1,1,1]
    s_waitcnt lgkmcnt(2)
    v_pk_fma_f32 v[144:145], v[152:153], v[28:29], v[144:145] op_sel:[0,0,0] op_sel_hi:[1,0,1]
    v_pk_fma_f32 v[146:147], v[154:155], v[28:29], v[146:147] op_sel:[0,1,0] op_sel_hi:[1,1,1]
    s_waitcnt lgkmcnt(0)
    v_pk_fma_f32 v[144:145], v[156:157], v[30:31], v[144:145] op_sel:[0,0,0] op_sel_hi:[1,0,1]
    v_pk_fma_f32 v[146:147], v[158:159], v[30:31], v[146:147] op_sel:[0,1,0] op_sel_hi:[1,1,1]
    s_cmp_eq_u32 s61, 1
    v_pk_add_f32 v[144:145], v[144:145], v[146:147]
    v_cvt_pk_bf16_f32 v32, v144, v145
    s_cbranch_scc0 L_oslow
    buffer_store_dword v32, v39, s[40:43], s98 offen
L_odone:
L_nopub:
    s_cmp_eq_u32 s59, 0
    s_cbranch_scc1 L_not1
L_poll_98:
    buffer_load_dwordx4 v[16:19], v105, s[40:43], s100 offen sc1
    buffer_load_dwordx4 v[20:23], v105, s[40:43], s100 offen offset:128 sc1
    s_sub_u32 s60, s60, 1
    s_cbranch_scc1 L_poll_98t
    s_waitcnt vmcnt(0)
    v_max3_u32 v38, v16, v17, v18
    v_max3_u32 v38, v38, v19, v20
    v_max3_u32 v38, v38, v21, v22
    v_max_u32 v38, v38, v23
    v_cmp_eq_u32 vcc, -1, v38
    s_cbranch_vccnz L_poll_98
L_poll_98e:
    v_smfmac_f32_16x16x64_bf16 v[112:115], v[16:19], v[72:79], v111
    v_smfmac_f32_16x16x64_bf16 v[116:119], v[16:19], v[80:87], v111
    v_smfmac_f32_16x16x64_bf16 v[112:115], v[20:23], v[88:95], v111
    v_smfmac_f32_16x16x64_bf16 v[116:119], v[20:23], v[96:103], v111
    s_nop 6
    v_pk_add_f32 v[112:113], v[112:113], v[114:115]
    v_pk_add_f32 v[116:117], v[116:117], v[118:119]
    v_add_f32 v12, v112, v113
    v_add_f32 v13, v116, v117
    ds_write2_b32 v106, v12, v13 offset0:0 offset1:32
    s_mov_b64 exec, 1
    ds_add_rtn_u32 v37, v109, v11
    s_mov_b64 exec, -1
    ds_read_b64 v[72:73], v107 offset:0
    ds_read_b64 v[74:75], v107 offset:16384
    ds_read_b64 v[76:77], v107 offset:32768
    ds_read_b64 v[78:79], v107 offset:49152
    s_cmp_eq_u32 s34, 2
    s_cselect_b32 s97, s61, 0
    s_waitcnt lgkmcnt(4)
    v_readfirstlane_b32 s96, v37
    s_waitcnt lgkmcnt(2)
    v_pk_add_f32 v[72:73], v[72:73], v[74:75]
    s_cmp_lg_u32 s96, 3
    s_cbranch_scc1 L_not1
    s_cmp_eq_u32 s97, 1
    s_waitcnt lgkmcnt(0)
    v_pk_add_f32 v[76:77], v[76:77], v[78:79]
    v_pk_add_f32 v[72:73], v[72:73], v[76:77]
    v_cvt_pk_bf16_f32 v12, v72, v73
    s_cbranch_scc1 L_pfast
    buffer_store_dword v12, v108, s[40:43], s101 offen sc1
    buffer_store_dword v12, v110, s[40:43], s101 offen sc1
L_pdone:
L_not1:
    s_waitcnt lgkmcnt(0)
    s_cmp_eq_u32 s39, 1
    s_cbranch_scc1 L_s_role
    s_endpgm
L_k_nopf:
    s_waitcnt vmcnt(3)
    s_bitcmp0_b32 s57, 22
    s_cbranch_scc1 L_sf_54
    s_waitcnt vmcnt(2)
    s_bitcmp0_b32 s58, 22
    s_cbranch_scc1 L_sf_54
    s_waitcnt vmcnt(1)
L_sf_54:
    buffer_load_dwordx4 v[128:131], v1, s[48:51], s97 offen offset:2048 nt
    v_and_b32 v39, 31, v0
    v_lshlrev_b32 v39, 2, v39
    buffer_load_dword v37, v39, s[44:47], 0 offen sc1
    s_waitcnt vmcnt(4)
    s_bitcmp0_b32 s57, 23
    s_cbranch_scc1 L_sf_55
    s_waitcnt vmcnt(3)
    s_bitcmp0_b32 s58, 23
    s_cbranch_scc1 L_sf_55
    s_waitcnt vmcnt(2)
L_sf_55:
    buffer_load_dwordx4 v[132:135], v1, s[48:51], s97 offen offset:3072 nt
    s_add_u32 s97, s97, 32768
    v_add_u32 v1, 4096, v1
    v_and_b32 v1, 0x7fff, v1
    s_waitcnt vmcnt(4)
    s_bitcmp0_b32 s57, 24
    s_cbranch_scc1 L_sf_56
    s_waitcnt vmcnt(3)
    s_bitcmp0_b32 s58, 24
    s_cbranch_scc1 L_sf_56
    s_waitcnt vmcnt(2)
L_sf_56:
    buffer_load_dwordx4 v[136:139], v1, s[48:51], s97 offen offset:0 nt
    s_waitcnt vmcnt(4)
    s_bitcmp0_b32 s57, 25
    s_cbranch_scc1 L_sf_57
    s_waitcnt vmcnt(3)
    s_bitcmp0_b32 s58, 25
    s_cbranch_scc1 L_sf_57
    s_waitcnt vmcnt(1)
L_sf_57:
    buffer_load_dwordx4 v[140:143], v1, s[48:51], s97 offen offset:1024 nt
    s_waitcnt vmcnt(4)
    s_bitcmp0_b32 s57, 26
    s_cbranch_scc1 L_sf_58
    s_waitcnt vmcnt(2)
    s_bitcmp0_b32 s58, 26
    s_cbranch_scc1 L_sf_58
    s_waitcnt vmcnt(1)
L_sf_58:
    buffer_load_dwordx4 v[144:147], v1, s[48:51], s97 offen offset:2048 nt
    s_waitcnt vmcnt(3)
    s_bitcmp0_b32 s57, 27
    s_cbranch_scc1 L_sf_59
    s_waitcnt vmcnt(2)
    s_bitcmp0_b32 s58, 27
    s_cbranch_scc1 L_sf_59
    s_waitcnt vmcnt(1)
L_sf_59:
    buffer_load_dwordx4 v[148:151], v1, s[48:51], s97 offen offset:3072 nt
    s_add_u32 s97, s97, 32768
    v_add_u32 v1, 4096, v1
    v_and_b32 v1, 0x7fff, v1
    v_cmp_eq_u32 vcc, 0, v37
    s_nop 0
    s_or_b32 s96, vcc_lo, vcc_hi
    buffer_load_dwordx4 v[4:7], v2, s[40:43], s98 offen sc1
    s_waitcnt vmcnt(4)
    s_bitcmp0_b32 s57, 28
    s_cbranch_scc1 L_sf_60
    s_waitcnt vmcnt(3)
    s_bitcmp0_b32 s58, 28
    s_cbranch_scc1 L_sf_60
    s_waitcnt vmcnt(2)
L_sf_60:
    buffer_load_dwordx4 v[152:155], v1, s[48:51], s97 offen offset:0 nt
    s_waitcnt vmcnt(4)
    s_bitcmp0_b32 s57, 29
    s_cbranch_scc1 L_sf_61
    s_waitcnt vmcnt(3)
    s_bitcmp0_b32 s58, 29
    s_cbranch_scc1 L_sf_61
    s_waitcnt vmcnt(2)
L_sf_61:
    buffer_load_dwordx4 v[156:159], v1, s[48:51], s97 offen offset:1024 nt
    s_waitcnt vmcnt(4)
    s_bitcmp0_b32 s57, 30
    s_cbranch_scc1 L_sf_62
    s_waitcnt vmcnt(3)
    s_bitcmp0_b32 s58, 30
    s_cbranch_scc1 L_sf_62
    s_waitcnt vmcnt(1)
L_sf_62:
    buffer_load_dwordx4 v[160:163], v1, s[48:51], s97 offen offset:2048 nt
    s_waitcnt vmcnt(4)
    s_bitcmp0_b32 s57, 31
    s_cbranch_scc1 L_sf_63
    s_waitcnt vmcnt(2)
    s_bitcmp0_b32 s58, 31
    s_cbranch_scc1 L_sf_63
    s_waitcnt vmcnt(1)
L_sf_63:
    buffer_load_dwordx4 v[164:167], v1, s[48:51], s97 offen offset:3072 nt
    s_mov_b32 s97, 0
    v_add_u32 v1, 4096, v1
    v_and_b32 v1, 0x7fff, v1
    v_add_u32 v1, 8192, v1
    v_and_b32 v1, 0x7fff, v1
    s_mov_b32 s97, 65536
    s_branch L_k_join
L_v_nopf:
    v_and_b32_dpp v24, v19, v20 row_newbcast:0 row_mask:0xf bank_mask:0xf
    v_and_b32_dpp v25, v19, v21 row_newbcast:0 row_mask:0xf bank_mask:0xf
    v_and_b32_dpp v26, v19, v22 row_newbcast:0 row_mask:0xf bank_mask:0xf
    v_and_b32_dpp v27, v19, v23 row_newbcast:0 row_mask:0xf bank_mask:0xf
    s_waitcnt vmcnt(3)
    s_bitcmp0_b32 s14, 0
    s_cbranch_scc1 L_sf_90
    s_waitcnt vmcnt(2)
    s_bitcmp0_b32 s15, 0
    s_cbranch_scc1 L_sf_90
    s_waitcnt vmcnt(1)
L_sf_90:
    buffer_load_dwordx4 v[40:43], v1, s[52:55], s97 offen offset:0 nt
    v_mfma_f32_16x16x32_bf16 v[32:35], v[24:27], v[152:155], v[32:35]
    v_and_b32_dpp v28, v19, v20 row_newbcast:8 row_mask:0xf bank_mask:0xf
    v_and_b32_dpp v29, v19, v21 row_newbcast:8 row_mask:0xf bank_mask:0xf
    v_and_b32_dpp v30, v19, v22 row_newbcast:8 row_mask:0xf bank_mask:0xf
    v_and_b32_dpp v31, v19, v23 row_newbcast:8 row_mask:0xf bank_mask:0xf
    s_waitcnt vmcnt(3)
    s_bitcmp0_b32 s14, 1
    s_cbranch_scc1 L_sf_91
    s_waitcnt vmcnt(2)
    s_bitcmp0_b32 s15, 1
    s_cbranch_scc1 L_sf_91
    s_waitcnt vmcnt(1)
L_sf_91:
    buffer_load_dwordx4 v[44:47], v1, s[52:55], s97 offen offset:1024 nt
    v_mfma_f32_16x16x32_bf16 v[32:35], v[28:31], v[156:159], v[32:35]
    v_and_b32_dpp v24, v19, v20 row_newbcast:4 row_mask:0xf bank_mask:0xf
    v_and_b32_dpp v25, v19, v21 row_newbcast:4 row_mask:0xf bank_mask:0xf
    v_and_b32_dpp v26, v19, v22 row_newbcast:4 row_mask:0xf bank_mask:0xf
    v_and_b32_dpp v27, v19, v23 row_newbcast:4 row_mask:0xf bank_mask:0xf
    s_waitcnt vmcnt(3)
    s_bitcmp0_b32 s14, 2
    s_cbranch_scc1 L_sf_92
    s_waitcnt vmcnt(2)
    s_bitcmp0_b32 s15, 2
    s_cbranch_scc1 L_sf_92
    s_waitcnt vmcnt(1)
L_sf_92:
    buffer_load_dwordx4 v[48:51], v1, s[52:55], s97 offen offset:2048 nt
    v_mfma_f32_16x16x32_bf16 v[32:35], v[24:27], v[160:163], v[32:35]
    v_and_b32_dpp v28, v19, v20 row_newbcast:12 row_mask:0xf bank_mask:0xf
    v_and_b32_dpp v29, v19, v21 row_newbcast:12 row_mask:0xf bank_mask:0xf
    v_and_b32_dpp v30, v19, v22 row_newbcast:12 row_mask:0xf bank_mask:0xf
    v_and_b32_dpp v31, v19, v23 row_newbcast:12 row_mask:0xf bank_mask:0xf
    s_waitcnt vmcnt(3)
    s_bitcmp0_b32 s14, 3
    s_cbranch_scc1 L_sf_93
    s_waitcnt vmcnt(2)
    s_bitcmp0_b32 s15, 3
    s_cbranch_scc1 L_sf_93
    s_waitcnt vmcnt(1)
L_sf_93:
    buffer_load_dwordx4 v[52:55], v1, s[52:55], s97 offen offset:3072 nt
    s_add_u32 s97, s97, 32768
    v_add_u32 v1, 4096, v1
    v_and_b32 v1, 0x7fff, v1
    v_mfma_f32_16x16x32_bf16 v[32:35], v[28:31], v[164:167], v[32:35]
    v_and_b32_dpp v24, v12, v20 row_newbcast:0 row_mask:0xf bank_mask:0xf
    v_and_b32_dpp v25, v12, v21 row_newbcast:0 row_mask:0xf bank_mask:0xf
    v_and_b32_dpp v26, v12, v22 row_newbcast:0 row_mask:0xf bank_mask:0xf
    v_and_b32_dpp v27, v12, v23 row_newbcast:0 row_mask:0xf bank_mask:0xf
    s_waitcnt vmcnt(3)
    s_bitcmp0_b32 s14, 4
    s_cbranch_scc1 L_sf_94
    s_waitcnt vmcnt(2)
    s_bitcmp0_b32 s15, 4
    s_cbranch_scc1 L_sf_94
    s_waitcnt vmcnt(1)
L_sf_94:
    buffer_load_dwordx4 v[56:59], v1, s[52:55], s97 offen offset:0 nt
    v_mfma_f32_16x16x32_bf16 v[32:35], v[24:27], v[40:43], v[32:35]
    v_and_b32_dpp v28, v12, v20 row_newbcast:8 row_mask:0xf bank_mask:0xf
    v_and_b32_dpp v29, v12, v21 row_newbcast:8 row_mask:0xf bank_mask:0xf
    v_and_b32_dpp v30, v12, v22 row_newbcast:8 row_mask:0xf bank_mask:0xf
    v_and_b32_dpp v31, v12, v23 row_newbcast:8 row_mask:0xf bank_mask:0xf
    s_waitcnt vmcnt(3)
    s_bitcmp0_b32 s14, 5
    s_cbranch_scc1 L_sf_95
    s_waitcnt vmcnt(2)
    s_bitcmp0_b32 s15, 5
    s_cbranch_scc1 L_sf_95
    s_waitcnt vmcnt(1)
L_sf_95:
    buffer_load_dwordx4 v[60:63], v1, s[52:55], s97 offen offset:1024 nt
    v_mfma_f32_16x16x32_bf16 v[32:35], v[28:31], v[44:47], v[32:35]
    v_and_b32_dpp v24, v12, v20 row_newbcast:4 row_mask:0xf bank_mask:0xf
    v_and_b32_dpp v25, v12, v21 row_newbcast:4 row_mask:0xf bank_mask:0xf
    v_and_b32_dpp v26, v12, v22 row_newbcast:4 row_mask:0xf bank_mask:0xf
    v_and_b32_dpp v27, v12, v23 row_newbcast:4 row_mask:0xf bank_mask:0xf
    s_waitcnt vmcnt(3)
    s_bitcmp0_b32 s14, 6
    s_cbranch_scc1 L_sf_96
    s_waitcnt vmcnt(2)
    s_bitcmp0_b32 s15, 6
    s_cbranch_scc1 L_sf_96
    s_waitcnt vmcnt(1)
L_sf_96:
    buffer_load_dwordx4 v[64:67], v1, s[52:55], s97 offen offset:2048 nt
    v_mfma_f32_16x16x32_bf16 v[32:35], v[24:27], v[48:51], v[32:35]
    v_and_b32_dpp v28, v12, v20 row_newbcast:12 row_mask:0xf bank_mask:0xf
    v_and_b32_dpp v29, v12, v21 row_newbcast:12 row_mask:0xf bank_mask:0xf
    v_and_b32_dpp v30, v12, v22 row_newbcast:12 row_mask:0xf bank_mask:0xf
    v_and_b32_dpp v31, v12, v23 row_newbcast:12 row_mask:0xf bank_mask:0xf
    s_waitcnt vmcnt(3)
    s_bitcmp0_b32 s14, 7
    s_cbranch_scc1 L_sf_97
    s_waitcnt vmcnt(2)
    s_bitcmp0_b32 s15, 7
    s_cbranch_scc1 L_sf_97
    s_waitcnt vmcnt(1)
L_sf_97:
    buffer_load_dwordx4 v[68:71], v1, s[52:55], s97 offen offset:3072 nt
    s_add_u32 s97, s97, 32768
    v_add_u32 v1, 4096, v1
    v_and_b32 v1, 0x7fff, v1
    v_mfma_f32_16x16x32_bf16 v[32:35], v[28:31], v[52:55], v[32:35]
    v_and_b32_dpp v24, v13, v20 row_newbcast:0 row_mask:0xf bank_mask:0xf
    v_and_b32_dpp v25, v13, v21 row_newbcast:0 row_mask:0xf bank_mask:0xf
    v_and_b32_dpp v26, v13, v22 row_newbcast:0 row_mask:0xf bank_mask:0xf
    v_and_b32_dpp v27, v13, v23 row_newbcast:0 row_mask:0xf bank_mask:0xf
    s_waitcnt vmcnt(3)
    s_nop 0
    v_mfma_f32_16x16x32_bf16 v[32:35], v[24:27], v[56:59], v[32:35]
    v_and_b32_dpp v28, v13, v20 row_newbcast:8 row_mask:0xf bank_mask:0xf
    v_and_b32_dpp v29, v13, v21 row_newbcast:8 row_mask:0xf bank_mask:0xf
    v_and_b32_dpp v30, v13, v22 row_newbcast:8 row_mask:0xf bank_mask:0xf
    v_and_b32_dpp v31, v13, v23 row_newbcast:8 row_mask:0xf bank_mask:0xf
    s_waitcnt vmcnt(2)
    s_nop 0
    v_mfma_f32_16x16x32_bf16 v[32:35], v[28:31], v[60:63], v[32:35]
    v_and_b32_dpp v24, v13, v20 row_newbcast:4 row_mask:0xf bank_mask:0xf
    v_and_b32_dpp v25, v13, v21 row_newbcast:4 row_mask:0xf bank_mask:0xf
    v_and_b32_dpp v26, v13, v22 row_newbcast:4 row_mask:0xf bank_mask:0xf
    v_and_b32_dpp v27, v13, v23 row_newbcast:4 row_mask:0xf bank_mask:0xf
    s_waitcnt vmcnt(1)
    s_nop 0
    v_mfma_f32_16x16x32_bf16 v[32:35], v[24:27], v[64:67], v[32:35]
    v_and_b32_dpp v28, v13, v20 row_newbcast:12 row_mask:0xf bank_mask:0xf
    v_and_b32_dpp v29, v13, v21 row_newbcast:12 row_mask:0xf bank_mask:0xf
    v_and_b32_dpp v30, v13, v22 row_newbcast:12 row_mask:0xf bank_mask:0xf
    v_and_b32_dpp v31, v13, v23 row_newbcast:12 row_mask:0xf bank_mask:0xf
    s_waitcnt vmcnt(0)
    s_nop 0
    v_mfma_f32_16x16x32_bf16 v[32:35], v[28:31], v[68:71], v[32:35]
    s_branch L_v_join
L_oslow:
    buffer_store_dword v32, v39, s[40:43], s98 offen sc1
    s_branch L_odone
L_qslow:
L_wy_99:
    buffer_load_dword v37, v39, s[44:47], 0 offen sc1
    s_waitcnt vmcnt(0)
    v_cmp_ne_u32 vcc, -1, v37
    s_cbranch_vccz L_wy_99e
    s_sleep 4
    s_sub_u32 s60, s60, 1
    s_cbranch_scc0 L_wy_99
    s_mov_b32 s60, 0
L_wy_99e:
L_qslow2:
    s_branch L_poll_100
L_poll_100s:
    s_sleep 2
L_poll_100:
    buffer_load_dwordx4 v[4:7], v2, s[40:43], s98 offen sc1
    s_sub_u32 s60, s60, 1
    s_cbranch_scc1 L_poll_100t
    s_waitcnt vmcnt(0)
    v_max3_u32 v38, v4, v5, v6
    v_max_u32 v38, v38, v7
    v_cmp_eq_u32 vcc, -1, v38
    s_cbranch_vccnz L_poll_100s
L_poll_100e:
    s_branch L_qok
L_mljob:
    s_lshl_b32 s96, s38, 3
    s_add_u32 s96, s96, s3
    s_lshl3_add_u32 s96, s96, s99
    buffer_store_dwordx2 v[8:9], v36, s[40:43], s96 offen sc1
    s_branch L_mldone
L_service:
    v_mov_b32 v72, 0
    v_mov_b32 v73, 0
    v_mov_b32 v74, 0
    v_mov_b32 v75, 0
    v_mov_b32 v76, 0
    s_mov_b32 s59, 0
    v_mov_b32 v5, 0
    v_mov_b32 v105, 0
    v_mov_b32 v108, 0
    v_mov_b32 v110, 0
    v_mov_b32 v160, 0
    v_mov_b32 v163, 0
    v_mov_b32 v8, 162068
L_lw_101:
    ds_read_b32 v9, v8
    s_waitcnt lgkmcnt(0)
    v_cmp_gt_u32 vcc, 8, v9
    s_cbranch_vccz L_lw_101e
    s_sleep 8
    s_sub_u32 s60, s60, 1
    s_cbranch_scc0 L_lw_101
    s_mov_b32 s60, 0
L_lw_101e:
    v_and_b32 v2, 15, v0
    v_lshlrev_b32 v2, 3, v2
    v_add_u32 v3, 161920, v2
    ds_read_b64 v[8:9], v3
    v_mov_b32 v11, 162096
    ds_read_b32 v11, v11
    s_lshl_b32 s99, s37, 5
    s_add_u32 s99, s99, s36
    s_lshl_b32 s99, s99, 7
    s_add_u32 s99, s99, 73728
    s_lshl_b32 s62, s38, 6
    s_add_u32 s62, s62, s99
    s_getreg_b32 s58, hwreg(HW_REG_XCC_ID, 0, 4)
    s_lshl_b32 s98, s34, 5
    s_add_u32 s98, s98, s35
    s_lshl_b32 s63, s98, 2
    s_add_u32 s63, s63, 188416
    s_lshl_b32 s98, s98, 8
    s_add_u32 s98, s98, 90112
    v_lshlrev_b32 v39, 2, v0
    s_bfm_b64 exec, 8, 0
    s_waitcnt lgkmcnt(0)
    v_lshl_add_u32 v10, v11, 8, s58
    buffer_store_dwordx2 v[8:9], v2, s[40:43], s62 offen sc1
    s_mov_b64 exec, 1
    buffer_store_dword v10, v36, s[40:43], s63 offen sc1
    s_mov_b64 exec, -1
    v_mov_b32 v12, 162076
L_lw_102:
    ds_read_b32 v13, v12
    s_waitcnt lgkmcnt(0)
    v_cmp_gt_u32 vcc, 4, v13
    s_cbranch_vccz L_lw_102e
    s_sleep 4
    s_sub_u32 s60, s60, 1
    s_cbranch_scc0 L_lw_102
    s_mov_b32 s60, 0
L_lw_102e:
    v_and_b32 v11, 31, v0
    v_lshlrev_b32 v11, 2, v11
    s_lshl_b32 s63, s34, 7
    s_add_u32 s63, s63, 188416
    buffer_load_dword v12, v39, s[40:43], s98 offen sc1
    s_branch L_poll_103
L_poll_103s:
    s_sleep 16
L_poll_103:
    buffer_load_dwordx2 v[8:9], v2, s[40:43], s99 offen sc1
    buffer_load_dword v10, v11, s[40:43], s63 offen sc1
    s_sub_u32 s60, s60, 1
    s_cbranch_scc1 L_poll_103t
    s_waitcnt vmcnt(0)
    v_max3_u32 v38, v8, v9, v10
    v_cmp_eq_u32 vcc, -1, v38
    s_cbranch_vccnz L_poll_103s
L_poll_103e:
    v_mov_b32 v37, v8
    s_nop 1
    v_max_f32_dpp v37, v37, v37 quad_perm:[1,0,3,2] row_mask:0xf bank_mask:0xf
    s_nop 1
    v_max_f32_dpp v37, v37, v37 quad_perm:[2,3,0,1] row_mask:0xf bank_mask:0xf
    s_nop 1
    v_max_f32_dpp v37, v37, v37 row_ror:4 row_mask:0xf bank_mask:0xf
    s_nop 1
    v_max_f32_dpp v37, v37, v37 row_ror:8 row_mask:0xf bank_mask:0xf
    v_sub_f32 v8, v8, v37
    v_exp_f32 v8, v8
    s_nop 0
    v_mul_f32 v9, v8, v9
    s_nop 1
    v_add_f32_dpp v9, v9, v9 quad_perm:[1,0,3,2] row_mask:0xf bank_mask:0xf
    s_nop 1
    v_add_f32_dpp v9, v9, v9 quad_perm:[2,3,0,1] row_mask:0xf bank_mask:0xf
    s_nop 1
    v_add_f32_dpp v9, v9, v9 row_ror:4 row_mask:0xf bank_mask:0xf
    s_nop 1
    v_add_f32_dpp v9, v9, v9 row_ror:8 row_mask:0xf bank_mask:0xf
    v_and_b32 v10, 0xff, v10
    s_getreg_b32 s62, hwreg(HW_REG_XCC_ID, 0, 4)
    v_cmp_ne_u32 vcc, s62, v10
    s_nop 0
    s_cmp_eq_u64 vcc, 0
    s_cselect_b32 s61, 1, 0
    v_rcp_f32 v9, v9
    v_lshrrev_b32 v3, 1, v2
    v_add_u32 v3, 161984, v3
    v_mul_f32 v8, v8, v9
    v_mov_b32 v10, 162072
    v_mov_b32 v11, s61
    ds_write_b32 v3, v8
    ds_write_b32 v10, v11
    s_mov_b32 s3, 1
    v_lshrrev_b32 v9, 4, v0
    v_lshl_add_u32 v8, v9, 2, v2
    s_lshl_b32 s96, s3, 9
    s_add_u32 s96, s96, 157824
    v_lshl_add_u32 v8, v8, 2, s96
    v_lshlrev_b32 v9, 3, v0
    v_add_u32 v9, 157824, v9
    v_mov_b32 v10, 162048
    v_mov_b32 v11, 1
    s_lshl_b32 s96, s38, 5
    s_add_u32 s96, s96, 161984
    v_mov_b32 v3, s96
    s_sub_u32 s62, 8, s39
    s_lshl_b32 s98, s34, 5
    s_add_u32 s98, s98, s35
    s_lshl_b32 s98, s98, 8
    s_add_u32 s98, s98, 90112
    v_lshlrev_b32 v39, 2, v0
    s_branch L_t0b
L_jobend:
    v_lshlrev_b32 v9, 4, v0
    s_mov_b32 exec_hi, 0
    s_nop 3
    buffer_store_dwordx4 v[32:35], v9, s[40:43], s13 offen sc1
    s_endpgm
L_proxy:
    v_mov_b32 v72, 0
    v_mov_b32 v73, 0
    v_mov_b32 v74, 0
    v_mov_b32 v75, 0
    v_mov_b32 v76, 0
    v_mov_b32 v5, 0
    v_mov_b32 v105, 0
    v_mov_b32 v108, 0
    v_mov_b32 v110, 0
    v_mov_b32 v160, 0
    v_mov_b32 v163, 0
    s_barrier
    s_waitcnt lgkmcnt(0)
    s_mov_b32 s40, s32
    s_mov_b32 s41, s33
    s_mov_b32 s42, 589824
    s_mov_b32 s43, 0x20000
    s_mov_b32 s44, s30
    s_mov_b32 s45, s31
    s_mov_b32 s46, 256
    s_mov_b32 s47, 0x20000
    s_sub_u32 s97, 7, s3
    s_mul_i32 s97, s97, 27
    s_cmp_eq_u32 s3, 5
    s_cselect_b32 s97, 32, s97
    s_add_u32 s97, s97, s35
    s_lshl_b32 s97, s97, 9
    s_add_u32 s97, s97, 155648
    v_and_b32 v2, 15, v0
    v_lshlrev_b32 v2, 3, v2
    v_and_b32 v20, 31, v0
    v_lshlrev_b32 v20, 4, v20
    s_cmp_lg_u32 s3, 7
    s_cbranch_scc1 L_px6
    s_sub_u32 s96, 6, s59
    v_mov_b32 v8, 162068
L_lw_104:
    ds_read_b32 v9, v8
    s_waitcnt lgkmcnt(0)
    v_cmp_gt_u32 vcc, s96, v9
    s_cbranch_vccz L_lw_104e
    s_sleep 8
    s_sub_u32 s60, s60, 1
    s_cbranch_scc0 L_lw_104
    s_mov_b32 s60, 0
L_lw_104e:
    v_and_b32 v2, 15, v0
    v_lshlrev_b32 v2, 3, v2
    v_add_u32 v3, 161920, v2
    ds_read_b64 v[8:9], v3
    v_mov_b32 v11, 162096
    ds_read_b32 v11, v11
    s_lshl_b32 s99, s37, 5
    s_add_u32 s99, s99, s36
    s_lshl_b32 s99, s99, 7
    s_add_u32 s99, s99, 73728
    s_lshl_b32 s62, s38, 6
    s_add_u32 s62, s62, s99
    s_getreg_b32 s58, hwreg(HW_REG_XCC_ID, 0, 4)
    s_lshl_b32 s98, s34, 5
    s_add_u32 s98, s98, s35
    s_lshl_b32 s63, s98, 2
    s_add_u32 s63, s63, 188416
    s_lshl_b32 s98, s98, 8
    s_add_u32 s98, s98, 90112
    v_lshlrev_b32 v39, 2, v0
    s_bfm_b64 exec, s96, 0
    s_waitcnt lgkmcnt(0)
    v_lshl_add_u32 v10, v11, 8, s58
    buffer_store_dwordx2 v[8:9], v2, s[40:43], s62 offen sc1
    s_mov_b64 exec, 1
    buffer_store_dword v10, v36, s[40:43], s63 offen sc1
    s_mov_b64 exec, -1
    s_mov_b32 s100, 4
    s_lshl_b32 s63, s100, 8
    v_and_b32 v8, 15, v0
    v_lshl_add_u32 v8, v8, 4, s63
    v_lshrrev_b32 v9, 4, v0
    v_mul_u32_u24 v5, 1280, v9
    v_add_u32 v5, v5, v8
    v_mul_u32_u24 v4, 1296, v9
    v_add_u32 v4, v4, v8
    v_add_u32 v4, 82944, v4
    v_lshlrev_b32 v6, 1, v5
    v_add_u32 v6, 99328, v6
    s_lshl_b32 s62, s100, 9
    s_add_u32 s62, s62, 88128
    v_lshl_add_u32 v7, v0, 3, s62
    s_mov_b32 s48, s4
    s_mov_b32 s49, s5
    s_mov_b32 s50, 5120
    s_mov_b32 s51, 0x20000
    buffer_load_dwordx4 v[8:11], v5, s[48:51], 0 offen
    s_mov_b32 s62, 20480
    s_mov_b32 s63, 30720
    s_branch L_poll_105
L_poll_105s:
    s_sleep 32
L_poll_105:
    buffer_load_dwordx4 v[12:15], v5, s[40:43], s62 offen sc1
    buffer_load_dwordx4 v[16:19], v5, s[40:43], s63 offen sc1
    s_sub_u32 s60, s60, 1
    s_cbranch_scc1 L_poll_105t
    s_waitcnt vmcnt(0)
    v_max3_u32 v38, v12, v13, v14
    v_max3_u32 v38, v38, v15, v16
    v_max3_u32 v38, v38, v17, v18
    v_max_u32 v38, v38, v19
    v_cmp_eq_u32 vcc, -1, v38
    s_cbranch_vccnz L_poll_105s
L_poll_105e:
    v_lshlrev_b32 v40, 16, v8
    v_and_b32 v41, 0xffff0000, v8
    v_lshlrev_b32 v42, 16, v9
    v_and_b32 v43, 0xffff0000, v9
    v_lshlrev_b32 v44, 16, v10
    v_and_b32 v45, 0xffff0000, v10
    v_lshlrev_b32 v46, 16, v11
    v_and_b32 v47, 0xffff0000, v11
    v_lshlrev_b32 v48, 16, v12
    v_and_b32 v49, 0xffff0000, v12
    v_lshlrev_b32 v50, 16, v13
    v_and_b32 v51, 0xffff0000, v13
    v_lshlrev_b32 v52, 16, v14
    v_and_b32 v53, 0xffff0000, v14
    v_lshlrev_b32 v54, 16, v15
    v_and_b32 v55, 0xffff0000, v15
    v_lshlrev_b32 v56, 16, v16
    v_and_b32 v57, 0xffff0000, v16
    v_lshlrev_b32 v58, 16, v17
    v_and_b32 v59, 0xffff0000, v17
    v_lshlrev_b32 v60, 16, v18
    v_and_b32 v61, 0xffff0000, v18
    v_lshlrev_b32 v62, 16, v19
    v_and_b32 v63, 0xffff0000, v19
    v_mov_b32 v64, 0
    v_mov_b32 v65, 0
    v_mov_b32 v66, 0
    v_mov_b32 v67, 0
    v_mov_b32 v68, 0
    v_mov_b32 v69, 0
    v_mov_b32 v70, 0
    v_mov_b32 v71, 0
    v_bfe_u32 v5, v0, 2, 2
    v_lshlrev_b32 v5, 8, v5
    v_lshrrev_b32 v8, 4, v0
    v_lshl_add_u32 v5, v8, 6, v5
    v_and_b32 v8, 3, v0
    v_lshl_add_u32 v5, v8, 4, v5
    s_lshl_b32 s56, s100, 10
    s_or_b32 s96, s59, s39
    s_cbranch_scc0 L_nofrag_106
    v_mov_b32 v104, 162060
L_lw_107:
    ds_read_b32 v105, v104
    s_waitcnt lgkmcnt(0)
    v_cmp_gt_u32 vcc, 4, v105
    s_cbranch_vccz L_lw_107e
    s_sleep 2
    s_sub_u32 s60, s60, 1
    s_cbranch_scc0 L_lw_107
    s_mov_b32 s60, 0
L_lw_107e:
    s_cmp_eq_u32 s59, 0
    s_cbranch_scc1 L_nofrag_106
    v_bfe_u32 v104, v0, 2, 1
    v_bfe_u32 v110, v0, 4, 1
    v_lshl_add_u32 v104, v110, 2, v104
    v_and_b32 v110, 8, v0
    v_add_u32 v104, v104, v110
    v_lshrrev_b32 v110, 5, v0
    v_lshl_add_u32 v104, v110, 4, v104
    v_bfe_u32 v111, v0, 0, 1
    v_mul_u32_u24 v111, 0xaaaa, v111
    v_add_u32 v111, 0x4444, v111
    v_mov_b32 v112, 0
    v_mov_b32 v113, 0
    v_mov_b32 v114, 0
    v_mov_b32 v115, 0
    v_mov_b32 v116, 0
    v_mov_b32 v117, 0
    v_mov_b32 v118, 0
    v_mov_b32 v119, 0
    v_lshlrev_b32 v104, 7, v104
    v_and_b32 v110, 3, v0
    v_lshl_add_u32 v104, v110, 3, v104
    v_lshrrev_b32 v109, 4, v0
    v_and_b32 v110, 1, v0
    s_lshr_b32 s63, s3, 1
    s_and_b32 s62, s3, 1
    s_lshl_b32 s96, s63, 14
    s_lshl_b32 s100, s62, 6
    s_add_u32 s100, s100, 81920
    s_add_u32 s96, s96, s100
    v_add_u32 v104, s96, v104
    ds_read_b64_tr_b16 v[72:73], v104 offset:0
    ds_read_b64_tr_b16 v[74:75], v104 offset:256
    ds_read_b64_tr_b16 v[76:77], v104 offset:4096
    ds_read_b64_tr_b16 v[78:79], v104 offset:4352
    ds_read_b64_tr_b16 v[80:81], v104 offset:32
    ds_read_b64_tr_b16 v[82:83], v104 offset:288
    ds_read_b64_tr_b16 v[84:85], v104 offset:4128
    ds_read_b64_tr_b16 v[86:87], v104 offset:4384
    ds_read_b64_tr_b16 v[88:89], v104 offset:8192
    ds_read_b64_tr_b16 v[90:91], v104 offset:8448
    ds_read_b64_tr_b16 v[92:93], v104 offset:12288
    ds_read_b64_tr_b16 v[94:95], v104 offset:12544
    ds_read_b64_tr_b16 v[96:97], v104 offset:8224
    ds_read_b64_tr_b16 v[98:99], v104 offset:8480
    ds_read_b64_tr_b16 v[100:101], v104 offset:12320
    ds_read_b64_tr_b16 v[102:103], v104 offset:12576
    v_bfe_u32 v105, v0, 1, 3
    v_lshlrev_b32 v105, 8, v105
    v_lshl_add_u32 v105, v109, 5, v105
    v_lshl_add_u32 v105, v110, 4, v105
    v_lshrrev_b32 v106, 3, v0
    v_lshlrev_b32 v106, 7, v106
    v_and_b32 v110, 7, v0
    v_lshl_add_u32 v107, v110, 3, v106
    v_add_u32 v107, s100, v107
    v_lshlrev_b32 v106, 8, v109
    v_and_b32 v110, 15, v0
    v_lshl_add_u32 v106, v110, 2, v106
    v_add_u32 v106, s96, v106
    v_lshlrev_b32 v108, 2, v0
    s_lshl_b32 s96, s62, 2
    s_add_u32 s96, s96, 162088
    v_mov_b32 v109, s96
    s_lshl_b32 s100, s63, 11
    s_lshl_b32 s96, s34, 13
    s_add_u32 s100, s100, s96
    s_add_u32 s100, s100, 90112
    s_mul_i32 s101, s34, 5120
    s_lshl_b32 s96, s35, 9
    s_add_u32 s101, s101, s96
    s_lshl_b32 s96, s62, 8
    s_add_u32 s101, s101, s96
    s_sub_u32 s101, s101, 11264
    s_and_b32 s96, s101, 0xffffe000
    s_add_u32 s101, s101, s96
    s_add_u32 s101, s101, 196608
    v_add_u32 v110, 8192, v108
L_nofrag_106:
    s_cmp_ge_u32 s35, 20
    s_cbranch_scc1 L_nofin_108
    s_lshl1_add_u32 s62, s35, s3
    s_sub_u32 s62, s62, 6
    s_lshl_b32 s57, s62, 7
    s_mul_i32 s63, s62, 0x199a
    s_lshr_b32 s63, s63, 16
    s_mul_i32 s63, s63, 1280
    s_sub_u32 s63, s57, s63
    v_lshrrev_b32 v72, 3, v0
    v_mul_u32_u24 v72, 5120, v72
    v_and_b32 v8, 7, v0
    v_lshl_add_u32 v72, v8, 4, v72
    s_add_u32 s62, s57, 294912
    v_add_u32 v72, s62, v72
    v_add_u32 v73, 40960, v72
    v_add_u32 v74, 81920, v72
    v_add_u32 v75, 122880, v72
    v_bfe_u32 v9, v0, 4, 1
    v_lshlrev_b32 v76, 4, v8
    v_lshl_add_u32 v76, v9, 3, v76
    s_lshl_b32 s62, s57, 1
    s_add_u32 s62, s62, 99328
    v_lshl_add_u32 v77, v76, 1, s62
    s_mov_b32 s48, s22
    s_mov_b32 s49, s23
    s_mov_b32 s50, 1280
    s_mov_b32 s51, 0x20000
    buffer_load_dwordx2 v[86:87], v76, s[48:51], s63 offen
    s_add_u32 s62, s57, 35840
    s_branch L_poll_109
L_poll_109s:
    s_sleep 32
L_poll_109:
    buffer_load_dwordx2 v[8:9], v76, s[40:43], s62 offen sc1
    s_sub_u32 s60, s60, 1
    s_cbranch_scc1 L_poll_109t
    s_waitcnt vmcnt(0)
    v_max_u32 v38, v8, v9
    v_cmp_eq_u32 vcc, -1, v38
    s_cbranch_vccnz L_poll_109s
L_poll_109e:
    v_lshlrev_b32 v78, 16, v86
    v_and_b32 v79, 0xffff0000, v86
    v_lshlrev_b32 v82, 16, v8
    v_and_b32 v83, 0xffff0000, v8
    v_lshlrev_b32 v80, 16, v87
    v_and_b32 v81, 0xffff0000, v87
    v_lshlrev_b32 v84, 16, v9
    v_and_b32 v85, 0xffff0000, v9
    v_bfe_u32 v8, v0, 1, 3
    v_and_b32 v9, 1, v0
    v_lshlrev_b32 v9, 4, v9
    v_mov_b32 v10, 0x3f80
    v_lshlrev_b32 v9, v9, v10
    v_cmp_eq_u32 vcc, 0, v8
    v_mov_b32 v100, 0
    s_nop 0
    v_cndmask_b32 v104, 0, v9, vcc
    v_cmp_eq_u32 vcc, 1, v8
    v_mov_b32 v101, 0
    s_nop 0
    v_cndmask_b32 v105, 0, v9, vcc
    v_cmp_eq_u32 vcc, 2, v8
    v_mov_b32 v102, 0
    s_nop 0
    v_cndmask_b32 v106, 0, v9, vcc
    v_cmp_eq_u32 vcc, 3, v8
    v_mov_b32 v103, 0
    s_nop 0
    v_cndmask_b32 v107, 0, v9, vcc
L_nofin_108:
    v_mov_b32 v12, 162076
L_lw_110:
    ds_read_b32 v13, v12
    s_waitcnt lgkmcnt(0)
    v_cmp_gt_u32 vcc, 4, v13
    s_cbranch_vccz L_lw_110e
    s_sleep 4
    s_sub_u32 s60, s60, 1
    s_cbranch_scc0 L_lw_110
    s_mov_b32 s60, 0
L_lw_110e:
    v_and_b32 v11, 31, v0
    v_lshlrev_b32 v11, 2, v11
    s_lshl_b32 s63, s34, 7
    s_add_u32 s63, s63, 188416
    buffer_load_dword v12, v39, s[40:43], s98 offen sc1
    s_branch L_poll_111
L_poll_111s:
    s_sleep 4
L_poll_111:
    buffer_load_dwordx2 v[8:9], v2, s[40:43], s99 offen sc1
    buffer_load_dword v10, v11, s[40:43], s63 offen sc1
    buffer_load_dwordx4 v[32:35], v20, s[40:43], s97 offen sc1
    s_sub_u32 s60, s60, 1
    s_cbranch_scc1 L_poll_111t
    s_waitcnt vmcnt(0)
    v_max3_u32 v38, v8, v9, v10
    v_max3_u32 v38, v38, v32, v33
    v_max3_u32 v38, v38, v34, v35
    v_cmp_eq_u32 vcc, -1, v38
    s_cbranch_vccnz L_poll_111s
L_poll_111e:
    v_mov_b32 v37, v8
    s_nop 1
    v_max_f32_dpp v37, v37, v37 quad_perm:[1,0,3,2] row_mask:0xf bank_mask:0xf
    s_nop 1
    v_max_f32_dpp v37, v37, v37 quad_perm:[2,3,0,1] row_mask:0xf bank_mask:0xf
    s_nop 1
    v_max_f32_dpp v37, v37, v37 row_ror:4 row_mask:0xf bank_mask:0xf
    s_nop 1
    v_max_f32_dpp v37, v37, v37 row_ror:8 row_mask:0xf bank_mask:0xf
    v_sub_f32 v8, v8, v37
    v_exp_f32 v8, v8
    s_nop 0
    v_mul_f32 v9, v8, v9
    s_nop 1
    v_add_f32_dpp v9, v9, v9 quad_perm:[1,0,3,2] row_mask:0xf bank_mask:0xf
    s_nop 1
    v_add_f32_dpp v9, v9, v9 quad_perm:[2,3,0,1] row_mask:0xf bank_mask:0xf
    s_nop 1
    v_add_f32_dpp v9, v9, v9 row_ror:4 row_mask:0xf bank_mask:0xf
    s_nop 1
    v_add_f32_dpp v9, v9, v9 row_ror:8 row_mask:0xf bank_mask:0xf
    v_ashrrev_i32 v12, 8, v10
    s_nop 1
    v_add_u32_dpp v12, v12, v12 quad_perm:[1,0,3,2] row_mask:0xf bank_mask:0xf
    s_nop 1
    v_add_u32_dpp v12, v12, v12 quad_perm:[2,3,0,1] row_mask:0xf bank_mask:0xf
    s_nop 1
    v_add_u32_dpp v12, v12, v12 row_ror:4 row_mask:0xf bank_mask:0xf
    s_nop 1
    v_add_u32_dpp v12, v12, v12 row_ror:8 row_mask:0xf bank_mask:0xf
    v_mov_b32 v13, v12
    s_nop 1
    v_permlane16_swap_b32 v12, v13
    v_add_u32 v12, v12, v13
    v_mov_b32 v13, v12
    s_nop 1
    v_permlane32_swap_b32 v12, v13
    v_add_u32 v12, v12, v13
    v_ashrrev_i32 v12, 31, v12
    v_and_b32 v12, 8192, v12
    v_mov_b32 v13, 162084
    ds_write_b32 v13, v12
    v_and_b32 v10, 0xff, v10
    s_getreg_b32 s62, hwreg(HW_REG_XCC_ID, 0, 4)
    v_cmp_ne_u32 vcc, s62, v10
    s_nop 0
    s_cmp_eq_u64 vcc, 0
    s_cselect_b32 s61, 1, 0
    v_rcp_f32 v9, v9
    v_lshrrev_b32 v3, 1, v2
    v_add_u32 v3, 161984, v3
    v_mul_f32 v8, v8, v9
    v_mov_b32 v10, 162072
    v_mov_b32 v11, s61
    ds_write_b32 v3, v8
    ds_write_b32 v10, v11
    s_branch L_pxj
L_px6:
    s_mov_b32 s62, 3
    s_lshl1_add_u32 s96, s35, s3
    s_and_b32 s63, s96, 7
    s_lshl_b32 s63, s63, 14
    s_lshl_b32 s96, s96, 7
    s_add_u32 s96, s96, s63
    s_add_u32 s96, s96, 458752
    s_add_u32 s98, s32, s96
    s_addc_u32 s99, s33, 0
    s_load_dword s4, s[98:99], 0 glc
    s_load_dword s5, s[98:99], 8192 glc
    s_mov_b32 s63, 0
    s_waitcnt lgkmcnt(0)
L_np:
    s_not_b32 s4, s4
    s_mov_b32 s6, s4
    s_mov_b32 s7, 0
    s_load_dword s4, s[98:99], 0 glc
L_npc0:
    s_add_u32 s7, s7, 1
    s_cmp_eq_u32 s4, s6
    s_cselect_b32 s8, s7, 1000
    s_cmp_lt_u32 s8, 60
    s_cbranch_scc1 L_npc0
    s_waitcnt lgkmcnt(0)
    s_sub_u32 s63, s63, s7
    s_not_b32 s5, s5
    s_mov_b32 s6, s5
    s_mov_b32 s7, 0
    s_load_dword s5, s[98:99], 8192 glc
L_npc1:
    s_add_u32 s7, s7, 1
    s_cmp_eq_u32 s5, s6
    s_cselect_b32 s8, s7, 1000
    s_cmp_lt_u32 s8, 60
    s_cbranch_scc1 L_npc1
    s_waitcnt lgkmcnt(0)
    s_add_u32 s63, s63, s7
    s_sub_u32 s62, s62, 1
    s_cmp_lg_u32 s62, 0
    s_cbranch_scc1 L_np
    v_mov_b32 v8, 162096
    v_mov_b32 v9, s63
    s_mov_b64 exec, 1
    ds_add_u32 v8, v9
    s_mov_b64 exec, -1
    s_or_b32 s96, s59, s39
    s_cbranch_scc0 L_nofrag_112
    v_mov_b32 v104, 162060
L_lw_113:
    ds_read_b32 v105, v104
    s_waitcnt lgkmcnt(0)
    v_cmp_gt_u32 vcc, 4, v105
    s_cbranch_vccz L_lw_113e
    s_sleep 2
    s_sub_u32 s60, s60, 1
    s_cbranch_scc0 L_lw_113
    s_mov_b32 s60, 0
L_lw_113e:
    s_cmp_eq_u32 s59, 0
    s_cbranch_scc1 L_nofrag_112
    v_bfe_u32 v104, v0, 2, 1
    v_bfe_u32 v110, v0, 4, 1
    v_lshl_add_u32 v104, v110, 2, v104
    v_and_b32 v110, 8, v0
    v_add_u32 v104, v104, v110
    v_lshrrev_b32 v110, 5, v0
    v_lshl_add_u32 v104, v110, 4, v104
    v_bfe_u32 v111, v0, 0, 1
    v_mul_u32_u24 v111, 0xaaaa, v111
    v_add_u32 v111, 0x4444, v111
    v_mov_b32 v112, 0
    v_mov_b32 v113, 0
    v_mov_b32 v114, 0
    v_mov_b32 v115, 0
    v_mov_b32 v116, 0
    v_mov_b32 v117, 0
    v_mov_b32 v118, 0
    v_mov_b32 v119, 0
    v_lshlrev_b32 v104, 7, v104
    v_and_b32 v110, 3, v0
    v_lshl_add_u32 v104, v110, 3, v104
    v_lshrrev_b32 v109, 4, v0
    v_and_b32 v110, 1, v0
    s_lshr_b32 s63, s3, 1
    s_and_b32 s62, s3, 1
    s_lshl_b32 s96, s63, 14
    s_lshl_b32 s100, s62, 6
    s_add_u32 s100, s100, 81920
    s_add_u32 s96, s96, s100
    v_add_u32 v104, s96, v104
    ds_read_b64_tr_b16 v[72:73], v104 offset:0
    ds_read_b64_tr_b16 v[74:75], v104 offset:256
    ds_read_b64_tr_b16 v[76:77], v104 offset:4096
    ds_read_b64_tr_b16 v[78:79], v104 offset:4352
    ds_read_b64_tr_b16 v[80:81], v104 offset:32
    ds_read_b64_tr_b16 v[82:83], v104 offset:288
    ds_read_b64_tr_b16 v[84:85], v104 offset:4128
    ds_read_b64_tr_b16 v[86:87], v104 offset:4384
    ds_read_b64_tr_b16 v[88:89], v104 offset:8192
    ds_read_b64_tr_b16 v[90:91], v104 offset:8448
    ds_read_b64_tr_b16 v[92:93], v104 offset:12288
    ds_read_b64_tr_b16 v[94:95], v104 offset:12544
    ds_read_b64_tr_b16 v[96:97], v104 offset:8224
    ds_read_b64_tr_b16 v[98:99], v104 offset:8480
    ds_read_b64_tr_b16 v[100:101], v104 offset:12320
    ds_read_b64_tr_b16 v[102:103], v104 offset:12576
    v_bfe_u32 v105, v0, 1, 3
    v_lshlrev_b32 v105, 8, v105
    v_lshl_add_u32 v105, v109, 5, v105
    v_lshl_add_u32 v105, v110, 4, v105
    v_lshrrev_b32 v106, 3, v0
    v_lshlrev_b32 v106, 7, v106
    v_and_b32 v110, 7, v0
    v_lshl_add_u32 v107, v110, 3, v106
    v_add_u32 v107, s100, v107
    v_lshlrev_b32 v106, 8, v109
    v_and_b32 v110, 15, v0
    v_lshl_add_u32 v106, v110, 2, v106
    v_add_u32 v106, s96, v106
    v_lshlrev_b32 v108, 2, v0
    s_lshl_b32 s96, s62, 2
    s_add_u32 s96, s96, 162088
    v_mov_b32 v109, s96
    s_lshl_b32 s100, s63, 11
    s_lshl_b32 s96, s34, 13
    s_add_u32 s100, s100, s96
    s_add_u32 s100, s100, 90112
    s_mul_i32 s101, s34, 5120
    s_lshl_b32 s96, s35, 9
    s_add_u32 s101, s101, s96
    s_lshl_b32 s96, s62, 8
    s_add_u32 s101, s101, s96
    s_sub_u32 s101, s101, 11264
    s_and_b32 s96, s101, 0xffffe000
    s_add_u32 s101, s101, s96
    s_add_u32 s101, s101, 196608
    v_add_u32 v110, 8192, v108
L_nofrag_112:
    v_mov_b32 v8, 162068
L_lw_114:
    ds_read_b32 v9, v8
    s_waitcnt lgkmcnt(0)
    v_cmp_gt_u32 vcc, 1, v9
    s_cbranch_vccz L_lw_114e
    s_sleep 32
    s_sub_u32 s60, s60, 1
    s_cbranch_scc0 L_lw_114
    s_mov_b32 s60, 0
L_lw_114e:
    s_cmp_ge_u32 s35, 20
    s_cbranch_scc1 L_nofin_115
    s_lshl1_add_u32 s62, s35, s3
    s_sub_u32 s62, s62, 6
    s_lshl_b32 s57, s62, 7
    s_mul_i32 s63, s62, 0x199a
    s_lshr_b32 s63, s63, 16
    s_mul_i32 s63, s63, 1280
    s_sub_u32 s63, s57, s63
    v_lshrrev_b32 v72, 3, v0
    v_mul_u32_u24 v72, 5120, v72
    v_and_b32 v8, 7, v0
    v_lshl_add_u32 v72, v8, 4, v72
    s_add_u32 s62, s57, 294912
    v_add_u32 v72, s62, v72
    v_add_u32 v73, 40960, v72
    v_add_u32 v74, 81920, v72
    v_add_u32 v75, 122880, v72
    v_bfe_u32 v9, v0, 4, 1
    v_lshlrev_b32 v76, 4, v8
    v_lshl_add_u32 v76, v9, 3, v76
    s_lshl_b32 s62, s57, 1
    s_add_u32 s62, s62, 99328
    v_lshl_add_u32 v77, v76, 1, s62
    s_mov_b32 s48, s22
    s_mov_b32 s49, s23
    s_mov_b32 s50, 1280
    s_mov_b32 s51, 0x20000
    buffer_load_dwordx2 v[86:87], v76, s[48:51], s63 offen
    s_add_u32 s62, s57, 35840
    s_branch L_poll_116
L_poll_116s:
    s_sleep 32
L_poll_116:
    buffer_load_dwordx2 v[8:9], v76, s[40:43], s62 offen sc1
    s_sub_u32 s60, s60, 1
    s_cbranch_scc1 L_poll_116t
    s_waitcnt vmcnt(0)
    v_max_u32 v38, v8, v9
    v_cmp_eq_u32 vcc, -1, v38
    s_cbranch_vccnz L_poll_116s
L_poll_116e:
    v_lshlrev_b32 v78, 16, v86
    v_and_b32 v79, 0xffff0000, v86
    v_lshlrev_b32 v82, 16, v8
    v_and_b32 v83, 0xffff0000, v8
    v_lshlrev_b32 v80, 16, v87
    v_and_b32 v81, 0xffff0000, v87
    v_lshlrev_b32 v84, 16, v9
    v_and_b32 v85, 0xffff0000, v9
    v_bfe_u32 v8, v0, 1, 3
    v_and_b32 v9, 1, v0
    v_lshlrev_b32 v9, 4, v9
    v_mov_b32 v10, 0x3f80
    v_lshlrev_b32 v9, v9, v10
    v_cmp_eq_u32 vcc, 0, v8
    v_mov_b32 v100, 0
    s_nop 0
    v_cndmask_b32 v104, 0, v9, vcc
    v_cmp_eq_u32 vcc, 1, v8
    v_mov_b32 v101, 0
    s_nop 0
    v_cndmask_b32 v105, 0, v9, vcc
    v_cmp_eq_u32 vcc, 2, v8
    v_mov_b32 v102, 0
    s_nop 0
    v_cndmask_b32 v106, 0, v9, vcc
    v_cmp_eq_u32 vcc, 3, v8
    v_mov_b32 v103, 0
    s_nop 0
    v_cndmask_b32 v107, 0, v9, vcc
L_nofin_115:
    v_mov_b32 v8, 162076
L_lw_117:
    ds_read_b32 v9, v8
    s_waitcnt lgkmcnt(0)
    v_cmp_gt_u32 vcc, 4, v9
    s_cbranch_vccz L_lw_117e
    s_sleep 16
    s_sub_u32 s60, s60, 1
    s_cbranch_scc0 L_lw_117
    s_mov_b32 s60, 0
L_lw_117e:
    s_branch L_poll_118
L_poll_118s:
    s_sleep 4
L_poll_118:
    buffer_load_dwordx4 v[32:35], v20, s[40:43], s97 offen sc1
    s_sub_u32 s60, s60, 1
    s_cbranch_scc1 L_poll_118t
    s_waitcnt vmcnt(0)
    v_max3_u32 v38, v32, v33, v34
    v_max_u32 v38, v38, v35
    v_cmp_eq_u32 vcc, -1, v38
    s_cbranch_vccnz L_poll_118s
L_poll_118e:
L_pxj:
    s_cmp_ge_u32 s35, 20
    s_cbranch_scc1 L_pxk
    buffer_load_dwordx4 v[88:91], v72, s[40:43], 0 offen sc1
    buffer_load_dwordx4 v[92:95], v73, s[40:43], 0 offen sc1
    buffer_load_dwordx4 v[96:99], v74, s[40:43], 0 offen sc1
    s_mov_b64 exec, 0xffffff
    buffer_load_dwordx4 v[100:103], v75, s[40:43], 0 offen sc1
    s_mov_b64 exec, -1
L_pxk:
    v_mov_b32 v8, 162048
L_lw_119:
    ds_read_b32 v9, v8
    s_waitcnt lgkmcnt(0)
    v_cmp_gt_u32 vcc, 3, v9
    s_cbranch_vccz L_lw_119e
    s_sleep 2
    s_sub_u32 s60, s60, 1
    s_cbranch_scc0 L_lw_119
    s_mov_b32 s60, 0
L_lw_119e:
    v_lshrrev_b32 v9, 4, v0
    v_lshl_add_u32 v8, v9, 2, v2
    s_lshl_b32 s96, s3, 9
    s_add_u32 s96, s96, 157824
    v_lshl_add_u32 v8, v8, 2, s96
    v_lshlrev_b32 v9, 3, v0
    v_add_u32 v9, 157824, v9
    v_mov_b32 v10, 162048
    v_mov_b32 v11, 1
    s_lshl_b32 s96, s38, 5
    s_add_u32 s96, s96, 161984
    v_mov_b32 v3, s96
    s_sub_u32 s62, 8, s39
    s_lshl_b32 s98, s34, 5
    s_add_u32 s98, s98, s35
    s_lshl_b32 s98, s98, 8
    s_add_u32 s98, s98, 90112
    v_lshlrev_b32 v39, 2, v0
    s_branch L_t0
L_s_role:
    s_cmp_eq_u32 s3, 7
    s_cbranch_scc1 L_t2gate
    s_cmp_gt_u32 s3, 3
    s_cbranch_scc1 L_fin_prep
    s_mov_b32 s48, s18
    s_mov_b32 s49, s19
    s_mov_b32 s50, 3456
    s_mov_b32 s51, 0x20000
    v_lshrrev_b32 v3, 4, v0
    v_and_b32 v4, 15, v0
    v_lshlrev_b32 v4, 1, v4
    s_lshl_b32 s62, s35, 7
    s_lshl_b32 s63, s3, 5
    s_add_u32 s62, s62, s63
    buffer_load_ushort v82, v4, s[48:51], s62 offen
    v_mov_b32 v72, 162064
L_lw_120:
    ds_read_b32 v73, v72
    s_waitcnt lgkmcnt(0)
    v_cmp_gt_u32 vcc, 4, v73
    s_cbranch_vccz L_lw_120e
    s_sleep 2
    s_sub_u32 s60, s60, 1
    s_cbranch_scc0 L_lw_120
    s_mov_b32 s60, 0
L_lw_120e:
    v_bfe_u32 v72, v0, 2, 1
    v_bfe_u32 v73, v0, 4, 1
    v_lshl_add_u32 v72, v73, 2, v72
    v_and_b32 v73, 8, v0
    v_add_u32 v72, v72, v73
    v_lshrrev_b32 v73, 5, v0
    v_lshl_add_u32 v72, v73, 4, v72
    v_lshlrev_b32 v72, 7, v72
    v_and_b32 v73, 3, v0
    v_lshl_add_u32 v72, v73, 3, v72
    v_and_b32 v73, 8, v0
    v_lshl_add_u32 v72, v73, 3, v72
    v_xor_b32 v72, s63, v72
    v_xor_b32 v73, 32, v72
    v_add_u32 v74, 40960, v72
    v_add_u32 v75, 40960, v73
    v_bfe_u32 v1, v0, 2, 2
    v_bfe_u32 v2, v0, 1, 1
    v_and_b32 v6, 1, v0
    v_lshlrev_b32 v7, 5, v3
    v_lshl_add_u32 v7, v6, 4, v7
    v_lshl_add_u32 v5, v2, 2, v1
    v_mul_u32_u24 v5, 1296, v5
    v_add_u32 v5, v5, v7
    v_add_u32 v5, 147456, v5
    v_bfe_u32 v87, v0, 0, 1
    v_mul_u32_u24 v87, 0xaaaa, v87
    v_add_u32 v87, 0x4444, v87
    ds_read_b64_tr_b16 v[88:89], v72 offset:0
    ds_read_b64_tr_b16 v[90:91], v73 offset:256
    ds_read_b64_tr_b16 v[92:93], v72 offset:4096
    ds_read_b64_tr_b16 v[94:95], v73 offset:4352
    ds_read_b64_tr_b16 v[96:97], v72 offset:8192
    ds_read_b64_tr_b16 v[98:99], v73 offset:8448
    ds_read_b64_tr_b16 v[100:101], v72 offset:12288
    ds_read_b64_tr_b16 v[102:103], v73 offset:12544
    ds_read_b64_tr_b16 v[104:105], v72 offset:16384
    ds_read_b64_tr_b16 v[106:107], v73 offset:16640
    ds_read_b64_tr_b16 v[108:109], v72 offset:20480
    ds_read_b64_tr_b16 v[110:111], v73 offset:20736
    ds_read_b64_tr_b16 v[112:113], v72 offset:24576
    ds_read_b64_tr_b16 v[114:115], v73 offset:24832
    ds_read_b64_tr_b16 v[116:117], v72 offset:28672
    ds_read_b64_tr_b16 v[118:119], v73 offset:28928
    ds_read_b64_tr_b16 v[120:121], v72 offset:32768
    ds_read_b64_tr_b16 v[122:123], v73 offset:33024
    ds_read_b64_tr_b16 v[124:125], v72 offset:36864
    ds_read_b64_tr_b16 v[126:127], v73 offset:37120
    ds_read_b64_tr_b16 v[128:129], v74 offset:0
    ds_read_b64_tr_b16 v[130:131], v75 offset:256
    ds_read_b64_tr_b16 v[132:133], v74 offset:4096
    ds_read_b64_tr_b16 v[134:135], v75 offset:4352
    ds_read_b64_tr_b16 v[136:137], v74 offset:8192
    ds_read_b64_tr_b16 v[138:139], v75 offset:8448
    ds_read_b64_tr_b16 v[140:141], v74 offset:12288
    ds_read_b64_tr_b16 v[142:143], v75 offset:12544
    ds_read_b64_tr_b16 v[144:145], v74 offset:16384
    ds_read_b64_tr_b16 v[146:147], v75 offset:16640
    ds_read_b64_tr_b16 v[148:149], v74 offset:20480
    ds_read_b64_tr_b16 v[150:151], v75 offset:20736
    ds_read_b64_tr_b16 v[152:153], v74 offset:24576
    ds_read_b64_tr_b16 v[154:155], v75 offset:24832
    ds_read_b64_tr_b16 v[156:157], v74 offset:28672
    ds_read_b64_tr_b16 v[158:159], v75 offset:28928
    ds_read_b64_tr_b16 v[160:161], v74 offset:32768
    ds_read_b64_tr_b16 v[162:163], v75 offset:33024
    ds_read_b64_tr_b16 v[164:165], v74 offset:36864
    ds_read_b64_tr_b16 v[166:167], v75 offset:37120
    ds_read_b128 v[8:11], v5 offset:0
    ds_read_b128 v[12:15], v5 offset:128
    ds_read_b128 v[16:19], v5 offset:256
    ds_read_b128 v[20:23], v5 offset:384
    ds_read_b128 v[24:27], v5 offset:512
    ds_read_b128 v[28:31], v5 offset:640
    ds_read_b128 v[32:35], v5 offset:768
    ds_read_b128 v[36:39], v5 offset:896
    ds_read_b128 v[40:43], v5 offset:1024
    ds_read_b128 v[44:47], v5 offset:1152
    v_mov_b32 v48, 0
    v_mov_b32 v49, 0
    v_mov_b32 v50, 0
    v_mov_b32 v51, 0
    v_mov_b32 v52, 0
    v_mov_b32 v53, 0
    v_mov_b32 v54, 0
    v_mov_b32 v55, 0
    v_mov_b32 v56, 0
    v_mov_b32 v57, 0
    v_mov_b32 v58, 0
    v_mov_b32 v59, 0
    s_waitcnt lgkmcnt(9)
    v_smfmac_f32_16x16x64_bf16 v[48:51], v[8:11], v[88:95], v87
    s_waitcnt lgkmcnt(8)
    v_smfmac_f32_16x16x64_bf16 v[48:51], v[12:15], v[96:103], v87
    s_waitcnt lgkmcnt(7)
    v_smfmac_f32_16x16x64_bf16 v[48:51], v[16:19], v[104:111], v87
    s_waitcnt lgkmcnt(6)
    v_smfmac_f32_16x16x64_bf16 v[48:51], v[20:23], v[112:119], v87
    s_waitcnt lgkmcnt(5)
    v_smfmac_f32_16x16x64_bf16 v[48:51], v[24:27], v[120:127], v87
    s_waitcnt lgkmcnt(4)
    v_smfmac_f32_16x16x64_bf16 v[48:51], v[28:31], v[128:135], v87
    s_waitcnt lgkmcnt(3)
    v_smfmac_f32_16x16x64_bf16 v[48:51], v[32:35], v[136:143], v87
    s_waitcnt lgkmcnt(2)
    v_smfmac_f32_16x16x64_bf16 v[48:51], v[36:39], v[144:151], v87
    s_waitcnt lgkmcnt(1)
    v_smfmac_f32_16x16x64_bf16 v[48:51], v[40:43], v[152:159], v87
    s_waitcnt lgkmcnt(0)
    v_smfmac_f32_16x16x64_bf16 v[48:51], v[44:47], v[160:167], v87
    v_mul_u32_u24 v79, 1296, v1
    v_lshl_add_u32 v79, v2, 7, v79
    v_add_u32 v79, v79, v7
    v_add_u32 v79, 82944, v79
    v_mul_u32_u24 v80, 144, v3
    v_add3_u32 v80, v80, v4, s63
    v_add_u32 v80, 90688, v80
    v_lshlrev_b32 v81, 3, v0
    v_add_u32 v81, 88128, v81
    v_add_f32 v84, v48, v49
    v_add_f32 v85, v50, v51
    s_mov_b32 s62, 0xbacccccd
    s_mov_b32 s63, 0xbdd2d3e8
    v_mov_b32 v86, 0xc0135761
    s_waitcnt vmcnt(0)
    v_lshlrev_b32 v82, 16, v82
    v_add_f32 v85, v85, v82
    s_branch L_ffn1
L_fin_prep:
    s_cmp_lg_u32 s3, 6
    s_cbranch_scc1 L_end
    s_cmp_ge_u32 s35, 20
    s_cbranch_scc1 L_end
    s_barrier
L_fin:
    s_mov_b32 s52, s28
    s_mov_b32 s53, s29
    s_mov_b32 s54, 5120
    s_mov_b32 s55, 0x20000
    s_mov_b64 s[4:5], -1
    s_mov_b64 s[6:7], -1
    s_mov_b64 s[8:9], -1
    s_mov_b64 s[10:11], 0xffffff
    s_barrier
    ds_read_b128 v[108:111], v77
    s_barrier
L_yg:
    s_mov_b64 exec, s[4:5]
    buffer_load_dwordx4 v[88:91], v72, s[40:43], 0 offen sc1
    s_mov_b64 exec, s[6:7]
    buffer_load_dwordx4 v[92:95], v73, s[40:43], 0 offen sc1
    s_mov_b64 exec, s[8:9]
    buffer_load_dwordx4 v[96:99], v74, s[40:43], 0 offen sc1
    s_mov_b64 exec, s[10:11]
    buffer_load_dwordx4 v[100:103], v75, s[40:43], 0 offen sc1
    s_mov_b64 exec, -1
    s_sub_u32 s60, s60, 1
    s_cbranch_scc1 L_ygt
    s_waitcnt vmcnt(3)
    v_max3_u32 v3, v88, v89, v90
    v_max_u32 v3, v3, v91
    v_cmp_eq_u32 s[4:5], -1, v3
    s_waitcnt vmcnt(2)
    v_max3_u32 v3, v92, v93, v94
    v_max_u32 v3, v3, v95
    v_cmp_eq_u32 s[6:7], -1, v3
    s_waitcnt vmcnt(1)
    v_max3_u32 v3, v96, v97, v98
    v_max_u32 v3, v3, v99
    v_cmp_eq_u32 s[8:9], -1, v3
    s_waitcnt vmcnt(0)
    v_max3_u32 v3, v100, v101, v102
    v_max_u32 v3, v3, v103
    v_cmp_eq_u32 s[10:11], -1, v3
    s_or_b64 s[16:17], s[4:5], s[6:7]
    s_or_b64 s[16:17], s[16:17], s[8:9]
    s_or_b64 s[16:17], s[16:17], s[10:11]
    s_cbranch_scc1 L_yg
L_ygd:
    v_mfma_f32_16x16x32_bf16 v[112:115], v[104:107], v[88:91], 0
    v_mfma_f32_16x16x32_bf16 v[112:115], v[104:107], v[92:95], v[112:115]
    v_mfma_f32_16x16x32_bf16 v[112:115], v[104:107], v[96:99], v[112:115]
    v_mfma_f32_16x16x32_bf16 v[112:115], v[104:107], v[100:103], v[112:115]
    s_waitcnt lgkmcnt(0)
    v_pk_fma_f32 v[108:109], v[78:79], v[82:83], v[108:109]
    v_pk_fma_f32 v[110:111], v[80:81], v[84:85], v[110:111]
    s_nop 4
    v_add_f32_dpp v112, v112, v112 row_ror:8 row_mask:0xf bank_mask:0xf
    v_add_f32_dpp v113, v113, v113 row_ror:8 row_mask:0xf bank_mask:0xf
    v_add_f32_dpp v114, v114, v114 row_ror:8 row_mask:0xf bank_mask:0xf
    v_add_f32_dpp v115, v115, v115 row_ror:8 row_mask:0xf bank_mask:0xf
    v_pk_fma_f32 v[112:113], v[112:113], v[82:83], v[108:109]
    v_pk_fma_f32 v[114:115], v[114:115], v[84:85], v[110:111]
    v_cvt_pk_bf16_f32 v112, v112, v113
    v_cvt_pk_bf16_f32 v113, v114, v115
    s_mov_b64 exec, 0x00ff00ff
    buffer_store_dwordx2 v[112:113], v76, s[52:55], s57 offen
    s_endpgm
L_t2gate:
    v_mov_b32 v8, 162048
L_lw_121:
    ds_read_b32 v9, v8
    s_waitcnt lgkmcnt(0)
    v_cmp_gt_u32 vcc, 8, v9
    s_cbranch_vccz L_lw_121e
    s_sleep 2
    s_sub_u32 s60, s60, 1
    s_cbranch_scc0 L_lw_121
    s_mov_b32 s60, 0
L_lw_121e:
    ds_read_b32 v9, v8 offset:24
    ds_read_b32 v10, v8 offset:36
    v_add_u32 v5, 196608, v5
    s_waitcnt lgkmcnt(0)
    v_readfirstlane_b32 s61, v9
    v_add_u32 v5, v5, v10
    s_mov_b32 s58, 0x3f80
    s_mov_b32 s59, 0x3f800000
    s_mov_b32 s63, 0xff
L_prb:
    s_bcnt1_i32_b32 s62, s63
    s_mov_b32 s97, s63
    s_ff1_i32_b32 s12, s97
    s_bitset0_b32 s97, s12
    s_mul_i32 s4, s12, 5120
    s_add_u32 s4, s4, s56
    s_and_b32 s96, s4, 0xffffe000
    s_add_u32 s4, s4, s96
    s_cmp_eq_u32 s62, 1
    s_cbranch_scc1 L_pi1
    s_ff1_i32_b32 s13, s97
    s_bitset0_b32 s97, s13
    s_mul_i32 s5, s13, 5120
    s_add_u32 s5, s5, s56
    s_and_b32 s96, s5, 0xffffe000
    s_add_u32 s5, s5, s96
    s_cmp_eq_u32 s62, 2
    s_cbranch_scc1 L_pi2
    s_ff1_i32_b32 s14, s97
    s_bitset0_b32 s97, s14
    s_mul_i32 s6, s14, 5120
    s_add_u32 s6, s6, s56
    s_and_b32 s96, s6, 0xffffe000
    s_add_u32 s6, s6, s96
    s_cmp_eq_u32 s62, 3
    s_cbranch_scc1 L_pi3
    s_ff1_i32_b32 s15, s97
    s_bitset0_b32 s97, s15
    s_mul_i32 s7, s15, 5120
    s_add_u32 s7, s7, s56
    s_and_b32 s96, s7, 0xffffe000
    s_add_u32 s7, s7, s96
    s_cmp_eq_u32 s62, 4
    s_cbranch_scc1 L_pi4
    s_ff1_i32_b32 s16, s97
    s_bitset0_b32 s97, s16
    s_mul_i32 s8, s16, 5120
    s_add_u32 s8, s8, s56
    s_and_b32 s96, s8, 0xffffe000
    s_add_u32 s8, s8, s96
    s_cmp_eq_u32 s62, 5
    s_cbranch_scc1 L_pi5
    s_ff1_i32_b32 s17, s97
    s_bitset0_b32 s97, s17
    s_mul_i32 s9, s17, 5120
    s_add_u32 s9, s9, s56
    s_and_b32 s96, s9, 0xffffe000
    s_add_u32 s9, s9, s96
    s_cmp_eq_u32 s62, 6
    s_cbranch_scc1 L_pi6
    s_ff1_i32_b32 s18, s97
    s_bitset0_b32 s97, s18
    s_mul_i32 s10, s18, 5120
    s_add_u32 s10, s10, s56
    s_and_b32 s96, s10, 0xffffe000
    s_add_u32 s10, s10, s96
    s_cmp_eq_u32 s62, 7
    s_cbranch_scc1 L_pi7
    s_ff1_i32_b32 s19, s97
    s_bitset0_b32 s97, s19
    s_mul_i32 s11, s19, 5120
    s_add_u32 s11, s11, s56
    s_and_b32 s96, s11, 0xffffe000
    s_add_u32 s11, s11, s96
L_pi8:
    buffer_load_dwordx4 v[36:39], v5, s[40:43], s11 offen sc1
L_pi7:
    buffer_load_dwordx4 v[32:35], v5, s[40:43], s10 offen sc1
L_pi6:
    buffer_load_dwordx4 v[28:31], v5, s[40:43], s9 offen sc1
L_pi5:
    buffer_load_dwordx4 v[24:27], v5, s[40:43], s8 offen sc1
L_pi4:
    buffer_load_dwordx4 v[20:23], v5, s[40:43], s7 offen sc1
L_pi3:
    buffer_load_dwordx4 v[16:19], v5, s[40:43], s6 offen sc1
L_pi2:
    buffer_load_dwordx4 v[12:15], v5, s[40:43], s5 offen sc1
    buffer_load_dwordx4 v[8:11], v5, s[40:43], s4 offen sc1
    s_sub_u32 s60, s60, 1
    s_cbranch_scc1 L_pto
    s_waitcnt vmcnt(0)
    v_max3_u32 v3, v8, v9, v10
    v_max_u32 v3, v3, v11
    v_cmp_eq_u32 vcc, -1, v3
    s_cbranch_vccz L_pgot0
    v_max3_u32 v3, v12, v13, v14
    v_max_u32 v3, v3, v15
    v_cmp_eq_u32 vcc, -1, v3
    s_cbranch_vccz L_pgot1
    s_cmp_eq_u32 s62, 2
    s_cbranch_scc1 L_pi2
    v_max3_u32 v3, v16, v17, v18
    v_max_u32 v3, v3, v19
    v_cmp_eq_u32 vcc, -1, v3
    s_cbranch_vccz L_pgot2
    s_cmp_eq_u32 s62, 3
    s_cbranch_scc1 L_pi3
    v_max3_u32 v3, v20, v21, v22
    v_max_u32 v3, v3, v23
    v_cmp_eq_u32 vcc, -1, v3
    s_cbranch_vccz L_pgot3
    s_cmp_eq_u32 s62, 4
    s_cbranch_scc1 L_pi4
    v_max3_u32 v3, v24, v25, v26
    v_max_u32 v3, v3, v27
    v_cmp_eq_u32 vcc, -1, v3
    s_cbranch_vccz L_pgot4
    s_cmp_eq_u32 s62, 5
    s_cbranch_scc1 L_pi5
    v_max3_u32 v3, v28, v29, v30
    v_max_u32 v3, v3, v31
    v_cmp_eq_u32 vcc, -1, v3
    s_cbranch_vccz L_pgot5
    s_cmp_eq_u32 s62, 6
    s_cbranch_scc1 L_pi6
    v_max3_u32 v3, v32, v33, v34
    v_max_u32 v3, v3, v35
    v_cmp_eq_u32 vcc, -1, v3
    s_cbranch_vccz L_pgot6
    s_cmp_eq_u32 s62, 7
    s_cbranch_scc1 L_pi7
    v_max3_u32 v3, v36, v37, v38
    v_max_u32 v3, v3, v39
    v_cmp_eq_u32 vcc, -1, v3
    s_cbranch_vccz L_pgot7
    s_branch L_pi8
L_pgot0:
    v_dot2c_f32_bf16 v64, s58, v8
    v_dot2c_f32_bf16 v65, s59, v8
    v_dot2c_f32_bf16 v66, s58, v9
    v_dot2c_f32_bf16 v67, s59, v9
    v_dot2c_f32_bf16 v68, s58, v10
    v_dot2c_f32_bf16 v69, s59, v10
    v_dot2c_f32_bf16 v70, s58, v11
    v_dot2c_f32_bf16 v71, s59, v11
    s_bitset0_b32 s63, s12
    s_cmp_eq_u32 s63, 0
    s_cbranch_scc1 L_pgd
L_pn0:
    s_cmp_eq_u32 s62, 1
    s_cbranch_scc1 L_prb
    v_max3_u32 v3, v12, v13, v14
    v_max_u32 v3, v3, v15
    v_cmp_eq_u32 vcc, -1, v3
    s_cbranch_vccnz L_pn1
L_pgot1:
    v_dot2c_f32_bf16 v64, s58, v12
    v_dot2c_f32_bf16 v65, s59, v12
    v_dot2c_f32_bf16 v66, s58, v13
    v_dot2c_f32_bf16 v67, s59, v13
    v_dot2c_f32_bf16 v68, s58, v14
    v_dot2c_f32_bf16 v69, s59, v14
    v_dot2c_f32_bf16 v70, s58, v15
    v_dot2c_f32_bf16 v71, s59, v15
    s_bitset0_b32 s63, s13
    s_cmp_eq_u32 s63, 0
    s_cbranch_scc1 L_pgd
L_pn1:
    s_cmp_eq_u32 s62, 2
    s_cbranch_scc1 L_prb
    v_max3_u32 v3, v16, v17, v18
    v_max_u32 v3, v3, v19
    v_cmp_eq_u32 vcc, -1, v3
    s_cbranch_vccnz L_pn2
L_pgot2:
    v_dot2c_f32_bf16 v64, s58, v16
    v_dot2c_f32_bf16 v65, s59, v16
    v_dot2c_f32_bf16 v66, s58, v17
    v_dot2c_f32_bf16 v67, s59, v17
    v_dot2c_f32_bf16 v68, s58, v18
    v_dot2c_f32_bf16 v69, s59, v18
    v_dot2c_f32_bf16 v70, s58, v19
    v_dot2c_f32_bf16 v71, s59, v19
    s_bitset0_b32 s63, s14
    s_cmp_eq_u32 s63, 0
    s_cbranch_scc1 L_pgd
L_pn2:
    s_cmp_eq_u32 s62, 3
    s_cbranch_scc1 L_prb
    v_max3_u32 v3, v20, v21, v22
    v_max_u32 v3, v3, v23
    v_cmp_eq_u32 vcc, -1, v3
    s_cbranch_vccnz L_pn3
L_pgot3:
    v_dot2c_f32_bf16 v64, s58, v20
    v_dot2c_f32_bf16 v65, s59, v20
    v_dot2c_f32_bf16 v66, s58, v21
    v_dot2c_f32_bf16 v67, s59, v21
    v_dot2c_f32_bf16 v68, s58, v22
    v_dot2c_f32_bf16 v69, s59, v22
    v_dot2c_f32_bf16 v70, s58, v23
    v_dot2c_f32_bf16 v71, s59, v23
    s_bitset0_b32 s63, s15
    s_cmp_eq_u32 s63, 0
    s_cbranch_scc1 L_pgd
L_pn3:
    s_cmp_eq_u32 s62, 4
    s_cbranch_scc1 L_prb
    v_max3_u32 v3, v24, v25, v26
    v_max_u32 v3, v3, v27
    v_cmp_eq_u32 vcc, -1, v3
    s_cbranch_vccnz L_pn4
L_pgot4:
    v_dot2c_f32_bf16 v64, s58, v24
    v_dot2c_f32_bf16 v65, s59, v24
    v_dot2c_f32_bf16 v66, s58, v25
    v_dot2c_f32_bf16 v67, s59, v25
    v_dot2c_f32_bf16 v68, s58, v26
    v_dot2c_f32_bf16 v69, s59, v26
    v_dot2c_f32_bf16 v70, s58, v27
    v_dot2c_f32_bf16 v71, s59, v27
    s_bitset0_b32 s63, s16
    s_cmp_eq_u32 s63, 0
    s_cbranch_scc1 L_pgd
L_pn4:
    s_cmp_eq_u32 s62, 5
    s_cbranch_scc1 L_prb
    v_max3_u32 v3, v28, v29, v30
    v_max_u32 v3, v3, v31
    v_cmp_eq_u32 vcc, -1, v3
    s_cbranch_vccnz L_pn5
L_pgot5:
    v_dot2c_f32_bf16 v64, s58, v28
    v_dot2c_f32_bf16 v65, s59, v28
    v_dot2c_f32_bf16 v66, s58, v29
    v_dot2c_f32_bf16 v67, s59, v29
    v_dot2c_f32_bf16 v68, s58, v30
    v_dot2c_f32_bf16 v69, s59, v30
    v_dot2c_f32_bf16 v70, s58, v31
    v_dot2c_f32_bf16 v71, s59, v31
    s_bitset0_b32 s63, s17
    s_cmp_eq_u32 s63, 0
    s_cbranch_scc1 L_pgd
L_pn5:
    s_cmp_eq_u32 s62, 6
    s_cbranch_scc1 L_prb
    v_max3_u32 v3, v32, v33, v34
    v_max_u32 v3, v3, v35
    v_cmp_eq_u32 vcc, -1, v3
    s_cbranch_vccnz L_pn6
L_pgot6:
    v_dot2c_f32_bf16 v64, s58, v32
    v_dot2c_f32_bf16 v65, s59, v32
    v_dot2c_f32_bf16 v66, s58, v33
    v_dot2c_f32_bf16 v67, s59, v33
    v_dot2c_f32_bf16 v68, s58, v34
    v_dot2c_f32_bf16 v69, s59, v34
    v_dot2c_f32_bf16 v70, s58, v35
    v_dot2c_f32_bf16 v71, s59, v35
    s_bitset0_b32 s63, s18
    s_cmp_eq_u32 s63, 0
    s_cbranch_scc1 L_pgd
L_pn6:
    s_cmp_eq_u32 s62, 7
    s_cbranch_scc1 L_prb
    v_max3_u32 v3, v36, v37, v38
    v_max_u32 v3, v3, v39
    v_cmp_eq_u32 vcc, -1, v3
    s_cbranch_vccnz L_pn7
L_pgot7:
    v_dot2c_f32_bf16 v64, s58, v36
    v_dot2c_f32_bf16 v65, s59, v36
    v_dot2c_f32_bf16 v66, s58, v37
    v_dot2c_f32_bf16 v67, s59, v37
    v_dot2c_f32_bf16 v68, s58, v38
    v_dot2c_f32_bf16 v69, s59, v38
    v_dot2c_f32_bf16 v70, s58, v39
    v_dot2c_f32_bf16 v71, s59, v39
    s_bitset0_b32 s63, s19
    s_cmp_eq_u32 s63, 0
    s_cbranch_scc1 L_pgd
L_pn7:
    s_branch L_prb
L_pi1:
L_poll_122:
    buffer_load_dwordx4 v[8:11], v5, s[40:43], s4 offen sc1
    s_sub_u32 s60, s60, 1
    s_cbranch_scc1 L_poll_122t
    s_waitcnt vmcnt(0)
    v_max3_u32 v3, v8, v9, v10
    v_max_u32 v3, v3, v11
    v_cmp_eq_u32 vcc, -1, v3
    s_cbranch_vccnz L_poll_122
L_poll_122e:
    v_dot2c_f32_bf16 v64, s58, v8
    v_dot2c_f32_bf16 v65, s59, v8
    v_dot2c_f32_bf16 v66, s58, v9
    v_dot2c_f32_bf16 v67, s59, v9
    v_dot2c_f32_bf16 v68, s58, v10
    v_dot2c_f32_bf16 v69, s59, v10
    v_dot2c_f32_bf16 v70, s58, v11
    v_dot2c_f32_bf16 v71, s59, v11
L_pgd:
    v_pk_fma_f32 v[64:65], v[64:65], v[48:49], v[40:41]
    v_pk_fma_f32 v[66:67], v[66:67], v[50:51], v[42:43]
    v_pk_fma_f32 v[68:69], v[68:69], v[52:53], v[44:45]
    v_pk_fma_f32 v[70:71], v[70:71], v[54:55], v[46:47]
    v_pk_mul_f32 v[56:57], v[64:65], v[56:57]
    v_pk_mul_f32 v[58:59], v[66:67], v[58:59]
    v_pk_mul_f32 v[60:61], v[68:69], v[60:61]
    v_pk_mul_f32 v[62:63], v[70:71], v[62:63]
    v_cvt_pk_bf16_f32 v8, v56, v57
    v_cvt_pk_bf16_f32 v9, v58, v59
    v_cvt_pk_bf16_f32 v10, v60, v61
    v_cvt_pk_bf16_f32 v11, v62, v63
    ds_write_b128 v4, v[8:11]
    v_pk_add_f32 v[40:41], v[64:65], v[66:67]
    v_pk_add_f32 v[42:43], v[68:69], v[70:71]
    v_pk_mul_f32 v[44:45], v[64:65], v[64:65]
    v_pk_mul_f32 v[46:47], v[66:67], v[66:67]
    v_pk_add_f32 v[40:41], v[40:41], v[42:43]
    v_pk_fma_f32 v[44:45], v[68:69], v[68:69], v[44:45]
    v_pk_fma_f32 v[46:47], v[70:71], v[70:71], v[46:47]
    v_add_f32 v40, v40, v41
    v_pk_add_f32 v[44:45], v[44:45], v[46:47]
    v_add_f32 v41, v44, v45
    ds_write_b64 v7, v[40:41]
    s_waitcnt lgkmcnt(0)
    s_barrier
    v_mov_b32 v16, 0
    v_mov_b32 v17, 0
    v_mov_b32 v18, 0
    v_mov_b32 v19, 0
    v_mov_b32 v20, 0
    v_mov_b32 v21, 0
    v_mov_b32 v22, 0
    v_mov_b32 v23, 0
    v_mov_b32 v24, 0
    v_mov_b32 v25, 0
    v_mov_b32 v26, 0
    v_mov_b32 v27, 0
    v_mov_b32 v28, 0
    v_mov_b32 v29, 0
    v_mov_b32 v30, 0
    v_mov_b32 v31, 0
    v_mov_b32 v32, 0
    v_mov_b32 v33, 0
    v_mov_b32 v34, 0
    v_mov_b32 v35, 0
    ds_write_b128 v6, v[64:67]
    ds_write_b128 v6, v[68:71] offset:16
    s_waitcnt lgkmcnt(0)
    s_cmp_lg_u32 s3, 7
    s_cbranch_scc1 L_ffn2
    s_cmp_lt_u32 s35, 20
    s_cbranch_scc1 L_fin
    s_endpgm
L_ffn1:
    s_barrier
L_ffn1b:
    ds_read_b128 v[8:11], v79
    ds_read_b64 v[30:31], v81 offset:0
    ds_read_b64 v[32:33], v81 offset:512
    ds_read_b64 v[34:35], v81 offset:1024
    ds_read_b64 v[36:37], v81 offset:1536
    ds_read_b64 v[38:39], v81 offset:2048
    ds_read_b128 v[12:15], v79 offset:256
    ds_read_b128 v[16:19], v79 offset:512
    ds_read_b128 v[20:23], v79 offset:768
    ds_read_b128 v[24:27], v79 offset:1024
    s_waitcnt lgkmcnt(9)
    v_smfmac_f32_16x16x64_bf16 v[52:55], v[8:11], v[88:95], v87
    v_smfmac_f32_16x16x64_bf16 v[56:59], v[8:11], v[96:103], v87
    s_waitcnt lgkmcnt(3)
    v_smfmac_f32_16x16x64_bf16 v[52:55], v[12:15], v[104:111], v87
    v_pk_add_f32 v[30:31], v[30:31], v[32:33]
    v_pk_add_f32 v[34:35], v[34:35], v[36:37]
    v_smfmac_f32_16x16x64_bf16 v[56:59], v[12:15], v[112:119], v87
    v_pk_add_f32 v[30:31], v[30:31], v[38:39]
    v_pk_add_f32 v[30:31], v[30:31], v[34:35]
    s_nop 0
    s_waitcnt lgkmcnt(2)
    v_smfmac_f32_16x16x64_bf16 v[52:55], v[16:19], v[120:127], v87
    v_add_f32_dpp v30, v30, v30 quad_perm:[1,0,3,2] row_mask:0xf bank_mask:0xf
    v_add_f32_dpp v31, v31, v31 quad_perm:[1,0,3,2] row_mask:0xf bank_mask:0xf
    v_smfmac_f32_16x16x64_bf16 v[56:59], v[16:19], v[128:135], v87
    v_add_f32_dpp v30, v30, v30 quad_perm:[2,3,0,1] row_mask:0xf bank_mask:0xf
    v_add_f32_dpp v31, v31, v31 quad_perm:[2,3,0,1] row_mask:0xf bank_mask:0xf
    s_waitcnt lgkmcnt(1)
    v_smfmac_f32_16x16x64_bf16 v[52:55], v[20:23], v[136:143], v87
    v_add_f32_dpp v30, v30, v30 row_ror:4 row_mask:0xf bank_mask:0xf
    v_add_f32_dpp v31, v31, v31 row_ror:4 row_mask:0xf bank_mask:0xf
    v_smfmac_f32_16x16x64_bf16 v[56:59], v[20:23], v[144:151], v87
    v_add_f32_dpp v30, v30, v30 row_ror:8 row_mask:0xf bank_mask:0xf
    v_add_f32_dpp v31, v31, v31 row_ror:8 row_mask:0xf bank_mask:0xf
    s_waitcnt lgkmcnt(0)
    v_smfmac_f32_16x16x64_bf16 v[52:55], v[24:27], v[152:159], v87
    v_mul_f32 v48, s62, v30
    v_mul_f32 v49, s62, v31
    v_smfmac_f32_16x16x64_bf16 v[56:59], v[24:27], v[160:167], v87
    v_mul_f32 v7, v84, v48
    v_fma_f32 v49, -v48, v48, -v49
    v_max_f32 v49, 0, v49
    v_add_f32 v49, 0x3727c5ac, v49
    v_rsq_f32 v49, v49
    v_add_f32 v4, v52, v53
    v_add_f32 v4, v4, v7
    s_nop 0
    v_add_f32 v5, v58, v59
    v_add_f32 v4, v4, v5
    v_fma_f32 v4, v4, v49, v85
    v_mul_f32 v5, v4, v4
    v_fma_f32 v5, v5, s63, v86
    v_mul_f32 v5, v5, v4
    v_exp_f32 v5, v5
    s_nop 0
    v_add_f32 v5, 1.0, v5
    v_rcp_f32 v5, v5
    s_nop 0
    v_mul_f32 v4, v4, v5
    v_cvt_pk_bf16_f32 v4, v4, v4
    ds_write_b16 v80, v4
    s_waitcnt lgkmcnt(0)
    s_barrier
    s_endpgm
L_h_t1:
    s_cmp_lg_u32 s3, 3
    s_cbranch_scc1 L_h_noclr
    s_sub_u32 s62, s56, 154
    s_cmp_lt_u32 s62, 32
    s_cbranch_scc0 L_h_noclr
    s_lshl_b32 s63, s62, 2
    s_lshl_b32 s62, s62, 13
    s_add_u32 s62, s62, 20480
    v_mov_b32 v4, -1
    v_mov_b32 v5, -1
    v_mov_b32 v6, -1
    v_mov_b32 v7, -1
    v_lshlrev_b32 v8, 4, v0
    buffer_store_dwordx4 v[4:7], v8, s[40:43], s62 offen offset:0 sc1
    buffer_store_dwordx4 v[4:7], v8, s[40:43], s62 offen offset:1024 sc1
    buffer_store_dwordx4 v[4:7], v8, s[40:43], s62 offen offset:2048 sc1
    buffer_store_dwordx4 v[4:7], v8, s[40:43], s62 offen offset:3072 sc1
    s_add_u32 s62, s62, 4096
    buffer_store_dwordx4 v[4:7], v8, s[40:43], s62 offen offset:0 sc1
    buffer_store_dwordx4 v[4:7], v8, s[40:43], s62 offen offset:1024 sc1
    buffer_store_dwordx4 v[4:7], v8, s[40:43], s62 offen offset:2048 sc1
    buffer_store_dwordx4 v[4:7], v8, s[40:43], s62 offen offset:3072 sc1
    s_add_u32 s62, s62, 4096
    v_mov_b32 v8, s63
    s_waitcnt vmcnt(0)
    s_mov_b64 exec, 1
    buffer_store_dword v4, v8, s[44:47], 0 offen sc1
    s_mov_b64 exec, -1
L_h_noclr:
    v_lshrrev_b32 v1, 3, v0
    v_mul_u32_u24 v1, 1280, v1
    v_and_b32 v2, 7, v0
    v_lshl_add_u32 v1, v2, 4, v1
    s_lshl2_add_u32 s63, s34, s3
    s_mul_i32 s63, s63, 163840
    s_lshl_b32 s62, s35, 7
    s_add_u32 s63, s63, s62
    s_sub_u32 s63, s63, 2816
    s_lshl_b32 s62, s3, 14
    s_add_u32 s62, s62, 81920
    s_mov_b32 m0, s62
    s_mov_b32 s48, s12
    s_mov_b32 s49, s13
    s_mov_b32 s50, 5242880
    s_mov_b32 s51, 0x20000
    s_add_u32 s100, s39, 1
    s_mov_b32 s62, 8
L_dma_4:
    buffer_load_dwordx4 v1, s[48:51], s63 offen nt lds
    s_add_u32 m0, m0, 1024
    s_add_u32 s63, s63, 10240
    s_cmp_eq_u32 s100, 0
    s_cbranch_scc1 L_dma_4n0
    s_waitcnt vmcnt(7)
    s_cmp_eq_u32 s100, 2
    s_cbranch_scc1 L_dma_4n0
    s_waitcnt vmcnt(3)
L_dma_4n0:
    buffer_load_dwordx4 v1, s[48:51], s63 offen nt lds
    s_add_u32 m0, m0, 1024
    s_add_u32 s63, s63, 10240
    s_cmp_eq_u32 s100, 0
    s_cbranch_scc1 L_dma_4n1
    s_waitcnt vmcnt(7)
    s_cmp_eq_u32 s100, 2
    s_cbranch_scc1 L_dma_4n1
    s_waitcnt vmcnt(3)
L_dma_4n1:
    s_sub_u32 s62, s62, 1
    s_cmp_lg_u32 s62, 0
    s_cbranch_scc1 L_dma_4
    s_cmp_eq_u32 s39, 1
    s_cbranch_scc1 L_h_role
    s_waitcnt vmcnt(0)
    v_mov_b32 v4, 162060
    v_mov_b32 v5, 1
    s_mov_b64 exec, 1
    ds_add_u32 v4, v5
    s_mov_b64 exec, -1
    s_cmp_eq_u32 s3, 0
    s_cbranch_scc1 L_service
    s_endpgm
L_h_role:
    v_mov_b32 v72, 0
    v_mov_b32 v73, 0
    v_mov_b32 v74, 0
    v_mov_b32 v75, 0
    v_mov_b32 v76, 0
    v_lshrrev_b32 v3, 4, v0
    v_and_b32 v2, 3, v0
    v_bfe_u32 v1, v0, 2, 2
    v_mul_u32_u24 v160, 1280, v3
    v_and_b32 v4, 15, v0
    v_lshl_add_u32 v163, v4, 2, v160
    v_lshl_add_u32 v160, v4, 3, v160
    s_mul_i32 s57, s35, 5120
    s_mul_i32 s62, s3, 320
    s_add_u32 s57, s57, s62
    s_add_u32 s57, s57, 294912
    v_mov_b32 v4, -1
    v_mov_b32 v5, -1
    v_mov_b32 v6, -1
    v_mov_b32 v7, -1
    v_lshlrev_b32 v8, 4, v0
    s_mul_i32 s62, s3, 960
    s_add_u32 s62, s62, s57
    buffer_store_dwordx4 v[4:7], v8, s[40:43], s62 offen sc1
    s_mov_b64 exec, 0xffff
    buffer_store_dwordx4 v[4:7], v8, s[40:43], s62 offen offset:1024 sc1
    s_mov_b64 exec, -1
    v_add_u32 v8, 0, v0
    v_mul_u32_u24 v10, 0xccd, v8
    v_lshrrev_b32 v10, 16, v10
    v_mul_u32_u24 v9, 20, v10
    v_sub_u32 v8, v8, v9
    v_mul_u32_u24 v10, 1280, v10
    v_lshl_add_u32 v10, v8, 4, v10
    v_add_u32 v8, 64, v0
    v_mul_u32_u24 v11, 0xccd, v8
    v_lshrrev_b32 v11, 16, v11
    v_mul_u32_u24 v9, 20, v11
    v_sub_u32 v8, v8, v9
    v_mul_u32_u24 v11, 1280, v11
    v_lshl_add_u32 v11, v8, 4, v11
    v_add_u32 v8, 128, v0
    v_mul_u32_u24 v12, 0xccd, v8
    v_lshrrev_b32 v12, 16, v12
    v_mul_u32_u24 v9, 20, v12
    v_sub_u32 v8, v8, v9
    v_mul_u32_u24 v12, 1280, v12
    v_lshl_add_u32 v12, v8, 4, v12
    v_add_u32 v8, 192, v0
    v_mul_u32_u24 v13, 0xccd, v8
    v_lshrrev_b32 v13, 16, v13
    v_mul_u32_u24 v9, 20, v13
    v_sub_u32 v8, v8, v9
    v_mul_u32_u24 v13, 1280, v13
    v_lshl_add_u32 v13, v8, 4, v13
    v_add_u32 v8, 256, v0
    v_mul_u32_u24 v14, 0xccd, v8
    v_lshrrev_b32 v14, 16, v14
    v_mul_u32_u24 v9, 20, v14
    v_sub_u32 v8, v8, v9
    v_mul_u32_u24 v14, 1280, v14
    v_lshl_add_u32 v14, v8, 4, v14
    s_waitcnt vmcnt(0)
    v_mov_b32 v8, 162060
    v_mov_b32 v9, 1
    s_mov_b64 exec, 1
    ds_add_u32 v8, v9
    s_mov_b64 exec, -1
    s_mov_b32 s48, s20
    s_mov_b32 s49, s21
    s_mov_b32 s50, 2211840
    s_mov_b32 s51, 0x20000
    s_mul_i32 s63, s35, 81920
    s_mul_i32 s62, s3, 320
    s_add_u32 s63, s63, s62
    s_mov_b32 m0, s101
    s_mov_b32 s62, 4
L_w2dma:
    buffer_load_dwordx4 v10, s[48:51], s63 offen nt lds
    s_add_u32 m0, m0, 1024
    s_waitcnt vmcnt(7)
    s_cmp_ge_u32 s35, 22
    s_cbranch_scc1 L_w2n0
    s_waitcnt vmcnt(7)
L_w2n0:
    buffer_load_dwordx4 v11, s[48:51], s63 offen nt lds
    s_add_u32 m0, m0, 1024
    s_waitcnt vmcnt(7)
    s_cmp_ge_u32 s35, 22
    s_cbranch_scc1 L_w2n1
    s_waitcnt vmcnt(7)
L_w2n1:
    buffer_load_dwordx4 v12, s[48:51], s63 offen nt lds
    s_add_u32 m0, m0, 1024
    s_waitcnt vmcnt(7)
    s_cmp_ge_u32 s35, 22
    s_cbranch_scc1 L_w2n2
    s_waitcnt vmcnt(7)
L_w2n2:
    buffer_load_dwordx4 v13, s[48:51], s63 offen nt lds
    s_add_u32 m0, m0, 1024
    s_waitcnt vmcnt(7)
    s_cmp_ge_u32 s35, 22
    s_cbranch_scc1 L_w2n3
    s_waitcnt vmcnt(7)
L_w2n3:
    buffer_load_dwordx4 v14, s[48:51], s63 offen nt lds
    s_add_u32 m0, m0, 1024
    s_waitcnt vmcnt(7)
    s_cmp_ge_u32 s35, 22
    s_cbranch_scc1 L_w2n4
    s_waitcnt vmcnt(7)
L_w2n4:
    s_add_u32 s63, s63, 20480
    s_sub_u32 s62, s62, 1
    s_cmp_lg_u32 s62, 0
    s_cbranch_scc1 L_w2dma
    v_lshrrev_b32 v8, 5, v0
    v_lshlrev_b32 v8, 2, v8
    v_bfe_u32 v9, v0, 4, 1
    v_add_u32 v8, v8, v9
    v_mul_u32_u24 v8, 1280, v8
    v_add_u32 v8, s101, v8
    v_and_b32 v10, 15, v0
    v_lshl_add_u32 v9, v10, 2, v8
    v_lshl_add_u32 v8, v10, 3, v8
    s_mov_b32 s62, 0x05040100
    s_mov_b32 s63, 0x07060302
    s_waitcnt vmcnt(0)
    ds_read_b64 v[16:17], v8 offset:0
    ds_read_b64 v[18:19], v8 offset:320
    ds_read_b64 v[20:21], v8 offset:2560
    ds_read_b64 v[22:23], v8 offset:2880
    ds_read_b64 v[24:25], v8 offset:640
    ds_read_b64 v[26:27], v8 offset:960
    ds_read_b64 v[28:29], v8 offset:3200
    ds_read_b64 v[30:31], v8 offset:3520
    ds_read_b64 v[32:33], v8 offset:10240
    ds_read_b64 v[34:35], v8 offset:10560
    ds_read_b64 v[36:37], v8 offset:12800
    ds_read_b64 v[38:39], v8 offset:13120
    ds_read_b64 v[40:41], v8 offset:10880
    ds_read_b64 v[42:43], v8 offset:11200
    ds_read_b64 v[44:45], v8 offset:13440
    ds_read_b64 v[46:47], v8 offset:13760
    s_waitcnt lgkmcnt(0)
    v_perm_b32 v80, v18, v16, s62
    v_perm_b32 v88, v18, v16, s63
    v_perm_b32 v96, v19, v17, s62
    v_perm_b32 v104, v19, v17, s63
    v_perm_b32 v81, v22, v20, s62
    v_perm_b32 v89, v22, v20, s63
    v_perm_b32 v97, v23, v21, s62
    v_perm_b32 v105, v23, v21, s63
    v_perm_b32 v82, v26, v24, s62
    v_perm_b32 v90, v26, v24, s63
    v_perm_b32 v98, v27, v25, s62
    v_perm_b32 v106, v27, v25, s63
    v_perm_b32 v83, v30, v28, s62
    v_perm_b32 v91, v30, v28, s63
    v_perm_b32 v99, v31, v29, s62
    v_perm_b32 v107, v31, v29, s63
    v_perm_b32 v84, v34, v32, s62
    v_perm_b32 v92, v34, v32, s63
    v_perm_b32 v100, v35, v33, s62
    v_perm_b32 v108, v35, v33, s63
    v_perm_b32 v85, v38, v36, s62
    v_perm_b32 v93, v38, v36, s63
    v_perm_b32 v101, v39, v37, s62
    v_perm_b32 v109, v39, v37, s63
    v_perm_b32 v86, v42, v40, s62
    v_perm_b32 v94, v42, v40, s63
    v_perm_b32 v102, v43, v41, s62
    v_perm_b32 v110, v43, v41, s63
    v_perm_b32 v87, v46, v44, s62
    v_perm_b32 v95, v46, v44, s63
    v_perm_b32 v103, v47, v45, s62
    v_perm_b32 v111, v47, v45, s63
    ds_read_b64 v[16:17], v8 offset:128
    ds_read_b64 v[18:19], v8 offset:448
    ds_read_b64 v[20:21], v8 offset:2688
    ds_read_b64 v[22:23], v8 offset:3008
    ds_read_b64 v[24:25], v8 offset:768
    ds_read_b64 v[26:27], v8 offset:1088
    ds_read_b64 v[28:29], v8 offset:3328
    ds_read_b64 v[30:31], v8 offset:3648
    ds_read_b64 v[32:33], v8 offset:10368
    ds_read_b64 v[34:35], v8 offset:10688
    ds_read_b64 v[36:37], v8 offset:12928
    ds_read_b64 v[38:39], v8 offset:13248
    ds_read_b64 v[40:41], v8 offset:11008
    ds_read_b64 v[42:43], v8 offset:11328
    ds_read_b64 v[44:45], v8 offset:13568
    ds_read_b64 v[46:47], v8 offset:13888
    s_waitcnt lgkmcnt(0)
    v_perm_b32 v112, v18, v16, s62
    v_perm_b32 v120, v18, v16, s63
    v_perm_b32 v128, v19, v17, s62
    v_perm_b32 v136, v19, v17, s63
    v_perm_b32 v113, v22, v20, s62
    v_perm_b32 v121, v22, v20, s63
    v_perm_b32 v129, v23, v21, s62
    v_perm_b32 v137, v23, v21, s63
    v_perm_b32 v114, v26, v24, s62
    v_perm_b32 v122, v26, v24, s63
    v_perm_b32 v130, v27, v25, s62
    v_perm_b32 v138, v27, v25, s63
    v_perm_b32 v115, v30, v28, s62
    v_perm_b32 v123, v30, v28, s63
    v_perm_b32 v131, v31, v29, s62
    v_perm_b32 v139, v31, v29, s63
    v_perm_b32 v116, v34, v32, s62
    v_perm_b32 v124, v34, v32, s63
    v_perm_b32 v132, v35, v33, s62
    v_perm_b32 v140, v35, v33, s63
    v_perm_b32 v117, v38, v36, s62
    v_perm_b32 v125, v38, v36, s63
    v_perm_b32 v133, v39, v37, s62
    v_perm_b32 v141, v39, v37, s63
    v_perm_b32 v118, v42, v40, s62
    v_perm_b32 v126, v42, v40, s63
    v_perm_b32 v134, v43, v41, s62
    v_perm_b32 v142, v43, v41, s63
    v_perm_b32 v119, v46, v44, s62
    v_perm_b32 v127, v46, v44, s63
    v_perm_b32 v135, v47, v45, s62
    v_perm_b32 v143, v47, v45, s63
    ds_read_b32 v16, v9 offset:256
    ds_read_b32 v18, v9 offset:576
    ds_read_b32 v20, v9 offset:2816
    ds_read_b32 v22, v9 offset:3136
    ds_read_b32 v24, v9 offset:896
    ds_read_b32 v26, v9 offset:1216
    ds_read_b32 v28, v9 offset:3456
    ds_read_b32 v30, v9 offset:3776
    ds_read_b32 v32, v9 offset:10496
    ds_read_b32 v34, v9 offset:10816
    ds_read_b32 v36, v9 offset:13056
    ds_read_b32 v38, v9 offset:13376
    ds_read_b32 v40, v9 offset:11136
    ds_read_b32 v42, v9 offset:11456
    ds_read_b32 v44, v9 offset:13696
    ds_read_b32 v46, v9 offset:14016
    s_waitcnt lgkmcnt(0)
    v_perm_b32 v144, v18, v16, s62
    v_perm_b32 v152, v18, v16, s63
    v_perm_b32 v145, v22, v20, s62
    v_perm_b32 v153, v22, v20, s63
    v_perm_b32 v146, v26, v24, s62
    v_perm_b32 v154, v26, v24, s63
    v_perm_b32 v147, v30, v28, s62
    v_perm_b32 v155, v30, v28, s63
    v_perm_b32 v148, v34, v32, s62
    v_perm_b32 v156, v34, v32, s63
    v_perm_b32 v149, v38, v36, s62
    v_perm_b32 v157, v38, v36, s63
    v_perm_b32 v150, v42, v40, s62
    v_perm_b32 v158, v42, v40, s63
    v_perm_b32 v151, v46, v44, s62
    v_perm_b32 v159, v46, v44, s63
    s_mov_b32 s48, s16
    s_mov_b32 s49, s17
    s_mov_b32 s50, 2211840
    s_mov_b32 s51, 0x20000
    s_lshl_b32 s98, s35, 7
    s_mov_b32 s99, 3456
    v_lshrrev_b32 v9, 3, v0
    v_mul_lo_u32 v10, v9, s99
    v_and_b32 v9, 2, v9
    v_xor_b32 v9, v9, v0
    v_and_b32 v9, 7, v9
    v_lshl_add_u32 v10, v9, 4, v10
    v_add_u32 v10, s98, v10
    v_xor_b32 v11, 64, v10
    s_mul_i32 s63, s3, 552960
    s_mov_b32 m0, s101
    s_waitcnt lgkmcnt(0)
    s_cmp_ge_u32 s35, 22
    s_cselect_b32 s100, 2, 1
    s_mov_b32 s62, 10
L_dma_5:
    buffer_load_dwordx4 v10, s[48:51], s63 offen nt lds
    s_add_u32 m0, m0, 1024
    s_add_u32 s63, s63, 27648
    s_cmp_eq_u32 s100, 0
    s_cbranch_scc1 L_dma_5n0
    s_waitcnt vmcnt(7)
    s_cmp_eq_u32 s100, 2
    s_cbranch_scc1 L_dma_5n0
    s_waitcnt vmcnt(7)
L_dma_5n0:
    buffer_load_dwordx4 v11, s[48:51], s63 offen nt lds
    s_add_u32 m0, m0, 1024
    s_add_u32 s63, s63, 27648
    s_cmp_eq_u32 s100, 0
    s_cbranch_scc1 L_dma_5n1
    s_waitcnt vmcnt(7)
    s_cmp_eq_u32 s100, 2
    s_cbranch_scc1 L_dma_5n1
    s_waitcnt vmcnt(7)
L_dma_5n1:
    s_sub_u32 s62, s62, 1
    s_cmp_lg_u32 s62, 0
    s_cbranch_scc1 L_dma_5
    v_mov_b32 v8, 162068
L_lw_6:
    ds_read_b32 v9, v8
    s_waitcnt lgkmcnt(0)
    v_cmp_gt_u32 vcc, 1, v9
    s_cbranch_vccz L_lw_6e
    s_sleep 8
    s_sub_u32 s60, s60, 1
    s_cbranch_scc0 L_lw_6
    s_mov_b32 s60, 0
L_lw_6e:
    s_cmp_lg_u32 s3, 3
    s_cbranch_scc1 L_h_nomo
    v_and_b32 v4, 15, v0
    v_lshlrev_b32 v4, 4, v4
    v_mul_u32_u24 v5, 1280, v3
    v_add_u32 v5, v5, v4
    v_mul_u32_u24 v6, 1296, v3
    v_add_u32 v6, v6, v4
    v_add_u32 v6, 147456, v6
    s_mov_b32 s62, 30720
    s_mov_b32 s63, 25600
    s_branch L_poll_7
L_poll_7s:
    s_sleep 8
L_poll_7:
    buffer_load_dwordx4 v[40:43], v5, s[40:43], s62 offen offset:0 sc1
    buffer_load_dwordx4 v[44:47], v5, s[40:43], s62 offen offset:256 sc1
    buffer_load_dwordx4 v[48:51], v5, s[40:43], s62 offen offset:512 sc1
    buffer_load_dwordx4 v[52:55], v5, s[40:43], s62 offen offset:768 sc1
    buffer_load_dwordx4 v[56:59], v5, s[40:43], s62 offen offset:1024 sc1
    buffer_load_dwordx4 v[60:63], v5, s[40:43], s63 offen offset:0 sc1
    buffer_load_dwordx4 v[64:67], v5, s[40:43], s63 offen offset:256 sc1
    buffer_load_dwordx4 v[68:71], v5, s[40:43], s63 offen offset:512 sc1
    buffer_load_dwordx4 v[72:75], v5, s[40:43], s63 offen offset:768 sc1
    buffer_load_dwordx4 v[76:79], v5, s[40:43], s63 offen offset:1024 sc1
    s_sub_u32 s60, s60, 1
    s_cbranch_scc1 L_poll_7t
    s_waitcnt vmcnt(0)
    v_max3_u32 v7, v40, v41, v42
    v_max3_u32 v7, v7, v43, v44
    v_max3_u32 v7, v7, v45, v46
    v_max3_u32 v7, v7, v47, v48
    v_max3_u32 v7, v7, v49, v50
    v_max3_u32 v7, v7, v51, v52
    v_max3_u32 v7, v7, v53, v54
    v_max3_u32 v7, v7, v55, v56
    v_max3_u32 v7, v7, v57, v58
    v_max3_u32 v7, v7, v59, v60
    v_max3_u32 v7, v7, v61, v62
    v_max3_u32 v7, v7, v63, v64
    v_max3_u32 v7, v7, v65, v66
    v_max3_u32 v7, v7, v67, v68
    v_max3_u32 v7, v7, v69, v70
    v_max3_u32 v7, v7, v71, v72
    v_max3_u32 v7, v7, v73, v74
    v_max3_u32 v7, v7, v75, v76
    v_max3_u32 v7, v7, v77, v78
    v_max_u32 v7, v7, v79
    v_cmp_eq_u32 vcc, -1, v7
    s_cbranch_vccnz L_poll_7s
L_poll_7e:
    ds_write_b128 v6, v[40:43] offset:0
    ds_write_b128 v6, v[44:47] offset:256
    ds_write_b128 v6, v[48:51] offset:512
    ds_write_b128 v6, v[52:55] offset:768
    ds_write_b128 v6, v[56:59] offset:1024
    ds_write_b128 v6, v[60:63] offset:5184
    ds_write_b128 v6, v[64:67] offset:5440
    ds_write_b128 v6, v[68:71] offset:5696
    ds_write_b128 v6, v[72:75] offset:5952
    ds_write_b128 v6, v[76:79] offset:6208
L_h_nomo:
    v_mul_u32_u24 v4, 144, v1
    v_lshl_add_u32 v4, v3, 5, v4
    v_bfe_u32 v5, v0, 1, 1
    v_lshl_add_u32 v4, v5, 4, v4
    v_add_u32 v4, 90688, v4
    v_mov_b32 v5, 162112
    v_and_b32 v6, 1, v0
    v_cmp_eq_u32 vcc, 0, v6
    s_nop 1
    v_cndmask_b32 v161, v5, v4, vcc
    v_cndmask_b32 v162, v4, v5, vcc
    v_bfe_u32 v164, v0, 1, 1
    v_mul_u32_u24 v164, 0xaaaa, v164
    v_add_u32 v164, 0x4444, v164
    s_mov_b32 s100, s3
    s_lshl_b32 s63, s100, 8
    v_and_b32 v8, 15, v0
    v_lshl_add_u32 v8, v8, 4, s63
    v_lshrrev_b32 v9, 4, v0
    v_mul_u32_u24 v5, 1280, v9
    v_add_u32 v5, v5, v8
    v_mul_u32_u24 v4, 1296, v9
    v_add_u32 v4, v4, v8
    v_add_u32 v4, 82944, v4
    v_lshlrev_b32 v6, 1, v5
    v_add_u32 v6, 99328, v6
    s_lshl_b32 s62, s100, 9
    s_add_u32 s62, s62, 88128
    v_lshl_add_u32 v7, v0, 3, s62
    s_mov_b32 s48, s4
    s_mov_b32 s49, s5
    s_mov_b32 s50, 5120
    s_mov_b32 s51, 0x20000
    buffer_load_dwordx4 v[8:11], v5, s[48:51], 0 offen
    s_mov_b32 s62, 20480
    s_mov_b32 s63, 30720
    s_branch L_poll_8
L_poll_8s:
    s_sleep 8
L_poll_8:
    buffer_load_dwordx4 v[12:15], v5, s[40:43], s62 offen sc1
    buffer_load_dwordx4 v[16:19], v5, s[40:43], s63 offen sc1
    s_sub_u32 s60, s60, 1
    s_cbranch_scc1 L_poll_8t
    s_waitcnt vmcnt(0)
    v_max3_u32 v38, v12, v13, v14
    v_max3_u32 v38, v38, v15, v16
    v_max3_u32 v38, v38, v17, v18
    v_max_u32 v38, v38, v19
    v_cmp_eq_u32 vcc, -1, v38
    s_cbranch_vccnz L_poll_8s
L_poll_8e:
    v_lshlrev_b32 v40, 16, v8
    v_and_b32 v41, 0xffff0000, v8
    v_lshlrev_b32 v42, 16, v9
    v_and_b32 v43, 0xffff0000, v9
    v_lshlrev_b32 v44, 16, v10
    v_and_b32 v45, 0xffff0000, v10
    v_lshlrev_b32 v46, 16, v11
    v_and_b32 v47, 0xffff0000, v11
    v_lshlrev_b32 v48, 16, v12
    v_and_b32 v49, 0xffff0000, v12
    v_lshlrev_b32 v50, 16, v13
    v_and_b32 v51, 0xffff0000, v13
    v_lshlrev_b32 v52, 16, v14
    v_and_b32 v53, 0xffff0000, v14
    v_lshlrev_b32 v54, 16, v15
    v_and_b32 v55, 0xffff0000, v15
    v_lshlrev_b32 v56, 16, v16
    v_and_b32 v57, 0xffff0000, v16
    v_lshlrev_b32 v58, 16, v17
    v_and_b32 v59, 0xffff0000, v17
    v_lshlrev_b32 v60, 16, v18
    v_and_b32 v61, 0xffff0000, v18
    v_lshlrev_b32 v62, 16, v19
    v_and_b32 v63, 0xffff0000, v19
    v_mov_b32 v64, 0
    v_mov_b32 v65, 0
    v_mov_b32 v66, 0
    v_mov_b32 v67, 0
    v_mov_b32 v68, 0
    v_mov_b32 v69, 0
    v_mov_b32 v70, 0
    v_mov_b32 v71, 0
    v_bfe_u32 v5, v0, 2, 2
    v_lshlrev_b32 v5, 8, v5
    v_lshrrev_b32 v8, 4, v0
    v_lshl_add_u32 v5, v8, 6, v5
    v_and_b32 v8, 3, v0
    v_lshl_add_u32 v5, v8, 4, v5
    s_lshl_b32 s56, s100, 10
    s_waitcnt vmcnt(0) lgkmcnt(0)
    v_mov_b32 v8, 162064
    v_mov_b32 v9, 1
    s_mov_b64 exec, 1
    ds_add_u32 v8, v9
    s_mov_b64 exec, -1
    s_branch L_t2gate
L_ffn2:
    s_barrier
L_ffn2b:
    ds_read_b128 v[8:11], v161
    ds_read_b128 v[12:15], v162
    s_cmp_eq_u32 s61, 1
    s_cbranch_scc0 L_f2slow
    s_waitcnt lgkmcnt(1)
    v_smfmac_f32_16x16x64_bf16 v[16:19], v[8:11], v[80:87], v164
    v_smfmac_f32_16x16x64_bf16 v[20:23], v[8:11], v[96:103], v164
    s_waitcnt lgkmcnt(0)
    v_smfmac_f32_16x16x64_bf16 v[16:19], v[12:15], v[88:95], v164
    v_smfmac_f32_16x16x64_bf16 v[20:23], v[12:15], v[104:111], v164
    v_smfmac_f32_16x16x64_bf16 v[24:27], v[8:11], v[112:119], v164
    v_smfmac_f32_16x16x64_bf16 v[28:31], v[8:11], v[128:135], v164
    v_smfmac_f32_16x16x64_bf16 v[24:27], v[12:15], v[120:127], v164
    v_smfmac_f32_16x16x64_bf16 v[28:31], v[12:15], v[136:143], v164
    v_smfmac_f32_16x16x64_bf16 v[32:35], v[8:11], v[144:151], v164
    v_smfmac_f32_16x16x64_bf16 v[32:35], v[12:15], v[152:159], v164
    s_nop 0
    v_pk_add_f32 v[16:17], v[16:17], v[18:19]
    v_cvt_pk_bf16_f32 v40, v16, v17
    v_pk_add_f32 v[20:21], v[20:21], v[22:23]
    v_cvt_pk_bf16_f32 v41, v20, v21
    buffer_store_dwordx2 v[40:41], v160, s[40:43], s57 offen
    v_pk_add_f32 v[24:25], v[24:25], v[26:27]
    v_cvt_pk_bf16_f32 v42, v24, v25
    v_pk_add_f32 v[28:29], v[28:29], v[30:31]
    v_cvt_pk_bf16_f32 v43, v28, v29
    buffer_store_dwordx2 v[42:43], v160, s[40:43], s57 offen offset:128
    v_pk_add_f32 v[32:33], v[32:33], v[34:35]
    v_cvt_pk_bf16_f32 v44, v32, v33
    buffer_store_dword v44, v163, s[40:43], s57 offen offset:256
L_f2done:
    s_barrier
    s_endpgm
L_f2slow:
    s_waitcnt lgkmcnt(1)
    v_smfmac_f32_16x16x64_bf16 v[16:19], v[8:11], v[80:87], v164
    v_smfmac_f32_16x16x64_bf16 v[20:23], v[8:11], v[96:103], v164
    s_waitcnt lgkmcnt(0)
    v_smfmac_f32_16x16x64_bf16 v[16:19], v[12:15], v[88:95], v164
    v_smfmac_f32_16x16x64_bf16 v[20:23], v[12:15], v[104:111], v164
    v_smfmac_f32_16x16x64_bf16 v[24:27], v[8:11], v[112:119], v164
    v_smfmac_f32_16x16x64_bf16 v[28:31], v[8:11], v[128:135], v164
    v_smfmac_f32_16x16x64_bf16 v[24:27], v[12:15], v[120:127], v164
    v_smfmac_f32_16x16x64_bf16 v[28:31], v[12:15], v[136:143], v164
    v_smfmac_f32_16x16x64_bf16 v[32:35], v[8:11], v[144:151], v164
    v_smfmac_f32_16x16x64_bf16 v[32:35], v[12:15], v[152:159], v164
    s_nop 0
    v_pk_add_f32 v[16:17], v[16:17], v[18:19]
    v_cvt_pk_bf16_f32 v40, v16, v17
    v_pk_add_f32 v[20:21], v[20:21], v[22:23]
    v_cvt_pk_bf16_f32 v41, v20, v21
    buffer_store_dwordx2 v[40:41], v160, s[40:43], s57 offen sc1
    v_pk_add_f32 v[24:25], v[24:25], v[26:27]
    v_cvt_pk_bf16_f32 v42, v24, v25
    v_pk_add_f32 v[28:29], v[28:29], v[30:31]
    v_cvt_pk_bf16_f32 v43, v28, v29
    buffer_store_dwordx2 v[42:43], v160, s[40:43], s57 offen offset:128 sc1
    v_pk_add_f32 v[32:33], v[32:33], v[34:35]
    v_cvt_pk_bf16_f32 v44, v32, v33
    buffer_store_dword v44, v163, s[40:43], s57 offen offset:256 sc1
    s_branch L_f2done
L_poll_3t:
    s_mov_b32 s60, 0
    s_waitcnt vmcnt(0)
    s_branch L_poll_3e
L_poll_7t:
    s_mov_b32 s60, 0
    s_waitcnt vmcnt(0)
    s_branch L_poll_7e
L_poll_8t:
    s_mov_b32 s60, 0
    s_waitcnt vmcnt(0)
    s_branch L_poll_8e
L_poll_98t:
    s_mov_b32 s60, 0
    s_waitcnt vmcnt(0)
    s_branch L_poll_98e
L_pfast:
    buffer_store_dword v12, v108, s[40:43], s101 offen
    buffer_store_dword v12, v110, s[40:43], s101 offen
    s_branch L_pdone
L_poll_100t:
    s_mov_b32 s60, 0
    s_waitcnt vmcnt(0)
    s_branch L_poll_100e
L_poll_103t:
    s_mov_b32 s60, 0
    s_waitcnt vmcnt(0)
    s_branch L_poll_103e
L_poll_105t:
    s_mov_b32 s60, 0
    s_waitcnt vmcnt(0)
    s_branch L_poll_105e
L_poll_109t:
    s_mov_b32 s60, 0
    s_waitcnt vmcnt(0)
    s_branch L_poll_109e
L_poll_111t:
    s_mov_b32 s60, 0
    s_waitcnt vmcnt(0)
    s_branch L_poll_111e
L_poll_116t:
    s_mov_b32 s60, 0
    s_waitcnt vmcnt(0)
    s_branch L_poll_116e
L_poll_118t:
    s_mov_b32 s60, 0
    s_waitcnt vmcnt(0)
    s_branch L_poll_118e
L_ygt:
    s_waitcnt vmcnt(0)
    s_branch L_ygd
L_pto:
    s_mov_b32 s60, 0
    s_waitcnt vmcnt(0)
    s_branch L_pgot0
L_poll_122t:
    s_mov_b32 s60, 0
    s_waitcnt vmcnt(0)
    s_branch L_poll_122e
L_end:
    s_endpgm
L_codeend:
.section .rodata,"a"
.p2align 6
.amdhsa_kernel adaLN_cond__sliding_block_cached__dense_activation_gelu__decode_kernel
  .amdhsa_next_free_vgpr 168
  .amdhsa_next_free_sgpr 102
  .amdhsa_accum_offset 168
  .amdhsa_group_segment_fixed_size 0
  .amdhsa_kernarg_size 120
  .amdhsa_user_sgpr_count 2
  .amdhsa_user_sgpr_kernarg_segment_ptr 1
  .amdhsa_system_sgpr_workgroup_id_x 1
.end_amdhsa_kernel
```

```asm
; @launch grid=(256,1,1) block=(768,1,1) lds=162176
.amdgcn_target "amdgcn-amd-amdhsa--gfx950"
.text
.globl adaLN_cond__sliding_block_cached__dense_activation_gelu__decode_kernel
.p2align 8
.type adaLN_cond__sliding_block_cached__dense_activation_gelu__decode_kernel,@function
adaLN_cond__sliding_block_cached__dense_activation_gelu__decode_kernel:
    s_load_dwordx16 s[4:19], s[0:1], 0
    s_load_dwordx8 s[20:27], s[0:1], 64
    s_load_dwordx4 s[28:31], s[0:1], 96
    s_load_dwordx2 s[32:33], s[0:1], 112
    s_cmp_ge_u32 s2, 256
    s_cbranch_scc1 L_end
    v_lshrrev_b32 v1, 6, v0
    v_mul_u32_u24 v2, 36, v0
    v_readfirstlane_b32 s3, v1
    v_and_b32 v0, 63, v0
    s_and_b32 s34, s2, 7
    s_lshr_b32 s35, s2, 3
    s_cmp_lg_u32 s35, 21
    s_cbranch_scc1 L_nopf
    s_getpc_b64 s[48:49]
L_pc:
    v_min_u32 v2, L_codeend-L_pc-4, v2
    v_mov_b32 v3, s49
    v_add_co_u32 v2, vcc, s48, v2
    s_nop 1
    v_addc_co_u32 v3, vcc, 0, v3, vcc
    global_load_dword v152, v[2:3], off
L_nopf:
    s_lshr_b32 s36, s35, 3
    s_lshl2_add_u32 s36, s34, s36
    s_bfe_u32 s37, s35, 0x20001
    s_and_b32 s38, s35, 1
    s_cmp_lt_u32 s35, 27
    s_cselect_b32 s39, 1, 0
    s_cmp_eq_u32 s34, 2
    s_cselect_b32 s39, s39, 0
    s_sub_u32 s62, s34, 3
    s_and_b32 s62, s62, 7
    s_mul_i32 s56, s35, 7
    s_add_u32 s56, s56, s62
    s_cmp_eq_u32 s62, 7
    s_cselect_b32 s56, 255, s56
    s_mov_b32 s60, 1000000
    s_mov_b32 s61, 0
    v_mov_b32 v36, 0
    s_cmp_lt_u32 s3, 4
    s_cbranch_scc1 L_helpers
    s_sub_u32 s3, s3, 4
    s_cmp_ge_u32 s35, 22
    s_cselect_b32 s59, 1, 0
    s_add_u32 s62, s3, s59
    s_cmp_ge_u32 s62, 6
    s_cselect_b32 s62, s39, 0
    s_cmp_eq_u32 s62, 1
    s_cbranch_scc1 L_proxy
    s_cmp_eq_u32 s59, 1
    s_cselect_b32 s100, 0, 81920
    s_lshl_b32 s62, s3, 13
    s_add_u32 s100, s100, s62
    s_and_b32 s62, s39, s59
    s_cselect_b32 s100, -1, s100
    s_mov_b32 s101, 0
L_stream:
    s_lshl_b32 s62, s37, 5
    s_add_u32 s62, s62, s36
    s_lshl_b32 s63, s62, 21
    s_lshl_b32 s96, s38, 18
    s_add_u32 s63, s63, s96
    s_add_u32 s63, s63, 1572864
    v_lshlrev_b32 v1, 4, v0
    s_lshl_b32 s96, s3, 12
    v_add_u32 v1, s96, v1
    s_mov_b32 s97, 0
    s_mov_b32 s50, 262144
    s_mov_b32 s51, 0x20000
    s_waitcnt lgkmcnt(0)
    s_add_u32 s48, s6, s63
    s_addc_u32 s49, s7, 0
    s_cmp_lt_u32 s56, 40
    s_cbranch_scc0 L_nob0
    s_barrier
L_nob0:
    buffer_load_dwordx4 v[40:43], v1, s[48:51], s97 offen offset:0 nt
    buffer_load_dwordx4 v[44:47], v1, s[48:51], s97 offen offset:1024 nt
    s_cmp_lt_u32 s56, 40
    s_cbranch_scc1 L_stream2
    s_barrier
    s_branch L_stream2
L_helpers:
    s_cmp_lg_u32 s3, 0
    s_cbranch_scc1 L_noinit
    v_lshlrev_b32 v1, 2, v0
    v_add_u32 v1, 161920, v1
    ds_write_b32 v1, v36
L_noinit:
    s_waitcnt lgkmcnt(0)
    s_mov_b32 s40, s32
    s_mov_b32 s41, s33
    s_mov_b32 s42, 589824
    s_mov_b32 s43, 0x20000
    s_mov_b32 s44, s30
    s_mov_b32 s45, s31
    s_mov_b32 s46, 256
    s_mov_b32 s47, 0x20000
    s_lshl2_add_u32 s62, s35, s3
    s_cmp_eq_u32 s62, 87
    s_cbranch_scc1 L_touch
L_notp:
    s_mul_i32 s101, s3, 20480
    s_mov_b32 s96, s56
    s_cmp_lt_u32 s56, 40
    s_cbranch_scc0 L_nothalf
    s_cmp_lt_u32 s3, 2
    s_cbranch_scc1 L_unit
    s_add_u32 s62, s56, 20
    s_cmp_eq_u32 s3, 2
    s_cbranch_scc1 L_job
    s_lshr_b32 s62, s56, 1
    s_lshl_b32 s63, s62, 11
    s_cmp_ge_u32 s62, 10
    s_cselect_b32 s62, -19968, 0
    s_add_u32 s63, s63, s62
    s_and_b32 s62, s56, 1
    s_lshl_b32 s62, s62, 8
    s_add_u32 s63, s63, s62
    v_lshrrev_b32 v1, 5, v0
    v_lshlrev_b32 v1, 10, v1
    v_and_b32 v2, 31, v0
    v_lshl_add_u32 v1, v2, 3, v1
    v_mov_b32 v4, -1
    v_mov_b32 v5, -1
    buffer_store_dwordx2 v[4:5], v1, s[40:43], s63 offen sc1
    s_lshl_b32 s62, s56, 1
    s_waitcnt vmcnt(0)
    s_mov_b64 exec, 1
    buffer_store_short v4, v36, s[44:47], s62 offen offset:128 sc1
    s_mov_b64 exec, -1
    s_barrier
    s_branch L_service
L_nothalf:
    s_cmp_lt_u32 s56, 104
    s_cbranch_scc1 L_unit
    s_sub_u32 s62, s56, 144
    s_cmp_lt_u32 s62, 10
    s_cbranch_scc0 L_nojob
    s_cmp_lt_u32 s3, 2
    s_cbranch_scc0 L_nojob
    s_mul_i32 s63, s3, 10
    s_add_u32 s62, s62, s63
L_job:
    s_cmp_lt_u32 s62, 59
    s_cbranch_scc0 L_end
    s_mov_b32 s100, s101
    s_lshl_b32 s101, s62, 9
    s_add_u32 s101, s101, 172032
    s_cmp_lt_u32 s62, 27
    s_cselect_b32 s63, 0, 27
    s_cselect_b32 s3, 7, 6
    s_cmp_lt_u32 s62, 54
    s_cselect_b32 s63, s63, 32
    s_cselect_b32 s3, s3, 5
    s_sub_u32 s35, s62, s63
    s_mov_b32 s34, 2
    s_lshr_b32 s36, s35, 3
    s_add_u32 s36, s36, 8
    s_bfe_u32 s37, s35, 0x20001
    s_and_b32 s38, s35, 1
    s_mov_b32 s59, 0
    s_branch L_stream
L_nojob:
    s_barrier
    s_cmp_ge_u32 s35, 22
    s_cbranch_scc1 L_h_t1
    s_cmp_eq_u32 s39, 1
    s_cbranch_scc1 L_h_role
    s_cmp_lt_u32 s96, 144
    s_cbranch_scc1 L_unit
    s_cmp_eq_u32 s3, 3
    s_cbranch_scc1 L_service
    s_endpgm
L_unit:
    v_lshrrev_b32 v3, 4, v0
    v_and_b32 v4, 3, v0
    v_bfe_u32 v7, v0, 2, 2
    s_mov_b32 s14, s3
    s_mov_b32 s15, 3
    s_sub_u32 s62, s96, 40
    s_cmp_lt_u32 s62, 64
    s_cbranch_scc1 L_u_q
    s_mov_b32 s100, 1
    s_sub_u32 s96, s96, 84
    s_cmp_lt_u32 s56, 40
    s_cbranch_scc0 L_u_full
    s_mov_b32 s100, 0
    s_lshr_b32 s96, s56, 1
    s_and_b32 s62, s56, 1
    s_lshl1_add_u32 s14, s62, s14
    s_mov_b32 s15, 1
L_u_full:
    s_mov_b32 s97, 0
    s_mov_b32 s99, 7680
    s_mov_b32 s48, s26
    s_mov_b32 s49, s27
    s_mov_b32 s50, 4915200
    s_mov_b32 s51, 0x20000
    s_mov_b32 s52, s24
    s_mov_b32 s53, s25
    s_mov_b32 s54, 5120
    s_mov_b32 s55, 0x20000
    v_and_b32 v6, 15, v0
    v_lshlrev_b32 v6, 4, v6
    v_mul_u32_u24 v5, 1280, v3
    v_add_u32 v5, v5, v6
    s_mul_i32 s62, s14, 320
    buffer_load_dwordx4 v[8:11], v5, s[52:55], s62 offen
    s_mov_b32 exec_lo, 0x000f000f
    s_mov_b32 exec_hi, 0x000f000f
    buffer_load_dwordx4 v[12:15], v5, s[52:55], s62 offen offset:256
    s_mov_b64 exec, -1
    s_lshl_b32 s98, s96, 7
    s_mul_i32 s13, s96, 0x199a
    s_lshr_b32 s13, s13, 16
    s_cmp_lg_u32 s13, 1
    s_cbranch_scc1 L_u_go
    s_mov_b32 s52, s4
    s_mov_b32 s53, s5
    s_mov_b32 s54, 5120
    s_mov_b32 s55, 0x20000
    v_mul_u32_u24 v5, 1280, v4
    v_lshlrev_b32 v64, 5, v7
    v_lshl_add_u32 v64, v3, 3, v64
    v_add_u32 v64, v64, v5
    v_lshrrev_b32 v6, 2, v0
    v_lshl_add_u32 v6, v6, 4, v5
    s_sub_u32 s62, s98, 1280
    buffer_load_dwordx4 v[16:19], v6, s[52:55], 0 offen offset:0
    buffer_load_dwordx4 v[20:23], v6, s[52:55], 0 offen offset:256
    buffer_load_dwordx4 v[24:27], v6, s[52:55], 0 offen offset:512
    buffer_load_dwordx4 v[28:31], v6, s[52:55], 0 offen offset:768
    buffer_load_dwordx4 v[32:35], v6, s[52:55], 0 offen offset:1024
    buffer_load_dwordx2 v[66:67], v64, s[52:55], s62 offen
    s_branch L_u_go
L_u_q:
    s_mov_b32 s97, 1
    s_mov_b32 s99, 8192
    s_mov_b32 s100, 0
    s_lshl_b32 s98, s62, 7
    s_mov_b32 s48, s10
    s_mov_b32 s49, s11
    s_mov_b32 s50, 5242880
    s_mov_b32 s51, 0x20000
L_u_go:
    v_lshrrev_b32 v6, 3, v0
    v_mul_lo_u32 v1, v6, s99
    v_and_b32 v6, 2, v6
    v_xor_b32 v6, v6, v0
    v_and_b32 v6, 7, v6
    v_lshl_add_u32 v1, v6, 4, v1
    v_add_u32 v1, s98, v1
    v_xor_b32 v2, 64, v1
    s_mul_i32 s63, s99, s14
    s_mul_i32 s63, s63, 160
    s_lshl_b32 s59, s99, 3
    s_mov_b32 m0, s101
    s_mov_b32 s62, 10
L_dma_1:
    buffer_load_dwordx4 v1, s[48:51], s63 offen nt lds
    s_add_u32 m0, m0, 1024
    s_add_u32 s63, s63, s59
    s_cmp_eq_u32 s100, 0
    s_cbranch_scc1 L_dma_1n0
    s_waitcnt vmcnt(3)
    s_cmp_eq_u32 s100, 2
    s_cbranch_scc1 L_dma_1n0
    s_waitcnt vmcnt(3)
L_dma_1n0:
    buffer_load_dwordx4 v2, s[48:51], s63 offen nt lds
    s_add_u32 m0, m0, 1024
    s_add_u32 s63, s63, s59
    s_cmp_eq_u32 s100, 0
    s_cbranch_scc1 L_dma_1n1
    s_waitcnt vmcnt(3)
    s_cmp_eq_u32 s100, 2
    s_cbranch_scc1 L_dma_1n1
    s_waitcnt vmcnt(3)
L_dma_1n1:
    s_sub_u32 s62, s62, 1
    s_cmp_lg_u32 s62, 0
    s_cbranch_scc1 L_dma_1
    v_and_b32 v65, 31, v0
    v_lshlrev_b32 v65, 2, v65
    s_cmp_lt_u32 s56, 104
    s_cselect_b32 s62, 32, 64
    v_min_u32 v6, 51, v0
    v_lshlrev_b32 v6, 2, v6
    v_cmp_le_u32 vcc, s62, v0
    s_nop 1
    v_cndmask_b32 v65, v65, v6, vcc
    v_mov_b32 v68, -1
    s_cmp_lt_u32 s56, 40
    s_cbranch_scc1 L_u_nofl
    buffer_load_dword v68, v65, s[44:47], 0 offen sc1
L_u_nofl:
    s_cmp_lt_u32 s56, 104
    s_cbranch_scc0 L_u_nob
    s_barrier
L_u_nob:
    v_lshrrev_b32 v60, 4, v0
    v_lshlrev_b32 v60, 10, v60
    v_bfe_u32 v6, v0, 2, 2
    v_lshl_add_u32 v60, v6, 7, v60
    v_and_b32 v6, 3, v0
    v_lshl_add_u32 v60, v6, 3, v60
    v_bfe_u32 v6, v0, 3, 2
    v_lshl_add_u32 v60, v6, 5, v60
    v_xor_b32 v61, 32, v60
    v_xor_b32 v62, 64, v60
    v_xor_b32 v63, 0x60, v60
    v_add_u32 v60, s101, v60
    v_add_u32 v61, s101, v61
    v_add_u32 v62, s101, v62
    v_add_u32 v63, s101, v63
    v_mov_b32 v56, 1.0
    v_mov_b32 v57, 1.0
    v_mov_b32 v58, 1.0
    v_mov_b32 v59, 1.0
    s_mov_b32 s58, 0
    v_lshl_add_u32 v69, v7, 2, v3
    v_lshl_add_u32 v69, v4, 4, v69
    v_and_b32 v64, 15, v0
    v_lshlrev_b32 v64, 3, v64
    s_cmp_eq_u32 s97, 1
    s_cbranch_scc1 L_u_q2
    v_mul_u32_u24 v6, 1280, v3
    v_add_u32 v64, v64, v6
    s_mul_i32 s63, s13, 3840
    s_add_u32 s57, s98, s63
    s_add_u32 s57, s57, 10240
    s_cmp_lt_u32 s56, 40
    s_cbranch_scc0 L_u_nat
    v_lshrrev_b32 v69, 1, v3
    v_lshlrev_b32 v69, 3, v69
    v_lshl_add_u32 v69, v7, 4, v69
    v_lshl_add_u32 v69, v4, 1, v69
    v_and_b32 v6, 1, v3
    v_add_u32 v69, v69, v6
    s_lshr_b32 s62, s56, 1
    s_lshl_b32 s57, s62, 11
    s_cmp_ge_u32 s62, 10
    s_cselect_b32 s62, -19968, 0
    s_add_u32 s57, s57, s62
    s_and_b32 s62, s56, 1
    s_lshl_b32 s62, s62, 8
    s_add_u32 s57, s57, s62
    v_lshrrev_b32 v64, 5, v0
    v_lshlrev_b32 v64, 10, v64
    v_and_b32 v6, 31, v0
    v_lshl_add_u32 v64, v6, 3, v64
L_u_nat:
    s_cmp_eq_u32 s13, 4
    s_cselect_b32 s58, 1.0, 0
    s_cmp_eq_u32 s13, 1
    s_cselect_b32 s58, 1.0, s58
    s_cselect_b32 s56, 1, 0
    s_cmp_eq_u32 s14, 0
    s_cselect_b32 s58, s58, 0
    s_waitcnt vmcnt(20)
    s_mov_b32 s62, 0xbfb8aa3b
    v_lshlrev_b32 v40, 16, v8
    v_and_b32 v41, 0xffff0000, v8
    v_lshlrev_b32 v42, 16, v9
    v_and_b32 v43, 0xffff0000, v9
    v_lshlrev_b32 v44, 16, v10
    v_and_b32 v45, 0xffff0000, v10
    v_lshlrev_b32 v46, 16, v11
    v_and_b32 v47, 0xffff0000, v11
    v_mul_f32 v48, s62, v40
    v_mul_f32 v49, s62, v41
    v_mul_f32 v50, s62, v42
    v_mul_f32 v51, s62, v43
    v_mul_f32 v52, s62, v44
    v_mul_f32 v53, s62, v45
    v_mul_f32 v54, s62, v46
    v_mul_f32 v55, s62, v47
    v_exp_f32 v48, v48
    v_exp_f32 v49, v49
    v_exp_f32 v50, v50
    v_exp_f32 v51, v51
    v_exp_f32 v52, v52
    v_exp_f32 v53, v53
    v_exp_f32 v54, v54
    v_exp_f32 v55, v55
    v_add_f32 v48, 1.0, v48
    v_add_f32 v49, 1.0, v49
    v_add_f32 v50, 1.0, v50
    v_add_f32 v51, 1.0, v51
    v_add_f32 v52, 1.0, v52
    v_add_f32 v53, 1.0, v53
    v_add_f32 v54, 1.0, v54
    v_add_f32 v55, 1.0, v55
    v_rcp_f32 v48, v48
    v_rcp_f32 v49, v49
    v_rcp_f32 v50, v50
    v_rcp_f32 v51, v51
    v_rcp_f32 v52, v52
    v_rcp_f32 v53, v53
    v_rcp_f32 v54, v54
    v_rcp_f32 v55, v55
    v_mul_f32 v40, v40, v48
    v_mul_f32 v41, v41, v49
    v_mul_f32 v42, v42, v50
    v_mul_f32 v43, v43, v51
    v_mul_f32 v44, v44, v52
    v_mul_f32 v45, v45, v53
    v_mul_f32 v46, v46, v54
    v_mul_f32 v47, v47, v55
    v_cvt_pk_bf16_f32 v8, v40, v41
    v_cvt_pk_bf16_f32 v9, v42, v43
    v_cvt_pk_bf16_f32 v10, v44, v45
    v_cvt_pk_bf16_f32 v11, v46, v47
    v_lshlrev_b32 v40, 16, v12
    v_and_b32 v41, 0xffff0000, v12
    v_lshlrev_b32 v42, 16, v13
    v_and_b32 v43, 0xffff0000, v13
    v_lshlrev_b32 v44, 16, v14
    v_and_b32 v45, 0xffff0000, v14
    v_lshlrev_b32 v46, 16, v15
    v_and_b32 v47, 0xffff0000, v15
    v_mul_f32 v48, s62, v40
    v_mul_f32 v49, s62, v41
    v_mul_f32 v50, s62, v42
    v_mul_f32 v51, s62, v43
    v_mul_f32 v52, s62, v44
    v_mul_f32 v53, s62, v45
    v_mul_f32 v54, s62, v46
    v_mul_f32 v55, s62, v47
    v_exp_f32 v48, v48
    v_exp_f32 v49, v49
    v_exp_f32 v50, v50
    v_exp_f32 v51, v51
    v_exp_f32 v52, v52
    v_exp_f32 v53, v53
    v_exp_f32 v54, v54
    v_exp_f32 v55, v55
    v_add_f32 v48, 1.0, v48
    v_add_f32 v49, 1.0, v49
    v_add_f32 v50, 1.0, v50
    v_add_f32 v51, 1.0, v51
    v_add_f32 v52, 1.0, v52
    v_add_f32 v53, 1.0, v53
    v_add_f32 v54, 1.0, v54
    v_add_f32 v55, 1.0, v55
    v_rcp_f32 v48, v48
    v_rcp_f32 v49, v49
    v_rcp_f32 v50, v50
    v_rcp_f32 v51, v51
    v_rcp_f32 v52, v52
    v_rcp_f32 v53, v53
    v_rcp_f32 v54, v54
    v_rcp_f32 v55, v55
    v_mul_f32 v40, v40, v48
    v_mul_f32 v41, v41, v49
    v_mul_f32 v42, v42, v50
    v_mul_f32 v43, v43, v51
    v_mul_f32 v44, v44, v52
    v_mul_f32 v45, v45, v53
    v_mul_f32 v46, v46, v54
    v_mul_f32 v47, v47, v55
    v_cvt_pk_bf16_f32 v12, v40, v41
    v_cvt_pk_bf16_f32 v13, v42, v43
    v_cvt_pk_bf16_f32 v14, v44, v45
    v_cvt_pk_bf16_f32 v15, v46, v47
    s_mul_i32 s62, s3, 1344
    s_add_u32 s62, s62, 151552
    v_mul_u32_u24 v5, 336, v3
    v_and_b32 v6, 15, v0
    v_lshl_add_u32 v5, v6, 4, v5
    v_add_u32 v5, s62, v5
    ds_write_b128 v5, v[8:11]
    s_mov_b32 exec_lo, 0x000f000f
    s_mov_b32 exec_hi, 0x000f000f
    ds_write_b128 v5, v[12:15] offset:256
    s_mov_b64 exec, -1
    v_mul_u32_u24 v5, 336, v4
    v_lshl_add_u32 v5, v3, 4, v5
    v_add_u32 v5, s62, v5
    s_mov_b32 s59, 0x3e800000
    s_cmp_eq_u32 s56, 0
    s_cbranch_scc1 L_u_nost
    v_mov_b32 v40, 0
    v_mov_b32 v41, 0
    s_mov_b32 s62, 0x3f803f80
    v_dot2c_f32_bf16 v40, s62, v16
    v_dot2c_f32_bf16 v41, v16, v16
    v_dot2c_f32_bf16 v40, s62, v17
    v_dot2c_f32_bf16 v41, v17, v17
    v_dot2c_f32_bf16 v40, s62, v18
    v_dot2c_f32_bf16 v41, v18, v18
    v_dot2c_f32_bf16 v40, s62, v19
    v_dot2c_f32_bf16 v41, v19, v19
    v_dot2c_f32_bf16 v40, s62, v20
    v_dot2c_f32_bf16 v41, v20, v20
    v_dot2c_f32_bf16 v40, s62, v21
    v_dot2c_f32_bf16 v41, v21, v21
    v_dot2c_f32_bf16 v40, s62, v22
    v_dot2c_f32_bf16 v41, v22, v22
    v_dot2c_f32_bf16 v40, s62, v23
    v_dot2c_f32_bf16 v41, v23, v23
    v_dot2c_f32_bf16 v40, s62, v24
    v_dot2c_f32_bf16 v41, v24, v24
    v_dot2c_f32_bf16 v40, s62, v25
    v_dot2c_f32_bf16 v41, v25, v25
    v_dot2c_f32_bf16 v40, s62, v26
    v_dot2c_f32_bf16 v41, v26, v26
    v_dot2c_f32_bf16 v40, s62, v27
    v_dot2c_f32_bf16 v41, v27, v27
    v_dot2c_f32_bf16 v40, s62, v28
    v_dot2c_f32_bf16 v41, v28, v28
    v_dot2c_f32_bf16 v40, s62, v29
    v_dot2c_f32_bf16 v41, v29, v29
    v_dot2c_f32_bf16 v40, s62, v30
    v_dot2c_f32_bf16 v41, v30, v30
    v_dot2c_f32_bf16 v40, s62, v31
    v_dot2c_f32_bf16 v41, v31, v31
    v_dot2c_f32_bf16 v40, s62, v32
    v_dot2c_f32_bf16 v41, v32, v32
    v_dot2c_f32_bf16 v40, s62, v33
    v_dot2c_f32_bf16 v41, v33, v33
    v_dot2c_f32_bf16 v40, s62, v34
    v_dot2c_f32_bf16 v41, v34, v34
    v_dot2c_f32_bf16 v40, s62, v35
    v_dot2c_f32_bf16 v41, v35, v35
    s_nop 1
    v_add_f32_dpp v40, v40, v40 row_ror:4 row_mask:0xf bank_mask:0xf
    v_add_f32_dpp v41, v41, v41 row_ror:4 row_mask:0xf bank_mask:0xf
    s_nop 0
    v_add_f32_dpp v40, v40, v40 row_ror:8 row_mask:0xf bank_mask:0xf
    v_add_f32_dpp v41, v41, v41 row_ror:8 row_mask:0xf bank_mask:0xf
    v_mov_b32 v42, v40
    v_mov_b32 v43, v41
    s_nop 0
    v_permlane16_swap_b32 v40, v42
    v_permlane16_swap_b32 v41, v43
    v_add_f32 v40, v40, v42
    v_add_f32 v41, v41, v43
    v_mov_b32 v42, v40
    v_mov_b32 v43, v41
    s_nop 0
    v_permlane32_swap_b32 v40, v42
    v_permlane32_swap_b32 v41, v43
    v_add_f32 v40, v40, v42
    v_add_f32 v41, v41, v43
    s_mov_b32 s62, 0x3acccccd
    v_mul_f32 v40, s62, v40
    v_mul_f32 v41, s62, v41
    v_fma_f32 v41, -v40, v40, v41
    v_max_f32 v41, 0, v41
    v_add_f32 v41, 0x3727c5ac, v41
    v_rsq_f32 v41, v41
    v_lshlrev_b32 v56, 16, v66
    v_and_b32 v57, 0xffff0000, v66
    v_lshlrev_b32 v58, 16, v67
    v_and_b32 v59, 0xffff0000, v67
    v_sub_f32 v56, v56, v40
    v_sub_f32 v57, v57, v40
    v_sub_f32 v58, v58, v40
    v_sub_f32 v59, v59, v40
    v_mul_f32 v56, v56, v41
    v_mul_f32 v57, v57, v41
    v_mul_f32 v58, v58, v41
    v_mul_f32 v59, v59, v41
L_u_nost:
    ds_read_b128 v[8:11], v5 offset:0
    ds_read_b128 v[12:15], v5 offset:64
    ds_read_b128 v[16:19], v5 offset:128
    ds_read_b128 v[20:23], v5 offset:192
    ds_read_b128 v[24:27], v5 offset:256
    s_branch L_u_frag
L_u_q2:
    v_lshl_add_u32 v64, v3, 13, v64
    s_add_u32 s57, s98, 40960
    v_lshlrev_b32 v5, 8, v7
    v_lshl_add_u32 v5, v3, 6, v5
    v_lshl_add_u32 v5, v4, 4, v5
    s_mul_i32 s63, s3, 5120
    s_add_u32 s63, s63, 0
    s_add_u32 s12, s63, 4096
    s_mov_b32 s59, 1.0
L_u_frag:
    s_waitcnt vmcnt(0)
    v_cmp_ne_u32 vcc, -1, v68
    s_cbranch_vccz L_u_yok
L_wy_2:
    buffer_load_dword v37, v65, s[44:47], 0 offen sc1
    s_waitcnt vmcnt(0)
    v_cmp_ne_u32 vcc, -1, v37
    s_cbranch_vccz L_wy_2e
    s_sleep 4
    s_sub_u32 s60, s60, 1
    s_cbranch_scc0 L_wy_2
    s_mov_b32 s60, 0
L_wy_2e:
L_u_yok:
    ds_read_b64_tr_b16 v[80:81], v60 offset:0
    ds_read_b64_tr_b16 v[82:83], v60 offset:512
    ds_read_b64_tr_b16 v[84:85], v61 offset:0
    ds_read_b64_tr_b16 v[86:87], v61 offset:512
    ds_read_b64_tr_b16 v[88:89], v62 offset:0
    ds_read_b64_tr_b16 v[90:91], v62 offset:512
    ds_read_b64_tr_b16 v[92:93], v63 offset:0
    ds_read_b64_tr_b16 v[94:95], v63 offset:512
    ds_read_b64_tr_b16 v[96:97], v60 offset:4096
    ds_read_b64_tr_b16 v[98:99], v60 offset:4608
    ds_read_b64_tr_b16 v[100:101], v61 offset:4096
    ds_read_b64_tr_b16 v[102:103], v61 offset:4608
    ds_read_b64_tr_b16 v[104:105], v62 offset:4096
    ds_read_b64_tr_b16 v[106:107], v62 offset:4608
    ds_read_b64_tr_b16 v[108:109], v63 offset:4096
    ds_read_b64_tr_b16 v[110:111], v63 offset:4608
    ds_read_b64_tr_b16 v[112:113], v60 offset:8192
    ds_read_b64_tr_b16 v[114:115], v60 offset:8704
    ds_read_b64_tr_b16 v[116:117], v61 offset:8192
    ds_read_b64_tr_b16 v[118:119], v61 offset:8704
    ds_read_b64_tr_b16 v[120:121], v62 offset:8192
    ds_read_b64_tr_b16 v[122:123], v62 offset:8704
    ds_read_b64_tr_b16 v[124:125], v63 offset:8192
    ds_read_b64_tr_b16 v[126:127], v63 offset:8704
    ds_read_b64_tr_b16 v[128:129], v60 offset:12288
    ds_read_b64_tr_b16 v[130:131], v60 offset:12800
    ds_read_b64_tr_b16 v[132:133], v61 offset:12288
    ds_read_b64_tr_b16 v[134:135], v61 offset:12800
    ds_read_b64_tr_b16 v[136:137], v62 offset:12288
    ds_read_b64_tr_b16 v[138:139], v62 offset:12800
    ds_read_b64_tr_b16 v[140:141], v63 offset:12288
    ds_read_b64_tr_b16 v[142:143], v63 offset:12800
    ds_read_b64_tr_b16 v[144:145], v60 offset:16384
    ds_read_b64_tr_b16 v[146:147], v60 offset:16896
    ds_read_b64_tr_b16 v[148:149], v61 offset:16384
    ds_read_b64_tr_b16 v[150:151], v61 offset:16896
    ds_read_b64_tr_b16 v[152:153], v62 offset:16384
    ds_read_b64_tr_b16 v[154:155], v62 offset:16896
    ds_read_b64_tr_b16 v[156:157], v63 offset:16384
    ds_read_b64_tr_b16 v[158:159], v63 offset:16896
    s_cmp_eq_u32 s97, 0
    s_cbranch_scc1 L_u_mm
    s_branch L_poll_3
L_poll_3s:
    s_sleep 8
L_poll_3:
    buffer_load_dwordx4 v[8:11], v5, s[40:43], s63 offen offset:0 sc1
    buffer_load_dwordx4 v[12:15], v5, s[40:43], s63 offen offset:1024 sc1
    buffer_load_dwordx4 v[16:19], v5, s[40:43], s63 offen offset:2048 sc1
    buffer_load_dwordx4 v[20:23], v5, s[40:43], s63 offen offset:3072 sc1
    buffer_load_dwordx4 v[24:27], v5, s[40:43], s12 offen offset:0 sc1
    s_sub_u32 s60, s60, 1
    s_cbranch_scc1 L_poll_3t
    s_waitcnt vmcnt(0)
    v_max3_u32 v37, v8, v9, v10
    v_max3_u32 v37, v37, v11, v12
    v_max3_u32 v37, v37, v13, v14
    v_max3_u32 v37, v37, v15, v16
    v_max3_u32 v37, v37, v17, v18
    v_max3_u32 v37, v37, v19, v20
    v_max3_u32 v37, v37, v21, v22
    v_max3_u32 v37, v37, v23, v24
    v_max3_u32 v37, v37, v25, v26
    v_max_u32 v37, v37, v27
    v_cmp_eq_u32 vcc, -1, v37
    s_cbranch_vccnz L_poll_3s
L_poll_3e:
L_u_got:
L_u_mm:
    s_waitcnt lgkmcnt(0)
    v_mfma_f32_16x16x32_bf16 v[40:43], v[80:83], v[8:11], 0
    v_mfma_f32_16x16x32_bf16 v[44:47], v[84:87], v[8:11], 0
    v_mfma_f32_16x16x32_bf16 v[48:51], v[88:91], v[8:11], 0
    v_mfma_f32_16x16x32_bf16 v[52:55], v[92:95], v[8:11], 0
    v_mfma_f32_16x16x32_bf16 v[40:43], v[96:99], v[12:15], v[40:43]
    v_mfma_f32_16x16x32_bf16 v[44:47], v[100:103], v[12:15], v[44:47]
    v_mfma_f32_16x16x32_bf16 v[48:51], v[104:107], v[12:15], v[48:51]
    v_mfma_f32_16x16x32_bf16 v[52:55], v[108:111], v[12:15], v[52:55]
    v_mfma_f32_16x16x32_bf16 v[40:43], v[112:115], v[16:19], v[40:43]
    v_mfma_f32_16x16x32_bf16 v[44:47], v[116:119], v[16:19], v[44:47]
    v_mfma_f32_16x16x32_bf16 v[48:51], v[120:123], v[16:19], v[48:51]
    v_mfma_f32_16x16x32_bf16 v[52:55], v[124:127], v[16:19], v[52:55]
    v_mfma_f32_16x16x32_bf16 v[40:43], v[128:131], v[20:23], v[40:43]
    v_mfma_f32_16x16x32_bf16 v[44:47], v[132:135], v[20:23], v[44:47]
    v_mfma_f32_16x16x32_bf16 v[48:51], v[136:139], v[20:23], v[48:51]
    v_mfma_f32_16x16x32_bf16 v[52:55], v[140:143], v[20:23], v[52:55]
    v_mfma_f32_16x16x32_bf16 v[40:43], v[144:147], v[24:27], v[40:43]
    v_mfma_f32_16x16x32_bf16 v[44:47], v[148:151], v[24:27], v[44:47]
    v_mfma_f32_16x16x32_bf16 v[48:51], v[152:155], v[24:27], v[48:51]
    v_mfma_f32_16x16x32_bf16 v[52:55], v[156:159], v[24:27], v[52:55]
    v_lshlrev_b32 v5, 4, v0
    v_add_u32 v5, 147456, v5
    s_lshl_b32 s62, s3, 10
    s_add_u32 s62, s62, 147456
    v_lshl_add_u32 v6, v69, 4, s62
    v_mov_b32 v24, s58
    v_mov_b32 v32, 162056
    v_mov_b32 v33, 1
    v_add_f32_dpp v40, v40, v40 row_ror:8 row_mask:0xf bank_mask:0xf
    v_add_f32_dpp v41, v41, v41 row_ror:8 row_mask:0xf bank_mask:0xf
    v_add_f32_dpp v42, v42, v42 row_ror:8 row_mask:0xf bank_mask:0xf
    v_add_f32_dpp v43, v43, v43 row_ror:8 row_mask:0xf bank_mask:0xf
    v_add_f32_dpp v44, v44, v44 row_ror:8 row_mask:0xf bank_mask:0xf
    v_add_f32_dpp v45, v45, v45 row_ror:8 row_mask:0xf bank_mask:0xf
    v_add_f32_dpp v46, v46, v46 row_ror:8 row_mask:0xf bank_mask:0xf
    v_add_f32_dpp v47, v47, v47 row_ror:8 row_mask:0xf bank_mask:0xf
    v_add_f32_dpp v48, v48, v48 row_ror:8 row_mask:0xf bank_mask:0xf
    v_add_f32_dpp v49, v49, v49 row_ror:8 row_mask:0xf bank_mask:0xf
    v_add_f32_dpp v50, v50, v50 row_ror:8 row_mask:0xf bank_mask:0xf
    v_add_f32_dpp v51, v51, v51 row_ror:8 row_mask:0xf bank_mask:0xf
    v_add_f32_dpp v52, v52, v52 row_ror:8 row_mask:0xf bank_mask:0xf
    v_add_f32_dpp v53, v53, v53 row_ror:8 row_mask:0xf bank_mask:0xf
    v_add_f32_dpp v54, v54, v54 row_ror:8 row_mask:0xf bank_mask:0xf
    v_add_f32_dpp v55, v55, v55 row_ror:8 row_mask:0xf bank_mask:0xf
    v_add_f32_dpp v28, v40, v40 row_ror:4 row_mask:0xf bank_mask:0x1
    v_add_f32_dpp v29, v41, v41 row_ror:4 row_mask:0xf bank_mask:0x1
    v_add_f32_dpp v30, v42, v42 row_ror:4 row_mask:0xf bank_mask:0x1
    v_add_f32_dpp v31, v43, v43 row_ror:4 row_mask:0xf bank_mask:0x1
    v_add_f32_dpp v28, v44, v44 row_ror:4 row_mask:0xf bank_mask:0x2
    v_add_f32_dpp v29, v45, v45 row_ror:4 row_mask:0xf bank_mask:0x2
    v_add_f32_dpp v30, v46, v46 row_ror:4 row_mask:0xf bank_mask:0x2
    v_add_f32_dpp v31, v47, v47 row_ror:4 row_mask:0xf bank_mask:0x2
    v_add_f32_dpp v28, v48, v48 row_ror:4 row_mask:0xf bank_mask:0x4
    v_add_f32_dpp v29, v49, v49 row_ror:4 row_mask:0xf bank_mask:0x4
    v_add_f32_dpp v30, v50, v50 row_ror:4 row_mask:0xf bank_mask:0x4
    v_add_f32_dpp v31, v51, v51 row_ror:4 row_mask:0xf bank_mask:0x4
    v_add_f32_dpp v28, v52, v52 row_ror:4 row_mask:0xf bank_mask:0x8
    v_add_f32_dpp v29, v53, v53 row_ror:4 row_mask:0xf bank_mask:0x8
    v_add_f32_dpp v30, v54, v54 row_ror:4 row_mask:0xf bank_mask:0x8
    v_add_f32_dpp v31, v55, v55 row_ror:4 row_mask:0xf bank_mask:0x8
    v_fma_f32 v28, v28, s59, v24
    v_fma_f32 v29, v29, s59, v24
    v_fma_f32 v30, v30, s59, v24
    v_fma_f32 v31, v31, s59, v24
    v_mul_f32 v28, v28, v56
    v_mul_f32 v29, v29, v57
    v_mul_f32 v30, v30, v58
    v_mul_f32 v31, v31, v59
    ds_write_b128 v6, v[28:31]
    s_mov_b64 exec, 1
    ds_add_rtn_u32 v34, v32, v33
    s_mov_b64 exec, -1
    ds_read_b128 v[8:11], v5
    ds_read_b128 v[12:15], v5 offset:1024
    ds_read_b128 v[16:19], v5 offset:2048
    ds_read_b128 v[20:23], v5 offset:3072
    s_waitcnt lgkmcnt(0)
    v_readfirstlane_b32 s62, v34
    s_nop 0
    s_cmp_eq_u32 s62, s15
    s_cbranch_scc1 L_u_last
    s_cmp_eq_u32 s62, 1
    s_cbranch_scc1 L_service
    s_endpgm
L_u_last:
    v_add_f32 v8, v8, v12
    v_add_f32 v9, v9, v13
    v_add_f32 v10, v10, v14
    v_add_f32 v11, v11, v15
    s_cmp_eq_u32 s15, 1
    s_cbranch_scc1 L_u_two
    v_add_f32 v16, v16, v20
    v_add_f32 v17, v17, v21
    v_add_f32 v18, v18, v22
    v_add_f32 v19, v19, v23
    v_add_f32 v8, v8, v16
    v_add_f32 v9, v9, v17
    v_add_f32 v10, v10, v18
    v_add_f32 v11, v11, v19
L_u_two:
    v_cvt_pk_bf16_f32 v8, v8, v9
    v_cvt_pk_bf16_f32 v9, v10, v11
    buffer_store_dwordx2 v[8:9], v64, s[40:43], s57 offen sc1
    s_endpgm
L_touch:
    s_load_dword s0, s[32:33], 0
    s_load_dword s0, s[30:31], 0
    s_cmp_eq_u32 s39, 1
    s_cbranch_scc1 L_tpr
    s_mov_b32 s62, 16777216
    s_load_dword s0, s[8:9], s62
    s_mov_b32 s62, 83886080
    s_load_dword s0, s[8:9], s62
    s_mov_b32 s62, 150994944
    s_load_dword s0, s[8:9], s62
    s_mov_b32 s62, 218103808
    s_load_dword s0, s[8:9], s62
    s_branch L_tpv
L_tpr:
    s_load_dword s0, s[20:21], 0
    s_mov_b32 s62, 2211836
    s_load_dword s0, s[20:21], s62
    s_load_dword s0, s[16:17], 0
    s_mov_b32 s62, 2211836
    s_load_dword s0, s[16:17], s62
    s_load_dword s0, s[18:19], 0
    s_load_dword s0, s[22:23], 0
    s_load_dword s0, s[28:29], 0
    s_load_dword s0, s[4:5], 0
L_tpv:
    s_lshl_b32 s62, s34, 23
    s_load_dword s0, s[8:9], s62
    s_add_u32 s62, s62, 67108864
    s_load_dword s0, s[8:9], s62
    s_add_u32 s62, s62, 67108864
    s_load_dword s0, s[8:9], s62
    s_add_u32 s62, s62, 67108864
    s_load_dword s0, s[8:9], s62
    s_add_u32 s62, s62, 67108864
    s_branch L_notp
L_stream2:
    s_mov_b32 s12, s100
    s_mov_b32 s13, s101
    s_mov_b32 s40, s32
    s_mov_b32 s41, s33
    s_mov_b32 s42, 589824
    s_mov_b32 s43, 0x20000
    s_mov_b32 s44, s30
    s_mov_b32 s45, s31
    s_mov_b32 s46, 256
    s_mov_b32 s47, 0x20000
    s_bitcmp1_b32 s3, 0
    s_mov_b32 s57, 0xffffffff
    s_mov_b32 s58, 0xffff
    s_mov_b32 s14, 0xffffffff
    s_mov_b32 s15, 0x0
L_pm_9:
    s_cmp_lt_u32 s56, 104
    s_cbranch_scc0 L_pm_10
    s_bitcmp1_b32 s3, 0
    s_mov_b32 s57, 0xffff
    s_mov_b32 s58, 0x0
    s_mov_b32 s14, 0xffffffff
    s_mov_b32 s15, 0x0
L_pm_10:
    s_sub_u32 s96, s56, 43
    s_and_b32 s96, s96, 0xffffffc7
    s_cmp_eq_u32 s96, 0
    s_cbranch_scc0 L_pm_11
    s_bitcmp1_b32 s3, 0
    s_mov_b32 s57, 0x0
    s_mov_b32 s58, 0x0
    s_mov_b32 s14, 0x0
    s_mov_b32 s15, 0x0
L_pm_11:
    s_cmp_lt_u32 s56, 40
    s_cbranch_scc0 L_pm_12
    s_bitcmp1_b32 s3, 0
    s_mov_b32 s57, 0xffffffff
    s_mov_b32 s58, 0xf
    s_mov_b32 s14, 0xffffffff
    s_mov_b32 s15, 0x0
L_pm_12:
    s_cmp_eq_u32 s39, 1
    s_cbranch_scc0 L_pm_13
    s_bitcmp1_b32 s3, 0
    s_mov_b32 s57, 0xff
    s_mov_b32 s58, 0xff
    s_mov_b32 s14, 0xff00ff
    s_cselect_b32 s14, 0xff00ff00, s14
    s_mov_b32 s15, 0x0
L_pm_13:
    s_cmp_lg_u32 s13, 0
    s_cbranch_scc0 L_pm_14
    s_bitcmp1_b32 s3, 0
    s_mov_b32 s57, 0xff00ff
    s_cselect_b32 s57, 0xff00ff00, s57
    s_mov_b32 s58, 0x0
    s_mov_b32 s14, 0x0
    s_mov_b32 s15, 0x0
L_pm_14:
    s_and_b32 s96, s39, s59
    s_cbranch_scc0 L_pm_15
    s_bitcmp1_b32 s3, 0
    s_mov_b32 s57, 0x3ff
    s_mov_b32 s58, 0x3ff
    s_mov_b32 s14, 0x0
    s_mov_b32 s15, 0x0
L_pm_15:
    s_add_u32 s52, s8, s63
    s_addc_u32 s53, s9, 0
    s_mov_b32 s54, 262144
    s_mov_b32 s55, 0x20000
    v_and_b32 v2, 15, v0
    v_lshrrev_b32 v3, 1, v2
    v_and_b32 v37, 1, v2
    v_lshlrev_b32 v37, 4, v37
    v_mov_b32 v38, 0xffff
    v_lshlrev_b32 v37, v37, v38
    v_cmp_eq_u32 vcc, 0, v3
    v_mov_b32 v32, 0
    s_nop 0
    v_cndmask_b32 v20, 0, v37, vcc
    v_cmp_eq_u32 vcc, 1, v3
    v_mov_b32 v33, 0
    s_nop 0
    v_cndmask_b32 v21, 0, v37, vcc
    v_cmp_eq_u32 vcc, 2, v3
    v_mov_b32 v34, 0
    s_nop 0
    v_cndmask_b32 v22, 0, v37, vcc
    v_cmp_eq_u32 vcc, 3, v3
    v_mov_b32 v35, 0
    s_nop 0
    v_cndmask_b32 v23, 0, v37, vcc
    v_lshlrev_b32 v2, 4, v2
    s_lshl_b32 s98, s62, 8
    s_add_u32 s98, s98, 40960
    s_bitcmp0_b32 s57, 2
    s_cbranch_scc1 L_sf_16
    s_bitcmp0_b32 s58, 2
    s_cbranch_scc1 L_sf_16
    s_waitcnt vmcnt(1)
L_sf_16:
    buffer_load_dwordx4 v[48:51], v1, s[48:51], s97 offen offset:2048 nt
    s_bitcmp0_b32 s57, 3
    s_cbranch_scc1 L_sf_17
    s_waitcnt vmcnt(2)
    s_bitcmp0_b32 s58, 3
    s_cbranch_scc1 L_sf_17
    s_waitcnt vmcnt(1)
L_sf_17:
    buffer_load_dwordx4 v[52:55], v1, s[48:51], s97 offen offset:3072 nt
    s_add_u32 s97, s97, 32768
    v_add_u32 v1, 4096, v1
    v_and_b32 v1, 0x7fff, v1
    s_waitcnt vmcnt(3)
    s_bitcmp0_b32 s57, 4
    s_cbranch_scc1 L_sf_18
    s_waitcnt vmcnt(2)
    s_bitcmp0_b32 s58, 4
    s_cbranch_scc1 L_sf_18
    s_waitcnt vmcnt(1)
L_sf_18:
    buffer_load_dwordx4 v[56:59], v1, s[48:51], s97 offen offset:0 nt
    s_waitcnt vmcnt(3)
    s_bitcmp0_b32 s57, 5
    s_cbranch_scc1 L_sf_19
    s_waitcnt vmcnt(2)
    s_bitcmp0_b32 s58, 5
    s_cbranch_scc1 L_sf_19
    s_waitcnt vmcnt(1)
L_sf_19:
    buffer_load_dwordx4 v[60:63], v1, s[48:51], s97 offen offset:1024 nt
    s_waitcnt vmcnt(3)
    s_bitcmp0_b32 s57, 6
    s_cbranch_scc1 L_sf_20
    s_waitcnt vmcnt(2)
    s_bitcmp0_b32 s58, 6
    s_cbranch_scc1 L_sf_20
    s_waitcnt vmcnt(1)
L_sf_20:
    buffer_load_dwordx4 v[64:67], v1, s[48:51], s97 offen offset:2048 nt
    s_waitcnt vmcnt(3)
    s_bitcmp0_b32 s57, 7
    s_cbranch_scc1 L_sf_21
    s_waitcnt vmcnt(2)
    s_bitcmp0_b32 s58, 7
    s_cbranch_scc1 L_sf_21
    s_waitcnt vmcnt(1)
L_sf_21:
    buffer_load_dwordx4 v[68:71], v1, s[48:51], s97 offen offset:3072 nt
    s_add_u32 s97, s97, 32768
    v_add_u32 v1, 4096, v1
    v_and_b32 v1, 0x7fff, v1
    s_waitcnt vmcnt(3)
    s_bitcmp0_b32 s57, 8
    s_cbranch_scc1 L_sf_22
    s_waitcnt vmcnt(2)
    s_bitcmp0_b32 s58, 8
    s_cbranch_scc1 L_sf_22
    s_waitcnt vmcnt(1)
L_sf_22:
    buffer_load_dwordx4 v[72:75], v1, s[48:51], s97 offen offset:0 nt
    s_waitcnt vmcnt(3)
    s_bitcmp0_b32 s57, 9
    s_cbranch_scc1 L_sf_23
    s_waitcnt vmcnt(2)
    s_bitcmp0_b32 s58, 9
    s_cbranch_scc1 L_sf_23
    s_waitcnt vmcnt(1)
L_sf_23:
    buffer_load_dwordx4 v[76:79], v1, s[48:51], s97 offen offset:1024 nt
    s_waitcnt vmcnt(3)
    s_bitcmp0_b32 s57, 10
    s_cbranch_scc1 L_sf_24
    s_waitcnt vmcnt(2)
    s_bitcmp0_b32 s58, 10
    s_cbranch_scc1 L_sf_24
    s_waitcnt vmcnt(1)
L_sf_24:
    buffer_load_dwordx4 v[80:83], v1, s[48:51], s97 offen offset:2048 nt
    s_waitcnt vmcnt(3)
    s_bitcmp0_b32 s57, 11
    s_cbranch_scc1 L_sf_25
    s_waitcnt vmcnt(2)
    s_bitcmp0_b32 s58, 11
    s_cbranch_scc1 L_sf_25
    s_waitcnt vmcnt(1)
L_sf_25:
    buffer_load_dwordx4 v[84:87], v1, s[48:51], s97 offen offset:3072 nt
    s_add_u32 s97, s97, 32768
    v_add_u32 v1, 4096, v1
    v_and_b32 v1, 0x7fff, v1
    s_waitcnt vmcnt(3)
    s_bitcmp0_b32 s57, 12
    s_cbranch_scc1 L_sf_26
    s_waitcnt vmcnt(2)
    s_bitcmp0_b32 s58, 12
    s_cbranch_scc1 L_sf_26
    s_waitcnt vmcnt(1)
L_sf_26:
    buffer_load_dwordx4 v[88:91], v1, s[48:51], s97 offen offset:0 nt
    s_waitcnt vmcnt(3)
    s_bitcmp0_b32 s57, 13
    s_cbranch_scc1 L_sf_27
    s_waitcnt vmcnt(2)
    s_bitcmp0_b32 s58, 13
    s_cbranch_scc1 L_sf_27
    s_waitcnt vmcnt(1)
L_sf_27:
    buffer_load_dwordx4 v[92:95], v1, s[48:51], s97 offen offset:1024 nt
    s_waitcnt vmcnt(3)
    s_bitcmp0_b32 s57, 14
    s_cbranch_scc1 L_sf_28
    s_waitcnt vmcnt(2)
    s_bitcmp0_b32 s58, 14
    s_cbranch_scc1 L_sf_28
    s_waitcnt vmcnt(1)
L_sf_28:
    buffer_load_dwordx4 v[96:99], v1, s[48:51], s97 offen offset:2048 nt
    s_waitcnt vmcnt(3)
    s_bitcmp0_b32 s57, 15
    s_cbranch_scc1 L_sf_29
    s_waitcnt vmcnt(2)
    s_bitcmp0_b32 s58, 15
    s_cbranch_scc1 L_sf_29
    s_waitcnt vmcnt(1)
L_sf_29:
    buffer_load_dwordx4 v[100:103], v1, s[48:51], s97 offen offset:3072 nt
    s_add_u32 s97, s97, 32768
    v_add_u32 v1, 4096, v1
    v_and_b32 v1, 0x7fff, v1
    s_waitcnt vmcnt(3)
    s_bitcmp0_b32 s57, 16
    s_cbranch_scc1 L_sf_30
    s_waitcnt vmcnt(2)
    s_bitcmp0_b32 s58, 16
    s_cbranch_scc1 L_sf_30
    s_waitcnt vmcnt(1)
L_sf_30:
    buffer_load_dwordx4 v[104:107], v1, s[48:51], s97 offen offset:0 nt
    s_waitcnt vmcnt(3)
    s_bitcmp0_b32 s57, 17
    s_cbranch_scc1 L_sf_31
    s_waitcnt vmcnt(2)
    s_bitcmp0_b32 s58, 17
    s_cbranch_scc1 L_sf_31
    s_waitcnt vmcnt(1)
L_sf_31:
    buffer_load_dwordx4 v[108:111], v1, s[48:51], s97 offen offset:1024 nt
    s_waitcnt vmcnt(3)
    s_bitcmp0_b32 s57, 18
    s_cbranch_scc1 L_sf_32
    s_waitcnt vmcnt(2)
    s_bitcmp0_b32 s58, 18
    s_cbranch_scc1 L_sf_32
    s_waitcnt vmcnt(1)
L_sf_32:
    buffer_load_dwordx4 v[112:115], v1, s[48:51], s97 offen offset:2048 nt
    s_waitcnt vmcnt(3)
    s_bitcmp0_b32 s57, 19
    s_cbranch_scc1 L_sf_33
    s_waitcnt vmcnt(2)
    s_bitcmp0_b32 s58, 19
    s_cbranch_scc1 L_sf_33
    s_waitcnt vmcnt(1)
L_sf_33:
    buffer_load_dwordx4 v[116:119], v1, s[48:51], s97 offen offset:3072 nt
    s_add_u32 s97, s97, 32768
    v_add_u32 v1, 4096, v1
    v_and_b32 v1, 0x7fff, v1
    s_waitcnt vmcnt(3)
    s_bitcmp0_b32 s57, 20
    s_cbranch_scc1 L_sf_34
    s_waitcnt vmcnt(2)
    s_bitcmp0_b32 s58, 20
    s_cbranch_scc1 L_sf_34
    s_waitcnt vmcnt(1)
L_sf_34:
    buffer_load_dwordx4 v[120:123], v1, s[48:51], s97 offen offset:0 nt
    s_waitcnt vmcnt(3)
    s_bitcmp0_b32 s57, 21
    s_cbranch_scc1 L_sf_35
    s_waitcnt vmcnt(2)
    s_bitcmp0_b32 s58, 21
    s_cbranch_scc1 L_sf_35
    s_waitcnt vmcnt(1)
L_sf_35:
    buffer_load_dwordx4 v[124:127], v1, s[48:51], s97 offen offset:1024 nt
    s_cmp_eq_u32 s12, -1
    s_cbranch_scc1 L_k_nopf
    s_waitcnt vmcnt(3)
    s_bitcmp0_b32 s57, 22
    s_cbranch_scc1 L_sf_36
    s_waitcnt vmcnt(2)
    s_bitcmp0_b32 s58, 22
    s_cbranch_scc1 L_sf_36
    s_waitcnt vmcnt(1)
L_sf_36:
    buffer_load_dwordx4 v[128:131], v1, s[48:51], s97 offen offset:2048 nt
    s_waitcnt vmcnt(3)
    s_bitcmp0_b32 s57, 23
    s_cbranch_scc1 L_sf_37
    s_waitcnt vmcnt(2)
    s_bitcmp0_b32 s58, 23
    s_cbranch_scc1 L_sf_37
    s_waitcnt vmcnt(1)
L_sf_37:
    buffer_load_dwordx4 v[132:135], v1, s[48:51], s97 offen offset:3072 nt
    s_add_u32 s97, s97, 32768
    v_add_u32 v1, 4096, v1
    v_and_b32 v1, 0x7fff, v1
    s_waitcnt vmcnt(3)
    s_bitcmp0_b32 s57, 24
    s_cbranch_scc1 L_sf_38
    s_waitcnt vmcnt(2)
    s_bitcmp0_b32 s58, 24
    s_cbranch_scc1 L_sf_38
    s_waitcnt vmcnt(1)
L_sf_38:
    buffer_load_dwordx4 v[136:139], v1, s[48:51], s97 offen offset:0 nt
    s_waitcnt vmcnt(3)
    s_bitcmp0_b32 s57, 25
    s_cbranch_scc1 L_sf_39
    s_waitcnt vmcnt(2)
    s_bitcmp0_b32 s58, 25
    s_cbranch_scc1 L_sf_39
    s_waitcnt vmcnt(1)
L_sf_39:
    buffer_load_dwordx4 v[140:143], v1, s[48:51], s97 offen offset:1024 nt
    s_waitcnt vmcnt(3)
    s_bitcmp0_b32 s57, 26
    s_cbranch_scc1 L_sf_40
    s_waitcnt vmcnt(2)
    s_bitcmp0_b32 s58, 26
    s_cbranch_scc1 L_sf_40
    s_waitcnt vmcnt(1)
L_sf_40:
    buffer_load_dwordx4 v[144:147], v1, s[48:51], s97 offen offset:2048 nt
    s_waitcnt vmcnt(3)
    s_bitcmp0_b32 s57, 27
    s_cbranch_scc1 L_sf_41
    s_waitcnt vmcnt(2)
    s_bitcmp0_b32 s58, 27
    s_cbranch_scc1 L_sf_41
    s_waitcnt vmcnt(1)
L_sf_41:
    buffer_load_dwordx4 v[148:151], v1, s[48:51], s97 offen offset:3072 nt
    s_add_u32 s97, s97, 32768
    v_add_u32 v1, 4096, v1
    v_and_b32 v1, 0x7fff, v1
    s_waitcnt vmcnt(3)
    s_bitcmp0_b32 s57, 28
    s_cbranch_scc1 L_sf_42
    s_waitcnt vmcnt(2)
    s_bitcmp0_b32 s58, 28
    s_cbranch_scc1 L_sf_42
    s_waitcnt vmcnt(1)
L_sf_42:
    buffer_load_dwordx4 v[152:155], v1, s[48:51], s97 offen offset:0 nt
    s_waitcnt vmcnt(3)
    s_bitcmp0_b32 s57, 29
    s_cbranch_scc1 L_sf_43
    s_waitcnt vmcnt(2)
    s_bitcmp0_b32 s58, 29
    s_cbranch_scc1 L_sf_43
    s_waitcnt vmcnt(1)
L_sf_43:
    buffer_load_dwordx4 v[156:159], v1, s[48:51], s97 offen offset:1024 nt
    s_waitcnt vmcnt(3)
    s_bitcmp0_b32 s57, 30
    s_cbranch_scc1 L_sf_44
    s_waitcnt vmcnt(2)
    s_bitcmp0_b32 s58, 30
    s_cbranch_scc1 L_sf_44
    s_waitcnt vmcnt(1)
L_sf_44:
    buffer_load_dwordx4 v[160:163], v1, s[48:51], s97 offen offset:2048 nt
    v_and_b32 v39, 31, v0
    v_lshlrev_b32 v39, 2, v39
    buffer_load_dword v37, v39, s[44:47], 0 offen sc1
    s_waitcnt vmcnt(4)
    s_bitcmp0_b32 s57, 31
    s_cbranch_scc1 L_sf_45
    s_waitcnt vmcnt(3)
    s_bitcmp0_b32 s58, 31
    s_cbranch_scc1 L_sf_45
    s_waitcnt vmcnt(2)
L_sf_45:
    buffer_load_dwordx4 v[164:167], v1, s[48:51], s97 offen offset:3072 nt
    s_mov_b32 s97, 0
    v_add_u32 v1, 4096, v1
    v_and_b32 v1, 0x7fff, v1
    s_waitcnt vmcnt(4)
    s_bitcmp0_b32 s14, 0
    s_cbranch_scc1 L_sf_46
    s_waitcnt vmcnt(3)
    s_bitcmp0_b32 s15, 0
    s_cbranch_scc1 L_sf_46
    s_waitcnt vmcnt(2)
L_sf_46:
    s_add_u32 m0, s12, 0
    s_nop 0
    buffer_load_dwordx4 v1, s[52:55], s97 offen offset:0 nt lds
    s_waitcnt vmcnt(4)
    s_bitcmp0_b32 s14, 1
    s_cbranch_scc1 L_sf_47
    s_waitcnt vmcnt(3)
    s_bitcmp0_b32 s15, 1
    s_cbranch_scc1 L_sf_47
    s_waitcnt vmcnt(1)
L_sf_47:
    buffer_load_dwordx4 v1, s[52:55], s97 offen offset:1024 nt lds
    s_waitcnt vmcnt(4)
    s_bitcmp0_b32 s14, 2
    s_cbranch_scc1 L_sf_48
    s_waitcnt vmcnt(2)
    s_bitcmp0_b32 s15, 2
    s_cbranch_scc1 L_sf_48
    s_waitcnt vmcnt(1)
L_sf_48:
    buffer_load_dwordx4 v1, s[52:55], s97 offen offset:2048 nt lds
    s_waitcnt vmcnt(3)
    s_bitcmp0_b32 s14, 3
    s_cbranch_scc1 L_sf_49
    s_waitcnt vmcnt(2)
    s_bitcmp0_b32 s15, 3
    s_cbranch_scc1 L_sf_49
    s_waitcnt vmcnt(1)
L_sf_49:
    buffer_load_dwordx4 v1, s[52:55], s97 offen offset:3072 nt lds
    s_add_u32 s97, s97, 32768
    v_add_u32 v1, 4096, v1
    v_and_b32 v1, 0x7fff, v1
    v_cmp_eq_u32 vcc, 0, v37
    s_nop 0
    s_or_b32 s96, vcc_lo, vcc_hi
    buffer_load_dwordx4 v[4:7], v2, s[40:43], s98 offen sc1
    s_waitcnt vmcnt(4)
    s_bitcmp0_b32 s14, 4
    s_cbranch_scc1 L_sf_50
    s_waitcnt vmcnt(3)
    s_bitcmp0_b32 s15, 4
    s_cbranch_scc1 L_sf_50
    s_waitcnt vmcnt(2)
L_sf_50:
    s_add_u32 m0, s12, 4096
    s_nop 0
    buffer_load_dwordx4 v1, s[52:55], s97 offen offset:0 nt lds
    s_waitcnt vmcnt(4)
    s_bitcmp0_b32 s14, 5
    s_cbranch_scc1 L_sf_51
    s_waitcnt vmcnt(3)
    s_bitcmp0_b32 s15, 5
    s_cbranch_scc1 L_sf_51
    s_waitcnt vmcnt(2)
L_sf_51:
    buffer_load_dwordx4 v1, s[52:55], s97 offen offset:1024 nt lds
    s_waitcnt vmcnt(4)
    s_bitcmp0_b32 s14, 6
    s_cbranch_scc1 L_sf_52
    s_waitcnt vmcnt(3)
    s_bitcmp0_b32 s15, 6
    s_cbranch_scc1 L_sf_52
    s_waitcnt vmcnt(1)
L_sf_52:
    buffer_load_dwordx4 v1, s[52:55], s97 offen offset:2048 nt lds
    s_waitcnt vmcnt(4)
    s_bitcmp0_b32 s14, 7
    s_cbranch_scc1 L_sf_53
    s_waitcnt vmcnt(2)
    s_bitcmp0_b32 s15, 7
    s_cbranch_scc1 L_sf_53
    s_waitcnt vmcnt(1)
L_sf_53:
    buffer_load_dwordx4 v1, s[52:55], s97 offen offset:3072 nt lds
    s_add_u32 s97, s97, 32768
    v_add_u32 v1, 4096, v1
    v_and_b32 v1, 0x7fff, v1
L_k_join:
    s_waitcnt vmcnt(4)
    v_max3_u32 v38, v4, v5, v6
    v_max_u32 v38, v38, v7
    v_cmp_eq_u32 vcc, -1, v38
    s_cmp_lg_u32 s96, 0
    s_cbranch_scc1 L_qslow
    s_cbranch_vccnz L_qslow2
L_qok:
    v_dot2_f32_bf16 v8, v72, v4, 0
    v_dot2_f32_bf16 v9, v76, v4, 0
    v_dot2_f32_bf16 v10, v80, v4, 0
    v_dot2_f32_bf16 v11, v84, v4, 0
    v_dot2_f32_bf16 v24, v88, v4, 0
    v_dot2_f32_bf16 v25, v92, v4, 0
    v_dot2_f32_bf16 v26, v96, v4, 0
    v_dot2_f32_bf16 v27, v100, v4, 0
    v_dot2_f32_bf16 v8, v73, v5, v8
    v_dot2_f32_bf16 v9, v77, v5, v9
    v_dot2_f32_bf16 v10, v81, v5, v10
    v_dot2_f32_bf16 v11, v85, v5, v11
    v_dot2_f32_bf16 v24, v89, v5, v24
    v_dot2_f32_bf16 v25, v93, v5, v25
    v_dot2_f32_bf16 v26, v97, v5, v26
    v_dot2_f32_bf16 v27, v101, v5, v27
    v_dot2_f32_bf16 v8, v74, v6, v8
    v_dot2_f32_bf16 v9, v78, v6, v9
    v_dot2_f32_bf16 v10, v82, v6, v10
    v_dot2_f32_bf16 v11, v86, v6, v11
    v_dot2_f32_bf16 v24, v90, v6, v24
    v_dot2_f32_bf16 v25, v94, v6, v25
    v_dot2_f32_bf16 v26, v98, v6, v26
    v_dot2_f32_bf16 v27, v102, v6, v27
    v_dot2_f32_bf16 v8, v75, v7, v8
    v_dot2_f32_bf16 v9, v79, v7, v9
    v_dot2_f32_bf16 v10, v83, v7, v10
    v_dot2_f32_bf16 v11, v87, v7, v11
    v_dot2_f32_bf16 v24, v91, v7, v24
    v_dot2_f32_bf16 v25, v95, v7, v25
    v_dot2_f32_bf16 v26, v99, v7, v26
    v_dot2_f32_bf16 v27, v103, v7, v27
    v_add_f32_dpp v8, v8, v8 row_ror:8 row_mask:0xf bank_mask:0x3
    v_add_f32_dpp v10, v10, v10 row_ror:8 row_mask:0xf bank_mask:0x3
    v_add_f32_dpp v24, v24, v24 row_ror:8 row_mask:0xf bank_mask:0x3
    v_add_f32_dpp v26, v26, v26 row_ror:8 row_mask:0xf bank_mask:0x3
    v_add_f32_dpp v8, v9, v9 row_ror:8 row_mask:0xf bank_mask:0xc
    v_add_f32_dpp v10, v11, v11 row_ror:8 row_mask:0xf bank_mask:0xc
    v_add_f32_dpp v24, v25, v25 row_ror:8 row_mask:0xf bank_mask:0xc
    v_add_f32_dpp v26, v27, v27 row_ror:8 row_mask:0xf bank_mask:0xc
    v_add_f32_dpp v14, v8, v8 row_half_mirror row_mask:0xf bank_mask:0x5
    v_add_f32_dpp v15, v24, v24 row_half_mirror row_mask:0xf bank_mask:0x5
    v_add_f32_dpp v14, v10, v10 row_half_mirror row_mask:0xf bank_mask:0xa
    v_add_f32_dpp v15, v26, v26 row_half_mirror row_mask:0xf bank_mask:0xa
    s_nop 0
    v_add_f32_dpp v14, v14, v14 quad_perm:[1,0,3,2] row_mask:0xf bank_mask:0xf
    v_add_f32_dpp v15, v15, v15 quad_perm:[1,0,3,2] row_mask:0xf bank_mask:0xf
    s_nop 0
    v_add_f32_dpp v14, v14, v14 quad_perm:[2,3,0,1] row_mask:0xf bank_mask:0xf
    v_add_f32_dpp v15, v15, v15 quad_perm:[2,3,0,1] row_mask:0xf bank_mask:0xf
    s_waitcnt vmcnt(3)
    s_bitcmp0_b32 s14, 8
    s_cbranch_scc1 L_sf_64
    s_waitcnt vmcnt(2)
    s_bitcmp0_b32 s15, 8
    s_cbranch_scc1 L_sf_64
    s_waitcnt vmcnt(1)
L_sf_64:
    buffer_load_dwordx4 v[72:75], v1, s[52:55], s97 offen offset:0 nt
    v_dot2_f32_bf16 v8, v40, v4, 0
    v_dot2_f32_bf16 v9, v44, v4, 0
    v_dot2_f32_bf16 v10, v48, v4, 0
    v_dot2_f32_bf16 v11, v52, v4, 0
    v_dot2_f32_bf16 v24, v56, v4, 0
    v_dot2_f32_bf16 v25, v60, v4, 0
    v_dot2_f32_bf16 v26, v64, v4, 0
    v_dot2_f32_bf16 v27, v68, v4, 0
    v_dot2_f32_bf16 v28, v104, v4, 0
    v_dot2_f32_bf16 v29, v108, v4, 0
    v_dot2_f32_bf16 v30, v112, v4, 0
    v_dot2_f32_bf16 v31, v116, v4, 0
    v_dot2_f32_bf16 v8, v41, v5, v8
    v_dot2_f32_bf16 v9, v45, v5, v9
    v_dot2_f32_bf16 v10, v49, v5, v10
    v_dot2_f32_bf16 v11, v53, v5, v11
    v_dot2_f32_bf16 v24, v57, v5, v24
    v_dot2_f32_bf16 v25, v61, v5, v25
    v_dot2_f32_bf16 v26, v65, v5, v26
    v_dot2_f32_bf16 v27, v69, v5, v27
    v_dot2_f32_bf16 v28, v105, v5, v28
    v_dot2_f32_bf16 v29, v109, v5, v29
    v_dot2_f32_bf16 v30, v113, v5, v30
    v_dot2_f32_bf16 v31, v117, v5, v31
    v_dot2_f32_bf16 v8, v42, v6, v8
    v_dot2_f32_bf16 v9, v46, v6, v9
    v_dot2_f32_bf16 v10, v50, v6, v10
    v_dot2_f32_bf16 v11, v54, v6, v11
    v_dot2_f32_bf16 v24, v58, v6, v24
    v_dot2_f32_bf16 v25, v62, v6, v25
    v_dot2_f32_bf16 v26, v66, v6, v26
    v_dot2_f32_bf16 v27, v70, v6, v27
    v_dot2_f32_bf16 v28, v106, v6, v28
    v_dot2_f32_bf16 v29, v110, v6, v29
    v_dot2_f32_bf16 v30, v114, v6, v30
    v_dot2_f32_bf16 v31, v118, v6, v31
    v_dot2_f32_bf16 v8, v43, v7, v8
    v_dot2_f32_bf16 v9, v47, v7, v9
    v_dot2_f32_bf16 v10, v51, v7, v10
    v_dot2_f32_bf16 v11, v55, v7, v11
    v_dot2_f32_bf16 v24, v59, v7, v24
    v_dot2_f32_bf16 v25, v63, v7, v25
    v_dot2_f32_bf16 v26, v67, v7, v26
    v_dot2_f32_bf16 v27, v71, v7, v27
    v_dot2_f32_bf16 v28, v107, v7, v28
    v_dot2_f32_bf16 v29, v111, v7, v29
    v_dot2_f32_bf16 v30, v115, v7, v30
    v_dot2_f32_bf16 v31, v119, v7, v31
    v_add_f32_dpp v8, v8, v8 row_ror:8 row_mask:0xf bank_mask:0x3
    v_add_f32_dpp v10, v10, v10 row_ror:8 row_mask:0xf bank_mask:0x3
    v_add_f32_dpp v24, v24, v24 row_ror:8 row_mask:0xf bank_mask:0x3
    v_add_f32_dpp v26, v26, v26 row_ror:8 row_mask:0xf bank_mask:0x3
    v_add_f32_dpp v28, v28, v28 row_ror:8 row_mask:0xf bank_mask:0x3
    v_add_f32_dpp v30, v30, v30 row_ror:8 row_mask:0xf bank_mask:0x3
    v_add_f32_dpp v8, v9, v9 row_ror:8 row_mask:0xf bank_mask:0xc
    v_add_f32_dpp v10, v11, v11 row_ror:8 row_mask:0xf bank_mask:0xc
    v_add_f32_dpp v24, v25, v25 row_ror:8 row_mask:0xf bank_mask:0xc
    v_add_f32_dpp v26, v27, v27 row_ror:8 row_mask:0xf bank_mask:0xc
    v_add_f32_dpp v28, v29, v29 row_ror:8 row_mask:0xf bank_mask:0xc
    v_add_f32_dpp v30, v31, v31 row_ror:8 row_mask:0xf bank_mask:0xc
    v_add_f32_dpp v12, v8, v8 row_half_mirror row_mask:0xf bank_mask:0x5
    v_add_f32_dpp v13, v24, v24 row_half_mirror row_mask:0xf bank_mask:0x5
    v_add_f32_dpp v16, v28, v28 row_half_mirror row_mask:0xf bank_mask:0x5
    v_add_f32_dpp v12, v10, v10 row_half_mirror row_mask:0xf bank_mask:0xa
    v_add_f32_dpp v13, v26, v26 row_half_mirror row_mask:0xf bank_mask:0xa
    v_add_f32_dpp v16, v30, v30 row_half_mirror row_mask:0xf bank_mask:0xa
    v_add_f32_dpp v12, v12, v12 quad_perm:[1,0,3,2] row_mask:0xf bank_mask:0xf
    v_add_f32_dpp v13, v13, v13 quad_perm:[1,0,3,2] row_mask:0xf bank_mask:0xf
    v_add_f32_dpp v16, v16, v16 quad_perm:[1,0,3,2] row_mask:0xf bank_mask:0xf
    v_add_f32_dpp v12, v12, v12 quad_perm:[2,3,0,1] row_mask:0xf bank_mask:0xf
    v_add_f32_dpp v13, v13, v13 quad_perm:[2,3,0,1] row_mask:0xf bank_mask:0xf
    v_add_f32_dpp v16, v16, v16 quad_perm:[2,3,0,1] row_mask:0xf bank_mask:0xf
    s_waitcnt vmcnt(3)
    s_bitcmp0_b32 s14, 9
    s_cbranch_scc1 L_sf_65
    s_waitcnt vmcnt(2)
    s_bitcmp0_b32 s15, 9
    s_cbranch_scc1 L_sf_65
    s_waitcnt vmcnt(1)
L_sf_65:
    buffer_load_dwordx4 v[76:79], v1, s[52:55], s97 offen offset:1024 nt
    v_dot2_f32_bf16 v8, v120, v4, 0
    v_dot2_f32_bf16 v9, v124, v4, 0
    v_dot2_f32_bf16 v10, v128, v4, 0
    v_dot2_f32_bf16 v11, v132, v4, 0
    v_dot2_f32_bf16 v24, v136, v4, 0
    v_dot2_f32_bf16 v25, v140, v4, 0
    v_dot2_f32_bf16 v26, v144, v4, 0
    v_dot2_f32_bf16 v27, v148, v4, 0
    v_dot2_f32_bf16 v8, v121, v5, v8
    v_dot2_f32_bf16 v9, v125, v5, v9
    v_dot2_f32_bf16 v10, v129, v5, v10
    v_dot2_f32_bf16 v11, v133, v5, v11
    v_dot2_f32_bf16 v24, v137, v5, v24
    v_dot2_f32_bf16 v25, v141, v5, v25
    v_dot2_f32_bf16 v26, v145, v5, v26
    v_dot2_f32_bf16 v27, v149, v5, v27
    v_dot2_f32_bf16 v8, v122, v6, v8
    v_dot2_f32_bf16 v9, v126, v6, v9
    v_dot2_f32_bf16 v10, v130, v6, v10
    v_dot2_f32_bf16 v11, v134, v6, v11
    v_dot2_f32_bf16 v24, v138, v6, v24
    v_dot2_f32_bf16 v25, v142, v6, v25
    v_dot2_f32_bf16 v26, v146, v6, v26
    v_dot2_f32_bf16 v27, v150, v6, v27
    v_dot2_f32_bf16 v8, v123, v7, v8
    v_dot2_f32_bf16 v9, v127, v7, v9
    v_dot2_f32_bf16 v10, v131, v7, v10
    v_dot2_f32_bf16 v11, v135, v7, v11
    v_dot2_f32_bf16 v24, v139, v7, v24
    v_dot2_f32_bf16 v25, v143, v7, v25
    v_dot2_f32_bf16 v26, v147, v7, v26
    v_dot2_f32_bf16 v27, v151, v7, v27
    v_add_f32_dpp v8, v8, v8 row_ror:8 row_mask:0xf bank_mask:0x3
    v_add_f32_dpp v10, v10, v10 row_ror:8 row_mask:0xf bank_mask:0x3
    v_add_f32_dpp v24, v24, v24 row_ror:8 row_mask:0xf bank_mask:0x3
    v_add_f32_dpp v26, v26, v26 row_ror:8 row_mask:0xf bank_mask:0x3
    v_add_f32_dpp v8, v9, v9 row_ror:8 row_mask:0xf bank_mask:0xc
    v_add_f32_dpp v10, v11, v11 row_ror:8 row_mask:0xf bank_mask:0xc
    v_add_f32_dpp v24, v25, v25 row_ror:8 row_mask:0xf bank_mask:0xc
    v_add_f32_dpp v26, v27, v27 row_ror:8 row_mask:0xf bank_mask:0xc
    v_add_f32_dpp v17, v8, v8 row_half_mirror row_mask:0xf bank_mask:0x5
    v_add_f32_dpp v18, v24, v24 row_half_mirror row_mask:0xf bank_mask:0x5
    v_add_f32_dpp v17, v10, v10 row_half_mirror row_mask:0xf bank_mask:0xa
    v_add_f32_dpp v18, v26, v26 row_half_mirror row_mask:0xf bank_mask:0xa
    s_nop 0
    v_add_f32_dpp v17, v17, v17 quad_perm:[1,0,3,2] row_mask:0xf bank_mask:0xf
    v_add_f32_dpp v18, v18, v18 quad_perm:[1,0,3,2] row_mask:0xf bank_mask:0xf
    s_nop 0
    v_add_f32_dpp v17, v17, v17 quad_perm:[2,3,0,1] row_mask:0xf bank_mask:0xf
    v_add_f32_dpp v18, v18, v18 quad_perm:[2,3,0,1] row_mask:0xf bank_mask:0xf
    s_waitcnt vmcnt(3)
    s_bitcmp0_b32 s14, 10
    s_cbranch_scc1 L_sf_66
    s_waitcnt vmcnt(2)
    s_bitcmp0_b32 s15, 10
    s_cbranch_scc1 L_sf_66
    s_waitcnt vmcnt(1)
L_sf_66:
    buffer_load_dwordx4 v[80:83], v1, s[52:55], s97 offen offset:2048 nt
    s_waitcnt vmcnt(3)
    s_bitcmp0_b32 s14, 11
    s_cbranch_scc1 L_sf_67
    s_waitcnt vmcnt(2)
    s_bitcmp0_b32 s15, 11
    s_cbranch_scc1 L_sf_67
    s_waitcnt vmcnt(1)
L_sf_67:
    buffer_load_dwordx4 v[84:87], v1, s[52:55], s97 offen offset:3072 nt
    s_add_u32 s97, s97, 32768
    v_add_u32 v1, 4096, v1
    v_and_b32 v1, 0x7fff, v1
    s_cmp_eq_u32 s12, -1
    s_cbranch_scc1 L_nopfrd
    v_lshl_add_u32 v38, v0, 4, s12
    ds_read_b128 v[40:43], v38 offset:0
    ds_read_b128 v[44:47], v38 offset:1024
    ds_read_b128 v[48:51], v38 offset:2048
    ds_read_b128 v[52:55], v38 offset:3072
    ds_read_b128 v[56:59], v38 offset:4096
    ds_read_b128 v[60:63], v38 offset:5120
    ds_read_b128 v[64:67], v38 offset:6144
    ds_read_b128 v[68:71], v38 offset:7168
L_nopfrd:
    v_dot2_f32_bf16 v8, v152, v4, 0
    v_dot2_f32_bf16 v9, v156, v4, 0
    v_dot2_f32_bf16 v10, v160, v4, 0
    v_dot2_f32_bf16 v11, v164, v4, 0
    v_dot2_f32_bf16 v8, v153, v5, v8
    v_dot2_f32_bf16 v9, v157, v5, v9
    v_dot2_f32_bf16 v10, v161, v5, v10
    v_dot2_f32_bf16 v11, v165, v5, v11
    v_dot2_f32_bf16 v8, v154, v6, v8
    v_dot2_f32_bf16 v9, v158, v6, v9
    v_dot2_f32_bf16 v10, v162, v6, v10
    v_dot2_f32_bf16 v11, v166, v6, v11
    v_dot2_f32_bf16 v8, v155, v7, v8
    v_dot2_f32_bf16 v9, v159, v7, v9
    v_dot2_f32_bf16 v10, v163, v7, v10
    v_dot2_f32_bf16 v11, v167, v7, v11
    v_add_f32_dpp v8, v8, v8 row_ror:8 row_mask:0xf bank_mask:0x3
    s_nop 0
    v_add_f32_dpp v10, v10, v10 row_ror:8 row_mask:0xf bank_mask:0x3
    v_add_f32_dpp v8, v9, v9 row_ror:8 row_mask:0xf bank_mask:0xc
    v_add_f32_dpp v10, v11, v11 row_ror:8 row_mask:0xf bank_mask:0xc
    s_nop 0
    v_add_f32_dpp v19, v8, v8 row_half_mirror row_mask:0xf bank_mask:0x5
    v_add_f32_dpp v19, v10, v10 row_half_mirror row_mask:0xf bank_mask:0xa
    s_nop 1
    v_add_f32_dpp v19, v19, v19 quad_perm:[1,0,3,2] row_mask:0xf bank_mask:0xf
    s_nop 1
    v_add_f32_dpp v19, v19, v19 quad_perm:[2,3,0,1] row_mask:0xf bank_mask:0xf
    v_max3_f32 v3, v12, v13, v14
    v_max3_f32 v8, v15, v16, v17
    v_max3_f32 v3, v3, v18, v19
    v_max_f32 v3, v3, v8
    s_nop 1
    v_max_f32_dpp v3, v3, v3 row_ror:4 row_mask:0xf bank_mask:0xf
    s_nop 1
    v_max_f32_dpp v3, v3, v3 row_ror:8 row_mask:0xf bank_mask:0xf
    v_mov_b32 v8, v3
    s_nop 1
    v_permlane16_swap_b32 v3, v8
    v_max_f32 v3, v3, v8
    v_mov_b32 v8, v3
    s_nop 1
    v_permlane32_swap_b32 v3, v8
    v_max_f32 v3, v3, v8
    s_mov_b32 s96, 0x3e0293ee
    v_mul_f32 v8, s96, v3
    v_fma_f32 v12, v12, s96, -v8
    v_fma_f32 v13, v13, s96, -v8
    v_fma_f32 v14, v14, s96, -v8
    v_fma_f32 v15, v15, s96, -v8
    v_fma_f32 v16, v16, s96, -v8
    v_fma_f32 v17, v17, s96, -v8
    v_fma_f32 v18, v18, s96, -v8
    v_fma_f32 v19, v19, s96, -v8
    v_exp_f32 v12, v12
    v_exp_f32 v13, v13
    v_exp_f32 v14, v14
    v_exp_f32 v15, v15
    v_exp_f32 v16, v16
    v_exp_f32 v17, v17
    v_exp_f32 v18, v18
    v_exp_f32 v19, v19
    v_add_f32 v9, v12, v13
    v_add_f32 v10, v14, v15
    v_add_f32 v11, v16, v17
    v_add_f32 v3, v18, v19
    v_add_f32 v9, v9, v10
    v_add_f32 v3, v3, v11
    v_add_f32 v9, v9, v3
    v_cvt_pk_bf16_f32 v12, v12, v12
    v_cvt_pk_bf16_f32 v13, v13, v13
    v_cvt_pk_bf16_f32 v14, v14, v14
    v_cvt_pk_bf16_f32 v15, v15, v15
    v_cvt_pk_bf16_f32 v16, v16, v16
    v_cvt_pk_bf16_f32 v17, v17, v17
    v_cvt_pk_bf16_f32 v18, v18, v18
    v_cvt_pk_bf16_f32 v19, v19, v19
    v_add_f32_dpp v9, v9, v9 row_ror:4 row_mask:0xf bank_mask:0xf
    s_nop 1
    v_add_f32_dpp v9, v9, v9 row_ror:8 row_mask:0xf bank_mask:0xf
    v_mov_b32 v10, v9
    s_nop 1
    v_permlane16_swap_b32 v9, v10
    v_add_f32 v9, v9, v10
    v_mov_b32 v10, v9
    s_nop 1
    v_permlane32_swap_b32 v9, v10
    v_add_f32 v9, v9, v10
    s_mov_b64 exec, 1
    s_cmp_lg_u32 s13, 0
    s_cbranch_scc1 L_mljob
    s_lshl_b32 s96, s3, 3
    s_add_u32 s96, s96, 161920
    v_mov_b32 v10, s96
    v_mov_b32 v11, 162068
    v_mov_b32 v3, 1
    ds_write_b64 v10, v[8:9]
    ds_add_u32 v11, v3
L_mldone:
    s_mov_b64 exec, -1
    v_lshrrev_b32 v2, 1, v2
    v_and_b32_dpp v24, v14, v20 row_newbcast:0 row_mask:0xf bank_mask:0xf
    v_and_b32_dpp v25, v14, v21 row_newbcast:0 row_mask:0xf bank_mask:0xf
    v_and_b32_dpp v26, v14, v22 row_newbcast:0 row_mask:0xf bank_mask:0xf
    v_and_b32_dpp v27, v14, v23 row_newbcast:0 row_mask:0xf bank_mask:0xf
    s_waitcnt vmcnt(3)
    s_bitcmp0_b32 s14, 12
    s_cbranch_scc1 L_sf_68
    s_waitcnt vmcnt(2)
    s_bitcmp0_b32 s15, 12
    s_cbranch_scc1 L_sf_68
    s_waitcnt vmcnt(1)
L_sf_68:
    buffer_load_dwordx4 v[88:91], v1, s[52:55], s97 offen offset:0 nt
    v_mfma_f32_16x16x32_bf16 v[32:35], v[24:27], v[72:75], v[32:35]
    s_cmp_eq_u32 s12, -1
    s_cbranch_scc1 L_nopfpv8
    s_waitcnt lgkmcnt(0)
    v_and_b32_dpp v24, v12, v20 row_newbcast:0 row_mask:0xf bank_mask:0xf
    v_and_b32_dpp v25, v12, v21 row_newbcast:0 row_mask:0xf bank_mask:0xf
    v_and_b32_dpp v26, v12, v22 row_newbcast:0 row_mask:0xf bank_mask:0xf
    v_and_b32_dpp v27, v12, v23 row_newbcast:0 row_mask:0xf bank_mask:0xf
    s_nop 1
    v_mfma_f32_16x16x32_bf16 v[32:35], v[24:27], v[40:43], v[32:35]
    v_and_b32_dpp v28, v12, v20 row_newbcast:8 row_mask:0xf bank_mask:0xf
    v_and_b32_dpp v29, v12, v21 row_newbcast:8 row_mask:0xf bank_mask:0xf
    v_and_b32_dpp v30, v12, v22 row_newbcast:8 row_mask:0xf bank_mask:0xf
    v_and_b32_dpp v31, v12, v23 row_newbcast:8 row_mask:0xf bank_mask:0xf
    s_nop 1
    v_mfma_f32_16x16x32_bf16 v[32:35], v[28:31], v[44:47], v[32:35]
    v_and_b32_dpp v24, v12, v20 row_newbcast:4 row_mask:0xf bank_mask:0xf
    v_and_b32_dpp v25, v12, v21 row_newbcast:4 row_mask:0xf bank_mask:0xf
    v_and_b32_dpp v26, v12, v22 row_newbcast:4 row_mask:0xf bank_mask:0xf
    v_and_b32_dpp v27, v12, v23 row_newbcast:4 row_mask:0xf bank_mask:0xf
    s_nop 1
    v_mfma_f32_16x16x32_bf16 v[32:35], v[24:27], v[48:51], v[32:35]
    v_and_b32_dpp v28, v12, v20 row_newbcast:12 row_mask:0xf bank_mask:0xf
    v_and_b32_dpp v29, v12, v21 row_newbcast:12 row_mask:0xf bank_mask:0xf
    v_and_b32_dpp v30, v12, v22 row_newbcast:12 row_mask:0xf bank_mask:0xf
    v_and_b32_dpp v31, v12, v23 row_newbcast:12 row_mask:0xf bank_mask:0xf
    s_nop 1
    v_mfma_f32_16x16x32_bf16 v[32:35], v[28:31], v[52:55], v[32:35]
L_nopfpv8:
    v_and_b32_dpp v28, v14, v20 row_newbcast:8 row_mask:0xf bank_mask:0xf
    v_and_b32_dpp v29, v14, v21 row_newbcast:8 row_mask:0xf bank_mask:0xf
    v_and_b32_dpp v30, v14, v22 row_newbcast:8 row_mask:0xf bank_mask:0xf
    v_and_b32_dpp v31, v14, v23 row_newbcast:8 row_mask:0xf bank_mask:0xf
    s_waitcnt vmcnt(3)
    s_bitcmp0_b32 s14, 13
    s_cbranch_scc1 L_sf_69
    s_waitcnt vmcnt(2)
    s_bitcmp0_b32 s15, 13
    s_cbranch_scc1 L_sf_69
    s_waitcnt vmcnt(1)
L_sf_69:
    buffer_load_dwordx4 v[92:95], v1, s[52:55], s97 offen offset:1024 nt
    v_mfma_f32_16x16x32_bf16 v[32:35], v[28:31], v[76:79], v[32:35]
    s_cmp_eq_u32 s12, -1
    s_cbranch_scc1 L_nopfpv9
    s_waitcnt lgkmcnt(0)
    v_and_b32_dpp v24, v13, v20 row_newbcast:0 row_mask:0xf bank_mask:0xf
    v_and_b32_dpp v25, v13, v21 row_newbcast:0 row_mask:0xf bank_mask:0xf
    v_and_b32_dpp v26, v13, v22 row_newbcast:0 row_mask:0xf bank_mask:0xf
    v_and_b32_dpp v27, v13, v23 row_newbcast:0 row_mask:0xf bank_mask:0xf
    s_nop 1
    v_mfma_f32_16x16x32_bf16 v[32:35], v[24:27], v[56:59], v[32:35]
    v_and_b32_dpp v28, v13, v20 row_newbcast:8 row_mask:0xf bank_mask:0xf
    v_and_b32_dpp v29, v13, v21 row_newbcast:8 row_mask:0xf bank_mask:0xf
    v_and_b32_dpp v30, v13, v22 row_newbcast:8 row_mask:0xf bank_mask:0xf
    v_and_b32_dpp v31, v13, v23 row_newbcast:8 row_mask:0xf bank_mask:0xf
    s_nop 1
    v_mfma_f32_16x16x32_bf16 v[32:35], v[28:31], v[60:63], v[32:35]
    v_and_b32_dpp v24, v13, v20 row_newbcast:4 row_mask:0xf bank_mask:0xf
    v_and_b32_dpp v25, v13, v21 row_newbcast:4 row_mask:0xf bank_mask:0xf
    v_and_b32_dpp v26, v13, v22 row_newbcast:4 row_mask:0xf bank_mask:0xf
    v_and_b32_dpp v27, v13, v23 row_newbcast:4 row_mask:0xf bank_mask:0xf
    s_nop 1
    v_mfma_f32_16x16x32_bf16 v[32:35], v[24:27], v[64:67], v[32:35]
    v_and_b32_dpp v28, v13, v20 row_newbcast:12 row_mask:0xf bank_mask:0xf
    v_and_b32_dpp v29, v13, v21 row_newbcast:12 row_mask:0xf bank_mask:0xf
    v_and_b32_dpp v30, v13, v22 row_newbcast:12 row_mask:0xf bank_mask:0xf
    v_and_b32_dpp v31, v13, v23 row_newbcast:12 row_mask:0xf bank_mask:0xf
    s_nop 1
    v_mfma_f32_16x16x32_bf16 v[32:35], v[28:31], v[68:71], v[32:35]
L_nopfpv9:
    v_and_b32_dpp v24, v14, v20 row_newbcast:4 row_mask:0xf bank_mask:0xf
    v_and_b32_dpp v25, v14, v21 row_newbcast:4 row_mask:0xf bank_mask:0xf
    v_and_b32_dpp v26, v14, v22 row_newbcast:4 row_mask:0xf bank_mask:0xf
    v_and_b32_dpp v27, v14, v23 row_newbcast:4 row_mask:0xf bank_mask:0xf
    s_waitcnt vmcnt(3)
    s_bitcmp0_b32 s14, 14
    s_cbranch_scc1 L_sf_70
    s_waitcnt vmcnt(2)
    s_bitcmp0_b32 s15, 14
    s_cbranch_scc1 L_sf_70
    s_waitcnt vmcnt(1)
L_sf_70:
    buffer_load_dwordx4 v[96:99], v1, s[52:55], s97 offen offset:2048 nt
    v_mfma_f32_16x16x32_bf16 v[32:35], v[24:27], v[80:83], v[32:35]
    v_and_b32_dpp v28, v14, v20 row_newbcast:12 row_mask:0xf bank_mask:0xf
    v_and_b32_dpp v29, v14, v21 row_newbcast:12 row_mask:0xf bank_mask:0xf
    v_and_b32_dpp v30, v14, v22 row_newbcast:12 row_mask:0xf bank_mask:0xf
    v_and_b32_dpp v31, v14, v23 row_newbcast:12 row_mask:0xf bank_mask:0xf
    s_waitcnt vmcnt(3)
    s_bitcmp0_b32 s14, 15
    s_cbranch_scc1 L_sf_71
    s_waitcnt vmcnt(2)
    s_bitcmp0_b32 s15, 15
    s_cbranch_scc1 L_sf_71
    s_waitcnt vmcnt(1)
L_sf_71:
    buffer_load_dwordx4 v[100:103], v1, s[52:55], s97 offen offset:3072 nt
    s_add_u32 s97, s97, 32768
    v_add_u32 v1, 4096, v1
    v_and_b32 v1, 0x7fff, v1
    v_mfma_f32_16x16x32_bf16 v[32:35], v[28:31], v[84:87], v[32:35]
    v_and_b32_dpp v24, v15, v20 row_newbcast:0 row_mask:0xf bank_mask:0xf
    v_and_b32_dpp v25, v15, v21 row_newbcast:0 row_mask:0xf bank_mask:0xf
    v_and_b32_dpp v26, v15, v22 row_newbcast:0 row_mask:0xf bank_mask:0xf
    v_and_b32_dpp v27, v15, v23 row_newbcast:0 row_mask:0xf bank_mask:0xf
    s_waitcnt vmcnt(3)
    s_bitcmp0_b32 s14, 16
    s_cbranch_scc1 L_sf_72
    s_waitcnt vmcnt(2)
    s_bitcmp0_b32 s15, 16
    s_cbranch_scc1 L_sf_72
    s_waitcnt vmcnt(1)
L_sf_72:
    buffer_load_dwordx4 v[104:107], v1, s[52:55], s97 offen offset:0 nt
    v_mfma_f32_16x16x32_bf16 v[32:35], v[24:27], v[88:91], v[32:35]
    v_and_b32_dpp v28, v15, v20 row_newbcast:8 row_mask:0xf bank_mask:0xf
    v_and_b32_dpp v29, v15, v21 row_newbcast:8 row_mask:0xf bank_mask:0xf
    v_and_b32_dpp v30, v15, v22 row_newbcast:8 row_mask:0xf bank_mask:0xf
    v_and_b32_dpp v31, v15, v23 row_newbcast:8 row_mask:0xf bank_mask:0xf
    s_waitcnt vmcnt(3)
    s_bitcmp0_b32 s14, 17
    s_cbranch_scc1 L_sf_73
    s_waitcnt vmcnt(2)
    s_bitcmp0_b32 s15, 17
    s_cbranch_scc1 L_sf_73
    s_waitcnt vmcnt(1)
L_sf_73:
    buffer_load_dwordx4 v[108:111], v1, s[52:55], s97 offen offset:1024 nt
    v_mfma_f32_16x16x32_bf16 v[32:35], v[28:31], v[92:95], v[32:35]
    v_and_b32_dpp v24, v15, v20 row_newbcast:4 row_mask:0xf bank_mask:0xf
    v_and_b32_dpp v25, v15, v21 row_newbcast:4 row_mask:0xf bank_mask:0xf
    v_and_b32_dpp v26, v15, v22 row_newbcast:4 row_mask:0xf bank_mask:0xf
    v_and_b32_dpp v27, v15, v23 row_newbcast:4 row_mask:0xf bank_mask:0xf
    s_waitcnt vmcnt(3)
    s_bitcmp0_b32 s14, 18
    s_cbranch_scc1 L_sf_74
    s_waitcnt vmcnt(2)
    s_bitcmp0_b32 s15, 18
    s_cbranch_scc1 L_sf_74
    s_waitcnt vmcnt(1)
L_sf_74:
    buffer_load_dwordx4 v[112:115], v1, s[52:55], s97 offen offset:2048 nt
    v_mfma_f32_16x16x32_bf16 v[32:35], v[24:27], v[96:99], v[32:35]
    v_and_b32_dpp v28, v15, v20 row_newbcast:12 row_mask:0xf bank_mask:0xf
    v_and_b32_dpp v29, v15, v21 row_newbcast:12 row_mask:0xf bank_mask:0xf
    v_and_b32_dpp v30, v15, v22 row_newbcast:12 row_mask:0xf bank_mask:0xf
    v_and_b32_dpp v31, v15, v23 row_newbcast:12 row_mask:0xf bank_mask:0xf
    s_waitcnt vmcnt(3)
    s_bitcmp0_b32 s14, 19
    s_cbranch_scc1 L_sf_75
    s_waitcnt vmcnt(2)
    s_bitcmp0_b32 s15, 19
    s_cbranch_scc1 L_sf_75
    s_waitcnt vmcnt(1)
L_sf_75:
    buffer_load_dwordx4 v[116:119], v1, s[52:55], s97 offen offset:3072 nt
    s_add_u32 s97, s97, 32768
    v_add_u32 v1, 4096, v1
    v_and_b32 v1, 0x7fff, v1
    v_mfma_f32_16x16x32_bf16 v[32:35], v[28:31], v[100:103], v[32:35]
    v_and_b32_dpp v24, v16, v20 row_newbcast:0 row_mask:0xf bank_mask:0xf
    v_and_b32_dpp v25, v16, v21 row_newbcast:0 row_mask:0xf bank_mask:0xf
    v_and_b32_dpp v26, v16, v22 row_newbcast:0 row_mask:0xf bank_mask:0xf
    v_and_b32_dpp v27, v16, v23 row_newbcast:0 row_mask:0xf bank_mask:0xf
    s_waitcnt vmcnt(3)
    s_bitcmp0_b32 s14, 20
    s_cbranch_scc1 L_sf_76
    s_waitcnt vmcnt(2)
    s_bitcmp0_b32 s15, 20
    s_cbranch_scc1 L_sf_76
    s_waitcnt vmcnt(1)
L_sf_76:
    buffer_load_dwordx4 v[120:123], v1, s[52:55], s97 offen offset:0 nt
    v_mfma_f32_16x16x32_bf16 v[32:35], v[24:27], v[104:107], v[32:35]
    v_and_b32_dpp v28, v16, v20 row_newbcast:8 row_mask:0xf bank_mask:0xf
    v_and_b32_dpp v29, v16, v21 row_newbcast:8 row_mask:0xf bank_mask:0xf
    v_and_b32_dpp v30, v16, v22 row_newbcast:8 row_mask:0xf bank_mask:0xf
    v_and_b32_dpp v31, v16, v23 row_newbcast:8 row_mask:0xf bank_mask:0xf
    s_waitcnt vmcnt(3)
    s_bitcmp0_b32 s14, 21
    s_cbranch_scc1 L_sf_77
    s_waitcnt vmcnt(2)
    s_bitcmp0_b32 s15, 21
    s_cbranch_scc1 L_sf_77
    s_waitcnt vmcnt(1)
L_sf_77:
    buffer_load_dwordx4 v[124:127], v1, s[52:55], s97 offen offset:1024 nt
    v_mfma_f32_16x16x32_bf16 v[32:35], v[28:31], v[108:111], v[32:35]
    v_and_b32_dpp v24, v16, v20 row_newbcast:4 row_mask:0xf bank_mask:0xf
    v_and_b32_dpp v25, v16, v21 row_newbcast:4 row_mask:0xf bank_mask:0xf
    v_and_b32_dpp v26, v16, v22 row_newbcast:4 row_mask:0xf bank_mask:0xf
    v_and_b32_dpp v27, v16, v23 row_newbcast:4 row_mask:0xf bank_mask:0xf
    s_waitcnt vmcnt(3)
    s_bitcmp0_b32 s14, 22
    s_cbranch_scc1 L_sf_78
    s_waitcnt vmcnt(2)
    s_bitcmp0_b32 s15, 22
    s_cbranch_scc1 L_sf_78
    s_waitcnt vmcnt(1)
L_sf_78:
    buffer_load_dwordx4 v[128:131], v1, s[52:55], s97 offen offset:2048 nt
    v_mfma_f32_16x16x32_bf16 v[32:35], v[24:27], v[112:115], v[32:35]
    v_and_b32_dpp v28, v16, v20 row_newbcast:12 row_mask:0xf bank_mask:0xf
    v_and_b32_dpp v29, v16, v21 row_newbcast:12 row_mask:0xf bank_mask:0xf
    v_and_b32_dpp v30, v16, v22 row_newbcast:12 row_mask:0xf bank_mask:0xf
    v_and_b32_dpp v31, v16, v23 row_newbcast:12 row_mask:0xf bank_mask:0xf
    s_waitcnt vmcnt(3)
    s_bitcmp0_b32 s14, 23
    s_cbranch_scc1 L_sf_79
    s_waitcnt vmcnt(2)
    s_bitcmp0_b32 s15, 23
    s_cbranch_scc1 L_sf_79
    s_waitcnt vmcnt(1)
L_sf_79:
    buffer_load_dwordx4 v[132:135], v1, s[52:55], s97 offen offset:3072 nt
    s_add_u32 s97, s97, 32768
    v_add_u32 v1, 4096, v1
    v_and_b32 v1, 0x7fff, v1
    v_mfma_f32_16x16x32_bf16 v[32:35], v[28:31], v[116:119], v[32:35]
    v_and_b32_dpp v24, v17, v20 row_newbcast:0 row_mask:0xf bank_mask:0xf
    v_and_b32_dpp v25, v17, v21 row_newbcast:0 row_mask:0xf bank_mask:0xf
    v_and_b32_dpp v26, v17, v22 row_newbcast:0 row_mask:0xf bank_mask:0xf
    v_and_b32_dpp v27, v17, v23 row_newbcast:0 row_mask:0xf bank_mask:0xf
    s_waitcnt vmcnt(3)
    s_bitcmp0_b32 s14, 24
    s_cbranch_scc1 L_sf_80
    s_waitcnt vmcnt(2)
    s_bitcmp0_b32 s15, 24
    s_cbranch_scc1 L_sf_80
    s_waitcnt vmcnt(1)
L_sf_80:
    buffer_load_dwordx4 v[136:139], v1, s[52:55], s97 offen offset:0 nt
    v_mfma_f32_16x16x32_bf16 v[32:35], v[24:27], v[120:123], v[32:35]
    s_or_b32 s96, s59, s39
    s_cbranch_scc0 L_nofrag_81
    v_mov_b32 v104, 162060
L_lw_82:
    ds_read_b32 v105, v104
    s_waitcnt lgkmcnt(0)
    v_cmp_gt_u32 vcc, 4, v105
    s_cbranch_vccz L_lw_82e
    s_sleep 2
    s_sub_u32 s60, s60, 1
    s_cbranch_scc0 L_lw_82
    s_mov_b32 s60, 0
L_lw_82e:
    s_cmp_eq_u32 s59, 0
    s_cbranch_scc1 L_nofrag_81
    v_bfe_u32 v104, v0, 2, 1
    v_bfe_u32 v110, v0, 4, 1
    v_lshl_add_u32 v104, v110, 2, v104
    v_and_b32 v110, 8, v0
    v_add_u32 v104, v104, v110
    v_lshrrev_b32 v110, 5, v0
    v_lshl_add_u32 v104, v110, 4, v104
    v_bfe_u32 v111, v0, 0, 1
    v_mul_u32_u24 v111, 0xaaaa, v111
    v_add_u32 v111, 0x4444, v111
    v_mov_b32 v112, 0
    v_mov_b32 v113, 0
    v_mov_b32 v114, 0
    v_mov_b32 v115, 0
    v_mov_b32 v116, 0
    v_mov_b32 v117, 0
    v_mov_b32 v118, 0
    v_mov_b32 v119, 0
    v_lshlrev_b32 v104, 7, v104
    v_and_b32 v110, 3, v0
    v_lshl_add_u32 v104, v110, 3, v104
    v_lshrrev_b32 v109, 4, v0
    v_and_b32 v110, 1, v0
    s_lshr_b32 s63, s3, 1
    s_and_b32 s62, s3, 1
    s_lshl_b32 s96, s63, 14
    s_lshl_b32 s100, s62, 6
    s_add_u32 s100, s100, 81920
    s_add_u32 s96, s96, s100
    v_add_u32 v104, s96, v104
    ds_read_b64_tr_b16 v[72:73], v104 offset:0
    ds_read_b64_tr_b16 v[74:75], v104 offset:256
    ds_read_b64_tr_b16 v[76:77], v104 offset:4096
    ds_read_b64_tr_b16 v[78:79], v104 offset:4352
    ds_read_b64_tr_b16 v[80:81], v104 offset:32
    ds_read_b64_tr_b16 v[82:83], v104 offset:288
    ds_read_b64_tr_b16 v[84:85], v104 offset:4128
    ds_read_b64_tr_b16 v[86:87], v104 offset:4384
    ds_read_b64_tr_b16 v[88:89], v104 offset:8192
    ds_read_b64_tr_b16 v[90:91], v104 offset:8448
    ds_read_b64_tr_b16 v[92:93], v104 offset:12288
    ds_read_b64_tr_b16 v[94:95], v104 offset:12544
    ds_read_b64_tr_b16 v[96:97], v104 offset:8224
    ds_read_b64_tr_b16 v[98:99], v104 offset:8480
    ds_read_b64_tr_b16 v[100:101], v104 offset:12320
    ds_read_b64_tr_b16 v[102:103], v104 offset:12576
    v_bfe_u32 v105, v0, 1, 3
    v_lshlrev_b32 v105, 8, v105
    v_lshl_add_u32 v105, v109, 5, v105
    v_lshl_add_u32 v105, v110, 4, v105
    v_lshrrev_b32 v106, 3, v0
    v_lshlrev_b32 v106, 7, v106
    v_and_b32 v110, 7, v0
    v_lshl_add_u32 v107, v110, 3, v106
    v_add_u32 v107, s100, v107
    v_lshlrev_b32 v106, 8, v109
    v_and_b32 v110, 15, v0
    v_lshl_add_u32 v106, v110, 2, v106
    v_add_u32 v106, s96, v106
    v_lshlrev_b32 v108, 2, v0
    s_lshl_b32 s96, s62, 2
    s_add_u32 s96, s96, 162088
    v_mov_b32 v109, s96
    s_lshl_b32 s100, s63, 11
    s_lshl_b32 s96, s34, 13
    s_add_u32 s100, s100, s96
    s_add_u32 s100, s100, 106496
    s_mul_i32 s101, s34, 5120
    s_lshl_b32 s96, s35, 9
    s_add_u32 s101, s101, s96
    s_lshl_b32 s96, s62, 8
    s_add_u32 s101, s101, s96
    s_sub_u32 s101, s101, 11264
    s_and_b32 s96, s101, 0xffffe000
    s_add_u32 s101, s101, s96
    s_add_u32 s101, s101, 212992
    v_add_u32 v110, 8192, v108
L_nofrag_81:
    v_and_b32_dpp v28, v17, v20 row_newbcast:8 row_mask:0xf bank_mask:0xf
    v_and_b32_dpp v29, v17, v21 row_newbcast:8 row_mask:0xf bank_mask:0xf
    v_and_b32_dpp v30, v17, v22 row_newbcast:8 row_mask:0xf bank_mask:0xf
    v_and_b32_dpp v31, v17, v23 row_newbcast:8 row_mask:0xf bank_mask:0xf
    s_waitcnt vmcnt(3)
    s_bitcmp0_b32 s14, 25
    s_cbranch_scc1 L_sf_83
    s_waitcnt vmcnt(2)
    s_bitcmp0_b32 s15, 25
    s_cbranch_scc1 L_sf_83
    s_waitcnt vmcnt(1)
L_sf_83:
    buffer_load_dwordx4 v[140:143], v1, s[52:55], s97 offen offset:1024 nt
    v_mfma_f32_16x16x32_bf16 v[32:35], v[28:31], v[124:127], v[32:35]
    v_and_b32_dpp v24, v17, v20 row_newbcast:4 row_mask:0xf bank_mask:0xf
    v_and_b32_dpp v25, v17, v21 row_newbcast:4 row_mask:0xf bank_mask:0xf
    v_and_b32_dpp v26, v17, v22 row_newbcast:4 row_mask:0xf bank_mask:0xf
    v_and_b32_dpp v27, v17, v23 row_newbcast:4 row_mask:0xf bank_mask:0xf
    s_waitcnt vmcnt(3)
    s_bitcmp0_b32 s14, 26
    s_cbranch_scc1 L_sf_84
    s_waitcnt vmcnt(2)
    s_bitcmp0_b32 s15, 26
    s_cbranch_scc1 L_sf_84
    s_waitcnt vmcnt(1)
L_sf_84:
    buffer_load_dwordx4 v[144:147], v1, s[52:55], s97 offen offset:2048 nt
    v_mfma_f32_16x16x32_bf16 v[32:35], v[24:27], v[128:131], v[32:35]
    v_and_b32_dpp v28, v17, v20 row_newbcast:12 row_mask:0xf bank_mask:0xf
    v_and_b32_dpp v29, v17, v21 row_newbcast:12 row_mask:0xf bank_mask:0xf
    v_and_b32_dpp v30, v17, v22 row_newbcast:12 row_mask:0xf bank_mask:0xf
    v_and_b32_dpp v31, v17, v23 row_newbcast:12 row_mask:0xf bank_mask:0xf
    s_waitcnt vmcnt(3)
    s_bitcmp0_b32 s14, 27
    s_cbranch_scc1 L_sf_85
    s_waitcnt vmcnt(2)
    s_bitcmp0_b32 s15, 27
    s_cbranch_scc1 L_sf_85
    s_waitcnt vmcnt(1)
L_sf_85:
    buffer_load_dwordx4 v[148:151], v1, s[52:55], s97 offen offset:3072 nt
    s_add_u32 s97, s97, 32768
    v_add_u32 v1, 4096, v1
    v_and_b32 v1, 0x7fff, v1
    v_mfma_f32_16x16x32_bf16 v[32:35], v[28:31], v[132:135], v[32:35]
    v_and_b32_dpp v24, v18, v20 row_newbcast:0 row_mask:0xf bank_mask:0xf
    v_and_b32_dpp v25, v18, v21 row_newbcast:0 row_mask:0xf bank_mask:0xf
    v_and_b32_dpp v26, v18, v22 row_newbcast:0 row_mask:0xf bank_mask:0xf
    v_and_b32_dpp v27, v18, v23 row_newbcast:0 row_mask:0xf bank_mask:0xf
    s_waitcnt vmcnt(3)
    s_bitcmp0_b32 s14, 28
    s_cbranch_scc1 L_sf_86
    s_waitcnt vmcnt(2)
    s_bitcmp0_b32 s15, 28
    s_cbranch_scc1 L_sf_86
    s_waitcnt vmcnt(1)
L_sf_86:
    buffer_load_dwordx4 v[152:155], v1, s[52:55], s97 offen offset:0 nt
    v_mfma_f32_16x16x32_bf16 v[32:35], v[24:27], v[136:139], v[32:35]
    v_mov_b32 v10, 162076
    v_mov_b32 v11, 1
    s_mov_b64 exec, 1
    ds_add_u32 v10, v11
    s_mov_b64 exec, -1
    v_and_b32_dpp v28, v18, v20 row_newbcast:8 row_mask:0xf bank_mask:0xf
    v_and_b32_dpp v29, v18, v21 row_newbcast:8 row_mask:0xf bank_mask:0xf
    v_and_b32_dpp v30, v18, v22 row_newbcast:8 row_mask:0xf bank_mask:0xf
    v_and_b32_dpp v31, v18, v23 row_newbcast:8 row_mask:0xf bank_mask:0xf
    s_waitcnt vmcnt(3)
    s_bitcmp0_b32 s14, 29
    s_cbranch_scc1 L_sf_87
    s_waitcnt vmcnt(2)
    s_bitcmp0_b32 s15, 29
    s_cbranch_scc1 L_sf_87
    s_waitcnt vmcnt(1)
L_sf_87:
    buffer_load_dwordx4 v[156:159], v1, s[52:55], s97 offen offset:1024 nt
    v_mfma_f32_16x16x32_bf16 v[32:35], v[28:31], v[140:143], v[32:35]
    v_and_b32_dpp v24, v18, v20 row_newbcast:4 row_mask:0xf bank_mask:0xf
    v_and_b32_dpp v25, v18, v21 row_newbcast:4 row_mask:0xf bank_mask:0xf
    v_and_b32_dpp v26, v18, v22 row_newbcast:4 row_mask:0xf bank_mask:0xf
    v_and_b32_dpp v27, v18, v23 row_newbcast:4 row_mask:0xf bank_mask:0xf
    s_waitcnt vmcnt(3)
    s_bitcmp0_b32 s14, 30
    s_cbranch_scc1 L_sf_88
    s_waitcnt vmcnt(2)
    s_bitcmp0_b32 s15, 30
    s_cbranch_scc1 L_sf_88
    s_waitcnt vmcnt(1)
L_sf_88:
    buffer_load_dwordx4 v[160:163], v1, s[52:55], s97 offen offset:2048 nt
    v_mfma_f32_16x16x32_bf16 v[32:35], v[24:27], v[144:147], v[32:35]
    v_lshrrev_b32 v9, 4, v0
    v_lshl_add_u32 v8, v9, 2, v2
    s_lshl_b32 s96, s3, 9
    s_add_u32 s96, s96, 157824
    v_lshl_add_u32 v8, v8, 2, s96
    v_lshlrev_b32 v9, 3, v0
    v_add_u32 v9, 157824, v9
    v_mov_b32 v10, 162048
    v_mov_b32 v11, 1
    s_lshl_b32 s96, s38, 5
    s_add_u32 s96, s96, 161984
    v_mov_b32 v3, s96
    s_sub_u32 s62, 8, s39
    s_lshl_b32 s98, s34, 5
    s_add_u32 s98, s98, s35
    s_lshl_b32 s98, s98, 8
    s_add_u32 s98, s98, 106496
    v_lshlrev_b32 v39, 2, v0
    v_and_b32_dpp v28, v18, v20 row_newbcast:12 row_mask:0xf bank_mask:0xf
    v_and_b32_dpp v29, v18, v21 row_newbcast:12 row_mask:0xf bank_mask:0xf
    v_and_b32_dpp v30, v18, v22 row_newbcast:12 row_mask:0xf bank_mask:0xf
    v_and_b32_dpp v31, v18, v23 row_newbcast:12 row_mask:0xf bank_mask:0xf
    s_waitcnt vmcnt(3)
    s_bitcmp0_b32 s14, 31
    s_cbranch_scc1 L_sf_89
    s_waitcnt vmcnt(2)
    s_bitcmp0_b32 s15, 31
    s_cbranch_scc1 L_sf_89
    s_waitcnt vmcnt(1)
L_sf_89:
    buffer_load_dwordx4 v[164:167], v1, s[52:55], s97 offen offset:3072 nt
    s_mov_b32 s97, 0
    v_add_u32 v1, 4096, v1
    v_and_b32 v1, 0x7fff, v1
    v_mfma_f32_16x16x32_bf16 v[32:35], v[28:31], v[148:151], v[32:35]
    s_cmp_eq_u32 s12, -1
    s_cbranch_scc1 L_v_nopf
    v_and_b32_dpp v24, v19, v20 row_newbcast:0 row_mask:0xf bank_mask:0xf
    v_and_b32_dpp v25, v19, v21 row_newbcast:0 row_mask:0xf bank_mask:0xf
    v_and_b32_dpp v26, v19, v22 row_newbcast:0 row_mask:0xf bank_mask:0xf
    v_and_b32_dpp v27, v19, v23 row_newbcast:0 row_mask:0xf bank_mask:0xf
    s_waitcnt vmcnt(3)
    s_nop 0
    v_mfma_f32_16x16x32_bf16 v[32:35], v[24:27], v[152:155], v[32:35]
    v_and_b32_dpp v28, v19, v20 row_newbcast:8 row_mask:0xf bank_mask:0xf
    v_and_b32_dpp v29, v19, v21 row_newbcast:8 row_mask:0xf bank_mask:0xf
    v_and_b32_dpp v30, v19, v22 row_newbcast:8 row_mask:0xf bank_mask:0xf
    v_and_b32_dpp v31, v19, v23 row_newbcast:8 row_mask:0xf bank_mask:0xf
    s_waitcnt vmcnt(2)
    s_nop 0
    v_mfma_f32_16x16x32_bf16 v[32:35], v[28:31], v[156:159], v[32:35]
    v_and_b32_dpp v24, v19, v20 row_newbcast:4 row_mask:0xf bank_mask:0xf
    v_and_b32_dpp v25, v19, v21 row_newbcast:4 row_mask:0xf bank_mask:0xf
    v_and_b32_dpp v26, v19, v22 row_newbcast:4 row_mask:0xf bank_mask:0xf
    v_and_b32_dpp v27, v19, v23 row_newbcast:4 row_mask:0xf bank_mask:0xf
    s_waitcnt vmcnt(1)
    s_nop 0
    v_mfma_f32_16x16x32_bf16 v[32:35], v[24:27], v[160:163], v[32:35]
    v_and_b32_dpp v28, v19, v20 row_newbcast:12 row_mask:0xf bank_mask:0xf
    v_and_b32_dpp v29, v19, v21 row_newbcast:12 row_mask:0xf bank_mask:0xf
    v_and_b32_dpp v30, v19, v22 row_newbcast:12 row_mask:0xf bank_mask:0xf
    v_and_b32_dpp v31, v19, v23 row_newbcast:12 row_mask:0xf bank_mask:0xf
    s_waitcnt vmcnt(0)
    s_nop 0
    v_mfma_f32_16x16x32_bf16 v[32:35], v[28:31], v[164:167], v[32:35]
L_v_join:
    s_cmp_lg_u32 s13, 0
    s_cbranch_scc1 L_jobend
L_t0:
    s_mov_b32 exec_hi, 0
    s_nop 4
    ds_write_b128 v8, v[32:35]
L_t0b:
    s_mov_b64 exec, 1
    ds_add_rtn_u32 v37, v10, v11
    s_mov_b64 exec, -1
    ds_read_b32 v38, v10 offset:24
    ds_read_b128 v[24:27], v3
    ds_read_b128 v[28:31], v3 offset:16
    ds_read_b64 v[144:145], v9 offset:0
    ds_read_b64 v[146:147], v9 offset:512
    ds_read_b64 v[148:149], v9 offset:1024
    ds_read_b64 v[150:151], v9 offset:1536
    ds_read_b64 v[152:153], v9 offset:2048
    ds_read_b64 v[154:155], v9 offset:2560
    ds_read_b64 v[156:157], v9 offset:3072
    ds_read_b64 v[158:159], v9 offset:3584
    s_waitcnt lgkmcnt(10)
    v_readfirstlane_b32 s96, v37
    v_readfirstlane_b32 s61, v38
    s_cmp_lg_u32 s96, s62
    s_cbranch_scc1 L_nopub
    s_waitcnt lgkmcnt(6)
    v_pk_mul_f32 v[144:145], v[144:145], v[24:25] op_sel:[0,0] op_sel_hi:[1,0]
    v_pk_mul_f32 v[146:147], v[146:147], v[24:25] op_sel:[0,1] op_sel_hi:[1,1]
    s_waitcnt lgkmcnt(4)
    v_pk_fma_f32 v[144:145], v[148:149], v[26:27], v[144:145] op_sel:[0,0,0] op_sel_hi:[1,0,1]
    v_pk_fma_f32 v[146:147], v[150:151], v[26:27], v[146:147] op_sel:[0,1,0] op_sel_hi:[1,1,1]
    s_waitcnt lgkmcnt(2)
    v_pk_fma_f32 v[144:145], v[152:153], v[28:29], v[144:145] op_sel:[0,0,0] op_sel_hi:[1,0,1]
    v_pk_fma_f32 v[146:147], v[154:155], v[28:29], v[146:147] op_sel:[0,1,0] op_sel_hi:[1,1,1]
    s_waitcnt lgkmcnt(0)
    v_pk_fma_f32 v[144:145], v[156:157], v[30:31], v[144:145] op_sel:[0,0,0] op_sel_hi:[1,0,1]
    v_pk_fma_f32 v[146:147], v[158:159], v[30:31], v[146:147] op_sel:[0,1,0] op_sel_hi:[1,1,1]
    s_cmp_eq_u32 s61, 1
    v_pk_add_f32 v[144:145], v[144:145], v[146:147]
    v_cvt_pk_bf16_f32 v32, v144, v145
    s_cbranch_scc0 L_oslow
    buffer_store_dword v32, v39, s[40:43], s98 offen
L_odone:
L_nopub:
    s_cmp_eq_u32 s59, 0
    s_cbranch_scc1 L_not1
L_poll_98:
    buffer_load_dwordx4 v[16:19], v105, s[40:43], s100 offen sc1
    buffer_load_dwordx4 v[20:23], v105, s[40:43], s100 offen offset:128 sc1
    s_sub_u32 s60, s60, 1
    s_cbranch_scc1 L_poll_98t
    s_waitcnt vmcnt(0)
    v_max3_u32 v38, v16, v17, v18
    v_max3_u32 v38, v38, v19, v20
    v_max3_u32 v38, v38, v21, v22
    v_max_u32 v38, v38, v23
    v_cmp_eq_u32 vcc, -1, v38
    s_cbranch_vccnz L_poll_98
L_poll_98e:
    v_smfmac_f32_16x16x64_bf16 v[112:115], v[16:19], v[72:79], v111
    v_smfmac_f32_16x16x64_bf16 v[116:119], v[16:19], v[80:87], v111
    v_smfmac_f32_16x16x64_bf16 v[112:115], v[20:23], v[88:95], v111
    v_smfmac_f32_16x16x64_bf16 v[116:119], v[20:23], v[96:103], v111
    s_nop 6
    v_pk_add_f32 v[112:113], v[112:113], v[114:115]
    v_pk_add_f32 v[116:117], v[116:117], v[118:119]
    v_add_f32 v12, v112, v113
    v_add_f32 v13, v116, v117
    ds_write2_b32 v106, v12, v13 offset0:0 offset1:32
    s_mov_b64 exec, 1
    ds_add_rtn_u32 v37, v109, v11
    s_mov_b64 exec, -1
    ds_read_b64 v[72:73], v107 offset:0
    ds_read_b64 v[74:75], v107 offset:16384
    ds_read_b64 v[76:77], v107 offset:32768
    ds_read_b64 v[78:79], v107 offset:49152
    s_cmp_eq_u32 s34, 2
    s_cselect_b32 s97, s61, 0
    s_waitcnt lgkmcnt(4)
    v_readfirstlane_b32 s96, v37
    s_waitcnt lgkmcnt(2)
    v_pk_add_f32 v[72:73], v[72:73], v[74:75]
    s_cmp_lg_u32 s96, 3
    s_cbranch_scc1 L_not1
    s_cmp_eq_u32 s97, 1
    s_waitcnt lgkmcnt(0)
    v_pk_add_f32 v[76:77], v[76:77], v[78:79]
    v_pk_add_f32 v[72:73], v[72:73], v[76:77]
    v_cvt_pk_bf16_f32 v12, v72, v73
    s_cbranch_scc1 L_pfast
    buffer_store_dword v12, v108, s[40:43], s101 offen sc1
    buffer_store_dword v12, v110, s[40:43], s101 offen sc1
L_pdone:
L_not1:
    s_waitcnt lgkmcnt(0)
    s_cmp_eq_u32 s39, 1
    s_cbranch_scc1 L_s_role
    s_endpgm
L_k_nopf:
    s_waitcnt vmcnt(3)
    s_bitcmp0_b32 s57, 22
    s_cbranch_scc1 L_sf_54
    s_waitcnt vmcnt(2)
    s_bitcmp0_b32 s58, 22
    s_cbranch_scc1 L_sf_54
    s_waitcnt vmcnt(1)
L_sf_54:
    buffer_load_dwordx4 v[128:131], v1, s[48:51], s97 offen offset:2048 nt
    v_and_b32 v39, 31, v0
    v_lshlrev_b32 v39, 2, v39
    buffer_load_dword v37, v39, s[44:47], 0 offen sc1
    s_waitcnt vmcnt(4)
    s_bitcmp0_b32 s57, 23
    s_cbranch_scc1 L_sf_55
    s_waitcnt vmcnt(3)
    s_bitcmp0_b32 s58, 23
    s_cbranch_scc1 L_sf_55
    s_waitcnt vmcnt(2)
L_sf_55:
    buffer_load_dwordx4 v[132:135], v1, s[48:51], s97 offen offset:3072 nt
    s_add_u32 s97, s97, 32768
    v_add_u32 v1, 4096, v1
    v_and_b32 v1, 0x7fff, v1
    s_waitcnt vmcnt(4)
    s_bitcmp0_b32 s57, 24
    s_cbranch_scc1 L_sf_56
    s_waitcnt vmcnt(3)
    s_bitcmp0_b32 s58, 24
    s_cbranch_scc1 L_sf_56
    s_waitcnt vmcnt(2)
L_sf_56:
    buffer_load_dwordx4 v[136:139], v1, s[48:51], s97 offen offset:0 nt
    s_waitcnt vmcnt(4)
    s_bitcmp0_b32 s57, 25
    s_cbranch_scc1 L_sf_57
    s_waitcnt vmcnt(3)
    s_bitcmp0_b32 s58, 25
    s_cbranch_scc1 L_sf_57
    s_waitcnt vmcnt(1)
L_sf_57:
    buffer_load_dwordx4 v[140:143], v1, s[48:51], s97 offen offset:1024 nt
    s_waitcnt vmcnt(4)
    s_bitcmp0_b32 s57, 26
    s_cbranch_scc1 L_sf_58
    s_waitcnt vmcnt(2)
    s_bitcmp0_b32 s58, 26
    s_cbranch_scc1 L_sf_58
    s_waitcnt vmcnt(1)
L_sf_58:
    buffer_load_dwordx4 v[144:147], v1, s[48:51], s97 offen offset:2048 nt
    s_waitcnt vmcnt(3)
    s_bitcmp0_b32 s57, 27
    s_cbranch_scc1 L_sf_59
    s_waitcnt vmcnt(2)
    s_bitcmp0_b32 s58, 27
    s_cbranch_scc1 L_sf_59
    s_waitcnt vmcnt(1)
L_sf_59:
    buffer_load_dwordx4 v[148:151], v1, s[48:51], s97 offen offset:3072 nt
    s_add_u32 s97, s97, 32768
    v_add_u32 v1, 4096, v1
    v_and_b32 v1, 0x7fff, v1
    v_cmp_eq_u32 vcc, 0, v37
    s_nop 0
    s_or_b32 s96, vcc_lo, vcc_hi
    buffer_load_dwordx4 v[4:7], v2, s[40:43], s98 offen sc1
    s_waitcnt vmcnt(4)
    s_bitcmp0_b32 s57, 28
    s_cbranch_scc1 L_sf_60
    s_waitcnt vmcnt(3)
    s_bitcmp0_b32 s58, 28
    s_cbranch_scc1 L_sf_60
    s_waitcnt vmcnt(2)
L_sf_60:
    buffer_load_dwordx4 v[152:155], v1, s[48:51], s97 offen offset:0 nt
    s_waitcnt vmcnt(4)
    s_bitcmp0_b32 s57, 29
    s_cbranch_scc1 L_sf_61
    s_waitcnt vmcnt(3)
    s_bitcmp0_b32 s58, 29
    s_cbranch_scc1 L_sf_61
    s_waitcnt vmcnt(2)
L_sf_61:
    buffer_load_dwordx4 v[156:159], v1, s[48:51], s97 offen offset:1024 nt
    s_waitcnt vmcnt(4)
    s_bitcmp0_b32 s57, 30
    s_cbranch_scc1 L_sf_62
    s_waitcnt vmcnt(3)
    s_bitcmp0_b32 s58, 30
    s_cbranch_scc1 L_sf_62
    s_waitcnt vmcnt(1)
L_sf_62:
    buffer_load_dwordx4 v[160:163], v1, s[48:51], s97 offen offset:2048 nt
    s_waitcnt vmcnt(4)
    s_bitcmp0_b32 s57, 31
    s_cbranch_scc1 L_sf_63
    s_waitcnt vmcnt(2)
    s_bitcmp0_b32 s58, 31
    s_cbranch_scc1 L_sf_63
    s_waitcnt vmcnt(1)
L_sf_63:
    buffer_load_dwordx4 v[164:167], v1, s[48:51], s97 offen offset:3072 nt
    s_mov_b32 s97, 0
    v_add_u32 v1, 4096, v1
    v_and_b32 v1, 0x7fff, v1
    v_add_u32 v1, 8192, v1
    v_and_b32 v1, 0x7fff, v1
    s_mov_b32 s97, 65536
    s_branch L_k_join
L_v_nopf:
    v_and_b32_dpp v24, v19, v20 row_newbcast:0 row_mask:0xf bank_mask:0xf
    v_and_b32_dpp v25, v19, v21 row_newbcast:0 row_mask:0xf bank_mask:0xf
    v_and_b32_dpp v26, v19, v22 row_newbcast:0 row_mask:0xf bank_mask:0xf
    v_and_b32_dpp v27, v19, v23 row_newbcast:0 row_mask:0xf bank_mask:0xf
    s_waitcnt vmcnt(3)
    s_bitcmp0_b32 s14, 0
    s_cbranch_scc1 L_sf_90
    s_waitcnt vmcnt(2)
    s_bitcmp0_b32 s15, 0
    s_cbranch_scc1 L_sf_90
    s_waitcnt vmcnt(1)
L_sf_90:
    buffer_load_dwordx4 v[40:43], v1, s[52:55], s97 offen offset:0 nt
    v_mfma_f32_16x16x32_bf16 v[32:35], v[24:27], v[152:155], v[32:35]
    v_and_b32_dpp v28, v19, v20 row_newbcast:8 row_mask:0xf bank_mask:0xf
    v_and_b32_dpp v29, v19, v21 row_newbcast:8 row_mask:0xf bank_mask:0xf
    v_and_b32_dpp v30, v19, v22 row_newbcast:8 row_mask:0xf bank_mask:0xf
    v_and_b32_dpp v31, v19, v23 row_newbcast:8 row_mask:0xf bank_mask:0xf
    s_waitcnt vmcnt(3)
    s_bitcmp0_b32 s14, 1
    s_cbranch_scc1 L_sf_91
    s_waitcnt vmcnt(2)
    s_bitcmp0_b32 s15, 1
    s_cbranch_scc1 L_sf_91
    s_waitcnt vmcnt(1)
L_sf_91:
    buffer_load_dwordx4 v[44:47], v1, s[52:55], s97 offen offset:1024 nt
    v_mfma_f32_16x16x32_bf16 v[32:35], v[28:31], v[156:159], v[32:35]
    v_and_b32_dpp v24, v19, v20 row_newbcast:4 row_mask:0xf bank_mask:0xf
    v_and_b32_dpp v25, v19, v21 row_newbcast:4 row_mask:0xf bank_mask:0xf
    v_and_b32_dpp v26, v19, v22 row_newbcast:4 row_mask:0xf bank_mask:0xf
    v_and_b32_dpp v27, v19, v23 row_newbcast:4 row_mask:0xf bank_mask:0xf
    s_waitcnt vmcnt(3)
    s_bitcmp0_b32 s14, 2
    s_cbranch_scc1 L_sf_92
    s_waitcnt vmcnt(2)
    s_bitcmp0_b32 s15, 2
    s_cbranch_scc1 L_sf_92
    s_waitcnt vmcnt(1)
L_sf_92:
    buffer_load_dwordx4 v[48:51], v1, s[52:55], s97 offen offset:2048 nt
    v_mfma_f32_16x16x32_bf16 v[32:35], v[24:27], v[160:163], v[32:35]
    v_and_b32_dpp v28, v19, v20 row_newbcast:12 row_mask:0xf bank_mask:0xf
    v_and_b32_dpp v29, v19, v21 row_newbcast:12 row_mask:0xf bank_mask:0xf
    v_and_b32_dpp v30, v19, v22 row_newbcast:12 row_mask:0xf bank_mask:0xf
    v_and_b32_dpp v31, v19, v23 row_newbcast:12 row_mask:0xf bank_mask:0xf
    s_waitcnt vmcnt(3)
    s_bitcmp0_b32 s14, 3
    s_cbranch_scc1 L_sf_93
    s_waitcnt vmcnt(2)
    s_bitcmp0_b32 s15, 3
    s_cbranch_scc1 L_sf_93
    s_waitcnt vmcnt(1)
L_sf_93:
    buffer_load_dwordx4 v[52:55], v1, s[52:55], s97 offen offset:3072 nt
    s_add_u32 s97, s97, 32768
    v_add_u32 v1, 4096, v1
    v_and_b32 v1, 0x7fff, v1
    v_mfma_f32_16x16x32_bf16 v[32:35], v[28:31], v[164:167], v[32:35]
    v_and_b32_dpp v24, v12, v20 row_newbcast:0 row_mask:0xf bank_mask:0xf
    v_and_b32_dpp v25, v12, v21 row_newbcast:0 row_mask:0xf bank_mask:0xf
    v_and_b32_dpp v26, v12, v22 row_newbcast:0 row_mask:0xf bank_mask:0xf
    v_and_b32_dpp v27, v12, v23 row_newbcast:0 row_mask:0xf bank_mask:0xf
    s_waitcnt vmcnt(3)
    s_bitcmp0_b32 s14, 4
    s_cbranch_scc1 L_sf_94
    s_waitcnt vmcnt(2)
    s_bitcmp0_b32 s15, 4
    s_cbranch_scc1 L_sf_94
    s_waitcnt vmcnt(1)
L_sf_94:
    buffer_load_dwordx4 v[56:59], v1, s[52:55], s97 offen offset:0 nt
    v_mfma_f32_16x16x32_bf16 v[32:35], v[24:27], v[40:43], v[32:35]
    v_and_b32_dpp v28, v12, v20 row_newbcast:8 row_mask:0xf bank_mask:0xf
    v_and_b32_dpp v29, v12, v21 row_newbcast:8 row_mask:0xf bank_mask:0xf
    v_and_b32_dpp v30, v12, v22 row_newbcast:8 row_mask:0xf bank_mask:0xf
    v_and_b32_dpp v31, v12, v23 row_newbcast:8 row_mask:0xf bank_mask:0xf
    s_waitcnt vmcnt(3)
    s_bitcmp0_b32 s14, 5
    s_cbranch_scc1 L_sf_95
    s_waitcnt vmcnt(2)
    s_bitcmp0_b32 s15, 5
    s_cbranch_scc1 L_sf_95
    s_waitcnt vmcnt(1)
L_sf_95:
    buffer_load_dwordx4 v[60:63], v1, s[52:55], s97 offen offset:1024 nt
    v_mfma_f32_16x16x32_bf16 v[32:35], v[28:31], v[44:47], v[32:35]
    v_and_b32_dpp v24, v12, v20 row_newbcast:4 row_mask:0xf bank_mask:0xf
    v_and_b32_dpp v25, v12, v21 row_newbcast:4 row_mask:0xf bank_mask:0xf
    v_and_b32_dpp v26, v12, v22 row_newbcast:4 row_mask:0xf bank_mask:0xf
    v_and_b32_dpp v27, v12, v23 row_newbcast:4 row_mask:0xf bank_mask:0xf
    s_waitcnt vmcnt(3)
    s_bitcmp0_b32 s14, 6
    s_cbranch_scc1 L_sf_96
    s_waitcnt vmcnt(2)
    s_bitcmp0_b32 s15, 6
    s_cbranch_scc1 L_sf_96
    s_waitcnt vmcnt(1)
L_sf_96:
    buffer_load_dwordx4 v[64:67], v1, s[52:55], s97 offen offset:2048 nt
    v_mfma_f32_16x16x32_bf16 v[32:35], v[24:27], v[48:51], v[32:35]
    v_and_b32_dpp v28, v12, v20 row_newbcast:12 row_mask:0xf bank_mask:0xf
    v_and_b32_dpp v29, v12, v21 row_newbcast:12 row_mask:0xf bank_mask:0xf
    v_and_b32_dpp v30, v12, v22 row_newbcast:12 row_mask:0xf bank_mask:0xf
    v_and_b32_dpp v31, v12, v23 row_newbcast:12 row_mask:0xf bank_mask:0xf
    s_waitcnt vmcnt(3)
    s_bitcmp0_b32 s14, 7
    s_cbranch_scc1 L_sf_97
    s_waitcnt vmcnt(2)
    s_bitcmp0_b32 s15, 7
    s_cbranch_scc1 L_sf_97
    s_waitcnt vmcnt(1)
L_sf_97:
    buffer_load_dwordx4 v[68:71], v1, s[52:55], s97 offen offset:3072 nt
    s_add_u32 s97, s97, 32768
    v_add_u32 v1, 4096, v1
    v_and_b32 v1, 0x7fff, v1
    v_mfma_f32_16x16x32_bf16 v[32:35], v[28:31], v[52:55], v[32:35]
    v_and_b32_dpp v24, v13, v20 row_newbcast:0 row_mask:0xf bank_mask:0xf
    v_and_b32_dpp v25, v13, v21 row_newbcast:0 row_mask:0xf bank_mask:0xf
    v_and_b32_dpp v26, v13, v22 row_newbcast:0 row_mask:0xf bank_mask:0xf
    v_and_b32_dpp v27, v13, v23 row_newbcast:0 row_mask:0xf bank_mask:0xf
    s_waitcnt vmcnt(3)
    s_nop 0
    v_mfma_f32_16x16x32_bf16 v[32:35], v[24:27], v[56:59], v[32:35]
    v_and_b32_dpp v28, v13, v20 row_newbcast:8 row_mask:0xf bank_mask:0xf
    v_and_b32_dpp v29, v13, v21 row_newbcast:8 row_mask:0xf bank_mask:0xf
    v_and_b32_dpp v30, v13, v22 row_newbcast:8 row_mask:0xf bank_mask:0xf
    v_and_b32_dpp v31, v13, v23 row_newbcast:8 row_mask:0xf bank_mask:0xf
    s_waitcnt vmcnt(2)
    s_nop 0
    v_mfma_f32_16x16x32_bf16 v[32:35], v[28:31], v[60:63], v[32:35]
    v_and_b32_dpp v24, v13, v20 row_newbcast:4 row_mask:0xf bank_mask:0xf
    v_and_b32_dpp v25, v13, v21 row_newbcast:4 row_mask:0xf bank_mask:0xf
    v_and_b32_dpp v26, v13, v22 row_newbcast:4 row_mask:0xf bank_mask:0xf
    v_and_b32_dpp v27, v13, v23 row_newbcast:4 row_mask:0xf bank_mask:0xf
    s_waitcnt vmcnt(1)
    s_nop 0
    v_mfma_f32_16x16x32_bf16 v[32:35], v[24:27], v[64:67], v[32:35]
    v_and_b32_dpp v28, v13, v20 row_newbcast:12 row_mask:0xf bank_mask:0xf
    v_and_b32_dpp v29, v13, v21 row_newbcast:12 row_mask:0xf bank_mask:0xf
    v_and_b32_dpp v30, v13, v22 row_newbcast:12 row_mask:0xf bank_mask:0xf
    v_and_b32_dpp v31, v13, v23 row_newbcast:12 row_mask:0xf bank_mask:0xf
    s_waitcnt vmcnt(0)
    s_nop 0
    v_mfma_f32_16x16x32_bf16 v[32:35], v[28:31], v[68:71], v[32:35]
    s_branch L_v_join
L_oslow:
    buffer_store_dword v32, v39, s[40:43], s98 offen sc1
    s_branch L_odone
L_qslow:
L_wy_99:
    buffer_load_dword v37, v39, s[44:47], 0 offen sc1
    s_waitcnt vmcnt(0)
    v_cmp_ne_u32 vcc, -1, v37
    s_cbranch_vccz L_wy_99e
    s_sleep 4
    s_sub_u32 s60, s60, 1
    s_cbranch_scc0 L_wy_99
    s_mov_b32 s60, 0
L_wy_99e:
L_qslow2:
    s_branch L_poll_100
L_poll_100s:
    s_sleep 2
L_poll_100:
    buffer_load_dwordx4 v[4:7], v2, s[40:43], s98 offen sc1
    s_sub_u32 s60, s60, 1
    s_cbranch_scc1 L_poll_100t
    s_waitcnt vmcnt(0)
    v_max3_u32 v38, v4, v5, v6
    v_max_u32 v38, v38, v7
    v_cmp_eq_u32 vcc, -1, v38
    s_cbranch_vccnz L_poll_100s
L_poll_100e:
    s_branch L_qok
L_mljob:
    s_lshl4_add_u32 s96, s35, s3
    s_lshl_b32 s96, s96, 3
    s_add_u32 s96, s96, 81920
    buffer_store_dwordx2 v[8:9], v36, s[40:43], s96 offen sc1
    s_branch L_mldone
L_service:
    v_mov_b32 v72, 0
    v_mov_b32 v73, 0
    v_mov_b32 v74, 0
    v_mov_b32 v75, 0
    v_mov_b32 v76, 0
    s_mov_b32 s59, 0
    v_mov_b32 v5, 0
    v_mov_b32 v105, 0
    v_mov_b32 v108, 0
    v_mov_b32 v110, 0
    v_mov_b32 v160, 0
    v_mov_b32 v163, 0
    v_mov_b32 v8, 162068
L_lw_101:
    ds_read_b32 v9, v8
    s_waitcnt lgkmcnt(0)
    v_cmp_gt_u32 vcc, 8, v9
    s_cbranch_vccz L_lw_101e
    s_sleep 8
    s_sub_u32 s60, s60, 1
    s_cbranch_scc0 L_lw_101
    s_mov_b32 s60, 0
L_lw_101e:
    v_and_b32 v2, 15, v0
    v_lshlrev_b32 v2, 3, v2
    v_add_u32 v3, 161920, v2
    ds_read_b64 v[8:9], v3
    v_mov_b32 v11, 162096
    ds_read_b32 v11, v11
    s_getreg_b32 s58, hwreg(HW_REG_XCC_ID, 0, 4)
    s_lshl_b32 s98, s34, 5
    s_add_u32 s98, s98, s35
    s_lshl_b32 s62, s98, 7
    s_add_u32 s62, s62, 73728
    s_and_b32 s99, s62, 0xffffff00
    s_lshl_b32 s98, s98, 8
    s_add_u32 s98, s98, 106496
    v_lshlrev_b32 v39, 2, v0
    v_and_b32 v21, 64, v2
    v_add_u32 v21, v21, v2
    v_cmp_eq_u32 vcc, 8, v0
    s_bfm_b64 exec, 8, 0
    s_bitset1_b32 exec_lo, 8
    s_waitcnt lgkmcnt(0)
    v_lshl_add_u32 v10, v11, 8, s58
    v_cndmask_b32 v8, v8, v10, vcc
    buffer_store_dwordx2 v[8:9], v2, s[40:43], s62 offen sc1
    s_mov_b64 exec, -1
    v_mov_b32 v12, 162076
L_lw_102:
    ds_read_b32 v13, v12
    s_waitcnt lgkmcnt(0)
    v_cmp_gt_u32 vcc, 4, v13
    s_cbranch_vccz L_lw_102e
    s_sleep 4
    s_sub_u32 s60, s60, 1
    s_cbranch_scc0 L_lw_102
    s_mov_b32 s60, 0
L_lw_102e:
    v_and_b32 v11, 31, v0
    v_lshlrev_b32 v11, 7, v11
    s_lshl_b32 s63, s34, 12
    s_add_u32 s63, s63, 73792
    buffer_load_dword v12, v39, s[40:43], s98 offen sc1
    s_branch L_poll_103
L_poll_103s:
    s_sleep 16
L_poll_103:
    buffer_load_dwordx2 v[8:9], v21, s[40:43], s99 offen sc1
    buffer_load_dword v10, v11, s[40:43], s63 offen sc1
    s_sub_u32 s60, s60, 1
    s_cbranch_scc1 L_poll_103t
    s_waitcnt vmcnt(0)
    v_max3_u32 v38, v8, v9, v10
    v_cmp_eq_u32 vcc, -1, v38
    s_cbranch_vccnz L_poll_103s
L_poll_103e:
    v_mov_b32 v37, v8
    s_nop 1
    v_max_f32_dpp v37, v37, v37 quad_perm:[1,0,3,2] row_mask:0xf bank_mask:0xf
    s_nop 1
    v_max_f32_dpp v37, v37, v37 quad_perm:[2,3,0,1] row_mask:0xf bank_mask:0xf
    s_nop 1
    v_max_f32_dpp v37, v37, v37 row_ror:4 row_mask:0xf bank_mask:0xf
    s_nop 1
    v_max_f32_dpp v37, v37, v37 row_ror:8 row_mask:0xf bank_mask:0xf
    v_sub_f32 v8, v8, v37
    v_exp_f32 v8, v8
    s_nop 0
    v_mul_f32 v9, v8, v9
    s_nop 1
    v_add_f32_dpp v9, v9, v9 quad_perm:[1,0,3,2] row_mask:0xf bank_mask:0xf
    s_nop 1
    v_add_f32_dpp v9, v9, v9 quad_perm:[2,3,0,1] row_mask:0xf bank_mask:0xf
    s_nop 1
    v_add_f32_dpp v9, v9, v9 row_ror:4 row_mask:0xf bank_mask:0xf
    s_nop 1
    v_add_f32_dpp v9, v9, v9 row_ror:8 row_mask:0xf bank_mask:0xf
    v_and_b32 v10, 0xff, v10
    s_getreg_b32 s62, hwreg(HW_REG_XCC_ID, 0, 4)
    v_cmp_ne_u32 vcc, s62, v10
    s_nop 0
    s_cmp_eq_u64 vcc, 0
    s_cselect_b32 s61, 1, 0
    v_rcp_f32 v9, v9
    v_lshrrev_b32 v3, 1, v2
    v_add_u32 v3, 161984, v3
    v_mul_f32 v8, v8, v9
    v_mov_b32 v10, 162072
    v_mov_b32 v11, s61
    ds_write_b32 v3, v8
    ds_write_b32 v10, v11
    s_mov_b32 s3, 1
    v_lshrrev_b32 v9, 4, v0
    v_lshl_add_u32 v8, v9, 2, v2
    s_lshl_b32 s96, s3, 9
    s_add_u32 s96, s96, 157824
    v_lshl_add_u32 v8, v8, 2, s96
    v_lshlrev_b32 v9, 3, v0
    v_add_u32 v9, 157824, v9
    v_mov_b32 v10, 162048
    v_mov_b32 v11, 1
    s_lshl_b32 s96, s38, 5
    s_add_u32 s96, s96, 161984
    v_mov_b32 v3, s96
    s_sub_u32 s62, 8, s39
    s_lshl_b32 s98, s34, 5
    s_add_u32 s98, s98, s35
    s_lshl_b32 s98, s98, 8
    s_add_u32 s98, s98, 106496
    v_lshlrev_b32 v39, 2, v0
    s_branch L_t0b
L_jobend:
    v_lshlrev_b32 v9, 4, v0
    s_mov_b32 exec_hi, 0
    s_nop 3
    buffer_store_dwordx4 v[32:35], v9, s[40:43], s13 offen sc1
    s_endpgm
L_proxy:
    v_mov_b32 v72, 0
    v_mov_b32 v73, 0
    v_mov_b32 v74, 0
    v_mov_b32 v75, 0
    v_mov_b32 v76, 0
    v_mov_b32 v5, 0
    v_mov_b32 v105, 0
    v_mov_b32 v108, 0
    v_mov_b32 v110, 0
    v_mov_b32 v160, 0
    v_mov_b32 v163, 0
    s_barrier
    s_waitcnt lgkmcnt(0)
    s_mov_b32 s40, s32
    s_mov_b32 s41, s33
    s_mov_b32 s42, 589824
    s_mov_b32 s43, 0x20000
    s_mov_b32 s44, s30
    s_mov_b32 s45, s31
    s_mov_b32 s46, 256
    s_mov_b32 s47, 0x20000
    s_sub_u32 s97, 7, s3
    s_mul_i32 s97, s97, 27
    s_cmp_eq_u32 s3, 5
    s_cselect_b32 s97, 32, s97
    s_add_u32 s97, s97, s35
    s_lshl_b32 s97, s97, 9
    s_add_u32 s97, s97, 172032
    v_and_b32 v2, 15, v0
    v_lshlrev_b32 v2, 3, v2
    v_and_b32 v20, 31, v0
    v_lshlrev_b32 v20, 4, v20
    s_cmp_lg_u32 s3, 7
    s_cbranch_scc1 L_px6
    s_sub_u32 s96, 6, s59
    v_mov_b32 v8, 162068
L_lw_104:
    ds_read_b32 v9, v8
    s_waitcnt lgkmcnt(0)
    v_cmp_gt_u32 vcc, s96, v9
    s_cbranch_vccz L_lw_104e
    s_sleep 8
    s_sub_u32 s60, s60, 1
    s_cbranch_scc0 L_lw_104
    s_mov_b32 s60, 0
L_lw_104e:
    v_and_b32 v2, 15, v0
    v_lshlrev_b32 v2, 3, v2
    v_add_u32 v3, 161920, v2
    ds_read_b64 v[8:9], v3
    v_mov_b32 v11, 162096
    ds_read_b32 v11, v11
    s_getreg_b32 s58, hwreg(HW_REG_XCC_ID, 0, 4)
    s_lshl_b32 s98, s34, 5
    s_add_u32 s98, s98, s35
    s_lshl_b32 s62, s98, 7
    s_add_u32 s62, s62, 73728
    s_and_b32 s99, s62, 0xffffff00
    s_lshl_b32 s98, s98, 8
    s_add_u32 s98, s98, 106496
    v_lshlrev_b32 v39, 2, v0
    v_and_b32 v21, 64, v2
    v_add_u32 v21, v21, v2
    v_cmp_eq_u32 vcc, 8, v0
    s_bfm_b64 exec, s96, 0
    s_bitset1_b32 exec_lo, 8
    s_waitcnt lgkmcnt(0)
    v_lshl_add_u32 v10, v11, 8, s58
    v_cndmask_b32 v8, v8, v10, vcc
    buffer_store_dwordx2 v[8:9], v2, s[40:43], s62 offen sc1
    s_mov_b64 exec, -1
    s_mov_b32 s100, 4
    s_lshl_b32 s63, s100, 8
    v_and_b32 v8, 15, v0
    v_lshl_add_u32 v8, v8, 4, s63
    v_lshrrev_b32 v9, 4, v0
    v_mul_u32_u24 v5, 1280, v9
    v_add_u32 v5, v5, v8
    v_mul_u32_u24 v4, 1296, v9
    v_add_u32 v4, v4, v8
    v_add_u32 v4, 82944, v4
    v_lshlrev_b32 v6, 1, v5
    v_add_u32 v6, 99328, v6
    s_lshl_b32 s62, s100, 9
    s_add_u32 s62, s62, 88128
    v_lshl_add_u32 v7, v0, 3, s62
    s_mov_b32 s48, s4
    s_mov_b32 s49, s5
    s_mov_b32 s50, 5120
    s_mov_b32 s51, 0x20000
    buffer_load_dwordx4 v[8:11], v5, s[48:51], 0 offen
    s_mov_b32 s62, 20480
    s_mov_b32 s63, 30720
    s_branch L_poll_105
L_poll_105s:
    s_sleep 32
L_poll_105:
    buffer_load_dwordx4 v[12:15], v5, s[40:43], s62 offen sc1
    buffer_load_dwordx4 v[16:19], v5, s[40:43], s63 offen sc1
    s_sub_u32 s60, s60, 1
    s_cbranch_scc1 L_poll_105t
    s_waitcnt vmcnt(0)
    v_max3_u32 v38, v12, v13, v14
    v_max3_u32 v38, v38, v15, v16
    v_max3_u32 v38, v38, v17, v18
    v_max_u32 v38, v38, v19
    v_cmp_eq_u32 vcc, -1, v38
    s_cbranch_vccnz L_poll_105s
L_poll_105e:
    v_lshlrev_b32 v40, 16, v8
    v_and_b32 v41, 0xffff0000, v8
    v_lshlrev_b32 v42, 16, v9
    v_and_b32 v43, 0xffff0000, v9
    v_lshlrev_b32 v44, 16, v10
    v_and_b32 v45, 0xffff0000, v10
    v_lshlrev_b32 v46, 16, v11
    v_and_b32 v47, 0xffff0000, v11
    v_lshlrev_b32 v48, 16, v12
    v_and_b32 v49, 0xffff0000, v12
    v_lshlrev_b32 v50, 16, v13
    v_and_b32 v51, 0xffff0000, v13
    v_lshlrev_b32 v52, 16, v14
    v_and_b32 v53, 0xffff0000, v14
    v_lshlrev_b32 v54, 16, v15
    v_and_b32 v55, 0xffff0000, v15
    v_lshlrev_b32 v56, 16, v16
    v_and_b32 v57, 0xffff0000, v16
    v_lshlrev_b32 v58, 16, v17
    v_and_b32 v59, 0xffff0000, v17
    v_lshlrev_b32 v60, 16, v18
    v_and_b32 v61, 0xffff0000, v18
    v_lshlrev_b32 v62, 16, v19
    v_and_b32 v63, 0xffff0000, v19
    v_mov_b32 v64, 0
    v_mov_b32 v65, 0
    v_mov_b32 v66, 0
    v_mov_b32 v67, 0
    v_mov_b32 v68, 0
    v_mov_b32 v69, 0
    v_mov_b32 v70, 0
    v_mov_b32 v71, 0
    v_bfe_u32 v5, v0, 2, 2
    v_lshlrev_b32 v5, 8, v5
    v_lshrrev_b32 v8, 4, v0
    v_lshl_add_u32 v5, v8, 6, v5
    v_and_b32 v8, 3, v0
    v_lshl_add_u32 v5, v8, 4, v5
    s_lshl_b32 s56, s100, 10
    s_or_b32 s96, s59, s39
    s_cbranch_scc0 L_nofrag_106
    v_mov_b32 v104, 162060
L_lw_107:
    ds_read_b32 v105, v104
    s_waitcnt lgkmcnt(0)
    v_cmp_gt_u32 vcc, 4, v105
    s_cbranch_vccz L_lw_107e
    s_sleep 2
    s_sub_u32 s60, s60, 1
    s_cbranch_scc0 L_lw_107
    s_mov_b32 s60, 0
L_lw_107e:
    s_cmp_eq_u32 s59, 0
    s_cbranch_scc1 L_nofrag_106
    v_bfe_u32 v104, v0, 2, 1
    v_bfe_u32 v110, v0, 4, 1
    v_lshl_add_u32 v104, v110, 2, v104
    v_and_b32 v110, 8, v0
    v_add_u32 v104, v104, v110
    v_lshrrev_b32 v110, 5, v0
    v_lshl_add_u32 v104, v110, 4, v104
    v_bfe_u32 v111, v0, 0, 1
    v_mul_u32_u24 v111, 0xaaaa, v111
    v_add_u32 v111, 0x4444, v111
    v_mov_b32 v112, 0
    v_mov_b32 v113, 0
    v_mov_b32 v114, 0
    v_mov_b32 v115, 0
    v_mov_b32 v116, 0
    v_mov_b32 v117, 0
    v_mov_b32 v118, 0
    v_mov_b32 v119, 0
    v_lshlrev_b32 v104, 7, v104
    v_and_b32 v110, 3, v0
    v_lshl_add_u32 v104, v110, 3, v104
    v_lshrrev_b32 v109, 4, v0
    v_and_b32 v110, 1, v0
    s_lshr_b32 s63, s3, 1
    s_and_b32 s62, s3, 1
    s_lshl_b32 s96, s63, 14
    s_lshl_b32 s100, s62, 6
    s_add_u32 s100, s100, 81920
    s_add_u32 s96, s96, s100
    v_add_u32 v104, s96, v104
    ds_read_b64_tr_b16 v[72:73], v104 offset:0
    ds_read_b64_tr_b16 v[74:75], v104 offset:256
    ds_read_b64_tr_b16 v[76:77], v104 offset:4096
    ds_read_b64_tr_b16 v[78:79], v104 offset:4352
    ds_read_b64_tr_b16 v[80:81], v104 offset:32
    ds_read_b64_tr_b16 v[82:83], v104 offset:288
    ds_read_b64_tr_b16 v[84:85], v104 offset:4128
    ds_read_b64_tr_b16 v[86:87], v104 offset:4384
    ds_read_b64_tr_b16 v[88:89], v104 offset:8192
    ds_read_b64_tr_b16 v[90:91], v104 offset:8448
    ds_read_b64_tr_b16 v[92:93], v104 offset:12288
    ds_read_b64_tr_b16 v[94:95], v104 offset:12544
    ds_read_b64_tr_b16 v[96:97], v104 offset:8224
    ds_read_b64_tr_b16 v[98:99], v104 offset:8480
    ds_read_b64_tr_b16 v[100:101], v104 offset:12320
    ds_read_b64_tr_b16 v[102:103], v104 offset:12576
    v_bfe_u32 v105, v0, 1, 3
    v_lshlrev_b32 v105, 8, v105
    v_lshl_add_u32 v105, v109, 5, v105
    v_lshl_add_u32 v105, v110, 4, v105
    v_lshrrev_b32 v106, 3, v0
    v_lshlrev_b32 v106, 7, v106
    v_and_b32 v110, 7, v0
    v_lshl_add_u32 v107, v110, 3, v106
    v_add_u32 v107, s100, v107
    v_lshlrev_b32 v106, 8, v109
    v_and_b32 v110, 15, v0
    v_lshl_add_u32 v106, v110, 2, v106
    v_add_u32 v106, s96, v106
    v_lshlrev_b32 v108, 2, v0
    s_lshl_b32 s96, s62, 2
    s_add_u32 s96, s96, 162088
    v_mov_b32 v109, s96
    s_lshl_b32 s100, s63, 11
    s_lshl_b32 s96, s34, 13
    s_add_u32 s100, s100, s96
    s_add_u32 s100, s100, 106496
    s_mul_i32 s101, s34, 5120
    s_lshl_b32 s96, s35, 9
    s_add_u32 s101, s101, s96
    s_lshl_b32 s96, s62, 8
    s_add_u32 s101, s101, s96
    s_sub_u32 s101, s101, 11264
    s_and_b32 s96, s101, 0xffffe000
    s_add_u32 s101, s101, s96
    s_add_u32 s101, s101, 212992
    v_add_u32 v110, 8192, v108
L_nofrag_106:
    s_cmp_ge_u32 s35, 20
    s_cbranch_scc1 L_nofin_108
    s_lshl1_add_u32 s62, s35, s3
    s_sub_u32 s62, s62, 6
    s_lshl_b32 s57, s62, 7
    s_mul_i32 s63, s62, 0x199a
    s_lshr_b32 s63, s63, 16
    s_mul_i32 s63, s63, 1280
    s_sub_u32 s63, s57, s63
    v_lshrrev_b32 v72, 3, v0
    v_mul_u32_u24 v72, 5120, v72
    v_and_b32 v8, 7, v0
    v_lshl_add_u32 v72, v8, 4, v72
    s_add_u32 s62, s57, 327680
    v_add_u32 v72, s62, v72
    v_add_u32 v73, 40960, v72
    v_add_u32 v74, 81920, v72
    v_add_u32 v75, 122880, v72
    v_bfe_u32 v9, v0, 4, 1
    v_lshlrev_b32 v76, 4, v8
    v_lshl_add_u32 v76, v9, 3, v76
    s_lshl_b32 s62, s57, 1
    s_add_u32 s62, s62, 99328
    v_lshl_add_u32 v77, v76, 1, s62
    s_mov_b32 s48, s22
    s_mov_b32 s49, s23
    s_mov_b32 s50, 1280
    s_mov_b32 s51, 0x20000
    buffer_load_dwordx2 v[86:87], v76, s[48:51], s63 offen
    s_add_u32 s62, s57, 35840
    s_branch L_poll_109
L_poll_109s:
    s_sleep 32
L_poll_109:
    buffer_load_dwordx2 v[8:9], v76, s[40:43], s62 offen sc1
    s_sub_u32 s60, s60, 1
    s_cbranch_scc1 L_poll_109t
    s_waitcnt vmcnt(0)
    v_max_u32 v38, v8, v9
    v_cmp_eq_u32 vcc, -1, v38
    s_cbranch_vccnz L_poll_109s
L_poll_109e:
    v_lshlrev_b32 v78, 16, v86
    v_and_b32 v79, 0xffff0000, v86
    v_lshlrev_b32 v82, 16, v8
    v_and_b32 v83, 0xffff0000, v8
    v_lshlrev_b32 v80, 16, v87
    v_and_b32 v81, 0xffff0000, v87
    v_lshlrev_b32 v84, 16, v9
    v_and_b32 v85, 0xffff0000, v9
    v_bfe_u32 v8, v0, 1, 3
    v_and_b32 v9, 1, v0
    v_lshlrev_b32 v9, 4, v9
    v_mov_b32 v10, 0x3f80
    v_lshlrev_b32 v9, v9, v10
    v_cmp_eq_u32 vcc, 0, v8
    v_mov_b32 v100, 0
    s_nop 0
    v_cndmask_b32 v104, 0, v9, vcc
    v_cmp_eq_u32 vcc, 1, v8
    v_mov_b32 v101, 0
    s_nop 0
    v_cndmask_b32 v105, 0, v9, vcc
    v_cmp_eq_u32 vcc, 2, v8
    v_mov_b32 v102, 0
    s_nop 0
    v_cndmask_b32 v106, 0, v9, vcc
    v_cmp_eq_u32 vcc, 3, v8
    v_mov_b32 v103, 0
    s_nop 0
    v_cndmask_b32 v107, 0, v9, vcc
L_nofin_108:
    v_mov_b32 v12, 162076
L_lw_110:
    ds_read_b32 v13, v12
    s_waitcnt lgkmcnt(0)
    v_cmp_gt_u32 vcc, 4, v13
    s_cbranch_vccz L_lw_110e
    s_sleep 4
    s_sub_u32 s60, s60, 1
    s_cbranch_scc0 L_lw_110
    s_mov_b32 s60, 0
L_lw_110e:
    v_and_b32 v11, 31, v0
    v_lshlrev_b32 v11, 7, v11
    s_lshl_b32 s63, s34, 12
    s_add_u32 s63, s63, 73792
    buffer_load_dword v12, v39, s[40:43], s98 offen sc1
    s_branch L_poll_111
L_poll_111s:
    s_sleep 4
L_poll_111:
    buffer_load_dwordx2 v[8:9], v21, s[40:43], s99 offen sc1
    buffer_load_dword v10, v11, s[40:43], s63 offen sc1
    buffer_load_dwordx4 v[32:35], v20, s[40:43], s97 offen sc1
    s_sub_u32 s60, s60, 1
    s_cbranch_scc1 L_poll_111t
    s_waitcnt vmcnt(0)
    v_max3_u32 v38, v8, v9, v10
    v_max3_u32 v38, v38, v32, v33
    v_max3_u32 v38, v38, v34, v35
    v_cmp_eq_u32 vcc, -1, v38
    s_cbranch_vccnz L_poll_111s
L_poll_111e:
    v_mov_b32 v37, v8
    s_nop 1
    v_max_f32_dpp v37, v37, v37 quad_perm:[1,0,3,2] row_mask:0xf bank_mask:0xf
    s_nop 1
    v_max_f32_dpp v37, v37, v37 quad_perm:[2,3,0,1] row_mask:0xf bank_mask:0xf
    s_nop 1
    v_max_f32_dpp v37, v37, v37 row_ror:4 row_mask:0xf bank_mask:0xf
    s_nop 1
    v_max_f32_dpp v37, v37, v37 row_ror:8 row_mask:0xf bank_mask:0xf
    v_sub_f32 v8, v8, v37
    v_exp_f32 v8, v8
    s_nop 0
    v_mul_f32 v9, v8, v9
    s_nop 1
    v_add_f32_dpp v9, v9, v9 quad_perm:[1,0,3,2] row_mask:0xf bank_mask:0xf
    s_nop 1
    v_add_f32_dpp v9, v9, v9 quad_perm:[2,3,0,1] row_mask:0xf bank_mask:0xf
    s_nop 1
    v_add_f32_dpp v9, v9, v9 row_ror:4 row_mask:0xf bank_mask:0xf
    s_nop 1
    v_add_f32_dpp v9, v9, v9 row_ror:8 row_mask:0xf bank_mask:0xf
    v_ashrrev_i32 v12, 8, v10
    s_nop 1
    v_add_u32_dpp v12, v12, v12 quad_perm:[1,0,3,2] row_mask:0xf bank_mask:0xf
    s_nop 1
    v_add_u32_dpp v12, v12, v12 quad_perm:[2,3,0,1] row_mask:0xf bank_mask:0xf
    s_nop 1
    v_add_u32_dpp v12, v12, v12 row_ror:4 row_mask:0xf bank_mask:0xf
    s_nop 1
    v_add_u32_dpp v12, v12, v12 row_ror:8 row_mask:0xf bank_mask:0xf
    v_mov_b32 v13, v12
    s_nop 1
    v_permlane16_swap_b32 v12, v13
    v_add_u32 v12, v12, v13
    v_mov_b32 v13, v12
    s_nop 1
    v_permlane32_swap_b32 v12, v13
    v_add_u32 v12, v12, v13
    v_ashrrev_i32 v12, 31, v12
    v_and_b32 v12, 8192, v12
    v_mov_b32 v13, 162084
    ds_write_b32 v13, v12
    v_and_b32 v10, 0xff, v10
    s_getreg_b32 s62, hwreg(HW_REG_XCC_ID, 0, 4)
    v_cmp_ne_u32 vcc, s62, v10
    s_nop 0
    s_cmp_eq_u64 vcc, 0
    s_cselect_b32 s61, 1, 0
    v_rcp_f32 v9, v9
    v_lshrrev_b32 v3, 1, v2
    v_add_u32 v3, 161984, v3
    v_mul_f32 v8, v8, v9
    v_mov_b32 v10, 162072
    v_mov_b32 v11, s61
    ds_write_b32 v3, v8
    ds_write_b32 v10, v11
    s_branch L_pxj
L_px6:
    s_mov_b32 s62, 3
    s_lshl1_add_u32 s96, s35, s3
    s_and_b32 s63, s96, 7
    s_lshl_b32 s63, s63, 14
    s_lshl_b32 s96, s96, 7
    s_add_u32 s96, s96, s63
    s_add_u32 s96, s96, 475136
    s_add_u32 s98, s32, s96
    s_addc_u32 s99, s33, 0
    s_load_dword s4, s[98:99], 0 glc
    s_load_dword s5, s[98:99], 8192 glc
    s_mov_b32 s63, 0
    s_waitcnt lgkmcnt(0)
L_np:
    s_not_b32 s4, s4
    s_mov_b32 s6, s4
    s_mov_b32 s7, 0
    s_load_dword s4, s[98:99], 0 glc
L_npc0:
    s_add_u32 s7, s7, 1
    s_cmp_eq_u32 s4, s6
    s_cselect_b32 s8, s7, 1000
    s_cmp_lt_u32 s8, 60
    s_cbranch_scc1 L_npc0
    s_waitcnt lgkmcnt(0)
    s_sub_u32 s63, s63, s7
    s_not_b32 s5, s5
    s_mov_b32 s6, s5
    s_mov_b32 s7, 0
    s_load_dword s5, s[98:99], 8192 glc
L_npc1:
    s_add_u32 s7, s7, 1
    s_cmp_eq_u32 s5, s6
    s_cselect_b32 s8, s7, 1000
    s_cmp_lt_u32 s8, 60
    s_cbranch_scc1 L_npc1
    s_waitcnt lgkmcnt(0)
    s_add_u32 s63, s63, s7
    s_sub_u32 s62, s62, 1
    s_cmp_lg_u32 s62, 0
    s_cbranch_scc1 L_np
    v_mov_b32 v8, 162096
    v_mov_b32 v9, s63
    s_mov_b64 exec, 1
    ds_add_u32 v8, v9
    s_mov_b64 exec, -1
    s_or_b32 s96, s59, s39
    s_cbranch_scc0 L_nofrag_112
    v_mov_b32 v104, 162060
L_lw_113:
    ds_read_b32 v105, v104
    s_waitcnt lgkmcnt(0)
    v_cmp_gt_u32 vcc, 4, v105
    s_cbranch_vccz L_lw_113e
    s_sleep 2
    s_sub_u32 s60, s60, 1
    s_cbranch_scc0 L_lw_113
    s_mov_b32 s60, 0
L_lw_113e:
    s_cmp_eq_u32 s59, 0
    s_cbranch_scc1 L_nofrag_112
    v_bfe_u32 v104, v0, 2, 1
    v_bfe_u32 v110, v0, 4, 1
    v_lshl_add_u32 v104, v110, 2, v104
    v_and_b32 v110, 8, v0
    v_add_u32 v104, v104, v110
    v_lshrrev_b32 v110, 5, v0
    v_lshl_add_u32 v104, v110, 4, v104
    v_bfe_u32 v111, v0, 0, 1
    v_mul_u32_u24 v111, 0xaaaa, v111
    v_add_u32 v111, 0x4444, v111
    v_mov_b32 v112, 0
    v_mov_b32 v113, 0
    v_mov_b32 v114, 0
    v_mov_b32 v115, 0
    v_mov_b32 v116, 0
    v_mov_b32 v117, 0
    v_mov_b32 v118, 0
    v_mov_b32 v119, 0
    v_lshlrev_b32 v104, 7, v104
    v_and_b32 v110, 3, v0
    v_lshl_add_u32 v104, v110, 3, v104
    v_lshrrev_b32 v109, 4, v0
    v_and_b32 v110, 1, v0
    s_lshr_b32 s63, s3, 1
    s_and_b32 s62, s3, 1
    s_lshl_b32 s96, s63, 14
    s_lshl_b32 s100, s62, 6
    s_add_u32 s100, s100, 81920
    s_add_u32 s96, s96, s100
    v_add_u32 v104, s96, v104
    ds_read_b64_tr_b16 v[72:73], v104 offset:0
    ds_read_b64_tr_b16 v[74:75], v104 offset:256
    ds_read_b64_tr_b16 v[76:77], v104 offset:4096
    ds_read_b64_tr_b16 v[78:79], v104 offset:4352
    ds_read_b64_tr_b16 v[80:81], v104 offset:32
    ds_read_b64_tr_b16 v[82:83], v104 offset:288
    ds_read_b64_tr_b16 v[84:85], v104 offset:4128
    ds_read_b64_tr_b16 v[86:87], v104 offset:4384
    ds_read_b64_tr_b16 v[88:89], v104 offset:8192
    ds_read_b64_tr_b16 v[90:91], v104 offset:8448
    ds_read_b64_tr_b16 v[92:93], v104 offset:12288
    ds_read_b64_tr_b16 v[94:95], v104 offset:12544
    ds_read_b64_tr_b16 v[96:97], v104 offset:8224
    ds_read_b64_tr_b16 v[98:99], v104 offset:8480
    ds_read_b64_tr_b16 v[100:101], v104 offset:12320
    ds_read_b64_tr_b16 v[102:103], v104 offset:12576
    v_bfe_u32 v105, v0, 1, 3
    v_lshlrev_b32 v105, 8, v105
    v_lshl_add_u32 v105, v109, 5, v105
    v_lshl_add_u32 v105, v110, 4, v105
    v_lshrrev_b32 v106, 3, v0
    v_lshlrev_b32 v106, 7, v106
    v_and_b32 v110, 7, v0
    v_lshl_add_u32 v107, v110, 3, v106
    v_add_u32 v107, s100, v107
    v_lshlrev_b32 v106, 8, v109
    v_and_b32 v110, 15, v0
    v_lshl_add_u32 v106, v110, 2, v106
    v_add_u32 v106, s96, v106
    v_lshlrev_b32 v108, 2, v0
    s_lshl_b32 s96, s62, 2
    s_add_u32 s96, s96, 162088
    v_mov_b32 v109, s96
    s_lshl_b32 s100, s63, 11
    s_lshl_b32 s96, s34, 13
    s_add_u32 s100, s100, s96
    s_add_u32 s100, s100, 106496
    s_mul_i32 s101, s34, 5120
    s_lshl_b32 s96, s35, 9
    s_add_u32 s101, s101, s96
    s_lshl_b32 s96, s62, 8
    s_add_u32 s101, s101, s96
    s_sub_u32 s101, s101, 11264
    s_and_b32 s96, s101, 0xffffe000
    s_add_u32 s101, s101, s96
    s_add_u32 s101, s101, 212992
    v_add_u32 v110, 8192, v108
L_nofrag_112:
    v_mov_b32 v8, 162068
L_lw_114:
    ds_read_b32 v9, v8
    s_waitcnt lgkmcnt(0)
    v_cmp_gt_u32 vcc, 1, v9
    s_cbranch_vccz L_lw_114e
    s_sleep 32
    s_sub_u32 s60, s60, 1
    s_cbranch_scc0 L_lw_114
    s_mov_b32 s60, 0
L_lw_114e:
    s_cmp_ge_u32 s35, 20
    s_cbranch_scc1 L_nofin_115
    s_lshl1_add_u32 s62, s35, s3
    s_sub_u32 s62, s62, 6
    s_lshl_b32 s57, s62, 7
    s_mul_i32 s63, s62, 0x199a
    s_lshr_b32 s63, s63, 16
    s_mul_i32 s63, s63, 1280
    s_sub_u32 s63, s57, s63
    v_lshrrev_b32 v72, 3, v0
    v_mul_u32_u24 v72, 5120, v72
    v_and_b32 v8, 7, v0
    v_lshl_add_u32 v72, v8, 4, v72
    s_add_u32 s62, s57, 327680
    v_add_u32 v72, s62, v72
    v_add_u32 v73, 40960, v72
    v_add_u32 v74, 81920, v72
    v_add_u32 v75, 122880, v72
    v_bfe_u32 v9, v0, 4, 1
    v_lshlrev_b32 v76, 4, v8
    v_lshl_add_u32 v76, v9, 3, v76
    s_lshl_b32 s62, s57, 1
    s_add_u32 s62, s62, 99328
    v_lshl_add_u32 v77, v76, 1, s62
    s_mov_b32 s48, s22
    s_mov_b32 s49, s23
    s_mov_b32 s50, 1280
    s_mov_b32 s51, 0x20000
    buffer_load_dwordx2 v[86:87], v76, s[48:51], s63 offen
    s_add_u32 s62, s57, 35840
    s_branch L_poll_116
L_poll_116s:
    s_sleep 32
L_poll_116:
    buffer_load_dwordx2 v[8:9], v76, s[40:43], s62 offen sc1
    s_sub_u32 s60, s60, 1
    s_cbranch_scc1 L_poll_116t
    s_waitcnt vmcnt(0)
    v_max_u32 v38, v8, v9
    v_cmp_eq_u32 vcc, -1, v38
    s_cbranch_vccnz L_poll_116s
L_poll_116e:
    v_lshlrev_b32 v78, 16, v86
    v_and_b32 v79, 0xffff0000, v86
    v_lshlrev_b32 v82, 16, v8
    v_and_b32 v83, 0xffff0000, v8
    v_lshlrev_b32 v80, 16, v87
    v_and_b32 v81, 0xffff0000, v87
    v_lshlrev_b32 v84, 16, v9
    v_and_b32 v85, 0xffff0000, v9
    v_bfe_u32 v8, v0, 1, 3
    v_and_b32 v9, 1, v0
    v_lshlrev_b32 v9, 4, v9
    v_mov_b32 v10, 0x3f80
    v_lshlrev_b32 v9, v9, v10
    v_cmp_eq_u32 vcc, 0, v8
    v_mov_b32 v100, 0
    s_nop 0
    v_cndmask_b32 v104, 0, v9, vcc
    v_cmp_eq_u32 vcc, 1, v8
    v_mov_b32 v101, 0
    s_nop 0
    v_cndmask_b32 v105, 0, v9, vcc
    v_cmp_eq_u32 vcc, 2, v8
    v_mov_b32 v102, 0
    s_nop 0
    v_cndmask_b32 v106, 0, v9, vcc
    v_cmp_eq_u32 vcc, 3, v8
    v_mov_b32 v103, 0
    s_nop 0
    v_cndmask_b32 v107, 0, v9, vcc
L_nofin_115:
    v_mov_b32 v8, 162076
L_lw_117:
    ds_read_b32 v9, v8
    s_waitcnt lgkmcnt(0)
    v_cmp_gt_u32 vcc, 4, v9
    s_cbranch_vccz L_lw_117e
    s_sleep 16
    s_sub_u32 s60, s60, 1
    s_cbranch_scc0 L_lw_117
    s_mov_b32 s60, 0
L_lw_117e:
    s_branch L_poll_118
L_poll_118s:
    s_sleep 4
L_poll_118:
    buffer_load_dwordx4 v[32:35], v20, s[40:43], s97 offen sc1
    s_sub_u32 s60, s60, 1
    s_cbranch_scc1 L_poll_118t
    s_waitcnt vmcnt(0)
    v_max3_u32 v38, v32, v33, v34
    v_max_u32 v38, v38, v35
    v_cmp_eq_u32 vcc, -1, v38
    s_cbranch_vccnz L_poll_118s
L_poll_118e:
L_pxj:
    s_cmp_ge_u32 s35, 20
    s_cbranch_scc1 L_pxk
    buffer_load_dwordx4 v[88:91], v72, s[40:43], 0 offen sc1
    buffer_load_dwordx4 v[92:95], v73, s[40:43], 0 offen sc1
    buffer_load_dwordx4 v[96:99], v74, s[40:43], 0 offen sc1
    s_mov_b64 exec, 0xffffff
    buffer_load_dwordx4 v[100:103], v75, s[40:43], 0 offen sc1
    s_mov_b64 exec, -1
L_pxk:
    v_mov_b32 v8, 162048
L_lw_119:
    ds_read_b32 v9, v8
    s_waitcnt lgkmcnt(0)
    v_cmp_gt_u32 vcc, 3, v9
    s_cbranch_vccz L_lw_119e
    s_sleep 2
    s_sub_u32 s60, s60, 1
    s_cbranch_scc0 L_lw_119
    s_mov_b32 s60, 0
L_lw_119e:
    v_lshrrev_b32 v9, 4, v0
    v_lshl_add_u32 v8, v9, 2, v2
    s_lshl_b32 s96, s3, 9
    s_add_u32 s96, s96, 157824
    v_lshl_add_u32 v8, v8, 2, s96
    v_lshlrev_b32 v9, 3, v0
    v_add_u32 v9, 157824, v9
    v_mov_b32 v10, 162048
    v_mov_b32 v11, 1
    s_lshl_b32 s96, s38, 5
    s_add_u32 s96, s96, 161984
    v_mov_b32 v3, s96
    s_sub_u32 s62, 8, s39
    s_lshl_b32 s98, s34, 5
    s_add_u32 s98, s98, s35
    s_lshl_b32 s98, s98, 8
    s_add_u32 s98, s98, 106496
    v_lshlrev_b32 v39, 2, v0
    s_branch L_t0
L_s_role:
    s_cmp_eq_u32 s3, 7
    s_cbranch_scc1 L_t2gate
    s_cmp_gt_u32 s3, 3
    s_cbranch_scc1 L_fin_prep
    s_mov_b32 s48, s18
    s_mov_b32 s49, s19
    s_mov_b32 s50, 3456
    s_mov_b32 s51, 0x20000
    v_lshrrev_b32 v3, 4, v0
    v_and_b32 v4, 15, v0
    v_lshlrev_b32 v4, 1, v4
    s_lshl_b32 s62, s35, 7
    s_lshl_b32 s63, s3, 5
    s_add_u32 s62, s62, s63
    buffer_load_ushort v82, v4, s[48:51], s62 offen
    v_mov_b32 v72, 162064
L_lw_120:
    ds_read_b32 v73, v72
    s_waitcnt lgkmcnt(0)
    v_cmp_gt_u32 vcc, 4, v73
    s_cbranch_vccz L_lw_120e
    s_sleep 2
    s_sub_u32 s60, s60, 1
    s_cbranch_scc0 L_lw_120
    s_mov_b32 s60, 0
L_lw_120e:
    v_bfe_u32 v72, v0, 2, 1
    v_bfe_u32 v73, v0, 4, 1
    v_lshl_add_u32 v72, v73, 2, v72
    v_and_b32 v73, 8, v0
    v_add_u32 v72, v72, v73
    v_lshrrev_b32 v73, 5, v0
    v_lshl_add_u32 v72, v73, 4, v72
    v_lshlrev_b32 v72, 7, v72
    v_and_b32 v73, 3, v0
    v_lshl_add_u32 v72, v73, 3, v72
    v_and_b32 v73, 8, v0
    v_lshl_add_u32 v72, v73, 3, v72
    v_xor_b32 v72, s63, v72
    v_xor_b32 v73, 32, v72
    v_add_u32 v74, 40960, v72
    v_add_u32 v75, 40960, v73
    v_bfe_u32 v1, v0, 2, 2
    v_bfe_u32 v2, v0, 1, 1
    v_and_b32 v6, 1, v0
    v_lshlrev_b32 v7, 5, v3
    v_lshl_add_u32 v7, v6, 4, v7
    v_lshl_add_u32 v5, v2, 2, v1
    v_mul_u32_u24 v5, 1296, v5
    v_add_u32 v5, v5, v7
    v_add_u32 v5, 147456, v5
    v_bfe_u32 v87, v0, 0, 1
    v_mul_u32_u24 v87, 0xaaaa, v87
    v_add_u32 v87, 0x4444, v87
    ds_read_b64_tr_b16 v[88:89], v72 offset:0
    ds_read_b64_tr_b16 v[90:91], v73 offset:256
    ds_read_b64_tr_b16 v[92:93], v72 offset:4096
    ds_read_b64_tr_b16 v[94:95], v73 offset:4352
    ds_read_b64_tr_b16 v[96:97], v72 offset:8192
    ds_read_b64_tr_b16 v[98:99], v73 offset:8448
    ds_read_b64_tr_b16 v[100:101], v72 offset:12288
    ds_read_b64_tr_b16 v[102:103], v73 offset:12544
    ds_read_b64_tr_b16 v[104:105], v72 offset:16384
    ds_read_b64_tr_b16 v[106:107], v73 offset:16640
    ds_read_b64_tr_b16 v[108:109], v72 offset:20480
    ds_read_b64_tr_b16 v[110:111], v73 offset:20736
    ds_read_b64_tr_b16 v[112:113], v72 offset:24576
    ds_read_b64_tr_b16 v[114:115], v73 offset:24832
    ds_read_b64_tr_b16 v[116:117], v72 offset:28672
    ds_read_b64_tr_b16 v[118:119], v73 offset:28928
    ds_read_b64_tr_b16 v[120:121], v72 offset:32768
    ds_read_b64_tr_b16 v[122:123], v73 offset:33024
    ds_read_b64_tr_b16 v[124:125], v72 offset:36864
    ds_read_b64_tr_b16 v[126:127], v73 offset:37120
    ds_read_b64_tr_b16 v[128:129], v74 offset:0
    ds_read_b64_tr_b16 v[130:131], v75 offset:256
    ds_read_b64_tr_b16 v[132:133], v74 offset:4096
    ds_read_b64_tr_b16 v[134:135], v75 offset:4352
    ds_read_b64_tr_b16 v[136:137], v74 offset:8192
    ds_read_b64_tr_b16 v[138:139], v75 offset:8448
    ds_read_b64_tr_b16 v[140:141], v74 offset:12288
    ds_read_b64_tr_b16 v[142:143], v75 offset:12544
    ds_read_b64_tr_b16 v[144:145], v74 offset:16384
    ds_read_b64_tr_b16 v[146:147], v75 offset:16640
    ds_read_b64_tr_b16 v[148:149], v74 offset:20480
    ds_read_b64_tr_b16 v[150:151], v75 offset:20736
    ds_read_b64_tr_b16 v[152:153], v74 offset:24576
    ds_read_b64_tr_b16 v[154:155], v75 offset:24832
    ds_read_b64_tr_b16 v[156:157], v74 offset:28672
    ds_read_b64_tr_b16 v[158:159], v75 offset:28928
    ds_read_b64_tr_b16 v[160:161], v74 offset:32768
    ds_read_b64_tr_b16 v[162:163], v75 offset:33024
    ds_read_b64_tr_b16 v[164:165], v74 offset:36864
    ds_read_b64_tr_b16 v[166:167], v75 offset:37120
    ds_read_b128 v[8:11], v5 offset:0
    ds_read_b128 v[12:15], v5 offset:128
    ds_read_b128 v[16:19], v5 offset:256
    ds_read_b128 v[20:23], v5 offset:384
    ds_read_b128 v[24:27], v5 offset:512
    ds_read_b128 v[28:31], v5 offset:640
    ds_read_b128 v[32:35], v5 offset:768
    ds_read_b128 v[36:39], v5 offset:896
    ds_read_b128 v[40:43], v5 offset:1024
    ds_read_b128 v[44:47], v5 offset:1152
    v_mov_b32 v48, 0
    v_mov_b32 v49, 0
    v_mov_b32 v50, 0
    v_mov_b32 v51, 0
    v_mov_b32 v52, 0
    v_mov_b32 v53, 0
    v_mov_b32 v54, 0
    v_mov_b32 v55, 0
    v_mov_b32 v56, 0
    v_mov_b32 v57, 0
    v_mov_b32 v58, 0
    v_mov_b32 v59, 0
    s_waitcnt lgkmcnt(9)
    v_smfmac_f32_16x16x64_bf16 v[48:51], v[8:11], v[88:95], v87
    s_waitcnt lgkmcnt(8)
    v_smfmac_f32_16x16x64_bf16 v[48:51], v[12:15], v[96:103], v87
    s_waitcnt lgkmcnt(7)
    v_smfmac_f32_16x16x64_bf16 v[48:51], v[16:19], v[104:111], v87
    s_waitcnt lgkmcnt(6)
    v_smfmac_f32_16x16x64_bf16 v[48:51], v[20:23], v[112:119], v87
    s_waitcnt lgkmcnt(5)
    v_smfmac_f32_16x16x64_bf16 v[48:51], v[24:27], v[120:127], v87
    s_waitcnt lgkmcnt(4)
    v_smfmac_f32_16x16x64_bf16 v[48:51], v[28:31], v[128:135], v87
    s_waitcnt lgkmcnt(3)
    v_smfmac_f32_16x16x64_bf16 v[48:51], v[32:35], v[136:143], v87
    s_waitcnt lgkmcnt(2)
    v_smfmac_f32_16x16x64_bf16 v[48:51], v[36:39], v[144:151], v87
    s_waitcnt lgkmcnt(1)
    v_smfmac_f32_16x16x64_bf16 v[48:51], v[40:43], v[152:159], v87
    s_waitcnt lgkmcnt(0)
    v_smfmac_f32_16x16x64_bf16 v[48:51], v[44:47], v[160:167], v87
    v_mul_u32_u24 v79, 1296, v1
    v_lshl_add_u32 v79, v2, 7, v79
    v_add_u32 v79, v79, v7
    v_add_u32 v79, 82944, v79
    v_mul_u32_u24 v80, 144, v3
    v_add3_u32 v80, v80, v4, s63
    v_add_u32 v80, 90688, v80
    v_lshlrev_b32 v81, 3, v0
    v_add_u32 v81, 88128, v81
    v_add_f32 v84, v48, v49
    v_add_f32 v85, v50, v51
    s_mov_b32 s62, 0xbacccccd
    s_mov_b32 s63, 0xbdd2d3e8
    v_mov_b32 v86, 0xc0135761
    s_waitcnt vmcnt(0)
    v_lshlrev_b32 v82, 16, v82
    v_add_f32 v85, v85, v82
    s_branch L_ffn1
L_fin_prep:
    s_cmp_lg_u32 s3, 6
    s_cbranch_scc1 L_end
    s_cmp_ge_u32 s35, 20
    s_cbranch_scc1 L_end
    s_barrier
L_fin:
    s_mov_b32 s52, s28
    s_mov_b32 s53, s29
    s_mov_b32 s54, 5120
    s_mov_b32 s55, 0x20000
    s_mov_b64 s[4:5], -1
    s_mov_b64 s[6:7], -1
    s_mov_b64 s[8:9], -1
    s_mov_b64 s[10:11], 0xffffff
    s_barrier
    ds_read_b128 v[108:111], v77
    s_barrier
L_yg:
    s_mov_b64 exec, s[4:5]
    buffer_load_dwordx4 v[88:91], v72, s[40:43], 0 offen sc1
    s_mov_b64 exec, s[6:7]
    buffer_load_dwordx4 v[92:95], v73, s[40:43], 0 offen sc1
    s_mov_b64 exec, s[8:9]
    buffer_load_dwordx4 v[96:99], v74, s[40:43], 0 offen sc1
    s_mov_b64 exec, s[10:11]
    buffer_load_dwordx4 v[100:103], v75, s[40:43], 0 offen sc1
    s_mov_b64 exec, -1
    s_sub_u32 s60, s60, 1
    s_cbranch_scc1 L_ygt
    s_waitcnt vmcnt(3)
    v_max3_u32 v3, v88, v89, v90
    v_max_u32 v3, v3, v91
    v_cmp_eq_u32 s[4:5], -1, v3
    s_waitcnt vmcnt(2)
    v_max3_u32 v3, v92, v93, v94
    v_max_u32 v3, v3, v95
    v_cmp_eq_u32 s[6:7], -1, v3
    s_waitcnt vmcnt(1)
    v_max3_u32 v3, v96, v97, v98
    v_max_u32 v3, v3, v99
    v_cmp_eq_u32 s[8:9], -1, v3
    s_waitcnt vmcnt(0)
    v_max3_u32 v3, v100, v101, v102
    v_max_u32 v3, v3, v103
    v_cmp_eq_u32 s[10:11], -1, v3
    s_or_b64 s[16:17], s[4:5], s[6:7]
    s_or_b64 s[16:17], s[16:17], s[8:9]
    s_or_b64 s[16:17], s[16:17], s[10:11]
    s_cbranch_scc1 L_yg
L_ygd:
    v_mfma_f32_16x16x32_bf16 v[112:115], v[104:107], v[88:91], 0
    v_mfma_f32_16x16x32_bf16 v[112:115], v[104:107], v[92:95], v[112:115]
    v_mfma_f32_16x16x32_bf16 v[112:115], v[104:107], v[96:99], v[112:115]
    v_mfma_f32_16x16x32_bf16 v[112:115], v[104:107], v[100:103], v[112:115]
    s_waitcnt lgkmcnt(0)
    v_pk_fma_f32 v[108:109], v[78:79], v[82:83], v[108:109]
    v_pk_fma_f32 v[110:111], v[80:81], v[84:85], v[110:111]
    s_nop 4
    v_add_f32_dpp v112, v112, v112 row_ror:8 row_mask:0xf bank_mask:0xf
    v_add_f32_dpp v113, v113, v113 row_ror:8 row_mask:0xf bank_mask:0xf
    v_add_f32_dpp v114, v114, v114 row_ror:8 row_mask:0xf bank_mask:0xf
    v_add_f32_dpp v115, v115, v115 row_ror:8 row_mask:0xf bank_mask:0xf
    v_pk_fma_f32 v[112:113], v[112:113], v[82:83], v[108:109]
    v_pk_fma_f32 v[114:115], v[114:115], v[84:85], v[110:111]
    v_cvt_pk_bf16_f32 v112, v112, v113
    v_cvt_pk_bf16_f32 v113, v114, v115
    s_mov_b64 exec, 0x00ff00ff
    buffer_store_dwordx2 v[112:113], v76, s[52:55], s57 offen
    s_endpgm
L_t2gate:
    v_mov_b32 v8, 162048
L_lw_121:
    ds_read_b32 v9, v8
    s_waitcnt lgkmcnt(0)
    v_cmp_gt_u32 vcc, 8, v9
    s_cbranch_vccz L_lw_121e
    s_sleep 2
    s_sub_u32 s60, s60, 1
    s_cbranch_scc0 L_lw_121
    s_mov_b32 s60, 0
L_lw_121e:
    ds_read_b32 v9, v8 offset:24
    ds_read_b32 v10, v8 offset:36
    v_add_u32 v5, 212992, v5
    s_waitcnt lgkmcnt(0)
    v_readfirstlane_b32 s61, v9
    v_add_u32 v5, v5, v10
    s_mov_b32 s58, 0x3f80
    s_mov_b32 s59, 0x3f800000
    s_mov_b32 s63, 0xff
L_prb:
    s_bcnt1_i32_b32 s62, s63
    s_mov_b32 s97, s63
    s_ff1_i32_b32 s12, s97
    s_bitset0_b32 s97, s12
    s_mul_i32 s4, s12, 5120
    s_add_u32 s4, s4, s56
    s_and_b32 s96, s4, 0xffffe000
    s_add_u32 s4, s4, s96
    s_cmp_eq_u32 s62, 1
    s_cbranch_scc1 L_pi1
    s_ff1_i32_b32 s13, s97
    s_bitset0_b32 s97, s13
    s_mul_i32 s5, s13, 5120
    s_add_u32 s5, s5, s56
    s_and_b32 s96, s5, 0xffffe000
    s_add_u32 s5, s5, s96
    s_cmp_eq_u32 s62, 2
    s_cbranch_scc1 L_pi2
    s_ff1_i32_b32 s14, s97
    s_bitset0_b32 s97, s14
    s_mul_i32 s6, s14, 5120
    s_add_u32 s6, s6, s56
    s_and_b32 s96, s6, 0xffffe000
    s_add_u32 s6, s6, s96
    s_cmp_eq_u32 s62, 3
    s_cbranch_scc1 L_pi3
    s_ff1_i32_b32 s15, s97
    s_bitset0_b32 s97, s15
    s_mul_i32 s7, s15, 5120
    s_add_u32 s7, s7, s56
    s_and_b32 s96, s7, 0xffffe000
    s_add_u32 s7, s7, s96
    s_cmp_eq_u32 s62, 4
    s_cbranch_scc1 L_pi4
    s_ff1_i32_b32 s16, s97
    s_bitset0_b32 s97, s16
    s_mul_i32 s8, s16, 5120
    s_add_u32 s8, s8, s56
    s_and_b32 s96, s8, 0xffffe000
    s_add_u32 s8, s8, s96
    s_cmp_eq_u32 s62, 5
    s_cbranch_scc1 L_pi5
    s_ff1_i32_b32 s17, s97
    s_bitset0_b32 s97, s17
    s_mul_i32 s9, s17, 5120
    s_add_u32 s9, s9, s56
    s_and_b32 s96, s9, 0xffffe000
    s_add_u32 s9, s9, s96
    s_cmp_eq_u32 s62, 6
    s_cbranch_scc1 L_pi6
    s_ff1_i32_b32 s18, s97
    s_bitset0_b32 s97, s18
    s_mul_i32 s10, s18, 5120
    s_add_u32 s10, s10, s56
    s_and_b32 s96, s10, 0xffffe000
    s_add_u32 s10, s10, s96
    s_cmp_eq_u32 s62, 7
    s_cbranch_scc1 L_pi7
    s_ff1_i32_b32 s19, s97
    s_bitset0_b32 s97, s19
    s_mul_i32 s11, s19, 5120
    s_add_u32 s11, s11, s56
    s_and_b32 s96, s11, 0xffffe000
    s_add_u32 s11, s11, s96
L_pi8:
    buffer_load_dwordx4 v[36:39], v5, s[40:43], s11 offen sc1
L_pi7:
    buffer_load_dwordx4 v[32:35], v5, s[40:43], s10 offen sc1
L_pi6:
    buffer_load_dwordx4 v[28:31], v5, s[40:43], s9 offen sc1
L_pi5:
    buffer_load_dwordx4 v[24:27], v5, s[40:43], s8 offen sc1
L_pi4:
    buffer_load_dwordx4 v[20:23], v5, s[40:43], s7 offen sc1
L_pi3:
    buffer_load_dwordx4 v[16:19], v5, s[40:43], s6 offen sc1
L_pi2:
    buffer_load_dwordx4 v[12:15], v5, s[40:43], s5 offen sc1
    buffer_load_dwordx4 v[8:11], v5, s[40:43], s4 offen sc1
    s_sub_u32 s60, s60, 1
    s_cbranch_scc1 L_pto
    s_waitcnt vmcnt(0)
    v_max3_u32 v3, v8, v9, v10
    v_max_u32 v3, v3, v11
    v_cmp_eq_u32 vcc, -1, v3
    s_cbranch_vccz L_pgot0
    v_max3_u32 v3, v12, v13, v14
    v_max_u32 v3, v3, v15
    v_cmp_eq_u32 vcc, -1, v3
    s_cbranch_vccz L_pgot1
    s_cmp_eq_u32 s62, 2
    s_cbranch_scc1 L_pi2
    v_max3_u32 v3, v16, v17, v18
    v_max_u32 v3, v3, v19
    v_cmp_eq_u32 vcc, -1, v3
    s_cbranch_vccz L_pgot2
    s_cmp_eq_u32 s62, 3
    s_cbranch_scc1 L_pi3
    v_max3_u32 v3, v20, v21, v22
    v_max_u32 v3, v3, v23
    v_cmp_eq_u32 vcc, -1, v3
    s_cbranch_vccz L_pgot3
    s_cmp_eq_u32 s62, 4
    s_cbranch_scc1 L_pi4
    v_max3_u32 v3, v24, v25, v26
    v_max_u32 v3, v3, v27
    v_cmp_eq_u32 vcc, -1, v3
    s_cbranch_vccz L_pgot4
    s_cmp_eq_u32 s62, 5
    s_cbranch_scc1 L_pi5
    v_max3_u32 v3, v28, v29, v30
    v_max_u32 v3, v3, v31
    v_cmp_eq_u32 vcc, -1, v3
    s_cbranch_vccz L_pgot5
    s_cmp_eq_u32 s62, 6
    s_cbranch_scc1 L_pi6
    v_max3_u32 v3, v32, v33, v34
    v_max_u32 v3, v3, v35
    v_cmp_eq_u32 vcc, -1, v3
    s_cbranch_vccz L_pgot6
    s_cmp_eq_u32 s62, 7
    s_cbranch_scc1 L_pi7
    v_max3_u32 v3, v36, v37, v38
    v_max_u32 v3, v3, v39
    v_cmp_eq_u32 vcc, -1, v3
    s_cbranch_vccz L_pgot7
    s_branch L_pi8
L_pgot0:
    v_dot2c_f32_bf16 v64, s58, v8
    v_dot2c_f32_bf16 v65, s59, v8
    v_dot2c_f32_bf16 v66, s58, v9
    v_dot2c_f32_bf16 v67, s59, v9
    v_dot2c_f32_bf16 v68, s58, v10
    v_dot2c_f32_bf16 v69, s59, v10
    v_dot2c_f32_bf16 v70, s58, v11
    v_dot2c_f32_bf16 v71, s59, v11
    s_bitset0_b32 s63, s12
    s_cmp_eq_u32 s63, 0
    s_cbranch_scc1 L_pgd
L_pn0:
    s_cmp_eq_u32 s62, 1
    s_cbranch_scc1 L_prb
    v_max3_u32 v3, v12, v13, v14
    v_max_u32 v3, v3, v15
    v_cmp_eq_u32 vcc, -1, v3
    s_cbranch_vccnz L_pn1
L_pgot1:
    v_dot2c_f32_bf16 v64, s58, v12
    v_dot2c_f32_bf16 v65, s59, v12
    v_dot2c_f32_bf16 v66, s58, v13
    v_dot2c_f32_bf16 v67, s59, v13
    v_dot2c_f32_bf16 v68, s58, v14
    v_dot2c_f32_bf16 v69, s59, v14
    v_dot2c_f32_bf16 v70, s58, v15
    v_dot2c_f32_bf16 v71, s59, v15
    s_bitset0_b32 s63, s13
    s_cmp_eq_u32 s63, 0
    s_cbranch_scc1 L_pgd
L_pn1:
    s_cmp_eq_u32 s62, 2
    s_cbranch_scc1 L_prb
    v_max3_u32 v3, v16, v17, v18
    v_max_u32 v3, v3, v19
    v_cmp_eq_u32 vcc, -1, v3
    s_cbranch_vccnz L_pn2
L_pgot2:
    v_dot2c_f32_bf16 v64, s58, v16
    v_dot2c_f32_bf16 v65, s59, v16
    v_dot2c_f32_bf16 v66, s58, v17
    v_dot2c_f32_bf16 v67, s59, v17
    v_dot2c_f32_bf16 v68, s58, v18
    v_dot2c_f32_bf16 v69, s59, v18
    v_dot2c_f32_bf16 v70, s58, v19
    v_dot2c_f32_bf16 v71, s59, v19
    s_bitset0_b32 s63, s14
    s_cmp_eq_u32 s63, 0
    s_cbranch_scc1 L_pgd
L_pn2:
    s_cmp_eq_u32 s62, 3
    s_cbranch_scc1 L_prb
    v_max3_u32 v3, v20, v21, v22
    v_max_u32 v3, v3, v23
    v_cmp_eq_u32 vcc, -1, v3
    s_cbranch_vccnz L_pn3
L_pgot3:
    v_dot2c_f32_bf16 v64, s58, v20
    v_dot2c_f32_bf16 v65, s59, v20
    v_dot2c_f32_bf16 v66, s58, v21
    v_dot2c_f32_bf16 v67, s59, v21
    v_dot2c_f32_bf16 v68, s58, v22
    v_dot2c_f32_bf16 v69, s59, v22
    v_dot2c_f32_bf16 v70, s58, v23
    v_dot2c_f32_bf16 v71, s59, v23
    s_bitset0_b32 s63, s15
    s_cmp_eq_u32 s63, 0
    s_cbranch_scc1 L_pgd
L_pn3:
    s_cmp_eq_u32 s62, 4
    s_cbranch_scc1 L_prb
    v_max3_u32 v3, v24, v25, v26
    v_max_u32 v3, v3, v27
    v_cmp_eq_u32 vcc, -1, v3
    s_cbranch_vccnz L_pn4
L_pgot4:
    v_dot2c_f32_bf16 v64, s58, v24
    v_dot2c_f32_bf16 v65, s59, v24
    v_dot2c_f32_bf16 v66, s58, v25
    v_dot2c_f32_bf16 v67, s59, v25
    v_dot2c_f32_bf16 v68, s58, v26
    v_dot2c_f32_bf16 v69, s59, v26
    v_dot2c_f32_bf16 v70, s58, v27
    v_dot2c_f32_bf16 v71, s59, v27
    s_bitset0_b32 s63, s16
    s_cmp_eq_u32 s63, 0
    s_cbranch_scc1 L_pgd
L_pn4:
    s_cmp_eq_u32 s62, 5
    s_cbranch_scc1 L_prb
    v_max3_u32 v3, v28, v29, v30
    v_max_u32 v3, v3, v31
    v_cmp_eq_u32 vcc, -1, v3
    s_cbranch_vccnz L_pn5
L_pgot5:
    v_dot2c_f32_bf16 v64, s58, v28
    v_dot2c_f32_bf16 v65, s59, v28
    v_dot2c_f32_bf16 v66, s58, v29
    v_dot2c_f32_bf16 v67, s59, v29
    v_dot2c_f32_bf16 v68, s58, v30
    v_dot2c_f32_bf16 v69, s59, v30
    v_dot2c_f32_bf16 v70, s58, v31
    v_dot2c_f32_bf16 v71, s59, v31
    s_bitset0_b32 s63, s17
    s_cmp_eq_u32 s63, 0
    s_cbranch_scc1 L_pgd
L_pn5:
    s_cmp_eq_u32 s62, 6
    s_cbranch_scc1 L_prb
    v_max3_u32 v3, v32, v33, v34
    v_max_u32 v3, v3, v35
    v_cmp_eq_u32 vcc, -1, v3
    s_cbranch_vccnz L_pn6
L_pgot6:
    v_dot2c_f32_bf16 v64, s58, v32
    v_dot2c_f32_bf16 v65, s59, v32
    v_dot2c_f32_bf16 v66, s58, v33
    v_dot2c_f32_bf16 v67, s59, v33
    v_dot2c_f32_bf16 v68, s58, v34
    v_dot2c_f32_bf16 v69, s59, v34
    v_dot2c_f32_bf16 v70, s58, v35
    v_dot2c_f32_bf16 v71, s59, v35
    s_bitset0_b32 s63, s18
    s_cmp_eq_u32 s63, 0
    s_cbranch_scc1 L_pgd
L_pn6:
    s_cmp_eq_u32 s62, 7
    s_cbranch_scc1 L_prb
    v_max3_u32 v3, v36, v37, v38
    v_max_u32 v3, v3, v39
    v_cmp_eq_u32 vcc, -1, v3
    s_cbranch_vccnz L_pn7
L_pgot7:
    v_dot2c_f32_bf16 v64, s58, v36
    v_dot2c_f32_bf16 v65, s59, v36
    v_dot2c_f32_bf16 v66, s58, v37
    v_dot2c_f32_bf16 v67, s59, v37
    v_dot2c_f32_bf16 v68, s58, v38
    v_dot2c_f32_bf16 v69, s59, v38
    v_dot2c_f32_bf16 v70, s58, v39
    v_dot2c_f32_bf16 v71, s59, v39
    s_bitset0_b32 s63, s19
    s_cmp_eq_u32 s63, 0
    s_cbranch_scc1 L_pgd
L_pn7:
    s_branch L_prb
L_pi1:
L_poll_122:
    buffer_load_dwordx4 v[8:11], v5, s[40:43], s4 offen sc1
    s_sub_u32 s60, s60, 1
    s_cbranch_scc1 L_poll_122t
    s_waitcnt vmcnt(0)
    v_max3_u32 v3, v8, v9, v10
    v_max_u32 v3, v3, v11
    v_cmp_eq_u32 vcc, -1, v3
    s_cbranch_vccnz L_poll_122
L_poll_122e:
    v_dot2c_f32_bf16 v64, s58, v8
    v_dot2c_f32_bf16 v65, s59, v8
    v_dot2c_f32_bf16 v66, s58, v9
    v_dot2c_f32_bf16 v67, s59, v9
    v_dot2c_f32_bf16 v68, s58, v10
    v_dot2c_f32_bf16 v69, s59, v10
    v_dot2c_f32_bf16 v70, s58, v11
    v_dot2c_f32_bf16 v71, s59, v11
L_pgd:
    v_pk_fma_f32 v[64:65], v[64:65], v[48:49], v[40:41]
    v_pk_fma_f32 v[66:67], v[66:67], v[50:51], v[42:43]
    v_pk_fma_f32 v[68:69], v[68:69], v[52:53], v[44:45]
    v_pk_fma_f32 v[70:71], v[70:71], v[54:55], v[46:47]
    v_pk_mul_f32 v[56:57], v[64:65], v[56:57]
    v_pk_mul_f32 v[58:59], v[66:67], v[58:59]
    v_pk_mul_f32 v[60:61], v[68:69], v[60:61]
    v_pk_mul_f32 v[62:63], v[70:71], v[62:63]
    v_cvt_pk_bf16_f32 v8, v56, v57
    v_cvt_pk_bf16_f32 v9, v58, v59
    v_cvt_pk_bf16_f32 v10, v60, v61
    v_cvt_pk_bf16_f32 v11, v62, v63
    ds_write_b128 v4, v[8:11]
    v_pk_add_f32 v[40:41], v[64:65], v[66:67]
    v_pk_add_f32 v[42:43], v[68:69], v[70:71]
    v_pk_mul_f32 v[44:45], v[64:65], v[64:65]
    v_pk_mul_f32 v[46:47], v[66:67], v[66:67]
    v_pk_add_f32 v[40:41], v[40:41], v[42:43]
    v_pk_fma_f32 v[44:45], v[68:69], v[68:69], v[44:45]
    v_pk_fma_f32 v[46:47], v[70:71], v[70:71], v[46:47]
    v_add_f32 v40, v40, v41
    v_pk_add_f32 v[44:45], v[44:45], v[46:47]
    v_add_f32 v41, v44, v45
    ds_write_b64 v7, v[40:41]
    s_waitcnt lgkmcnt(0)
    s_barrier
    v_mov_b32 v16, 0
    v_mov_b32 v17, 0
    v_mov_b32 v18, 0
    v_mov_b32 v19, 0
    v_mov_b32 v20, 0
    v_mov_b32 v21, 0
    v_mov_b32 v22, 0
    v_mov_b32 v23, 0
    v_mov_b32 v24, 0
    v_mov_b32 v25, 0
    v_mov_b32 v26, 0
    v_mov_b32 v27, 0
    v_mov_b32 v28, 0
    v_mov_b32 v29, 0
    v_mov_b32 v30, 0
    v_mov_b32 v31, 0
    v_mov_b32 v32, 0
    v_mov_b32 v33, 0
    v_mov_b32 v34, 0
    v_mov_b32 v35, 0
    ds_write_b128 v6, v[64:67]
    ds_write_b128 v6, v[68:71] offset:16
    s_waitcnt lgkmcnt(0)
    s_cmp_lg_u32 s3, 7
    s_cbranch_scc1 L_ffn2
    s_cmp_lt_u32 s35, 20
    s_cbranch_scc1 L_fin
    s_endpgm
L_ffn1:
    s_barrier
L_ffn1b:
    ds_read_b128 v[8:11], v79
    ds_read_b64 v[30:31], v81 offset:0
    ds_read_b64 v[32:33], v81 offset:512
    ds_read_b64 v[34:35], v81 offset:1024
    ds_read_b64 v[36:37], v81 offset:1536
    ds_read_b64 v[38:39], v81 offset:2048
    ds_read_b128 v[12:15], v79 offset:256
    ds_read_b128 v[16:19], v79 offset:512
    ds_read_b128 v[20:23], v79 offset:768
    ds_read_b128 v[24:27], v79 offset:1024
    s_waitcnt lgkmcnt(9)
    v_smfmac_f32_16x16x64_bf16 v[52:55], v[8:11], v[88:95], v87
    v_smfmac_f32_16x16x64_bf16 v[56:59], v[8:11], v[96:103], v87
    s_waitcnt lgkmcnt(3)
    v_smfmac_f32_16x16x64_bf16 v[52:55], v[12:15], v[104:111], v87
    v_pk_add_f32 v[30:31], v[30:31], v[32:33]
    v_pk_add_f32 v[34:35], v[34:35], v[36:37]
    v_smfmac_f32_16x16x64_bf16 v[56:59], v[12:15], v[112:119], v87
    v_pk_add_f32 v[30:31], v[30:31], v[38:39]
    v_pk_add_f32 v[30:31], v[30:31], v[34:35]
    s_nop 0
    s_waitcnt lgkmcnt(2)
    v_smfmac_f32_16x16x64_bf16 v[52:55], v[16:19], v[120:127], v87
    v_add_f32_dpp v30, v30, v30 quad_perm:[1,0,3,2] row_mask:0xf bank_mask:0xf
    v_add_f32_dpp v31, v31, v31 quad_perm:[1,0,3,2] row_mask:0xf bank_mask:0xf
    v_smfmac_f32_16x16x64_bf16 v[56:59], v[16:19], v[128:135], v87
    v_add_f32_dpp v30, v30, v30 quad_perm:[2,3,0,1] row_mask:0xf bank_mask:0xf
    v_add_f32_dpp v31, v31, v31 quad_perm:[2,3,0,1] row_mask:0xf bank_mask:0xf
    s_waitcnt lgkmcnt(1)
    v_smfmac_f32_16x16x64_bf16 v[52:55], v[20:23], v[136:143], v87
    v_add_f32_dpp v30, v30, v30 row_ror:4 row_mask:0xf bank_mask:0xf
    v_add_f32_dpp v31, v31, v31 row_ror:4 row_mask:0xf bank_mask:0xf
    v_smfmac_f32_16x16x64_bf16 v[56:59], v[20:23], v[144:151], v87
    v_add_f32_dpp v30, v30, v30 row_ror:8 row_mask:0xf bank_mask:0xf
    v_add_f32_dpp v31, v31, v31 row_ror:8 row_mask:0xf bank_mask:0xf
    s_waitcnt lgkmcnt(0)
    v_smfmac_f32_16x16x64_bf16 v[52:55], v[24:27], v[152:159], v87
    v_mul_f32 v48, s62, v30
    v_mul_f32 v49, s62, v31
    v_smfmac_f32_16x16x64_bf16 v[56:59], v[24:27], v[160:167], v87
    v_mul_f32 v7, v84, v48
    v_fma_f32 v49, -v48, v48, -v49
    v_max_f32 v49, 0, v49
    v_add_f32 v49, 0x3727c5ac, v49
    v_rsq_f32 v49, v49
    v_add_f32 v4, v52, v53
    v_add_f32 v4, v4, v7
    s_nop 0
    v_add_f32 v5, v58, v59
    v_add_f32 v4, v4, v5
    v_fma_f32 v4, v4, v49, v85
    v_mul_f32 v5, v4, v4
    v_fma_f32 v5, v5, s63, v86
    v_mul_f32 v5, v5, v4
    v_exp_f32 v5, v5
    s_nop 0
    v_add_f32 v5, 1.0, v5
    v_rcp_f32 v5, v5
    s_nop 0
    v_mul_f32 v4, v4, v5
    v_cvt_pk_bf16_f32 v4, v4, v4
    ds_write_b16 v80, v4
    s_waitcnt lgkmcnt(0)
    s_barrier
    s_endpgm
L_h_t1:
    s_cmp_lg_u32 s3, 3
    s_cbranch_scc1 L_h_noclr
    s_sub_u32 s62, s56, 154
    s_cmp_lt_u32 s62, 32
    s_cbranch_scc0 L_h_noclr
    s_lshl_b32 s63, s62, 2
    s_mul_i32 s62, s62, 9216
    s_add_u32 s62, s62, 20480
    v_mov_b32 v4, -1
    v_mov_b32 v5, -1
    v_mov_b32 v6, -1
    v_mov_b32 v7, -1
    v_lshlrev_b32 v8, 4, v0
    buffer_store_dwordx4 v[4:7], v8, s[40:43], s62 offen offset:0 sc1
    buffer_store_dwordx4 v[4:7], v8, s[40:43], s62 offen offset:1024 sc1
    buffer_store_dwordx4 v[4:7], v8, s[40:43], s62 offen offset:2048 sc1
    buffer_store_dwordx4 v[4:7], v8, s[40:43], s62 offen offset:3072 sc1
    s_add_u32 s62, s62, 4096
    buffer_store_dwordx4 v[4:7], v8, s[40:43], s62 offen offset:0 sc1
    buffer_store_dwordx4 v[4:7], v8, s[40:43], s62 offen offset:1024 sc1
    buffer_store_dwordx4 v[4:7], v8, s[40:43], s62 offen offset:2048 sc1
    buffer_store_dwordx4 v[4:7], v8, s[40:43], s62 offen offset:3072 sc1
    s_add_u32 s62, s62, 4096
    buffer_store_dwordx4 v[4:7], v8, s[40:43], s62 offen offset:0 sc1
    v_mov_b32 v8, s63
    s_waitcnt vmcnt(0)
    s_mov_b64 exec, 1
    buffer_store_dword v4, v8, s[44:47], 0 offen sc1
    s_mov_b64 exec, -1
L_h_noclr:
    v_lshrrev_b32 v1, 3, v0
    v_mul_u32_u24 v1, 1280, v1
    v_and_b32 v2, 7, v0
    v_lshl_add_u32 v1, v2, 4, v1
    s_lshl2_add_u32 s63, s34, s3
    s_mul_i32 s63, s63, 163840
    s_lshl_b32 s62, s35, 7
    s_add_u32 s63, s63, s62
    s_sub_u32 s63, s63, 2816
    s_lshl_b32 s62, s3, 14
    s_add_u32 s62, s62, 81920
    s_mov_b32 m0, s62
    s_mov_b32 s48, s12
    s_mov_b32 s49, s13
    s_mov_b32 s50, 5242880
    s_mov_b32 s51, 0x20000
    s_add_u32 s100, s39, 1
    s_mov_b32 s62, 8
L_dma_4:
    buffer_load_dwordx4 v1, s[48:51], s63 offen nt lds
    s_add_u32 m0, m0, 1024
    s_add_u32 s63, s63, 10240
    s_cmp_eq_u32 s100, 0
    s_cbranch_scc1 L_dma_4n0
    s_waitcnt vmcnt(7)
    s_cmp_eq_u32 s100, 2
    s_cbranch_scc1 L_dma_4n0
    s_waitcnt vmcnt(3)
L_dma_4n0:
    buffer_load_dwordx4 v1, s[48:51], s63 offen nt lds
    s_add_u32 m0, m0, 1024
    s_add_u32 s63, s63, 10240
    s_cmp_eq_u32 s100, 0
    s_cbranch_scc1 L_dma_4n1
    s_waitcnt vmcnt(7)
    s_cmp_eq_u32 s100, 2
    s_cbranch_scc1 L_dma_4n1
    s_waitcnt vmcnt(3)
L_dma_4n1:
    s_sub_u32 s62, s62, 1
    s_cmp_lg_u32 s62, 0
    s_cbranch_scc1 L_dma_4
    s_cmp_eq_u32 s39, 1
    s_cbranch_scc1 L_h_role
    s_waitcnt vmcnt(0)
    v_mov_b32 v4, 162060
    v_mov_b32 v5, 1
    s_mov_b64 exec, 1
    ds_add_u32 v4, v5
    s_mov_b64 exec, -1
    s_cmp_eq_u32 s3, 0
    s_cbranch_scc1 L_service
    s_endpgm
L_h_role:
    v_mov_b32 v72, 0
    v_mov_b32 v73, 0
    v_mov_b32 v74, 0
    v_mov_b32 v75, 0
    v_mov_b32 v76, 0
    v_lshrrev_b32 v3, 4, v0
    v_and_b32 v2, 3, v0
    v_bfe_u32 v1, v0, 2, 2
    v_mul_u32_u24 v160, 1280, v3
    v_and_b32 v4, 15, v0
    v_lshl_add_u32 v163, v4, 2, v160
    v_lshl_add_u32 v160, v4, 3, v160
    s_mul_i32 s57, s35, 5120
    s_mul_i32 s62, s3, 320
    s_add_u32 s57, s57, s62
    s_add_u32 s57, s57, 327680
    v_mov_b32 v4, -1
    v_mov_b32 v5, -1
    v_mov_b32 v6, -1
    v_mov_b32 v7, -1
    v_lshlrev_b32 v8, 4, v0
    s_mul_i32 s62, s3, 960
    s_add_u32 s62, s62, s57
    buffer_store_dwordx4 v[4:7], v8, s[40:43], s62 offen sc1
    s_mov_b64 exec, 0xffff
    buffer_store_dwordx4 v[4:7], v8, s[40:43], s62 offen offset:1024 sc1
    s_mov_b64 exec, -1
    v_add_u32 v8, 0, v0
    v_mul_u32_u24 v10, 0xccd, v8
    v_lshrrev_b32 v10, 16, v10
    v_mul_u32_u24 v9, 20, v10
    v_sub_u32 v8, v8, v9
    v_mul_u32_u24 v10, 1280, v10
    v_lshl_add_u32 v10, v8, 4, v10
    v_add_u32 v8, 64, v0
    v_mul_u32_u24 v11, 0xccd, v8
    v_lshrrev_b32 v11, 16, v11
    v_mul_u32_u24 v9, 20, v11
    v_sub_u32 v8, v8, v9
    v_mul_u32_u24 v11, 1280, v11
    v_lshl_add_u32 v11, v8, 4, v11
    v_add_u32 v8, 128, v0
    v_mul_u32_u24 v12, 0xccd, v8
    v_lshrrev_b32 v12, 16, v12
    v_mul_u32_u24 v9, 20, v12
    v_sub_u32 v8, v8, v9
    v_mul_u32_u24 v12, 1280, v12
    v_lshl_add_u32 v12, v8, 4, v12
    v_add_u32 v8, 192, v0
    v_mul_u32_u24 v13, 0xccd, v8
    v_lshrrev_b32 v13, 16, v13
    v_mul_u32_u24 v9, 20, v13
    v_sub_u32 v8, v8, v9
    v_mul_u32_u24 v13, 1280, v13
    v_lshl_add_u32 v13, v8, 4, v13
    v_add_u32 v8, 256, v0
    v_mul_u32_u24 v14, 0xccd, v8
    v_lshrrev_b32 v14, 16, v14
    v_mul_u32_u24 v9, 20, v14
    v_sub_u32 v8, v8, v9
    v_mul_u32_u24 v14, 1280, v14
    v_lshl_add_u32 v14, v8, 4, v14
    s_waitcnt vmcnt(0)
    v_mov_b32 v8, 162060
    v_mov_b32 v9, 1
    s_mov_b64 exec, 1
    ds_add_u32 v8, v9
    s_mov_b64 exec, -1
    s_mov_b32 s48, s20
    s_mov_b32 s49, s21
    s_mov_b32 s50, 2211840
    s_mov_b32 s51, 0x20000
    s_mul_i32 s63, s35, 81920
    s_mul_i32 s62, s3, 320
    s_add_u32 s63, s63, s62
    s_mov_b32 m0, s101
    s_mov_b32 s62, 4
L_w2dma:
    buffer_load_dwordx4 v10, s[48:51], s63 offen nt lds
    s_add_u32 m0, m0, 1024
    s_waitcnt vmcnt(7)
    s_cmp_ge_u32 s35, 22
    s_cbranch_scc1 L_w2n0
    s_waitcnt vmcnt(7)
L_w2n0:
    buffer_load_dwordx4 v11, s[48:51], s63 offen nt lds
    s_add_u32 m0, m0, 1024
    s_waitcnt vmcnt(7)
    s_cmp_ge_u32 s35, 22
    s_cbranch_scc1 L_w2n1
    s_waitcnt vmcnt(7)
L_w2n1:
    buffer_load_dwordx4 v12, s[48:51], s63 offen nt lds
    s_add_u32 m0, m0, 1024
    s_waitcnt vmcnt(7)
    s_cmp_ge_u32 s35, 22
    s_cbranch_scc1 L_w2n2
    s_waitcnt vmcnt(7)
L_w2n2:
    buffer_load_dwordx4 v13, s[48:51], s63 offen nt lds
    s_add_u32 m0, m0, 1024
    s_waitcnt vmcnt(7)
    s_cmp_ge_u32 s35, 22
    s_cbranch_scc1 L_w2n3
    s_waitcnt vmcnt(7)
L_w2n3:
    buffer_load_dwordx4 v14, s[48:51], s63 offen nt lds
    s_add_u32 m0, m0, 1024
    s_waitcnt vmcnt(7)
    s_cmp_ge_u32 s35, 22
    s_cbranch_scc1 L_w2n4
    s_waitcnt vmcnt(7)
L_w2n4:
    s_add_u32 s63, s63, 20480
    s_sub_u32 s62, s62, 1
    s_cmp_lg_u32 s62, 0
    s_cbranch_scc1 L_w2dma
    v_lshrrev_b32 v8, 5, v0
    v_lshlrev_b32 v8, 2, v8
    v_bfe_u32 v9, v0, 4, 1
    v_add_u32 v8, v8, v9
    v_mul_u32_u24 v8, 1280, v8
    v_add_u32 v8, s101, v8
    v_and_b32 v10, 15, v0
    v_lshl_add_u32 v9, v10, 2, v8
    v_lshl_add_u32 v8, v10, 3, v8
    s_mov_b32 s62, 0x05040100
    s_mov_b32 s63, 0x07060302
    s_waitcnt vmcnt(0)
    ds_read_b64 v[16:17], v8 offset:0
    ds_read_b64 v[18:19], v8 offset:320
    ds_read_b64 v[20:21], v8 offset:2560
    ds_read_b64 v[22:23], v8 offset:2880
    ds_read_b64 v[24:25], v8 offset:640
    ds_read_b64 v[26:27], v8 offset:960
    ds_read_b64 v[28:29], v8 offset:3200
    ds_read_b64 v[30:31], v8 offset:3520
    ds_read_b64 v[32:33], v8 offset:10240
    ds_read_b64 v[34:35], v8 offset:10560
    ds_read_b64 v[36:37], v8 offset:12800
    ds_read_b64 v[38:39], v8 offset:13120
    ds_read_b64 v[40:41], v8 offset:10880
    ds_read_b64 v[42:43], v8 offset:11200
    ds_read_b64 v[44:45], v8 offset:13440
    ds_read_b64 v[46:47], v8 offset:13760
    s_waitcnt lgkmcnt(0)
    v_perm_b32 v80, v18, v16, s62
    v_perm_b32 v88, v18, v16, s63
    v_perm_b32 v96, v19, v17, s62
    v_perm_b32 v104, v19, v17, s63
    v_perm_b32 v81, v22, v20, s62
    v_perm_b32 v89, v22, v20, s63
    v_perm_b32 v97, v23, v21, s62
    v_perm_b32 v105, v23, v21, s63
    v_perm_b32 v82, v26, v24, s62
    v_perm_b32 v90, v26, v24, s63
    v_perm_b32 v98, v27, v25, s62
    v_perm_b32 v106, v27, v25, s63
    v_perm_b32 v83, v30, v28, s62
    v_perm_b32 v91, v30, v28, s63
    v_perm_b32 v99, v31, v29, s62
    v_perm_b32 v107, v31, v29, s63
    v_perm_b32 v84, v34, v32, s62
    v_perm_b32 v92, v34, v32, s63
    v_perm_b32 v100, v35, v33, s62
    v_perm_b32 v108, v35, v33, s63
    v_perm_b32 v85, v38, v36, s62
    v_perm_b32 v93, v38, v36, s63
    v_perm_b32 v101, v39, v37, s62
    v_perm_b32 v109, v39, v37, s63
    v_perm_b32 v86, v42, v40, s62
    v_perm_b32 v94, v42, v40, s63
    v_perm_b32 v102, v43, v41, s62
    v_perm_b32 v110, v43, v41, s63
    v_perm_b32 v87, v46, v44, s62
    v_perm_b32 v95, v46, v44, s63
    v_perm_b32 v103, v47, v45, s62
    v_perm_b32 v111, v47, v45, s63
    ds_read_b64 v[16:17], v8 offset:128
    ds_read_b64 v[18:19], v8 offset:448
    ds_read_b64 v[20:21], v8 offset:2688
    ds_read_b64 v[22:23], v8 offset:3008
    ds_read_b64 v[24:25], v8 offset:768
    ds_read_b64 v[26:27], v8 offset:1088
    ds_read_b64 v[28:29], v8 offset:3328
    ds_read_b64 v[30:31], v8 offset:3648
    ds_read_b64 v[32:33], v8 offset:10368
    ds_read_b64 v[34:35], v8 offset:10688
    ds_read_b64 v[36:37], v8 offset:12928
    ds_read_b64 v[38:39], v8 offset:13248
    ds_read_b64 v[40:41], v8 offset:11008
    ds_read_b64 v[42:43], v8 offset:11328
    ds_read_b64 v[44:45], v8 offset:13568
    ds_read_b64 v[46:47], v8 offset:13888
    s_waitcnt lgkmcnt(0)
    v_perm_b32 v112, v18, v16, s62
    v_perm_b32 v120, v18, v16, s63
    v_perm_b32 v128, v19, v17, s62
    v_perm_b32 v136, v19, v17, s63
    v_perm_b32 v113, v22, v20, s62
    v_perm_b32 v121, v22, v20, s63
    v_perm_b32 v129, v23, v21, s62
    v_perm_b32 v137, v23, v21, s63
    v_perm_b32 v114, v26, v24, s62
    v_perm_b32 v122, v26, v24, s63
    v_perm_b32 v130, v27, v25, s62
    v_perm_b32 v138, v27, v25, s63
    v_perm_b32 v115, v30, v28, s62
    v_perm_b32 v123, v30, v28, s63
    v_perm_b32 v131, v31, v29, s62
    v_perm_b32 v139, v31, v29, s63
    v_perm_b32 v116, v34, v32, s62
    v_perm_b32 v124, v34, v32, s63
    v_perm_b32 v132, v35, v33, s62
    v_perm_b32 v140, v35, v33, s63
    v_perm_b32 v117, v38, v36, s62
    v_perm_b32 v125, v38, v36, s63
    v_perm_b32 v133, v39, v37, s62
    v_perm_b32 v141, v39, v37, s63
    v_perm_b32 v118, v42, v40, s62
    v_perm_b32 v126, v42, v40, s63
    v_perm_b32 v134, v43, v41, s62
    v_perm_b32 v142, v43, v41, s63
    v_perm_b32 v119, v46, v44, s62
    v_perm_b32 v127, v46, v44, s63
    v_perm_b32 v135, v47, v45, s62
    v_perm_b32 v143, v47, v45, s63
    ds_read_b32 v16, v9 offset:256
    ds_read_b32 v18, v9 offset:576
    ds_read_b32 v20, v9 offset:2816
    ds_read_b32 v22, v9 offset:3136
    ds_read_b32 v24, v9 offset:896
    ds_read_b32 v26, v9 offset:1216
    ds_read_b32 v28, v9 offset:3456
    ds_read_b32 v30, v9 offset:3776
    ds_read_b32 v32, v9 offset:10496
    ds_read_b32 v34, v9 offset:10816
    ds_read_b32 v36, v9 offset:13056
    ds_read_b32 v38, v9 offset:13376
    ds_read_b32 v40, v9 offset:11136
    ds_read_b32 v42, v9 offset:11456
    ds_read_b32 v44, v9 offset:13696
    ds_read_b32 v46, v9 offset:14016
    s_waitcnt lgkmcnt(0)
    v_perm_b32 v144, v18, v16, s62
    v_perm_b32 v152, v18, v16, s63
    v_perm_b32 v145, v22, v20, s62
    v_perm_b32 v153, v22, v20, s63
    v_perm_b32 v146, v26, v24, s62
    v_perm_b32 v154, v26, v24, s63
    v_perm_b32 v147, v30, v28, s62
    v_perm_b32 v155, v30, v28, s63
    v_perm_b32 v148, v34, v32, s62
    v_perm_b32 v156, v34, v32, s63
    v_perm_b32 v149, v38, v36, s62
    v_perm_b32 v157, v38, v36, s63
    v_perm_b32 v150, v42, v40, s62
    v_perm_b32 v158, v42, v40, s63
    v_perm_b32 v151, v46, v44, s62
    v_perm_b32 v159, v46, v44, s63
    s_mov_b32 s48, s16
    s_mov_b32 s49, s17
    s_mov_b32 s50, 2211840
    s_mov_b32 s51, 0x20000
    s_lshl_b32 s98, s35, 7
    s_mov_b32 s99, 3456
    v_lshrrev_b32 v9, 3, v0
    v_mul_lo_u32 v10, v9, s99
    v_and_b32 v9, 2, v9
    v_xor_b32 v9, v9, v0
    v_and_b32 v9, 7, v9
    v_lshl_add_u32 v10, v9, 4, v10
    v_add_u32 v10, s98, v10
    v_xor_b32 v11, 64, v10
    s_mul_i32 s63, s3, 552960
    s_mov_b32 m0, s101
    s_waitcnt lgkmcnt(0)
    s_cmp_ge_u32 s35, 22
    s_cselect_b32 s100, 2, 1
    s_mov_b32 s62, 10
L_dma_5:
    buffer_load_dwordx4 v10, s[48:51], s63 offen nt lds
    s_add_u32 m0, m0, 1024
    s_add_u32 s63, s63, 27648
    s_cmp_eq_u32 s100, 0
    s_cbranch_scc1 L_dma_5n0
    s_waitcnt vmcnt(7)
    s_cmp_eq_u32 s100, 2
    s_cbranch_scc1 L_dma_5n0
    s_waitcnt vmcnt(7)
L_dma_5n0:
    buffer_load_dwordx4 v11, s[48:51], s63 offen nt lds
    s_add_u32 m0, m0, 1024
    s_add_u32 s63, s63, 27648
    s_cmp_eq_u32 s100, 0
    s_cbranch_scc1 L_dma_5n1
    s_waitcnt vmcnt(7)
    s_cmp_eq_u32 s100, 2
    s_cbranch_scc1 L_dma_5n1
    s_waitcnt vmcnt(7)
L_dma_5n1:
    s_sub_u32 s62, s62, 1
    s_cmp_lg_u32 s62, 0
    s_cbranch_scc1 L_dma_5
    v_mov_b32 v8, 162068
L_lw_6:
    ds_read_b32 v9, v8
    s_waitcnt lgkmcnt(0)
    v_cmp_gt_u32 vcc, 1, v9
    s_cbranch_vccz L_lw_6e
    s_sleep 8
    s_sub_u32 s60, s60, 1
    s_cbranch_scc0 L_lw_6
    s_mov_b32 s60, 0
L_lw_6e:
    s_cmp_lg_u32 s3, 3
    s_cbranch_scc1 L_h_nomo
    v_and_b32 v4, 15, v0
    v_lshlrev_b32 v4, 4, v4
    v_mul_u32_u24 v5, 1280, v3
    v_add_u32 v5, v5, v4
    v_mul_u32_u24 v6, 1296, v3
    v_add_u32 v6, v6, v4
    v_add_u32 v6, 147456, v6
    s_mov_b32 s62, 30720
    s_mov_b32 s63, 25600
    s_branch L_poll_7
L_poll_7s:
    s_sleep 8
L_poll_7:
    buffer_load_dwordx4 v[40:43], v5, s[40:43], s62 offen offset:0 sc1
    buffer_load_dwordx4 v[44:47], v5, s[40:43], s62 offen offset:256 sc1
    buffer_load_dwordx4 v[48:51], v5, s[40:43], s62 offen offset:512 sc1
    buffer_load_dwordx4 v[52:55], v5, s[40:43], s62 offen offset:768 sc1
    buffer_load_dwordx4 v[56:59], v5, s[40:43], s62 offen offset:1024 sc1
    buffer_load_dwordx4 v[60:63], v5, s[40:43], s63 offen offset:0 sc1
    buffer_load_dwordx4 v[64:67], v5, s[40:43], s63 offen offset:256 sc1
    buffer_load_dwordx4 v[68:71], v5, s[40:43], s63 offen offset:512 sc1
    buffer_load_dwordx4 v[72:75], v5, s[40:43], s63 offen offset:768 sc1
    buffer_load_dwordx4 v[76:79], v5, s[40:43], s63 offen offset:1024 sc1
    s_sub_u32 s60, s60, 1
    s_cbranch_scc1 L_poll_7t
    s_waitcnt vmcnt(0)
    v_max3_u32 v7, v40, v41, v42
    v_max3_u32 v7, v7, v43, v44
    v_max3_u32 v7, v7, v45, v46
    v_max3_u32 v7, v7, v47, v48
    v_max3_u32 v7, v7, v49, v50
    v_max3_u32 v7, v7, v51, v52
    v_max3_u32 v7, v7, v53, v54
    v_max3_u32 v7, v7, v55, v56
    v_max3_u32 v7, v7, v57, v58
    v_max3_u32 v7, v7, v59, v60
    v_max3_u32 v7, v7, v61, v62
    v_max3_u32 v7, v7, v63, v64
    v_max3_u32 v7, v7, v65, v66
    v_max3_u32 v7, v7, v67, v68
    v_max3_u32 v7, v7, v69, v70
    v_max3_u32 v7, v7, v71, v72
    v_max3_u32 v7, v7, v73, v74
    v_max3_u32 v7, v7, v75, v76
    v_max3_u32 v7, v7, v77, v78
    v_max_u32 v7, v7, v79
    v_cmp_eq_u32 vcc, -1, v7
    s_cbranch_vccnz L_poll_7s
L_poll_7e:
    ds_write_b128 v6, v[40:43] offset:0
    ds_write_b128 v6, v[44:47] offset:256
    ds_write_b128 v6, v[48:51] offset:512
    ds_write_b128 v6, v[52:55] offset:768
    ds_write_b128 v6, v[56:59] offset:1024
    ds_write_b128 v6, v[60:63] offset:5184
    ds_write_b128 v6, v[64:67] offset:5440
    ds_write_b128 v6, v[68:71] offset:5696
    ds_write_b128 v6, v[72:75] offset:5952
    ds_write_b128 v6, v[76:79] offset:6208
L_h_nomo:
    v_mul_u32_u24 v4, 144, v1
    v_lshl_add_u32 v4, v3, 5, v4
    v_bfe_u32 v5, v0, 1, 1
    v_lshl_add_u32 v4, v5, 4, v4
    v_add_u32 v4, 90688, v4
    v_mov_b32 v5, 162112
    v_and_b32 v6, 1, v0
    v_cmp_eq_u32 vcc, 0, v6
    s_nop 1
    v_cndmask_b32 v161, v5, v4, vcc
    v_cndmask_b32 v162, v4, v5, vcc
    v_bfe_u32 v164, v0, 1, 1
    v_mul_u32_u24 v164, 0xaaaa, v164
    v_add_u32 v164, 0x4444, v164
    s_mov_b32 s100, s3
    s_lshl_b32 s63, s100, 8
    v_and_b32 v8, 15, v0
    v_lshl_add_u32 v8, v8, 4, s63
    v_lshrrev_b32 v9, 4, v0
    v_mul_u32_u24 v5, 1280, v9
    v_add_u32 v5, v5, v8
    v_mul_u32_u24 v4, 1296, v9
    v_add_u32 v4, v4, v8
    v_add_u32 v4, 82944, v4
    v_lshlrev_b32 v6, 1, v5
    v_add_u32 v6, 99328, v6
    s_lshl_b32 s62, s100, 9
    s_add_u32 s62, s62, 88128
    v_lshl_add_u32 v7, v0, 3, s62
    s_mov_b32 s48, s4
    s_mov_b32 s49, s5
    s_mov_b32 s50, 5120
    s_mov_b32 s51, 0x20000
    buffer_load_dwordx4 v[8:11], v5, s[48:51], 0 offen
    s_mov_b32 s62, 20480
    s_mov_b32 s63, 30720
    s_branch L_poll_8
L_poll_8s:
    s_sleep 8
L_poll_8:
    buffer_load_dwordx4 v[12:15], v5, s[40:43], s62 offen sc1
    buffer_load_dwordx4 v[16:19], v5, s[40:43], s63 offen sc1
    s_sub_u32 s60, s60, 1
    s_cbranch_scc1 L_poll_8t
    s_waitcnt vmcnt(0)
    v_max3_u32 v38, v12, v13, v14
    v_max3_u32 v38, v38, v15, v16
    v_max3_u32 v38, v38, v17, v18
    v_max_u32 v38, v38, v19
    v_cmp_eq_u32 vcc, -1, v38
    s_cbranch_vccnz L_poll_8s
L_poll_8e:
    v_lshlrev_b32 v40, 16, v8
    v_and_b32 v41, 0xffff0000, v8
    v_lshlrev_b32 v42, 16, v9
    v_and_b32 v43, 0xffff0000, v9
    v_lshlrev_b32 v44, 16, v10
    v_and_b32 v45, 0xffff0000, v10
    v_lshlrev_b32 v46, 16, v11
    v_and_b32 v47, 0xffff0000, v11
    v_lshlrev_b32 v48, 16, v12
    v_and_b32 v49, 0xffff0000, v12
    v_lshlrev_b32 v50, 16, v13
    v_and_b32 v51, 0xffff0000, v13
    v_lshlrev_b32 v52, 16, v14
    v_and_b32 v53, 0xffff0000, v14
    v_lshlrev_b32 v54, 16, v15
    v_and_b32 v55, 0xffff0000, v15
    v_lshlrev_b32 v56, 16, v16
    v_and_b32 v57, 0xffff0000, v16
    v_lshlrev_b32 v58, 16, v17
    v_and_b32 v59, 0xffff0000, v17
    v_lshlrev_b32 v60, 16, v18
    v_and_b32 v61, 0xffff0000, v18
    v_lshlrev_b32 v62, 16, v19
    v_and_b32 v63, 0xffff0000, v19
    v_mov_b32 v64, 0
    v_mov_b32 v65, 0
    v_mov_b32 v66, 0
    v_mov_b32 v67, 0
    v_mov_b32 v68, 0
    v_mov_b32 v69, 0
    v_mov_b32 v70, 0
    v_mov_b32 v71, 0
    v_bfe_u32 v5, v0, 2, 2
    v_lshlrev_b32 v5, 8, v5
    v_lshrrev_b32 v8, 4, v0
    v_lshl_add_u32 v5, v8, 6, v5
    v_and_b32 v8, 3, v0
    v_lshl_add_u32 v5, v8, 4, v5
    s_lshl_b32 s56, s100, 10
    s_waitcnt vmcnt(0) lgkmcnt(0)
    v_mov_b32 v8, 162064
    v_mov_b32 v9, 1
    s_mov_b64 exec, 1
    ds_add_u32 v8, v9
    s_mov_b64 exec, -1
    s_branch L_t2gate
L_ffn2:
    s_barrier
L_ffn2b:
    ds_read_b128 v[8:11], v161
    ds_read_b128 v[12:15], v162
    s_cmp_eq_u32 s61, 1
    s_cbranch_scc0 L_f2slow
    s_waitcnt lgkmcnt(1)
    v_smfmac_f32_16x16x64_bf16 v[16:19], v[8:11], v[80:87], v164
    v_smfmac_f32_16x16x64_bf16 v[20:23], v[8:11], v[96:103], v164
    s_waitcnt lgkmcnt(0)
    v_smfmac_f32_16x16x64_bf16 v[16:19], v[12:15], v[88:95], v164
    v_smfmac_f32_16x16x64_bf16 v[20:23], v[12:15], v[104:111], v164
    v_smfmac_f32_16x16x64_bf16 v[24:27], v[8:11], v[112:119], v164
    v_smfmac_f32_16x16x64_bf16 v[28:31], v[8:11], v[128:135], v164
    v_smfmac_f32_16x16x64_bf16 v[24:27], v[12:15], v[120:127], v164
    v_smfmac_f32_16x16x64_bf16 v[28:31], v[12:15], v[136:143], v164
    v_smfmac_f32_16x16x64_bf16 v[32:35], v[8:11], v[144:151], v164
    v_smfmac_f32_16x16x64_bf16 v[32:35], v[12:15], v[152:159], v164
    s_nop 0
    v_pk_add_f32 v[16:17], v[16:17], v[18:19]
    v_cvt_pk_bf16_f32 v40, v16, v17
    v_pk_add_f32 v[20:21], v[20:21], v[22:23]
    v_cvt_pk_bf16_f32 v41, v20, v21
    buffer_store_dwordx2 v[40:41], v160, s[40:43], s57 offen
    v_pk_add_f32 v[24:25], v[24:25], v[26:27]
    v_cvt_pk_bf16_f32 v42, v24, v25
    v_pk_add_f32 v[28:29], v[28:29], v[30:31]
    v_cvt_pk_bf16_f32 v43, v28, v29
    buffer_store_dwordx2 v[42:43], v160, s[40:43], s57 offen offset:128
    v_pk_add_f32 v[32:33], v[32:33], v[34:35]
    v_cvt_pk_bf16_f32 v44, v32, v33
    buffer_store_dword v44, v163, s[40:43], s57 offen offset:256
L_f2done:
    s_barrier
    s_endpgm
L_f2slow:
    s_waitcnt lgkmcnt(1)
    v_smfmac_f32_16x16x64_bf16 v[16:19], v[8:11], v[80:87], v164
    v_smfmac_f32_16x16x64_bf16 v[20:23], v[8:11], v[96:103], v164
    s_waitcnt lgkmcnt(0)
    v_smfmac_f32_16x16x64_bf16 v[16:19], v[12:15], v[88:95], v164
    v_smfmac_f32_16x16x64_bf16 v[20:23], v[12:15], v[104:111], v164
    v_smfmac_f32_16x16x64_bf16 v[24:27], v[8:11], v[112:119], v164
    v_smfmac_f32_16x16x64_bf16 v[28:31], v[8:11], v[128:135], v164
    v_smfmac_f32_16x16x64_bf16 v[24:27], v[12:15], v[120:127], v164
    v_smfmac_f32_16x16x64_bf16 v[28:31], v[12:15], v[136:143], v164
    v_smfmac_f32_16x16x64_bf16 v[32:35], v[8:11], v[144:151], v164
    v_smfmac_f32_16x16x64_bf16 v[32:35], v[12:15], v[152:159], v164
    s_nop 0
    v_pk_add_f32 v[16:17], v[16:17], v[18:19]
    v_cvt_pk_bf16_f32 v40, v16, v17
    v_pk_add_f32 v[20:21], v[20:21], v[22:23]
    v_cvt_pk_bf16_f32 v41, v20, v21
    buffer_store_dwordx2 v[40:41], v160, s[40:43], s57 offen sc1
    v_pk_add_f32 v[24:25], v[24:25], v[26:27]
    v_cvt_pk_bf16_f32 v42, v24, v25
    v_pk_add_f32 v[28:29], v[28:29], v[30:31]
    v_cvt_pk_bf16_f32 v43, v28, v29
    buffer_store_dwordx2 v[42:43], v160, s[40:43], s57 offen offset:128 sc1
    v_pk_add_f32 v[32:33], v[32:33], v[34:35]
    v_cvt_pk_bf16_f32 v44, v32, v33
    buffer_store_dword v44, v163, s[40:43], s57 offen offset:256 sc1
    s_branch L_f2done
L_poll_3t:
    s_mov_b32 s60, 0
    s_waitcnt vmcnt(0)
    s_branch L_poll_3e
L_poll_7t:
    s_mov_b32 s60, 0
    s_waitcnt vmcnt(0)
    s_branch L_poll_7e
L_poll_8t:
    s_mov_b32 s60, 0
    s_waitcnt vmcnt(0)
    s_branch L_poll_8e
L_poll_98t:
    s_mov_b32 s60, 0
    s_waitcnt vmcnt(0)
    s_branch L_poll_98e
L_pfast:
    buffer_store_dword v12, v108, s[40:43], s101 offen
    buffer_store_dword v12, v110, s[40:43], s101 offen
    s_branch L_pdone
L_poll_100t:
    s_mov_b32 s60, 0
    s_waitcnt vmcnt(0)
    s_branch L_poll_100e
L_poll_103t:
    s_mov_b32 s60, 0
    s_waitcnt vmcnt(0)
    s_branch L_poll_103e
L_poll_105t:
    s_mov_b32 s60, 0
    s_waitcnt vmcnt(0)
    s_branch L_poll_105e
L_poll_109t:
    s_mov_b32 s60, 0
    s_waitcnt vmcnt(0)
    s_branch L_poll_109e
L_poll_111t:
    s_mov_b32 s60, 0
    s_waitcnt vmcnt(0)
    s_branch L_poll_111e
L_poll_116t:
    s_mov_b32 s60, 0
    s_waitcnt vmcnt(0)
    s_branch L_poll_116e
L_poll_118t:
    s_mov_b32 s60, 0
    s_waitcnt vmcnt(0)
    s_branch L_poll_118e
L_ygt:
    s_waitcnt vmcnt(0)
    s_branch L_ygd
L_pto:
    s_mov_b32 s60, 0
    s_waitcnt vmcnt(0)
    s_branch L_pgot0
L_poll_122t:
    s_mov_b32 s60, 0
    s_waitcnt vmcnt(0)
    s_branch L_poll_122e
L_end:
    s_endpgm
L_codeend:
.section .rodata,"a"
.p2align 6
.amdhsa_kernel adaLN_cond__sliding_block_cached__dense_activation_gelu__decode_kernel
  .amdhsa_next_free_vgpr 168
  .amdhsa_next_free_sgpr 102
  .amdhsa_accum_offset 168
  .amdhsa_group_segment_fixed_size 0
  .amdhsa_kernarg_size 120
  .amdhsa_user_sgpr_count 2
  .amdhsa_user_sgpr_kernarg_segment_ptr 1
  .amdhsa_system_sgpr_workgroup_id_x 1
.end_amdhsa_kernel
```

```asm
; @launch grid=(256,1,1) block=(768,1,1) lds=162176
.amdgcn_target "amdgcn-amd-amdhsa--gfx950"
.text
.globl adaLN_cond__sliding_block_cached__dense_activation_gelu__decode_kernel
.p2align 8
.type adaLN_cond__sliding_block_cached__dense_activation_gelu__decode_kernel,@function
adaLN_cond__sliding_block_cached__dense_activation_gelu__decode_kernel:
    s_load_dwordx16 s[4:19], s[0:1], 0
    s_load_dwordx8 s[20:27], s[0:1], 64
    s_load_dwordx4 s[28:31], s[0:1], 96
    s_load_dwordx2 s[32:33], s[0:1], 112
    s_cmp_ge_u32 s2, 256
    s_cbranch_scc1 L_end
    v_lshrrev_b32 v1, 6, v0
    v_mul_u32_u24 v2, 36, v0
    v_readfirstlane_b32 s3, v1
    v_and_b32 v0, 63, v0
    s_and_b32 s34, s2, 7
    s_lshr_b32 s35, s2, 3
    s_cmp_lg_u32 s35, 21
    s_cbranch_scc1 L_nopf
    s_getpc_b64 s[48:49]
L_pc:
    v_min_u32 v2, L_codeend-L_pc-4, v2
    v_mov_b32 v3, s49
    v_add_co_u32 v2, vcc, s48, v2
    s_nop 1
    v_addc_co_u32 v3, vcc, 0, v3, vcc
    global_load_dword v152, v[2:3], off
L_nopf:
    s_lshr_b32 s36, s35, 3
    s_lshl2_add_u32 s36, s34, s36
    s_bfe_u32 s37, s35, 0x20001
    s_and_b32 s38, s35, 1
    s_cmp_lt_u32 s35, 27
    s_cselect_b32 s39, 1, 0
    s_cmp_eq_u32 s34, 2
    s_cselect_b32 s39, s39, 0
    s_sub_u32 s62, s34, 3
    s_and_b32 s62, s62, 7
    s_mul_i32 s56, s35, 7
    s_add_u32 s56, s56, s62
    s_cmp_eq_u32 s62, 7
    s_cselect_b32 s56, 255, s56
    s_mov_b32 s60, 1000000
    s_mov_b32 s61, 0
    v_mov_b32 v36, 0
    s_cmp_lt_u32 s3, 4
    s_cbranch_scc1 L_helpers
    s_sub_u32 s3, s3, 4
    s_cmp_ge_u32 s35, 22
    s_cselect_b32 s59, 1, 0
    s_add_u32 s62, s3, s59
    s_cmp_ge_u32 s62, 6
    s_cselect_b32 s62, s39, 0
    s_cmp_eq_u32 s62, 1
    s_cbranch_scc1 L_proxy
    s_cmp_eq_u32 s59, 1
    s_cselect_b32 s100, 0, 81920
    s_lshl_b32 s62, s3, 13
    s_add_u32 s100, s100, s62
    s_and_b32 s62, s39, s59
    s_cselect_b32 s100, -1, s100
    s_mov_b32 s101, 0
L_stream:
    s_lshl_b32 s62, s37, 5
    s_add_u32 s62, s62, s36
    s_lshl_b32 s63, s62, 21
    s_lshl_b32 s96, s38, 18
    s_add_u32 s63, s63, s96
    s_add_u32 s63, s63, 1572864
    v_lshlrev_b32 v1, 4, v0
    s_lshl_b32 s96, s3, 12
    v_add_u32 v1, s96, v1
    s_mov_b32 s97, 0
    s_mov_b32 s50, 262144
    s_mov_b32 s51, 0x20000
    s_waitcnt lgkmcnt(0)
    s_add_u32 s48, s6, s63
    s_addc_u32 s49, s7, 0
    s_cmp_lt_u32 s56, 40
    s_cbranch_scc0 L_nob0
    s_barrier
L_nob0:
    buffer_load_dwordx4 v[40:43], v1, s[48:51], s97 offen offset:0 nt
    buffer_load_dwordx4 v[44:47], v1, s[48:51], s97 offen offset:1024 nt
    s_cmp_lt_u32 s56, 40
    s_cbranch_scc1 L_stream2
    s_barrier
    s_branch L_stream2
L_helpers:
    s_cmp_lg_u32 s3, 0
    s_cbranch_scc1 L_noinit
    v_lshlrev_b32 v1, 2, v0
    v_add_u32 v1, 161920, v1
    ds_write_b32 v1, v36
L_noinit:
    s_waitcnt lgkmcnt(0)
    s_mov_b32 s40, s32
    s_mov_b32 s41, s33
    s_mov_b32 s42, 589824
    s_mov_b32 s43, 0x20000
    s_mov_b32 s44, s30
    s_mov_b32 s45, s31
    s_mov_b32 s46, 256
    s_mov_b32 s47, 0x20000
    s_lshl2_add_u32 s62, s35, s3
    s_cmp_eq_u32 s62, 87
    s_cbranch_scc1 L_touch
L_notp:
    s_mul_i32 s101, s3, 20480
    s_mov_b32 s96, s56
    s_cmp_lt_u32 s56, 40
    s_cbranch_scc0 L_nothalf
    s_cmp_lt_u32 s3, 2
    s_cbranch_scc1 L_unit
    s_add_u32 s62, s56, 20
    s_cmp_eq_u32 s3, 2
    s_cbranch_scc1 L_job
    s_barrier
    s_branch L_service
L_nothalf:
    s_cmp_lt_u32 s56, 104
    s_cbranch_scc1 L_unit
    s_sub_u32 s62, s56, 144
    s_cmp_lt_u32 s62, 10
    s_cbranch_scc0 L_nojob
    s_cmp_lt_u32 s3, 2
    s_cbranch_scc0 L_nojob
    s_mul_i32 s63, s3, 10
    s_add_u32 s62, s62, s63
L_job:
    s_cmp_lt_u32 s62, 59
    s_cbranch_scc0 L_end
    s_mov_b32 s100, s101
    s_lshl_b32 s101, s62, 9
    s_add_u32 s101, s101, 172032
    s_cmp_lt_u32 s62, 27
    s_cselect_b32 s63, 0, 27
    s_cselect_b32 s3, 7, 6
    s_cmp_lt_u32 s62, 54
    s_cselect_b32 s63, s63, 32
    s_cselect_b32 s3, s3, 5
    s_sub_u32 s35, s62, s63
    s_mov_b32 s34, 2
    s_lshr_b32 s36, s35, 3
    s_add_u32 s36, s36, 8
    s_bfe_u32 s37, s35, 0x20001
    s_and_b32 s38, s35, 1
    s_mov_b32 s59, 0
    s_branch L_stream
L_nojob:
    s_barrier
    s_cmp_ge_u32 s35, 22
    s_cbranch_scc1 L_h_t1
    s_cmp_eq_u32 s39, 1
    s_cbranch_scc1 L_h_role
    s_cmp_lt_u32 s96, 144
    s_cbranch_scc1 L_unit
    s_cmp_eq_u32 s3, 3
    s_cbranch_scc1 L_service
    s_endpgm
L_unit:
    v_lshrrev_b32 v3, 4, v0
    v_and_b32 v4, 3, v0
    v_bfe_u32 v7, v0, 2, 2
    s_mov_b32 s14, s3
    s_mov_b32 s15, 3
    s_sub_u32 s62, s96, 40
    s_cmp_lt_u32 s62, 64
    s_cbranch_scc1 L_u_q
    s_mov_b32 s100, 1
    s_sub_u32 s96, s96, 84
    s_cmp_lt_u32 s56, 40
    s_cbranch_scc0 L_u_full
    s_mov_b32 s100, 0
    s_lshr_b32 s96, s56, 1
    s_and_b32 s62, s56, 1
    s_lshl1_add_u32 s14, s62, s14
    s_mov_b32 s15, 1
L_u_full:
    s_mov_b32 s97, 0
    s_mov_b32 s99, 7680
    s_mov_b32 s48, s26
    s_mov_b32 s49, s27
    s_mov_b32 s50, 4915200
    s_mov_b32 s51, 0x20000
    s_mov_b32 s52, s24
    s_mov_b32 s53, s25
    s_mov_b32 s54, 5120
    s_mov_b32 s55, 0x20000
    v_and_b32 v6, 15, v0
    v_lshlrev_b32 v6, 4, v6
    v_mul_u32_u24 v5, 1280, v3
    v_add_u32 v5, v5, v6
    s_mul_i32 s62, s14, 320
    buffer_load_dwordx4 v[8:11], v5, s[52:55], s62 offen
    s_mov_b32 exec_lo, 0x000f000f
    s_mov_b32 exec_hi, 0x000f000f
    buffer_load_dwordx4 v[12:15], v5, s[52:55], s62 offen offset:256
    s_mov_b64 exec, -1
    s_lshl_b32 s98, s96, 7
    s_mul_i32 s13, s96, 0x199a
    s_lshr_b32 s13, s13, 16
    s_cmp_lg_u32 s13, 1
    s_cbranch_scc1 L_u_go
    s_mov_b32 s52, s4
    s_mov_b32 s53, s5
    s_mov_b32 s54, 5120
    s_mov_b32 s55, 0x20000
    v_mul_u32_u24 v5, 1280, v4
    v_lshlrev_b32 v64, 5, v7
    v_lshl_add_u32 v64, v3, 3, v64
    v_add_u32 v64, v64, v5
    v_lshrrev_b32 v6, 2, v0
    v_lshl_add_u32 v6, v6, 4, v5
    s_sub_u32 s62, s98, 1280
    buffer_load_dwordx4 v[16:19], v6, s[52:55], 0 offen offset:0
    buffer_load_dwordx4 v[20:23], v6, s[52:55], 0 offen offset:256
    buffer_load_dwordx4 v[24:27], v6, s[52:55], 0 offen offset:512
    buffer_load_dwordx4 v[28:31], v6, s[52:55], 0 offen offset:768
    buffer_load_dwordx4 v[32:35], v6, s[52:55], 0 offen offset:1024
    buffer_load_dwordx2 v[66:67], v64, s[52:55], s62 offen
    s_branch L_u_go
L_u_q:
    s_mov_b32 s97, 1
    s_mov_b32 s99, 8192
    s_mov_b32 s100, 0
    s_lshl_b32 s98, s62, 7
    s_mov_b32 s48, s10
    s_mov_b32 s49, s11
    s_mov_b32 s50, 5242880
    s_mov_b32 s51, 0x20000
L_u_go:
    v_lshrrev_b32 v6, 3, v0
    v_mul_lo_u32 v1, v6, s99
    v_and_b32 v6, 2, v6
    v_xor_b32 v6, v6, v0
    v_and_b32 v6, 7, v6
    v_lshl_add_u32 v1, v6, 4, v1
    v_add_u32 v1, s98, v1
    v_xor_b32 v2, 64, v1
    s_mul_i32 s63, s99, s14
    s_mul_i32 s63, s63, 160
    s_lshl_b32 s59, s99, 3
    s_mov_b32 m0, s101
    s_mov_b32 s62, 10
L_dma_1:
    buffer_load_dwordx4 v1, s[48:51], s63 offen nt lds
    s_add_u32 m0, m0, 1024
    s_add_u32 s63, s63, s59
    s_cmp_eq_u32 s100, 0
    s_cbranch_scc1 L_dma_1n0
    s_waitcnt vmcnt(3)
    s_cmp_eq_u32 s100, 2
    s_cbranch_scc1 L_dma_1n0
    s_waitcnt vmcnt(3)
L_dma_1n0:
    buffer_load_dwordx4 v2, s[48:51], s63 offen nt lds
    s_add_u32 m0, m0, 1024
    s_add_u32 s63, s63, s59
    s_cmp_eq_u32 s100, 0
    s_cbranch_scc1 L_dma_1n1
    s_waitcnt vmcnt(3)
    s_cmp_eq_u32 s100, 2
    s_cbranch_scc1 L_dma_1n1
    s_waitcnt vmcnt(3)
L_dma_1n1:
    s_sub_u32 s62, s62, 1
    s_cmp_lg_u32 s62, 0
    s_cbranch_scc1 L_dma_1
    v_min_u32 v65, 15, v0
    v_and_b32 v6, 1, v65
    v_mul_u32_u24 v6, 126, v6
    v_lshl_add_u32 v65, v65, 1, v6
    v_mov_b32 v68, 0
    s_cmp_lt_u32 s56, 40
    s_cbranch_scc1 L_u_nofl
    buffer_load_dword v68, v65, s[44:47], 0 offen sc1
L_u_nofl:
    s_cmp_lt_u32 s56, 104
    s_cbranch_scc0 L_u_nob
    s_barrier
L_u_nob:
    v_lshrrev_b32 v60, 4, v0
    v_lshlrev_b32 v60, 10, v60
    v_bfe_u32 v6, v0, 2, 2
    v_lshl_add_u32 v60, v6, 7, v60
    v_and_b32 v6, 3, v0
    v_lshl_add_u32 v60, v6, 3, v60
    v_bfe_u32 v6, v0, 3, 2
    v_lshl_add_u32 v60, v6, 5, v60
    v_xor_b32 v61, 32, v60
    v_xor_b32 v62, 64, v60
    v_xor_b32 v63, 0x60, v60
    v_add_u32 v60, s101, v60
    v_add_u32 v61, s101, v61
    v_add_u32 v62, s101, v62
    v_add_u32 v63, s101, v63
    v_mov_b32 v56, 1.0
    v_mov_b32 v57, 1.0
    v_mov_b32 v58, 1.0
    v_mov_b32 v59, 1.0
    s_mov_b32 s58, 0
    v_lshl_add_u32 v69, v7, 2, v3
    v_lshl_add_u32 v69, v4, 4, v69
    v_and_b32 v64, 15, v0
    v_lshlrev_b32 v64, 3, v64
    s_cmp_eq_u32 s97, 1
    s_cbranch_scc1 L_u_q2
    v_mul_u32_u24 v6, 1280, v3
    v_add_u32 v64, v64, v6
    s_mul_i32 s63, s13, 3840
    s_add_u32 s57, s98, s63
    s_add_u32 s57, s57, 10240
    s_cmp_lt_u32 s56, 40
    s_cbranch_scc0 L_u_nat
    v_lshrrev_b32 v69, 1, v3
    v_lshlrev_b32 v69, 3, v69
    v_lshl_add_u32 v69, v7, 4, v69
    v_lshl_add_u32 v69, v4, 1, v69
    v_and_b32 v6, 1, v3
    v_add_u32 v69, v69, v6
    s_lshr_b32 s62, s56, 1
    s_lshl_b32 s57, s62, 11
    s_cmp_ge_u32 s62, 10
    s_cselect_b32 s62, -19968, 0
    s_add_u32 s57, s57, s62
    s_and_b32 s62, s56, 1
    s_lshl_b32 s62, s62, 8
    s_add_u32 s57, s57, s62
    v_lshrrev_b32 v64, 5, v0
    v_lshlrev_b32 v64, 10, v64
    v_and_b32 v6, 31, v0
    v_lshl_add_u32 v64, v6, 3, v64
L_u_nat:
    s_cmp_eq_u32 s13, 4
    s_cselect_b32 s58, 1.0, 0
    s_cmp_eq_u32 s13, 1
    s_cselect_b32 s58, 1.0, s58
    s_cselect_b32 s56, 1, 0
    s_cmp_eq_u32 s14, 0
    s_cselect_b32 s58, s58, 0
    s_waitcnt vmcnt(20)
    s_mov_b32 s62, 0xbfb8aa3b
    v_lshlrev_b32 v40, 16, v8
    v_and_b32 v41, 0xffff0000, v8
    v_lshlrev_b32 v42, 16, v9
    v_and_b32 v43, 0xffff0000, v9
    v_lshlrev_b32 v44, 16, v10
    v_and_b32 v45, 0xffff0000, v10
    v_lshlrev_b32 v46, 16, v11
    v_and_b32 v47, 0xffff0000, v11
    v_mul_f32 v48, s62, v40
    v_mul_f32 v49, s62, v41
    v_mul_f32 v50, s62, v42
    v_mul_f32 v51, s62, v43
    v_mul_f32 v52, s62, v44
    v_mul_f32 v53, s62, v45
    v_mul_f32 v54, s62, v46
    v_mul_f32 v55, s62, v47
    v_exp_f32 v48, v48
    v_exp_f32 v49, v49
    v_exp_f32 v50, v50
    v_exp_f32 v51, v51
    v_exp_f32 v52, v52
    v_exp_f32 v53, v53
    v_exp_f32 v54, v54
    v_exp_f32 v55, v55
    v_add_f32 v48, 1.0, v48
    v_add_f32 v49, 1.0, v49
    v_add_f32 v50, 1.0, v50
    v_add_f32 v51, 1.0, v51
    v_add_f32 v52, 1.0, v52
    v_add_f32 v53, 1.0, v53
    v_add_f32 v54, 1.0, v54
    v_add_f32 v55, 1.0, v55
    v_rcp_f32 v48, v48
    v_rcp_f32 v49, v49
    v_rcp_f32 v50, v50
    v_rcp_f32 v51, v51
    v_rcp_f32 v52, v52
    v_rcp_f32 v53, v53
    v_rcp_f32 v54, v54
    v_rcp_f32 v55, v55
    v_mul_f32 v40, v40, v48
    v_mul_f32 v41, v41, v49
    v_mul_f32 v42, v42, v50
    v_mul_f32 v43, v43, v51
    v_mul_f32 v44, v44, v52
    v_mul_f32 v45, v45, v53
    v_mul_f32 v46, v46, v54
    v_mul_f32 v47, v47, v55
    v_cvt_pk_bf16_f32 v8, v40, v41
    v_cvt_pk_bf16_f32 v9, v42, v43
    v_cvt_pk_bf16_f32 v10, v44, v45
    v_cvt_pk_bf16_f32 v11, v46, v47
    v_lshlrev_b32 v40, 16, v12
    v_and_b32 v41, 0xffff0000, v12
    v_lshlrev_b32 v42, 16, v13
    v_and_b32 v43, 0xffff0000, v13
    v_lshlrev_b32 v44, 16, v14
    v_and_b32 v45, 0xffff0000, v14
    v_lshlrev_b32 v46, 16, v15
    v_and_b32 v47, 0xffff0000, v15
    v_mul_f32 v48, s62, v40
    v_mul_f32 v49, s62, v41
    v_mul_f32 v50, s62, v42
    v_mul_f32 v51, s62, v43
    v_mul_f32 v52, s62, v44
    v_mul_f32 v53, s62, v45
    v_mul_f32 v54, s62, v46
    v_mul_f32 v55, s62, v47
    v_exp_f32 v48, v48
    v_exp_f32 v49, v49
    v_exp_f32 v50, v50
    v_exp_f32 v51, v51
    v_exp_f32 v52, v52
    v_exp_f32 v53, v53
    v_exp_f32 v54, v54
    v_exp_f32 v55, v55
    v_add_f32 v48, 1.0, v48
    v_add_f32 v49, 1.0, v49
    v_add_f32 v50, 1.0, v50
    v_add_f32 v51, 1.0, v51
    v_add_f32 v52, 1.0, v52
    v_add_f32 v53, 1.0, v53
    v_add_f32 v54, 1.0, v54
    v_add_f32 v55, 1.0, v55
    v_rcp_f32 v48, v48
    v_rcp_f32 v49, v49
    v_rcp_f32 v50, v50
    v_rcp_f32 v51, v51
    v_rcp_f32 v52, v52
    v_rcp_f32 v53, v53
    v_rcp_f32 v54, v54
    v_rcp_f32 v55, v55
    v_mul_f32 v40, v40, v48
    v_mul_f32 v41, v41, v49
    v_mul_f32 v42, v42, v50
    v_mul_f32 v43, v43, v51
    v_mul_f32 v44, v44, v52
    v_mul_f32 v45, v45, v53
    v_mul_f32 v46, v46, v54
    v_mul_f32 v47, v47, v55
    v_cvt_pk_bf16_f32 v12, v40, v41
    v_cvt_pk_bf16_f32 v13, v42, v43
    v_cvt_pk_bf16_f32 v14, v44, v45
    v_cvt_pk_bf16_f32 v15, v46, v47
    s_mul_i32 s62, s3, 1344
    s_add_u32 s62, s62, 151552
    v_mul_u32_u24 v5, 336, v3
    v_and_b32 v6, 15, v0
    v_lshl_add_u32 v5, v6, 4, v5
    v_add_u32 v5, s62, v5
    ds_write_b128 v5, v[8:11]
    s_mov_b32 exec_lo, 0x000f000f
    s_mov_b32 exec_hi, 0x000f000f
    ds_write_b128 v5, v[12:15] offset:256
    s_mov_b64 exec, -1
    v_mul_u32_u24 v5, 336, v4
    v_lshl_add_u32 v5, v3, 4, v5
    v_add_u32 v5, s62, v5
    s_mov_b32 s59, 0x3e800000
    s_cmp_eq_u32 s56, 0
    s_cbranch_scc1 L_u_nost
    v_mov_b32 v40, 0
    v_mov_b32 v41, 0
    s_mov_b32 s62, 0x3f803f80
    v_dot2c_f32_bf16 v40, s62, v16
    v_dot2c_f32_bf16 v41, v16, v16
    v_dot2c_f32_bf16 v40, s62, v17
    v_dot2c_f32_bf16 v41, v17, v17
    v_dot2c_f32_bf16 v40, s62, v18
    v_dot2c_f32_bf16 v41, v18, v18
    v_dot2c_f32_bf16 v40, s62, v19
    v_dot2c_f32_bf16 v41, v19, v19
    v_dot2c_f32_bf16 v40, s62, v20
    v_dot2c_f32_bf16 v41, v20, v20
    v_dot2c_f32_bf16 v40, s62, v21
    v_dot2c_f32_bf16 v41, v21, v21
    v_dot2c_f32_bf16 v40, s62, v22
    v_dot2c_f32_bf16 v41, v22, v22
    v_dot2c_f32_bf16 v40, s62, v23
    v_dot2c_f32_bf16 v41, v23, v23
    v_dot2c_f32_bf16 v40, s62, v24
    v_dot2c_f32_bf16 v41, v24, v24
    v_dot2c_f32_bf16 v40, s62, v25
    v_dot2c_f32_bf16 v41, v25, v25
    v_dot2c_f32_bf16 v40, s62, v26
    v_dot2c_f32_bf16 v41, v26, v26
    v_dot2c_f32_bf16 v40, s62, v27
    v_dot2c_f32_bf16 v41, v27, v27
    v_dot2c_f32_bf16 v40, s62, v28
    v_dot2c_f32_bf16 v41, v28, v28
    v_dot2c_f32_bf16 v40, s62, v29
    v_dot2c_f32_bf16 v41, v29, v29
    v_dot2c_f32_bf16 v40, s62, v30
    v_dot2c_f32_bf16 v41, v30, v30
    v_dot2c_f32_bf16 v40, s62, v31
    v_dot2c_f32_bf16 v41, v31, v31
    v_dot2c_f32_bf16 v40, s62, v32
    v_dot2c_f32_bf16 v41, v32, v32
    v_dot2c_f32_bf16 v40, s62, v33
    v_dot2c_f32_bf16 v41, v33, v33
    v_dot2c_f32_bf16 v40, s62, v34
    v_dot2c_f32_bf16 v41, v34, v34
    v_dot2c_f32_bf16 v40, s62, v35
    v_dot2c_f32_bf16 v41, v35, v35
    s_nop 1
    v_add_f32_dpp v40, v40, v40 row_ror:4 row_mask:0xf bank_mask:0xf
    v_add_f32_dpp v41, v41, v41 row_ror:4 row_mask:0xf bank_mask:0xf
    s_nop 0
    v_add_f32_dpp v40, v40, v40 row_ror:8 row_mask:0xf bank_mask:0xf
    v_add_f32_dpp v41, v41, v41 row_ror:8 row_mask:0xf bank_mask:0xf
    v_mov_b32 v42, v40
    v_mov_b32 v43, v41
    s_nop 0
    v_permlane16_swap_b32 v40, v42
    v_permlane16_swap_b32 v41, v43
    v_add_f32 v40, v40, v42
    v_add_f32 v41, v41, v43
    v_mov_b32 v42, v40
    v_mov_b32 v43, v41
    s_nop 0
    v_permlane32_swap_b32 v40, v42
    v_permlane32_swap_b32 v41, v43
    v_add_f32 v40, v40, v42
    v_add_f32 v41, v41, v43
    s_mov_b32 s62, 0x3acccccd
    v_mul_f32 v40, s62, v40
    v_mul_f32 v41, s62, v41
    v_fma_f32 v41, -v40, v40, v41
    v_max_f32 v41, 0, v41
    v_add_f32 v41, 0x3727c5ac, v41
    v_rsq_f32 v41, v41
    v_lshlrev_b32 v56, 16, v66
    v_and_b32 v57, 0xffff0000, v66
    v_lshlrev_b32 v58, 16, v67
    v_and_b32 v59, 0xffff0000, v67
    v_sub_f32 v56, v56, v40
    v_sub_f32 v57, v57, v40
    v_sub_f32 v58, v58, v40
    v_sub_f32 v59, v59, v40
    v_mul_f32 v56, v56, v41
    v_mul_f32 v57, v57, v41
    v_mul_f32 v58, v58, v41
    v_mul_f32 v59, v59, v41
L_u_nost:
    ds_read_b128 v[8:11], v5 offset:0
    ds_read_b128 v[12:15], v5 offset:64
    ds_read_b128 v[16:19], v5 offset:128
    ds_read_b128 v[20:23], v5 offset:192
    ds_read_b128 v[24:27], v5 offset:256
    s_branch L_u_frag
L_u_q2:
    v_lshl_add_u32 v64, v3, 13, v64
    s_add_u32 s57, s98, 40960
    v_lshlrev_b32 v5, 8, v7
    v_lshl_add_u32 v5, v3, 6, v5
    v_lshl_add_u32 v5, v4, 4, v5
    s_mul_i32 s63, s3, 5120
    s_add_u32 s63, s63, 0
    s_add_u32 s12, s63, 4096
    s_mov_b32 s59, 1.0
L_u_frag:
    s_waitcnt vmcnt(0)
    v_cmp_ne_u32 vcc, -1, v68
    s_cbranch_vccz L_u_yok
    s_cmp_eq_u32 s97, 1
    s_cbranch_scc1 L_u_ywait
    buffer_load_dword v68, v65, s[44:47], 0 offen sc1
    s_branch L_u_yok
L_u_ywait:
L_wy_2:
    buffer_load_dword v68, v65, s[44:47], 0 offen sc1
    s_waitcnt vmcnt(0)
    v_cmp_ne_u32 vcc, -1, v68
    s_cbranch_vccz L_wy_2e
    s_sleep 4
    s_sub_u32 s60, s60, 1
    s_cbranch_scc0 L_wy_2
    s_mov_b32 s60, 0
L_wy_2e:
L_u_yok:
    ds_read_b64_tr_b16 v[80:81], v60 offset:0
    ds_read_b64_tr_b16 v[82:83], v60 offset:512
    ds_read_b64_tr_b16 v[84:85], v61 offset:0
    ds_read_b64_tr_b16 v[86:87], v61 offset:512
    ds_read_b64_tr_b16 v[88:89], v62 offset:0
    ds_read_b64_tr_b16 v[90:91], v62 offset:512
    ds_read_b64_tr_b16 v[92:93], v63 offset:0
    ds_read_b64_tr_b16 v[94:95], v63 offset:512
    ds_read_b64_tr_b16 v[96:97], v60 offset:4096
    ds_read_b64_tr_b16 v[98:99], v60 offset:4608
    ds_read_b64_tr_b16 v[100:101], v61 offset:4096
    ds_read_b64_tr_b16 v[102:103], v61 offset:4608
    ds_read_b64_tr_b16 v[104:105], v62 offset:4096
    ds_read_b64_tr_b16 v[106:107], v62 offset:4608
    ds_read_b64_tr_b16 v[108:109], v63 offset:4096
    ds_read_b64_tr_b16 v[110:111], v63 offset:4608
    ds_read_b64_tr_b16 v[112:113], v60 offset:8192
    ds_read_b64_tr_b16 v[114:115], v60 offset:8704
    ds_read_b64_tr_b16 v[116:117], v61 offset:8192
    ds_read_b64_tr_b16 v[118:119], v61 offset:8704
    ds_read_b64_tr_b16 v[120:121], v62 offset:8192
    ds_read_b64_tr_b16 v[122:123], v62 offset:8704
    ds_read_b64_tr_b16 v[124:125], v63 offset:8192
    ds_read_b64_tr_b16 v[126:127], v63 offset:8704
    ds_read_b64_tr_b16 v[128:129], v60 offset:12288
    ds_read_b64_tr_b16 v[130:131], v60 offset:12800
    ds_read_b64_tr_b16 v[132:133], v61 offset:12288
    ds_read_b64_tr_b16 v[134:135], v61 offset:12800
    ds_read_b64_tr_b16 v[136:137], v62 offset:12288
    ds_read_b64_tr_b16 v[138:139], v62 offset:12800
    ds_read_b64_tr_b16 v[140:141], v63 offset:12288
    ds_read_b64_tr_b16 v[142:143], v63 offset:12800
    ds_read_b64_tr_b16 v[144:145], v60 offset:16384
    ds_read_b64_tr_b16 v[146:147], v60 offset:16896
    ds_read_b64_tr_b16 v[148:149], v61 offset:16384
    ds_read_b64_tr_b16 v[150:151], v61 offset:16896
    ds_read_b64_tr_b16 v[152:153], v62 offset:16384
    ds_read_b64_tr_b16 v[154:155], v62 offset:16896
    ds_read_b64_tr_b16 v[156:157], v63 offset:16384
    ds_read_b64_tr_b16 v[158:159], v63 offset:16896
    s_cmp_eq_u32 s97, 0
    s_cbranch_scc1 L_u_mm
    s_branch L_poll_3
L_poll_3s:
    s_sleep 8
L_poll_3:
    buffer_load_dwordx4 v[8:11], v5, s[40:43], s63 offen offset:0 sc1
    buffer_load_dwordx4 v[12:15], v5, s[40:43], s63 offen offset:1024 sc1
    buffer_load_dwordx4 v[16:19], v5, s[40:43], s63 offen offset:2048 sc1
    buffer_load_dwordx4 v[20:23], v5, s[40:43], s63 offen offset:3072 sc1
    buffer_load_dwordx4 v[24:27], v5, s[40:43], s12 offen offset:0 sc1
    s_sub_u32 s60, s60, 1
    s_cbranch_scc1 L_poll_3t
    s_waitcnt vmcnt(0)
    v_max3_u32 v37, v8, v9, v10
    v_max3_u32 v37, v37, v11, v12
    v_max3_u32 v37, v37, v13, v14
    v_max3_u32 v37, v37, v15, v16
    v_max3_u32 v37, v37, v17, v18
    v_max3_u32 v37, v37, v19, v20
    v_max3_u32 v37, v37, v21, v22
    v_max3_u32 v37, v37, v23, v24
    v_max3_u32 v37, v37, v25, v26
    v_max_u32 v37, v37, v27
    v_cmp_eq_u32 vcc, -1, v37
    s_cbranch_vccnz L_poll_3s
L_poll_3e:
L_u_got:
L_u_mm:
    s_waitcnt lgkmcnt(0)
    v_mfma_f32_16x16x32_bf16 v[40:43], v[80:83], v[8:11], 0
    v_mfma_f32_16x16x32_bf16 v[44:47], v[84:87], v[8:11], 0
    v_mfma_f32_16x16x32_bf16 v[48:51], v[88:91], v[8:11], 0
    v_mfma_f32_16x16x32_bf16 v[52:55], v[92:95], v[8:11], 0
    v_mfma_f32_16x16x32_bf16 v[40:43], v[96:99], v[12:15], v[40:43]
    v_mfma_f32_16x16x32_bf16 v[44:47], v[100:103], v[12:15], v[44:47]
    v_mfma_f32_16x16x32_bf16 v[48:51], v[104:107], v[12:15], v[48:51]
    v_mfma_f32_16x16x32_bf16 v[52:55], v[108:111], v[12:15], v[52:55]
    v_mfma_f32_16x16x32_bf16 v[40:43], v[112:115], v[16:19], v[40:43]
    v_mfma_f32_16x16x32_bf16 v[44:47], v[116:119], v[16:19], v[44:47]
    v_mfma_f32_16x16x32_bf16 v[48:51], v[120:123], v[16:19], v[48:51]
    v_mfma_f32_16x16x32_bf16 v[52:55], v[124:127], v[16:19], v[52:55]
    v_mfma_f32_16x16x32_bf16 v[40:43], v[128:131], v[20:23], v[40:43]
    v_mfma_f32_16x16x32_bf16 v[44:47], v[132:135], v[20:23], v[44:47]
    v_mfma_f32_16x16x32_bf16 v[48:51], v[136:139], v[20:23], v[48:51]
    v_mfma_f32_16x16x32_bf16 v[52:55], v[140:143], v[20:23], v[52:55]
    v_mfma_f32_16x16x32_bf16 v[40:43], v[144:147], v[24:27], v[40:43]
    v_mfma_f32_16x16x32_bf16 v[44:47], v[148:151], v[24:27], v[44:47]
    v_mfma_f32_16x16x32_bf16 v[48:51], v[152:155], v[24:27], v[48:51]
    v_mfma_f32_16x16x32_bf16 v[52:55], v[156:159], v[24:27], v[52:55]
    v_lshlrev_b32 v5, 4, v0
    v_add_u32 v5, 147456, v5
    s_lshl_b32 s62, s3, 10
    s_add_u32 s62, s62, 147456
    v_lshl_add_u32 v6, v69, 4, s62
    v_mov_b32 v24, s58
    v_mov_b32 v32, 162056
    v_mov_b32 v33, 1
    v_add_f32_dpp v40, v40, v40 row_ror:8 row_mask:0xf bank_mask:0xf
    v_add_f32_dpp v41, v41, v41 row_ror:8 row_mask:0xf bank_mask:0xf
    v_add_f32_dpp v42, v42, v42 row_ror:8 row_mask:0xf bank_mask:0xf
    v_add_f32_dpp v43, v43, v43 row_ror:8 row_mask:0xf bank_mask:0xf
    v_add_f32_dpp v44, v44, v44 row_ror:8 row_mask:0xf bank_mask:0xf
    v_add_f32_dpp v45, v45, v45 row_ror:8 row_mask:0xf bank_mask:0xf
    v_add_f32_dpp v46, v46, v46 row_ror:8 row_mask:0xf bank_mask:0xf
    v_add_f32_dpp v47, v47, v47 row_ror:8 row_mask:0xf bank_mask:0xf
    v_add_f32_dpp v48, v48, v48 row_ror:8 row_mask:0xf bank_mask:0xf
    v_add_f32_dpp v49, v49, v49 row_ror:8 row_mask:0xf bank_mask:0xf
    v_add_f32_dpp v50, v50, v50 row_ror:8 row_mask:0xf bank_mask:0xf
    v_add_f32_dpp v51, v51, v51 row_ror:8 row_mask:0xf bank_mask:0xf
    v_add_f32_dpp v52, v52, v52 row_ror:8 row_mask:0xf bank_mask:0xf
    v_add_f32_dpp v53, v53, v53 row_ror:8 row_mask:0xf bank_mask:0xf
    v_add_f32_dpp v54, v54, v54 row_ror:8 row_mask:0xf bank_mask:0xf
    v_add_f32_dpp v55, v55, v55 row_ror:8 row_mask:0xf bank_mask:0xf
    v_add_f32_dpp v28, v40, v40 row_ror:4 row_mask:0xf bank_mask:0x1
    v_add_f32_dpp v29, v41, v41 row_ror:4 row_mask:0xf bank_mask:0x1
    v_add_f32_dpp v30, v42, v42 row_ror:4 row_mask:0xf bank_mask:0x1
    v_add_f32_dpp v31, v43, v43 row_ror:4 row_mask:0xf bank_mask:0x1
    v_add_f32_dpp v28, v44, v44 row_ror:4 row_mask:0xf bank_mask:0x2
    v_add_f32_dpp v29, v45, v45 row_ror:4 row_mask:0xf bank_mask:0x2
    v_add_f32_dpp v30, v46, v46 row_ror:4 row_mask:0xf bank_mask:0x2
    v_add_f32_dpp v31, v47, v47 row_ror:4 row_mask:0xf bank_mask:0x2
    v_add_f32_dpp v28, v48, v48 row_ror:4 row_mask:0xf bank_mask:0x4
    v_add_f32_dpp v29, v49, v49 row_ror:4 row_mask:0xf bank_mask:0x4
    v_add_f32_dpp v30, v50, v50 row_ror:4 row_mask:0xf bank_mask:0x4
    v_add_f32_dpp v31, v51, v51 row_ror:4 row_mask:0xf bank_mask:0x4
    v_add_f32_dpp v28, v52, v52 row_ror:4 row_mask:0xf bank_mask:0x8
    v_add_f32_dpp v29, v53, v53 row_ror:4 row_mask:0xf bank_mask:0x8
    v_add_f32_dpp v30, v54, v54 row_ror:4 row_mask:0xf bank_mask:0x8
    v_add_f32_dpp v31, v55, v55 row_ror:4 row_mask:0xf bank_mask:0x8
    v_fma_f32 v28, v28, s59, v24
    v_fma_f32 v29, v29, s59, v24
    v_fma_f32 v30, v30, s59, v24
    v_fma_f32 v31, v31, s59, v24
    v_mul_f32 v28, v28, v56
    v_mul_f32 v29, v29, v57
    v_mul_f32 v30, v30, v58
    v_mul_f32 v31, v31, v59
    ds_write_b128 v6, v[28:31]
    s_mov_b64 exec, 1
    ds_add_rtn_u32 v34, v32, v33
    s_mov_b64 exec, -1
    ds_read_b128 v[8:11], v5
    ds_read_b128 v[12:15], v5 offset:1024
    ds_read_b128 v[16:19], v5 offset:2048
    ds_read_b128 v[20:23], v5 offset:3072
    s_waitcnt lgkmcnt(0)
    v_readfirstlane_b32 s62, v34
    s_nop 0
    s_cmp_eq_u32 s62, s15
    s_cbranch_scc1 L_u_last
    s_cmp_eq_u32 s62, 1
    s_cbranch_scc1 L_service
    s_endpgm
L_u_last:
    v_add_f32 v8, v8, v12
    v_add_f32 v9, v9, v13
    v_add_f32 v10, v10, v14
    v_add_f32 v11, v11, v15
    s_cmp_eq_u32 s15, 1
    s_cbranch_scc1 L_u_two
    v_add_f32 v16, v16, v20
    v_add_f32 v17, v17, v21
    v_add_f32 v18, v18, v22
    v_add_f32 v19, v19, v23
    v_add_f32 v8, v8, v16
    v_add_f32 v9, v9, v17
    v_add_f32 v10, v10, v18
    v_add_f32 v11, v11, v19
L_u_two:
    v_cvt_pk_bf16_f32 v8, v8, v9
    v_cvt_pk_bf16_f32 v9, v10, v11
    s_waitcnt vmcnt(0)
    v_cmp_ne_u32 vcc, -1, v68
    s_cbranch_vccz L_u_st
L_wy_4:
    buffer_load_dword v68, v65, s[44:47], 0 offen sc1
    s_waitcnt vmcnt(0)
    v_cmp_ne_u32 vcc, -1, v68
    s_cbranch_vccz L_wy_4e
    s_sleep 4
    s_sub_u32 s60, s60, 1
    s_cbranch_scc0 L_wy_4
    s_mov_b32 s60, 0
L_wy_4e:
L_u_st:
    buffer_store_dwordx2 v[8:9], v64, s[40:43], s57 offen sc1
    s_endpgm
L_touch:
    s_load_dword s0, s[32:33], 0
    s_load_dword s0, s[30:31], 0
    s_cmp_eq_u32 s39, 1
    s_cbranch_scc1 L_tpr
    s_mov_b32 s62, 16777216
    s_load_dword s0, s[8:9], s62
    s_mov_b32 s62, 83886080
    s_load_dword s0, s[8:9], s62
    s_mov_b32 s62, 150994944
    s_load_dword s0, s[8:9], s62
    s_mov_b32 s62, 218103808
    s_load_dword s0, s[8:9], s62
    s_branch L_tpv
L_tpr:
    s_load_dword s0, s[20:21], 0
    s_mov_b32 s62, 2211836
    s_load_dword s0, s[20:21], s62
    s_load_dword s0, s[16:17], 0
    s_mov_b32 s62, 2211836
    s_load_dword s0, s[16:17], s62
    s_load_dword s0, s[18:19], 0
    s_load_dword s0, s[22:23], 0
    s_load_dword s0, s[28:29], 0
    s_load_dword s0, s[4:5], 0
L_tpv:
    s_lshl_b32 s62, s34, 23
    s_load_dword s0, s[8:9], s62
    s_add_u32 s62, s62, 67108864
    s_load_dword s0, s[8:9], s62
    s_add_u32 s62, s62, 67108864
    s_load_dword s0, s[8:9], s62
    s_add_u32 s62, s62, 67108864
    s_load_dword s0, s[8:9], s62
    s_add_u32 s62, s62, 67108864
    s_branch L_notp
L_stream2:
    s_mov_b32 s12, s100
    s_mov_b32 s13, s101
    s_mov_b32 s40, s32
    s_mov_b32 s41, s33
    s_mov_b32 s42, 589824
    s_mov_b32 s43, 0x20000
    s_mov_b32 s44, s30
    s_mov_b32 s45, s31
    s_mov_b32 s46, 256
    s_mov_b32 s47, 0x20000
    s_bitcmp1_b32 s3, 0
    s_mov_b32 s57, 0xffffffff
    s_mov_b32 s58, 0xffff
    s_mov_b32 s14, 0xffffffff
    s_mov_b32 s15, 0x0
L_pm_10:
    s_cmp_lt_u32 s56, 104
    s_cbranch_scc0 L_pm_11
    s_bitcmp1_b32 s3, 0
    s_mov_b32 s57, 0xffff
    s_mov_b32 s58, 0x0
    s_mov_b32 s14, 0xffffffff
    s_mov_b32 s15, 0x0
L_pm_11:
    s_sub_u32 s96, s56, 43
    s_and_b32 s96, s96, 0xffffffc7
    s_cmp_eq_u32 s96, 0
    s_cbranch_scc0 L_pm_12
    s_bitcmp1_b32 s3, 0
    s_mov_b32 s57, 0x0
    s_mov_b32 s58, 0x0
    s_mov_b32 s14, 0x0
    s_mov_b32 s15, 0x0
L_pm_12:
    s_cmp_lt_u32 s56, 40
    s_cbranch_scc0 L_pm_13
    s_bitcmp1_b32 s3, 0
    s_mov_b32 s57, 0xffffffff
    s_mov_b32 s58, 0xf
    s_mov_b32 s14, 0xffffffff
    s_mov_b32 s15, 0x0
L_pm_13:
    s_cmp_eq_u32 s39, 1
    s_cbranch_scc0 L_pm_14
    s_bitcmp1_b32 s3, 0
    s_mov_b32 s57, 0xff
    s_mov_b32 s58, 0xff
    s_mov_b32 s14, 0xff00ff
    s_cselect_b32 s14, 0xff00ff00, s14
    s_mov_b32 s15, 0x0
L_pm_14:
    s_cmp_lg_u32 s13, 0
    s_cbranch_scc0 L_pm_15
    s_bitcmp1_b32 s3, 0
    s_mov_b32 s57, 0xffffffff
    s_mov_b32 s58, 0x0
    s_mov_b32 s14, 0x0
    s_mov_b32 s15, 0x0
L_pm_15:
    s_and_b32 s96, s39, s59
    s_cbranch_scc0 L_pm_16
    s_bitcmp1_b32 s3, 0
    s_mov_b32 s57, 0x3ff
    s_mov_b32 s58, 0x3ff
    s_mov_b32 s14, 0x0
    s_mov_b32 s15, 0x0
L_pm_16:
    s_add_u32 s52, s8, s63
    s_addc_u32 s53, s9, 0
    s_mov_b32 s54, 262144
    s_mov_b32 s55, 0x20000
    v_and_b32 v2, 15, v0
    v_lshrrev_b32 v3, 1, v2
    v_and_b32 v37, 1, v2
    v_lshlrev_b32 v37, 4, v37
    v_mov_b32 v38, 0xffff
    v_lshlrev_b32 v37, v37, v38
    v_cmp_eq_u32 vcc, 0, v3
    v_mov_b32 v32, 0
    s_nop 0
    v_cndmask_b32 v20, 0, v37, vcc
    v_cmp_eq_u32 vcc, 1, v3
    v_mov_b32 v33, 0
    s_nop 0
    v_cndmask_b32 v21, 0, v37, vcc
    v_cmp_eq_u32 vcc, 2, v3
    v_mov_b32 v34, 0
    s_nop 0
    v_cndmask_b32 v22, 0, v37, vcc
    v_cmp_eq_u32 vcc, 3, v3
    v_mov_b32 v35, 0
    s_nop 0
    v_cndmask_b32 v23, 0, v37, vcc
    v_lshlrev_b32 v2, 4, v2
    s_lshl_b32 s98, s62, 8
    s_add_u32 s98, s98, 40960
    s_bitcmp0_b32 s57, 2
    s_cbranch_scc1 L_sf_17
    s_bitcmp0_b32 s58, 2
    s_cbranch_scc1 L_sf_17
    s_waitcnt vmcnt(1)
L_sf_17:
    buffer_load_dwordx4 v[48:51], v1, s[48:51], s97 offen offset:2048 nt
    s_bitcmp0_b32 s57, 3
    s_cbranch_scc1 L_sf_18
    s_waitcnt vmcnt(2)
    s_bitcmp0_b32 s58, 3
    s_cbranch_scc1 L_sf_18
    s_waitcnt vmcnt(1)
L_sf_18:
    buffer_load_dwordx4 v[52:55], v1, s[48:51], s97 offen offset:3072 nt
    s_add_u32 s97, s97, 32768
    v_add_u32 v1, 4096, v1
    v_and_b32 v1, 0x7fff, v1
    s_waitcnt vmcnt(3)
    s_bitcmp0_b32 s57, 4
    s_cbranch_scc1 L_sf_19
    s_waitcnt vmcnt(2)
    s_bitcmp0_b32 s58, 4
    s_cbranch_scc1 L_sf_19
    s_waitcnt vmcnt(1)
L_sf_19:
    buffer_load_dwordx4 v[56:59], v1, s[48:51], s97 offen offset:0 nt
    s_waitcnt vmcnt(3)
    s_bitcmp0_b32 s57, 5
    s_cbranch_scc1 L_sf_20
    s_waitcnt vmcnt(2)
    s_bitcmp0_b32 s58, 5
    s_cbranch_scc1 L_sf_20
    s_waitcnt vmcnt(1)
L_sf_20:
    buffer_load_dwordx4 v[60:63], v1, s[48:51], s97 offen offset:1024 nt
    s_waitcnt vmcnt(3)
    s_bitcmp0_b32 s57, 6
    s_cbranch_scc1 L_sf_21
    s_waitcnt vmcnt(2)
    s_bitcmp0_b32 s58, 6
    s_cbranch_scc1 L_sf_21
    s_waitcnt vmcnt(1)
L_sf_21:
    buffer_load_dwordx4 v[64:67], v1, s[48:51], s97 offen offset:2048 nt
    s_waitcnt vmcnt(3)
    s_bitcmp0_b32 s57, 7
    s_cbranch_scc1 L_sf_22
    s_waitcnt vmcnt(2)
    s_bitcmp0_b32 s58, 7
    s_cbranch_scc1 L_sf_22
    s_waitcnt vmcnt(1)
L_sf_22:
    buffer_load_dwordx4 v[68:71], v1, s[48:51], s97 offen offset:3072 nt
    s_add_u32 s97, s97, 32768
    v_add_u32 v1, 4096, v1
    v_and_b32 v1, 0x7fff, v1
    s_waitcnt vmcnt(3)
    s_bitcmp0_b32 s57, 8
    s_cbranch_scc1 L_sf_23
    s_waitcnt vmcnt(2)
    s_bitcmp0_b32 s58, 8
    s_cbranch_scc1 L_sf_23
    s_waitcnt vmcnt(1)
L_sf_23:
    buffer_load_dwordx4 v[72:75], v1, s[48:51], s97 offen offset:0 nt
    s_waitcnt vmcnt(3)
    s_bitcmp0_b32 s57, 9
    s_cbranch_scc1 L_sf_24
    s_waitcnt vmcnt(2)
    s_bitcmp0_b32 s58, 9
    s_cbranch_scc1 L_sf_24
    s_waitcnt vmcnt(1)
L_sf_24:
    buffer_load_dwordx4 v[76:79], v1, s[48:51], s97 offen offset:1024 nt
    s_waitcnt vmcnt(3)
    s_bitcmp0_b32 s57, 10
    s_cbranch_scc1 L_sf_25
    s_waitcnt vmcnt(2)
    s_bitcmp0_b32 s58, 10
    s_cbranch_scc1 L_sf_25
    s_waitcnt vmcnt(1)
L_sf_25:
    buffer_load_dwordx4 v[80:83], v1, s[48:51], s97 offen offset:2048 nt
    s_waitcnt vmcnt(3)
    s_bitcmp0_b32 s57, 11
    s_cbranch_scc1 L_sf_26
    s_waitcnt vmcnt(2)
    s_bitcmp0_b32 s58, 11
    s_cbranch_scc1 L_sf_26
    s_waitcnt vmcnt(1)
L_sf_26:
    buffer_load_dwordx4 v[84:87], v1, s[48:51], s97 offen offset:3072 nt
    s_add_u32 s97, s97, 32768
    v_add_u32 v1, 4096, v1
    v_and_b32 v1, 0x7fff, v1
    s_waitcnt vmcnt(3)
    s_bitcmp0_b32 s57, 12
    s_cbranch_scc1 L_sf_27
    s_waitcnt vmcnt(2)
    s_bitcmp0_b32 s58, 12
    s_cbranch_scc1 L_sf_27
    s_waitcnt vmcnt(1)
L_sf_27:
    buffer_load_dwordx4 v[88:91], v1, s[48:51], s97 offen offset:0 nt
    s_waitcnt vmcnt(3)
    s_bitcmp0_b32 s57, 13
    s_cbranch_scc1 L_sf_28
    s_waitcnt vmcnt(2)
    s_bitcmp0_b32 s58, 13
    s_cbranch_scc1 L_sf_28
    s_waitcnt vmcnt(1)
L_sf_28:
    buffer_load_dwordx4 v[92:95], v1, s[48:51], s97 offen offset:1024 nt
    s_waitcnt vmcnt(3)
    s_bitcmp0_b32 s57, 14
    s_cbranch_scc1 L_sf_29
    s_waitcnt vmcnt(2)
    s_bitcmp0_b32 s58, 14
    s_cbranch_scc1 L_sf_29
    s_waitcnt vmcnt(1)
L_sf_29:
    buffer_load_dwordx4 v[96:99], v1, s[48:51], s97 offen offset:2048 nt
    s_waitcnt vmcnt(3)
    s_bitcmp0_b32 s57, 15
    s_cbranch_scc1 L_sf_30
    s_waitcnt vmcnt(2)
    s_bitcmp0_b32 s58, 15
    s_cbranch_scc1 L_sf_30
    s_waitcnt vmcnt(1)
L_sf_30:
    buffer_load_dwordx4 v[100:103], v1, s[48:51], s97 offen offset:3072 nt
    s_add_u32 s97, s97, 32768
    v_add_u32 v1, 4096, v1
    v_and_b32 v1, 0x7fff, v1
    s_waitcnt vmcnt(3)
    s_bitcmp0_b32 s57, 16
    s_cbranch_scc1 L_sf_31
    s_waitcnt vmcnt(2)
    s_bitcmp0_b32 s58, 16
    s_cbranch_scc1 L_sf_31
    s_waitcnt vmcnt(1)
L_sf_31:
    buffer_load_dwordx4 v[104:107], v1, s[48:51], s97 offen offset:0 nt
    s_waitcnt vmcnt(3)
    s_bitcmp0_b32 s57, 17
    s_cbranch_scc1 L_sf_32
    s_waitcnt vmcnt(2)
    s_bitcmp0_b32 s58, 17
    s_cbranch_scc1 L_sf_32
    s_waitcnt vmcnt(1)
L_sf_32:
    buffer_load_dwordx4 v[108:111], v1, s[48:51], s97 offen offset:1024 nt
    s_waitcnt vmcnt(3)
    s_bitcmp0_b32 s57, 18
    s_cbranch_scc1 L_sf_33
    s_waitcnt vmcnt(2)
    s_bitcmp0_b32 s58, 18
    s_cbranch_scc1 L_sf_33
    s_waitcnt vmcnt(1)
L_sf_33:
    buffer_load_dwordx4 v[112:115], v1, s[48:51], s97 offen offset:2048 nt
    s_waitcnt vmcnt(3)
    s_bitcmp0_b32 s57, 19
    s_cbranch_scc1 L_sf_34
    s_waitcnt vmcnt(2)
    s_bitcmp0_b32 s58, 19
    s_cbranch_scc1 L_sf_34
    s_waitcnt vmcnt(1)
L_sf_34:
    buffer_load_dwordx4 v[116:119], v1, s[48:51], s97 offen offset:3072 nt
    s_add_u32 s97, s97, 32768
    v_add_u32 v1, 4096, v1
    v_and_b32 v1, 0x7fff, v1
    s_waitcnt vmcnt(3)
    s_bitcmp0_b32 s57, 20
    s_cbranch_scc1 L_sf_35
    s_waitcnt vmcnt(2)
    s_bitcmp0_b32 s58, 20
    s_cbranch_scc1 L_sf_35
    s_waitcnt vmcnt(1)
L_sf_35:
    buffer_load_dwordx4 v[120:123], v1, s[48:51], s97 offen offset:0 nt
    s_waitcnt vmcnt(3)
    s_bitcmp0_b32 s57, 21
    s_cbranch_scc1 L_sf_36
    s_waitcnt vmcnt(2)
    s_bitcmp0_b32 s58, 21
    s_cbranch_scc1 L_sf_36
    s_waitcnt vmcnt(1)
L_sf_36:
    buffer_load_dwordx4 v[124:127], v1, s[48:51], s97 offen offset:1024 nt
    s_cmp_eq_u32 s12, -1
    s_cbranch_scc1 L_k_nopf
    s_waitcnt vmcnt(3)
    s_bitcmp0_b32 s57, 22
    s_cbranch_scc1 L_sf_37
    s_waitcnt vmcnt(2)
    s_bitcmp0_b32 s58, 22
    s_cbranch_scc1 L_sf_37
    s_waitcnt vmcnt(1)
L_sf_37:
    buffer_load_dwordx4 v[128:131], v1, s[48:51], s97 offen offset:2048 nt
    s_waitcnt vmcnt(3)
    s_bitcmp0_b32 s57, 23
    s_cbranch_scc1 L_sf_38
    s_waitcnt vmcnt(2)
    s_bitcmp0_b32 s58, 23
    s_cbranch_scc1 L_sf_38
    s_waitcnt vmcnt(1)
L_sf_38:
    buffer_load_dwordx4 v[132:135], v1, s[48:51], s97 offen offset:3072 nt
    s_add_u32 s97, s97, 32768
    v_add_u32 v1, 4096, v1
    v_and_b32 v1, 0x7fff, v1
    s_waitcnt vmcnt(3)
    s_bitcmp0_b32 s57, 24
    s_cbranch_scc1 L_sf_39
    s_waitcnt vmcnt(2)
    s_bitcmp0_b32 s58, 24
    s_cbranch_scc1 L_sf_39
    s_waitcnt vmcnt(1)
L_sf_39:
    buffer_load_dwordx4 v[136:139], v1, s[48:51], s97 offen offset:0 nt
    s_waitcnt vmcnt(3)
    s_bitcmp0_b32 s57, 25
    s_cbranch_scc1 L_sf_40
    s_waitcnt vmcnt(2)
    s_bitcmp0_b32 s58, 25
    s_cbranch_scc1 L_sf_40
    s_waitcnt vmcnt(1)
L_sf_40:
    buffer_load_dwordx4 v[140:143], v1, s[48:51], s97 offen offset:1024 nt
    s_waitcnt vmcnt(3)
    s_bitcmp0_b32 s57, 26
    s_cbranch_scc1 L_sf_41
    s_waitcnt vmcnt(2)
    s_bitcmp0_b32 s58, 26
    s_cbranch_scc1 L_sf_41
    s_waitcnt vmcnt(1)
L_sf_41:
    buffer_load_dwordx4 v[144:147], v1, s[48:51], s97 offen offset:2048 nt
    s_waitcnt vmcnt(3)
    s_bitcmp0_b32 s57, 27
    s_cbranch_scc1 L_sf_42
    s_waitcnt vmcnt(2)
    s_bitcmp0_b32 s58, 27
    s_cbranch_scc1 L_sf_42
    s_waitcnt vmcnt(1)
L_sf_42:
    buffer_load_dwordx4 v[148:151], v1, s[48:51], s97 offen offset:3072 nt
    s_add_u32 s97, s97, 32768
    v_add_u32 v1, 4096, v1
    v_and_b32 v1, 0x7fff, v1
    s_waitcnt vmcnt(3)
    s_bitcmp0_b32 s57, 28
    s_cbranch_scc1 L_sf_43
    s_waitcnt vmcnt(2)
    s_bitcmp0_b32 s58, 28
    s_cbranch_scc1 L_sf_43
    s_waitcnt vmcnt(1)
L_sf_43:
    buffer_load_dwordx4 v[152:155], v1, s[48:51], s97 offen offset:0 nt
    s_waitcnt vmcnt(3)
    s_bitcmp0_b32 s57, 29
    s_cbranch_scc1 L_sf_44
    s_waitcnt vmcnt(2)
    s_bitcmp0_b32 s58, 29
    s_cbranch_scc1 L_sf_44
    s_waitcnt vmcnt(1)
L_sf_44:
    buffer_load_dwordx4 v[156:159], v1, s[48:51], s97 offen offset:1024 nt
    s_waitcnt vmcnt(3)
    s_bitcmp0_b32 s57, 30
    s_cbranch_scc1 L_sf_45
    s_waitcnt vmcnt(2)
    s_bitcmp0_b32 s58, 30
    s_cbranch_scc1 L_sf_45
    s_waitcnt vmcnt(1)
L_sf_45:
    buffer_load_dwordx4 v[160:163], v1, s[48:51], s97 offen offset:2048 nt
    v_min_u32 v39, 15, v0
    v_and_b32 v38, 1, v39
    v_mul_u32_u24 v38, 126, v38
    v_lshl_add_u32 v39, v39, 1, v38
    buffer_load_dword v37, v39, s[44:47], 0 offen sc1
    s_waitcnt vmcnt(4)
    s_bitcmp0_b32 s57, 31
    s_cbranch_scc1 L_sf_46
    s_waitcnt vmcnt(3)
    s_bitcmp0_b32 s58, 31
    s_cbranch_scc1 L_sf_46
    s_waitcnt vmcnt(2)
L_sf_46:
    buffer_load_dwordx4 v[164:167], v1, s[48:51], s97 offen offset:3072 nt
    s_mov_b32 s97, 0
    v_add_u32 v1, 4096, v1
    v_and_b32 v1, 0x7fff, v1
    s_waitcnt vmcnt(4)
    s_bitcmp0_b32 s14, 0
    s_cbranch_scc1 L_sf_47
    s_waitcnt vmcnt(3)
    s_bitcmp0_b32 s15, 0
    s_cbranch_scc1 L_sf_47
    s_waitcnt vmcnt(2)
L_sf_47:
    s_add_u32 m0, s12, 0
    s_nop 0
    buffer_load_dwordx4 v1, s[52:55], s97 offen offset:0 nt lds
    s_waitcnt vmcnt(4)
    s_bitcmp0_b32 s14, 1
    s_cbranch_scc1 L_sf_48
    s_waitcnt vmcnt(3)
    s_bitcmp0_b32 s15, 1
    s_cbranch_scc1 L_sf_48
    s_waitcnt vmcnt(1)
L_sf_48:
    buffer_load_dwordx4 v1, s[52:55], s97 offen offset:1024 nt lds
    s_waitcnt vmcnt(4)
    s_bitcmp0_b32 s14, 2
    s_cbranch_scc1 L_sf_49
    s_waitcnt vmcnt(2)
    s_bitcmp0_b32 s15, 2
    s_cbranch_scc1 L_sf_49
    s_waitcnt vmcnt(1)
L_sf_49:
    buffer_load_dwordx4 v1, s[52:55], s97 offen offset:2048 nt lds
    s_waitcnt vmcnt(3)
    s_bitcmp0_b32 s14, 3
    s_cbranch_scc1 L_sf_50
    s_waitcnt vmcnt(2)
    s_bitcmp0_b32 s15, 3
    s_cbranch_scc1 L_sf_50
    s_waitcnt vmcnt(1)
L_sf_50:
    buffer_load_dwordx4 v1, s[52:55], s97 offen offset:3072 nt lds
    s_add_u32 s97, s97, 32768
    v_add_u32 v1, 4096, v1
    v_and_b32 v1, 0x7fff, v1
    v_cmp_eq_u32 vcc, 0, v37
    s_nop 0
    s_or_b32 s96, vcc_lo, vcc_hi
    buffer_load_dwordx4 v[4:7], v2, s[40:43], s98 offen sc1
    s_waitcnt vmcnt(4)
    s_bitcmp0_b32 s14, 4
    s_cbranch_scc1 L_sf_51
    s_waitcnt vmcnt(3)
    s_bitcmp0_b32 s15, 4
    s_cbranch_scc1 L_sf_51
    s_waitcnt vmcnt(2)
L_sf_51:
    s_add_u32 m0, s12, 4096
    s_nop 0
    buffer_load_dwordx4 v1, s[52:55], s97 offen offset:0 nt lds
    s_waitcnt vmcnt(4)
    s_bitcmp0_b32 s14, 5
    s_cbranch_scc1 L_sf_52
    s_waitcnt vmcnt(3)
    s_bitcmp0_b32 s15, 5
    s_cbranch_scc1 L_sf_52
    s_waitcnt vmcnt(2)
L_sf_52:
    buffer_load_dwordx4 v1, s[52:55], s97 offen offset:1024 nt lds
    s_waitcnt vmcnt(4)
    s_bitcmp0_b32 s14, 6
    s_cbranch_scc1 L_sf_53
    s_waitcnt vmcnt(3)
    s_bitcmp0_b32 s15, 6
    s_cbranch_scc1 L_sf_53
    s_waitcnt vmcnt(1)
L_sf_53:
    buffer_load_dwordx4 v1, s[52:55], s97 offen offset:2048 nt lds
    s_waitcnt vmcnt(4)
    s_bitcmp0_b32 s14, 7
    s_cbranch_scc1 L_sf_54
    s_waitcnt vmcnt(2)
    s_bitcmp0_b32 s15, 7
    s_cbranch_scc1 L_sf_54
    s_waitcnt vmcnt(1)
L_sf_54:
    buffer_load_dwordx4 v1, s[52:55], s97 offen offset:3072 nt lds
    s_add_u32 s97, s97, 32768
    v_add_u32 v1, 4096, v1
    v_and_b32 v1, 0x7fff, v1
L_k_join:
    s_waitcnt vmcnt(4)
    v_max3_u32 v38, v4, v5, v6
    v_max_u32 v38, v38, v7
    v_cmp_eq_u32 vcc, -1, v38
    s_cmp_lg_u32 s96, 0
    s_cbranch_scc1 L_qslow
    s_cbranch_vccnz L_qslow2
L_qok:
    v_dot2_f32_bf16 v8, v72, v4, 0
    v_dot2_f32_bf16 v9, v76, v4, 0
    v_dot2_f32_bf16 v10, v80, v4, 0
    v_dot2_f32_bf16 v11, v84, v4, 0
    v_dot2_f32_bf16 v24, v88, v4, 0
    v_dot2_f32_bf16 v25, v92, v4, 0
    v_dot2_f32_bf16 v26, v96, v4, 0
    v_dot2_f32_bf16 v27, v100, v4, 0
    v_dot2_f32_bf16 v8, v73, v5, v8
    v_dot2_f32_bf16 v9, v77, v5, v9
    v_dot2_f32_bf16 v10, v81, v5, v10
    v_dot2_f32_bf16 v11, v85, v5, v11
    v_dot2_f32_bf16 v24, v89, v5, v24
    v_dot2_f32_bf16 v25, v93, v5, v25
    v_dot2_f32_bf16 v26, v97, v5, v26
    v_dot2_f32_bf16 v27, v101, v5, v27
    v_dot2_f32_bf16 v8, v74, v6, v8
    v_dot2_f32_bf16 v9, v78, v6, v9
    v_dot2_f32_bf16 v10, v82, v6, v10
    v_dot2_f32_bf16 v11, v86, v6, v11
    v_dot2_f32_bf16 v24, v90, v6, v24
    v_dot2_f32_bf16 v25, v94, v6, v25
    v_dot2_f32_bf16 v26, v98, v6, v26
    v_dot2_f32_bf16 v27, v102, v6, v27
    v_dot2_f32_bf16 v8, v75, v7, v8
    v_dot2_f32_bf16 v9, v79, v7, v9
    v_dot2_f32_bf16 v10, v83, v7, v10
    v_dot2_f32_bf16 v11, v87, v7, v11
    v_dot2_f32_bf16 v24, v91, v7, v24
    v_dot2_f32_bf16 v25, v95, v7, v25
    v_dot2_f32_bf16 v26, v99, v7, v26
    v_dot2_f32_bf16 v27, v103, v7, v27
    v_add_f32_dpp v8, v8, v8 row_ror:8 row_mask:0xf bank_mask:0x3
    v_add_f32_dpp v10, v10, v10 row_ror:8 row_mask:0xf bank_mask:0x3
    v_add_f32_dpp v24, v24, v24 row_ror:8 row_mask:0xf bank_mask:0x3
    v_add_f32_dpp v26, v26, v26 row_ror:8 row_mask:0xf bank_mask:0x3
    v_add_f32_dpp v8, v9, v9 row_ror:8 row_mask:0xf bank_mask:0xc
    v_add_f32_dpp v10, v11, v11 row_ror:8 row_mask:0xf bank_mask:0xc
    v_add_f32_dpp v24, v25, v25 row_ror:8 row_mask:0xf bank_mask:0xc
    v_add_f32_dpp v26, v27, v27 row_ror:8 row_mask:0xf bank_mask:0xc
    v_add_f32_dpp v14, v8, v8 row_half_mirror row_mask:0xf bank_mask:0x5
    v_add_f32_dpp v15, v24, v24 row_half_mirror row_mask:0xf bank_mask:0x5
    v_add_f32_dpp v14, v10, v10 row_half_mirror row_mask:0xf bank_mask:0xa
    v_add_f32_dpp v15, v26, v26 row_half_mirror row_mask:0xf bank_mask:0xa
    s_nop 0
    v_add_f32_dpp v14, v14, v14 quad_perm:[1,0,3,2] row_mask:0xf bank_mask:0xf
    v_add_f32_dpp v15, v15, v15 quad_perm:[1,0,3,2] row_mask:0xf bank_mask:0xf
    s_nop 0
    v_add_f32_dpp v14, v14, v14 quad_perm:[2,3,0,1] row_mask:0xf bank_mask:0xf
    v_add_f32_dpp v15, v15, v15 quad_perm:[2,3,0,1] row_mask:0xf bank_mask:0xf
    s_waitcnt vmcnt(3)
    s_bitcmp0_b32 s14, 8
    s_cbranch_scc1 L_sf_65
    s_waitcnt vmcnt(2)
    s_bitcmp0_b32 s15, 8
    s_cbranch_scc1 L_sf_65
    s_waitcnt vmcnt(1)
L_sf_65:
    buffer_load_dwordx4 v[72:75], v1, s[52:55], s97 offen offset:0 nt
    v_dot2_f32_bf16 v8, v40, v4, 0
    v_dot2_f32_bf16 v9, v44, v4, 0
    v_dot2_f32_bf16 v10, v48, v4, 0
    v_dot2_f32_bf16 v11, v52, v4, 0
    v_dot2_f32_bf16 v24, v56, v4, 0
    v_dot2_f32_bf16 v25, v60, v4, 0
    v_dot2_f32_bf16 v26, v64, v4, 0
    v_dot2_f32_bf16 v27, v68, v4, 0
    v_dot2_f32_bf16 v28, v104, v4, 0
    v_dot2_f32_bf16 v29, v108, v4, 0
    v_dot2_f32_bf16 v30, v112, v4, 0
    v_dot2_f32_bf16 v31, v116, v4, 0
    v_dot2_f32_bf16 v8, v41, v5, v8
    v_dot2_f32_bf16 v9, v45, v5, v9
    v_dot2_f32_bf16 v10, v49, v5, v10
    v_dot2_f32_bf16 v11, v53, v5, v11
    v_dot2_f32_bf16 v24, v57, v5, v24
    v_dot2_f32_bf16 v25, v61, v5, v25
    v_dot2_f32_bf16 v26, v65, v5, v26
    v_dot2_f32_bf16 v27, v69, v5, v27
    v_dot2_f32_bf16 v28, v105, v5, v28
    v_dot2_f32_bf16 v29, v109, v5, v29
    v_dot2_f32_bf16 v30, v113, v5, v30
    v_dot2_f32_bf16 v31, v117, v5, v31
    v_dot2_f32_bf16 v8, v42, v6, v8
    v_dot2_f32_bf16 v9, v46, v6, v9
    v_dot2_f32_bf16 v10, v50, v6, v10
    v_dot2_f32_bf16 v11, v54, v6, v11
    v_dot2_f32_bf16 v24, v58, v6, v24
    v_dot2_f32_bf16 v25, v62, v6, v25
    v_dot2_f32_bf16 v26, v66, v6, v26
    v_dot2_f32_bf16 v27, v70, v6, v27
    v_dot2_f32_bf16 v28, v106, v6, v28
    v_dot2_f32_bf16 v29, v110, v6, v29
    v_dot2_f32_bf16 v30, v114, v6, v30
    v_dot2_f32_bf16 v31, v118, v6, v31
    v_dot2_f32_bf16 v8, v43, v7, v8
    v_dot2_f32_bf16 v9, v47, v7, v9
    v_dot2_f32_bf16 v10, v51, v7, v10
    v_dot2_f32_bf16 v11, v55, v7, v11
    v_dot2_f32_bf16 v24, v59, v7, v24
    v_dot2_f32_bf16 v25, v63, v7, v25
    v_dot2_f32_bf16 v26, v67, v7, v26
    v_dot2_f32_bf16 v27, v71, v7, v27
    v_dot2_f32_bf16 v28, v107, v7, v28
    v_dot2_f32_bf16 v29, v111, v7, v29
    v_dot2_f32_bf16 v30, v115, v7, v30
    v_dot2_f32_bf16 v31, v119, v7, v31
    v_add_f32_dpp v8, v8, v8 row_ror:8 row_mask:0xf bank_mask:0x3
    v_add_f32_dpp v10, v10, v10 row_ror:8 row_mask:0xf bank_mask:0x3
    v_add_f32_dpp v24, v24, v24 row_ror:8 row_mask:0xf bank_mask:0x3
    v_add_f32_dpp v26, v26, v26 row_ror:8 row_mask:0xf bank_mask:0x3
    v_add_f32_dpp v28, v28, v28 row_ror:8 row_mask:0xf bank_mask:0x3
    v_add_f32_dpp v30, v30, v30 row_ror:8 row_mask:0xf bank_mask:0x3
    v_add_f32_dpp v8, v9, v9 row_ror:8 row_mask:0xf bank_mask:0xc
    v_add_f32_dpp v10, v11, v11 row_ror:8 row_mask:0xf bank_mask:0xc
    v_add_f32_dpp v24, v25, v25 row_ror:8 row_mask:0xf bank_mask:0xc
    v_add_f32_dpp v26, v27, v27 row_ror:8 row_mask:0xf bank_mask:0xc
    v_add_f32_dpp v28, v29, v29 row_ror:8 row_mask:0xf bank_mask:0xc
    v_add_f32_dpp v30, v31, v31 row_ror:8 row_mask:0xf bank_mask:0xc
    v_add_f32_dpp v12, v8, v8 row_half_mirror row_mask:0xf bank_mask:0x5
    v_add_f32_dpp v13, v24, v24 row_half_mirror row_mask:0xf bank_mask:0x5
    v_add_f32_dpp v16, v28, v28 row_half_mirror row_mask:0xf bank_mask:0x5
    v_add_f32_dpp v12, v10, v10 row_half_mirror row_mask:0xf bank_mask:0xa
    v_add_f32_dpp v13, v26, v26 row_half_mirror row_mask:0xf bank_mask:0xa
    v_add_f32_dpp v16, v30, v30 row_half_mirror row_mask:0xf bank_mask:0xa
    v_add_f32_dpp v12, v12, v12 quad_perm:[1,0,3,2] row_mask:0xf bank_mask:0xf
    v_add_f32_dpp v13, v13, v13 quad_perm:[1,0,3,2] row_mask:0xf bank_mask:0xf
    v_add_f32_dpp v16, v16, v16 quad_perm:[1,0,3,2] row_mask:0xf bank_mask:0xf
    v_add_f32_dpp v12, v12, v12 quad_perm:[2,3,0,1] row_mask:0xf bank_mask:0xf
    v_add_f32_dpp v13, v13, v13 quad_perm:[2,3,0,1] row_mask:0xf bank_mask:0xf
    v_add_f32_dpp v16, v16, v16 quad_perm:[2,3,0,1] row_mask:0xf bank_mask:0xf
    s_waitcnt vmcnt(3)
    s_bitcmp0_b32 s14, 9
    s_cbranch_scc1 L_sf_66
    s_waitcnt vmcnt(2)
    s_bitcmp0_b32 s15, 9
    s_cbranch_scc1 L_sf_66
    s_waitcnt vmcnt(1)
L_sf_66:
    buffer_load_dwordx4 v[76:79], v1, s[52:55], s97 offen offset:1024 nt
    v_dot2_f32_bf16 v8, v120, v4, 0
    v_dot2_f32_bf16 v9, v124, v4, 0
    v_dot2_f32_bf16 v10, v128, v4, 0
    v_dot2_f32_bf16 v11, v132, v4, 0
    v_dot2_f32_bf16 v24, v136, v4, 0
    v_dot2_f32_bf16 v25, v140, v4, 0
    v_dot2_f32_bf16 v26, v144, v4, 0
    v_dot2_f32_bf16 v27, v148, v4, 0
    v_dot2_f32_bf16 v8, v121, v5, v8
    v_dot2_f32_bf16 v9, v125, v5, v9
    v_dot2_f32_bf16 v10, v129, v5, v10
    v_dot2_f32_bf16 v11, v133, v5, v11
    v_dot2_f32_bf16 v24, v137, v5, v24
    v_dot2_f32_bf16 v25, v141, v5, v25
    v_dot2_f32_bf16 v26, v145, v5, v26
    v_dot2_f32_bf16 v27, v149, v5, v27
    v_dot2_f32_bf16 v8, v122, v6, v8
    v_dot2_f32_bf16 v9, v126, v6, v9
    v_dot2_f32_bf16 v10, v130, v6, v10
    v_dot2_f32_bf16 v11, v134, v6, v11
    v_dot2_f32_bf16 v24, v138, v6, v24
    v_dot2_f32_bf16 v25, v142, v6, v25
    v_dot2_f32_bf16 v26, v146, v6, v26
    v_dot2_f32_bf16 v27, v150, v6, v27
    v_dot2_f32_bf16 v8, v123, v7, v8
    v_dot2_f32_bf16 v9, v127, v7, v9
    v_dot2_f32_bf16 v10, v131, v7, v10
    v_dot2_f32_bf16 v11, v135, v7, v11
    v_dot2_f32_bf16 v24, v139, v7, v24
    v_dot2_f32_bf16 v25, v143, v7, v25
    v_dot2_f32_bf16 v26, v147, v7, v26
    v_dot2_f32_bf16 v27, v151, v7, v27
    v_add_f32_dpp v8, v8, v8 row_ror:8 row_mask:0xf bank_mask:0x3
    v_add_f32_dpp v10, v10, v10 row_ror:8 row_mask:0xf bank_mask:0x3
    v_add_f32_dpp v24, v24, v24 row_ror:8 row_mask:0xf bank_mask:0x3
    v_add_f32_dpp v26, v26, v26 row_ror:8 row_mask:0xf bank_mask:0x3
    v_add_f32_dpp v8, v9, v9 row_ror:8 row_mask:0xf bank_mask:0xc
    v_add_f32_dpp v10, v11, v11 row_ror:8 row_mask:0xf bank_mask:0xc
    v_add_f32_dpp v24, v25, v25 row_ror:8 row_mask:0xf bank_mask:0xc
    v_add_f32_dpp v26, v27, v27 row_ror:8 row_mask:0xf bank_mask:0xc
    v_add_f32_dpp v17, v8, v8 row_half_mirror row_mask:0xf bank_mask:0x5
    v_add_f32_dpp v18, v24, v24 row_half_mirror row_mask:0xf bank_mask:0x5
    v_add_f32_dpp v17, v10, v10 row_half_mirror row_mask:0xf bank_mask:0xa
    v_add_f32_dpp v18, v26, v26 row_half_mirror row_mask:0xf bank_mask:0xa
    s_nop 0
    v_add_f32_dpp v17, v17, v17 quad_perm:[1,0,3,2] row_mask:0xf bank_mask:0xf
    v_add_f32_dpp v18, v18, v18 quad_perm:[1,0,3,2] row_mask:0xf bank_mask:0xf
    s_nop 0
    v_add_f32_dpp v17, v17, v17 quad_perm:[2,3,0,1] row_mask:0xf bank_mask:0xf
    v_add_f32_dpp v18, v18, v18 quad_perm:[2,3,0,1] row_mask:0xf bank_mask:0xf
    s_waitcnt vmcnt(3)
    s_bitcmp0_b32 s14, 10
    s_cbranch_scc1 L_sf_67
    s_waitcnt vmcnt(2)
    s_bitcmp0_b32 s15, 10
    s_cbranch_scc1 L_sf_67
    s_waitcnt vmcnt(1)
L_sf_67:
    buffer_load_dwordx4 v[80:83], v1, s[52:55], s97 offen offset:2048 nt
    s_waitcnt vmcnt(3)
    s_bitcmp0_b32 s14, 11
    s_cbranch_scc1 L_sf_68
    s_waitcnt vmcnt(2)
    s_bitcmp0_b32 s15, 11
    s_cbranch_scc1 L_sf_68
    s_waitcnt vmcnt(1)
L_sf_68:
    buffer_load_dwordx4 v[84:87], v1, s[52:55], s97 offen offset:3072 nt
    s_add_u32 s97, s97, 32768
    v_add_u32 v1, 4096, v1
    v_and_b32 v1, 0x7fff, v1
    s_cmp_eq_u32 s12, -1
    s_cbranch_scc1 L_nopfrd
    v_lshl_add_u32 v38, v0, 4, s12
    ds_read_b128 v[40:43], v38 offset:0
    ds_read_b128 v[44:47], v38 offset:1024
    ds_read_b128 v[48:51], v38 offset:2048
    ds_read_b128 v[52:55], v38 offset:3072
    ds_read_b128 v[56:59], v38 offset:4096
    ds_read_b128 v[60:63], v38 offset:5120
    ds_read_b128 v[64:67], v38 offset:6144
    ds_read_b128 v[68:71], v38 offset:7168
L_nopfrd:
    v_dot2_f32_bf16 v8, v152, v4, 0
    v_dot2_f32_bf16 v9, v156, v4, 0
    v_dot2_f32_bf16 v10, v160, v4, 0
    v_dot2_f32_bf16 v11, v164, v4, 0
    v_dot2_f32_bf16 v8, v153, v5, v8
    v_dot2_f32_bf16 v9, v157, v5, v9
    v_dot2_f32_bf16 v10, v161, v5, v10
    v_dot2_f32_bf16 v11, v165, v5, v11
    v_dot2_f32_bf16 v8, v154, v6, v8
    v_dot2_f32_bf16 v9, v158, v6, v9
    v_dot2_f32_bf16 v10, v162, v6, v10
    v_dot2_f32_bf16 v11, v166, v6, v11
    v_dot2_f32_bf16 v8, v155, v7, v8
    v_dot2_f32_bf16 v9, v159, v7, v9
    v_dot2_f32_bf16 v10, v163, v7, v10
    v_dot2_f32_bf16 v11, v167, v7, v11
    v_add_f32_dpp v8, v8, v8 row_ror:8 row_mask:0xf bank_mask:0x3
    s_nop 0
    v_add_f32_dpp v10, v10, v10 row_ror:8 row_mask:0xf bank_mask:0x3
    v_add_f32_dpp v8, v9, v9 row_ror:8 row_mask:0xf bank_mask:0xc
    v_add_f32_dpp v10, v11, v11 row_ror:8 row_mask:0xf bank_mask:0xc
    s_nop 0
    v_add_f32_dpp v19, v8, v8 row_half_mirror row_mask:0xf bank_mask:0x5
    v_add_f32_dpp v19, v10, v10 row_half_mirror row_mask:0xf bank_mask:0xa
    s_nop 1
    v_add_f32_dpp v19, v19, v19 quad_perm:[1,0,3,2] row_mask:0xf bank_mask:0xf
    s_nop 1
    v_add_f32_dpp v19, v19, v19 quad_perm:[2,3,0,1] row_mask:0xf bank_mask:0xf
    v_max3_f32 v3, v12, v13, v14
    v_max3_f32 v8, v15, v16, v17
    v_max3_f32 v3, v3, v18, v19
    v_max_f32 v3, v3, v8
    s_nop 1
    v_max_f32_dpp v3, v3, v3 row_ror:4 row_mask:0xf bank_mask:0xf
    s_nop 1
    v_max_f32_dpp v3, v3, v3 row_ror:8 row_mask:0xf bank_mask:0xf
    v_mov_b32 v8, v3
    s_nop 1
    v_permlane16_swap_b32 v3, v8
    v_max_f32 v3, v3, v8
    v_mov_b32 v8, v3
    s_nop 1
    v_permlane32_swap_b32 v3, v8
    v_max_f32 v3, v3, v8
    s_mov_b32 s96, 0x3e0293ee
    v_mul_f32 v8, s96, v3
    v_fma_f32 v12, v12, s96, -v8
    v_fma_f32 v13, v13, s96, -v8
    v_fma_f32 v14, v14, s96, -v8
    v_fma_f32 v15, v15, s96, -v8
    v_fma_f32 v16, v16, s96, -v8
    v_fma_f32 v17, v17, s96, -v8
    v_fma_f32 v18, v18, s96, -v8
    v_fma_f32 v19, v19, s96, -v8
    v_exp_f32 v12, v12
    v_exp_f32 v13, v13
    v_exp_f32 v14, v14
    v_exp_f32 v15, v15
    v_exp_f32 v16, v16
    v_exp_f32 v17, v17
    v_exp_f32 v18, v18
    v_exp_f32 v19, v19
    v_add_f32 v9, v12, v13
    v_add_f32 v10, v14, v15
    v_add_f32 v11, v16, v17
    v_add_f32 v3, v18, v19
    v_add_f32 v9, v9, v10
    v_add_f32 v3, v3, v11
    v_add_f32 v9, v9, v3
    v_cvt_pk_bf16_f32 v12, v12, v12
    v_cvt_pk_bf16_f32 v13, v13, v13
    v_cvt_pk_bf16_f32 v14, v14, v14
    v_cvt_pk_bf16_f32 v15, v15, v15
    v_cvt_pk_bf16_f32 v16, v16, v16
    v_cvt_pk_bf16_f32 v17, v17, v17
    v_cvt_pk_bf16_f32 v18, v18, v18
    v_cvt_pk_bf16_f32 v19, v19, v19
    v_add_f32_dpp v9, v9, v9 row_ror:4 row_mask:0xf bank_mask:0xf
    s_nop 1
    v_add_f32_dpp v9, v9, v9 row_ror:8 row_mask:0xf bank_mask:0xf
    v_mov_b32 v10, v9
    s_nop 1
    v_permlane16_swap_b32 v9, v10
    v_add_f32 v9, v9, v10
    v_mov_b32 v10, v9
    s_nop 1
    v_permlane32_swap_b32 v9, v10
    v_add_f32 v9, v9, v10
    s_mov_b64 exec, 1
    s_cmp_lg_u32 s13, 0
    s_cbranch_scc1 L_mljob
    s_lshl_b32 s96, s3, 3
    s_add_u32 s96, s96, 161920
    v_mov_b32 v10, s96
    v_mov_b32 v11, 162068
    v_mov_b32 v3, 1
    ds_write_b64 v10, v[8:9]
    ds_add_u32 v11, v3
L_mldone:
    s_mov_b64 exec, -1
    v_lshrrev_b32 v2, 1, v2
    v_and_b32_dpp v24, v14, v20 row_newbcast:0 row_mask:0xf bank_mask:0xf
    v_and_b32_dpp v25, v14, v21 row_newbcast:0 row_mask:0xf bank_mask:0xf
    v_and_b32_dpp v26, v14, v22 row_newbcast:0 row_mask:0xf bank_mask:0xf
    v_and_b32_dpp v27, v14, v23 row_newbcast:0 row_mask:0xf bank_mask:0xf
    s_waitcnt vmcnt(3)
    s_bitcmp0_b32 s14, 12
    s_cbranch_scc1 L_sf_69
    s_waitcnt vmcnt(2)
    s_bitcmp0_b32 s15, 12
    s_cbranch_scc1 L_sf_69
    s_waitcnt vmcnt(1)
L_sf_69:
    buffer_load_dwordx4 v[88:91], v1, s[52:55], s97 offen offset:0 nt
    v_mfma_f32_16x16x32_bf16 v[32:35], v[24:27], v[72:75], v[32:35]
    s_cmp_eq_u32 s12, -1
    s_cbranch_scc1 L_nopfpv8
    s_waitcnt lgkmcnt(0)
    v_and_b32_dpp v24, v12, v20 row_newbcast:0 row_mask:0xf bank_mask:0xf
    v_and_b32_dpp v25, v12, v21 row_newbcast:0 row_mask:0xf bank_mask:0xf
    v_and_b32_dpp v26, v12, v22 row_newbcast:0 row_mask:0xf bank_mask:0xf
    v_and_b32_dpp v27, v12, v23 row_newbcast:0 row_mask:0xf bank_mask:0xf
    s_nop 1
    v_mfma_f32_16x16x32_bf16 v[32:35], v[24:27], v[40:43], v[32:35]
    v_and_b32_dpp v28, v12, v20 row_newbcast:8 row_mask:0xf bank_mask:0xf
    v_and_b32_dpp v29, v12, v21 row_newbcast:8 row_mask:0xf bank_mask:0xf
    v_and_b32_dpp v30, v12, v22 row_newbcast:8 row_mask:0xf bank_mask:0xf
    v_and_b32_dpp v31, v12, v23 row_newbcast:8 row_mask:0xf bank_mask:0xf
    s_nop 1
    v_mfma_f32_16x16x32_bf16 v[32:35], v[28:31], v[44:47], v[32:35]
    v_and_b32_dpp v24, v12, v20 row_newbcast:4 row_mask:0xf bank_mask:0xf
    v_and_b32_dpp v25, v12, v21 row_newbcast:4 row_mask:0xf bank_mask:0xf
    v_and_b32_dpp v26, v12, v22 row_newbcast:4 row_mask:0xf bank_mask:0xf
    v_and_b32_dpp v27, v12, v23 row_newbcast:4 row_mask:0xf bank_mask:0xf
    s_nop 1
    v_mfma_f32_16x16x32_bf16 v[32:35], v[24:27], v[48:51], v[32:35]
    v_and_b32_dpp v28, v12, v20 row_newbcast:12 row_mask:0xf bank_mask:0xf
    v_and_b32_dpp v29, v12, v21 row_newbcast:12 row_mask:0xf bank_mask:0xf
    v_and_b32_dpp v30, v12, v22 row_newbcast:12 row_mask:0xf bank_mask:0xf
    v_and_b32_dpp v31, v12, v23 row_newbcast:12 row_mask:0xf bank_mask:0xf
    s_nop 1
    v_mfma_f32_16x16x32_bf16 v[32:35], v[28:31], v[52:55], v[32:35]
L_nopfpv8:
    v_and_b32_dpp v28, v14, v20 row_newbcast:8 row_mask:0xf bank_mask:0xf
    v_and_b32_dpp v29, v14, v21 row_newbcast:8 row_mask:0xf bank_mask:0xf
    v_and_b32_dpp v30, v14, v22 row_newbcast:8 row_mask:0xf bank_mask:0xf
    v_and_b32_dpp v31, v14, v23 row_newbcast:8 row_mask:0xf bank_mask:0xf
    s_waitcnt vmcnt(3)
    s_bitcmp0_b32 s14, 13
    s_cbranch_scc1 L_sf_70
    s_waitcnt vmcnt(2)
    s_bitcmp0_b32 s15, 13
    s_cbranch_scc1 L_sf_70
    s_waitcnt vmcnt(1)
L_sf_70:
    buffer_load_dwordx4 v[92:95], v1, s[52:55], s97 offen offset:1024 nt
    v_mfma_f32_16x16x32_bf16 v[32:35], v[28:31], v[76:79], v[32:35]
    s_cmp_eq_u32 s12, -1
    s_cbranch_scc1 L_nopfpv9
    s_waitcnt lgkmcnt(0)
    v_and_b32_dpp v24, v13, v20 row_newbcast:0 row_mask:0xf bank_mask:0xf
    v_and_b32_dpp v25, v13, v21 row_newbcast:0 row_mask:0xf bank_mask:0xf
    v_and_b32_dpp v26, v13, v22 row_newbcast:0 row_mask:0xf bank_mask:0xf
    v_and_b32_dpp v27, v13, v23 row_newbcast:0 row_mask:0xf bank_mask:0xf
    s_nop 1
    v_mfma_f32_16x16x32_bf16 v[32:35], v[24:27], v[56:59], v[32:35]
    v_and_b32_dpp v28, v13, v20 row_newbcast:8 row_mask:0xf bank_mask:0xf
    v_and_b32_dpp v29, v13, v21 row_newbcast:8 row_mask:0xf bank_mask:0xf
    v_and_b32_dpp v30, v13, v22 row_newbcast:8 row_mask:0xf bank_mask:0xf
    v_and_b32_dpp v31, v13, v23 row_newbcast:8 row_mask:0xf bank_mask:0xf
    s_nop 1
    v_mfma_f32_16x16x32_bf16 v[32:35], v[28:31], v[60:63], v[32:35]
    v_and_b32_dpp v24, v13, v20 row_newbcast:4 row_mask:0xf bank_mask:0xf
    v_and_b32_dpp v25, v13, v21 row_newbcast:4 row_mask:0xf bank_mask:0xf
    v_and_b32_dpp v26, v13, v22 row_newbcast:4 row_mask:0xf bank_mask:0xf
    v_and_b32_dpp v27, v13, v23 row_newbcast:4 row_mask:0xf bank_mask:0xf
    s_nop 1
    v_mfma_f32_16x16x32_bf16 v[32:35], v[24:27], v[64:67], v[32:35]
    v_and_b32_dpp v28, v13, v20 row_newbcast:12 row_mask:0xf bank_mask:0xf
    v_and_b32_dpp v29, v13, v21 row_newbcast:12 row_mask:0xf bank_mask:0xf
    v_and_b32_dpp v30, v13, v22 row_newbcast:12 row_mask:0xf bank_mask:0xf
    v_and_b32_dpp v31, v13, v23 row_newbcast:12 row_mask:0xf bank_mask:0xf
    s_nop 1
    v_mfma_f32_16x16x32_bf16 v[32:35], v[28:31], v[68:71], v[32:35]
L_nopfpv9:
    v_and_b32_dpp v24, v14, v20 row_newbcast:4 row_mask:0xf bank_mask:0xf
    v_and_b32_dpp v25, v14, v21 row_newbcast:4 row_mask:0xf bank_mask:0xf
    v_and_b32_dpp v26, v14, v22 row_newbcast:4 row_mask:0xf bank_mask:0xf
    v_and_b32_dpp v27, v14, v23 row_newbcast:4 row_mask:0xf bank_mask:0xf
    s_waitcnt vmcnt(3)
    s_bitcmp0_b32 s14, 14
    s_cbranch_scc1 L_sf_71
    s_waitcnt vmcnt(2)
    s_bitcmp0_b32 s15, 14
    s_cbranch_scc1 L_sf_71
    s_waitcnt vmcnt(1)
L_sf_71:
    buffer_load_dwordx4 v[96:99], v1, s[52:55], s97 offen offset:2048 nt
    v_mfma_f32_16x16x32_bf16 v[32:35], v[24:27], v[80:83], v[32:35]
    v_and_b32_dpp v28, v14, v20 row_newbcast:12 row_mask:0xf bank_mask:0xf
    v_and_b32_dpp v29, v14, v21 row_newbcast:12 row_mask:0xf bank_mask:0xf
    v_and_b32_dpp v30, v14, v22 row_newbcast:12 row_mask:0xf bank_mask:0xf
    v_and_b32_dpp v31, v14, v23 row_newbcast:12 row_mask:0xf bank_mask:0xf
    s_waitcnt vmcnt(3)
    s_bitcmp0_b32 s14, 15
    s_cbranch_scc1 L_sf_72
    s_waitcnt vmcnt(2)
    s_bitcmp0_b32 s15, 15
    s_cbranch_scc1 L_sf_72
    s_waitcnt vmcnt(1)
L_sf_72:
    buffer_load_dwordx4 v[100:103], v1, s[52:55], s97 offen offset:3072 nt
    s_add_u32 s97, s97, 32768
    v_add_u32 v1, 4096, v1
    v_and_b32 v1, 0x7fff, v1
    v_mfma_f32_16x16x32_bf16 v[32:35], v[28:31], v[84:87], v[32:35]
    v_and_b32_dpp v24, v15, v20 row_newbcast:0 row_mask:0xf bank_mask:0xf
    v_and_b32_dpp v25, v15, v21 row_newbcast:0 row_mask:0xf bank_mask:0xf
    v_and_b32_dpp v26, v15, v22 row_newbcast:0 row_mask:0xf bank_mask:0xf
    v_and_b32_dpp v27, v15, v23 row_newbcast:0 row_mask:0xf bank_mask:0xf
    s_waitcnt vmcnt(3)
    s_bitcmp0_b32 s14, 16
    s_cbranch_scc1 L_sf_73
    s_waitcnt vmcnt(2)
    s_bitcmp0_b32 s15, 16
    s_cbranch_scc1 L_sf_73
    s_waitcnt vmcnt(1)
L_sf_73:
    buffer_load_dwordx4 v[104:107], v1, s[52:55], s97 offen offset:0 nt
    v_mfma_f32_16x16x32_bf16 v[32:35], v[24:27], v[88:91], v[32:35]
    v_and_b32_dpp v28, v15, v20 row_newbcast:8 row_mask:0xf bank_mask:0xf
    v_and_b32_dpp v29, v15, v21 row_newbcast:8 row_mask:0xf bank_mask:0xf
    v_and_b32_dpp v30, v15, v22 row_newbcast:8 row_mask:0xf bank_mask:0xf
    v_and_b32_dpp v31, v15, v23 row_newbcast:8 row_mask:0xf bank_mask:0xf
    s_waitcnt vmcnt(3)
    s_bitcmp0_b32 s14, 17
    s_cbranch_scc1 L_sf_74
    s_waitcnt vmcnt(2)
    s_bitcmp0_b32 s15, 17
    s_cbranch_scc1 L_sf_74
    s_waitcnt vmcnt(1)
L_sf_74:
    buffer_load_dwordx4 v[108:111], v1, s[52:55], s97 offen offset:1024 nt
    v_mfma_f32_16x16x32_bf16 v[32:35], v[28:31], v[92:95], v[32:35]
    v_and_b32_dpp v24, v15, v20 row_newbcast:4 row_mask:0xf bank_mask:0xf
    v_and_b32_dpp v25, v15, v21 row_newbcast:4 row_mask:0xf bank_mask:0xf
    v_and_b32_dpp v26, v15, v22 row_newbcast:4 row_mask:0xf bank_mask:0xf
    v_and_b32_dpp v27, v15, v23 row_newbcast:4 row_mask:0xf bank_mask:0xf
    s_waitcnt vmcnt(3)
    s_bitcmp0_b32 s14, 18
    s_cbranch_scc1 L_sf_75
    s_waitcnt vmcnt(2)
    s_bitcmp0_b32 s15, 18
    s_cbranch_scc1 L_sf_75
    s_waitcnt vmcnt(1)
L_sf_75:
    buffer_load_dwordx4 v[112:115], v1, s[52:55], s97 offen offset:2048 nt
    v_mfma_f32_16x16x32_bf16 v[32:35], v[24:27], v[96:99], v[32:35]
    v_and_b32_dpp v28, v15, v20 row_newbcast:12 row_mask:0xf bank_mask:0xf
    v_and_b32_dpp v29, v15, v21 row_newbcast:12 row_mask:0xf bank_mask:0xf
    v_and_b32_dpp v30, v15, v22 row_newbcast:12 row_mask:0xf bank_mask:0xf
    v_and_b32_dpp v31, v15, v23 row_newbcast:12 row_mask:0xf bank_mask:0xf
    s_waitcnt vmcnt(3)
    s_bitcmp0_b32 s14, 19
    s_cbranch_scc1 L_sf_76
    s_waitcnt vmcnt(2)
    s_bitcmp0_b32 s15, 19
    s_cbranch_scc1 L_sf_76
    s_waitcnt vmcnt(1)
L_sf_76:
    buffer_load_dwordx4 v[116:119], v1, s[52:55], s97 offen offset:3072 nt
    s_add_u32 s97, s97, 32768
    v_add_u32 v1, 4096, v1
    v_and_b32 v1, 0x7fff, v1
    v_mfma_f32_16x16x32_bf16 v[32:35], v[28:31], v[100:103], v[32:35]
    v_and_b32_dpp v24, v16, v20 row_newbcast:0 row_mask:0xf bank_mask:0xf
    v_and_b32_dpp v25, v16, v21 row_newbcast:0 row_mask:0xf bank_mask:0xf
    v_and_b32_dpp v26, v16, v22 row_newbcast:0 row_mask:0xf bank_mask:0xf
    v_and_b32_dpp v27, v16, v23 row_newbcast:0 row_mask:0xf bank_mask:0xf
    s_waitcnt vmcnt(3)
    s_bitcmp0_b32 s14, 20
    s_cbranch_scc1 L_sf_77
    s_waitcnt vmcnt(2)
    s_bitcmp0_b32 s15, 20
    s_cbranch_scc1 L_sf_77
    s_waitcnt vmcnt(1)
L_sf_77:
    buffer_load_dwordx4 v[120:123], v1, s[52:55], s97 offen offset:0 nt
    v_mfma_f32_16x16x32_bf16 v[32:35], v[24:27], v[104:107], v[32:35]
    v_and_b32_dpp v28, v16, v20 row_newbcast:8 row_mask:0xf bank_mask:0xf
    v_and_b32_dpp v29, v16, v21 row_newbcast:8 row_mask:0xf bank_mask:0xf
    v_and_b32_dpp v30, v16, v22 row_newbcast:8 row_mask:0xf bank_mask:0xf
    v_and_b32_dpp v31, v16, v23 row_newbcast:8 row_mask:0xf bank_mask:0xf
    s_waitcnt vmcnt(3)
    s_bitcmp0_b32 s14, 21
    s_cbranch_scc1 L_sf_78
    s_waitcnt vmcnt(2)
    s_bitcmp0_b32 s15, 21
    s_cbranch_scc1 L_sf_78
    s_waitcnt vmcnt(1)
L_sf_78:
    buffer_load_dwordx4 v[124:127], v1, s[52:55], s97 offen offset:1024 nt
    v_mfma_f32_16x16x32_bf16 v[32:35], v[28:31], v[108:111], v[32:35]
    v_and_b32_dpp v24, v16, v20 row_newbcast:4 row_mask:0xf bank_mask:0xf
    v_and_b32_dpp v25, v16, v21 row_newbcast:4 row_mask:0xf bank_mask:0xf
    v_and_b32_dpp v26, v16, v22 row_newbcast:4 row_mask:0xf bank_mask:0xf
    v_and_b32_dpp v27, v16, v23 row_newbcast:4 row_mask:0xf bank_mask:0xf
    s_waitcnt vmcnt(3)
    s_bitcmp0_b32 s14, 22
    s_cbranch_scc1 L_sf_79
    s_waitcnt vmcnt(2)
    s_bitcmp0_b32 s15, 22
    s_cbranch_scc1 L_sf_79
    s_waitcnt vmcnt(1)
L_sf_79:
    buffer_load_dwordx4 v[128:131], v1, s[52:55], s97 offen offset:2048 nt
    v_mfma_f32_16x16x32_bf16 v[32:35], v[24:27], v[112:115], v[32:35]
    v_and_b32_dpp v28, v16, v20 row_newbcast:12 row_mask:0xf bank_mask:0xf
    v_and_b32_dpp v29, v16, v21 row_newbcast:12 row_mask:0xf bank_mask:0xf
    v_and_b32_dpp v30, v16, v22 row_newbcast:12 row_mask:0xf bank_mask:0xf
    v_and_b32_dpp v31, v16, v23 row_newbcast:12 row_mask:0xf bank_mask:0xf
    s_waitcnt vmcnt(3)
    s_bitcmp0_b32 s14, 23
    s_cbranch_scc1 L_sf_80
    s_waitcnt vmcnt(2)
    s_bitcmp0_b32 s15, 23
    s_cbranch_scc1 L_sf_80
    s_waitcnt vmcnt(1)
L_sf_80:
    buffer_load_dwordx4 v[132:135], v1, s[52:55], s97 offen offset:3072 nt
    s_add_u32 s97, s97, 32768
    v_add_u32 v1, 4096, v1
    v_and_b32 v1, 0x7fff, v1
    v_mfma_f32_16x16x32_bf16 v[32:35], v[28:31], v[116:119], v[32:35]
    v_and_b32_dpp v24, v17, v20 row_newbcast:0 row_mask:0xf bank_mask:0xf
    v_and_b32_dpp v25, v17, v21 row_newbcast:0 row_mask:0xf bank_mask:0xf
    v_and_b32_dpp v26, v17, v22 row_newbcast:0 row_mask:0xf bank_mask:0xf
    v_and_b32_dpp v27, v17, v23 row_newbcast:0 row_mask:0xf bank_mask:0xf
    s_waitcnt vmcnt(3)
    s_bitcmp0_b32 s14, 24
    s_cbranch_scc1 L_sf_81
    s_waitcnt vmcnt(2)
    s_bitcmp0_b32 s15, 24
    s_cbranch_scc1 L_sf_81
    s_waitcnt vmcnt(1)
L_sf_81:
    buffer_load_dwordx4 v[136:139], v1, s[52:55], s97 offen offset:0 nt
    v_mfma_f32_16x16x32_bf16 v[32:35], v[24:27], v[120:123], v[32:35]
    s_or_b32 s96, s59, s39
    s_cbranch_scc0 L_nofrag_82
    v_mov_b32 v104, 162060
L_lw_83:
    ds_read_b32 v105, v104
    s_waitcnt lgkmcnt(0)
    v_cmp_gt_u32 vcc, 4, v105
    s_cbranch_vccz L_lw_83e
    s_sleep 2
    s_sub_u32 s60, s60, 1
    s_cbranch_scc0 L_lw_83
    s_mov_b32 s60, 0
L_lw_83e:
    s_cmp_eq_u32 s59, 0
    s_cbranch_scc1 L_nofrag_82
    v_bfe_u32 v104, v0, 2, 1
    v_bfe_u32 v110, v0, 4, 1
    v_lshl_add_u32 v104, v110, 2, v104
    v_and_b32 v110, 8, v0
    v_add_u32 v104, v104, v110
    v_lshrrev_b32 v110, 5, v0
    v_lshl_add_u32 v104, v110, 4, v104
    v_bfe_u32 v111, v0, 0, 1
    v_mul_u32_u24 v111, 0xaaaa, v111
    v_add_u32 v111, 0x4444, v111
    v_mov_b32 v112, 0
    v_mov_b32 v113, 0
    v_mov_b32 v114, 0
    v_mov_b32 v115, 0
    v_mov_b32 v116, 0
    v_mov_b32 v117, 0
    v_mov_b32 v118, 0
    v_mov_b32 v119, 0
    v_lshlrev_b32 v104, 7, v104
    v_and_b32 v110, 3, v0
    v_lshl_add_u32 v104, v110, 3, v104
    v_lshrrev_b32 v109, 4, v0
    v_and_b32 v110, 1, v0
    s_lshr_b32 s63, s3, 1
    s_and_b32 s62, s3, 1
    s_lshl_b32 s96, s63, 14
    s_lshl_b32 s100, s62, 6
    s_add_u32 s100, s100, 81920
    s_add_u32 s96, s96, s100
    v_add_u32 v104, s96, v104
    ds_read_b64_tr_b16 v[72:73], v104 offset:0
    ds_read_b64_tr_b16 v[74:75], v104 offset:256
    ds_read_b64_tr_b16 v[76:77], v104 offset:4096
    ds_read_b64_tr_b16 v[78:79], v104 offset:4352
    ds_read_b64_tr_b16 v[80:81], v104 offset:32
    ds_read_b64_tr_b16 v[82:83], v104 offset:288
    ds_read_b64_tr_b16 v[84:85], v104 offset:4128
    ds_read_b64_tr_b16 v[86:87], v104 offset:4384
    ds_read_b64_tr_b16 v[88:89], v104 offset:8192
    ds_read_b64_tr_b16 v[90:91], v104 offset:8448
    ds_read_b64_tr_b16 v[92:93], v104 offset:12288
    ds_read_b64_tr_b16 v[94:95], v104 offset:12544
    ds_read_b64_tr_b16 v[96:97], v104 offset:8224
    ds_read_b64_tr_b16 v[98:99], v104 offset:8480
    ds_read_b64_tr_b16 v[100:101], v104 offset:12320
    ds_read_b64_tr_b16 v[102:103], v104 offset:12576
    v_bfe_u32 v105, v0, 1, 3
    v_lshlrev_b32 v105, 8, v105
    v_lshl_add_u32 v105, v109, 5, v105
    v_lshl_add_u32 v105, v110, 4, v105
    v_lshrrev_b32 v106, 3, v0
    v_lshlrev_b32 v106, 7, v106
    v_and_b32 v110, 7, v0
    v_lshl_add_u32 v107, v110, 3, v106
    v_add_u32 v107, s100, v107
    v_lshlrev_b32 v106, 8, v109
    v_and_b32 v110, 15, v0
    v_lshl_add_u32 v106, v110, 2, v106
    v_add_u32 v106, s96, v106
    v_lshlrev_b32 v108, 2, v0
    s_lshl_b32 s96, s62, 2
    s_add_u32 s96, s96, 162088
    v_mov_b32 v109, s96
    s_lshl_b32 s100, s63, 11
    s_lshl_b32 s96, s34, 13
    s_add_u32 s100, s100, s96
    s_add_u32 s100, s100, 106496
    s_mul_i32 s101, s34, 5120
    s_lshl_b32 s96, s35, 9
    s_add_u32 s101, s101, s96
    s_lshl_b32 s96, s62, 8
    s_add_u32 s101, s101, s96
    s_sub_u32 s101, s101, 11264
    s_and_b32 s96, s101, 0xffffe000
    s_add_u32 s101, s101, s96
    s_add_u32 s101, s101, 212992
    v_add_u32 v110, 8192, v108
L_nofrag_82:
    v_and_b32_dpp v28, v17, v20 row_newbcast:8 row_mask:0xf bank_mask:0xf
    v_and_b32_dpp v29, v17, v21 row_newbcast:8 row_mask:0xf bank_mask:0xf
    v_and_b32_dpp v30, v17, v22 row_newbcast:8 row_mask:0xf bank_mask:0xf
    v_and_b32_dpp v31, v17, v23 row_newbcast:8 row_mask:0xf bank_mask:0xf
    s_waitcnt vmcnt(3)
    s_bitcmp0_b32 s14, 25
    s_cbranch_scc1 L_sf_84
    s_waitcnt vmcnt(2)
    s_bitcmp0_b32 s15, 25
    s_cbranch_scc1 L_sf_84
    s_waitcnt vmcnt(1)
L_sf_84:
    buffer_load_dwordx4 v[140:143], v1, s[52:55], s97 offen offset:1024 nt
    v_mfma_f32_16x16x32_bf16 v[32:35], v[28:31], v[124:127], v[32:35]
    v_and_b32_dpp v24, v17, v20 row_newbcast:4 row_mask:0xf bank_mask:0xf
    v_and_b32_dpp v25, v17, v21 row_newbcast:4 row_mask:0xf bank_mask:0xf
    v_and_b32_dpp v26, v17, v22 row_newbcast:4 row_mask:0xf bank_mask:0xf
    v_and_b32_dpp v27, v17, v23 row_newbcast:4 row_mask:0xf bank_mask:0xf
    s_waitcnt vmcnt(3)
    s_bitcmp0_b32 s14, 26
    s_cbranch_scc1 L_sf_85
    s_waitcnt vmcnt(2)
    s_bitcmp0_b32 s15, 26
    s_cbranch_scc1 L_sf_85
    s_waitcnt vmcnt(1)
L_sf_85:
    buffer_load_dwordx4 v[144:147], v1, s[52:55], s97 offen offset:2048 nt
    v_mfma_f32_16x16x32_bf16 v[32:35], v[24:27], v[128:131], v[32:35]
    v_and_b32_dpp v28, v17, v20 row_newbcast:12 row_mask:0xf bank_mask:0xf
    v_and_b32_dpp v29, v17, v21 row_newbcast:12 row_mask:0xf bank_mask:0xf
    v_and_b32_dpp v30, v17, v22 row_newbcast:12 row_mask:0xf bank_mask:0xf
    v_and_b32_dpp v31, v17, v23 row_newbcast:12 row_mask:0xf bank_mask:0xf
    s_waitcnt vmcnt(3)
    s_bitcmp0_b32 s14, 27
    s_cbranch_scc1 L_sf_86
    s_waitcnt vmcnt(2)
    s_bitcmp0_b32 s15, 27
    s_cbranch_scc1 L_sf_86
    s_waitcnt vmcnt(1)
L_sf_86:
    buffer_load_dwordx4 v[148:151], v1, s[52:55], s97 offen offset:3072 nt
    s_add_u32 s97, s97, 32768
    v_add_u32 v1, 4096, v1
    v_and_b32 v1, 0x7fff, v1
    v_mfma_f32_16x16x32_bf16 v[32:35], v[28:31], v[132:135], v[32:35]
    v_and_b32_dpp v24, v18, v20 row_newbcast:0 row_mask:0xf bank_mask:0xf
    v_and_b32_dpp v25, v18, v21 row_newbcast:0 row_mask:0xf bank_mask:0xf
    v_and_b32_dpp v26, v18, v22 row_newbcast:0 row_mask:0xf bank_mask:0xf
    v_and_b32_dpp v27, v18, v23 row_newbcast:0 row_mask:0xf bank_mask:0xf
    s_waitcnt vmcnt(3)
    s_bitcmp0_b32 s14, 28
    s_cbranch_scc1 L_sf_87
    s_waitcnt vmcnt(2)
    s_bitcmp0_b32 s15, 28
    s_cbranch_scc1 L_sf_87
    s_waitcnt vmcnt(1)
L_sf_87:
    buffer_load_dwordx4 v[152:155], v1, s[52:55], s97 offen offset:0 nt
    v_mfma_f32_16x16x32_bf16 v[32:35], v[24:27], v[136:139], v[32:35]
    v_mov_b32 v10, 162076
    v_mov_b32 v11, 1
    s_mov_b64 exec, 1
    ds_add_u32 v10, v11
    s_mov_b64 exec, -1
    v_and_b32_dpp v28, v18, v20 row_newbcast:8 row_mask:0xf bank_mask:0xf
    v_and_b32_dpp v29, v18, v21 row_newbcast:8 row_mask:0xf bank_mask:0xf
    v_and_b32_dpp v30, v18, v22 row_newbcast:8 row_mask:0xf bank_mask:0xf
    v_and_b32_dpp v31, v18, v23 row_newbcast:8 row_mask:0xf bank_mask:0xf
    s_waitcnt vmcnt(3)
    s_bitcmp0_b32 s14, 29
    s_cbranch_scc1 L_sf_88
    s_waitcnt vmcnt(2)
    s_bitcmp0_b32 s15, 29
    s_cbranch_scc1 L_sf_88
    s_waitcnt vmcnt(1)
L_sf_88:
    buffer_load_dwordx4 v[156:159], v1, s[52:55], s97 offen offset:1024 nt
    v_mfma_f32_16x16x32_bf16 v[32:35], v[28:31], v[140:143], v[32:35]
    v_and_b32_dpp v24, v18, v20 row_newbcast:4 row_mask:0xf bank_mask:0xf
    v_and_b32_dpp v25, v18, v21 row_newbcast:4 row_mask:0xf bank_mask:0xf
    v_and_b32_dpp v26, v18, v22 row_newbcast:4 row_mask:0xf bank_mask:0xf
    v_and_b32_dpp v27, v18, v23 row_newbcast:4 row_mask:0xf bank_mask:0xf
    s_waitcnt vmcnt(3)
    s_bitcmp0_b32 s14, 30
    s_cbranch_scc1 L_sf_89
    s_waitcnt vmcnt(2)
    s_bitcmp0_b32 s15, 30
    s_cbranch_scc1 L_sf_89
    s_waitcnt vmcnt(1)
L_sf_89:
    buffer_load_dwordx4 v[160:163], v1, s[52:55], s97 offen offset:2048 nt
    v_mfma_f32_16x16x32_bf16 v[32:35], v[24:27], v[144:147], v[32:35]
    v_lshrrev_b32 v9, 4, v0
    v_lshl_add_u32 v8, v9, 2, v2
    s_lshl_b32 s96, s3, 9
    s_add_u32 s96, s96, 157824
    v_lshl_add_u32 v8, v8, 2, s96
    v_lshlrev_b32 v9, 3, v0
    v_add_u32 v9, 157824, v9
    v_mov_b32 v10, 162048
    v_mov_b32 v11, 1
    s_lshl_b32 s96, s38, 5
    s_add_u32 s96, s96, 161984
    v_mov_b32 v3, s96
    s_sub_u32 s62, 8, s39
    s_lshl_b32 s98, s34, 5
    s_add_u32 s98, s98, s35
    s_lshl_b32 s98, s98, 8
    s_add_u32 s98, s98, 106496
    v_lshlrev_b32 v39, 2, v0
    v_and_b32_dpp v28, v18, v20 row_newbcast:12 row_mask:0xf bank_mask:0xf
    v_and_b32_dpp v29, v18, v21 row_newbcast:12 row_mask:0xf bank_mask:0xf
    v_and_b32_dpp v30, v18, v22 row_newbcast:12 row_mask:0xf bank_mask:0xf
    v_and_b32_dpp v31, v18, v23 row_newbcast:12 row_mask:0xf bank_mask:0xf
    s_waitcnt vmcnt(3)
    s_bitcmp0_b32 s14, 31
    s_cbranch_scc1 L_sf_90
    s_waitcnt vmcnt(2)
    s_bitcmp0_b32 s15, 31
    s_cbranch_scc1 L_sf_90
    s_waitcnt vmcnt(1)
L_sf_90:
    buffer_load_dwordx4 v[164:167], v1, s[52:55], s97 offen offset:3072 nt
    s_mov_b32 s97, 0
    v_add_u32 v1, 4096, v1
    v_and_b32 v1, 0x7fff, v1
    v_mfma_f32_16x16x32_bf16 v[32:35], v[28:31], v[148:151], v[32:35]
    s_cmp_eq_u32 s12, -1
    s_cbranch_scc1 L_v_nopf
    v_and_b32_dpp v24, v19, v20 row_newbcast:0 row_mask:0xf bank_mask:0xf
    v_and_b32_dpp v25, v19, v21 row_newbcast:0 row_mask:0xf bank_mask:0xf
    v_and_b32_dpp v26, v19, v22 row_newbcast:0 row_mask:0xf bank_mask:0xf
    v_and_b32_dpp v27, v19, v23 row_newbcast:0 row_mask:0xf bank_mask:0xf
    s_waitcnt vmcnt(3)
    s_nop 0
    v_mfma_f32_16x16x32_bf16 v[32:35], v[24:27], v[152:155], v[32:35]
    v_and_b32_dpp v28, v19, v20 row_newbcast:8 row_mask:0xf bank_mask:0xf
    v_and_b32_dpp v29, v19, v21 row_newbcast:8 row_mask:0xf bank_mask:0xf
    v_and_b32_dpp v30, v19, v22 row_newbcast:8 row_mask:0xf bank_mask:0xf
    v_and_b32_dpp v31, v19, v23 row_newbcast:8 row_mask:0xf bank_mask:0xf
    s_waitcnt vmcnt(2)
    s_nop 0
    v_mfma_f32_16x16x32_bf16 v[32:35], v[28:31], v[156:159], v[32:35]
    v_and_b32_dpp v24, v19, v20 row_newbcast:4 row_mask:0xf bank_mask:0xf
    v_and_b32_dpp v25, v19, v21 row_newbcast:4 row_mask:0xf bank_mask:0xf
    v_and_b32_dpp v26, v19, v22 row_newbcast:4 row_mask:0xf bank_mask:0xf
    v_and_b32_dpp v27, v19, v23 row_newbcast:4 row_mask:0xf bank_mask:0xf
    s_waitcnt vmcnt(1)
    s_nop 0
    v_mfma_f32_16x16x32_bf16 v[32:35], v[24:27], v[160:163], v[32:35]
    v_and_b32_dpp v28, v19, v20 row_newbcast:12 row_mask:0xf bank_mask:0xf
    v_and_b32_dpp v29, v19, v21 row_newbcast:12 row_mask:0xf bank_mask:0xf
    v_and_b32_dpp v30, v19, v22 row_newbcast:12 row_mask:0xf bank_mask:0xf
    v_and_b32_dpp v31, v19, v23 row_newbcast:12 row_mask:0xf bank_mask:0xf
    s_waitcnt vmcnt(0)
    s_nop 0
    v_mfma_f32_16x16x32_bf16 v[32:35], v[28:31], v[164:167], v[32:35]
L_v_join:
    s_cmp_lg_u32 s13, 0
    s_cbranch_scc1 L_jobend
L_t0:
    s_mov_b32 exec_hi, 0
    s_nop 4
    ds_write_b128 v8, v[32:35]
L_t0b:
    s_mov_b64 exec, 1
    ds_add_rtn_u32 v37, v10, v11
    s_mov_b64 exec, -1
    ds_read_b32 v38, v10 offset:24
    ds_read_b128 v[24:27], v3
    ds_read_b128 v[28:31], v3 offset:16
    ds_read_b64 v[144:145], v9 offset:0
    ds_read_b64 v[146:147], v9 offset:512
    ds_read_b64 v[148:149], v9 offset:1024
    ds_read_b64 v[150:151], v9 offset:1536
    ds_read_b64 v[152:153], v9 offset:2048
    ds_read_b64 v[154:155], v9 offset:2560
    ds_read_b64 v[156:157], v9 offset:3072
    ds_read_b64 v[158:159], v9 offset:3584
    s_waitcnt lgkmcnt(10)
    v_readfirstlane_b32 s96, v37
    v_readfirstlane_b32 s61, v38
    s_cmp_lg_u32 s96, s62
    s_cbranch_scc1 L_nopub
    s_waitcnt lgkmcnt(6)
    v_pk_mul_f32 v[144:145], v[144:145], v[24:25] op_sel:[0,0] op_sel_hi:[1,0]
    v_pk_mul_f32 v[146:147], v[146:147], v[24:25] op_sel:[0,1] op_sel_hi:[1,1]
    s_waitcnt lgkmcnt(4)
    v_pk_fma_f32 v[144:145], v[148:149], v[26:27], v[144:145] op_sel:[0,0,0] op_sel_hi:[1,0,1]
    v_pk_fma_f32 v[146:147], v[150:151], v[26:27], v[146:147] op_sel:[0,1,0] op_sel_hi:[1,1,1]
    s_waitcnt lgkmcnt(2)
    v_pk_fma_f32 v[144:145], v[152:153], v[28:29], v[144:145] op_sel:[0,0,0] op_sel_hi:[1,0,1]
    v_pk_fma_f32 v[146:147], v[154:155], v[28:29], v[146:147] op_sel:[0,1,0] op_sel_hi:[1,1,1]
    s_waitcnt lgkmcnt(0)
    v_pk_fma_f32 v[144:145], v[156:157], v[30:31], v[144:145] op_sel:[0,0,0] op_sel_hi:[1,0,1]
    v_pk_fma_f32 v[146:147], v[158:159], v[30:31], v[146:147] op_sel:[0,1,0] op_sel_hi:[1,1,1]
    s_cmp_eq_u32 s61, 1
    v_pk_add_f32 v[144:145], v[144:145], v[146:147]
    v_cvt_pk_bf16_f32 v32, v144, v145
    s_cbranch_scc0 L_oslow
    buffer_store_dword v32, v39, s[40:43], s98 offen
L_odone:
L_nopub:
    s_cmp_eq_u32 s59, 0
    s_cbranch_scc1 L_not1
L_poll_99:
    buffer_load_dwordx4 v[16:19], v105, s[40:43], s100 offen sc1
    buffer_load_dwordx4 v[20:23], v105, s[40:43], s100 offen offset:128 sc1
    s_sub_u32 s60, s60, 1
    s_cbranch_scc1 L_poll_99t
    s_waitcnt vmcnt(0)
    v_max3_u32 v38, v16, v17, v18
    v_max3_u32 v38, v38, v19, v20
    v_max3_u32 v38, v38, v21, v22
    v_max_u32 v38, v38, v23
    v_cmp_eq_u32 vcc, -1, v38
    s_cbranch_vccnz L_poll_99
L_poll_99e:
    v_smfmac_f32_16x16x64_bf16 v[112:115], v[16:19], v[72:79], v111
    v_smfmac_f32_16x16x64_bf16 v[116:119], v[16:19], v[80:87], v111
    v_smfmac_f32_16x16x64_bf16 v[112:115], v[20:23], v[88:95], v111
    v_smfmac_f32_16x16x64_bf16 v[116:119], v[20:23], v[96:103], v111
    s_nop 6
    v_pk_add_f32 v[112:113], v[112:113], v[114:115]
    v_pk_add_f32 v[116:117], v[116:117], v[118:119]
    v_add_f32 v12, v112, v113
    v_add_f32 v13, v116, v117
    ds_write2_b32 v106, v12, v13 offset0:0 offset1:32
    s_mov_b64 exec, 1
    ds_add_rtn_u32 v37, v109, v11
    s_mov_b64 exec, -1
    ds_read_b64 v[72:73], v107 offset:0
    ds_read_b64 v[74:75], v107 offset:16384
    ds_read_b64 v[76:77], v107 offset:32768
    ds_read_b64 v[78:79], v107 offset:49152
    s_cmp_eq_u32 s34, 2
    s_cselect_b32 s97, s61, 0
    s_waitcnt lgkmcnt(4)
    v_readfirstlane_b32 s96, v37
    s_waitcnt lgkmcnt(2)
    v_pk_add_f32 v[72:73], v[72:73], v[74:75]
    s_cmp_lg_u32 s96, 3
    s_cbranch_scc1 L_not1
    s_cmp_eq_u32 s97, 1
    s_waitcnt lgkmcnt(0)
    v_pk_add_f32 v[76:77], v[76:77], v[78:79]
    v_pk_add_f32 v[72:73], v[72:73], v[76:77]
    v_cvt_pk_bf16_f32 v12, v72, v73
    s_cbranch_scc1 L_pfast
    buffer_store_dword v12, v108, s[40:43], s101 offen sc1
    buffer_store_dword v12, v110, s[40:43], s101 offen sc1
L_pdone:
L_not1:
    s_waitcnt lgkmcnt(0)
    s_cmp_eq_u32 s39, 1
    s_cbranch_scc1 L_s_role
    s_endpgm
L_k_nopf:
    s_waitcnt vmcnt(3)
    s_bitcmp0_b32 s57, 22
    s_cbranch_scc1 L_sf_55
    s_waitcnt vmcnt(2)
    s_bitcmp0_b32 s58, 22
    s_cbranch_scc1 L_sf_55
    s_waitcnt vmcnt(1)
L_sf_55:
    buffer_load_dwordx4 v[128:131], v1, s[48:51], s97 offen offset:2048 nt
    v_min_u32 v39, 15, v0
    v_and_b32 v38, 1, v39
    v_mul_u32_u24 v38, 126, v38
    v_lshl_add_u32 v39, v39, 1, v38
    buffer_load_dword v37, v39, s[44:47], 0 offen sc1
    s_waitcnt vmcnt(4)
    s_bitcmp0_b32 s57, 23
    s_cbranch_scc1 L_sf_56
    s_waitcnt vmcnt(3)
    s_bitcmp0_b32 s58, 23
    s_cbranch_scc1 L_sf_56
    s_waitcnt vmcnt(2)
L_sf_56:
    buffer_load_dwordx4 v[132:135], v1, s[48:51], s97 offen offset:3072 nt
    s_add_u32 s97, s97, 32768
    v_add_u32 v1, 4096, v1
    v_and_b32 v1, 0x7fff, v1
    s_waitcnt vmcnt(4)
    s_bitcmp0_b32 s57, 24
    s_cbranch_scc1 L_sf_57
    s_waitcnt vmcnt(3)
    s_bitcmp0_b32 s58, 24
    s_cbranch_scc1 L_sf_57
    s_waitcnt vmcnt(2)
L_sf_57:
    buffer_load_dwordx4 v[136:139], v1, s[48:51], s97 offen offset:0 nt
    s_waitcnt vmcnt(4)
    s_bitcmp0_b32 s57, 25
    s_cbranch_scc1 L_sf_58
    s_waitcnt vmcnt(3)
    s_bitcmp0_b32 s58, 25
    s_cbranch_scc1 L_sf_58
    s_waitcnt vmcnt(1)
L_sf_58:
    buffer_load_dwordx4 v[140:143], v1, s[48:51], s97 offen offset:1024 nt
    s_waitcnt vmcnt(4)
    s_bitcmp0_b32 s57, 26
    s_cbranch_scc1 L_sf_59
    s_waitcnt vmcnt(2)
    s_bitcmp0_b32 s58, 26
    s_cbranch_scc1 L_sf_59
    s_waitcnt vmcnt(1)
L_sf_59:
    buffer_load_dwordx4 v[144:147], v1, s[48:51], s97 offen offset:2048 nt
    s_waitcnt vmcnt(3)
    s_bitcmp0_b32 s57, 27
    s_cbranch_scc1 L_sf_60
    s_waitcnt vmcnt(2)
    s_bitcmp0_b32 s58, 27
    s_cbranch_scc1 L_sf_60
    s_waitcnt vmcnt(1)
L_sf_60:
    buffer_load_dwordx4 v[148:151], v1, s[48:51], s97 offen offset:3072 nt
    s_add_u32 s97, s97, 32768
    v_add_u32 v1, 4096, v1
    v_and_b32 v1, 0x7fff, v1
    v_cmp_eq_u32 vcc, 0, v37
    s_nop 0
    s_or_b32 s96, vcc_lo, vcc_hi
    buffer_load_dwordx4 v[4:7], v2, s[40:43], s98 offen sc1
    s_waitcnt vmcnt(4)
    s_bitcmp0_b32 s57, 28
    s_cbranch_scc1 L_sf_61
    s_waitcnt vmcnt(3)
    s_bitcmp0_b32 s58, 28
    s_cbranch_scc1 L_sf_61
    s_waitcnt vmcnt(2)
L_sf_61:
    buffer_load_dwordx4 v[152:155], v1, s[48:51], s97 offen offset:0 nt
    s_waitcnt vmcnt(4)
    s_bitcmp0_b32 s57, 29
    s_cbranch_scc1 L_sf_62
    s_waitcnt vmcnt(3)
    s_bitcmp0_b32 s58, 29
    s_cbranch_scc1 L_sf_62
    s_waitcnt vmcnt(2)
L_sf_62:
    buffer_load_dwordx4 v[156:159], v1, s[48:51], s97 offen offset:1024 nt
    s_waitcnt vmcnt(4)
    s_bitcmp0_b32 s57, 30
    s_cbranch_scc1 L_sf_63
    s_waitcnt vmcnt(3)
    s_bitcmp0_b32 s58, 30
    s_cbranch_scc1 L_sf_63
    s_waitcnt vmcnt(1)
L_sf_63:
    buffer_load_dwordx4 v[160:163], v1, s[48:51], s97 offen offset:2048 nt
    s_waitcnt vmcnt(4)
    s_bitcmp0_b32 s57, 31
    s_cbranch_scc1 L_sf_64
    s_waitcnt vmcnt(2)
    s_bitcmp0_b32 s58, 31
    s_cbranch_scc1 L_sf_64
    s_waitcnt vmcnt(1)
L_sf_64:
    buffer_load_dwordx4 v[164:167], v1, s[48:51], s97 offen offset:3072 nt
    s_mov_b32 s97, 0
    v_add_u32 v1, 4096, v1
    v_and_b32 v1, 0x7fff, v1
    v_add_u32 v1, 8192, v1
    v_and_b32 v1, 0x7fff, v1
    s_mov_b32 s97, 65536
    s_branch L_k_join
L_v_nopf:
    v_and_b32_dpp v24, v19, v20 row_newbcast:0 row_mask:0xf bank_mask:0xf
    v_and_b32_dpp v25, v19, v21 row_newbcast:0 row_mask:0xf bank_mask:0xf
    v_and_b32_dpp v26, v19, v22 row_newbcast:0 row_mask:0xf bank_mask:0xf
    v_and_b32_dpp v27, v19, v23 row_newbcast:0 row_mask:0xf bank_mask:0xf
    s_waitcnt vmcnt(3)
    s_bitcmp0_b32 s14, 0
    s_cbranch_scc1 L_sf_91
    s_waitcnt vmcnt(2)
    s_bitcmp0_b32 s15, 0
    s_cbranch_scc1 L_sf_91
    s_waitcnt vmcnt(1)
L_sf_91:
    buffer_load_dwordx4 v[40:43], v1, s[52:55], s97 offen offset:0 nt
    v_mfma_f32_16x16x32_bf16 v[32:35], v[24:27], v[152:155], v[32:35]
    v_and_b32_dpp v28, v19, v20 row_newbcast:8 row_mask:0xf bank_mask:0xf
    v_and_b32_dpp v29, v19, v21 row_newbcast:8 row_mask:0xf bank_mask:0xf
    v_and_b32_dpp v30, v19, v22 row_newbcast:8 row_mask:0xf bank_mask:0xf
    v_and_b32_dpp v31, v19, v23 row_newbcast:8 row_mask:0xf bank_mask:0xf
    s_waitcnt vmcnt(3)
    s_bitcmp0_b32 s14, 1
    s_cbranch_scc1 L_sf_92
    s_waitcnt vmcnt(2)
    s_bitcmp0_b32 s15, 1
    s_cbranch_scc1 L_sf_92
    s_waitcnt vmcnt(1)
L_sf_92:
    buffer_load_dwordx4 v[44:47], v1, s[52:55], s97 offen offset:1024 nt
    v_mfma_f32_16x16x32_bf16 v[32:35], v[28:31], v[156:159], v[32:35]
    v_and_b32_dpp v24, v19, v20 row_newbcast:4 row_mask:0xf bank_mask:0xf
    v_and_b32_dpp v25, v19, v21 row_newbcast:4 row_mask:0xf bank_mask:0xf
    v_and_b32_dpp v26, v19, v22 row_newbcast:4 row_mask:0xf bank_mask:0xf
    v_and_b32_dpp v27, v19, v23 row_newbcast:4 row_mask:0xf bank_mask:0xf
    s_waitcnt vmcnt(3)
    s_bitcmp0_b32 s14, 2
    s_cbranch_scc1 L_sf_93
    s_waitcnt vmcnt(2)
    s_bitcmp0_b32 s15, 2
    s_cbranch_scc1 L_sf_93
    s_waitcnt vmcnt(1)
L_sf_93:
    buffer_load_dwordx4 v[48:51], v1, s[52:55], s97 offen offset:2048 nt
    v_mfma_f32_16x16x32_bf16 v[32:35], v[24:27], v[160:163], v[32:35]
    v_and_b32_dpp v28, v19, v20 row_newbcast:12 row_mask:0xf bank_mask:0xf
    v_and_b32_dpp v29, v19, v21 row_newbcast:12 row_mask:0xf bank_mask:0xf
    v_and_b32_dpp v30, v19, v22 row_newbcast:12 row_mask:0xf bank_mask:0xf
    v_and_b32_dpp v31, v19, v23 row_newbcast:12 row_mask:0xf bank_mask:0xf
    s_waitcnt vmcnt(3)
    s_bitcmp0_b32 s14, 3
    s_cbranch_scc1 L_sf_94
    s_waitcnt vmcnt(2)
    s_bitcmp0_b32 s15, 3
    s_cbranch_scc1 L_sf_94
    s_waitcnt vmcnt(1)
L_sf_94:
    buffer_load_dwordx4 v[52:55], v1, s[52:55], s97 offen offset:3072 nt
    s_add_u32 s97, s97, 32768
    v_add_u32 v1, 4096, v1
    v_and_b32 v1, 0x7fff, v1
    v_mfma_f32_16x16x32_bf16 v[32:35], v[28:31], v[164:167], v[32:35]
    v_and_b32_dpp v24, v12, v20 row_newbcast:0 row_mask:0xf bank_mask:0xf
    v_and_b32_dpp v25, v12, v21 row_newbcast:0 row_mask:0xf bank_mask:0xf
    v_and_b32_dpp v26, v12, v22 row_newbcast:0 row_mask:0xf bank_mask:0xf
    v_and_b32_dpp v27, v12, v23 row_newbcast:0 row_mask:0xf bank_mask:0xf
    s_waitcnt vmcnt(3)
    s_bitcmp0_b32 s14, 4
    s_cbranch_scc1 L_sf_95
    s_waitcnt vmcnt(2)
    s_bitcmp0_b32 s15, 4
    s_cbranch_scc1 L_sf_95
    s_waitcnt vmcnt(1)
L_sf_95:
    buffer_load_dwordx4 v[56:59], v1, s[52:55], s97 offen offset:0 nt
    v_mfma_f32_16x16x32_bf16 v[32:35], v[24:27], v[40:43], v[32:35]
    v_and_b32_dpp v28, v12, v20 row_newbcast:8 row_mask:0xf bank_mask:0xf
    v_and_b32_dpp v29, v12, v21 row_newbcast:8 row_mask:0xf bank_mask:0xf
    v_and_b32_dpp v30, v12, v22 row_newbcast:8 row_mask:0xf bank_mask:0xf
    v_and_b32_dpp v31, v12, v23 row_newbcast:8 row_mask:0xf bank_mask:0xf
    s_waitcnt vmcnt(3)
    s_bitcmp0_b32 s14, 5
    s_cbranch_scc1 L_sf_96
    s_waitcnt vmcnt(2)
    s_bitcmp0_b32 s15, 5
    s_cbranch_scc1 L_sf_96
    s_waitcnt vmcnt(1)
L_sf_96:
    buffer_load_dwordx4 v[60:63], v1, s[52:55], s97 offen offset:1024 nt
    v_mfma_f32_16x16x32_bf16 v[32:35], v[28:31], v[44:47], v[32:35]
    v_and_b32_dpp v24, v12, v20 row_newbcast:4 row_mask:0xf bank_mask:0xf
    v_and_b32_dpp v25, v12, v21 row_newbcast:4 row_mask:0xf bank_mask:0xf
    v_and_b32_dpp v26, v12, v22 row_newbcast:4 row_mask:0xf bank_mask:0xf
    v_and_b32_dpp v27, v12, v23 row_newbcast:4 row_mask:0xf bank_mask:0xf
    s_waitcnt vmcnt(3)
    s_bitcmp0_b32 s14, 6
    s_cbranch_scc1 L_sf_97
    s_waitcnt vmcnt(2)
    s_bitcmp0_b32 s15, 6
    s_cbranch_scc1 L_sf_97
    s_waitcnt vmcnt(1)
L_sf_97:
    buffer_load_dwordx4 v[64:67], v1, s[52:55], s97 offen offset:2048 nt
    v_mfma_f32_16x16x32_bf16 v[32:35], v[24:27], v[48:51], v[32:35]
    v_and_b32_dpp v28, v12, v20 row_newbcast:12 row_mask:0xf bank_mask:0xf
    v_and_b32_dpp v29, v12, v21 row_newbcast:12 row_mask:0xf bank_mask:0xf
    v_and_b32_dpp v30, v12, v22 row_newbcast:12 row_mask:0xf bank_mask:0xf
    v_and_b32_dpp v31, v12, v23 row_newbcast:12 row_mask:0xf bank_mask:0xf
    s_waitcnt vmcnt(3)
    s_bitcmp0_b32 s14, 7
    s_cbranch_scc1 L_sf_98
    s_waitcnt vmcnt(2)
    s_bitcmp0_b32 s15, 7
    s_cbranch_scc1 L_sf_98
    s_waitcnt vmcnt(1)
L_sf_98:
    buffer_load_dwordx4 v[68:71], v1, s[52:55], s97 offen offset:3072 nt
    s_add_u32 s97, s97, 32768
    v_add_u32 v1, 4096, v1
    v_and_b32 v1, 0x7fff, v1
    v_mfma_f32_16x16x32_bf16 v[32:35], v[28:31], v[52:55], v[32:35]
    v_and_b32_dpp v24, v13, v20 row_newbcast:0 row_mask:0xf bank_mask:0xf
    v_and_b32_dpp v25, v13, v21 row_newbcast:0 row_mask:0xf bank_mask:0xf
    v_and_b32_dpp v26, v13, v22 row_newbcast:0 row_mask:0xf bank_mask:0xf
    v_and_b32_dpp v27, v13, v23 row_newbcast:0 row_mask:0xf bank_mask:0xf
    s_waitcnt vmcnt(3)
    s_nop 0
    v_mfma_f32_16x16x32_bf16 v[32:35], v[24:27], v[56:59], v[32:35]
    v_and_b32_dpp v28, v13, v20 row_newbcast:8 row_mask:0xf bank_mask:0xf
    v_and_b32_dpp v29, v13, v21 row_newbcast:8 row_mask:0xf bank_mask:0xf
    v_and_b32_dpp v30, v13, v22 row_newbcast:8 row_mask:0xf bank_mask:0xf
    v_and_b32_dpp v31, v13, v23 row_newbcast:8 row_mask:0xf bank_mask:0xf
    s_waitcnt vmcnt(2)
    s_nop 0
    v_mfma_f32_16x16x32_bf16 v[32:35], v[28:31], v[60:63], v[32:35]
    v_and_b32_dpp v24, v13, v20 row_newbcast:4 row_mask:0xf bank_mask:0xf
    v_and_b32_dpp v25, v13, v21 row_newbcast:4 row_mask:0xf bank_mask:0xf
    v_and_b32_dpp v26, v13, v22 row_newbcast:4 row_mask:0xf bank_mask:0xf
    v_and_b32_dpp v27, v13, v23 row_newbcast:4 row_mask:0xf bank_mask:0xf
    s_waitcnt vmcnt(1)
    s_nop 0
    v_mfma_f32_16x16x32_bf16 v[32:35], v[24:27], v[64:67], v[32:35]
    v_and_b32_dpp v28, v13, v20 row_newbcast:12 row_mask:0xf bank_mask:0xf
    v_and_b32_dpp v29, v13, v21 row_newbcast:12 row_mask:0xf bank_mask:0xf
    v_and_b32_dpp v30, v13, v22 row_newbcast:12 row_mask:0xf bank_mask:0xf
    v_and_b32_dpp v31, v13, v23 row_newbcast:12 row_mask:0xf bank_mask:0xf
    s_waitcnt vmcnt(0)
    s_nop 0
    v_mfma_f32_16x16x32_bf16 v[32:35], v[28:31], v[68:71], v[32:35]
    s_branch L_v_join
L_oslow:
    buffer_store_dword v32, v39, s[40:43], s98 offen sc1
    s_branch L_odone
L_qslow:
L_wy_100:
    buffer_load_dword v37, v39, s[44:47], 0 offen sc1
    s_waitcnt vmcnt(0)
    v_cmp_ne_u32 vcc, -1, v37
    s_cbranch_vccz L_wy_100e
    s_sleep 4
    s_sub_u32 s60, s60, 1
    s_cbranch_scc0 L_wy_100
    s_mov_b32 s60, 0
L_wy_100e:
L_qslow2:
    s_branch L_poll_101
L_poll_101s:
    s_sleep 2
L_poll_101:
    buffer_load_dwordx4 v[4:7], v2, s[40:43], s98 offen sc1
    s_sub_u32 s60, s60, 1
    s_cbranch_scc1 L_poll_101t
    s_waitcnt vmcnt(0)
    v_max3_u32 v38, v4, v5, v6
    v_max_u32 v38, v38, v7
    v_cmp_eq_u32 vcc, -1, v38
    s_cbranch_vccnz L_poll_101s
L_poll_101e:
    s_branch L_qok
L_mljob:
    s_lshl4_add_u32 s96, s35, s3
    s_lshl_b32 s96, s96, 3
    s_add_u32 s96, s96, 81920
    buffer_store_dwordx2 v[8:9], v36, s[40:43], s96 offen sc1
    s_branch L_mldone
L_service:
    v_mov_b32 v72, 0
    v_mov_b32 v73, 0
    v_mov_b32 v74, 0
    v_mov_b32 v75, 0
    v_mov_b32 v76, 0
    s_mov_b32 s59, 0
    v_mov_b32 v5, 0
    v_mov_b32 v105, 0
    v_mov_b32 v108, 0
    v_mov_b32 v110, 0
    v_mov_b32 v160, 0
    v_mov_b32 v163, 0
    v_mov_b32 v8, 162068
L_lw_102:
    ds_read_b32 v9, v8
    s_waitcnt lgkmcnt(0)
    v_cmp_gt_u32 vcc, 8, v9
    s_cbranch_vccz L_lw_102e
    s_sleep 8
    s_sub_u32 s60, s60, 1
    s_cbranch_scc0 L_lw_102
    s_mov_b32 s60, 0
L_lw_102e:
    v_and_b32 v2, 15, v0
    v_lshlrev_b32 v2, 3, v2
    v_add_u32 v3, 161920, v2
    ds_read_b64 v[8:9], v3
    v_mov_b32 v11, 162096
    ds_read_b32 v11, v11
    s_getreg_b32 s58, hwreg(HW_REG_XCC_ID, 0, 4)
    s_lshl_b32 s98, s34, 5
    s_add_u32 s98, s98, s35
    s_lshl_b32 s62, s98, 7
    s_add_u32 s62, s62, 73728
    s_and_b32 s99, s62, 0xffffff00
    s_lshl_b32 s98, s98, 8
    s_add_u32 s98, s98, 106496
    v_lshlrev_b32 v39, 2, v0
    v_and_b32 v21, 64, v2
    v_add_u32 v21, v21, v2
    v_cmp_eq_u32 vcc, 8, v0
    s_bfm_b64 exec, 8, 0
    s_bitset1_b32 exec_lo, 8
    s_waitcnt lgkmcnt(0)
    v_lshl_add_u32 v10, v11, 8, s58
    v_cndmask_b32 v8, v8, v10, vcc
    buffer_store_dwordx2 v[8:9], v2, s[40:43], s62 offen sc1
    s_mov_b64 exec, -1
    v_mov_b32 v12, 162076
L_lw_103:
    ds_read_b32 v13, v12
    s_waitcnt lgkmcnt(0)
    v_cmp_gt_u32 vcc, 4, v13
    s_cbranch_vccz L_lw_103e
    s_sleep 4
    s_sub_u32 s60, s60, 1
    s_cbranch_scc0 L_lw_103
    s_mov_b32 s60, 0
L_lw_103e:
    v_and_b32 v11, 31, v0
    v_lshlrev_b32 v11, 7, v11
    s_lshl_b32 s63, s34, 12
    s_add_u32 s63, s63, 73792
    buffer_load_dword v12, v39, s[40:43], s98 offen sc1
    s_branch L_poll_104
L_poll_104s:
    s_sleep 16
L_poll_104:
    buffer_load_dwordx2 v[8:9], v21, s[40:43], s99 offen sc1
    buffer_load_dword v10, v11, s[40:43], s63 offen sc1
    s_sub_u32 s60, s60, 1
    s_cbranch_scc1 L_poll_104t
    s_waitcnt vmcnt(0)
    v_max3_u32 v38, v8, v9, v10
    v_cmp_eq_u32 vcc, -1, v38
    s_cbranch_vccnz L_poll_104s
L_poll_104e:
    v_mov_b32 v37, v8
    s_nop 1
    v_max_f32_dpp v37, v37, v37 quad_perm:[1,0,3,2] row_mask:0xf bank_mask:0xf
    s_nop 1
    v_max_f32_dpp v37, v37, v37 quad_perm:[2,3,0,1] row_mask:0xf bank_mask:0xf
    s_nop 1
    v_max_f32_dpp v37, v37, v37 row_ror:4 row_mask:0xf bank_mask:0xf
    s_nop 1
    v_max_f32_dpp v37, v37, v37 row_ror:8 row_mask:0xf bank_mask:0xf
    v_sub_f32 v8, v8, v37
    v_exp_f32 v8, v8
    s_nop 0
    v_mul_f32 v9, v8, v9
    s_nop 1
    v_add_f32_dpp v9, v9, v9 quad_perm:[1,0,3,2] row_mask:0xf bank_mask:0xf
    s_nop 1
    v_add_f32_dpp v9, v9, v9 quad_perm:[2,3,0,1] row_mask:0xf bank_mask:0xf
    s_nop 1
    v_add_f32_dpp v9, v9, v9 row_ror:4 row_mask:0xf bank_mask:0xf
    s_nop 1
    v_add_f32_dpp v9, v9, v9 row_ror:8 row_mask:0xf bank_mask:0xf
    v_and_b32 v10, 0xff, v10
    s_getreg_b32 s62, hwreg(HW_REG_XCC_ID, 0, 4)
    v_cmp_ne_u32 vcc, s62, v10
    s_nop 0
    s_cmp_eq_u64 vcc, 0
    s_cselect_b32 s61, 1, 0
    v_rcp_f32 v9, v9
    v_lshrrev_b32 v3, 1, v2
    v_add_u32 v3, 161984, v3
    v_mul_f32 v8, v8, v9
    v_mov_b32 v10, 162072
    v_mov_b32 v11, s61
    ds_write_b32 v3, v8
    ds_write_b32 v10, v11
    s_mov_b32 s3, 1
    v_lshrrev_b32 v9, 4, v0
    v_lshl_add_u32 v8, v9, 2, v2
    s_lshl_b32 s96, s3, 9
    s_add_u32 s96, s96, 157824
    v_lshl_add_u32 v8, v8, 2, s96
    v_lshlrev_b32 v9, 3, v0
    v_add_u32 v9, 157824, v9
    v_mov_b32 v10, 162048
    v_mov_b32 v11, 1
    s_lshl_b32 s96, s38, 5
    s_add_u32 s96, s96, 161984
    v_mov_b32 v3, s96
    s_sub_u32 s62, 8, s39
    s_lshl_b32 s98, s34, 5
    s_add_u32 s98, s98, s35
    s_lshl_b32 s98, s98, 8
    s_add_u32 s98, s98, 106496
    v_lshlrev_b32 v39, 2, v0
    s_branch L_t0b
L_jobend:
    v_lshlrev_b32 v9, 4, v0
    s_mov_b32 exec_hi, 0
    s_nop 3
    buffer_store_dwordx4 v[32:35], v9, s[40:43], s13 offen sc1
    s_endpgm
L_proxy:
    v_mov_b32 v72, 0
    v_mov_b32 v73, 0
    v_mov_b32 v74, 0
    v_mov_b32 v75, 0
    v_mov_b32 v76, 0
    v_mov_b32 v5, 0
    v_mov_b32 v105, 0
    v_mov_b32 v108, 0
    v_mov_b32 v110, 0
    v_mov_b32 v160, 0
    v_mov_b32 v163, 0
    s_barrier
    s_waitcnt lgkmcnt(0)
    s_mov_b32 s40, s32
    s_mov_b32 s41, s33
    s_mov_b32 s42, 589824
    s_mov_b32 s43, 0x20000
    s_mov_b32 s44, s30
    s_mov_b32 s45, s31
    s_mov_b32 s46, 256
    s_mov_b32 s47, 0x20000
    s_sub_u32 s97, 7, s3
    s_mul_i32 s97, s97, 27
    s_cmp_eq_u32 s3, 5
    s_cselect_b32 s97, 32, s97
    s_add_u32 s97, s97, s35
    s_lshl_b32 s97, s97, 9
    s_add_u32 s97, s97, 172032
    v_and_b32 v2, 15, v0
    v_lshlrev_b32 v2, 3, v2
    v_and_b32 v20, 31, v0
    v_lshlrev_b32 v20, 4, v20
    s_cmp_lg_u32 s3, 7
    s_cbranch_scc1 L_px6
    s_sub_u32 s96, 6, s59
    v_mov_b32 v8, 162068
L_lw_105:
    ds_read_b32 v9, v8
    s_waitcnt lgkmcnt(0)
    v_cmp_gt_u32 vcc, s96, v9
    s_cbranch_vccz L_lw_105e
    s_sleep 8
    s_sub_u32 s60, s60, 1
    s_cbranch_scc0 L_lw_105
    s_mov_b32 s60, 0
L_lw_105e:
    v_and_b32 v2, 15, v0
    v_lshlrev_b32 v2, 3, v2
    v_add_u32 v3, 161920, v2
    ds_read_b64 v[8:9], v3
    v_mov_b32 v11, 162096
    ds_read_b32 v11, v11
    s_getreg_b32 s58, hwreg(HW_REG_XCC_ID, 0, 4)
    s_lshl_b32 s98, s34, 5
    s_add_u32 s98, s98, s35
    s_lshl_b32 s62, s98, 7
    s_add_u32 s62, s62, 73728
    s_and_b32 s99, s62, 0xffffff00
    s_lshl_b32 s98, s98, 8
    s_add_u32 s98, s98, 106496
    v_lshlrev_b32 v39, 2, v0
    v_and_b32 v21, 64, v2
    v_add_u32 v21, v21, v2
    v_cmp_eq_u32 vcc, 8, v0
    s_bfm_b64 exec, s96, 0
    s_bitset1_b32 exec_lo, 8
    s_waitcnt lgkmcnt(0)
    v_lshl_add_u32 v10, v11, 8, s58
    v_cndmask_b32 v8, v8, v10, vcc
    buffer_store_dwordx2 v[8:9], v2, s[40:43], s62 offen sc1
    s_mov_b64 exec, -1
    s_mov_b32 s100, 4
    s_lshl_b32 s63, s100, 8
    v_and_b32 v8, 15, v0
    v_lshl_add_u32 v8, v8, 4, s63
    v_lshrrev_b32 v9, 4, v0
    v_mul_u32_u24 v5, 1280, v9
    v_add_u32 v5, v5, v8
    v_mul_u32_u24 v4, 1296, v9
    v_add_u32 v4, v4, v8
    v_add_u32 v4, 82944, v4
    v_lshlrev_b32 v6, 1, v5
    v_add_u32 v6, 99328, v6
    s_lshl_b32 s62, s100, 9
    s_add_u32 s62, s62, 88128
    v_lshl_add_u32 v7, v0, 3, s62
    s_mov_b32 s48, s4
    s_mov_b32 s49, s5
    s_mov_b32 s50, 5120
    s_mov_b32 s51, 0x20000
    buffer_load_dwordx4 v[8:11], v5, s[48:51], 0 offen
    s_mov_b32 s62, 20480
    s_mov_b32 s63, 30720
    s_branch L_poll_106
L_poll_106s:
    s_sleep 32
L_poll_106:
    buffer_load_dwordx4 v[12:15], v5, s[40:43], s62 offen sc1
    buffer_load_dwordx4 v[16:19], v5, s[40:43], s63 offen sc1
    s_sub_u32 s60, s60, 1
    s_cbranch_scc1 L_poll_106t
    s_waitcnt vmcnt(0)
    v_max3_u32 v38, v12, v13, v14
    v_max3_u32 v38, v38, v15, v16
    v_max3_u32 v38, v38, v17, v18
    v_max_u32 v38, v38, v19
    v_cmp_eq_u32 vcc, -1, v38
    s_cbranch_vccnz L_poll_106s
L_poll_106e:
    v_lshlrev_b32 v40, 16, v8
    v_and_b32 v41, 0xffff0000, v8
    v_lshlrev_b32 v42, 16, v9
    v_and_b32 v43, 0xffff0000, v9
    v_lshlrev_b32 v44, 16, v10
    v_and_b32 v45, 0xffff0000, v10
    v_lshlrev_b32 v46, 16, v11
    v_and_b32 v47, 0xffff0000, v11
    v_lshlrev_b32 v48, 16, v12
    v_and_b32 v49, 0xffff0000, v12
    v_lshlrev_b32 v50, 16, v13
    v_and_b32 v51, 0xffff0000, v13
    v_lshlrev_b32 v52, 16, v14
    v_and_b32 v53, 0xffff0000, v14
    v_lshlrev_b32 v54, 16, v15
    v_and_b32 v55, 0xffff0000, v15
    v_lshlrev_b32 v56, 16, v16
    v_and_b32 v57, 0xffff0000, v16
    v_lshlrev_b32 v58, 16, v17
    v_and_b32 v59, 0xffff0000, v17
    v_lshlrev_b32 v60, 16, v18
    v_and_b32 v61, 0xffff0000, v18
    v_lshlrev_b32 v62, 16, v19
    v_and_b32 v63, 0xffff0000, v19
    v_mov_b32 v64, 0
    v_mov_b32 v65, 0
    v_mov_b32 v66, 0
    v_mov_b32 v67, 0
    v_mov_b32 v68, 0
    v_mov_b32 v69, 0
    v_mov_b32 v70, 0
    v_mov_b32 v71, 0
    v_bfe_u32 v5, v0, 2, 2
    v_lshlrev_b32 v5, 8, v5
    v_lshrrev_b32 v8, 4, v0
    v_lshl_add_u32 v5, v8, 6, v5
    v_and_b32 v8, 3, v0
    v_lshl_add_u32 v5, v8, 4, v5
    s_lshl_b32 s56, s100, 10
    s_or_b32 s96, s59, s39
    s_cbranch_scc0 L_nofrag_107
    v_mov_b32 v104, 162060
L_lw_108:
    ds_read_b32 v105, v104
    s_waitcnt lgkmcnt(0)
    v_cmp_gt_u32 vcc, 4, v105
    s_cbranch_vccz L_lw_108e
    s_sleep 2
    s_sub_u32 s60, s60, 1
    s_cbranch_scc0 L_lw_108
    s_mov_b32 s60, 0
L_lw_108e:
    s_cmp_eq_u32 s59, 0
    s_cbranch_scc1 L_nofrag_107
    v_bfe_u32 v104, v0, 2, 1
    v_bfe_u32 v110, v0, 4, 1
    v_lshl_add_u32 v104, v110, 2, v104
    v_and_b32 v110, 8, v0
    v_add_u32 v104, v104, v110
    v_lshrrev_b32 v110, 5, v0
    v_lshl_add_u32 v104, v110, 4, v104
    v_bfe_u32 v111, v0, 0, 1
    v_mul_u32_u24 v111, 0xaaaa, v111
    v_add_u32 v111, 0x4444, v111
    v_mov_b32 v112, 0
    v_mov_b32 v113, 0
    v_mov_b32 v114, 0
    v_mov_b32 v115, 0
    v_mov_b32 v116, 0
    v_mov_b32 v117, 0
    v_mov_b32 v118, 0
    v_mov_b32 v119, 0
    v_lshlrev_b32 v104, 7, v104
    v_and_b32 v110, 3, v0
    v_lshl_add_u32 v104, v110, 3, v104
    v_lshrrev_b32 v109, 4, v0
    v_and_b32 v110, 1, v0
    s_lshr_b32 s63, s3, 1
    s_and_b32 s62, s3, 1
    s_lshl_b32 s96, s63, 14
    s_lshl_b32 s100, s62, 6
    s_add_u32 s100, s100, 81920
    s_add_u32 s96, s96, s100
    v_add_u32 v104, s96, v104
    ds_read_b64_tr_b16 v[72:73], v104 offset:0
    ds_read_b64_tr_b16 v[74:75], v104 offset:256
    ds_read_b64_tr_b16 v[76:77], v104 offset:4096
    ds_read_b64_tr_b16 v[78:79], v104 offset:4352
    ds_read_b64_tr_b16 v[80:81], v104 offset:32
    ds_read_b64_tr_b16 v[82:83], v104 offset:288
    ds_read_b64_tr_b16 v[84:85], v104 offset:4128
    ds_read_b64_tr_b16 v[86:87], v104 offset:4384
    ds_read_b64_tr_b16 v[88:89], v104 offset:8192
    ds_read_b64_tr_b16 v[90:91], v104 offset:8448
    ds_read_b64_tr_b16 v[92:93], v104 offset:12288
    ds_read_b64_tr_b16 v[94:95], v104 offset:12544
    ds_read_b64_tr_b16 v[96:97], v104 offset:8224
    ds_read_b64_tr_b16 v[98:99], v104 offset:8480
    ds_read_b64_tr_b16 v[100:101], v104 offset:12320
    ds_read_b64_tr_b16 v[102:103], v104 offset:12576
    v_bfe_u32 v105, v0, 1, 3
    v_lshlrev_b32 v105, 8, v105
    v_lshl_add_u32 v105, v109, 5, v105
    v_lshl_add_u32 v105, v110, 4, v105
    v_lshrrev_b32 v106, 3, v0
    v_lshlrev_b32 v106, 7, v106
    v_and_b32 v110, 7, v0
    v_lshl_add_u32 v107, v110, 3, v106
    v_add_u32 v107, s100, v107
    v_lshlrev_b32 v106, 8, v109
    v_and_b32 v110, 15, v0
    v_lshl_add_u32 v106, v110, 2, v106
    v_add_u32 v106, s96, v106
    v_lshlrev_b32 v108, 2, v0
    s_lshl_b32 s96, s62, 2
    s_add_u32 s96, s96, 162088
    v_mov_b32 v109, s96
    s_lshl_b32 s100, s63, 11
    s_lshl_b32 s96, s34, 13
    s_add_u32 s100, s100, s96
    s_add_u32 s100, s100, 106496
    s_mul_i32 s101, s34, 5120
    s_lshl_b32 s96, s35, 9
    s_add_u32 s101, s101, s96
    s_lshl_b32 s96, s62, 8
    s_add_u32 s101, s101, s96
    s_sub_u32 s101, s101, 11264
    s_and_b32 s96, s101, 0xffffe000
    s_add_u32 s101, s101, s96
    s_add_u32 s101, s101, 212992
    v_add_u32 v110, 8192, v108
L_nofrag_107:
    s_cmp_ge_u32 s35, 20
    s_cbranch_scc1 L_nofin_109
    s_lshl1_add_u32 s62, s35, s3
    s_sub_u32 s62, s62, 6
    s_lshl_b32 s57, s62, 7
    s_mul_i32 s63, s62, 0x199a
    s_lshr_b32 s63, s63, 16
    s_mul_i32 s63, s63, 1280
    s_sub_u32 s63, s57, s63
    v_lshrrev_b32 v72, 3, v0
    v_mul_u32_u24 v72, 5120, v72
    v_and_b32 v8, 7, v0
    v_lshl_add_u32 v72, v8, 4, v72
    s_add_u32 s62, s57, 327680
    v_add_u32 v72, s62, v72
    v_add_u32 v73, 40960, v72
    v_add_u32 v74, 81920, v72
    v_add_u32 v75, 122880, v72
    v_bfe_u32 v9, v0, 4, 1
    v_lshlrev_b32 v76, 4, v8
    v_lshl_add_u32 v76, v9, 3, v76
    s_lshl_b32 s62, s57, 1
    s_add_u32 s62, s62, 99328
    v_lshl_add_u32 v77, v76, 1, s62
    s_mov_b32 s48, s22
    s_mov_b32 s49, s23
    s_mov_b32 s50, 1280
    s_mov_b32 s51, 0x20000
    buffer_load_dwordx2 v[86:87], v76, s[48:51], s63 offen
    s_add_u32 s62, s57, 35840
    s_branch L_poll_110
L_poll_110s:
    s_sleep 32
L_poll_110:
    buffer_load_dwordx2 v[8:9], v76, s[40:43], s62 offen sc1
    s_sub_u32 s60, s60, 1
    s_cbranch_scc1 L_poll_110t
    s_waitcnt vmcnt(0)
    v_max_u32 v38, v8, v9
    v_cmp_eq_u32 vcc, -1, v38
    s_cbranch_vccnz L_poll_110s
L_poll_110e:
    v_lshlrev_b32 v78, 16, v86
    v_and_b32 v79, 0xffff0000, v86
    v_lshlrev_b32 v82, 16, v8
    v_and_b32 v83, 0xffff0000, v8
    v_lshlrev_b32 v80, 16, v87
    v_and_b32 v81, 0xffff0000, v87
    v_lshlrev_b32 v84, 16, v9
    v_and_b32 v85, 0xffff0000, v9
    v_bfe_u32 v8, v0, 1, 3
    v_and_b32 v9, 1, v0
    v_lshlrev_b32 v9, 4, v9
    v_mov_b32 v10, 0x3f80
    v_lshlrev_b32 v9, v9, v10
    v_cmp_eq_u32 vcc, 0, v8
    v_mov_b32 v100, 0
    s_nop 0
    v_cndmask_b32 v104, 0, v9, vcc
    v_cmp_eq_u32 vcc, 1, v8
    v_mov_b32 v101, 0
    s_nop 0
    v_cndmask_b32 v105, 0, v9, vcc
    v_cmp_eq_u32 vcc, 2, v8
    v_mov_b32 v102, 0
    s_nop 0
    v_cndmask_b32 v106, 0, v9, vcc
    v_cmp_eq_u32 vcc, 3, v8
    v_mov_b32 v103, 0
    s_nop 0
    v_cndmask_b32 v107, 0, v9, vcc
L_nofin_109:
    v_mov_b32 v12, 162076
L_lw_111:
    ds_read_b32 v13, v12
    s_waitcnt lgkmcnt(0)
    v_cmp_gt_u32 vcc, 4, v13
    s_cbranch_vccz L_lw_111e
    s_sleep 4
    s_sub_u32 s60, s60, 1
    s_cbranch_scc0 L_lw_111
    s_mov_b32 s60, 0
L_lw_111e:
    v_and_b32 v11, 31, v0
    v_lshlrev_b32 v11, 7, v11
    s_lshl_b32 s63, s34, 12
    s_add_u32 s63, s63, 73792
    buffer_load_dword v12, v39, s[40:43], s98 offen sc1
    s_branch L_poll_112
L_poll_112s:
    s_sleep 4
L_poll_112:
    buffer_load_dwordx2 v[8:9], v21, s[40:43], s99 offen sc1
    buffer_load_dword v10, v11, s[40:43], s63 offen sc1
    buffer_load_dwordx4 v[32:35], v20, s[40:43], s97 offen sc1
    s_sub_u32 s60, s60, 1
    s_cbranch_scc1 L_poll_112t
    s_waitcnt vmcnt(0)
    v_max3_u32 v38, v8, v9, v10
    v_max3_u32 v38, v38, v32, v33
    v_max3_u32 v38, v38, v34, v35
    v_cmp_eq_u32 vcc, -1, v38
    s_cbranch_vccnz L_poll_112s
L_poll_112e:
    v_mov_b32 v37, v8
    s_nop 1
    v_max_f32_dpp v37, v37, v37 quad_perm:[1,0,3,2] row_mask:0xf bank_mask:0xf
    s_nop 1
    v_max_f32_dpp v37, v37, v37 quad_perm:[2,3,0,1] row_mask:0xf bank_mask:0xf
    s_nop 1
    v_max_f32_dpp v37, v37, v37 row_ror:4 row_mask:0xf bank_mask:0xf
    s_nop 1
    v_max_f32_dpp v37, v37, v37 row_ror:8 row_mask:0xf bank_mask:0xf
    v_sub_f32 v8, v8, v37
    v_exp_f32 v8, v8
    s_nop 0
    v_mul_f32 v9, v8, v9
    s_nop 1
    v_add_f32_dpp v9, v9, v9 quad_perm:[1,0,3,2] row_mask:0xf bank_mask:0xf
    s_nop 1
    v_add_f32_dpp v9, v9, v9 quad_perm:[2,3,0,1] row_mask:0xf bank_mask:0xf
    s_nop 1
    v_add_f32_dpp v9, v9, v9 row_ror:4 row_mask:0xf bank_mask:0xf
    s_nop 1
    v_add_f32_dpp v9, v9, v9 row_ror:8 row_mask:0xf bank_mask:0xf
    v_ashrrev_i32 v12, 8, v10
    s_nop 1
    v_add_u32_dpp v12, v12, v12 quad_perm:[1,0,3,2] row_mask:0xf bank_mask:0xf
    s_nop 1
    v_add_u32_dpp v12, v12, v12 quad_perm:[2,3,0,1] row_mask:0xf bank_mask:0xf
    s_nop 1
    v_add_u32_dpp v12, v12, v12 row_ror:4 row_mask:0xf bank_mask:0xf
    s_nop 1
    v_add_u32_dpp v12, v12, v12 row_ror:8 row_mask:0xf bank_mask:0xf
    v_mov_b32 v13, v12
    s_nop 1
    v_permlane16_swap_b32 v12, v13
    v_add_u32 v12, v12, v13
    v_mov_b32 v13, v12
    s_nop 1
    v_permlane32_swap_b32 v12, v13
    v_add_u32 v12, v12, v13
    v_ashrrev_i32 v12, 31, v12
    v_and_b32 v12, 8192, v12
    v_mov_b32 v13, 162084
    ds_write_b32 v13, v12
    v_and_b32 v10, 0xff, v10
    s_getreg_b32 s62, hwreg(HW_REG_XCC_ID, 0, 4)
    v_cmp_ne_u32 vcc, s62, v10
    s_nop 0
    s_cmp_eq_u64 vcc, 0
    s_cselect_b32 s61, 1, 0
    v_rcp_f32 v9, v9
    v_lshrrev_b32 v3, 1, v2
    v_add_u32 v3, 161984, v3
    v_mul_f32 v8, v8, v9
    v_mov_b32 v10, 162072
    v_mov_b32 v11, s61
    ds_write_b32 v3, v8
    ds_write_b32 v10, v11
    s_branch L_pxj
L_px6:
    s_or_b32 s96, s59, s39
    s_cbranch_scc0 L_nofrag_113
    v_mov_b32 v104, 162060
L_lw_114:
    ds_read_b32 v105, v104
    s_waitcnt lgkmcnt(0)
    v_cmp_gt_u32 vcc, 4, v105
    s_cbranch_vccz L_lw_114e
    s_sleep 2
    s_sub_u32 s60, s60, 1
    s_cbranch_scc0 L_lw_114
    s_mov_b32 s60, 0
L_lw_114e:
    s_cmp_eq_u32 s59, 0
    s_cbranch_scc1 L_nofrag_113
    v_bfe_u32 v104, v0, 2, 1
    v_bfe_u32 v110, v0, 4, 1
    v_lshl_add_u32 v104, v110, 2, v104
    v_and_b32 v110, 8, v0
    v_add_u32 v104, v104, v110
    v_lshrrev_b32 v110, 5, v0
    v_lshl_add_u32 v104, v110, 4, v104
    v_bfe_u32 v111, v0, 0, 1
    v_mul_u32_u24 v111, 0xaaaa, v111
    v_add_u32 v111, 0x4444, v111
    v_mov_b32 v112, 0
    v_mov_b32 v113, 0
    v_mov_b32 v114, 0
    v_mov_b32 v115, 0
    v_mov_b32 v116, 0
    v_mov_b32 v117, 0
    v_mov_b32 v118, 0
    v_mov_b32 v119, 0
    v_lshlrev_b32 v104, 7, v104
    v_and_b32 v110, 3, v0
    v_lshl_add_u32 v104, v110, 3, v104
    v_lshrrev_b32 v109, 4, v0
    v_and_b32 v110, 1, v0
    s_lshr_b32 s63, s3, 1
    s_and_b32 s62, s3, 1
    s_lshl_b32 s96, s63, 14
    s_lshl_b32 s100, s62, 6
    s_add_u32 s100, s100, 81920
    s_add_u32 s96, s96, s100
    v_add_u32 v104, s96, v104
    ds_read_b64_tr_b16 v[72:73], v104 offset:0
    ds_read_b64_tr_b16 v[74:75], v104 offset:256
    ds_read_b64_tr_b16 v[76:77], v104 offset:4096
    ds_read_b64_tr_b16 v[78:79], v104 offset:4352
    ds_read_b64_tr_b16 v[80:81], v104 offset:32
    ds_read_b64_tr_b16 v[82:83], v104 offset:288
    ds_read_b64_tr_b16 v[84:85], v104 offset:4128
    ds_read_b64_tr_b16 v[86:87], v104 offset:4384
    ds_read_b64_tr_b16 v[88:89], v104 offset:8192
    ds_read_b64_tr_b16 v[90:91], v104 offset:8448
    ds_read_b64_tr_b16 v[92:93], v104 offset:12288
    ds_read_b64_tr_b16 v[94:95], v104 offset:12544
    ds_read_b64_tr_b16 v[96:97], v104 offset:8224
    ds_read_b64_tr_b16 v[98:99], v104 offset:8480
    ds_read_b64_tr_b16 v[100:101], v104 offset:12320
    ds_read_b64_tr_b16 v[102:103], v104 offset:12576
    v_bfe_u32 v105, v0, 1, 3
    v_lshlrev_b32 v105, 8, v105
    v_lshl_add_u32 v105, v109, 5, v105
    v_lshl_add_u32 v105, v110, 4, v105
    v_lshrrev_b32 v106, 3, v0
    v_lshlrev_b32 v106, 7, v106
    v_and_b32 v110, 7, v0
    v_lshl_add_u32 v107, v110, 3, v106
    v_add_u32 v107, s100, v107
    v_lshlrev_b32 v106, 8, v109
    v_and_b32 v110, 15, v0
    v_lshl_add_u32 v106, v110, 2, v106
    v_add_u32 v106, s96, v106
    v_lshlrev_b32 v108, 2, v0
    s_lshl_b32 s96, s62, 2
    s_add_u32 s96, s96, 162088
    v_mov_b32 v109, s96
    s_lshl_b32 s100, s63, 11
    s_lshl_b32 s96, s34, 13
    s_add_u32 s100, s100, s96
    s_add_u32 s100, s100, 106496
    s_mul_i32 s101, s34, 5120
    s_lshl_b32 s96, s35, 9
    s_add_u32 s101, s101, s96
    s_lshl_b32 s96, s62, 8
    s_add_u32 s101, s101, s96
    s_sub_u32 s101, s101, 11264
    s_and_b32 s96, s101, 0xffffe000
    s_add_u32 s101, s101, s96
    s_add_u32 s101, s101, 212992
    v_add_u32 v110, 8192, v108
L_nofrag_113:
    s_mov_b32 s62, 3
    s_lshl1_add_u32 s96, s35, s3
    s_and_b32 s63, s96, 7
    s_lshl_b32 s63, s63, 14
    s_lshl_b32 s96, s96, 7
    s_add_u32 s96, s96, s63
    s_add_u32 s96, s96, 475136
    s_add_u32 s98, s32, s96
    s_addc_u32 s99, s33, 0
    s_load_dword s4, s[98:99], 0 glc
    s_load_dword s5, s[98:99], 8192 glc
    s_mov_b32 s63, 0
    s_waitcnt lgkmcnt(0)
L_np:
    s_not_b32 s4, s4
    s_mov_b32 s6, s4
    s_mov_b32 s7, 0
    s_load_dword s4, s[98:99], 0 glc
L_npc0:
    s_add_u32 s7, s7, 1
    s_cmp_eq_u32 s4, s6
    s_cselect_b32 s8, s7, 1000
    s_cmp_lt_u32 s8, 60
    s_cbranch_scc1 L_npc0
    s_waitcnt lgkmcnt(0)
    s_sub_u32 s63, s63, s7
    s_not_b32 s5, s5
    s_mov_b32 s6, s5
    s_mov_b32 s7, 0
    s_load_dword s5, s[98:99], 8192 glc
L_npc1:
    s_add_u32 s7, s7, 1
    s_cmp_eq_u32 s5, s6
    s_cselect_b32 s8, s7, 1000
    s_cmp_lt_u32 s8, 60
    s_cbranch_scc1 L_npc1
    s_waitcnt lgkmcnt(0)
    s_add_u32 s63, s63, s7
    s_sub_u32 s62, s62, 1
    s_cmp_lg_u32 s62, 0
    s_cbranch_scc1 L_np
    v_mov_b32 v8, 162096
    v_mov_b32 v9, s63
    s_mov_b64 exec, 1
    ds_add_u32 v8, v9
    s_mov_b64 exec, -1
    v_mov_b32 v8, 162068
L_lw_115:
    ds_read_b32 v9, v8
    s_waitcnt lgkmcnt(0)
    v_cmp_gt_u32 vcc, 1, v9
    s_cbranch_vccz L_lw_115e
    s_sleep 32
    s_sub_u32 s60, s60, 1
    s_cbranch_scc0 L_lw_115
    s_mov_b32 s60, 0
L_lw_115e:
    s_cmp_ge_u32 s35, 20
    s_cbranch_scc1 L_nofin_116
    s_lshl1_add_u32 s62, s35, s3
    s_sub_u32 s62, s62, 6
    s_lshl_b32 s57, s62, 7
    s_mul_i32 s63, s62, 0x199a
    s_lshr_b32 s63, s63, 16
    s_mul_i32 s63, s63, 1280
    s_sub_u32 s63, s57, s63
    v_lshrrev_b32 v72, 3, v0
    v_mul_u32_u24 v72, 5120, v72
    v_and_b32 v8, 7, v0
    v_lshl_add_u32 v72, v8, 4, v72
    s_add_u32 s62, s57, 327680
    v_add_u32 v72, s62, v72
    v_add_u32 v73, 40960, v72
    v_add_u32 v74, 81920, v72
    v_add_u32 v75, 122880, v72
    v_bfe_u32 v9, v0, 4, 1
    v_lshlrev_b32 v76, 4, v8
    v_lshl_add_u32 v76, v9, 3, v76
    s_lshl_b32 s62, s57, 1
    s_add_u32 s62, s62, 99328
    v_lshl_add_u32 v77, v76, 1, s62
    s_mov_b32 s48, s22
    s_mov_b32 s49, s23
    s_mov_b32 s50, 1280
    s_mov_b32 s51, 0x20000
    buffer_load_dwordx2 v[86:87], v76, s[48:51], s63 offen
    s_add_u32 s62, s57, 35840
    s_branch L_poll_117
L_poll_117s:
    s_sleep 32
L_poll_117:
    buffer_load_dwordx2 v[8:9], v76, s[40:43], s62 offen sc1
    s_sub_u32 s60, s60, 1
    s_cbranch_scc1 L_poll_117t
    s_waitcnt vmcnt(0)
    v_max_u32 v38, v8, v9
    v_cmp_eq_u32 vcc, -1, v38
    s_cbranch_vccnz L_poll_117s
L_poll_117e:
    v_lshlrev_b32 v78, 16, v86
    v_and_b32 v79, 0xffff0000, v86
    v_lshlrev_b32 v82, 16, v8
    v_and_b32 v83, 0xffff0000, v8
    v_lshlrev_b32 v80, 16, v87
    v_and_b32 v81, 0xffff0000, v87
    v_lshlrev_b32 v84, 16, v9
    v_and_b32 v85, 0xffff0000, v9
    v_bfe_u32 v8, v0, 1, 3
    v_and_b32 v9, 1, v0
    v_lshlrev_b32 v9, 4, v9
    v_mov_b32 v10, 0x3f80
    v_lshlrev_b32 v9, v9, v10
    v_cmp_eq_u32 vcc, 0, v8
    v_mov_b32 v100, 0
    s_nop 0
    v_cndmask_b32 v104, 0, v9, vcc
    v_cmp_eq_u32 vcc, 1, v8
    v_mov_b32 v101, 0
    s_nop 0
    v_cndmask_b32 v105, 0, v9, vcc
    v_cmp_eq_u32 vcc, 2, v8
    v_mov_b32 v102, 0
    s_nop 0
    v_cndmask_b32 v106, 0, v9, vcc
    v_cmp_eq_u32 vcc, 3, v8
    v_mov_b32 v103, 0
    s_nop 0
    v_cndmask_b32 v107, 0, v9, vcc
L_nofin_116:
    v_mov_b32 v8, 162076
L_lw_118:
    ds_read_b32 v9, v8
    s_waitcnt lgkmcnt(0)
    v_cmp_gt_u32 vcc, 4, v9
    s_cbranch_vccz L_lw_118e
    s_sleep 16
    s_sub_u32 s60, s60, 1
    s_cbranch_scc0 L_lw_118
    s_mov_b32 s60, 0
L_lw_118e:
    s_branch L_poll_119
L_poll_119s:
    s_sleep 4
L_poll_119:
    buffer_load_dwordx4 v[32:35], v20, s[40:43], s97 offen sc1
    s_sub_u32 s60, s60, 1
    s_cbranch_scc1 L_poll_119t
    s_waitcnt vmcnt(0)
    v_max3_u32 v38, v32, v33, v34
    v_max_u32 v38, v38, v35
    v_cmp_eq_u32 vcc, -1, v38
    s_cbranch_vccnz L_poll_119s
L_poll_119e:
L_pxj:
    s_cmp_ge_u32 s35, 20
    s_cbranch_scc1 L_pxk
    buffer_load_dwordx4 v[88:91], v72, s[40:43], 0 offen sc1
    buffer_load_dwordx4 v[92:95], v73, s[40:43], 0 offen sc1
    buffer_load_dwordx4 v[96:99], v74, s[40:43], 0 offen sc1
    s_mov_b64 exec, 0xffffff
    buffer_load_dwordx4 v[100:103], v75, s[40:43], 0 offen sc1
    s_mov_b64 exec, -1
L_pxk:
    v_mov_b32 v8, 162048
L_lw_120:
    ds_read_b32 v9, v8
    s_waitcnt lgkmcnt(0)
    v_cmp_gt_u32 vcc, 3, v9
    s_cbranch_vccz L_lw_120e
    s_sleep 2
    s_sub_u32 s60, s60, 1
    s_cbranch_scc0 L_lw_120
    s_mov_b32 s60, 0
L_lw_120e:
    v_lshrrev_b32 v9, 4, v0
    v_lshl_add_u32 v8, v9, 2, v2
    s_lshl_b32 s96, s3, 9
    s_add_u32 s96, s96, 157824
    v_lshl_add_u32 v8, v8, 2, s96
    v_lshlrev_b32 v9, 3, v0
    v_add_u32 v9, 157824, v9
    v_mov_b32 v10, 162048
    v_mov_b32 v11, 1
    s_lshl_b32 s96, s38, 5
    s_add_u32 s96, s96, 161984
    v_mov_b32 v3, s96
    s_sub_u32 s62, 8, s39
    s_lshl_b32 s98, s34, 5
    s_add_u32 s98, s98, s35
    s_lshl_b32 s98, s98, 8
    s_add_u32 s98, s98, 106496
    v_lshlrev_b32 v39, 2, v0
    s_branch L_t0
L_s_role:
    s_cmp_eq_u32 s3, 7
    s_cbranch_scc1 L_t2gate
    s_cmp_gt_u32 s3, 3
    s_cbranch_scc1 L_fin_prep
    s_mov_b32 s48, s18
    s_mov_b32 s49, s19
    s_mov_b32 s50, 3456
    s_mov_b32 s51, 0x20000
    v_lshrrev_b32 v3, 4, v0
    v_and_b32 v4, 15, v0
    v_lshlrev_b32 v4, 1, v4
    s_lshl_b32 s62, s35, 7
    s_lshl_b32 s63, s3, 5
    s_add_u32 s62, s62, s63
    buffer_load_ushort v82, v4, s[48:51], s62 offen
    v_mov_b32 v72, 162064
L_lw_121:
    ds_read_b32 v73, v72
    s_waitcnt lgkmcnt(0)
    v_cmp_gt_u32 vcc, 4, v73
    s_cbranch_vccz L_lw_121e
    s_sleep 2
    s_sub_u32 s60, s60, 1
    s_cbranch_scc0 L_lw_121
    s_mov_b32 s60, 0
L_lw_121e:
    v_bfe_u32 v72, v0, 2, 1
    v_bfe_u32 v73, v0, 4, 1
    v_lshl_add_u32 v72, v73, 2, v72
    v_and_b32 v73, 8, v0
    v_add_u32 v72, v72, v73
    v_lshrrev_b32 v73, 5, v0
    v_lshl_add_u32 v72, v73, 4, v72
    v_lshlrev_b32 v72, 7, v72
    v_and_b32 v73, 3, v0
    v_lshl_add_u32 v72, v73, 3, v72
    v_and_b32 v73, 8, v0
    v_lshl_add_u32 v72, v73, 3, v72
    v_xor_b32 v72, s63, v72
    v_xor_b32 v73, 32, v72
    v_add_u32 v74, 40960, v72
    v_add_u32 v75, 40960, v73
    v_bfe_u32 v1, v0, 2, 2
    v_bfe_u32 v2, v0, 1, 1
    v_and_b32 v6, 1, v0
    v_lshlrev_b32 v7, 5, v3
    v_lshl_add_u32 v7, v6, 4, v7
    v_lshl_add_u32 v5, v2, 2, v1
    v_mul_u32_u24 v5, 1296, v5
    v_add_u32 v5, v5, v7
    v_add_u32 v5, 147456, v5
    v_bfe_u32 v87, v0, 0, 1
    v_mul_u32_u24 v87, 0xaaaa, v87
    v_add_u32 v87, 0x4444, v87
    ds_read_b64_tr_b16 v[88:89], v72 offset:0
    ds_read_b64_tr_b16 v[90:91], v73 offset:256
    ds_read_b64_tr_b16 v[92:93], v72 offset:4096
    ds_read_b64_tr_b16 v[94:95], v73 offset:4352
    ds_read_b64_tr_b16 v[96:97], v72 offset:8192
    ds_read_b64_tr_b16 v[98:99], v73 offset:8448
    ds_read_b64_tr_b16 v[100:101], v72 offset:12288
    ds_read_b64_tr_b16 v[102:103], v73 offset:12544
    ds_read_b64_tr_b16 v[104:105], v72 offset:16384
    ds_read_b64_tr_b16 v[106:107], v73 offset:16640
    ds_read_b64_tr_b16 v[108:109], v72 offset:20480
    ds_read_b64_tr_b16 v[110:111], v73 offset:20736
    ds_read_b64_tr_b16 v[112:113], v72 offset:24576
    ds_read_b64_tr_b16 v[114:115], v73 offset:24832
    ds_read_b64_tr_b16 v[116:117], v72 offset:28672
    ds_read_b64_tr_b16 v[118:119], v73 offset:28928
    ds_read_b64_tr_b16 v[120:121], v72 offset:32768
    ds_read_b64_tr_b16 v[122:123], v73 offset:33024
    ds_read_b64_tr_b16 v[124:125], v72 offset:36864
    ds_read_b64_tr_b16 v[126:127], v73 offset:37120
    ds_read_b64_tr_b16 v[128:129], v74 offset:0
    ds_read_b64_tr_b16 v[130:131], v75 offset:256
    ds_read_b64_tr_b16 v[132:133], v74 offset:4096
    ds_read_b64_tr_b16 v[134:135], v75 offset:4352
    ds_read_b64_tr_b16 v[136:137], v74 offset:8192
    ds_read_b64_tr_b16 v[138:139], v75 offset:8448
    ds_read_b64_tr_b16 v[140:141], v74 offset:12288
    ds_read_b64_tr_b16 v[142:143], v75 offset:12544
    ds_read_b64_tr_b16 v[144:145], v74 offset:16384
    ds_read_b64_tr_b16 v[146:147], v75 offset:16640
    ds_read_b64_tr_b16 v[148:149], v74 offset:20480
    ds_read_b64_tr_b16 v[150:151], v75 offset:20736
    ds_read_b64_tr_b16 v[152:153], v74 offset:24576
    ds_read_b64_tr_b16 v[154:155], v75 offset:24832
    ds_read_b64_tr_b16 v[156:157], v74 offset:28672
    ds_read_b64_tr_b16 v[158:159], v75 offset:28928
    ds_read_b64_tr_b16 v[160:161], v74 offset:32768
    ds_read_b64_tr_b16 v[162:163], v75 offset:33024
    ds_read_b64_tr_b16 v[164:165], v74 offset:36864
    ds_read_b64_tr_b16 v[166:167], v75 offset:37120
    ds_read_b128 v[8:11], v5 offset:0
    ds_read_b128 v[12:15], v5 offset:128
    ds_read_b128 v[16:19], v5 offset:256
    ds_read_b128 v[20:23], v5 offset:384
    ds_read_b128 v[24:27], v5 offset:512
    ds_read_b128 v[28:31], v5 offset:640
    ds_read_b128 v[32:35], v5 offset:768
    ds_read_b128 v[36:39], v5 offset:896
    ds_read_b128 v[40:43], v5 offset:1024
    ds_read_b128 v[44:47], v5 offset:1152
    v_mov_b32 v48, 0
    v_mov_b32 v49, 0
    v_mov_b32 v50, 0
    v_mov_b32 v51, 0
    v_mov_b32 v52, 0
    v_mov_b32 v53, 0
    v_mov_b32 v54, 0
    v_mov_b32 v55, 0
    v_mov_b32 v56, 0
    v_mov_b32 v57, 0
    v_mov_b32 v58, 0
    v_mov_b32 v59, 0
    s_waitcnt lgkmcnt(9)
    v_smfmac_f32_16x16x64_bf16 v[48:51], v[8:11], v[88:95], v87
    s_waitcnt lgkmcnt(8)
    v_smfmac_f32_16x16x64_bf16 v[48:51], v[12:15], v[96:103], v87
    s_waitcnt lgkmcnt(7)
    v_smfmac_f32_16x16x64_bf16 v[48:51], v[16:19], v[104:111], v87
    s_waitcnt lgkmcnt(6)
    v_smfmac_f32_16x16x64_bf16 v[48:51], v[20:23], v[112:119], v87
    s_waitcnt lgkmcnt(5)
    v_smfmac_f32_16x16x64_bf16 v[48:51], v[24:27], v[120:127], v87
    s_waitcnt lgkmcnt(4)
    v_smfmac_f32_16x16x64_bf16 v[48:51], v[28:31], v[128:135], v87
    s_waitcnt lgkmcnt(3)
    v_smfmac_f32_16x16x64_bf16 v[48:51], v[32:35], v[136:143], v87
    s_waitcnt lgkmcnt(2)
    v_smfmac_f32_16x16x64_bf16 v[48:51], v[36:39], v[144:151], v87
    s_waitcnt lgkmcnt(1)
    v_smfmac_f32_16x16x64_bf16 v[48:51], v[40:43], v[152:159], v87
    s_waitcnt lgkmcnt(0)
    v_smfmac_f32_16x16x64_bf16 v[48:51], v[44:47], v[160:167], v87
    v_mul_u32_u24 v79, 1296, v1
    v_lshl_add_u32 v79, v2, 7, v79
    v_add_u32 v79, v79, v7
    v_add_u32 v79, 82944, v79
    v_mul_u32_u24 v80, 144, v3
    v_add3_u32 v80, v80, v4, s63
    v_add_u32 v80, 90688, v80
    v_lshlrev_b32 v81, 3, v0
    v_add_u32 v81, 88128, v81
    v_add_f32 v84, v48, v49
    v_add_f32 v85, v50, v51
    s_mov_b32 s62, 0xbacccccd
    s_mov_b32 s63, 0xbdd2d3e8
    v_mov_b32 v86, 0xc0135761
    s_waitcnt vmcnt(0)
    v_lshlrev_b32 v82, 16, v82
    v_add_f32 v85, v85, v82
    s_branch L_ffn1
L_fin_prep:
    s_cmp_lg_u32 s3, 6
    s_cbranch_scc1 L_end
    s_cmp_ge_u32 s35, 20
    s_cbranch_scc1 L_end
    s_barrier
L_fin:
    s_mov_b32 s52, s28
    s_mov_b32 s53, s29
    s_mov_b32 s54, 5120
    s_mov_b32 s55, 0x20000
    s_mov_b64 s[4:5], -1
    s_mov_b64 s[6:7], -1
    s_mov_b64 s[8:9], -1
    s_mov_b64 s[10:11], 0xffffff
    s_barrier
    ds_read_b128 v[108:111], v77
    s_barrier
L_yg:
    s_mov_b64 exec, s[4:5]
    buffer_load_dwordx4 v[88:91], v72, s[40:43], 0 offen sc1
    s_mov_b64 exec, s[6:7]
    buffer_load_dwordx4 v[92:95], v73, s[40:43], 0 offen sc1
    s_mov_b64 exec, s[8:9]
    buffer_load_dwordx4 v[96:99], v74, s[40:43], 0 offen sc1
    s_mov_b64 exec, s[10:11]
    buffer_load_dwordx4 v[100:103], v75, s[40:43], 0 offen sc1
    s_mov_b64 exec, -1
    s_sub_u32 s60, s60, 1
    s_cbranch_scc1 L_ygt
    s_waitcnt vmcnt(3)
    v_max3_u32 v3, v88, v89, v90
    v_max_u32 v3, v3, v91
    v_cmp_eq_u32 s[4:5], -1, v3
    s_waitcnt vmcnt(2)
    v_max3_u32 v3, v92, v93, v94
    v_max_u32 v3, v3, v95
    v_cmp_eq_u32 s[6:7], -1, v3
    s_waitcnt vmcnt(1)
    v_max3_u32 v3, v96, v97, v98
    v_max_u32 v3, v3, v99
    v_cmp_eq_u32 s[8:9], -1, v3
    s_waitcnt vmcnt(0)
    v_max3_u32 v3, v100, v101, v102
    v_max_u32 v3, v3, v103
    v_cmp_eq_u32 s[10:11], -1, v3
    s_or_b64 s[16:17], s[4:5], s[6:7]
    s_or_b64 s[16:17], s[16:17], s[8:9]
    s_or_b64 s[16:17], s[16:17], s[10:11]
    s_cbranch_scc1 L_yg
L_ygd:
    v_mfma_f32_16x16x32_bf16 v[112:115], v[104:107], v[88:91], 0
    v_mfma_f32_16x16x32_bf16 v[112:115], v[104:107], v[92:95], v[112:115]
    v_mfma_f32_16x16x32_bf16 v[112:115], v[104:107], v[96:99], v[112:115]
    v_mfma_f32_16x16x32_bf16 v[112:115], v[104:107], v[100:103], v[112:115]
    s_waitcnt lgkmcnt(0)
    v_pk_fma_f32 v[108:109], v[78:79], v[82:83], v[108:109]
    v_pk_fma_f32 v[110:111], v[80:81], v[84:85], v[110:111]
    s_nop 4
    v_add_f32_dpp v112, v112, v112 row_ror:8 row_mask:0xf bank_mask:0xf
    v_add_f32_dpp v113, v113, v113 row_ror:8 row_mask:0xf bank_mask:0xf
    v_add_f32_dpp v114, v114, v114 row_ror:8 row_mask:0xf bank_mask:0xf
    v_add_f32_dpp v115, v115, v115 row_ror:8 row_mask:0xf bank_mask:0xf
    v_pk_fma_f32 v[112:113], v[112:113], v[82:83], v[108:109]
    v_pk_fma_f32 v[114:115], v[114:115], v[84:85], v[110:111]
    v_cvt_pk_bf16_f32 v112, v112, v113
    v_cvt_pk_bf16_f32 v113, v114, v115
    s_mov_b64 exec, 0x00ff00ff
    buffer_store_dwordx2 v[112:113], v76, s[52:55], s57 offen
    s_endpgm
L_t2gate:
    v_mov_b32 v8, 162048
L_lw_122:
    ds_read_b32 v9, v8
    s_waitcnt lgkmcnt(0)
    v_cmp_gt_u32 vcc, 8, v9
    s_cbranch_vccz L_lw_122e
    s_sleep 2
    s_sub_u32 s60, s60, 1
    s_cbranch_scc0 L_lw_122
    s_mov_b32 s60, 0
L_lw_122e:
    ds_read_b32 v9, v8 offset:24
    ds_read_b32 v10, v8 offset:36
    v_add_u32 v5, 212992, v5
    s_waitcnt lgkmcnt(0)
    v_readfirstlane_b32 s61, v9
    v_add_u32 v5, v5, v10
    s_mov_b32 s58, 0x3f80
    s_mov_b32 s59, 0x3f800000
    s_mov_b32 s63, 0xff
L_prb:
    s_bcnt1_i32_b32 s62, s63
    s_mov_b32 s97, s63
    s_ff1_i32_b32 s12, s97
    s_bitset0_b32 s97, s12
    s_mul_i32 s4, s12, 5120
    s_add_u32 s4, s4, s56
    s_and_b32 s96, s4, 0xffffe000
    s_add_u32 s4, s4, s96
    s_cmp_eq_u32 s62, 1
    s_cbranch_scc1 L_pi1
    s_ff1_i32_b32 s13, s97
    s_bitset0_b32 s97, s13
    s_mul_i32 s5, s13, 5120
    s_add_u32 s5, s5, s56
    s_and_b32 s96, s5, 0xffffe000
    s_add_u32 s5, s5, s96
    s_cmp_eq_u32 s62, 2
    s_cbranch_scc1 L_pi2
    s_ff1_i32_b32 s14, s97
    s_bitset0_b32 s97, s14
    s_mul_i32 s6, s14, 5120
    s_add_u32 s6, s6, s56
    s_and_b32 s96, s6, 0xffffe000
    s_add_u32 s6, s6, s96
    s_cmp_eq_u32 s62, 3
    s_cbranch_scc1 L_pi3
    s_ff1_i32_b32 s15, s97
    s_bitset0_b32 s97, s15
    s_mul_i32 s7, s15, 5120
    s_add_u32 s7, s7, s56
    s_and_b32 s96, s7, 0xffffe000
    s_add_u32 s7, s7, s96
    s_cmp_eq_u32 s62, 4
    s_cbranch_scc1 L_pi4
    s_ff1_i32_b32 s16, s97
    s_bitset0_b32 s97, s16
    s_mul_i32 s8, s16, 5120
    s_add_u32 s8, s8, s56
    s_and_b32 s96, s8, 0xffffe000
    s_add_u32 s8, s8, s96
    s_cmp_eq_u32 s62, 5
    s_cbranch_scc1 L_pi5
    s_ff1_i32_b32 s17, s97
    s_bitset0_b32 s97, s17
    s_mul_i32 s9, s17, 5120
    s_add_u32 s9, s9, s56
    s_and_b32 s96, s9, 0xffffe000
    s_add_u32 s9, s9, s96
    s_cmp_eq_u32 s62, 6
    s_cbranch_scc1 L_pi6
    s_ff1_i32_b32 s18, s97
    s_bitset0_b32 s97, s18
    s_mul_i32 s10, s18, 5120
    s_add_u32 s10, s10, s56
    s_and_b32 s96, s10, 0xffffe000
    s_add_u32 s10, s10, s96
    s_cmp_eq_u32 s62, 7
    s_cbranch_scc1 L_pi7
    s_ff1_i32_b32 s19, s97
    s_bitset0_b32 s97, s19
    s_mul_i32 s11, s19, 5120
    s_add_u32 s11, s11, s56
    s_and_b32 s96, s11, 0xffffe000
    s_add_u32 s11, s11, s96
L_pi8:
    buffer_load_dwordx4 v[36:39], v5, s[40:43], s11 offen sc1
L_pi7:
    buffer_load_dwordx4 v[32:35], v5, s[40:43], s10 offen sc1
L_pi6:
    buffer_load_dwordx4 v[28:31], v5, s[40:43], s9 offen sc1
L_pi5:
    buffer_load_dwordx4 v[24:27], v5, s[40:43], s8 offen sc1
L_pi4:
    buffer_load_dwordx4 v[20:23], v5, s[40:43], s7 offen sc1
L_pi3:
    buffer_load_dwordx4 v[16:19], v5, s[40:43], s6 offen sc1
L_pi2:
    buffer_load_dwordx4 v[12:15], v5, s[40:43], s5 offen sc1
    buffer_load_dwordx4 v[8:11], v5, s[40:43], s4 offen sc1
    s_sub_u32 s60, s60, 1
    s_cbranch_scc1 L_pto
    s_waitcnt vmcnt(0)
    v_max3_u32 v3, v8, v9, v10
    v_max_u32 v3, v3, v11
    v_cmp_eq_u32 vcc, -1, v3
    s_cbranch_vccz L_pgot0
    v_max3_u32 v3, v12, v13, v14
    v_max_u32 v3, v3, v15
    v_cmp_eq_u32 vcc, -1, v3
    s_cbranch_vccz L_pgot1
    s_cmp_eq_u32 s62, 2
    s_cbranch_scc1 L_pi2
    v_max3_u32 v3, v16, v17, v18
    v_max_u32 v3, v3, v19
    v_cmp_eq_u32 vcc, -1, v3
    s_cbranch_vccz L_pgot2
    s_cmp_eq_u32 s62, 3
    s_cbranch_scc1 L_pi3
    v_max3_u32 v3, v20, v21, v22
    v_max_u32 v3, v3, v23
    v_cmp_eq_u32 vcc, -1, v3
    s_cbranch_vccz L_pgot3
    s_cmp_eq_u32 s62, 4
    s_cbranch_scc1 L_pi4
    v_max3_u32 v3, v24, v25, v26
    v_max_u32 v3, v3, v27
    v_cmp_eq_u32 vcc, -1, v3
    s_cbranch_vccz L_pgot4
    s_cmp_eq_u32 s62, 5
    s_cbranch_scc1 L_pi5
    v_max3_u32 v3, v28, v29, v30
    v_max_u32 v3, v3, v31
    v_cmp_eq_u32 vcc, -1, v3
    s_cbranch_vccz L_pgot5
    s_cmp_eq_u32 s62, 6
    s_cbranch_scc1 L_pi6
    v_max3_u32 v3, v32, v33, v34
    v_max_u32 v3, v3, v35
    v_cmp_eq_u32 vcc, -1, v3
    s_cbranch_vccz L_pgot6
    s_cmp_eq_u32 s62, 7
    s_cbranch_scc1 L_pi7
    v_max3_u32 v3, v36, v37, v38
    v_max_u32 v3, v3, v39
    v_cmp_eq_u32 vcc, -1, v3
    s_cbranch_vccz L_pgot7
    s_branch L_pi8
L_pgot0:
    v_dot2c_f32_bf16 v64, s58, v8
    v_dot2c_f32_bf16 v65, s59, v8
    v_dot2c_f32_bf16 v66, s58, v9
    v_dot2c_f32_bf16 v67, s59, v9
    v_dot2c_f32_bf16 v68, s58, v10
    v_dot2c_f32_bf16 v69, s59, v10
    v_dot2c_f32_bf16 v70, s58, v11
    v_dot2c_f32_bf16 v71, s59, v11
    s_bitset0_b32 s63, s12
    s_cmp_eq_u32 s63, 0
    s_cbranch_scc1 L_pgd
L_pn0:
    s_cmp_eq_u32 s62, 1
    s_cbranch_scc1 L_prb
    v_max3_u32 v3, v12, v13, v14
    v_max_u32 v3, v3, v15
    v_cmp_eq_u32 vcc, -1, v3
    s_cbranch_vccnz L_pn1
L_pgot1:
    v_dot2c_f32_bf16 v64, s58, v12
    v_dot2c_f32_bf16 v65, s59, v12
    v_dot2c_f32_bf16 v66, s58, v13
    v_dot2c_f32_bf16 v67, s59, v13
    v_dot2c_f32_bf16 v68, s58, v14
    v_dot2c_f32_bf16 v69, s59, v14
    v_dot2c_f32_bf16 v70, s58, v15
    v_dot2c_f32_bf16 v71, s59, v15
    s_bitset0_b32 s63, s13
    s_cmp_eq_u32 s63, 0
    s_cbranch_scc1 L_pgd
L_pn1:
    s_cmp_eq_u32 s62, 2
    s_cbranch_scc1 L_prb
    v_max3_u32 v3, v16, v17, v18
    v_max_u32 v3, v3, v19
    v_cmp_eq_u32 vcc, -1, v3
    s_cbranch_vccnz L_pn2
L_pgot2:
    v_dot2c_f32_bf16 v64, s58, v16
    v_dot2c_f32_bf16 v65, s59, v16
    v_dot2c_f32_bf16 v66, s58, v17
    v_dot2c_f32_bf16 v67, s59, v17
    v_dot2c_f32_bf16 v68, s58, v18
    v_dot2c_f32_bf16 v69, s59, v18
    v_dot2c_f32_bf16 v70, s58, v19
    v_dot2c_f32_bf16 v71, s59, v19
    s_bitset0_b32 s63, s14
    s_cmp_eq_u32 s63, 0
    s_cbranch_scc1 L_pgd
L_pn2:
    s_cmp_eq_u32 s62, 3
    s_cbranch_scc1 L_prb
    v_max3_u32 v3, v20, v21, v22
    v_max_u32 v3, v3, v23
    v_cmp_eq_u32 vcc, -1, v3
    s_cbranch_vccnz L_pn3
L_pgot3:
    v_dot2c_f32_bf16 v64, s58, v20
    v_dot2c_f32_bf16 v65, s59, v20
    v_dot2c_f32_bf16 v66, s58, v21
    v_dot2c_f32_bf16 v67, s59, v21
    v_dot2c_f32_bf16 v68, s58, v22
    v_dot2c_f32_bf16 v69, s59, v22
    v_dot2c_f32_bf16 v70, s58, v23
    v_dot2c_f32_bf16 v71, s59, v23
    s_bitset0_b32 s63, s15
    s_cmp_eq_u32 s63, 0
    s_cbranch_scc1 L_pgd
L_pn3:
    s_cmp_eq_u32 s62, 4
    s_cbranch_scc1 L_prb
    v_max3_u32 v3, v24, v25, v26
    v_max_u32 v3, v3, v27
    v_cmp_eq_u32 vcc, -1, v3
    s_cbranch_vccnz L_pn4
L_pgot4:
    v_dot2c_f32_bf16 v64, s58, v24
    v_dot2c_f32_bf16 v65, s59, v24
    v_dot2c_f32_bf16 v66, s58, v25
    v_dot2c_f32_bf16 v67, s59, v25
    v_dot2c_f32_bf16 v68, s58, v26
    v_dot2c_f32_bf16 v69, s59, v26
    v_dot2c_f32_bf16 v70, s58, v27
    v_dot2c_f32_bf16 v71, s59, v27
    s_bitset0_b32 s63, s16
    s_cmp_eq_u32 s63, 0
    s_cbranch_scc1 L_pgd
L_pn4:
    s_cmp_eq_u32 s62, 5
    s_cbranch_scc1 L_prb
    v_max3_u32 v3, v28, v29, v30
    v_max_u32 v3, v3, v31
    v_cmp_eq_u32 vcc, -1, v3
    s_cbranch_vccnz L_pn5
L_pgot5:
    v_dot2c_f32_bf16 v64, s58, v28
    v_dot2c_f32_bf16 v65, s59, v28
    v_dot2c_f32_bf16 v66, s58, v29
    v_dot2c_f32_bf16 v67, s59, v29
    v_dot2c_f32_bf16 v68, s58, v30
    v_dot2c_f32_bf16 v69, s59, v30
    v_dot2c_f32_bf16 v70, s58, v31
    v_dot2c_f32_bf16 v71, s59, v31
    s_bitset0_b32 s63, s17
    s_cmp_eq_u32 s63, 0
    s_cbranch_scc1 L_pgd
L_pn5:
    s_cmp_eq_u32 s62, 6
    s_cbranch_scc1 L_prb
    v_max3_u32 v3, v32, v33, v34
    v_max_u32 v3, v3, v35
    v_cmp_eq_u32 vcc, -1, v3
    s_cbranch_vccnz L_pn6
L_pgot6:
    v_dot2c_f32_bf16 v64, s58, v32
    v_dot2c_f32_bf16 v65, s59, v32
    v_dot2c_f32_bf16 v66, s58, v33
    v_dot2c_f32_bf16 v67, s59, v33
    v_dot2c_f32_bf16 v68, s58, v34
    v_dot2c_f32_bf16 v69, s59, v34
    v_dot2c_f32_bf16 v70, s58, v35
    v_dot2c_f32_bf16 v71, s59, v35
    s_bitset0_b32 s63, s18
    s_cmp_eq_u32 s63, 0
    s_cbranch_scc1 L_pgd
L_pn6:
    s_cmp_eq_u32 s62, 7
    s_cbranch_scc1 L_prb
    v_max3_u32 v3, v36, v37, v38
    v_max_u32 v3, v3, v39
    v_cmp_eq_u32 vcc, -1, v3
    s_cbranch_vccnz L_pn7
L_pgot7:
    v_dot2c_f32_bf16 v64, s58, v36
    v_dot2c_f32_bf16 v65, s59, v36
    v_dot2c_f32_bf16 v66, s58, v37
    v_dot2c_f32_bf16 v67, s59, v37
    v_dot2c_f32_bf16 v68, s58, v38
    v_dot2c_f32_bf16 v69, s59, v38
    v_dot2c_f32_bf16 v70, s58, v39
    v_dot2c_f32_bf16 v71, s59, v39
    s_bitset0_b32 s63, s19
    s_cmp_eq_u32 s63, 0
    s_cbranch_scc1 L_pgd
L_pn7:
    s_branch L_prb
L_pi1:
L_poll_123:
    buffer_load_dwordx4 v[8:11], v5, s[40:43], s4 offen sc1
    s_sub_u32 s60, s60, 1
    s_cbranch_scc1 L_poll_123t
    s_waitcnt vmcnt(0)
    v_max3_u32 v3, v8, v9, v10
    v_max_u32 v3, v3, v11
    v_cmp_eq_u32 vcc, -1, v3
    s_cbranch_vccnz L_poll_123
L_poll_123e:
    v_dot2c_f32_bf16 v64, s58, v8
    v_dot2c_f32_bf16 v65, s59, v8
    v_dot2c_f32_bf16 v66, s58, v9
    v_dot2c_f32_bf16 v67, s59, v9
    v_dot2c_f32_bf16 v68, s58, v10
    v_dot2c_f32_bf16 v69, s59, v10
    v_dot2c_f32_bf16 v70, s58, v11
    v_dot2c_f32_bf16 v71, s59, v11
L_pgd:
    v_pk_fma_f32 v[64:65], v[64:65], v[48:49], v[40:41]
    v_pk_fma_f32 v[66:67], v[66:67], v[50:51], v[42:43]
    v_pk_fma_f32 v[68:69], v[68:69], v[52:53], v[44:45]
    v_pk_fma_f32 v[70:71], v[70:71], v[54:55], v[46:47]
    v_pk_mul_f32 v[56:57], v[64:65], v[56:57]
    v_pk_mul_f32 v[58:59], v[66:67], v[58:59]
    v_pk_mul_f32 v[60:61], v[68:69], v[60:61]
    v_pk_mul_f32 v[62:63], v[70:71], v[62:63]
    v_cvt_pk_bf16_f32 v8, v56, v57
    v_cvt_pk_bf16_f32 v9, v58, v59
    v_cvt_pk_bf16_f32 v10, v60, v61
    v_cvt_pk_bf16_f32 v11, v62, v63
    ds_write_b128 v4, v[8:11]
    v_pk_add_f32 v[40:41], v[64:65], v[66:67]
    v_pk_add_f32 v[42:43], v[68:69], v[70:71]
    v_pk_mul_f32 v[44:45], v[64:65], v[64:65]
    v_pk_mul_f32 v[46:47], v[66:67], v[66:67]
    v_pk_add_f32 v[40:41], v[40:41], v[42:43]
    v_pk_fma_f32 v[44:45], v[68:69], v[68:69], v[44:45]
    v_pk_fma_f32 v[46:47], v[70:71], v[70:71], v[46:47]
    v_add_f32 v40, v40, v41
    v_pk_add_f32 v[44:45], v[44:45], v[46:47]
    v_add_f32 v41, v44, v45
    ds_write_b64 v7, v[40:41]
    s_waitcnt lgkmcnt(0)
    s_barrier
    v_mov_b32 v16, 0
    v_mov_b32 v17, 0
    v_mov_b32 v18, 0
    v_mov_b32 v19, 0
    v_mov_b32 v20, 0
    v_mov_b32 v21, 0
    v_mov_b32 v22, 0
    v_mov_b32 v23, 0
    v_mov_b32 v24, 0
    v_mov_b32 v25, 0
    v_mov_b32 v26, 0
    v_mov_b32 v27, 0
    v_mov_b32 v28, 0
    v_mov_b32 v29, 0
    v_mov_b32 v30, 0
    v_mov_b32 v31, 0
    v_mov_b32 v32, 0
    v_mov_b32 v33, 0
    v_mov_b32 v34, 0
    v_mov_b32 v35, 0
    ds_write_b128 v6, v[64:67]
    ds_write_b128 v6, v[68:71] offset:16
    s_waitcnt lgkmcnt(0)
    s_cmp_lg_u32 s3, 7
    s_cbranch_scc1 L_ffn2
    s_cmp_lt_u32 s35, 20
    s_cbranch_scc1 L_fin
    s_endpgm
L_ffn1:
    s_barrier
L_ffn1b:
    ds_read_b128 v[8:11], v79
    ds_read_b64 v[30:31], v81 offset:0
    ds_read_b64 v[32:33], v81 offset:512
    ds_read_b64 v[34:35], v81 offset:1024
    ds_read_b64 v[36:37], v81 offset:1536
    ds_read_b64 v[38:39], v81 offset:2048
    ds_read_b128 v[12:15], v79 offset:256
    ds_read_b128 v[16:19], v79 offset:512
    ds_read_b128 v[20:23], v79 offset:768
    ds_read_b128 v[24:27], v79 offset:1024
    s_waitcnt lgkmcnt(9)
    v_smfmac_f32_16x16x64_bf16 v[52:55], v[8:11], v[88:95], v87
    v_smfmac_f32_16x16x64_bf16 v[56:59], v[8:11], v[96:103], v87
    s_waitcnt lgkmcnt(3)
    v_smfmac_f32_16x16x64_bf16 v[52:55], v[12:15], v[104:111], v87
    v_pk_add_f32 v[30:31], v[30:31], v[32:33]
    v_pk_add_f32 v[34:35], v[34:35], v[36:37]
    v_smfmac_f32_16x16x64_bf16 v[56:59], v[12:15], v[112:119], v87
    v_pk_add_f32 v[30:31], v[30:31], v[38:39]
    v_pk_add_f32 v[30:31], v[30:31], v[34:35]
    s_nop 0
    s_waitcnt lgkmcnt(2)
    v_smfmac_f32_16x16x64_bf16 v[52:55], v[16:19], v[120:127], v87
    v_add_f32_dpp v30, v30, v30 quad_perm:[1,0,3,2] row_mask:0xf bank_mask:0xf
    v_add_f32_dpp v31, v31, v31 quad_perm:[1,0,3,2] row_mask:0xf bank_mask:0xf
    v_smfmac_f32_16x16x64_bf16 v[56:59], v[16:19], v[128:135], v87
    v_add_f32_dpp v30, v30, v30 quad_perm:[2,3,0,1] row_mask:0xf bank_mask:0xf
    v_add_f32_dpp v31, v31, v31 quad_perm:[2,3,0,1] row_mask:0xf bank_mask:0xf
    s_waitcnt lgkmcnt(1)
    v_smfmac_f32_16x16x64_bf16 v[52:55], v[20:23], v[136:143], v87
    v_add_f32_dpp v30, v30, v30 row_ror:4 row_mask:0xf bank_mask:0xf
    v_add_f32_dpp v31, v31, v31 row_ror:4 row_mask:0xf bank_mask:0xf
    v_smfmac_f32_16x16x64_bf16 v[56:59], v[20:23], v[144:151], v87
    v_add_f32_dpp v30, v30, v30 row_ror:8 row_mask:0xf bank_mask:0xf
    v_add_f32_dpp v31, v31, v31 row_ror:8 row_mask:0xf bank_mask:0xf
    s_waitcnt lgkmcnt(0)
    v_smfmac_f32_16x16x64_bf16 v[52:55], v[24:27], v[152:159], v87
    v_mul_f32 v48, s62, v30
    v_mul_f32 v49, s62, v31
    v_smfmac_f32_16x16x64_bf16 v[56:59], v[24:27], v[160:167], v87
    v_mul_f32 v7, v84, v48
    v_fma_f32 v49, -v48, v48, -v49
    v_max_f32 v49, 0, v49
    v_add_f32 v49, 0x3727c5ac, v49
    v_rsq_f32 v49, v49
    v_add_f32 v4, v52, v53
    v_add_f32 v4, v4, v7
    s_nop 0
    v_add_f32 v5, v58, v59
    v_add_f32 v4, v4, v5
    v_fma_f32 v4, v4, v49, v85
    v_mul_f32 v5, v4, v4
    v_fma_f32 v5, v5, s63, v86
    v_mul_f32 v5, v5, v4
    v_exp_f32 v5, v5
    s_nop 0
    v_add_f32 v5, 1.0, v5
    v_rcp_f32 v5, v5
    s_nop 0
    v_mul_f32 v4, v4, v5
    v_cvt_pk_bf16_f32 v4, v4, v4
    ds_write_b16 v80, v4
    s_waitcnt lgkmcnt(0)
    s_barrier
    s_endpgm
L_h_t1:
    s_sub_u32 s63, s56, 154
    s_cmp_lt_u32 s63, 16
    s_cbranch_scc0 L_h_noclr
    s_lshl2_add_u32 s62, s63, s3
    s_mul_i32 s62, s62, 4608
    v_mov_b32 v4, -1
    v_mov_b32 v5, -1
    v_mov_b32 v6, -1
    v_mov_b32 v7, -1
    v_lshlrev_b32 v8, 4, v0
    buffer_store_dwordx4 v[4:7], v8, s[40:43], s62 offen offset:0 sc1
    buffer_store_dwordx4 v[4:7], v8, s[40:43], s62 offen offset:1024 sc1
    buffer_store_dwordx4 v[4:7], v8, s[40:43], s62 offen offset:2048 sc1
    buffer_store_dwordx4 v[4:7], v8, s[40:43], s62 offen offset:3072 sc1
    s_add_u32 s62, s62, 4096
    s_bfm_b64 exec, 32, 0
    buffer_store_dwordx4 v[4:7], v8, s[40:43], s62 offen offset:0 sc1
    s_mov_b64 exec, 1
    v_mov_b32 v9, 162100
    v_mov_b32 v10, 1
    s_and_b32 s62, s63, 1
    s_mul_i32 s62, s62, 126
    s_lshl1_add_u32 s63, s63, s62
    s_waitcnt vmcnt(0)
    ds_add_rtn_u32 v10, v9, v10
    s_waitcnt lgkmcnt(0)
    v_readfirstlane_b32 s62, v10
    s_nop 0
    s_cmp_lg_u32 s62, 3
    s_cbranch_scc1 L_h_clrd
    buffer_store_dword v4, v36, s[44:47], s63 offen sc1
L_h_clrd:
    s_mov_b64 exec, -1
L_h_noclr:
    v_lshrrev_b32 v1, 3, v0
    v_mul_u32_u24 v1, 1280, v1
    v_and_b32 v2, 7, v0
    v_lshl_add_u32 v1, v2, 4, v1
    s_lshl2_add_u32 s63, s34, s3
    s_mul_i32 s63, s63, 163840
    s_lshl_b32 s62, s35, 7
    s_add_u32 s63, s63, s62
    s_sub_u32 s63, s63, 2816
    s_lshl_b32 s62, s3, 14
    s_add_u32 s62, s62, 81920
    s_mov_b32 m0, s62
    s_mov_b32 s48, s12
    s_mov_b32 s49, s13
    s_mov_b32 s50, 5242880
    s_mov_b32 s51, 0x20000
    s_add_u32 s100, s39, 1
    s_mov_b32 s62, 8
L_dma_5:
    buffer_load_dwordx4 v1, s[48:51], s63 offen nt lds
    s_add_u32 m0, m0, 1024
    s_add_u32 s63, s63, 10240
    s_cmp_eq_u32 s100, 0
    s_cbranch_scc1 L_dma_5n0
    s_waitcnt vmcnt(7)
    s_cmp_eq_u32 s100, 2
    s_cbranch_scc1 L_dma_5n0
    s_waitcnt vmcnt(3)
L_dma_5n0:
    buffer_load_dwordx4 v1, s[48:51], s63 offen nt lds
    s_add_u32 m0, m0, 1024
    s_add_u32 s63, s63, 10240
    s_cmp_eq_u32 s100, 0
    s_cbranch_scc1 L_dma_5n1
    s_waitcnt vmcnt(7)
    s_cmp_eq_u32 s100, 2
    s_cbranch_scc1 L_dma_5n1
    s_waitcnt vmcnt(3)
L_dma_5n1:
    s_sub_u32 s62, s62, 1
    s_cmp_lg_u32 s62, 0
    s_cbranch_scc1 L_dma_5
    s_cmp_eq_u32 s39, 1
    s_cbranch_scc1 L_h_role
    s_waitcnt vmcnt(0)
    v_mov_b32 v4, 162060
    v_mov_b32 v5, 1
    s_mov_b64 exec, 1
    ds_add_u32 v4, v5
    s_mov_b64 exec, -1
    s_cmp_eq_u32 s3, 0
    s_cbranch_scc1 L_service
    s_endpgm
L_h_role:
    v_mov_b32 v72, 0
    v_mov_b32 v73, 0
    v_mov_b32 v74, 0
    v_mov_b32 v75, 0
    v_mov_b32 v76, 0
    v_lshrrev_b32 v3, 4, v0
    v_and_b32 v2, 3, v0
    v_bfe_u32 v1, v0, 2, 2
    v_mul_u32_u24 v160, 1280, v3
    v_and_b32 v4, 15, v0
    v_lshl_add_u32 v163, v4, 2, v160
    v_lshl_add_u32 v160, v4, 3, v160
    s_mul_i32 s57, s35, 5120
    s_mul_i32 s62, s3, 320
    s_add_u32 s57, s57, s62
    s_add_u32 s57, s57, 327680
    v_mov_b32 v4, -1
    v_mov_b32 v5, -1
    v_mov_b32 v6, -1
    v_mov_b32 v7, -1
    v_lshlrev_b32 v8, 4, v0
    s_mul_i32 s62, s3, 960
    s_add_u32 s62, s62, s57
    buffer_store_dwordx4 v[4:7], v8, s[40:43], s62 offen sc1
    s_mov_b64 exec, 0xffff
    buffer_store_dwordx4 v[4:7], v8, s[40:43], s62 offen offset:1024 sc1
    s_mov_b64 exec, -1
    v_add_u32 v8, 0, v0
    v_mul_u32_u24 v10, 0xccd, v8
    v_lshrrev_b32 v10, 16, v10
    v_mul_u32_u24 v9, 20, v10
    v_sub_u32 v8, v8, v9
    v_mul_u32_u24 v10, 1280, v10
    v_lshl_add_u32 v10, v8, 4, v10
    v_add_u32 v8, 64, v0
    v_mul_u32_u24 v11, 0xccd, v8
    v_lshrrev_b32 v11, 16, v11
    v_mul_u32_u24 v9, 20, v11
    v_sub_u32 v8, v8, v9
    v_mul_u32_u24 v11, 1280, v11
    v_lshl_add_u32 v11, v8, 4, v11
    v_add_u32 v8, 128, v0
    v_mul_u32_u24 v12, 0xccd, v8
    v_lshrrev_b32 v12, 16, v12
    v_mul_u32_u24 v9, 20, v12
    v_sub_u32 v8, v8, v9
    v_mul_u32_u24 v12, 1280, v12
    v_lshl_add_u32 v12, v8, 4, v12
    v_add_u32 v8, 192, v0
    v_mul_u32_u24 v13, 0xccd, v8
    v_lshrrev_b32 v13, 16, v13
    v_mul_u32_u24 v9, 20, v13
    v_sub_u32 v8, v8, v9
    v_mul_u32_u24 v13, 1280, v13
    v_lshl_add_u32 v13, v8, 4, v13
    v_add_u32 v8, 256, v0
    v_mul_u32_u24 v14, 0xccd, v8
    v_lshrrev_b32 v14, 16, v14
    v_mul_u32_u24 v9, 20, v14
    v_sub_u32 v8, v8, v9
    v_mul_u32_u24 v14, 1280, v14
    v_lshl_add_u32 v14, v8, 4, v14
    s_waitcnt vmcnt(0)
    v_mov_b32 v8, 162060
    v_mov_b32 v9, 1
    s_mov_b64 exec, 1
    ds_add_u32 v8, v9
    s_mov_b64 exec, -1
    s_mov_b32 s48, s20
    s_mov_b32 s49, s21
    s_mov_b32 s50, 2211840
    s_mov_b32 s51, 0x20000
    s_mul_i32 s63, s35, 81920
    s_mul_i32 s62, s3, 320
    s_add_u32 s63, s63, s62
    s_mov_b32 m0, s101
    s_mov_b32 s62, 4
L_w2dma:
    buffer_load_dwordx4 v10, s[48:51], s63 offen nt lds
    s_add_u32 m0, m0, 1024
    s_waitcnt vmcnt(7)
    s_cmp_ge_u32 s35, 22
    s_cbranch_scc1 L_w2n0
    s_waitcnt vmcnt(7)
L_w2n0:
    buffer_load_dwordx4 v11, s[48:51], s63 offen nt lds
    s_add_u32 m0, m0, 1024
    s_waitcnt vmcnt(7)
    s_cmp_ge_u32 s35, 22
    s_cbranch_scc1 L_w2n1
    s_waitcnt vmcnt(7)
L_w2n1:
    buffer_load_dwordx4 v12, s[48:51], s63 offen nt lds
    s_add_u32 m0, m0, 1024
    s_waitcnt vmcnt(7)
    s_cmp_ge_u32 s35, 22
    s_cbranch_scc1 L_w2n2
    s_waitcnt vmcnt(7)
L_w2n2:
    buffer_load_dwordx4 v13, s[48:51], s63 offen nt lds
    s_add_u32 m0, m0, 1024
    s_waitcnt vmcnt(7)
    s_cmp_ge_u32 s35, 22
    s_cbranch_scc1 L_w2n3
    s_waitcnt vmcnt(7)
L_w2n3:
    buffer_load_dwordx4 v14, s[48:51], s63 offen nt lds
    s_add_u32 m0, m0, 1024
    s_waitcnt vmcnt(7)
    s_cmp_ge_u32 s35, 22
    s_cbranch_scc1 L_w2n4
    s_waitcnt vmcnt(7)
L_w2n4:
    s_add_u32 s63, s63, 20480
    s_sub_u32 s62, s62, 1
    s_cmp_lg_u32 s62, 0
    s_cbranch_scc1 L_w2dma
    v_lshrrev_b32 v8, 5, v0
    v_lshlrev_b32 v8, 2, v8
    v_bfe_u32 v9, v0, 4, 1
    v_add_u32 v8, v8, v9
    v_mul_u32_u24 v8, 1280, v8
    v_add_u32 v8, s101, v8
    v_and_b32 v10, 15, v0
    v_lshl_add_u32 v9, v10, 2, v8
    v_lshl_add_u32 v8, v10, 3, v8
    s_mov_b32 s62, 0x05040100
    s_mov_b32 s63, 0x07060302
    s_waitcnt vmcnt(0)
    ds_read_b64 v[16:17], v8 offset:0
    ds_read_b64 v[18:19], v8 offset:320
    ds_read_b64 v[20:21], v8 offset:2560
    ds_read_b64 v[22:23], v8 offset:2880
    ds_read_b64 v[24:25], v8 offset:640
    ds_read_b64 v[26:27], v8 offset:960
    ds_read_b64 v[28:29], v8 offset:3200
    ds_read_b64 v[30:31], v8 offset:3520
    ds_read_b64 v[32:33], v8 offset:10240
    ds_read_b64 v[34:35], v8 offset:10560
    ds_read_b64 v[36:37], v8 offset:12800
    ds_read_b64 v[38:39], v8 offset:13120
    ds_read_b64 v[40:41], v8 offset:10880
    ds_read_b64 v[42:43], v8 offset:11200
    ds_read_b64 v[44:45], v8 offset:13440
    ds_read_b64 v[46:47], v8 offset:13760
    s_waitcnt lgkmcnt(0)
    v_perm_b32 v80, v18, v16, s62
    v_perm_b32 v88, v18, v16, s63
    v_perm_b32 v96, v19, v17, s62
    v_perm_b32 v104, v19, v17, s63
    v_perm_b32 v81, v22, v20, s62
    v_perm_b32 v89, v22, v20, s63
    v_perm_b32 v97, v23, v21, s62
    v_perm_b32 v105, v23, v21, s63
    v_perm_b32 v82, v26, v24, s62
    v_perm_b32 v90, v26, v24, s63
    v_perm_b32 v98, v27, v25, s62
    v_perm_b32 v106, v27, v25, s63
    v_perm_b32 v83, v30, v28, s62
    v_perm_b32 v91, v30, v28, s63
    v_perm_b32 v99, v31, v29, s62
    v_perm_b32 v107, v31, v29, s63
    v_perm_b32 v84, v34, v32, s62
    v_perm_b32 v92, v34, v32, s63
    v_perm_b32 v100, v35, v33, s62
    v_perm_b32 v108, v35, v33, s63
    v_perm_b32 v85, v38, v36, s62
    v_perm_b32 v93, v38, v36, s63
    v_perm_b32 v101, v39, v37, s62
    v_perm_b32 v109, v39, v37, s63
    v_perm_b32 v86, v42, v40, s62
    v_perm_b32 v94, v42, v40, s63
    v_perm_b32 v102, v43, v41, s62
    v_perm_b32 v110, v43, v41, s63
    v_perm_b32 v87, v46, v44, s62
    v_perm_b32 v95, v46, v44, s63
    v_perm_b32 v103, v47, v45, s62
    v_perm_b32 v111, v47, v45, s63
    ds_read_b64 v[16:17], v8 offset:128
    ds_read_b64 v[18:19], v8 offset:448
    ds_read_b64 v[20:21], v8 offset:2688
    ds_read_b64 v[22:23], v8 offset:3008
    ds_read_b64 v[24:25], v8 offset:768
    ds_read_b64 v[26:27], v8 offset:1088
    ds_read_b64 v[28:29], v8 offset:3328
    ds_read_b64 v[30:31], v8 offset:3648
    ds_read_b64 v[32:33], v8 offset:10368
    ds_read_b64 v[34:35], v8 offset:10688
    ds_read_b64 v[36:37], v8 offset:12928
    ds_read_b64 v[38:39], v8 offset:13248
    ds_read_b64 v[40:41], v8 offset:11008
    ds_read_b64 v[42:43], v8 offset:11328
    ds_read_b64 v[44:45], v8 offset:13568
    ds_read_b64 v[46:47], v8 offset:13888
    s_waitcnt lgkmcnt(0)
    v_perm_b32 v112, v18, v16, s62
    v_perm_b32 v120, v18, v16, s63
    v_perm_b32 v128, v19, v17, s62
    v_perm_b32 v136, v19, v17, s63
    v_perm_b32 v113, v22, v20, s62
    v_perm_b32 v121, v22, v20, s63
    v_perm_b32 v129, v23, v21, s62
    v_perm_b32 v137, v23, v21, s63
    v_perm_b32 v114, v26, v24, s62
    v_perm_b32 v122, v26, v24, s63
    v_perm_b32 v130, v27, v25, s62
    v_perm_b32 v138, v27, v25, s63
    v_perm_b32 v115, v30, v28, s62
    v_perm_b32 v123, v30, v28, s63
    v_perm_b32 v131, v31, v29, s62
    v_perm_b32 v139, v31, v29, s63
    v_perm_b32 v116, v34, v32, s62
    v_perm_b32 v124, v34, v32, s63
    v_perm_b32 v132, v35, v33, s62
    v_perm_b32 v140, v35, v33, s63
    v_perm_b32 v117, v38, v36, s62
    v_perm_b32 v125, v38, v36, s63
    v_perm_b32 v133, v39, v37, s62
    v_perm_b32 v141, v39, v37, s63
    v_perm_b32 v118, v42, v40, s62
    v_perm_b32 v126, v42, v40, s63
    v_perm_b32 v134, v43, v41, s62
    v_perm_b32 v142, v43, v41, s63
    v_perm_b32 v119, v46, v44, s62
    v_perm_b32 v127, v46, v44, s63
    v_perm_b32 v135, v47, v45, s62
    v_perm_b32 v143, v47, v45, s63
    ds_read_b32 v16, v9 offset:256
    ds_read_b32 v18, v9 offset:576
    ds_read_b32 v20, v9 offset:2816
    ds_read_b32 v22, v9 offset:3136
    ds_read_b32 v24, v9 offset:896
    ds_read_b32 v26, v9 offset:1216
    ds_read_b32 v28, v9 offset:3456
    ds_read_b32 v30, v9 offset:3776
    ds_read_b32 v32, v9 offset:10496
    ds_read_b32 v34, v9 offset:10816
    ds_read_b32 v36, v9 offset:13056
    ds_read_b32 v38, v9 offset:13376
    ds_read_b32 v40, v9 offset:11136
    ds_read_b32 v42, v9 offset:11456
    ds_read_b32 v44, v9 offset:13696
    ds_read_b32 v46, v9 offset:14016
    s_waitcnt lgkmcnt(0)
    v_perm_b32 v144, v18, v16, s62
    v_perm_b32 v152, v18, v16, s63
    v_perm_b32 v145, v22, v20, s62
    v_perm_b32 v153, v22, v20, s63
    v_perm_b32 v146, v26, v24, s62
    v_perm_b32 v154, v26, v24, s63
    v_perm_b32 v147, v30, v28, s62
    v_perm_b32 v155, v30, v28, s63
    v_perm_b32 v148, v34, v32, s62
    v_perm_b32 v156, v34, v32, s63
    v_perm_b32 v149, v38, v36, s62
    v_perm_b32 v157, v38, v36, s63
    v_perm_b32 v150, v42, v40, s62
    v_perm_b32 v158, v42, v40, s63
    v_perm_b32 v151, v46, v44, s62
    v_perm_b32 v159, v46, v44, s63
    s_mov_b32 s48, s16
    s_mov_b32 s49, s17
    s_mov_b32 s50, 2211840
    s_mov_b32 s51, 0x20000
    s_lshl_b32 s98, s35, 7
    s_mov_b32 s99, 3456
    v_lshrrev_b32 v9, 3, v0
    v_mul_lo_u32 v10, v9, s99
    v_and_b32 v9, 2, v9
    v_xor_b32 v9, v9, v0
    v_and_b32 v9, 7, v9
    v_lshl_add_u32 v10, v9, 4, v10
    v_add_u32 v10, s98, v10
    v_xor_b32 v11, 64, v10
    s_mul_i32 s63, s3, 552960
    s_mov_b32 m0, s101
    s_waitcnt lgkmcnt(0)
    s_cmp_ge_u32 s35, 22
    s_cselect_b32 s100, 2, 1
    s_mov_b32 s62, 10
L_dma_6:
    buffer_load_dwordx4 v10, s[48:51], s63 offen nt lds
    s_add_u32 m0, m0, 1024
    s_add_u32 s63, s63, 27648
    s_cmp_eq_u32 s100, 0
    s_cbranch_scc1 L_dma_6n0
    s_waitcnt vmcnt(7)
    s_cmp_eq_u32 s100, 2
    s_cbranch_scc1 L_dma_6n0
    s_waitcnt vmcnt(7)
L_dma_6n0:
    buffer_load_dwordx4 v11, s[48:51], s63 offen nt lds
    s_add_u32 m0, m0, 1024
    s_add_u32 s63, s63, 27648
    s_cmp_eq_u32 s100, 0
    s_cbranch_scc1 L_dma_6n1
    s_waitcnt vmcnt(7)
    s_cmp_eq_u32 s100, 2
    s_cbranch_scc1 L_dma_6n1
    s_waitcnt vmcnt(7)
L_dma_6n1:
    s_sub_u32 s62, s62, 1
    s_cmp_lg_u32 s62, 0
    s_cbranch_scc1 L_dma_6
    v_mov_b32 v8, 162068
L_lw_7:
    ds_read_b32 v9, v8
    s_waitcnt lgkmcnt(0)
    v_cmp_gt_u32 vcc, 1, v9
    s_cbranch_vccz L_lw_7e
    s_sleep 8
    s_sub_u32 s60, s60, 1
    s_cbranch_scc0 L_lw_7
    s_mov_b32 s60, 0
L_lw_7e:
    s_cmp_lg_u32 s3, 3
    s_cbranch_scc1 L_h_nomo
    v_and_b32 v4, 15, v0
    v_lshlrev_b32 v4, 4, v4
    v_mul_u32_u24 v5, 1280, v3
    v_add_u32 v5, v5, v4
    v_mul_u32_u24 v6, 1296, v3
    v_add_u32 v6, v6, v4
    v_add_u32 v6, 147456, v6
    s_mov_b32 s62, 30720
    s_mov_b32 s63, 25600
    s_branch L_poll_8
L_poll_8s:
    s_sleep 8
L_poll_8:
    buffer_load_dwordx4 v[40:43], v5, s[40:43], s62 offen offset:0 sc1
    buffer_load_dwordx4 v[44:47], v5, s[40:43], s62 offen offset:256 sc1
    buffer_load_dwordx4 v[48:51], v5, s[40:43], s62 offen offset:512 sc1
    buffer_load_dwordx4 v[52:55], v5, s[40:43], s62 offen offset:768 sc1
    buffer_load_dwordx4 v[56:59], v5, s[40:43], s62 offen offset:1024 sc1
    buffer_load_dwordx4 v[60:63], v5, s[40:43], s63 offen offset:0 sc1
    buffer_load_dwordx4 v[64:67], v5, s[40:43], s63 offen offset:256 sc1
    buffer_load_dwordx4 v[68:71], v5, s[40:43], s63 offen offset:512 sc1
    buffer_load_dwordx4 v[72:75], v5, s[40:43], s63 offen offset:768 sc1
    buffer_load_dwordx4 v[76:79], v5, s[40:43], s63 offen offset:1024 sc1
    s_sub_u32 s60, s60, 1
    s_cbranch_scc1 L_poll_8t
    s_waitcnt vmcnt(0)
    v_max3_u32 v7, v40, v41, v42
    v_max3_u32 v7, v7, v43, v44
    v_max3_u32 v7, v7, v45, v46
    v_max3_u32 v7, v7, v47, v48
    v_max3_u32 v7, v7, v49, v50
    v_max3_u32 v7, v7, v51, v52
    v_max3_u32 v7, v7, v53, v54
    v_max3_u32 v7, v7, v55, v56
    v_max3_u32 v7, v7, v57, v58
    v_max3_u32 v7, v7, v59, v60
    v_max3_u32 v7, v7, v61, v62
    v_max3_u32 v7, v7, v63, v64
    v_max3_u32 v7, v7, v65, v66
    v_max3_u32 v7, v7, v67, v68
    v_max3_u32 v7, v7, v69, v70
    v_max3_u32 v7, v7, v71, v72
    v_max3_u32 v7, v7, v73, v74
    v_max3_u32 v7, v7, v75, v76
    v_max3_u32 v7, v7, v77, v78
    v_max_u32 v7, v7, v79
    v_cmp_eq_u32 vcc, -1, v7
    s_cbranch_vccnz L_poll_8s
L_poll_8e:
    ds_write_b128 v6, v[40:43] offset:0
    ds_write_b128 v6, v[44:47] offset:256
    ds_write_b128 v6, v[48:51] offset:512
    ds_write_b128 v6, v[52:55] offset:768
    ds_write_b128 v6, v[56:59] offset:1024
    ds_write_b128 v6, v[60:63] offset:5184
    ds_write_b128 v6, v[64:67] offset:5440
    ds_write_b128 v6, v[68:71] offset:5696
    ds_write_b128 v6, v[72:75] offset:5952
    ds_write_b128 v6, v[76:79] offset:6208
L_h_nomo:
    v_mul_u32_u24 v4, 144, v1
    v_lshl_add_u32 v4, v3, 5, v4
    v_bfe_u32 v5, v0, 1, 1
    v_lshl_add_u32 v4, v5, 4, v4
    v_add_u32 v4, 90688, v4
    v_mov_b32 v5, 162112
    v_and_b32 v6, 1, v0
    v_cmp_eq_u32 vcc, 0, v6
    s_nop 1
    v_cndmask_b32 v161, v5, v4, vcc
    v_cndmask_b32 v162, v4, v5, vcc
    v_bfe_u32 v164, v0, 1, 1
    v_mul_u32_u24 v164, 0xaaaa, v164
    v_add_u32 v164, 0x4444, v164
    s_mov_b32 s100, s3
    s_lshl_b32 s63, s100, 8
    v_and_b32 v8, 15, v0
    v_lshl_add_u32 v8, v8, 4, s63
    v_lshrrev_b32 v9, 4, v0
    v_mul_u32_u24 v5, 1280, v9
    v_add_u32 v5, v5, v8
    v_mul_u32_u24 v4, 1296, v9
    v_add_u32 v4, v4, v8
    v_add_u32 v4, 82944, v4
    v_lshlrev_b32 v6, 1, v5
    v_add_u32 v6, 99328, v6
    s_lshl_b32 s62, s100, 9
    s_add_u32 s62, s62, 88128
    v_lshl_add_u32 v7, v0, 3, s62
    s_mov_b32 s48, s4
    s_mov_b32 s49, s5
    s_mov_b32 s50, 5120
    s_mov_b32 s51, 0x20000
    buffer_load_dwordx4 v[8:11], v5, s[48:51], 0 offen
    s_mov_b32 s62, 20480
    s_mov_b32 s63, 30720
    s_branch L_poll_9
L_poll_9s:
    s_sleep 8
L_poll_9:
    buffer_load_dwordx4 v[12:15], v5, s[40:43], s62 offen sc1
    buffer_load_dwordx4 v[16:19], v5, s[40:43], s63 offen sc1
    s_sub_u32 s60, s60, 1
    s_cbranch_scc1 L_poll_9t
    s_waitcnt vmcnt(0)
    v_max3_u32 v38, v12, v13, v14
    v_max3_u32 v38, v38, v15, v16
    v_max3_u32 v38, v38, v17, v18
    v_max_u32 v38, v38, v19
    v_cmp_eq_u32 vcc, -1, v38
    s_cbranch_vccnz L_poll_9s
L_poll_9e:
    v_lshlrev_b32 v40, 16, v8
    v_and_b32 v41, 0xffff0000, v8
    v_lshlrev_b32 v42, 16, v9
    v_and_b32 v43, 0xffff0000, v9
    v_lshlrev_b32 v44, 16, v10
    v_and_b32 v45, 0xffff0000, v10
    v_lshlrev_b32 v46, 16, v11
    v_and_b32 v47, 0xffff0000, v11
    v_lshlrev_b32 v48, 16, v12
    v_and_b32 v49, 0xffff0000, v12
    v_lshlrev_b32 v50, 16, v13
    v_and_b32 v51, 0xffff0000, v13
    v_lshlrev_b32 v52, 16, v14
    v_and_b32 v53, 0xffff0000, v14
    v_lshlrev_b32 v54, 16, v15
    v_and_b32 v55, 0xffff0000, v15
    v_lshlrev_b32 v56, 16, v16
    v_and_b32 v57, 0xffff0000, v16
    v_lshlrev_b32 v58, 16, v17
    v_and_b32 v59, 0xffff0000, v17
    v_lshlrev_b32 v60, 16, v18
    v_and_b32 v61, 0xffff0000, v18
    v_lshlrev_b32 v62, 16, v19
    v_and_b32 v63, 0xffff0000, v19
    v_mov_b32 v64, 0
    v_mov_b32 v65, 0
    v_mov_b32 v66, 0
    v_mov_b32 v67, 0
    v_mov_b32 v68, 0
    v_mov_b32 v69, 0
    v_mov_b32 v70, 0
    v_mov_b32 v71, 0
    v_bfe_u32 v5, v0, 2, 2
    v_lshlrev_b32 v5, 8, v5
    v_lshrrev_b32 v8, 4, v0
    v_lshl_add_u32 v5, v8, 6, v5
    v_and_b32 v8, 3, v0
    v_lshl_add_u32 v5, v8, 4, v5
    s_lshl_b32 s56, s100, 10
    s_waitcnt vmcnt(0) lgkmcnt(0)
    v_mov_b32 v8, 162064
    v_mov_b32 v9, 1
    s_mov_b64 exec, 1
    ds_add_u32 v8, v9
    s_mov_b64 exec, -1
    s_branch L_t2gate
L_ffn2:
    s_barrier
L_ffn2b:
    ds_read_b128 v[8:11], v161
    ds_read_b128 v[12:15], v162
    s_cmp_eq_u32 s61, 1
    s_cbranch_scc0 L_f2slow
    s_waitcnt lgkmcnt(1)
    v_smfmac_f32_16x16x64_bf16 v[16:19], v[8:11], v[80:87], v164
    v_smfmac_f32_16x16x64_bf16 v[20:23], v[8:11], v[96:103], v164
    s_waitcnt lgkmcnt(0)
    v_smfmac_f32_16x16x64_bf16 v[16:19], v[12:15], v[88:95], v164
    v_smfmac_f32_16x16x64_bf16 v[20:23], v[12:15], v[104:111], v164
    v_smfmac_f32_16x16x64_bf16 v[24:27], v[8:11], v[112:119], v164
    v_smfmac_f32_16x16x64_bf16 v[28:31], v[8:11], v[128:135], v164
    v_smfmac_f32_16x16x64_bf16 v[24:27], v[12:15], v[120:127], v164
    v_smfmac_f32_16x16x64_bf16 v[28:31], v[12:15], v[136:143], v164
    v_smfmac_f32_16x16x64_bf16 v[32:35], v[8:11], v[144:151], v164
    v_smfmac_f32_16x16x64_bf16 v[32:35], v[12:15], v[152:159], v164
    s_nop 0
    v_pk_add_f32 v[16:17], v[16:17], v[18:19]
    v_cvt_pk_bf16_f32 v40, v16, v17
    v_pk_add_f32 v[20:21], v[20:21], v[22:23]
    v_cvt_pk_bf16_f32 v41, v20, v21
    buffer_store_dwordx2 v[40:41], v160, s[40:43], s57 offen
    v_pk_add_f32 v[24:25], v[24:25], v[26:27]
    v_cvt_pk_bf16_f32 v42, v24, v25
    v_pk_add_f32 v[28:29], v[28:29], v[30:31]
    v_cvt_pk_bf16_f32 v43, v28, v29
    buffer_store_dwordx2 v[42:43], v160, s[40:43], s57 offen offset:128
    v_pk_add_f32 v[32:33], v[32:33], v[34:35]
    v_cvt_pk_bf16_f32 v44, v32, v33
    buffer_store_dword v44, v163, s[40:43], s57 offen offset:256
L_f2done:
    s_barrier
    s_endpgm
L_f2slow:
    s_waitcnt lgkmcnt(1)
    v_smfmac_f32_16x16x64_bf16 v[16:19], v[8:11], v[80:87], v164
    v_smfmac_f32_16x16x64_bf16 v[20:23], v[8:11], v[96:103], v164
    s_waitcnt lgkmcnt(0)
    v_smfmac_f32_16x16x64_bf16 v[16:19], v[12:15], v[88:95], v164
    v_smfmac_f32_16x16x64_bf16 v[20:23], v[12:15], v[104:111], v164
    v_smfmac_f32_16x16x64_bf16 v[24:27], v[8:11], v[112:119], v164
    v_smfmac_f32_16x16x64_bf16 v[28:31], v[8:11], v[128:135], v164
    v_smfmac_f32_16x16x64_bf16 v[24:27], v[12:15], v[120:127], v164
    v_smfmac_f32_16x16x64_bf16 v[28:31], v[12:15], v[136:143], v164
    v_smfmac_f32_16x16x64_bf16 v[32:35], v[8:11], v[144:151], v164
    v_smfmac_f32_16x16x64_bf16 v[32:35], v[12:15], v[152:159], v164
    s_nop 0
    v_pk_add_f32 v[16:17], v[16:17], v[18:19]
    v_cvt_pk_bf16_f32 v40, v16, v17
    v_pk_add_f32 v[20:21], v[20:21], v[22:23]
    v_cvt_pk_bf16_f32 v41, v20, v21
    buffer_store_dwordx2 v[40:41], v160, s[40:43], s57 offen sc1
    v_pk_add_f32 v[24:25], v[24:25], v[26:27]
    v_cvt_pk_bf16_f32 v42, v24, v25
    v_pk_add_f32 v[28:29], v[28:29], v[30:31]
    v_cvt_pk_bf16_f32 v43, v28, v29
    buffer_store_dwordx2 v[42:43], v160, s[40:43], s57 offen offset:128 sc1
    v_pk_add_f32 v[32:33], v[32:33], v[34:35]
    v_cvt_pk_bf16_f32 v44, v32, v33
    buffer_store_dword v44, v163, s[40:43], s57 offen offset:256 sc1
    s_branch L_f2done
L_poll_3t:
    s_mov_b32 s60, 0
    s_waitcnt vmcnt(0)
    s_branch L_poll_3e
L_poll_8t:
    s_mov_b32 s60, 0
    s_waitcnt vmcnt(0)
    s_branch L_poll_8e
L_poll_9t:
    s_mov_b32 s60, 0
    s_waitcnt vmcnt(0)
    s_branch L_poll_9e
L_poll_99t:
    s_mov_b32 s60, 0
    s_waitcnt vmcnt(0)
    s_branch L_poll_99e
L_pfast:
    buffer_store_dword v12, v108, s[40:43], s101 offen
    buffer_store_dword v12, v110, s[40:43], s101 offen
    s_branch L_pdone
L_poll_101t:
    s_mov_b32 s60, 0
    s_waitcnt vmcnt(0)
    s_branch L_poll_101e
L_poll_104t:
    s_mov_b32 s60, 0
    s_waitcnt vmcnt(0)
    s_branch L_poll_104e
L_poll_106t:
    s_mov_b32 s60, 0
    s_waitcnt vmcnt(0)
    s_branch L_poll_106e
L_poll_110t:
    s_mov_b32 s60, 0
    s_waitcnt vmcnt(0)
    s_branch L_poll_110e
L_poll_112t:
    s_mov_b32 s60, 0
    s_waitcnt vmcnt(0)
    s_branch L_poll_112e
L_poll_117t:
    s_mov_b32 s60, 0
    s_waitcnt vmcnt(0)
    s_branch L_poll_117e
L_poll_119t:
    s_mov_b32 s60, 0
    s_waitcnt vmcnt(0)
    s_branch L_poll_119e
L_ygt:
    s_waitcnt vmcnt(0)
    s_branch L_ygd
L_pto:
    s_mov_b32 s60, 0
    s_waitcnt vmcnt(0)
    s_branch L_pgot0
L_poll_123t:
    s_mov_b32 s60, 0
    s_waitcnt vmcnt(0)
    s_branch L_poll_123e
L_end:
    s_endpgm
L_codeend:
.section .rodata,"a"
.p2align 6
.amdhsa_kernel adaLN_cond__sliding_block_cached__dense_activation_gelu__decode_kernel
  .amdhsa_next_free_vgpr 168
  .amdhsa_next_free_sgpr 102
  .amdhsa_accum_offset 168
  .amdhsa_group_segment_fixed_size 0
  .amdhsa_kernarg_size 120
  .amdhsa_user_sgpr_count 2
  .amdhsa_user_sgpr_kernarg_segment_ptr 1
  .amdhsa_system_sgpr_workgroup_id_x 1
.end_amdhsa_kernel
```

```asm
; @launch grid=(256,1,1) block=(768,1,1) lds=162176
.amdgcn_target "amdgcn-amd-amdhsa--gfx950"
.text
.globl adaLN_cond__sliding_block_cached__dense_activation_gelu__decode_kernel
.p2align 8
.type adaLN_cond__sliding_block_cached__dense_activation_gelu__decode_kernel,@function
adaLN_cond__sliding_block_cached__dense_activation_gelu__decode_kernel:
    s_load_dwordx16 s[4:19], s[0:1], 0
    s_load_dwordx8 s[20:27], s[0:1], 64
    s_load_dwordx4 s[28:31], s[0:1], 96
    s_load_dwordx2 s[32:33], s[0:1], 112
    s_cmp_ge_u32 s2, 256
    s_cbranch_scc1 L_end
    v_lshrrev_b32 v1, 6, v0
    v_mul_u32_u24 v2, 36, v0
    v_readfirstlane_b32 s3, v1
    v_and_b32 v0, 63, v0
    s_and_b32 s34, s2, 7
    s_lshr_b32 s35, s2, 3
    s_cmp_lg_u32 s35, 21
    s_cbranch_scc1 L_nopf
    s_getpc_b64 s[48:49]
L_pc:
    v_min_u32 v2, L_codeend-L_pc-4, v2
    v_mov_b32 v3, s49
    v_add_co_u32 v2, vcc, s48, v2
    s_nop 1
    v_addc_co_u32 v3, vcc, 0, v3, vcc
    global_load_dword v152, v[2:3], off
L_nopf:
    s_lshr_b32 s36, s35, 3
    s_lshl2_add_u32 s36, s34, s36
    s_bfe_u32 s37, s35, 0x20001
    s_and_b32 s38, s35, 1
    s_cmp_lt_u32 s35, 27
    s_cselect_b32 s39, 1, 0
    s_cmp_eq_u32 s34, 2
    s_cselect_b32 s39, s39, 0
    s_sub_u32 s62, s34, 3
    s_and_b32 s62, s62, 7
    s_mul_i32 s56, s35, 7
    s_add_u32 s56, s56, s62
    s_cmp_eq_u32 s62, 7
    s_cselect_b32 s56, 255, s56
    s_mov_b32 s60, 1000000
    s_mov_b32 s61, 0
    v_mov_b32 v36, 0
    s_cmp_lt_u32 s3, 4
    s_cbranch_scc1 L_helpers
    s_sub_u32 s3, s3, 4
    s_cmp_ge_u32 s35, 22
    s_cselect_b32 s59, 1, 0
    s_add_u32 s62, s3, s59
    s_cmp_ge_u32 s62, 6
    s_cselect_b32 s62, s39, 0
    s_cmp_eq_u32 s62, 1
    s_cbranch_scc1 L_proxy
    s_cmp_eq_u32 s59, 1
    s_cselect_b32 s100, 0, 81920
    s_lshl_b32 s62, s3, 13
    s_add_u32 s100, s100, s62
    s_and_b32 s62, s39, s59
    s_cselect_b32 s100, -1, s100
    s_mov_b32 s101, 0
L_stream:
    s_lshl_b32 s62, s37, 5
    s_add_u32 s62, s62, s36
    s_lshl_b32 s63, s62, 21
    s_lshl_b32 s96, s38, 18
    s_add_u32 s63, s63, s96
    s_add_u32 s63, s63, 1572864
    v_lshlrev_b32 v1, 4, v0
    s_lshl_b32 s96, s3, 12
    v_add_u32 v1, s96, v1
    s_mov_b32 s97, 0
    s_mov_b32 s50, 262144
    s_mov_b32 s51, 0x20000
    s_waitcnt lgkmcnt(0)
    s_add_u32 s48, s6, s63
    s_addc_u32 s49, s7, 0
    s_cmp_lt_u32 s56, 40
    s_cbranch_scc0 L_nob0
    s_barrier
L_nob0:
    buffer_load_dwordx4 v[40:43], v1, s[48:51], s97 offen offset:0 nt
    buffer_load_dwordx4 v[44:47], v1, s[48:51], s97 offen offset:1024 nt
    s_cmp_lt_u32 s56, 40
    s_cbranch_scc1 L_stream2
    s_barrier
    s_branch L_stream2
L_helpers:
    s_cmp_lg_u32 s3, 0
    s_cbranch_scc1 L_noinit
    v_lshlrev_b32 v1, 2, v0
    v_add_u32 v1, 161920, v1
    ds_write_b32 v1, v36
L_noinit:
    s_waitcnt lgkmcnt(0)
    s_mov_b32 s40, s32
    s_mov_b32 s41, s33
    s_mov_b32 s42, 589824
    s_mov_b32 s43, 0x20000
    s_mov_b32 s44, s30
    s_mov_b32 s45, s31
    s_mov_b32 s46, 256
    s_mov_b32 s47, 0x20000
    s_lshl2_add_u32 s62, s35, s3
    s_cmp_eq_u32 s62, 87
    s_cbranch_scc1 L_touch
L_notp:
    s_mul_i32 s101, s3, 20480
    s_mov_b32 s96, s56
    s_cmp_lt_u32 s56, 40
    s_cbranch_scc0 L_nothalf
    s_cmp_lt_u32 s3, 2
    s_cbranch_scc1 L_unit
    s_add_u32 s62, s56, 20
    s_cmp_eq_u32 s3, 2
    s_cbranch_scc1 L_job
    s_barrier
    s_branch L_service
L_nothalf:
    s_cmp_lt_u32 s56, 104
    s_cbranch_scc1 L_unit
    s_sub_u32 s62, s56, 144
    s_cmp_lt_u32 s62, 10
    s_cbranch_scc0 L_nojob
    s_cmp_lt_u32 s3, 2
    s_cbranch_scc0 L_nojob
    s_mul_i32 s63, s3, 10
    s_add_u32 s62, s62, s63
L_job:
    s_cmp_lt_u32 s62, 59
    s_cbranch_scc0 L_end
    s_mov_b32 s100, s101
    s_lshl_b32 s101, s62, 9
    s_add_u32 s101, s101, 172032
    s_cmp_lt_u32 s62, 27
    s_cselect_b32 s63, 0, 27
    s_cselect_b32 s3, 7, 6
    s_cmp_lt_u32 s62, 54
    s_cselect_b32 s63, s63, 32
    s_cselect_b32 s3, s3, 5
    s_sub_u32 s35, s62, s63
    s_mov_b32 s34, 2
    s_lshr_b32 s36, s35, 3
    s_add_u32 s36, s36, 8
    s_bfe_u32 s37, s35, 0x20001
    s_and_b32 s38, s35, 1
    s_mov_b32 s59, 0
    s_branch L_stream
L_nojob:
    s_barrier
    s_cmp_ge_u32 s35, 22
    s_cbranch_scc1 L_h_t1
    s_cmp_eq_u32 s39, 1
    s_cbranch_scc1 L_h_role
    s_cmp_lt_u32 s96, 144
    s_cbranch_scc1 L_unit
    s_cmp_eq_u32 s3, 3
    s_cbranch_scc1 L_service
    s_endpgm
L_unit:
    v_lshrrev_b32 v3, 4, v0
    v_and_b32 v4, 3, v0
    v_bfe_u32 v7, v0, 2, 2
    s_mov_b32 s14, s3
    s_mov_b32 s15, 3
    s_sub_u32 s62, s96, 40
    s_cmp_lt_u32 s62, 64
    s_cbranch_scc1 L_u_q
    s_mov_b32 s100, 1
    s_sub_u32 s96, s96, 84
    s_cmp_lt_u32 s56, 40
    s_cbranch_scc0 L_u_full
    s_mov_b32 s100, 0
    s_lshr_b32 s96, s56, 1
    s_and_b32 s62, s56, 1
    s_lshl1_add_u32 s14, s62, s14
    s_mov_b32 s15, 1
L_u_full:
    s_mov_b32 s97, 0
    s_mov_b32 s99, 7680
    s_mov_b32 s48, s26
    s_mov_b32 s49, s27
    s_mov_b32 s50, 4915200
    s_mov_b32 s51, 0x20000
    s_mov_b32 s52, s24
    s_mov_b32 s53, s25
    s_mov_b32 s54, 5120
    s_mov_b32 s55, 0x20000
    v_and_b32 v6, 15, v0
    v_lshlrev_b32 v6, 4, v6
    v_mul_u32_u24 v5, 1280, v3
    v_add_u32 v5, v5, v6
    s_mul_i32 s62, s14, 320
    buffer_load_dwordx4 v[8:11], v5, s[52:55], s62 offen
    s_mov_b32 exec_lo, 0x000f000f
    s_mov_b32 exec_hi, 0x000f000f
    buffer_load_dwordx4 v[12:15], v5, s[52:55], s62 offen offset:256
    s_mov_b64 exec, -1
    s_lshl_b32 s98, s96, 7
    s_mul_i32 s13, s96, 0x199a
    s_lshr_b32 s13, s13, 16
    s_cmp_lg_u32 s13, 1
    s_cbranch_scc1 L_u_go
    s_mov_b32 s52, s4
    s_mov_b32 s53, s5
    s_mov_b32 s54, 5120
    s_mov_b32 s55, 0x20000
    v_mul_u32_u24 v5, 1280, v4
    v_lshlrev_b32 v64, 5, v7
    v_lshl_add_u32 v64, v3, 3, v64
    v_add_u32 v64, v64, v5
    v_lshrrev_b32 v6, 2, v0
    v_lshl_add_u32 v6, v6, 4, v5
    s_sub_u32 s62, s98, 1280
    buffer_load_dwordx4 v[16:19], v6, s[52:55], 0 offen offset:0
    buffer_load_dwordx4 v[20:23], v6, s[52:55], 0 offen offset:256
    buffer_load_dwordx4 v[24:27], v6, s[52:55], 0 offen offset:512
    buffer_load_dwordx4 v[28:31], v6, s[52:55], 0 offen offset:768
    buffer_load_dwordx4 v[32:35], v6, s[52:55], 0 offen offset:1024
    buffer_load_dwordx2 v[66:67], v64, s[52:55], s62 offen
    s_branch L_u_go
L_u_q:
    s_mov_b32 s97, 1
    s_mov_b32 s99, 8192
    s_mov_b32 s100, 0
    s_lshl_b32 s98, s62, 7
    s_mov_b32 s48, s10
    s_mov_b32 s49, s11
    s_mov_b32 s50, 5242880
    s_mov_b32 s51, 0x20000
L_u_go:
    v_lshrrev_b32 v6, 3, v0
    v_mul_lo_u32 v1, v6, s99
    v_and_b32 v6, 2, v6
    v_xor_b32 v6, v6, v0
    v_and_b32 v6, 7, v6
    v_lshl_add_u32 v1, v6, 4, v1
    v_add_u32 v1, s98, v1
    v_xor_b32 v2, 64, v1
    s_mul_i32 s63, s99, s14
    s_mul_i32 s63, s63, 160
    s_lshl_b32 s59, s99, 3
    s_mov_b32 m0, s101
    s_mov_b32 s62, 10
L_dma_1:
    buffer_load_dwordx4 v1, s[48:51], s63 offen nt lds
    s_add_u32 m0, m0, 1024
    s_add_u32 s63, s63, s59
    s_cmp_eq_u32 s100, 0
    s_cbranch_scc1 L_dma_1n0
    s_waitcnt vmcnt(3)
    s_cmp_eq_u32 s100, 2
    s_cbranch_scc1 L_dma_1n0
    s_waitcnt vmcnt(3)
L_dma_1n0:
    buffer_load_dwordx4 v2, s[48:51], s63 offen nt lds
    s_add_u32 m0, m0, 1024
    s_add_u32 s63, s63, s59
    s_cmp_eq_u32 s100, 0
    s_cbranch_scc1 L_dma_1n1
    s_waitcnt vmcnt(3)
    s_cmp_eq_u32 s100, 2
    s_cbranch_scc1 L_dma_1n1
    s_waitcnt vmcnt(3)
L_dma_1n1:
    s_sub_u32 s62, s62, 1
    s_cmp_lg_u32 s62, 0
    s_cbranch_scc1 L_dma_1
    v_min_u32 v65, 15, v0
    v_and_b32 v6, 1, v65
    v_mul_u32_u24 v6, 126, v6
    v_lshl_add_u32 v65, v65, 1, v6
    v_mov_b32 v68, 0
    s_cmp_lt_u32 s56, 40
    s_cbranch_scc1 L_u_nofl
    buffer_load_dword v68, v65, s[44:47], 0 offen sc1
L_u_nofl:
    s_cmp_lt_u32 s56, 104
    s_cbranch_scc0 L_u_nob
    s_barrier
L_u_nob:
    v_lshrrev_b32 v60, 4, v0
    v_lshlrev_b32 v60, 10, v60
    v_bfe_u32 v6, v0, 2, 2
    v_lshl_add_u32 v60, v6, 7, v60
    v_and_b32 v6, 3, v0
    v_lshl_add_u32 v60, v6, 3, v60
    v_bfe_u32 v6, v0, 3, 2
    v_lshl_add_u32 v60, v6, 5, v60
    v_xor_b32 v61, 32, v60
    v_xor_b32 v62, 64, v60
    v_xor_b32 v63, 0x60, v60
    v_add_u32 v60, s101, v60
    v_add_u32 v61, s101, v61
    v_add_u32 v62, s101, v62
    v_add_u32 v63, s101, v63
    v_mov_b32 v56, 1.0
    v_mov_b32 v57, 1.0
    v_mov_b32 v58, 1.0
    v_mov_b32 v59, 1.0
    s_mov_b32 s58, 0
    v_lshl_add_u32 v69, v7, 2, v3
    v_lshl_add_u32 v69, v4, 4, v69
    v_and_b32 v64, 15, v0
    v_lshlrev_b32 v64, 3, v64
    s_cmp_eq_u32 s97, 1
    s_cbranch_scc1 L_u_q2
    v_mul_u32_u24 v6, 1280, v3
    v_add_u32 v64, v64, v6
    s_mul_i32 s63, s13, 3840
    s_add_u32 s57, s98, s63
    s_add_u32 s57, s57, 10240
    s_cmp_lt_u32 s56, 40
    s_cbranch_scc0 L_u_nat
    v_lshrrev_b32 v69, 1, v3
    v_lshlrev_b32 v69, 3, v69
    v_lshl_add_u32 v69, v7, 4, v69
    v_lshl_add_u32 v69, v4, 1, v69
    v_and_b32 v6, 1, v3
    v_add_u32 v69, v69, v6
    s_lshr_b32 s62, s56, 1
    s_lshl_b32 s57, s62, 11
    s_cmp_ge_u32 s62, 10
    s_cselect_b32 s62, -19968, 0
    s_add_u32 s57, s57, s62
    s_and_b32 s62, s56, 1
    s_lshl_b32 s62, s62, 8
    s_add_u32 s57, s57, s62
    v_lshrrev_b32 v64, 5, v0
    v_lshlrev_b32 v64, 10, v64
    v_and_b32 v6, 31, v0
    v_lshl_add_u32 v64, v6, 3, v64
L_u_nat:
    s_cmp_eq_u32 s13, 4
    s_cselect_b32 s58, 1.0, 0
    s_cmp_eq_u32 s13, 1
    s_cselect_b32 s58, 1.0, s58
    s_cselect_b32 s56, 1, 0
    s_cmp_eq_u32 s14, 0
    s_cselect_b32 s58, s58, 0
    s_waitcnt vmcnt(20)
    s_mov_b32 s62, 0xbfb8aa3b
    v_lshlrev_b32 v40, 16, v8
    v_and_b32 v41, 0xffff0000, v8
    v_lshlrev_b32 v42, 16, v9
    v_and_b32 v43, 0xffff0000, v9
    v_lshlrev_b32 v44, 16, v10
    v_and_b32 v45, 0xffff0000, v10
    v_lshlrev_b32 v46, 16, v11
    v_and_b32 v47, 0xffff0000, v11
    v_mul_f32 v48, s62, v40
    v_mul_f32 v49, s62, v41
    v_mul_f32 v50, s62, v42
    v_mul_f32 v51, s62, v43
    v_mul_f32 v52, s62, v44
    v_mul_f32 v53, s62, v45
    v_mul_f32 v54, s62, v46
    v_mul_f32 v55, s62, v47
    v_exp_f32 v48, v48
    v_exp_f32 v49, v49
    v_exp_f32 v50, v50
    v_exp_f32 v51, v51
    v_exp_f32 v52, v52
    v_exp_f32 v53, v53
    v_exp_f32 v54, v54
    v_exp_f32 v55, v55
    v_add_f32 v48, 1.0, v48
    v_add_f32 v49, 1.0, v49
    v_add_f32 v50, 1.0, v50
    v_add_f32 v51, 1.0, v51
    v_add_f32 v52, 1.0, v52
    v_add_f32 v53, 1.0, v53
    v_add_f32 v54, 1.0, v54
    v_add_f32 v55, 1.0, v55
    v_rcp_f32 v48, v48
    v_rcp_f32 v49, v49
    v_rcp_f32 v50, v50
    v_rcp_f32 v51, v51
    v_rcp_f32 v52, v52
    v_rcp_f32 v53, v53
    v_rcp_f32 v54, v54
    v_rcp_f32 v55, v55
    v_mul_f32 v40, v40, v48
    v_mul_f32 v41, v41, v49
    v_mul_f32 v42, v42, v50
    v_mul_f32 v43, v43, v51
    v_mul_f32 v44, v44, v52
    v_mul_f32 v45, v45, v53
    v_mul_f32 v46, v46, v54
    v_mul_f32 v47, v47, v55
    v_cvt_pk_bf16_f32 v8, v40, v41
    v_cvt_pk_bf16_f32 v9, v42, v43
    v_cvt_pk_bf16_f32 v10, v44, v45
    v_cvt_pk_bf16_f32 v11, v46, v47
    v_lshlrev_b32 v40, 16, v12
    v_and_b32 v41, 0xffff0000, v12
    v_lshlrev_b32 v42, 16, v13
    v_and_b32 v43, 0xffff0000, v13
    v_lshlrev_b32 v44, 16, v14
    v_and_b32 v45, 0xffff0000, v14
    v_lshlrev_b32 v46, 16, v15
    v_and_b32 v47, 0xffff0000, v15
    v_mul_f32 v48, s62, v40
    v_mul_f32 v49, s62, v41
    v_mul_f32 v50, s62, v42
    v_mul_f32 v51, s62, v43
    v_mul_f32 v52, s62, v44
    v_mul_f32 v53, s62, v45
    v_mul_f32 v54, s62, v46
    v_mul_f32 v55, s62, v47
    v_exp_f32 v48, v48
    v_exp_f32 v49, v49
    v_exp_f32 v50, v50
    v_exp_f32 v51, v51
    v_exp_f32 v52, v52
    v_exp_f32 v53, v53
    v_exp_f32 v54, v54
    v_exp_f32 v55, v55
    v_add_f32 v48, 1.0, v48
    v_add_f32 v49, 1.0, v49
    v_add_f32 v50, 1.0, v50
    v_add_f32 v51, 1.0, v51
    v_add_f32 v52, 1.0, v52
    v_add_f32 v53, 1.0, v53
    v_add_f32 v54, 1.0, v54
    v_add_f32 v55, 1.0, v55
    v_rcp_f32 v48, v48
    v_rcp_f32 v49, v49
    v_rcp_f32 v50, v50
    v_rcp_f32 v51, v51
    v_rcp_f32 v52, v52
    v_rcp_f32 v53, v53
    v_rcp_f32 v54, v54
    v_rcp_f32 v55, v55
    v_mul_f32 v40, v40, v48
    v_mul_f32 v41, v41, v49
    v_mul_f32 v42, v42, v50
    v_mul_f32 v43, v43, v51
    v_mul_f32 v44, v44, v52
    v_mul_f32 v45, v45, v53
    v_mul_f32 v46, v46, v54
    v_mul_f32 v47, v47, v55
    v_cvt_pk_bf16_f32 v12, v40, v41
    v_cvt_pk_bf16_f32 v13, v42, v43
    v_cvt_pk_bf16_f32 v14, v44, v45
    v_cvt_pk_bf16_f32 v15, v46, v47
    s_mul_i32 s62, s3, 1344
    s_add_u32 s62, s62, 151552
    v_mul_u32_u24 v5, 336, v3
    v_and_b32 v6, 15, v0
    v_lshl_add_u32 v5, v6, 4, v5
    v_add_u32 v5, s62, v5
    ds_write_b128 v5, v[8:11]
    s_mov_b32 exec_lo, 0x000f000f
    s_mov_b32 exec_hi, 0x000f000f
    ds_write_b128 v5, v[12:15] offset:256
    s_mov_b64 exec, -1
    v_mul_u32_u24 v5, 336, v4
    v_lshl_add_u32 v5, v3, 4, v5
    v_add_u32 v5, s62, v5
    s_mov_b32 s59, 0x3e800000
    s_cmp_eq_u32 s56, 0
    s_cbranch_scc1 L_u_nost
    v_mov_b32 v40, 0
    v_mov_b32 v41, 0
    s_mov_b32 s62, 0x3f803f80
    v_dot2c_f32_bf16 v40, s62, v16
    v_dot2c_f32_bf16 v41, v16, v16
    v_dot2c_f32_bf16 v40, s62, v17
    v_dot2c_f32_bf16 v41, v17, v17
    v_dot2c_f32_bf16 v40, s62, v18
    v_dot2c_f32_bf16 v41, v18, v18
    v_dot2c_f32_bf16 v40, s62, v19
    v_dot2c_f32_bf16 v41, v19, v19
    v_dot2c_f32_bf16 v40, s62, v20
    v_dot2c_f32_bf16 v41, v20, v20
    v_dot2c_f32_bf16 v40, s62, v21
    v_dot2c_f32_bf16 v41, v21, v21
    v_dot2c_f32_bf16 v40, s62, v22
    v_dot2c_f32_bf16 v41, v22, v22
    v_dot2c_f32_bf16 v40, s62, v23
    v_dot2c_f32_bf16 v41, v23, v23
    v_dot2c_f32_bf16 v40, s62, v24
    v_dot2c_f32_bf16 v41, v24, v24
    v_dot2c_f32_bf16 v40, s62, v25
    v_dot2c_f32_bf16 v41, v25, v25
    v_dot2c_f32_bf16 v40, s62, v26
    v_dot2c_f32_bf16 v41, v26, v26
    v_dot2c_f32_bf16 v40, s62, v27
    v_dot2c_f32_bf16 v41, v27, v27
    v_dot2c_f32_bf16 v40, s62, v28
    v_dot2c_f32_bf16 v41, v28, v28
    v_dot2c_f32_bf16 v40, s62, v29
    v_dot2c_f32_bf16 v41, v29, v29
    v_dot2c_f32_bf16 v40, s62, v30
    v_dot2c_f32_bf16 v41, v30, v30
    v_dot2c_f32_bf16 v40, s62, v31
    v_dot2c_f32_bf16 v41, v31, v31
    v_dot2c_f32_bf16 v40, s62, v32
    v_dot2c_f32_bf16 v41, v32, v32
    v_dot2c_f32_bf16 v40, s62, v33
    v_dot2c_f32_bf16 v41, v33, v33
    v_dot2c_f32_bf16 v40, s62, v34
    v_dot2c_f32_bf16 v41, v34, v34
    v_dot2c_f32_bf16 v40, s62, v35
    v_dot2c_f32_bf16 v41, v35, v35
    s_nop 1
    v_add_f32_dpp v40, v40, v40 row_ror:4 row_mask:0xf bank_mask:0xf
    v_add_f32_dpp v41, v41, v41 row_ror:4 row_mask:0xf bank_mask:0xf
    s_nop 0
    v_add_f32_dpp v40, v40, v40 row_ror:8 row_mask:0xf bank_mask:0xf
    v_add_f32_dpp v41, v41, v41 row_ror:8 row_mask:0xf bank_mask:0xf
    v_mov_b32 v42, v40
    v_mov_b32 v43, v41
    s_nop 0
    v_permlane16_swap_b32 v40, v42
    v_permlane16_swap_b32 v41, v43
    v_add_f32 v40, v40, v42
    v_add_f32 v41, v41, v43
    v_mov_b32 v42, v40
    v_mov_b32 v43, v41
    s_nop 0
    v_permlane32_swap_b32 v40, v42
    v_permlane32_swap_b32 v41, v43
    v_add_f32 v40, v40, v42
    v_add_f32 v41, v41, v43
    s_mov_b32 s62, 0x3acccccd
    v_mul_f32 v40, s62, v40
    v_mul_f32 v41, s62, v41
    v_fma_f32 v41, -v40, v40, v41
    v_max_f32 v41, 0, v41
    v_add_f32 v41, 0x3727c5ac, v41
    v_rsq_f32 v41, v41
    v_lshlrev_b32 v56, 16, v66
    v_and_b32 v57, 0xffff0000, v66
    v_lshlrev_b32 v58, 16, v67
    v_and_b32 v59, 0xffff0000, v67
    v_sub_f32 v56, v56, v40
    v_sub_f32 v57, v57, v40
    v_sub_f32 v58, v58, v40
    v_sub_f32 v59, v59, v40
    v_mul_f32 v56, v56, v41
    v_mul_f32 v57, v57, v41
    v_mul_f32 v58, v58, v41
    v_mul_f32 v59, v59, v41
L_u_nost:
    ds_read_b128 v[8:11], v5 offset:0
    ds_read_b128 v[12:15], v5 offset:64
    ds_read_b128 v[16:19], v5 offset:128
    ds_read_b128 v[20:23], v5 offset:192
    ds_read_b128 v[24:27], v5 offset:256
    s_branch L_u_frag
L_u_q2:
    v_lshl_add_u32 v64, v3, 13, v64
    s_add_u32 s57, s98, 40960
    v_lshlrev_b32 v5, 8, v7
    v_lshl_add_u32 v5, v3, 6, v5
    v_lshl_add_u32 v5, v4, 4, v5
    s_mul_i32 s63, s3, 5120
    s_add_u32 s63, s63, 0
    s_add_u32 s12, s63, 4096
    s_mov_b32 s59, 1.0
L_u_frag:
    s_waitcnt vmcnt(0)
    v_cmp_ne_u32 vcc, -1, v68
    s_cbranch_vccz L_u_yok
    s_cmp_eq_u32 s97, 1
    s_cbranch_scc1 L_u_ywait
    buffer_load_dword v68, v65, s[44:47], 0 offen sc1
    s_branch L_u_yok
L_u_ywait:
L_wy_2:
    buffer_load_dword v68, v65, s[44:47], 0 offen sc1
    s_waitcnt vmcnt(0)
    v_cmp_ne_u32 vcc, -1, v68
    s_cbranch_vccz L_wy_2e
    s_sleep 4
    s_sub_u32 s60, s60, 1
    s_cbranch_scc0 L_wy_2
    s_mov_b32 s60, 0
L_wy_2e:
L_u_yok:
    ds_read_b64_tr_b16 v[80:81], v60 offset:0
    ds_read_b64_tr_b16 v[82:83], v60 offset:512
    ds_read_b64_tr_b16 v[84:85], v61 offset:0
    ds_read_b64_tr_b16 v[86:87], v61 offset:512
    ds_read_b64_tr_b16 v[88:89], v62 offset:0
    ds_read_b64_tr_b16 v[90:91], v62 offset:512
    ds_read_b64_tr_b16 v[92:93], v63 offset:0
    ds_read_b64_tr_b16 v[94:95], v63 offset:512
    ds_read_b64_tr_b16 v[96:97], v60 offset:4096
    ds_read_b64_tr_b16 v[98:99], v60 offset:4608
    ds_read_b64_tr_b16 v[100:101], v61 offset:4096
    ds_read_b64_tr_b16 v[102:103], v61 offset:4608
    ds_read_b64_tr_b16 v[104:105], v62 offset:4096
    ds_read_b64_tr_b16 v[106:107], v62 offset:4608
    ds_read_b64_tr_b16 v[108:109], v63 offset:4096
    ds_read_b64_tr_b16 v[110:111], v63 offset:4608
    ds_read_b64_tr_b16 v[112:113], v60 offset:8192
    ds_read_b64_tr_b16 v[114:115], v60 offset:8704
    ds_read_b64_tr_b16 v[116:117], v61 offset:8192
    ds_read_b64_tr_b16 v[118:119], v61 offset:8704
    ds_read_b64_tr_b16 v[120:121], v62 offset:8192
    ds_read_b64_tr_b16 v[122:123], v62 offset:8704
    ds_read_b64_tr_b16 v[124:125], v63 offset:8192
    ds_read_b64_tr_b16 v[126:127], v63 offset:8704
    ds_read_b64_tr_b16 v[128:129], v60 offset:12288
    ds_read_b64_tr_b16 v[130:131], v60 offset:12800
    ds_read_b64_tr_b16 v[132:133], v61 offset:12288
    ds_read_b64_tr_b16 v[134:135], v61 offset:12800
    ds_read_b64_tr_b16 v[136:137], v62 offset:12288
    ds_read_b64_tr_b16 v[138:139], v62 offset:12800
    ds_read_b64_tr_b16 v[140:141], v63 offset:12288
    ds_read_b64_tr_b16 v[142:143], v63 offset:12800
    ds_read_b64_tr_b16 v[144:145], v60 offset:16384
    ds_read_b64_tr_b16 v[146:147], v60 offset:16896
    ds_read_b64_tr_b16 v[148:149], v61 offset:16384
    ds_read_b64_tr_b16 v[150:151], v61 offset:16896
    ds_read_b64_tr_b16 v[152:153], v62 offset:16384
    ds_read_b64_tr_b16 v[154:155], v62 offset:16896
    ds_read_b64_tr_b16 v[156:157], v63 offset:16384
    ds_read_b64_tr_b16 v[158:159], v63 offset:16896
    s_cmp_eq_u32 s97, 0
    s_cbranch_scc1 L_u_mm
    s_branch L_poll_3
L_poll_3s:
    s_sleep 8
L_poll_3:
    buffer_load_dwordx4 v[8:11], v5, s[40:43], s63 offen offset:0 sc1
    buffer_load_dwordx4 v[12:15], v5, s[40:43], s63 offen offset:1024 sc1
    buffer_load_dwordx4 v[16:19], v5, s[40:43], s63 offen offset:2048 sc1
    buffer_load_dwordx4 v[20:23], v5, s[40:43], s63 offen offset:3072 sc1
    buffer_load_dwordx4 v[24:27], v5, s[40:43], s12 offen offset:0 sc1
    s_sub_u32 s60, s60, 1
    s_cbranch_scc1 L_poll_3t
    s_waitcnt vmcnt(0)
    v_max3_u32 v37, v8, v9, v10
    v_max3_u32 v37, v37, v11, v12
    v_max3_u32 v37, v37, v13, v14
    v_max3_u32 v37, v37, v15, v16
    v_max3_u32 v37, v37, v17, v18
    v_max3_u32 v37, v37, v19, v20
    v_max3_u32 v37, v37, v21, v22
    v_max3_u32 v37, v37, v23, v24
    v_max3_u32 v37, v37, v25, v26
    v_max_u32 v37, v37, v27
    v_cmp_eq_u32 vcc, -1, v37
    s_cbranch_vccnz L_poll_3s
L_poll_3e:
L_u_got:
L_u_mm:
    s_waitcnt lgkmcnt(0)
    v_mfma_f32_16x16x32_bf16 v[40:43], v[80:83], v[8:11], 0
    v_mfma_f32_16x16x32_bf16 v[44:47], v[84:87], v[8:11], 0
    v_mfma_f32_16x16x32_bf16 v[48:51], v[88:91], v[8:11], 0
    v_mfma_f32_16x16x32_bf16 v[52:55], v[92:95], v[8:11], 0
    v_mfma_f32_16x16x32_bf16 v[40:43], v[96:99], v[12:15], v[40:43]
    v_mfma_f32_16x16x32_bf16 v[44:47], v[100:103], v[12:15], v[44:47]
    v_mfma_f32_16x16x32_bf16 v[48:51], v[104:107], v[12:15], v[48:51]
    v_mfma_f32_16x16x32_bf16 v[52:55], v[108:111], v[12:15], v[52:55]
    v_mfma_f32_16x16x32_bf16 v[40:43], v[112:115], v[16:19], v[40:43]
    v_mfma_f32_16x16x32_bf16 v[44:47], v[116:119], v[16:19], v[44:47]
    v_mfma_f32_16x16x32_bf16 v[48:51], v[120:123], v[16:19], v[48:51]
    v_mfma_f32_16x16x32_bf16 v[52:55], v[124:127], v[16:19], v[52:55]
    v_mfma_f32_16x16x32_bf16 v[40:43], v[128:131], v[20:23], v[40:43]
    v_mfma_f32_16x16x32_bf16 v[44:47], v[132:135], v[20:23], v[44:47]
    v_mfma_f32_16x16x32_bf16 v[48:51], v[136:139], v[20:23], v[48:51]
    v_mfma_f32_16x16x32_bf16 v[52:55], v[140:143], v[20:23], v[52:55]
    v_mfma_f32_16x16x32_bf16 v[40:43], v[144:147], v[24:27], v[40:43]
    v_mfma_f32_16x16x32_bf16 v[44:47], v[148:151], v[24:27], v[44:47]
    v_mfma_f32_16x16x32_bf16 v[48:51], v[152:155], v[24:27], v[48:51]
    v_mfma_f32_16x16x32_bf16 v[52:55], v[156:159], v[24:27], v[52:55]
    v_lshlrev_b32 v5, 4, v0
    v_add_u32 v5, 147456, v5
    s_lshl_b32 s62, s3, 10
    s_add_u32 s62, s62, 147456
    v_lshl_add_u32 v6, v69, 4, s62
    v_mov_b32 v24, s58
    v_mov_b32 v32, 162056
    v_mov_b32 v33, 1
    v_add_f32_dpp v40, v40, v40 row_ror:8 row_mask:0xf bank_mask:0xf
    v_add_f32_dpp v41, v41, v41 row_ror:8 row_mask:0xf bank_mask:0xf
    v_add_f32_dpp v42, v42, v42 row_ror:8 row_mask:0xf bank_mask:0xf
    v_add_f32_dpp v43, v43, v43 row_ror:8 row_mask:0xf bank_mask:0xf
    v_add_f32_dpp v44, v44, v44 row_ror:8 row_mask:0xf bank_mask:0xf
    v_add_f32_dpp v45, v45, v45 row_ror:8 row_mask:0xf bank_mask:0xf
    v_add_f32_dpp v46, v46, v46 row_ror:8 row_mask:0xf bank_mask:0xf
    v_add_f32_dpp v47, v47, v47 row_ror:8 row_mask:0xf bank_mask:0xf
    v_add_f32_dpp v48, v48, v48 row_ror:8 row_mask:0xf bank_mask:0xf
    v_add_f32_dpp v49, v49, v49 row_ror:8 row_mask:0xf bank_mask:0xf
    v_add_f32_dpp v50, v50, v50 row_ror:8 row_mask:0xf bank_mask:0xf
    v_add_f32_dpp v51, v51, v51 row_ror:8 row_mask:0xf bank_mask:0xf
    v_add_f32_dpp v52, v52, v52 row_ror:8 row_mask:0xf bank_mask:0xf
    v_add_f32_dpp v53, v53, v53 row_ror:8 row_mask:0xf bank_mask:0xf
    v_add_f32_dpp v54, v54, v54 row_ror:8 row_mask:0xf bank_mask:0xf
    v_add_f32_dpp v55, v55, v55 row_ror:8 row_mask:0xf bank_mask:0xf
    v_add_f32_dpp v28, v40, v40 row_ror:4 row_mask:0xf bank_mask:0x1
    v_add_f32_dpp v29, v41, v41 row_ror:4 row_mask:0xf bank_mask:0x1
    v_add_f32_dpp v30, v42, v42 row_ror:4 row_mask:0xf bank_mask:0x1
    v_add_f32_dpp v31, v43, v43 row_ror:4 row_mask:0xf bank_mask:0x1
    v_add_f32_dpp v28, v44, v44 row_ror:4 row_mask:0xf bank_mask:0x2
    v_add_f32_dpp v29, v45, v45 row_ror:4 row_mask:0xf bank_mask:0x2
    v_add_f32_dpp v30, v46, v46 row_ror:4 row_mask:0xf bank_mask:0x2
    v_add_f32_dpp v31, v47, v47 row_ror:4 row_mask:0xf bank_mask:0x2
    v_add_f32_dpp v28, v48, v48 row_ror:4 row_mask:0xf bank_mask:0x4
    v_add_f32_dpp v29, v49, v49 row_ror:4 row_mask:0xf bank_mask:0x4
    v_add_f32_dpp v30, v50, v50 row_ror:4 row_mask:0xf bank_mask:0x4
    v_add_f32_dpp v31, v51, v51 row_ror:4 row_mask:0xf bank_mask:0x4
    v_add_f32_dpp v28, v52, v52 row_ror:4 row_mask:0xf bank_mask:0x8
    v_add_f32_dpp v29, v53, v53 row_ror:4 row_mask:0xf bank_mask:0x8
    v_add_f32_dpp v30, v54, v54 row_ror:4 row_mask:0xf bank_mask:0x8
    v_add_f32_dpp v31, v55, v55 row_ror:4 row_mask:0xf bank_mask:0x8
    v_fma_f32 v28, v28, s59, v24
    v_fma_f32 v29, v29, s59, v24
    v_fma_f32 v30, v30, s59, v24
    v_fma_f32 v31, v31, s59, v24
    v_mul_f32 v28, v28, v56
    v_mul_f32 v29, v29, v57
    v_mul_f32 v30, v30, v58
    v_mul_f32 v31, v31, v59
    ds_write_b128 v6, v[28:31]
    s_mov_b64 exec, 1
    ds_add_rtn_u32 v34, v32, v33
    s_mov_b64 exec, -1
    ds_read_b128 v[8:11], v5
    ds_read_b128 v[12:15], v5 offset:1024
    ds_read_b128 v[16:19], v5 offset:2048
    ds_read_b128 v[20:23], v5 offset:3072
    s_waitcnt lgkmcnt(0)
    v_readfirstlane_b32 s62, v34
    s_nop 0
    s_cmp_eq_u32 s62, s15
    s_cbranch_scc1 L_u_last
    s_cmp_eq_u32 s62, 1
    s_cbranch_scc1 L_service
    s_endpgm
L_u_last:
    v_add_f32 v8, v8, v12
    v_add_f32 v9, v9, v13
    v_add_f32 v10, v10, v14
    v_add_f32 v11, v11, v15
    s_cmp_eq_u32 s15, 1
    s_cbranch_scc1 L_u_two
    v_add_f32 v16, v16, v20
    v_add_f32 v17, v17, v21
    v_add_f32 v18, v18, v22
    v_add_f32 v19, v19, v23
    v_add_f32 v8, v8, v16
    v_add_f32 v9, v9, v17
    v_add_f32 v10, v10, v18
    v_add_f32 v11, v11, v19
L_u_two:
    v_cvt_pk_bf16_f32 v8, v8, v9
    v_cvt_pk_bf16_f32 v9, v10, v11
    s_waitcnt vmcnt(0)
    v_cmp_ne_u32 vcc, -1, v68
    s_cbranch_vccz L_u_st
L_wy_4:
    buffer_load_dword v68, v65, s[44:47], 0 offen sc1
    s_waitcnt vmcnt(0)
    v_cmp_ne_u32 vcc, -1, v68
    s_cbranch_vccz L_wy_4e
    s_sleep 4
    s_sub_u32 s60, s60, 1
    s_cbranch_scc0 L_wy_4
    s_mov_b32 s60, 0
L_wy_4e:
L_u_st:
    buffer_store_dwordx2 v[8:9], v64, s[40:43], s57 offen sc1
    s_endpgm
L_touch:
    s_load_dword s0, s[32:33], 0
    s_load_dword s0, s[30:31], 0
    s_cmp_eq_u32 s39, 1
    s_cbranch_scc1 L_tpr
    s_mov_b32 s62, 16777216
    s_load_dword s0, s[8:9], s62
    s_mov_b32 s62, 83886080
    s_load_dword s0, s[8:9], s62
    s_mov_b32 s62, 150994944
    s_load_dword s0, s[8:9], s62
    s_mov_b32 s62, 218103808
    s_load_dword s0, s[8:9], s62
    s_branch L_tpv
L_tpr:
    s_load_dword s0, s[20:21], 0
    s_mov_b32 s62, 2211836
    s_load_dword s0, s[20:21], s62
    s_load_dword s0, s[16:17], 0
    s_mov_b32 s62, 2211836
    s_load_dword s0, s[16:17], s62
    s_load_dword s0, s[18:19], 0
    s_load_dword s0, s[22:23], 0
    s_load_dword s0, s[28:29], 0
    s_load_dword s0, s[4:5], 0
L_tpv:
    s_lshl_b32 s62, s34, 23
    s_load_dword s0, s[8:9], s62
    s_add_u32 s62, s62, 67108864
    s_load_dword s0, s[8:9], s62
    s_add_u32 s62, s62, 67108864
    s_load_dword s0, s[8:9], s62
    s_add_u32 s62, s62, 67108864
    s_load_dword s0, s[8:9], s62
    s_add_u32 s62, s62, 67108864
    s_branch L_notp
L_stream2:
    s_mov_b32 s12, s100
    s_mov_b32 s13, s101
    s_mov_b32 s40, s32
    s_mov_b32 s41, s33
    s_mov_b32 s42, 589824
    s_mov_b32 s43, 0x20000
    s_mov_b32 s44, s30
    s_mov_b32 s45, s31
    s_mov_b32 s46, 256
    s_mov_b32 s47, 0x20000
    s_bitcmp1_b32 s3, 0
    s_mov_b32 s57, 0xffffffff
    s_mov_b32 s58, 0xffff
    s_mov_b32 s14, 0xffffffff
    s_mov_b32 s15, 0x0
L_pm_10:
    s_cmp_lt_u32 s56, 104
    s_cbranch_scc0 L_pm_11
    s_bitcmp1_b32 s3, 0
    s_mov_b32 s57, 0xffff
    s_mov_b32 s58, 0x0
    s_mov_b32 s14, 0xffffffff
    s_mov_b32 s15, 0x0
L_pm_11:
    s_sub_u32 s96, s56, 43
    s_and_b32 s96, s96, 0xffffffc7
    s_cmp_eq_u32 s96, 0
    s_cbranch_scc0 L_pm_12
    s_bitcmp1_b32 s3, 0
    s_mov_b32 s57, 0x0
    s_mov_b32 s58, 0x0
    s_mov_b32 s14, 0x0
    s_mov_b32 s15, 0x0
L_pm_12:
    s_cmp_lt_u32 s56, 40
    s_cbranch_scc0 L_pm_13
    s_bitcmp1_b32 s3, 0
    s_mov_b32 s57, 0xffffffff
    s_mov_b32 s58, 0xf
    s_mov_b32 s14, 0xffffffff
    s_mov_b32 s15, 0x0
L_pm_13:
    s_cmp_eq_u32 s39, 1
    s_cbranch_scc0 L_pm_14
    s_bitcmp1_b32 s3, 0
    s_mov_b32 s57, 0xff
    s_mov_b32 s58, 0xff
    s_mov_b32 s14, 0xff00ff
    s_cselect_b32 s14, 0xff00ff00, s14
    s_mov_b32 s15, 0x0
L_pm_14:
    s_cmp_lg_u32 s13, 0
    s_cbranch_scc0 L_pm_15
    s_bitcmp1_b32 s3, 0
    s_mov_b32 s57, 0xffffffff
    s_mov_b32 s58, 0x0
    s_mov_b32 s14, 0x0
    s_mov_b32 s15, 0x0
L_pm_15:
    s_and_b32 s96, s39, s59
    s_cbranch_scc0 L_pm_16
    s_bitcmp1_b32 s3, 0
    s_mov_b32 s57, 0x3ff
    s_mov_b32 s58, 0x3ff
    s_mov_b32 s14, 0x0
    s_mov_b32 s15, 0x0
L_pm_16:
    s_add_u32 s52, s8, s63
    s_addc_u32 s53, s9, 0
    s_mov_b32 s54, 262144
    s_mov_b32 s55, 0x20000
    v_and_b32 v2, 15, v0
    v_lshrrev_b32 v3, 1, v2
    v_and_b32 v37, 1, v2
    v_lshlrev_b32 v37, 4, v37
    v_mov_b32 v38, 0xffff
    v_lshlrev_b32 v37, v37, v38
    v_cmp_eq_u32 vcc, 0, v3
    v_mov_b32 v32, 0
    s_nop 0
    v_cndmask_b32 v20, 0, v37, vcc
    v_cmp_eq_u32 vcc, 1, v3
    v_mov_b32 v33, 0
    s_nop 0
    v_cndmask_b32 v21, 0, v37, vcc
    v_cmp_eq_u32 vcc, 2, v3
    v_mov_b32 v34, 0
    s_nop 0
    v_cndmask_b32 v22, 0, v37, vcc
    v_cmp_eq_u32 vcc, 3, v3
    v_mov_b32 v35, 0
    s_nop 0
    v_cndmask_b32 v23, 0, v37, vcc
    v_lshlrev_b32 v2, 4, v2
    s_lshl_b32 s98, s62, 8
    s_add_u32 s98, s98, 40960
    s_bitcmp0_b32 s57, 2
    s_cbranch_scc1 L_sf_17
    s_bitcmp0_b32 s58, 2
    s_cbranch_scc1 L_sf_17
    s_waitcnt vmcnt(1)
L_sf_17:
    buffer_load_dwordx4 v[48:51], v1, s[48:51], s97 offen offset:2048 nt
    s_bitcmp0_b32 s57, 3
    s_cbranch_scc1 L_sf_18
    s_waitcnt vmcnt(2)
    s_bitcmp0_b32 s58, 3
    s_cbranch_scc1 L_sf_18
    s_waitcnt vmcnt(1)
L_sf_18:
    buffer_load_dwordx4 v[52:55], v1, s[48:51], s97 offen offset:3072 nt
    s_add_u32 s97, s97, 32768
    v_add_u32 v1, 4096, v1
    v_and_b32 v1, 0x7fff, v1
    s_waitcnt vmcnt(3)
    s_bitcmp0_b32 s57, 4
    s_cbranch_scc1 L_sf_19
    s_waitcnt vmcnt(2)
    s_bitcmp0_b32 s58, 4
    s_cbranch_scc1 L_sf_19
    s_waitcnt vmcnt(1)
L_sf_19:
    buffer_load_dwordx4 v[56:59], v1, s[48:51], s97 offen offset:0 nt
    s_waitcnt vmcnt(3)
    s_bitcmp0_b32 s57, 5
    s_cbranch_scc1 L_sf_20
    s_waitcnt vmcnt(2)
    s_bitcmp0_b32 s58, 5
    s_cbranch_scc1 L_sf_20
    s_waitcnt vmcnt(1)
L_sf_20:
    buffer_load_dwordx4 v[60:63], v1, s[48:51], s97 offen offset:1024 nt
    s_waitcnt vmcnt(3)
    s_bitcmp0_b32 s57, 6
    s_cbranch_scc1 L_sf_21
    s_waitcnt vmcnt(2)
    s_bitcmp0_b32 s58, 6
    s_cbranch_scc1 L_sf_21
    s_waitcnt vmcnt(1)
L_sf_21:
    buffer_load_dwordx4 v[64:67], v1, s[48:51], s97 offen offset:2048 nt
    s_waitcnt vmcnt(3)
    s_bitcmp0_b32 s57, 7
    s_cbranch_scc1 L_sf_22
    s_waitcnt vmcnt(2)
    s_bitcmp0_b32 s58, 7
    s_cbranch_scc1 L_sf_22
    s_waitcnt vmcnt(1)
L_sf_22:
    buffer_load_dwordx4 v[68:71], v1, s[48:51], s97 offen offset:3072 nt
    s_add_u32 s97, s97, 32768
    v_add_u32 v1, 4096, v1
    v_and_b32 v1, 0x7fff, v1
    s_waitcnt vmcnt(3)
    s_bitcmp0_b32 s57, 8
    s_cbranch_scc1 L_sf_23
    s_waitcnt vmcnt(2)
    s_bitcmp0_b32 s58, 8
    s_cbranch_scc1 L_sf_23
    s_waitcnt vmcnt(1)
L_sf_23:
    buffer_load_dwordx4 v[72:75], v1, s[48:51], s97 offen offset:0 nt
    s_waitcnt vmcnt(3)
    s_bitcmp0_b32 s57, 9
    s_cbranch_scc1 L_sf_24
    s_waitcnt vmcnt(2)
    s_bitcmp0_b32 s58, 9
    s_cbranch_scc1 L_sf_24
    s_waitcnt vmcnt(1)
L_sf_24:
    buffer_load_dwordx4 v[76:79], v1, s[48:51], s97 offen offset:1024 nt
    s_waitcnt vmcnt(3)
    s_bitcmp0_b32 s57, 10
    s_cbranch_scc1 L_sf_25
    s_waitcnt vmcnt(2)
    s_bitcmp0_b32 s58, 10
    s_cbranch_scc1 L_sf_25
    s_waitcnt vmcnt(1)
L_sf_25:
    buffer_load_dwordx4 v[80:83], v1, s[48:51], s97 offen offset:2048 nt
    s_waitcnt vmcnt(3)
    s_bitcmp0_b32 s57, 11
    s_cbranch_scc1 L_sf_26
    s_waitcnt vmcnt(2)
    s_bitcmp0_b32 s58, 11
    s_cbranch_scc1 L_sf_26
    s_waitcnt vmcnt(1)
L_sf_26:
    buffer_load_dwordx4 v[84:87], v1, s[48:51], s97 offen offset:3072 nt
    s_add_u32 s97, s97, 32768
    v_add_u32 v1, 4096, v1
    v_and_b32 v1, 0x7fff, v1
    s_waitcnt vmcnt(3)
    s_bitcmp0_b32 s57, 12
    s_cbranch_scc1 L_sf_27
    s_waitcnt vmcnt(2)
    s_bitcmp0_b32 s58, 12
    s_cbranch_scc1 L_sf_27
    s_waitcnt vmcnt(1)
L_sf_27:
    buffer_load_dwordx4 v[88:91], v1, s[48:51], s97 offen offset:0 nt
    s_waitcnt vmcnt(3)
    s_bitcmp0_b32 s57, 13
    s_cbranch_scc1 L_sf_28
    s_waitcnt vmcnt(2)
    s_bitcmp0_b32 s58, 13
    s_cbranch_scc1 L_sf_28
    s_waitcnt vmcnt(1)
L_sf_28:
    buffer_load_dwordx4 v[92:95], v1, s[48:51], s97 offen offset:1024 nt
    s_waitcnt vmcnt(3)
    s_bitcmp0_b32 s57, 14
    s_cbranch_scc1 L_sf_29
    s_waitcnt vmcnt(2)
    s_bitcmp0_b32 s58, 14
    s_cbranch_scc1 L_sf_29
    s_waitcnt vmcnt(1)
L_sf_29:
    buffer_load_dwordx4 v[96:99], v1, s[48:51], s97 offen offset:2048 nt
    s_waitcnt vmcnt(3)
    s_bitcmp0_b32 s57, 15
    s_cbranch_scc1 L_sf_30
    s_waitcnt vmcnt(2)
    s_bitcmp0_b32 s58, 15
    s_cbranch_scc1 L_sf_30
    s_waitcnt vmcnt(1)
L_sf_30:
    buffer_load_dwordx4 v[100:103], v1, s[48:51], s97 offen offset:3072 nt
    s_add_u32 s97, s97, 32768
    v_add_u32 v1, 4096, v1
    v_and_b32 v1, 0x7fff, v1
    s_waitcnt vmcnt(3)
    s_bitcmp0_b32 s57, 16
    s_cbranch_scc1 L_sf_31
    s_waitcnt vmcnt(2)
    s_bitcmp0_b32 s58, 16
    s_cbranch_scc1 L_sf_31
    s_waitcnt vmcnt(1)
L_sf_31:
    buffer_load_dwordx4 v[104:107], v1, s[48:51], s97 offen offset:0 nt
    s_waitcnt vmcnt(3)
    s_bitcmp0_b32 s57, 17
    s_cbranch_scc1 L_sf_32
    s_waitcnt vmcnt(2)
    s_bitcmp0_b32 s58, 17
    s_cbranch_scc1 L_sf_32
    s_waitcnt vmcnt(1)
L_sf_32:
    buffer_load_dwordx4 v[108:111], v1, s[48:51], s97 offen offset:1024 nt
    s_waitcnt vmcnt(3)
    s_bitcmp0_b32 s57, 18
    s_cbranch_scc1 L_sf_33
    s_waitcnt vmcnt(2)
    s_bitcmp0_b32 s58, 18
    s_cbranch_scc1 L_sf_33
    s_waitcnt vmcnt(1)
L_sf_33:
    buffer_load_dwordx4 v[112:115], v1, s[48:51], s97 offen offset:2048 nt
    s_waitcnt vmcnt(3)
    s_bitcmp0_b32 s57, 19
    s_cbranch_scc1 L_sf_34
    s_waitcnt vmcnt(2)
    s_bitcmp0_b32 s58, 19
    s_cbranch_scc1 L_sf_34
    s_waitcnt vmcnt(1)
L_sf_34:
    buffer_load_dwordx4 v[116:119], v1, s[48:51], s97 offen offset:3072 nt
    s_add_u32 s97, s97, 32768
    v_add_u32 v1, 4096, v1
    v_and_b32 v1, 0x7fff, v1
    s_waitcnt vmcnt(3)
    s_bitcmp0_b32 s57, 20
    s_cbranch_scc1 L_sf_35
    s_waitcnt vmcnt(2)
    s_bitcmp0_b32 s58, 20
    s_cbranch_scc1 L_sf_35
    s_waitcnt vmcnt(1)
L_sf_35:
    buffer_load_dwordx4 v[120:123], v1, s[48:51], s97 offen offset:0 nt
    s_waitcnt vmcnt(3)
    s_bitcmp0_b32 s57, 21
    s_cbranch_scc1 L_sf_36
    s_waitcnt vmcnt(2)
    s_bitcmp0_b32 s58, 21
    s_cbranch_scc1 L_sf_36
    s_waitcnt vmcnt(1)
L_sf_36:
    buffer_load_dwordx4 v[124:127], v1, s[48:51], s97 offen offset:1024 nt
    s_cmp_eq_u32 s12, -1
    s_cbranch_scc1 L_k_nopf
    s_waitcnt vmcnt(3)
    s_bitcmp0_b32 s57, 22
    s_cbranch_scc1 L_sf_37
    s_waitcnt vmcnt(2)
    s_bitcmp0_b32 s58, 22
    s_cbranch_scc1 L_sf_37
    s_waitcnt vmcnt(1)
L_sf_37:
    buffer_load_dwordx4 v[128:131], v1, s[48:51], s97 offen offset:2048 nt
    s_waitcnt vmcnt(3)
    s_bitcmp0_b32 s57, 23
    s_cbranch_scc1 L_sf_38
    s_waitcnt vmcnt(2)
    s_bitcmp0_b32 s58, 23
    s_cbranch_scc1 L_sf_38
    s_waitcnt vmcnt(1)
L_sf_38:
    buffer_load_dwordx4 v[132:135], v1, s[48:51], s97 offen offset:3072 nt
    s_add_u32 s97, s97, 32768
    v_add_u32 v1, 4096, v1
    v_and_b32 v1, 0x7fff, v1
    s_waitcnt vmcnt(3)
    s_bitcmp0_b32 s57, 24
    s_cbranch_scc1 L_sf_39
    s_waitcnt vmcnt(2)
    s_bitcmp0_b32 s58, 24
    s_cbranch_scc1 L_sf_39
    s_waitcnt vmcnt(1)
L_sf_39:
    buffer_load_dwordx4 v[136:139], v1, s[48:51], s97 offen offset:0 nt
    s_waitcnt vmcnt(3)
    s_bitcmp0_b32 s57, 25
    s_cbranch_scc1 L_sf_40
    s_waitcnt vmcnt(2)
    s_bitcmp0_b32 s58, 25
    s_cbranch_scc1 L_sf_40
    s_waitcnt vmcnt(1)
L_sf_40:
    buffer_load_dwordx4 v[140:143], v1, s[48:51], s97 offen offset:1024 nt
    s_waitcnt vmcnt(3)
    s_bitcmp0_b32 s57, 26
    s_cbranch_scc1 L_sf_41
    s_waitcnt vmcnt(2)
    s_bitcmp0_b32 s58, 26
    s_cbranch_scc1 L_sf_41
    s_waitcnt vmcnt(1)
L_sf_41:
    buffer_load_dwordx4 v[144:147], v1, s[48:51], s97 offen offset:2048 nt
    s_waitcnt vmcnt(3)
    s_bitcmp0_b32 s57, 27
    s_cbranch_scc1 L_sf_42
    s_waitcnt vmcnt(2)
    s_bitcmp0_b32 s58, 27
    s_cbranch_scc1 L_sf_42
    s_waitcnt vmcnt(1)
L_sf_42:
    buffer_load_dwordx4 v[148:151], v1, s[48:51], s97 offen offset:3072 nt
    s_add_u32 s97, s97, 32768
    v_add_u32 v1, 4096, v1
    v_and_b32 v1, 0x7fff, v1
    s_waitcnt vmcnt(3)
    s_bitcmp0_b32 s57, 28
    s_cbranch_scc1 L_sf_43
    s_waitcnt vmcnt(2)
    s_bitcmp0_b32 s58, 28
    s_cbranch_scc1 L_sf_43
    s_waitcnt vmcnt(1)
L_sf_43:
    buffer_load_dwordx4 v[152:155], v1, s[48:51], s97 offen offset:0 nt
    s_waitcnt vmcnt(3)
    s_bitcmp0_b32 s57, 29
    s_cbranch_scc1 L_sf_44
    s_waitcnt vmcnt(2)
    s_bitcmp0_b32 s58, 29
    s_cbranch_scc1 L_sf_44
    s_waitcnt vmcnt(1)
L_sf_44:
    buffer_load_dwordx4 v[156:159], v1, s[48:51], s97 offen offset:1024 nt
    s_waitcnt vmcnt(3)
    s_bitcmp0_b32 s57, 30
    s_cbranch_scc1 L_sf_45
    s_waitcnt vmcnt(2)
    s_bitcmp0_b32 s58, 30
    s_cbranch_scc1 L_sf_45
    s_waitcnt vmcnt(1)
L_sf_45:
    buffer_load_dwordx4 v[160:163], v1, s[48:51], s97 offen offset:2048 nt
    v_min_u32 v39, 15, v0
    v_and_b32 v38, 1, v39
    v_mul_u32_u24 v38, 126, v38
    v_lshl_add_u32 v39, v39, 1, v38
    buffer_load_dword v37, v39, s[44:47], 0 offen sc1
    s_waitcnt vmcnt(4)
    s_bitcmp0_b32 s57, 31
    s_cbranch_scc1 L_sf_46
    s_waitcnt vmcnt(3)
    s_bitcmp0_b32 s58, 31
    s_cbranch_scc1 L_sf_46
    s_waitcnt vmcnt(2)
L_sf_46:
    buffer_load_dwordx4 v[164:167], v1, s[48:51], s97 offen offset:3072 nt
    s_mov_b32 s97, 0
    v_add_u32 v1, 4096, v1
    v_and_b32 v1, 0x7fff, v1
    s_waitcnt vmcnt(4)
    s_bitcmp0_b32 s14, 0
    s_cbranch_scc1 L_sf_47
    s_waitcnt vmcnt(3)
    s_bitcmp0_b32 s15, 0
    s_cbranch_scc1 L_sf_47
    s_waitcnt vmcnt(2)
L_sf_47:
    s_add_u32 m0, s12, 0
    s_nop 0
    buffer_load_dwordx4 v1, s[52:55], s97 offen offset:0 nt lds
    s_waitcnt vmcnt(4)
    s_bitcmp0_b32 s14, 1
    s_cbranch_scc1 L_sf_48
    s_waitcnt vmcnt(3)
    s_bitcmp0_b32 s15, 1
    s_cbranch_scc1 L_sf_48
    s_waitcnt vmcnt(1)
L_sf_48:
    buffer_load_dwordx4 v1, s[52:55], s97 offen offset:1024 nt lds
    s_waitcnt vmcnt(4)
    s_bitcmp0_b32 s14, 2
    s_cbranch_scc1 L_sf_49
    s_waitcnt vmcnt(2)
    s_bitcmp0_b32 s15, 2
    s_cbranch_scc1 L_sf_49
    s_waitcnt vmcnt(1)
L_sf_49:
    buffer_load_dwordx4 v1, s[52:55], s97 offen offset:2048 nt lds
    s_waitcnt vmcnt(3)
    s_bitcmp0_b32 s14, 3
    s_cbranch_scc1 L_sf_50
    s_waitcnt vmcnt(2)
    s_bitcmp0_b32 s15, 3
    s_cbranch_scc1 L_sf_50
    s_waitcnt vmcnt(1)
L_sf_50:
    buffer_load_dwordx4 v1, s[52:55], s97 offen offset:3072 nt lds
    s_add_u32 s97, s97, 32768
    v_add_u32 v1, 4096, v1
    v_and_b32 v1, 0x7fff, v1
    v_cmp_eq_u32 vcc, 0, v37
    s_nop 0
    s_or_b32 s96, vcc_lo, vcc_hi
    buffer_load_dwordx4 v[4:7], v2, s[40:43], s98 offen sc1
    s_waitcnt vmcnt(4)
    s_bitcmp0_b32 s14, 4
    s_cbranch_scc1 L_sf_51
    s_waitcnt vmcnt(3)
    s_bitcmp0_b32 s15, 4
    s_cbranch_scc1 L_sf_51
    s_waitcnt vmcnt(2)
L_sf_51:
    s_add_u32 m0, s12, 4096
    s_nop 0
    buffer_load_dwordx4 v1, s[52:55], s97 offen offset:0 nt lds
    s_waitcnt vmcnt(4)
    s_bitcmp0_b32 s14, 5
    s_cbranch_scc1 L_sf_52
    s_waitcnt vmcnt(3)
    s_bitcmp0_b32 s15, 5
    s_cbranch_scc1 L_sf_52
    s_waitcnt vmcnt(2)
L_sf_52:
    buffer_load_dwordx4 v1, s[52:55], s97 offen offset:1024 nt lds
    s_waitcnt vmcnt(4)
    s_bitcmp0_b32 s14, 6
    s_cbranch_scc1 L_sf_53
    s_waitcnt vmcnt(3)
    s_bitcmp0_b32 s15, 6
    s_cbranch_scc1 L_sf_53
    s_waitcnt vmcnt(1)
L_sf_53:
    buffer_load_dwordx4 v1, s[52:55], s97 offen offset:2048 nt lds
    s_waitcnt vmcnt(4)
    s_bitcmp0_b32 s14, 7
    s_cbranch_scc1 L_sf_54
    s_waitcnt vmcnt(2)
    s_bitcmp0_b32 s15, 7
    s_cbranch_scc1 L_sf_54
    s_waitcnt vmcnt(1)
L_sf_54:
    buffer_load_dwordx4 v1, s[52:55], s97 offen offset:3072 nt lds
    s_add_u32 s97, s97, 32768
    v_add_u32 v1, 4096, v1
    v_and_b32 v1, 0x7fff, v1
L_k_join:
    s_waitcnt vmcnt(4)
    v_max3_u32 v38, v4, v5, v6
    v_max_u32 v38, v38, v7
    v_cmp_eq_u32 vcc, -1, v38
    s_cmp_lg_u32 s96, 0
    s_cbranch_scc1 L_qslow
    s_cbranch_vccnz L_qslow2
L_qok:
    v_dot2_f32_bf16 v8, v72, v4, 0
    v_dot2_f32_bf16 v9, v76, v4, 0
    v_dot2_f32_bf16 v10, v80, v4, 0
    v_dot2_f32_bf16 v11, v84, v4, 0
    v_dot2_f32_bf16 v24, v88, v4, 0
    v_dot2_f32_bf16 v25, v92, v4, 0
    v_dot2_f32_bf16 v26, v96, v4, 0
    v_dot2_f32_bf16 v27, v100, v4, 0
    v_dot2_f32_bf16 v8, v73, v5, v8
    v_dot2_f32_bf16 v9, v77, v5, v9
    v_dot2_f32_bf16 v10, v81, v5, v10
    v_dot2_f32_bf16 v11, v85, v5, v11
    v_dot2_f32_bf16 v24, v89, v5, v24
    v_dot2_f32_bf16 v25, v93, v5, v25
    v_dot2_f32_bf16 v26, v97, v5, v26
    v_dot2_f32_bf16 v27, v101, v5, v27
    v_dot2_f32_bf16 v8, v74, v6, v8
    v_dot2_f32_bf16 v9, v78, v6, v9
    v_dot2_f32_bf16 v10, v82, v6, v10
    v_dot2_f32_bf16 v11, v86, v6, v11
    v_dot2_f32_bf16 v24, v90, v6, v24
    v_dot2_f32_bf16 v25, v94, v6, v25
    v_dot2_f32_bf16 v26, v98, v6, v26
    v_dot2_f32_bf16 v27, v102, v6, v27
    v_dot2_f32_bf16 v8, v75, v7, v8
    v_dot2_f32_bf16 v9, v79, v7, v9
    v_dot2_f32_bf16 v10, v83, v7, v10
    v_dot2_f32_bf16 v11, v87, v7, v11
    v_dot2_f32_bf16 v24, v91, v7, v24
    v_dot2_f32_bf16 v25, v95, v7, v25
    v_dot2_f32_bf16 v26, v99, v7, v26
    v_dot2_f32_bf16 v27, v103, v7, v27
    v_add_f32_dpp v8, v8, v8 row_ror:8 row_mask:0xf bank_mask:0x3
    v_add_f32_dpp v10, v10, v10 row_ror:8 row_mask:0xf bank_mask:0x3
    v_add_f32_dpp v24, v24, v24 row_ror:8 row_mask:0xf bank_mask:0x3
    v_add_f32_dpp v26, v26, v26 row_ror:8 row_mask:0xf bank_mask:0x3
    v_add_f32_dpp v8, v9, v9 row_ror:8 row_mask:0xf bank_mask:0xc
    v_add_f32_dpp v10, v11, v11 row_ror:8 row_mask:0xf bank_mask:0xc
    v_add_f32_dpp v24, v25, v25 row_ror:8 row_mask:0xf bank_mask:0xc
    v_add_f32_dpp v26, v27, v27 row_ror:8 row_mask:0xf bank_mask:0xc
    v_add_f32_dpp v14, v8, v8 row_half_mirror row_mask:0xf bank_mask:0x5
    v_add_f32_dpp v15, v24, v24 row_half_mirror row_mask:0xf bank_mask:0x5
    v_add_f32_dpp v14, v10, v10 row_half_mirror row_mask:0xf bank_mask:0xa
    v_add_f32_dpp v15, v26, v26 row_half_mirror row_mask:0xf bank_mask:0xa
    s_nop 0
    v_add_f32_dpp v14, v14, v14 quad_perm:[1,0,3,2] row_mask:0xf bank_mask:0xf
    v_add_f32_dpp v15, v15, v15 quad_perm:[1,0,3,2] row_mask:0xf bank_mask:0xf
    s_nop 0
    v_add_f32_dpp v14, v14, v14 quad_perm:[2,3,0,1] row_mask:0xf bank_mask:0xf
    v_add_f32_dpp v15, v15, v15 quad_perm:[2,3,0,1] row_mask:0xf bank_mask:0xf
    s_waitcnt vmcnt(3)
    s_bitcmp0_b32 s14, 8
    s_cbranch_scc1 L_sf_65
    s_waitcnt vmcnt(2)
    s_bitcmp0_b32 s15, 8
    s_cbranch_scc1 L_sf_65
    s_waitcnt vmcnt(1)
L_sf_65:
    buffer_load_dwordx4 v[72:75], v1, s[52:55], s97 offen offset:0 nt
    v_dot2_f32_bf16 v8, v40, v4, 0
    v_dot2_f32_bf16 v9, v44, v4, 0
    v_dot2_f32_bf16 v10, v48, v4, 0
    v_dot2_f32_bf16 v11, v52, v4, 0
    v_dot2_f32_bf16 v24, v56, v4, 0
    v_dot2_f32_bf16 v25, v60, v4, 0
    v_dot2_f32_bf16 v26, v64, v4, 0
    v_dot2_f32_bf16 v27, v68, v4, 0
    v_dot2_f32_bf16 v28, v104, v4, 0
    v_dot2_f32_bf16 v29, v108, v4, 0
    v_dot2_f32_bf16 v30, v112, v4, 0
    v_dot2_f32_bf16 v31, v116, v4, 0
    v_dot2_f32_bf16 v8, v41, v5, v8
    v_dot2_f32_bf16 v9, v45, v5, v9
    v_dot2_f32_bf16 v10, v49, v5, v10
    v_dot2_f32_bf16 v11, v53, v5, v11
    v_dot2_f32_bf16 v24, v57, v5, v24
    v_dot2_f32_bf16 v25, v61, v5, v25
    v_dot2_f32_bf16 v26, v65, v5, v26
    v_dot2_f32_bf16 v27, v69, v5, v27
    v_dot2_f32_bf16 v28, v105, v5, v28
    v_dot2_f32_bf16 v29, v109, v5, v29
    v_dot2_f32_bf16 v30, v113, v5, v30
    v_dot2_f32_bf16 v31, v117, v5, v31
    v_dot2_f32_bf16 v8, v42, v6, v8
    v_dot2_f32_bf16 v9, v46, v6, v9
    v_dot2_f32_bf16 v10, v50, v6, v10
    v_dot2_f32_bf16 v11, v54, v6, v11
    v_dot2_f32_bf16 v24, v58, v6, v24
    v_dot2_f32_bf16 v25, v62, v6, v25
    v_dot2_f32_bf16 v26, v66, v6, v26
    v_dot2_f32_bf16 v27, v70, v6, v27
    v_dot2_f32_bf16 v28, v106, v6, v28
    v_dot2_f32_bf16 v29, v110, v6, v29
    v_dot2_f32_bf16 v30, v114, v6, v30
    v_dot2_f32_bf16 v31, v118, v6, v31
    v_dot2_f32_bf16 v8, v43, v7, v8
    v_dot2_f32_bf16 v9, v47, v7, v9
    v_dot2_f32_bf16 v10, v51, v7, v10
    v_dot2_f32_bf16 v11, v55, v7, v11
    v_dot2_f32_bf16 v24, v59, v7, v24
    v_dot2_f32_bf16 v25, v63, v7, v25
    v_dot2_f32_bf16 v26, v67, v7, v26
    v_dot2_f32_bf16 v27, v71, v7, v27
    v_dot2_f32_bf16 v28, v107, v7, v28
    v_dot2_f32_bf16 v29, v111, v7, v29
    v_dot2_f32_bf16 v30, v115, v7, v30
    v_dot2_f32_bf16 v31, v119, v7, v31
    v_add_f32_dpp v8, v8, v8 row_ror:8 row_mask:0xf bank_mask:0x3
    v_add_f32_dpp v10, v10, v10 row_ror:8 row_mask:0xf bank_mask:0x3
    v_add_f32_dpp v24, v24, v24 row_ror:8 row_mask:0xf bank_mask:0x3
    v_add_f32_dpp v26, v26, v26 row_ror:8 row_mask:0xf bank_mask:0x3
    v_add_f32_dpp v28, v28, v28 row_ror:8 row_mask:0xf bank_mask:0x3
    v_add_f32_dpp v30, v30, v30 row_ror:8 row_mask:0xf bank_mask:0x3
    v_add_f32_dpp v8, v9, v9 row_ror:8 row_mask:0xf bank_mask:0xc
    v_add_f32_dpp v10, v11, v11 row_ror:8 row_mask:0xf bank_mask:0xc
    v_add_f32_dpp v24, v25, v25 row_ror:8 row_mask:0xf bank_mask:0xc
    v_add_f32_dpp v26, v27, v27 row_ror:8 row_mask:0xf bank_mask:0xc
    v_add_f32_dpp v28, v29, v29 row_ror:8 row_mask:0xf bank_mask:0xc
    v_add_f32_dpp v30, v31, v31 row_ror:8 row_mask:0xf bank_mask:0xc
    v_add_f32_dpp v12, v8, v8 row_half_mirror row_mask:0xf bank_mask:0x5
    v_add_f32_dpp v13, v24, v24 row_half_mirror row_mask:0xf bank_mask:0x5
    v_add_f32_dpp v16, v28, v28 row_half_mirror row_mask:0xf bank_mask:0x5
    v_add_f32_dpp v12, v10, v10 row_half_mirror row_mask:0xf bank_mask:0xa
    v_add_f32_dpp v13, v26, v26 row_half_mirror row_mask:0xf bank_mask:0xa
    v_add_f32_dpp v16, v30, v30 row_half_mirror row_mask:0xf bank_mask:0xa
    v_add_f32_dpp v12, v12, v12 quad_perm:[1,0,3,2] row_mask:0xf bank_mask:0xf
    v_add_f32_dpp v13, v13, v13 quad_perm:[1,0,3,2] row_mask:0xf bank_mask:0xf
    v_add_f32_dpp v16, v16, v16 quad_perm:[1,0,3,2] row_mask:0xf bank_mask:0xf
    v_add_f32_dpp v12, v12, v12 quad_perm:[2,3,0,1] row_mask:0xf bank_mask:0xf
    v_add_f32_dpp v13, v13, v13 quad_perm:[2,3,0,1] row_mask:0xf bank_mask:0xf
    v_add_f32_dpp v16, v16, v16 quad_perm:[2,3,0,1] row_mask:0xf bank_mask:0xf
    s_waitcnt vmcnt(3)
    s_bitcmp0_b32 s14, 9
    s_cbranch_scc1 L_sf_66
    s_waitcnt vmcnt(2)
    s_bitcmp0_b32 s15, 9
    s_cbranch_scc1 L_sf_66
    s_waitcnt vmcnt(1)
L_sf_66:
    buffer_load_dwordx4 v[76:79], v1, s[52:55], s97 offen offset:1024 nt
    v_dot2_f32_bf16 v8, v120, v4, 0
    v_dot2_f32_bf16 v9, v124, v4, 0
    v_dot2_f32_bf16 v10, v128, v4, 0
    v_dot2_f32_bf16 v11, v132, v4, 0
    v_dot2_f32_bf16 v24, v136, v4, 0
    v_dot2_f32_bf16 v25, v140, v4, 0
    v_dot2_f32_bf16 v26, v144, v4, 0
    v_dot2_f32_bf16 v27, v148, v4, 0
    v_dot2_f32_bf16 v8, v121, v5, v8
    v_dot2_f32_bf16 v9, v125, v5, v9
    v_dot2_f32_bf16 v10, v129, v5, v10
    v_dot2_f32_bf16 v11, v133, v5, v11
    v_dot2_f32_bf16 v24, v137, v5, v24
    v_dot2_f32_bf16 v25, v141, v5, v25
    v_dot2_f32_bf16 v26, v145, v5, v26
    v_dot2_f32_bf16 v27, v149, v5, v27
    v_dot2_f32_bf16 v8, v122, v6, v8
    v_dot2_f32_bf16 v9, v126, v6, v9
    v_dot2_f32_bf16 v10, v130, v6, v10
    v_dot2_f32_bf16 v11, v134, v6, v11
    v_dot2_f32_bf16 v24, v138, v6, v24
    v_dot2_f32_bf16 v25, v142, v6, v25
    v_dot2_f32_bf16 v26, v146, v6, v26
    v_dot2_f32_bf16 v27, v150, v6, v27
    v_dot2_f32_bf16 v8, v123, v7, v8
    v_dot2_f32_bf16 v9, v127, v7, v9
    v_dot2_f32_bf16 v10, v131, v7, v10
    v_dot2_f32_bf16 v11, v135, v7, v11
    v_dot2_f32_bf16 v24, v139, v7, v24
    v_dot2_f32_bf16 v25, v143, v7, v25
    v_dot2_f32_bf16 v26, v147, v7, v26
    v_dot2_f32_bf16 v27, v151, v7, v27
    v_add_f32_dpp v8, v8, v8 row_ror:8 row_mask:0xf bank_mask:0x3
    v_add_f32_dpp v10, v10, v10 row_ror:8 row_mask:0xf bank_mask:0x3
    v_add_f32_dpp v24, v24, v24 row_ror:8 row_mask:0xf bank_mask:0x3
    v_add_f32_dpp v26, v26, v26 row_ror:8 row_mask:0xf bank_mask:0x3
    v_add_f32_dpp v8, v9, v9 row_ror:8 row_mask:0xf bank_mask:0xc
    v_add_f32_dpp v10, v11, v11 row_ror:8 row_mask:0xf bank_mask:0xc
    v_add_f32_dpp v24, v25, v25 row_ror:8 row_mask:0xf bank_mask:0xc
    v_add_f32_dpp v26, v27, v27 row_ror:8 row_mask:0xf bank_mask:0xc
    v_add_f32_dpp v17, v8, v8 row_half_mirror row_mask:0xf bank_mask:0x5
    v_add_f32_dpp v18, v24, v24 row_half_mirror row_mask:0xf bank_mask:0x5
    v_add_f32_dpp v17, v10, v10 row_half_mirror row_mask:0xf bank_mask:0xa
    v_add_f32_dpp v18, v26, v26 row_half_mirror row_mask:0xf bank_mask:0xa
    s_nop 0
    v_add_f32_dpp v17, v17, v17 quad_perm:[1,0,3,2] row_mask:0xf bank_mask:0xf
    v_add_f32_dpp v18, v18, v18 quad_perm:[1,0,3,2] row_mask:0xf bank_mask:0xf
    s_nop 0
    v_add_f32_dpp v17, v17, v17 quad_perm:[2,3,0,1] row_mask:0xf bank_mask:0xf
    v_add_f32_dpp v18, v18, v18 quad_perm:[2,3,0,1] row_mask:0xf bank_mask:0xf
    s_waitcnt vmcnt(3)
    s_bitcmp0_b32 s14, 10
    s_cbranch_scc1 L_sf_67
    s_waitcnt vmcnt(2)
    s_bitcmp0_b32 s15, 10
    s_cbranch_scc1 L_sf_67
    s_waitcnt vmcnt(1)
L_sf_67:
    buffer_load_dwordx4 v[80:83], v1, s[52:55], s97 offen offset:2048 nt
    s_waitcnt vmcnt(3)
    s_bitcmp0_b32 s14, 11
    s_cbranch_scc1 L_sf_68
    s_waitcnt vmcnt(2)
    s_bitcmp0_b32 s15, 11
    s_cbranch_scc1 L_sf_68
    s_waitcnt vmcnt(1)
L_sf_68:
    buffer_load_dwordx4 v[84:87], v1, s[52:55], s97 offen offset:3072 nt
    s_add_u32 s97, s97, 32768
    v_add_u32 v1, 4096, v1
    v_and_b32 v1, 0x7fff, v1
    s_cmp_eq_u32 s12, -1
    s_cbranch_scc1 L_nopfrd
    v_lshl_add_u32 v38, v0, 4, s12
    ds_read_b128 v[40:43], v38 offset:0
    ds_read_b128 v[44:47], v38 offset:1024
    ds_read_b128 v[48:51], v38 offset:2048
    ds_read_b128 v[52:55], v38 offset:3072
    ds_read_b128 v[56:59], v38 offset:4096
    ds_read_b128 v[60:63], v38 offset:5120
    ds_read_b128 v[64:67], v38 offset:6144
    ds_read_b128 v[68:71], v38 offset:7168
L_nopfrd:
    v_dot2_f32_bf16 v8, v152, v4, 0
    v_dot2_f32_bf16 v9, v156, v4, 0
    v_dot2_f32_bf16 v10, v160, v4, 0
    v_dot2_f32_bf16 v11, v164, v4, 0
    v_dot2_f32_bf16 v8, v153, v5, v8
    v_dot2_f32_bf16 v9, v157, v5, v9
    v_dot2_f32_bf16 v10, v161, v5, v10
    v_dot2_f32_bf16 v11, v165, v5, v11
    v_dot2_f32_bf16 v8, v154, v6, v8
    v_dot2_f32_bf16 v9, v158, v6, v9
    v_dot2_f32_bf16 v10, v162, v6, v10
    v_dot2_f32_bf16 v11, v166, v6, v11
    v_dot2_f32_bf16 v8, v155, v7, v8
    v_dot2_f32_bf16 v9, v159, v7, v9
    v_dot2_f32_bf16 v10, v163, v7, v10
    v_dot2_f32_bf16 v11, v167, v7, v11
    v_add_f32_dpp v8, v8, v8 row_ror:8 row_mask:0xf bank_mask:0x3
    s_nop 0
    v_add_f32_dpp v10, v10, v10 row_ror:8 row_mask:0xf bank_mask:0x3
    v_add_f32_dpp v8, v9, v9 row_ror:8 row_mask:0xf bank_mask:0xc
    v_add_f32_dpp v10, v11, v11 row_ror:8 row_mask:0xf bank_mask:0xc
    s_nop 0
    v_add_f32_dpp v19, v8, v8 row_half_mirror row_mask:0xf bank_mask:0x5
    v_add_f32_dpp v19, v10, v10 row_half_mirror row_mask:0xf bank_mask:0xa
    s_nop 1
    v_add_f32_dpp v19, v19, v19 quad_perm:[1,0,3,2] row_mask:0xf bank_mask:0xf
    s_nop 1
    v_add_f32_dpp v19, v19, v19 quad_perm:[2,3,0,1] row_mask:0xf bank_mask:0xf
    v_max3_f32 v3, v12, v13, v14
    v_max3_f32 v8, v15, v16, v17
    v_max3_f32 v3, v3, v18, v19
    v_max_f32 v3, v3, v8
    s_nop 1
    v_max_f32_dpp v3, v3, v3 row_ror:4 row_mask:0xf bank_mask:0xf
    s_nop 1
    v_max_f32_dpp v3, v3, v3 row_ror:8 row_mask:0xf bank_mask:0xf
    v_mov_b32 v8, v3
    s_nop 1
    v_permlane16_swap_b32 v3, v8
    v_max_f32 v3, v3, v8
    v_mov_b32 v8, v3
    s_nop 1
    v_permlane32_swap_b32 v3, v8
    v_max_f32 v3, v3, v8
    s_mov_b32 s96, 0x3e0293ee
    v_mul_f32 v8, s96, v3
    v_fma_f32 v12, v12, s96, -v8
    v_fma_f32 v13, v13, s96, -v8
    v_fma_f32 v14, v14, s96, -v8
    v_fma_f32 v15, v15, s96, -v8
    v_fma_f32 v16, v16, s96, -v8
    v_fma_f32 v17, v17, s96, -v8
    v_fma_f32 v18, v18, s96, -v8
    v_fma_f32 v19, v19, s96, -v8
    v_exp_f32 v12, v12
    v_exp_f32 v13, v13
    v_exp_f32 v14, v14
    v_exp_f32 v15, v15
    v_exp_f32 v16, v16
    v_exp_f32 v17, v17
    v_exp_f32 v18, v18
    v_exp_f32 v19, v19
    v_add_f32 v9, v12, v13
    v_add_f32 v10, v14, v15
    v_add_f32 v11, v16, v17
    v_add_f32 v3, v18, v19
    v_add_f32 v9, v9, v10
    v_add_f32 v3, v3, v11
    v_add_f32 v9, v9, v3
    v_cvt_pk_bf16_f32 v12, v12, v12
    v_cvt_pk_bf16_f32 v13, v13, v13
    v_cvt_pk_bf16_f32 v14, v14, v14
    v_cvt_pk_bf16_f32 v15, v15, v15
    v_cvt_pk_bf16_f32 v16, v16, v16
    v_cvt_pk_bf16_f32 v17, v17, v17
    v_cvt_pk_bf16_f32 v18, v18, v18
    v_cvt_pk_bf16_f32 v19, v19, v19
    v_add_f32_dpp v9, v9, v9 row_ror:4 row_mask:0xf bank_mask:0xf
    s_nop 1
    v_add_f32_dpp v9, v9, v9 row_ror:8 row_mask:0xf bank_mask:0xf
    v_mov_b32 v10, v9
    s_nop 1
    v_permlane16_swap_b32 v9, v10
    v_add_f32 v9, v9, v10
    v_mov_b32 v10, v9
    s_nop 1
    v_permlane32_swap_b32 v9, v10
    v_add_f32 v9, v9, v10
    s_mov_b64 exec, 1
    s_cmp_lg_u32 s13, 0
    s_cbranch_scc1 L_mljob
    s_lshl_b32 s96, s3, 3
    s_add_u32 s96, s96, 161920
    v_mov_b32 v10, s96
    v_mov_b32 v11, 162068
    v_mov_b32 v3, 1
    ds_write_b64 v10, v[8:9]
    ds_add_u32 v11, v3
L_mldone:
    s_mov_b64 exec, -1
    v_lshrrev_b32 v2, 1, v2
    v_and_b32_dpp v24, v14, v20 row_newbcast:0 row_mask:0xf bank_mask:0xf
    v_and_b32_dpp v25, v14, v21 row_newbcast:0 row_mask:0xf bank_mask:0xf
    v_and_b32_dpp v26, v14, v22 row_newbcast:0 row_mask:0xf bank_mask:0xf
    v_and_b32_dpp v27, v14, v23 row_newbcast:0 row_mask:0xf bank_mask:0xf
    s_waitcnt vmcnt(3)
    s_bitcmp0_b32 s14, 12
    s_cbranch_scc1 L_sf_69
    s_waitcnt vmcnt(2)
    s_bitcmp0_b32 s15, 12
    s_cbranch_scc1 L_sf_69
    s_waitcnt vmcnt(1)
L_sf_69:
    buffer_load_dwordx4 v[88:91], v1, s[52:55], s97 offen offset:0 nt
    v_mfma_f32_16x16x32_bf16 v[32:35], v[24:27], v[72:75], v[32:35]
    s_cmp_eq_u32 s12, -1
    s_cbranch_scc1 L_nopfpv8
    s_waitcnt lgkmcnt(0)
    v_and_b32_dpp v24, v12, v20 row_newbcast:0 row_mask:0xf bank_mask:0xf
    v_and_b32_dpp v25, v12, v21 row_newbcast:0 row_mask:0xf bank_mask:0xf
    v_and_b32_dpp v26, v12, v22 row_newbcast:0 row_mask:0xf bank_mask:0xf
    v_and_b32_dpp v27, v12, v23 row_newbcast:0 row_mask:0xf bank_mask:0xf
    s_nop 1
    v_mfma_f32_16x16x32_bf16 v[32:35], v[24:27], v[40:43], v[32:35]
    v_and_b32_dpp v28, v12, v20 row_newbcast:8 row_mask:0xf bank_mask:0xf
    v_and_b32_dpp v29, v12, v21 row_newbcast:8 row_mask:0xf bank_mask:0xf
    v_and_b32_dpp v30, v12, v22 row_newbcast:8 row_mask:0xf bank_mask:0xf
    v_and_b32_dpp v31, v12, v23 row_newbcast:8 row_mask:0xf bank_mask:0xf
    s_nop 1
    v_mfma_f32_16x16x32_bf16 v[32:35], v[28:31], v[44:47], v[32:35]
    v_and_b32_dpp v24, v12, v20 row_newbcast:4 row_mask:0xf bank_mask:0xf
    v_and_b32_dpp v25, v12, v21 row_newbcast:4 row_mask:0xf bank_mask:0xf
    v_and_b32_dpp v26, v12, v22 row_newbcast:4 row_mask:0xf bank_mask:0xf
    v_and_b32_dpp v27, v12, v23 row_newbcast:4 row_mask:0xf bank_mask:0xf
    s_nop 1
    v_mfma_f32_16x16x32_bf16 v[32:35], v[24:27], v[48:51], v[32:35]
    v_and_b32_dpp v28, v12, v20 row_newbcast:12 row_mask:0xf bank_mask:0xf
    v_and_b32_dpp v29, v12, v21 row_newbcast:12 row_mask:0xf bank_mask:0xf
    v_and_b32_dpp v30, v12, v22 row_newbcast:12 row_mask:0xf bank_mask:0xf
    v_and_b32_dpp v31, v12, v23 row_newbcast:12 row_mask:0xf bank_mask:0xf
    s_nop 1
    v_mfma_f32_16x16x32_bf16 v[32:35], v[28:31], v[52:55], v[32:35]
L_nopfpv8:
    v_and_b32_dpp v28, v14, v20 row_newbcast:8 row_mask:0xf bank_mask:0xf
    v_and_b32_dpp v29, v14, v21 row_newbcast:8 row_mask:0xf bank_mask:0xf
    v_and_b32_dpp v30, v14, v22 row_newbcast:8 row_mask:0xf bank_mask:0xf
    v_and_b32_dpp v31, v14, v23 row_newbcast:8 row_mask:0xf bank_mask:0xf
    s_waitcnt vmcnt(3)
    s_bitcmp0_b32 s14, 13
    s_cbranch_scc1 L_sf_70
    s_waitcnt vmcnt(2)
    s_bitcmp0_b32 s15, 13
    s_cbranch_scc1 L_sf_70
    s_waitcnt vmcnt(1)
L_sf_70:
    buffer_load_dwordx4 v[92:95], v1, s[52:55], s97 offen offset:1024 nt
    v_mfma_f32_16x16x32_bf16 v[32:35], v[28:31], v[76:79], v[32:35]
    s_cmp_eq_u32 s12, -1
    s_cbranch_scc1 L_nopfpv9
    s_waitcnt lgkmcnt(0)
    v_and_b32_dpp v24, v13, v20 row_newbcast:0 row_mask:0xf bank_mask:0xf
    v_and_b32_dpp v25, v13, v21 row_newbcast:0 row_mask:0xf bank_mask:0xf
    v_and_b32_dpp v26, v13, v22 row_newbcast:0 row_mask:0xf bank_mask:0xf
    v_and_b32_dpp v27, v13, v23 row_newbcast:0 row_mask:0xf bank_mask:0xf
    s_nop 1
    v_mfma_f32_16x16x32_bf16 v[32:35], v[24:27], v[56:59], v[32:35]
    v_and_b32_dpp v28, v13, v20 row_newbcast:8 row_mask:0xf bank_mask:0xf
    v_and_b32_dpp v29, v13, v21 row_newbcast:8 row_mask:0xf bank_mask:0xf
    v_and_b32_dpp v30, v13, v22 row_newbcast:8 row_mask:0xf bank_mask:0xf
    v_and_b32_dpp v31, v13, v23 row_newbcast:8 row_mask:0xf bank_mask:0xf
    s_nop 1
    v_mfma_f32_16x16x32_bf16 v[32:35], v[28:31], v[60:63], v[32:35]
    v_and_b32_dpp v24, v13, v20 row_newbcast:4 row_mask:0xf bank_mask:0xf
    v_and_b32_dpp v25, v13, v21 row_newbcast:4 row_mask:0xf bank_mask:0xf
    v_and_b32_dpp v26, v13, v22 row_newbcast:4 row_mask:0xf bank_mask:0xf
    v_and_b32_dpp v27, v13, v23 row_newbcast:4 row_mask:0xf bank_mask:0xf
    s_nop 1
    v_mfma_f32_16x16x32_bf16 v[32:35], v[24:27], v[64:67], v[32:35]
    v_and_b32_dpp v28, v13, v20 row_newbcast:12 row_mask:0xf bank_mask:0xf
    v_and_b32_dpp v29, v13, v21 row_newbcast:12 row_mask:0xf bank_mask:0xf
    v_and_b32_dpp v30, v13, v22 row_newbcast:12 row_mask:0xf bank_mask:0xf
    v_and_b32_dpp v31, v13, v23 row_newbcast:12 row_mask:0xf bank_mask:0xf
    s_nop 1
    v_mfma_f32_16x16x32_bf16 v[32:35], v[28:31], v[68:71], v[32:35]
L_nopfpv9:
    v_and_b32_dpp v24, v14, v20 row_newbcast:4 row_mask:0xf bank_mask:0xf
    v_and_b32_dpp v25, v14, v21 row_newbcast:4 row_mask:0xf bank_mask:0xf
    v_and_b32_dpp v26, v14, v22 row_newbcast:4 row_mask:0xf bank_mask:0xf
    v_and_b32_dpp v27, v14, v23 row_newbcast:4 row_mask:0xf bank_mask:0xf
    s_waitcnt vmcnt(3)
    s_bitcmp0_b32 s14, 14
    s_cbranch_scc1 L_sf_71
    s_waitcnt vmcnt(2)
    s_bitcmp0_b32 s15, 14
    s_cbranch_scc1 L_sf_71
    s_waitcnt vmcnt(1)
L_sf_71:
    buffer_load_dwordx4 v[96:99], v1, s[52:55], s97 offen offset:2048 nt
    v_mfma_f32_16x16x32_bf16 v[32:35], v[24:27], v[80:83], v[32:35]
    v_and_b32_dpp v28, v14, v20 row_newbcast:12 row_mask:0xf bank_mask:0xf
    v_and_b32_dpp v29, v14, v21 row_newbcast:12 row_mask:0xf bank_mask:0xf
    v_and_b32_dpp v30, v14, v22 row_newbcast:12 row_mask:0xf bank_mask:0xf
    v_and_b32_dpp v31, v14, v23 row_newbcast:12 row_mask:0xf bank_mask:0xf
    s_waitcnt vmcnt(3)
    s_bitcmp0_b32 s14, 15
    s_cbranch_scc1 L_sf_72
    s_waitcnt vmcnt(2)
    s_bitcmp0_b32 s15, 15
    s_cbranch_scc1 L_sf_72
    s_waitcnt vmcnt(1)
L_sf_72:
    buffer_load_dwordx4 v[100:103], v1, s[52:55], s97 offen offset:3072 nt
    s_add_u32 s97, s97, 32768
    v_add_u32 v1, 4096, v1
    v_and_b32 v1, 0x7fff, v1
    v_mfma_f32_16x16x32_bf16 v[32:35], v[28:31], v[84:87], v[32:35]
    v_and_b32_dpp v24, v15, v20 row_newbcast:0 row_mask:0xf bank_mask:0xf
    v_and_b32_dpp v25, v15, v21 row_newbcast:0 row_mask:0xf bank_mask:0xf
    v_and_b32_dpp v26, v15, v22 row_newbcast:0 row_mask:0xf bank_mask:0xf
    v_and_b32_dpp v27, v15, v23 row_newbcast:0 row_mask:0xf bank_mask:0xf
    s_waitcnt vmcnt(3)
    s_bitcmp0_b32 s14, 16
    s_cbranch_scc1 L_sf_73
    s_waitcnt vmcnt(2)
    s_bitcmp0_b32 s15, 16
    s_cbranch_scc1 L_sf_73
    s_waitcnt vmcnt(1)
L_sf_73:
    buffer_load_dwordx4 v[104:107], v1, s[52:55], s97 offen offset:0 nt
    v_mfma_f32_16x16x32_bf16 v[32:35], v[24:27], v[88:91], v[32:35]
    v_and_b32_dpp v28, v15, v20 row_newbcast:8 row_mask:0xf bank_mask:0xf
    v_and_b32_dpp v29, v15, v21 row_newbcast:8 row_mask:0xf bank_mask:0xf
    v_and_b32_dpp v30, v15, v22 row_newbcast:8 row_mask:0xf bank_mask:0xf
    v_and_b32_dpp v31, v15, v23 row_newbcast:8 row_mask:0xf bank_mask:0xf
    s_waitcnt vmcnt(3)
    s_bitcmp0_b32 s14, 17
    s_cbranch_scc1 L_sf_74
    s_waitcnt vmcnt(2)
    s_bitcmp0_b32 s15, 17
    s_cbranch_scc1 L_sf_74
    s_waitcnt vmcnt(1)
L_sf_74:
    buffer_load_dwordx4 v[108:111], v1, s[52:55], s97 offen offset:1024 nt
    v_mfma_f32_16x16x32_bf16 v[32:35], v[28:31], v[92:95], v[32:35]
    v_and_b32_dpp v24, v15, v20 row_newbcast:4 row_mask:0xf bank_mask:0xf
    v_and_b32_dpp v25, v15, v21 row_newbcast:4 row_mask:0xf bank_mask:0xf
    v_and_b32_dpp v26, v15, v22 row_newbcast:4 row_mask:0xf bank_mask:0xf
    v_and_b32_dpp v27, v15, v23 row_newbcast:4 row_mask:0xf bank_mask:0xf
    s_waitcnt vmcnt(3)
    s_bitcmp0_b32 s14, 18
    s_cbranch_scc1 L_sf_75
    s_waitcnt vmcnt(2)
    s_bitcmp0_b32 s15, 18
    s_cbranch_scc1 L_sf_75
    s_waitcnt vmcnt(1)
L_sf_75:
    buffer_load_dwordx4 v[112:115], v1, s[52:55], s97 offen offset:2048 nt
    v_mfma_f32_16x16x32_bf16 v[32:35], v[24:27], v[96:99], v[32:35]
    v_and_b32_dpp v28, v15, v20 row_newbcast:12 row_mask:0xf bank_mask:0xf
    v_and_b32_dpp v29, v15, v21 row_newbcast:12 row_mask:0xf bank_mask:0xf
    v_and_b32_dpp v30, v15, v22 row_newbcast:12 row_mask:0xf bank_mask:0xf
    v_and_b32_dpp v31, v15, v23 row_newbcast:12 row_mask:0xf bank_mask:0xf
    s_waitcnt vmcnt(3)
    s_bitcmp0_b32 s14, 19
    s_cbranch_scc1 L_sf_76
    s_waitcnt vmcnt(2)
    s_bitcmp0_b32 s15, 19
    s_cbranch_scc1 L_sf_76
    s_waitcnt vmcnt(1)
L_sf_76:
    buffer_load_dwordx4 v[116:119], v1, s[52:55], s97 offen offset:3072 nt
    s_add_u32 s97, s97, 32768
    v_add_u32 v1, 4096, v1
    v_and_b32 v1, 0x7fff, v1
    v_mfma_f32_16x16x32_bf16 v[32:35], v[28:31], v[100:103], v[32:35]
    v_and_b32_dpp v24, v16, v20 row_newbcast:0 row_mask:0xf bank_mask:0xf
    v_and_b32_dpp v25, v16, v21 row_newbcast:0 row_mask:0xf bank_mask:0xf
    v_and_b32_dpp v26, v16, v22 row_newbcast:0 row_mask:0xf bank_mask:0xf
    v_and_b32_dpp v27, v16, v23 row_newbcast:0 row_mask:0xf bank_mask:0xf
    s_waitcnt vmcnt(3)
    s_bitcmp0_b32 s14, 20
    s_cbranch_scc1 L_sf_77
    s_waitcnt vmcnt(2)
    s_bitcmp0_b32 s15, 20
    s_cbranch_scc1 L_sf_77
    s_waitcnt vmcnt(1)
L_sf_77:
    buffer_load_dwordx4 v[120:123], v1, s[52:55], s97 offen offset:0 nt
    v_mfma_f32_16x16x32_bf16 v[32:35], v[24:27], v[104:107], v[32:35]
    v_and_b32_dpp v28, v16, v20 row_newbcast:8 row_mask:0xf bank_mask:0xf
    v_and_b32_dpp v29, v16, v21 row_newbcast:8 row_mask:0xf bank_mask:0xf
    v_and_b32_dpp v30, v16, v22 row_newbcast:8 row_mask:0xf bank_mask:0xf
    v_and_b32_dpp v31, v16, v23 row_newbcast:8 row_mask:0xf bank_mask:0xf
    s_waitcnt vmcnt(3)
    s_bitcmp0_b32 s14, 21
    s_cbranch_scc1 L_sf_78
    s_waitcnt vmcnt(2)
    s_bitcmp0_b32 s15, 21
    s_cbranch_scc1 L_sf_78
    s_waitcnt vmcnt(1)
L_sf_78:
    buffer_load_dwordx4 v[124:127], v1, s[52:55], s97 offen offset:1024 nt
    v_mfma_f32_16x16x32_bf16 v[32:35], v[28:31], v[108:111], v[32:35]
    v_and_b32_dpp v24, v16, v20 row_newbcast:4 row_mask:0xf bank_mask:0xf
    v_and_b32_dpp v25, v16, v21 row_newbcast:4 row_mask:0xf bank_mask:0xf
    v_and_b32_dpp v26, v16, v22 row_newbcast:4 row_mask:0xf bank_mask:0xf
    v_and_b32_dpp v27, v16, v23 row_newbcast:4 row_mask:0xf bank_mask:0xf
    s_waitcnt vmcnt(3)
    s_bitcmp0_b32 s14, 22
    s_cbranch_scc1 L_sf_79
    s_waitcnt vmcnt(2)
    s_bitcmp0_b32 s15, 22
    s_cbranch_scc1 L_sf_79
    s_waitcnt vmcnt(1)
L_sf_79:
    buffer_load_dwordx4 v[128:131], v1, s[52:55], s97 offen offset:2048 nt
    v_mfma_f32_16x16x32_bf16 v[32:35], v[24:27], v[112:115], v[32:35]
    v_and_b32_dpp v28, v16, v20 row_newbcast:12 row_mask:0xf bank_mask:0xf
    v_and_b32_dpp v29, v16, v21 row_newbcast:12 row_mask:0xf bank_mask:0xf
    v_and_b32_dpp v30, v16, v22 row_newbcast:12 row_mask:0xf bank_mask:0xf
    v_and_b32_dpp v31, v16, v23 row_newbcast:12 row_mask:0xf bank_mask:0xf
    s_waitcnt vmcnt(3)
    s_bitcmp0_b32 s14, 23
    s_cbranch_scc1 L_sf_80
    s_waitcnt vmcnt(2)
    s_bitcmp0_b32 s15, 23
    s_cbranch_scc1 L_sf_80
    s_waitcnt vmcnt(1)
L_sf_80:
    buffer_load_dwordx4 v[132:135], v1, s[52:55], s97 offen offset:3072 nt
    s_add_u32 s97, s97, 32768
    v_add_u32 v1, 4096, v1
    v_and_b32 v1, 0x7fff, v1
    v_mfma_f32_16x16x32_bf16 v[32:35], v[28:31], v[116:119], v[32:35]
    v_and_b32_dpp v24, v17, v20 row_newbcast:0 row_mask:0xf bank_mask:0xf
    v_and_b32_dpp v25, v17, v21 row_newbcast:0 row_mask:0xf bank_mask:0xf
    v_and_b32_dpp v26, v17, v22 row_newbcast:0 row_mask:0xf bank_mask:0xf
    v_and_b32_dpp v27, v17, v23 row_newbcast:0 row_mask:0xf bank_mask:0xf
    s_waitcnt vmcnt(3)
    s_bitcmp0_b32 s14, 24
    s_cbranch_scc1 L_sf_81
    s_waitcnt vmcnt(2)
    s_bitcmp0_b32 s15, 24
    s_cbranch_scc1 L_sf_81
    s_waitcnt vmcnt(1)
L_sf_81:
    buffer_load_dwordx4 v[136:139], v1, s[52:55], s97 offen offset:0 nt
    v_mfma_f32_16x16x32_bf16 v[32:35], v[24:27], v[120:123], v[32:35]
    s_or_b32 s96, s59, 0
    s_cbranch_scc0 L_nofrag_82
    v_mov_b32 v104, 162060
L_lw_83:
    ds_read_b32 v105, v104
    s_waitcnt lgkmcnt(0)
    v_cmp_gt_u32 vcc, 4, v105
    s_cbranch_vccz L_lw_83e
    s_sleep 2
    s_sub_u32 s60, s60, 1
    s_cbranch_scc0 L_lw_83
    s_mov_b32 s60, 0
L_lw_83e:
    s_cmp_eq_u32 s59, 0
    s_cbranch_scc1 L_nofrag_82
    v_bfe_u32 v104, v0, 2, 1
    v_bfe_u32 v110, v0, 4, 1
    v_lshl_add_u32 v104, v110, 2, v104
    v_and_b32 v110, 8, v0
    v_add_u32 v104, v104, v110
    v_lshrrev_b32 v110, 5, v0
    v_lshl_add_u32 v104, v110, 4, v104
    v_bfe_u32 v111, v0, 0, 1
    v_mul_u32_u24 v111, 0xaaaa, v111
    v_add_u32 v111, 0x4444, v111
    v_mov_b32 v112, 0
    v_mov_b32 v113, 0
    v_mov_b32 v114, 0
    v_mov_b32 v115, 0
    v_mov_b32 v116, 0
    v_mov_b32 v117, 0
    v_mov_b32 v118, 0
    v_mov_b32 v119, 0
    v_lshlrev_b32 v104, 7, v104
    v_and_b32 v110, 3, v0
    v_lshl_add_u32 v104, v110, 3, v104
    v_lshrrev_b32 v109, 4, v0
    v_and_b32 v110, 1, v0
    s_lshr_b32 s63, s3, 1
    s_and_b32 s62, s3, 1
    s_lshl_b32 s96, s63, 14
    s_lshl_b32 s100, s62, 6
    s_add_u32 s100, s100, 81920
    s_add_u32 s96, s96, s100
    v_add_u32 v104, s96, v104
    ds_read_b64_tr_b16 v[72:73], v104 offset:0
    ds_read_b64_tr_b16 v[74:75], v104 offset:256
    ds_read_b64_tr_b16 v[76:77], v104 offset:4096
    ds_read_b64_tr_b16 v[78:79], v104 offset:4352
    ds_read_b64_tr_b16 v[80:81], v104 offset:32
    ds_read_b64_tr_b16 v[82:83], v104 offset:288
    ds_read_b64_tr_b16 v[84:85], v104 offset:4128
    ds_read_b64_tr_b16 v[86:87], v104 offset:4384
    ds_read_b64_tr_b16 v[88:89], v104 offset:8192
    ds_read_b64_tr_b16 v[90:91], v104 offset:8448
    ds_read_b64_tr_b16 v[92:93], v104 offset:12288
    ds_read_b64_tr_b16 v[94:95], v104 offset:12544
    ds_read_b64_tr_b16 v[96:97], v104 offset:8224
    ds_read_b64_tr_b16 v[98:99], v104 offset:8480
    ds_read_b64_tr_b16 v[100:101], v104 offset:12320
    ds_read_b64_tr_b16 v[102:103], v104 offset:12576
    v_bfe_u32 v105, v0, 1, 3
    v_lshlrev_b32 v105, 8, v105
    v_lshl_add_u32 v105, v109, 5, v105
    v_lshl_add_u32 v105, v110, 4, v105
    v_lshrrev_b32 v106, 3, v0
    v_lshlrev_b32 v106, 7, v106
    v_and_b32 v110, 7, v0
    v_lshl_add_u32 v107, v110, 3, v106
    v_add_u32 v107, s100, v107
    v_lshlrev_b32 v106, 8, v109
    v_and_b32 v110, 15, v0
    v_lshl_add_u32 v106, v110, 2, v106
    v_add_u32 v106, s96, v106
    v_lshlrev_b32 v108, 2, v0
    s_lshl_b32 s96, s62, 2
    s_add_u32 s96, s96, 162088
    v_mov_b32 v109, s96
    s_lshl_b32 s100, s63, 11
    s_lshl_b32 s96, s34, 13
    s_add_u32 s100, s100, s96
    s_add_u32 s100, s100, 106496
    s_mul_i32 s101, s34, 5120
    s_lshl_b32 s96, s35, 9
    s_add_u32 s101, s101, s96
    s_lshl_b32 s96, s62, 8
    s_add_u32 s101, s101, s96
    s_sub_u32 s101, s101, 11264
    s_and_b32 s96, s101, 0xffffe000
    s_add_u32 s101, s101, s96
    s_add_u32 s101, s101, 212992
    v_add_u32 v110, 8192, v108
L_nofrag_82:
    v_and_b32_dpp v28, v17, v20 row_newbcast:8 row_mask:0xf bank_mask:0xf
    v_and_b32_dpp v29, v17, v21 row_newbcast:8 row_mask:0xf bank_mask:0xf
    v_and_b32_dpp v30, v17, v22 row_newbcast:8 row_mask:0xf bank_mask:0xf
    v_and_b32_dpp v31, v17, v23 row_newbcast:8 row_mask:0xf bank_mask:0xf
    s_waitcnt vmcnt(3)
    s_bitcmp0_b32 s14, 25
    s_cbranch_scc1 L_sf_84
    s_waitcnt vmcnt(2)
    s_bitcmp0_b32 s15, 25
    s_cbranch_scc1 L_sf_84
    s_waitcnt vmcnt(1)
L_sf_84:
    buffer_load_dwordx4 v[140:143], v1, s[52:55], s97 offen offset:1024 nt
    v_mfma_f32_16x16x32_bf16 v[32:35], v[28:31], v[124:127], v[32:35]
    v_and_b32_dpp v24, v17, v20 row_newbcast:4 row_mask:0xf bank_mask:0xf
    v_and_b32_dpp v25, v17, v21 row_newbcast:4 row_mask:0xf bank_mask:0xf
    v_and_b32_dpp v26, v17, v22 row_newbcast:4 row_mask:0xf bank_mask:0xf
    v_and_b32_dpp v27, v17, v23 row_newbcast:4 row_mask:0xf bank_mask:0xf
    s_waitcnt vmcnt(3)
    s_bitcmp0_b32 s14, 26
    s_cbranch_scc1 L_sf_85
    s_waitcnt vmcnt(2)
    s_bitcmp0_b32 s15, 26
    s_cbranch_scc1 L_sf_85
    s_waitcnt vmcnt(1)
L_sf_85:
    buffer_load_dwordx4 v[144:147], v1, s[52:55], s97 offen offset:2048 nt
    v_mfma_f32_16x16x32_bf16 v[32:35], v[24:27], v[128:131], v[32:35]
    v_and_b32_dpp v28, v17, v20 row_newbcast:12 row_mask:0xf bank_mask:0xf
    v_and_b32_dpp v29, v17, v21 row_newbcast:12 row_mask:0xf bank_mask:0xf
    v_and_b32_dpp v30, v17, v22 row_newbcast:12 row_mask:0xf bank_mask:0xf
    v_and_b32_dpp v31, v17, v23 row_newbcast:12 row_mask:0xf bank_mask:0xf
    s_waitcnt vmcnt(3)
    s_bitcmp0_b32 s14, 27
    s_cbranch_scc1 L_sf_86
    s_waitcnt vmcnt(2)
    s_bitcmp0_b32 s15, 27
    s_cbranch_scc1 L_sf_86
    s_waitcnt vmcnt(1)
L_sf_86:
    buffer_load_dwordx4 v[148:151], v1, s[52:55], s97 offen offset:3072 nt
    s_add_u32 s97, s97, 32768
    v_add_u32 v1, 4096, v1
    v_and_b32 v1, 0x7fff, v1
    v_mfma_f32_16x16x32_bf16 v[32:35], v[28:31], v[132:135], v[32:35]
    v_and_b32_dpp v24, v18, v20 row_newbcast:0 row_mask:0xf bank_mask:0xf
    v_and_b32_dpp v25, v18, v21 row_newbcast:0 row_mask:0xf bank_mask:0xf
    v_and_b32_dpp v26, v18, v22 row_newbcast:0 row_mask:0xf bank_mask:0xf
    v_and_b32_dpp v27, v18, v23 row_newbcast:0 row_mask:0xf bank_mask:0xf
    s_waitcnt vmcnt(3)
    s_bitcmp0_b32 s14, 28
    s_cbranch_scc1 L_sf_87
    s_waitcnt vmcnt(2)
    s_bitcmp0_b32 s15, 28
    s_cbranch_scc1 L_sf_87
    s_waitcnt vmcnt(1)
L_sf_87:
    buffer_load_dwordx4 v[152:155], v1, s[52:55], s97 offen offset:0 nt
    v_mfma_f32_16x16x32_bf16 v[32:35], v[24:27], v[136:139], v[32:35]
    v_mov_b32 v10, 162076
    v_mov_b32 v11, 1
    s_mov_b64 exec, 1
    ds_add_u32 v10, v11
    s_mov_b64 exec, -1
    v_and_b32_dpp v28, v18, v20 row_newbcast:8 row_mask:0xf bank_mask:0xf
    v_and_b32_dpp v29, v18, v21 row_newbcast:8 row_mask:0xf bank_mask:0xf
    v_and_b32_dpp v30, v18, v22 row_newbcast:8 row_mask:0xf bank_mask:0xf
    v_and_b32_dpp v31, v18, v23 row_newbcast:8 row_mask:0xf bank_mask:0xf
    s_waitcnt vmcnt(3)
    s_bitcmp0_b32 s14, 29
    s_cbranch_scc1 L_sf_88
    s_waitcnt vmcnt(2)
    s_bitcmp0_b32 s15, 29
    s_cbranch_scc1 L_sf_88
    s_waitcnt vmcnt(1)
L_sf_88:
    buffer_load_dwordx4 v[156:159], v1, s[52:55], s97 offen offset:1024 nt
    v_mfma_f32_16x16x32_bf16 v[32:35], v[28:31], v[140:143], v[32:35]
    v_and_b32_dpp v24, v18, v20 row_newbcast:4 row_mask:0xf bank_mask:0xf
    v_and_b32_dpp v25, v18, v21 row_newbcast:4 row_mask:0xf bank_mask:0xf
    v_and_b32_dpp v26, v18, v22 row_newbcast:4 row_mask:0xf bank_mask:0xf
    v_and_b32_dpp v27, v18, v23 row_newbcast:4 row_mask:0xf bank_mask:0xf
    s_waitcnt vmcnt(3)
    s_bitcmp0_b32 s14, 30
    s_cbranch_scc1 L_sf_89
    s_waitcnt vmcnt(2)
    s_bitcmp0_b32 s15, 30
    s_cbranch_scc1 L_sf_89
    s_waitcnt vmcnt(1)
L_sf_89:
    buffer_load_dwordx4 v[160:163], v1, s[52:55], s97 offen offset:2048 nt
    v_mfma_f32_16x16x32_bf16 v[32:35], v[24:27], v[144:147], v[32:35]
    v_lshrrev_b32 v9, 4, v0
    v_lshl_add_u32 v8, v9, 2, v2
    s_lshl_b32 s96, s3, 9
    s_add_u32 s96, s96, 157824
    v_lshl_add_u32 v8, v8, 2, s96
    v_lshlrev_b32 v9, 3, v0
    v_add_u32 v9, 157824, v9
    v_mov_b32 v10, 162048
    v_mov_b32 v11, 1
    s_lshl_b32 s96, s38, 5
    s_add_u32 s96, s96, 161984
    v_mov_b32 v3, s96
    s_sub_u32 s62, 8, s39
    s_lshl_b32 s98, s34, 5
    s_add_u32 s98, s98, s35
    s_lshl_b32 s98, s98, 8
    s_add_u32 s98, s98, 106496
    v_lshlrev_b32 v39, 2, v0
    v_and_b32_dpp v28, v18, v20 row_newbcast:12 row_mask:0xf bank_mask:0xf
    v_and_b32_dpp v29, v18, v21 row_newbcast:12 row_mask:0xf bank_mask:0xf
    v_and_b32_dpp v30, v18, v22 row_newbcast:12 row_mask:0xf bank_mask:0xf
    v_and_b32_dpp v31, v18, v23 row_newbcast:12 row_mask:0xf bank_mask:0xf
    s_waitcnt vmcnt(3)
    s_bitcmp0_b32 s14, 31
    s_cbranch_scc1 L_sf_90
    s_waitcnt vmcnt(2)
    s_bitcmp0_b32 s15, 31
    s_cbranch_scc1 L_sf_90
    s_waitcnt vmcnt(1)
L_sf_90:
    buffer_load_dwordx4 v[164:167], v1, s[52:55], s97 offen offset:3072 nt
    s_mov_b32 s97, 0
    v_add_u32 v1, 4096, v1
    v_and_b32 v1, 0x7fff, v1
    v_mfma_f32_16x16x32_bf16 v[32:35], v[28:31], v[148:151], v[32:35]
    s_cmp_eq_u32 s12, -1
    s_cbranch_scc1 L_v_nopf
    v_and_b32_dpp v24, v19, v20 row_newbcast:0 row_mask:0xf bank_mask:0xf
    v_and_b32_dpp v25, v19, v21 row_newbcast:0 row_mask:0xf bank_mask:0xf
    v_and_b32_dpp v26, v19, v22 row_newbcast:0 row_mask:0xf bank_mask:0xf
    v_and_b32_dpp v27, v19, v23 row_newbcast:0 row_mask:0xf bank_mask:0xf
    s_waitcnt vmcnt(3)
    s_nop 0
    v_mfma_f32_16x16x32_bf16 v[32:35], v[24:27], v[152:155], v[32:35]
    v_and_b32_dpp v28, v19, v20 row_newbcast:8 row_mask:0xf bank_mask:0xf
    v_and_b32_dpp v29, v19, v21 row_newbcast:8 row_mask:0xf bank_mask:0xf
    v_and_b32_dpp v30, v19, v22 row_newbcast:8 row_mask:0xf bank_mask:0xf
    v_and_b32_dpp v31, v19, v23 row_newbcast:8 row_mask:0xf bank_mask:0xf
    s_waitcnt vmcnt(2)
    s_nop 0
    v_mfma_f32_16x16x32_bf16 v[32:35], v[28:31], v[156:159], v[32:35]
    v_and_b32_dpp v24, v19, v20 row_newbcast:4 row_mask:0xf bank_mask:0xf
    v_and_b32_dpp v25, v19, v21 row_newbcast:4 row_mask:0xf bank_mask:0xf
    v_and_b32_dpp v26, v19, v22 row_newbcast:4 row_mask:0xf bank_mask:0xf
    v_and_b32_dpp v27, v19, v23 row_newbcast:4 row_mask:0xf bank_mask:0xf
    s_waitcnt vmcnt(1)
    s_nop 0
    v_mfma_f32_16x16x32_bf16 v[32:35], v[24:27], v[160:163], v[32:35]
    v_and_b32_dpp v28, v19, v20 row_newbcast:12 row_mask:0xf bank_mask:0xf
    v_and_b32_dpp v29, v19, v21 row_newbcast:12 row_mask:0xf bank_mask:0xf
    v_and_b32_dpp v30, v19, v22 row_newbcast:12 row_mask:0xf bank_mask:0xf
    v_and_b32_dpp v31, v19, v23 row_newbcast:12 row_mask:0xf bank_mask:0xf
    s_waitcnt vmcnt(0)
    s_nop 0
    v_mfma_f32_16x16x32_bf16 v[32:35], v[28:31], v[164:167], v[32:35]
L_v_join:
    s_cmp_lg_u32 s13, 0
    s_cbranch_scc1 L_jobend
L_t0:
    s_mov_b32 exec_hi, 0
    s_nop 4
    ds_write_b128 v8, v[32:35]
L_t0b:
    s_mov_b64 exec, 1
    ds_add_rtn_u32 v37, v10, v11
    s_mov_b64 exec, -1
    ds_read_b32 v38, v10 offset:24
    ds_read_b128 v[24:27], v3
    ds_read_b128 v[28:31], v3 offset:16
    ds_read_b64 v[144:145], v9 offset:0
    ds_read_b64 v[146:147], v9 offset:512
    ds_read_b64 v[148:149], v9 offset:1024
    ds_read_b64 v[150:151], v9 offset:1536
    ds_read_b64 v[152:153], v9 offset:2048
    ds_read_b64 v[154:155], v9 offset:2560
    ds_read_b64 v[156:157], v9 offset:3072
    ds_read_b64 v[158:159], v9 offset:3584
    s_waitcnt lgkmcnt(10)
    v_readfirstlane_b32 s96, v37
    v_readfirstlane_b32 s61, v38
    s_cmp_lg_u32 s96, s62
    s_cbranch_scc1 L_nopub
    s_waitcnt lgkmcnt(6)
    v_pk_mul_f32 v[144:145], v[144:145], v[24:25] op_sel:[0,0] op_sel_hi:[1,0]
    v_pk_mul_f32 v[146:147], v[146:147], v[24:25] op_sel:[0,1] op_sel_hi:[1,1]
    s_waitcnt lgkmcnt(4)
    v_pk_fma_f32 v[144:145], v[148:149], v[26:27], v[144:145] op_sel:[0,0,0] op_sel_hi:[1,0,1]
    v_pk_fma_f32 v[146:147], v[150:151], v[26:27], v[146:147] op_sel:[0,1,0] op_sel_hi:[1,1,1]
    s_waitcnt lgkmcnt(2)
    v_pk_fma_f32 v[144:145], v[152:153], v[28:29], v[144:145] op_sel:[0,0,0] op_sel_hi:[1,0,1]
    v_pk_fma_f32 v[146:147], v[154:155], v[28:29], v[146:147] op_sel:[0,1,0] op_sel_hi:[1,1,1]
    s_waitcnt lgkmcnt(0)
    v_pk_fma_f32 v[144:145], v[156:157], v[30:31], v[144:145] op_sel:[0,0,0] op_sel_hi:[1,0,1]
    v_pk_fma_f32 v[146:147], v[158:159], v[30:31], v[146:147] op_sel:[0,1,0] op_sel_hi:[1,1,1]
    s_cmp_eq_u32 s61, 1
    v_pk_add_f32 v[144:145], v[144:145], v[146:147]
    v_cvt_pk_bf16_f32 v32, v144, v145
    s_cbranch_scc0 L_oslow
    buffer_store_dword v32, v39, s[40:43], s98 offen
L_odone:
L_nopub:
    s_cmp_eq_u32 s59, 0
    s_cbranch_scc1 L_not1
L_poll_99:
    buffer_load_dwordx4 v[16:19], v105, s[40:43], s100 offen sc1
    buffer_load_dwordx4 v[20:23], v105, s[40:43], s100 offen offset:128 sc1
    s_sub_u32 s60, s60, 1
    s_cbranch_scc1 L_poll_99t
    s_waitcnt vmcnt(0)
    v_max3_u32 v38, v16, v17, v18
    v_max3_u32 v38, v38, v19, v20
    v_max3_u32 v38, v38, v21, v22
    v_max_u32 v38, v38, v23
    v_cmp_eq_u32 vcc, -1, v38
    s_cbranch_vccnz L_poll_99
L_poll_99e:
    v_smfmac_f32_16x16x64_bf16 v[112:115], v[16:19], v[72:79], v111
    v_smfmac_f32_16x16x64_bf16 v[116:119], v[16:19], v[80:87], v111
    v_smfmac_f32_16x16x64_bf16 v[112:115], v[20:23], v[88:95], v111
    v_smfmac_f32_16x16x64_bf16 v[116:119], v[20:23], v[96:103], v111
    s_nop 6
    v_pk_add_f32 v[112:113], v[112:113], v[114:115]
    v_pk_add_f32 v[116:117], v[116:117], v[118:119]
    v_add_f32 v12, v112, v113
    v_add_f32 v13, v116, v117
    ds_write2_b32 v106, v12, v13 offset0:0 offset1:32
    s_mov_b64 exec, 1
    ds_add_rtn_u32 v37, v109, v11
    s_mov_b64 exec, -1
    ds_read_b64 v[72:73], v107 offset:0
    ds_read_b64 v[74:75], v107 offset:16384
    ds_read_b64 v[76:77], v107 offset:32768
    ds_read_b64 v[78:79], v107 offset:49152
    s_cmp_eq_u32 s34, 2
    s_cselect_b32 s97, s61, 0
    s_waitcnt lgkmcnt(4)
    v_readfirstlane_b32 s96, v37
    s_waitcnt lgkmcnt(2)
    v_pk_add_f32 v[72:73], v[72:73], v[74:75]
    s_cmp_lg_u32 s96, 3
    s_cbranch_scc1 L_not1
    s_cmp_eq_u32 s97, 1
    s_waitcnt lgkmcnt(0)
    v_pk_add_f32 v[76:77], v[76:77], v[78:79]
    v_pk_add_f32 v[72:73], v[72:73], v[76:77]
    v_cvt_pk_bf16_f32 v12, v72, v73
    s_cbranch_scc1 L_pfast
    buffer_store_dword v12, v108, s[40:43], s101 offen sc1
    buffer_store_dword v12, v110, s[40:43], s101 offen sc1
L_pdone:
L_not1:
    s_waitcnt lgkmcnt(0)
    s_cmp_eq_u32 s39, 1
    s_cbranch_scc1 L_s_role
    s_endpgm
L_k_nopf:
    s_waitcnt vmcnt(3)
    s_bitcmp0_b32 s57, 22
    s_cbranch_scc1 L_sf_55
    s_waitcnt vmcnt(2)
    s_bitcmp0_b32 s58, 22
    s_cbranch_scc1 L_sf_55
    s_waitcnt vmcnt(1)
L_sf_55:
    buffer_load_dwordx4 v[128:131], v1, s[48:51], s97 offen offset:2048 nt
    v_min_u32 v39, 15, v0
    v_and_b32 v38, 1, v39
    v_mul_u32_u24 v38, 126, v38
    v_lshl_add_u32 v39, v39, 1, v38
    buffer_load_dword v37, v39, s[44:47], 0 offen sc1
    s_waitcnt vmcnt(4)
    s_bitcmp0_b32 s57, 23
    s_cbranch_scc1 L_sf_56
    s_waitcnt vmcnt(3)
    s_bitcmp0_b32 s58, 23
    s_cbranch_scc1 L_sf_56
    s_waitcnt vmcnt(2)
L_sf_56:
    buffer_load_dwordx4 v[132:135], v1, s[48:51], s97 offen offset:3072 nt
    s_add_u32 s97, s97, 32768
    v_add_u32 v1, 4096, v1
    v_and_b32 v1, 0x7fff, v1
    s_waitcnt vmcnt(4)
    s_bitcmp0_b32 s57, 24
    s_cbranch_scc1 L_sf_57
    s_waitcnt vmcnt(3)
    s_bitcmp0_b32 s58, 24
    s_cbranch_scc1 L_sf_57
    s_waitcnt vmcnt(2)
L_sf_57:
    buffer_load_dwordx4 v[136:139], v1, s[48:51], s97 offen offset:0 nt
    s_waitcnt vmcnt(4)
    s_bitcmp0_b32 s57, 25
    s_cbranch_scc1 L_sf_58
    s_waitcnt vmcnt(3)
    s_bitcmp0_b32 s58, 25
    s_cbranch_scc1 L_sf_58
    s_waitcnt vmcnt(1)
L_sf_58:
    buffer_load_dwordx4 v[140:143], v1, s[48:51], s97 offen offset:1024 nt
    s_waitcnt vmcnt(4)
    s_bitcmp0_b32 s57, 26
    s_cbranch_scc1 L_sf_59
    s_waitcnt vmcnt(2)
    s_bitcmp0_b32 s58, 26
    s_cbranch_scc1 L_sf_59
    s_waitcnt vmcnt(1)
L_sf_59:
    buffer_load_dwordx4 v[144:147], v1, s[48:51], s97 offen offset:2048 nt
    s_waitcnt vmcnt(3)
    s_bitcmp0_b32 s57, 27
    s_cbranch_scc1 L_sf_60
    s_waitcnt vmcnt(2)
    s_bitcmp0_b32 s58, 27
    s_cbranch_scc1 L_sf_60
    s_waitcnt vmcnt(1)
L_sf_60:
    buffer_load_dwordx4 v[148:151], v1, s[48:51], s97 offen offset:3072 nt
    s_add_u32 s97, s97, 32768
    v_add_u32 v1, 4096, v1
    v_and_b32 v1, 0x7fff, v1
    v_cmp_eq_u32 vcc, 0, v37
    s_nop 0
    s_or_b32 s96, vcc_lo, vcc_hi
    buffer_load_dwordx4 v[4:7], v2, s[40:43], s98 offen sc1
    s_waitcnt vmcnt(4)
    s_bitcmp0_b32 s57, 28
    s_cbranch_scc1 L_sf_61
    s_waitcnt vmcnt(3)
    s_bitcmp0_b32 s58, 28
    s_cbranch_scc1 L_sf_61
    s_waitcnt vmcnt(2)
L_sf_61:
    buffer_load_dwordx4 v[152:155], v1, s[48:51], s97 offen offset:0 nt
    s_waitcnt vmcnt(4)
    s_bitcmp0_b32 s57, 29
    s_cbranch_scc1 L_sf_62
    s_waitcnt vmcnt(3)
    s_bitcmp0_b32 s58, 29
    s_cbranch_scc1 L_sf_62
    s_waitcnt vmcnt(2)
L_sf_62:
    buffer_load_dwordx4 v[156:159], v1, s[48:51], s97 offen offset:1024 nt
    s_waitcnt vmcnt(4)
    s_bitcmp0_b32 s57, 30
    s_cbranch_scc1 L_sf_63
    s_waitcnt vmcnt(3)
    s_bitcmp0_b32 s58, 30
    s_cbranch_scc1 L_sf_63
    s_waitcnt vmcnt(1)
L_sf_63:
    buffer_load_dwordx4 v[160:163], v1, s[48:51], s97 offen offset:2048 nt
    s_waitcnt vmcnt(4)
    s_bitcmp0_b32 s57, 31
    s_cbranch_scc1 L_sf_64
    s_waitcnt vmcnt(2)
    s_bitcmp0_b32 s58, 31
    s_cbranch_scc1 L_sf_64
    s_waitcnt vmcnt(1)
L_sf_64:
    buffer_load_dwordx4 v[164:167], v1, s[48:51], s97 offen offset:3072 nt
    s_mov_b32 s97, 0
    v_add_u32 v1, 4096, v1
    v_and_b32 v1, 0x7fff, v1
    v_add_u32 v1, 8192, v1
    v_and_b32 v1, 0x7fff, v1
    s_mov_b32 s97, 65536
    s_branch L_k_join
L_v_nopf:
    v_and_b32_dpp v24, v19, v20 row_newbcast:0 row_mask:0xf bank_mask:0xf
    v_and_b32_dpp v25, v19, v21 row_newbcast:0 row_mask:0xf bank_mask:0xf
    v_and_b32_dpp v26, v19, v22 row_newbcast:0 row_mask:0xf bank_mask:0xf
    v_and_b32_dpp v27, v19, v23 row_newbcast:0 row_mask:0xf bank_mask:0xf
    s_waitcnt vmcnt(3)
    s_bitcmp0_b32 s14, 0
    s_cbranch_scc1 L_sf_91
    s_waitcnt vmcnt(2)
    s_bitcmp0_b32 s15, 0
    s_cbranch_scc1 L_sf_91
    s_waitcnt vmcnt(1)
L_sf_91:
    buffer_load_dwordx4 v[40:43], v1, s[52:55], s97 offen offset:0 nt
    v_mfma_f32_16x16x32_bf16 v[32:35], v[24:27], v[152:155], v[32:35]
    v_and_b32_dpp v28, v19, v20 row_newbcast:8 row_mask:0xf bank_mask:0xf
    v_and_b32_dpp v29, v19, v21 row_newbcast:8 row_mask:0xf bank_mask:0xf
    v_and_b32_dpp v30, v19, v22 row_newbcast:8 row_mask:0xf bank_mask:0xf
    v_and_b32_dpp v31, v19, v23 row_newbcast:8 row_mask:0xf bank_mask:0xf
    s_waitcnt vmcnt(3)
    s_bitcmp0_b32 s14, 1
    s_cbranch_scc1 L_sf_92
    s_waitcnt vmcnt(2)
    s_bitcmp0_b32 s15, 1
    s_cbranch_scc1 L_sf_92
    s_waitcnt vmcnt(1)
L_sf_92:
    buffer_load_dwordx4 v[44:47], v1, s[52:55], s97 offen offset:1024 nt
    v_mfma_f32_16x16x32_bf16 v[32:35], v[28:31], v[156:159], v[32:35]
    v_and_b32_dpp v24, v19, v20 row_newbcast:4 row_mask:0xf bank_mask:0xf
    v_and_b32_dpp v25, v19, v21 row_newbcast:4 row_mask:0xf bank_mask:0xf
    v_and_b32_dpp v26, v19, v22 row_newbcast:4 row_mask:0xf bank_mask:0xf
    v_and_b32_dpp v27, v19, v23 row_newbcast:4 row_mask:0xf bank_mask:0xf
    s_waitcnt vmcnt(3)
    s_bitcmp0_b32 s14, 2
    s_cbranch_scc1 L_sf_93
    s_waitcnt vmcnt(2)
    s_bitcmp0_b32 s15, 2
    s_cbranch_scc1 L_sf_93
    s_waitcnt vmcnt(1)
L_sf_93:
    buffer_load_dwordx4 v[48:51], v1, s[52:55], s97 offen offset:2048 nt
    v_mfma_f32_16x16x32_bf16 v[32:35], v[24:27], v[160:163], v[32:35]
    v_and_b32_dpp v28, v19, v20 row_newbcast:12 row_mask:0xf bank_mask:0xf
    v_and_b32_dpp v29, v19, v21 row_newbcast:12 row_mask:0xf bank_mask:0xf
    v_and_b32_dpp v30, v19, v22 row_newbcast:12 row_mask:0xf bank_mask:0xf
    v_and_b32_dpp v31, v19, v23 row_newbcast:12 row_mask:0xf bank_mask:0xf
    s_waitcnt vmcnt(3)
    s_bitcmp0_b32 s14, 3
    s_cbranch_scc1 L_sf_94
    s_waitcnt vmcnt(2)
    s_bitcmp0_b32 s15, 3
    s_cbranch_scc1 L_sf_94
    s_waitcnt vmcnt(1)
L_sf_94:
    buffer_load_dwordx4 v[52:55], v1, s[52:55], s97 offen offset:3072 nt
    s_add_u32 s97, s97, 32768
    v_add_u32 v1, 4096, v1
    v_and_b32 v1, 0x7fff, v1
    v_mfma_f32_16x16x32_bf16 v[32:35], v[28:31], v[164:167], v[32:35]
    v_and_b32_dpp v24, v12, v20 row_newbcast:0 row_mask:0xf bank_mask:0xf
    v_and_b32_dpp v25, v12, v21 row_newbcast:0 row_mask:0xf bank_mask:0xf
    v_and_b32_dpp v26, v12, v22 row_newbcast:0 row_mask:0xf bank_mask:0xf
    v_and_b32_dpp v27, v12, v23 row_newbcast:0 row_mask:0xf bank_mask:0xf
    s_waitcnt vmcnt(3)
    s_bitcmp0_b32 s14, 4
    s_cbranch_scc1 L_sf_95
    s_waitcnt vmcnt(2)
    s_bitcmp0_b32 s15, 4
    s_cbranch_scc1 L_sf_95
    s_waitcnt vmcnt(1)
L_sf_95:
    buffer_load_dwordx4 v[56:59], v1, s[52:55], s97 offen offset:0 nt
    v_mfma_f32_16x16x32_bf16 v[32:35], v[24:27], v[40:43], v[32:35]
    v_and_b32_dpp v28, v12, v20 row_newbcast:8 row_mask:0xf bank_mask:0xf
    v_and_b32_dpp v29, v12, v21 row_newbcast:8 row_mask:0xf bank_mask:0xf
    v_and_b32_dpp v30, v12, v22 row_newbcast:8 row_mask:0xf bank_mask:0xf
    v_and_b32_dpp v31, v12, v23 row_newbcast:8 row_mask:0xf bank_mask:0xf
    s_waitcnt vmcnt(3)
    s_bitcmp0_b32 s14, 5
    s_cbranch_scc1 L_sf_96
    s_waitcnt vmcnt(2)
    s_bitcmp0_b32 s15, 5
    s_cbranch_scc1 L_sf_96
    s_waitcnt vmcnt(1)
L_sf_96:
    buffer_load_dwordx4 v[60:63], v1, s[52:55], s97 offen offset:1024 nt
    v_mfma_f32_16x16x32_bf16 v[32:35], v[28:31], v[44:47], v[32:35]
    v_and_b32_dpp v24, v12, v20 row_newbcast:4 row_mask:0xf bank_mask:0xf
    v_and_b32_dpp v25, v12, v21 row_newbcast:4 row_mask:0xf bank_mask:0xf
    v_and_b32_dpp v26, v12, v22 row_newbcast:4 row_mask:0xf bank_mask:0xf
    v_and_b32_dpp v27, v12, v23 row_newbcast:4 row_mask:0xf bank_mask:0xf
    s_waitcnt vmcnt(3)
    s_bitcmp0_b32 s14, 6
    s_cbranch_scc1 L_sf_97
    s_waitcnt vmcnt(2)
    s_bitcmp0_b32 s15, 6
    s_cbranch_scc1 L_sf_97
    s_waitcnt vmcnt(1)
L_sf_97:
    buffer_load_dwordx4 v[64:67], v1, s[52:55], s97 offen offset:2048 nt
    v_mfma_f32_16x16x32_bf16 v[32:35], v[24:27], v[48:51], v[32:35]
    v_and_b32_dpp v28, v12, v20 row_newbcast:12 row_mask:0xf bank_mask:0xf
    v_and_b32_dpp v29, v12, v21 row_newbcast:12 row_mask:0xf bank_mask:0xf
    v_and_b32_dpp v30, v12, v22 row_newbcast:12 row_mask:0xf bank_mask:0xf
    v_and_b32_dpp v31, v12, v23 row_newbcast:12 row_mask:0xf bank_mask:0xf
    s_waitcnt vmcnt(3)
    s_bitcmp0_b32 s14, 7
    s_cbranch_scc1 L_sf_98
    s_waitcnt vmcnt(2)
    s_bitcmp0_b32 s15, 7
    s_cbranch_scc1 L_sf_98
    s_waitcnt vmcnt(1)
L_sf_98:
    buffer_load_dwordx4 v[68:71], v1, s[52:55], s97 offen offset:3072 nt
    s_add_u32 s97, s97, 32768
    v_add_u32 v1, 4096, v1
    v_and_b32 v1, 0x7fff, v1
    v_mfma_f32_16x16x32_bf16 v[32:35], v[28:31], v[52:55], v[32:35]
    v_and_b32_dpp v24, v13, v20 row_newbcast:0 row_mask:0xf bank_mask:0xf
    v_and_b32_dpp v25, v13, v21 row_newbcast:0 row_mask:0xf bank_mask:0xf
    v_and_b32_dpp v26, v13, v22 row_newbcast:0 row_mask:0xf bank_mask:0xf
    v_and_b32_dpp v27, v13, v23 row_newbcast:0 row_mask:0xf bank_mask:0xf
    s_waitcnt vmcnt(3)
    s_nop 0
    v_mfma_f32_16x16x32_bf16 v[32:35], v[24:27], v[56:59], v[32:35]
    v_and_b32_dpp v28, v13, v20 row_newbcast:8 row_mask:0xf bank_mask:0xf
    v_and_b32_dpp v29, v13, v21 row_newbcast:8 row_mask:0xf bank_mask:0xf
    v_and_b32_dpp v30, v13, v22 row_newbcast:8 row_mask:0xf bank_mask:0xf
    v_and_b32_dpp v31, v13, v23 row_newbcast:8 row_mask:0xf bank_mask:0xf
    s_waitcnt vmcnt(2)
    s_nop 0
    v_mfma_f32_16x16x32_bf16 v[32:35], v[28:31], v[60:63], v[32:35]
    v_and_b32_dpp v24, v13, v20 row_newbcast:4 row_mask:0xf bank_mask:0xf
    v_and_b32_dpp v25, v13, v21 row_newbcast:4 row_mask:0xf bank_mask:0xf
    v_and_b32_dpp v26, v13, v22 row_newbcast:4 row_mask:0xf bank_mask:0xf
    v_and_b32_dpp v27, v13, v23 row_newbcast:4 row_mask:0xf bank_mask:0xf
    s_waitcnt vmcnt(1)
    s_nop 0
    v_mfma_f32_16x16x32_bf16 v[32:35], v[24:27], v[64:67], v[32:35]
    v_and_b32_dpp v28, v13, v20 row_newbcast:12 row_mask:0xf bank_mask:0xf
    v_and_b32_dpp v29, v13, v21 row_newbcast:12 row_mask:0xf bank_mask:0xf
    v_and_b32_dpp v30, v13, v22 row_newbcast:12 row_mask:0xf bank_mask:0xf
    v_and_b32_dpp v31, v13, v23 row_newbcast:12 row_mask:0xf bank_mask:0xf
    s_waitcnt vmcnt(0)
    s_nop 0
    v_mfma_f32_16x16x32_bf16 v[32:35], v[28:31], v[68:71], v[32:35]
    s_branch L_v_join
L_oslow:
    buffer_store_dword v32, v39, s[40:43], s98 offen sc1
    s_branch L_odone
L_qslow:
L_wy_100:
    buffer_load_dword v37, v39, s[44:47], 0 offen sc1
    s_waitcnt vmcnt(0)
    v_cmp_ne_u32 vcc, -1, v37
    s_cbranch_vccz L_wy_100e
    s_sleep 4
    s_sub_u32 s60, s60, 1
    s_cbranch_scc0 L_wy_100
    s_mov_b32 s60, 0
L_wy_100e:
L_qslow2:
    s_branch L_poll_101
L_poll_101s:
    s_sleep 2
L_poll_101:
    buffer_load_dwordx4 v[4:7], v2, s[40:43], s98 offen sc1
    s_sub_u32 s60, s60, 1
    s_cbranch_scc1 L_poll_101t
    s_waitcnt vmcnt(0)
    v_max3_u32 v38, v4, v5, v6
    v_max_u32 v38, v38, v7
    v_cmp_eq_u32 vcc, -1, v38
    s_cbranch_vccnz L_poll_101s
L_poll_101e:
    s_branch L_qok
L_mljob:
    s_lshl4_add_u32 s96, s35, s3
    s_lshl_b32 s96, s96, 3
    s_add_u32 s96, s96, 81920
    buffer_store_dwordx2 v[8:9], v36, s[40:43], s96 offen sc1
    s_branch L_mldone
L_service:
    v_mov_b32 v72, 0
    v_mov_b32 v73, 0
    v_mov_b32 v74, 0
    v_mov_b32 v75, 0
    v_mov_b32 v76, 0
    s_mov_b32 s59, 0
    v_mov_b32 v5, 0
    v_mov_b32 v105, 0
    v_mov_b32 v108, 0
    v_mov_b32 v110, 0
    v_mov_b32 v160, 0
    v_mov_b32 v163, 0
    v_mov_b32 v8, 162068
L_lw_102:
    ds_read_b32 v9, v8
    s_waitcnt lgkmcnt(0)
    v_cmp_gt_u32 vcc, 8, v9
    s_cbranch_vccz L_lw_102e
    s_sleep 8
    s_sub_u32 s60, s60, 1
    s_cbranch_scc0 L_lw_102
    s_mov_b32 s60, 0
L_lw_102e:
    v_and_b32 v2, 15, v0
    v_lshlrev_b32 v2, 3, v2
    v_add_u32 v3, 161920, v2
    ds_read_b64 v[8:9], v3
    v_mov_b32 v11, 162096
    ds_read_b32 v11, v11
    s_getreg_b32 s58, hwreg(HW_REG_XCC_ID, 0, 4)
    s_lshl_b32 s98, s34, 5
    s_add_u32 s98, s98, s35
    s_lshl_b32 s62, s98, 7
    s_add_u32 s62, s62, 73728
    s_and_b32 s99, s62, 0xffffff00
    s_lshl_b32 s98, s98, 8
    s_add_u32 s98, s98, 106496
    v_lshlrev_b32 v39, 2, v0
    v_and_b32 v21, 64, v2
    v_add_u32 v21, v21, v2
    v_cmp_eq_u32 vcc, 8, v0
    s_bfm_b64 exec, 8, 0
    s_bitset1_b32 exec_lo, 8
    s_waitcnt lgkmcnt(0)
    v_lshl_add_u32 v10, v11, 8, s58
    v_cndmask_b32 v8, v8, v10, vcc
    buffer_store_dwordx2 v[8:9], v2, s[40:43], s62 offen sc1
    s_mov_b64 exec, -1
    v_mov_b32 v12, 162076
L_lw_103:
    ds_read_b32 v13, v12
    s_waitcnt lgkmcnt(0)
    v_cmp_gt_u32 vcc, 4, v13
    s_cbranch_vccz L_lw_103e
    s_sleep 4
    s_sub_u32 s60, s60, 1
    s_cbranch_scc0 L_lw_103
    s_mov_b32 s60, 0
L_lw_103e:
    v_and_b32 v11, 31, v0
    v_lshlrev_b32 v11, 7, v11
    s_lshl_b32 s63, s34, 12
    s_add_u32 s63, s63, 73792
    buffer_load_dword v12, v39, s[40:43], s98 offen sc1
    s_branch L_poll_104
L_poll_104s:
    s_sleep 16
L_poll_104:
    buffer_load_dwordx2 v[8:9], v21, s[40:43], s99 offen sc1
    buffer_load_dword v10, v11, s[40:43], s63 offen sc1
    s_sub_u32 s60, s60, 1
    s_cbranch_scc1 L_poll_104t
    s_waitcnt vmcnt(0)
    v_max3_u32 v38, v8, v9, v10
    v_cmp_eq_u32 vcc, -1, v38
    s_cbranch_vccnz L_poll_104s
L_poll_104e:
    v_mov_b32 v37, v8
    s_nop 1
    v_max_f32_dpp v37, v37, v37 quad_perm:[1,0,3,2] row_mask:0xf bank_mask:0xf
    s_nop 1
    v_max_f32_dpp v37, v37, v37 quad_perm:[2,3,0,1] row_mask:0xf bank_mask:0xf
    s_nop 1
    v_max_f32_dpp v37, v37, v37 row_ror:4 row_mask:0xf bank_mask:0xf
    s_nop 1
    v_max_f32_dpp v37, v37, v37 row_ror:8 row_mask:0xf bank_mask:0xf
    v_sub_f32 v8, v8, v37
    v_exp_f32 v8, v8
    s_nop 0
    v_mul_f32 v9, v8, v9
    s_nop 1
    v_add_f32_dpp v9, v9, v9 quad_perm:[1,0,3,2] row_mask:0xf bank_mask:0xf
    s_nop 1
    v_add_f32_dpp v9, v9, v9 quad_perm:[2,3,0,1] row_mask:0xf bank_mask:0xf
    s_nop 1
    v_add_f32_dpp v9, v9, v9 row_ror:4 row_mask:0xf bank_mask:0xf
    s_nop 1
    v_add_f32_dpp v9, v9, v9 row_ror:8 row_mask:0xf bank_mask:0xf
    v_and_b32 v10, 0xff, v10
    s_getreg_b32 s62, hwreg(HW_REG_XCC_ID, 0, 4)
    v_cmp_ne_u32 vcc, s62, v10
    s_nop 0
    s_cmp_eq_u64 vcc, 0
    s_cselect_b32 s61, 1, 0
    v_rcp_f32 v9, v9
    v_lshrrev_b32 v3, 1, v2
    v_add_u32 v3, 161984, v3
    v_mul_f32 v8, v8, v9
    v_mov_b32 v10, 162072
    v_mov_b32 v11, s61
    ds_write_b32 v3, v8
    ds_write_b32 v10, v11
    s_mov_b32 s3, 1
    v_lshrrev_b32 v9, 4, v0
    v_lshl_add_u32 v8, v9, 2, v2
    s_lshl_b32 s96, s3, 9
    s_add_u32 s96, s96, 157824
    v_lshl_add_u32 v8, v8, 2, s96
    v_lshlrev_b32 v9, 3, v0
    v_add_u32 v9, 157824, v9
    v_mov_b32 v10, 162048
    v_mov_b32 v11, 1
    s_lshl_b32 s96, s38, 5
    s_add_u32 s96, s96, 161984
    v_mov_b32 v3, s96
    s_sub_u32 s62, 8, s39
    s_lshl_b32 s98, s34, 5
    s_add_u32 s98, s98, s35
    s_lshl_b32 s98, s98, 8
    s_add_u32 s98, s98, 106496
    v_lshlrev_b32 v39, 2, v0
    s_branch L_t0b
L_jobend:
    v_lshlrev_b32 v9, 4, v0
    s_mov_b32 exec_hi, 0
    s_nop 3
    buffer_store_dwordx4 v[32:35], v9, s[40:43], s13 offen sc1
    s_endpgm
L_proxy:
    v_mov_b32 v72, 0
    v_mov_b32 v73, 0
    v_mov_b32 v74, 0
    v_mov_b32 v75, 0
    v_mov_b32 v76, 0
    v_mov_b32 v5, 0
    v_mov_b32 v105, 0
    v_mov_b32 v108, 0
    v_mov_b32 v110, 0
    v_mov_b32 v160, 0
    v_mov_b32 v163, 0
    s_barrier
    s_waitcnt lgkmcnt(0)
    s_mov_b32 s40, s32
    s_mov_b32 s41, s33
    s_mov_b32 s42, 589824
    s_mov_b32 s43, 0x20000
    s_mov_b32 s44, s30
    s_mov_b32 s45, s31
    s_mov_b32 s46, 256
    s_mov_b32 s47, 0x20000
    s_sub_u32 s97, 7, s3
    s_mul_i32 s97, s97, 27
    s_cmp_eq_u32 s3, 5
    s_cselect_b32 s97, 32, s97
    s_add_u32 s97, s97, s35
    s_lshl_b32 s97, s97, 9
    s_add_u32 s97, s97, 172032
    v_and_b32 v2, 15, v0
    v_lshlrev_b32 v2, 3, v2
    v_and_b32 v20, 31, v0
    v_lshlrev_b32 v20, 4, v20
    s_cmp_lg_u32 s3, 7
    s_cbranch_scc1 L_px6
    s_sub_u32 s96, 6, s59
    s_mul_i32 s62, s35, 5120
    s_add_u32 s62, s62, 327680
    v_lshl_add_u32 v22, v0, 4, s62
    v_add_u32 v23, 4096, v22
    v_mov_b32 v24, -1
    v_mov_b32 v25, -1
    v_mov_b32 v26, -1
    v_mov_b32 v27, -1
    v_mov_b32 v8, 162068
L_lw_105:
    ds_read_b32 v9, v8
    s_waitcnt lgkmcnt(0)
    v_cmp_gt_u32 vcc, s96, v9
    s_cbranch_vccz L_lw_105e
    s_sleep 8
    s_sub_u32 s60, s60, 1
    s_cbranch_scc0 L_lw_105
    s_mov_b32 s60, 0
L_lw_105e:
    v_and_b32 v2, 15, v0
    v_lshlrev_b32 v2, 3, v2
    v_add_u32 v3, 161920, v2
    ds_read_b64 v[8:9], v3
    v_mov_b32 v11, 162096
    ds_read_b32 v11, v11
    s_getreg_b32 s58, hwreg(HW_REG_XCC_ID, 0, 4)
    s_lshl_b32 s98, s34, 5
    s_add_u32 s98, s98, s35
    s_lshl_b32 s62, s98, 7
    s_add_u32 s62, s62, 73728
    s_and_b32 s99, s62, 0xffffff00
    s_lshl_b32 s98, s98, 8
    s_add_u32 s98, s98, 106496
    v_lshlrev_b32 v39, 2, v0
    v_and_b32 v21, 64, v2
    v_add_u32 v21, v21, v2
    v_cmp_eq_u32 vcc, 8, v0
    s_bfm_b64 exec, s96, 0
    s_bitset1_b32 exec_lo, 8
    s_waitcnt lgkmcnt(0)
    v_lshl_add_u32 v10, v11, 8, s58
    v_cndmask_b32 v8, v8, v10, vcc
    buffer_store_dwordx2 v[8:9], v2, s[40:43], s62 offen sc1
    s_mov_b64 exec, -1
    buffer_load_dwordx4 v[120:123], v22, s[40:43], 0 offen offset:0 sc1
    buffer_load_dwordx4 v[124:127], v22, s[40:43], 0 offen offset:1024 sc1
    buffer_load_dwordx4 v[128:131], v22, s[40:43], 0 offen offset:2048 sc1
    buffer_load_dwordx4 v[132:135], v22, s[40:43], 0 offen offset:3072 sc1
    buffer_load_dwordx4 v[136:139], v23, s[40:43], 0 offen offset:0 sc1
    s_mov_b32 s100, 4
    s_lshl_b32 s63, s100, 8
    v_and_b32 v8, 15, v0
    v_lshl_add_u32 v8, v8, 4, s63
    v_lshrrev_b32 v9, 4, v0
    v_mul_u32_u24 v5, 1280, v9
    v_add_u32 v5, v5, v8
    v_mul_u32_u24 v4, 1296, v9
    v_add_u32 v4, v4, v8
    v_add_u32 v4, 82944, v4
    v_lshlrev_b32 v6, 1, v5
    v_add_u32 v6, 99328, v6
    s_lshl_b32 s62, s100, 9
    s_add_u32 s62, s62, 88128
    v_lshl_add_u32 v7, v0, 3, s62
    s_mov_b32 s48, s4
    s_mov_b32 s49, s5
    s_mov_b32 s50, 5120
    s_mov_b32 s51, 0x20000
    buffer_load_dwordx4 v[8:11], v5, s[48:51], 0 offen
    s_mov_b32 s62, 20480
    s_mov_b32 s63, 30720
    s_branch L_poll_106
L_poll_106s:
    s_sleep 32
L_poll_106:
    buffer_load_dwordx4 v[12:15], v5, s[40:43], s62 offen sc1
    buffer_load_dwordx4 v[16:19], v5, s[40:43], s63 offen sc1
    s_sub_u32 s60, s60, 1
    s_cbranch_scc1 L_poll_106t
    s_waitcnt vmcnt(0)
    v_max3_u32 v38, v12, v13, v14
    v_max3_u32 v38, v38, v15, v16
    v_max3_u32 v38, v38, v17, v18
    v_max_u32 v38, v38, v19
    v_cmp_eq_u32 vcc, -1, v38
    s_cbranch_vccnz L_poll_106s
L_poll_106e:
    v_lshlrev_b32 v40, 16, v8
    v_and_b32 v41, 0xffff0000, v8
    v_lshlrev_b32 v42, 16, v9
    v_and_b32 v43, 0xffff0000, v9
    v_lshlrev_b32 v44, 16, v10
    v_and_b32 v45, 0xffff0000, v10
    v_lshlrev_b32 v46, 16, v11
    v_and_b32 v47, 0xffff0000, v11
    v_lshlrev_b32 v48, 16, v12
    v_and_b32 v49, 0xffff0000, v12
    v_lshlrev_b32 v50, 16, v13
    v_and_b32 v51, 0xffff0000, v13
    v_lshlrev_b32 v52, 16, v14
    v_and_b32 v53, 0xffff0000, v14
    v_lshlrev_b32 v54, 16, v15
    v_and_b32 v55, 0xffff0000, v15
    v_lshlrev_b32 v56, 16, v16
    v_and_b32 v57, 0xffff0000, v16
    v_lshlrev_b32 v58, 16, v17
    v_and_b32 v59, 0xffff0000, v17
    v_lshlrev_b32 v60, 16, v18
    v_and_b32 v61, 0xffff0000, v18
    v_lshlrev_b32 v62, 16, v19
    v_and_b32 v63, 0xffff0000, v19
    v_mov_b32 v64, 0
    v_mov_b32 v65, 0
    v_mov_b32 v66, 0
    v_mov_b32 v67, 0
    v_mov_b32 v68, 0
    v_mov_b32 v69, 0
    v_mov_b32 v70, 0
    v_mov_b32 v71, 0
    v_bfe_u32 v5, v0, 2, 2
    v_lshlrev_b32 v5, 8, v5
    v_lshrrev_b32 v8, 4, v0
    v_lshl_add_u32 v5, v8, 6, v5
    v_and_b32 v8, 3, v0
    v_lshl_add_u32 v5, v8, 4, v5
    s_lshl_b32 s56, s100, 10
    s_or_b32 s96, s59, 0
    s_cbranch_scc0 L_nofrag_107
    v_mov_b32 v104, 162060
L_lw_108:
    ds_read_b32 v105, v104
    s_waitcnt lgkmcnt(0)
    v_cmp_gt_u32 vcc, 4, v105
    s_cbranch_vccz L_lw_108e
    s_sleep 2
    s_sub_u32 s60, s60, 1
    s_cbranch_scc0 L_lw_108
    s_mov_b32 s60, 0
L_lw_108e:
    s_cmp_eq_u32 s59, 0
    s_cbranch_scc1 L_nofrag_107
    v_bfe_u32 v104, v0, 2, 1
    v_bfe_u32 v110, v0, 4, 1
    v_lshl_add_u32 v104, v110, 2, v104
    v_and_b32 v110, 8, v0
    v_add_u32 v104, v104, v110
    v_lshrrev_b32 v110, 5, v0
    v_lshl_add_u32 v104, v110, 4, v104
    v_bfe_u32 v111, v0, 0, 1
    v_mul_u32_u24 v111, 0xaaaa, v111
    v_add_u32 v111, 0x4444, v111
    v_mov_b32 v112, 0
    v_mov_b32 v113, 0
    v_mov_b32 v114, 0
    v_mov_b32 v115, 0
    v_mov_b32 v116, 0
    v_mov_b32 v117, 0
    v_mov_b32 v118, 0
    v_mov_b32 v119, 0
    v_lshlrev_b32 v104, 7, v104
    v_and_b32 v110, 3, v0
    v_lshl_add_u32 v104, v110, 3, v104
    v_lshrrev_b32 v109, 4, v0
    v_and_b32 v110, 1, v0
    s_lshr_b32 s63, s3, 1
    s_and_b32 s62, s3, 1
    s_lshl_b32 s96, s63, 14
    s_lshl_b32 s100, s62, 6
    s_add_u32 s100, s100, 81920
    s_add_u32 s96, s96, s100
    v_add_u32 v104, s96, v104
    ds_read_b64_tr_b16 v[72:73], v104 offset:0
    ds_read_b64_tr_b16 v[74:75], v104 offset:256
    ds_read_b64_tr_b16 v[76:77], v104 offset:4096
    ds_read_b64_tr_b16 v[78:79], v104 offset:4352
    ds_read_b64_tr_b16 v[80:81], v104 offset:32
    ds_read_b64_tr_b16 v[82:83], v104 offset:288
    ds_read_b64_tr_b16 v[84:85], v104 offset:4128
    ds_read_b64_tr_b16 v[86:87], v104 offset:4384
    ds_read_b64_tr_b16 v[88:89], v104 offset:8192
    ds_read_b64_tr_b16 v[90:91], v104 offset:8448
    ds_read_b64_tr_b16 v[92:93], v104 offset:12288
    ds_read_b64_tr_b16 v[94:95], v104 offset:12544
    ds_read_b64_tr_b16 v[96:97], v104 offset:8224
    ds_read_b64_tr_b16 v[98:99], v104 offset:8480
    ds_read_b64_tr_b16 v[100:101], v104 offset:12320
    ds_read_b64_tr_b16 v[102:103], v104 offset:12576
    v_bfe_u32 v105, v0, 1, 3
    v_lshlrev_b32 v105, 8, v105
    v_lshl_add_u32 v105, v109, 5, v105
    v_lshl_add_u32 v105, v110, 4, v105
    v_lshrrev_b32 v106, 3, v0
    v_lshlrev_b32 v106, 7, v106
    v_and_b32 v110, 7, v0
    v_lshl_add_u32 v107, v110, 3, v106
    v_add_u32 v107, s100, v107
    v_lshlrev_b32 v106, 8, v109
    v_and_b32 v110, 15, v0
    v_lshl_add_u32 v106, v110, 2, v106
    v_add_u32 v106, s96, v106
    v_lshlrev_b32 v108, 2, v0
    s_lshl_b32 s96, s62, 2
    s_add_u32 s96, s96, 162088
    v_mov_b32 v109, s96
    s_lshl_b32 s100, s63, 11
    s_lshl_b32 s96, s34, 13
    s_add_u32 s100, s100, s96
    s_add_u32 s100, s100, 106496
    s_mul_i32 s101, s34, 5120
    s_lshl_b32 s96, s35, 9
    s_add_u32 s101, s101, s96
    s_lshl_b32 s96, s62, 8
    s_add_u32 s101, s101, s96
    s_sub_u32 s101, s101, 11264
    s_and_b32 s96, s101, 0xffffe000
    s_add_u32 s101, s101, s96
    s_add_u32 s101, s101, 212992
    v_add_u32 v110, 8192, v108
L_nofrag_107:
    s_cmp_ge_u32 s35, 20
    s_cbranch_scc1 L_nofin_109
    s_lshl1_add_u32 s62, s35, s3
    s_sub_u32 s62, s62, 6
    s_lshl_b32 s57, s62, 7
    s_mul_i32 s63, s62, 0x199a
    s_lshr_b32 s63, s63, 16
    s_mul_i32 s63, s63, 1280
    s_sub_u32 s63, s57, s63
    v_lshrrev_b32 v72, 3, v0
    v_mul_u32_u24 v72, 5120, v72
    v_and_b32 v8, 7, v0
    v_lshl_add_u32 v72, v8, 4, v72
    s_add_u32 s62, s57, 327680
    v_add_u32 v72, s62, v72
    v_add_u32 v73, 40960, v72
    v_add_u32 v74, 81920, v72
    v_add_u32 v75, 122880, v72
    v_bfe_u32 v9, v0, 4, 1
    v_lshlrev_b32 v76, 4, v8
    v_lshl_add_u32 v76, v9, 3, v76
    s_lshl_b32 s62, s57, 1
    s_add_u32 s62, s62, 99328
    v_lshl_add_u32 v77, v76, 1, s62
    s_mov_b32 s48, s22
    s_mov_b32 s49, s23
    s_mov_b32 s50, 1280
    s_mov_b32 s51, 0x20000
    buffer_load_dwordx2 v[86:87], v76, s[48:51], s63 offen
    s_add_u32 s62, s57, 35840
    s_branch L_poll_110
L_poll_110s:
    s_sleep 32
L_poll_110:
    buffer_load_dwordx2 v[8:9], v76, s[40:43], s62 offen sc1
    s_sub_u32 s60, s60, 1
    s_cbranch_scc1 L_poll_110t
    s_waitcnt vmcnt(0)
    v_max_u32 v38, v8, v9
    v_cmp_eq_u32 vcc, -1, v38
    s_cbranch_vccnz L_poll_110s
L_poll_110e:
    v_lshlrev_b32 v78, 16, v86
    v_and_b32 v79, 0xffff0000, v86
    v_lshlrev_b32 v82, 16, v8
    v_and_b32 v83, 0xffff0000, v8
    v_lshlrev_b32 v80, 16, v87
    v_and_b32 v81, 0xffff0000, v87
    v_lshlrev_b32 v84, 16, v9
    v_and_b32 v85, 0xffff0000, v9
    v_bfe_u32 v8, v0, 1, 3
    v_and_b32 v9, 1, v0
    v_lshlrev_b32 v9, 4, v9
    v_mov_b32 v10, 0x3f80
    v_lshlrev_b32 v9, v9, v10
    v_cmp_eq_u32 vcc, 0, v8
    v_mov_b32 v100, 0
    s_nop 0
    v_cndmask_b32 v104, 0, v9, vcc
    v_cmp_eq_u32 vcc, 1, v8
    v_mov_b32 v101, 0
    s_nop 0
    v_cndmask_b32 v105, 0, v9, vcc
    v_cmp_eq_u32 vcc, 2, v8
    v_mov_b32 v102, 0
    s_nop 0
    v_cndmask_b32 v106, 0, v9, vcc
    v_cmp_eq_u32 vcc, 3, v8
    v_mov_b32 v103, 0
    s_nop 0
    v_cndmask_b32 v107, 0, v9, vcc
L_nofin_109:
    v_mov_b32 v12, 162076
L_lw_111:
    ds_read_b32 v13, v12
    s_waitcnt lgkmcnt(0)
    v_cmp_gt_u32 vcc, 4, v13
    s_cbranch_vccz L_lw_111e
    s_sleep 4
    s_sub_u32 s60, s60, 1
    s_cbranch_scc0 L_lw_111
    s_mov_b32 s60, 0
L_lw_111e:
    v_and_b32 v11, 31, v0
    v_lshlrev_b32 v11, 7, v11
    s_lshl_b32 s63, s34, 12
    s_add_u32 s63, s63, 73792
    buffer_load_dword v12, v39, s[40:43], s98 offen sc1
    s_branch L_poll_112
L_poll_112s:
    s_sleep 4
L_poll_112:
    buffer_load_dwordx2 v[8:9], v21, s[40:43], s99 offen sc1
    buffer_load_dword v10, v11, s[40:43], s63 offen sc1
    s_sub_u32 s60, s60, 1
    s_cbranch_scc1 L_poll_112t
    s_waitcnt vmcnt(0)
    v_max3_u32 v38, v8, v9, v10
    v_cmp_eq_u32 vcc, -1, v38
    s_cbranch_vccnz L_poll_112s
L_poll_112e:
    v_mov_b32 v37, v8
    s_nop 1
    v_max_f32_dpp v37, v37, v37 quad_perm:[1,0,3,2] row_mask:0xf bank_mask:0xf
    s_nop 1
    v_max_f32_dpp v37, v37, v37 quad_perm:[2,3,0,1] row_mask:0xf bank_mask:0xf
    s_nop 1
    v_max_f32_dpp v37, v37, v37 row_ror:4 row_mask:0xf bank_mask:0xf
    s_nop 1
    v_max_f32_dpp v37, v37, v37 row_ror:8 row_mask:0xf bank_mask:0xf
    v_sub_f32 v8, v8, v37
    v_exp_f32 v8, v8
    s_nop 0
    v_mul_f32 v9, v8, v9
    s_nop 1
    v_add_f32_dpp v9, v9, v9 quad_perm:[1,0,3,2] row_mask:0xf bank_mask:0xf
    s_nop 1
    v_add_f32_dpp v9, v9, v9 quad_perm:[2,3,0,1] row_mask:0xf bank_mask:0xf
    s_nop 1
    v_add_f32_dpp v9, v9, v9 row_ror:4 row_mask:0xf bank_mask:0xf
    s_nop 1
    v_add_f32_dpp v9, v9, v9 row_ror:8 row_mask:0xf bank_mask:0xf
    v_ashrrev_i32 v12, 8, v10
    s_nop 1
    v_add_u32_dpp v12, v12, v12 quad_perm:[1,0,3,2] row_mask:0xf bank_mask:0xf
    s_nop 1
    v_add_u32_dpp v12, v12, v12 quad_perm:[2,3,0,1] row_mask:0xf bank_mask:0xf
    s_nop 1
    v_add_u32_dpp v12, v12, v12 row_ror:4 row_mask:0xf bank_mask:0xf
    s_nop 1
    v_add_u32_dpp v12, v12, v12 row_ror:8 row_mask:0xf bank_mask:0xf
    v_mov_b32 v13, v12
    s_nop 1
    v_permlane16_swap_b32 v12, v13
    v_add_u32 v12, v12, v13
    v_mov_b32 v13, v12
    s_nop 1
    v_permlane32_swap_b32 v12, v13
    v_add_u32 v12, v12, v13
    v_ashrrev_i32 v12, 31, v12
    v_and_b32 v12, 8192, v12
    v_mov_b32 v13, 162084
    ds_write_b32 v13, v12
    v_and_b32 v10, 0xff, v10
    s_getreg_b32 s62, hwreg(HW_REG_XCC_ID, 0, 4)
    v_cmp_ne_u32 vcc, s62, v10
    s_nop 0
    s_cmp_eq_u64 vcc, 0
    s_cselect_b32 s61, 1, 0
    v_rcp_f32 v9, v9
    v_lshrrev_b32 v3, 1, v2
    v_add_u32 v3, 161984, v3
    v_mul_f32 v8, v8, v9
    v_mov_b32 v10, 162072
    v_mov_b32 v11, s61
    ds_write_b32 v3, v8
    ds_write_b32 v10, v11
    s_cmp_eq_u32 s61, 1
    s_cbranch_scc0 L_ycs
    buffer_store_dwordx4 v[24:27], v22, s[40:43], 0 offen offset:0
    buffer_store_dwordx4 v[24:27], v22, s[40:43], 0 offen offset:1024
    buffer_store_dwordx4 v[24:27], v22, s[40:43], 0 offen offset:2048
    buffer_store_dwordx4 v[24:27], v22, s[40:43], 0 offen offset:3072
    buffer_store_dwordx4 v[24:27], v23, s[40:43], 0 offen offset:0
L_ycd:
    s_branch L_poll_113
L_poll_113s:
    s_sleep 4
L_poll_113:
    buffer_load_dwordx4 v[32:35], v20, s[40:43], s97 offen sc1
    s_sub_u32 s60, s60, 1
    s_cbranch_scc1 L_poll_113t
    s_waitcnt vmcnt(0)
    v_max3_u32 v38, v32, v33, v34
    v_max_u32 v38, v38, v35
    v_cmp_eq_u32 vcc, -1, v38
    s_cbranch_vccnz L_poll_113s
L_poll_113e:
    s_branch L_pxj
L_px6:
    s_or_b32 s96, s59, s39
    s_cbranch_scc0 L_nofrag_114
    v_mov_b32 v104, 162060
L_lw_115:
    ds_read_b32 v105, v104
    s_waitcnt lgkmcnt(0)
    v_cmp_gt_u32 vcc, 4, v105
    s_cbranch_vccz L_lw_115e
    s_sleep 2
    s_sub_u32 s60, s60, 1
    s_cbranch_scc0 L_lw_115
    s_mov_b32 s60, 0
L_lw_115e:
    s_cmp_eq_u32 s59, 0
    s_cbranch_scc1 L_nofrag_114
    v_bfe_u32 v104, v0, 2, 1
    v_bfe_u32 v110, v0, 4, 1
    v_lshl_add_u32 v104, v110, 2, v104
    v_and_b32 v110, 8, v0
    v_add_u32 v104, v104, v110
    v_lshrrev_b32 v110, 5, v0
    v_lshl_add_u32 v104, v110, 4, v104
    v_bfe_u32 v111, v0, 0, 1
    v_mul_u32_u24 v111, 0xaaaa, v111
    v_add_u32 v111, 0x4444, v111
    v_mov_b32 v112, 0
    v_mov_b32 v113, 0
    v_mov_b32 v114, 0
    v_mov_b32 v115, 0
    v_mov_b32 v116, 0
    v_mov_b32 v117, 0
    v_mov_b32 v118, 0
    v_mov_b32 v119, 0
    v_lshlrev_b32 v104, 7, v104
    v_and_b32 v110, 3, v0
    v_lshl_add_u32 v104, v110, 3, v104
    v_lshrrev_b32 v109, 4, v0
    v_and_b32 v110, 1, v0
    s_lshr_b32 s63, s3, 1
    s_and_b32 s62, s3, 1
    s_lshl_b32 s96, s63, 14
    s_lshl_b32 s100, s62, 6
    s_add_u32 s100, s100, 81920
    s_add_u32 s96, s96, s100
    v_add_u32 v104, s96, v104
    ds_read_b64_tr_b16 v[72:73], v104 offset:0
    ds_read_b64_tr_b16 v[74:75], v104 offset:256
    ds_read_b64_tr_b16 v[76:77], v104 offset:4096
    ds_read_b64_tr_b16 v[78:79], v104 offset:4352
    ds_read_b64_tr_b16 v[80:81], v104 offset:32
    ds_read_b64_tr_b16 v[82:83], v104 offset:288
    ds_read_b64_tr_b16 v[84:85], v104 offset:4128
    ds_read_b64_tr_b16 v[86:87], v104 offset:4384
    ds_read_b64_tr_b16 v[88:89], v104 offset:8192
    ds_read_b64_tr_b16 v[90:91], v104 offset:8448
    ds_read_b64_tr_b16 v[92:93], v104 offset:12288
    ds_read_b64_tr_b16 v[94:95], v104 offset:12544
    ds_read_b64_tr_b16 v[96:97], v104 offset:8224
    ds_read_b64_tr_b16 v[98:99], v104 offset:8480
    ds_read_b64_tr_b16 v[100:101], v104 offset:12320
    ds_read_b64_tr_b16 v[102:103], v104 offset:12576
    v_bfe_u32 v105, v0, 1, 3
    v_lshlrev_b32 v105, 8, v105
    v_lshl_add_u32 v105, v109, 5, v105
    v_lshl_add_u32 v105, v110, 4, v105
    v_lshrrev_b32 v106, 3, v0
    v_lshlrev_b32 v106, 7, v106
    v_and_b32 v110, 7, v0
    v_lshl_add_u32 v107, v110, 3, v106
    v_add_u32 v107, s100, v107
    v_lshlrev_b32 v106, 8, v109
    v_and_b32 v110, 15, v0
    v_lshl_add_u32 v106, v110, 2, v106
    v_add_u32 v106, s96, v106
    v_lshlrev_b32 v108, 2, v0
    s_lshl_b32 s96, s62, 2
    s_add_u32 s96, s96, 162088
    v_mov_b32 v109, s96
    s_lshl_b32 s100, s63, 11
    s_lshl_b32 s96, s34, 13
    s_add_u32 s100, s100, s96
    s_add_u32 s100, s100, 106496
    s_mul_i32 s101, s34, 5120
    s_lshl_b32 s96, s35, 9
    s_add_u32 s101, s101, s96
    s_lshl_b32 s96, s62, 8
    s_add_u32 s101, s101, s96
    s_sub_u32 s101, s101, 11264
    s_and_b32 s96, s101, 0xffffe000
    s_add_u32 s101, s101, s96
    s_add_u32 s101, s101, 212992
    v_add_u32 v110, 8192, v108
L_nofrag_114:
    s_mov_b32 s62, 3
    s_lshl1_add_u32 s96, s35, s3
    s_and_b32 s63, s96, 7
    s_lshl_b32 s63, s63, 14
    s_lshl_b32 s96, s96, 7
    s_add_u32 s96, s96, s63
    s_add_u32 s96, s96, 475136
    s_add_u32 s98, s32, s96
    s_addc_u32 s99, s33, 0
    s_load_dword s4, s[98:99], 0 glc
    s_load_dword s5, s[98:99], 8192 glc
    s_mov_b32 s63, 0
    s_waitcnt lgkmcnt(0)
L_np:
    s_not_b32 s4, s4
    s_mov_b32 s6, s4
    s_mov_b32 s7, 0
    s_load_dword s4, s[98:99], 0 glc
L_npc0:
    s_add_u32 s7, s7, 1
    s_cmp_eq_u32 s4, s6
    s_cselect_b32 s8, s7, 1000
    s_cmp_lt_u32 s8, 60
    s_cbranch_scc1 L_npc0
    s_waitcnt lgkmcnt(0)
    s_sub_u32 s63, s63, s7
    s_not_b32 s5, s5
    s_mov_b32 s6, s5
    s_mov_b32 s7, 0
    s_load_dword s5, s[98:99], 8192 glc
L_npc1:
    s_add_u32 s7, s7, 1
    s_cmp_eq_u32 s5, s6
    s_cselect_b32 s8, s7, 1000
    s_cmp_lt_u32 s8, 60
    s_cbranch_scc1 L_npc1
    s_waitcnt lgkmcnt(0)
    s_add_u32 s63, s63, s7
    s_sub_u32 s62, s62, 1
    s_cmp_lg_u32 s62, 0
    s_cbranch_scc1 L_np
    v_mov_b32 v8, 162096
    v_mov_b32 v9, s63
    s_mov_b64 exec, 1
    ds_add_u32 v8, v9
    s_mov_b64 exec, -1
    v_mov_b32 v8, 162068
L_lw_116:
    ds_read_b32 v9, v8
    s_waitcnt lgkmcnt(0)
    v_cmp_gt_u32 vcc, 1, v9
    s_cbranch_vccz L_lw_116e
    s_sleep 32
    s_sub_u32 s60, s60, 1
    s_cbranch_scc0 L_lw_116
    s_mov_b32 s60, 0
L_lw_116e:
    s_cmp_ge_u32 s35, 20
    s_cbranch_scc1 L_nofin_117
    s_lshl1_add_u32 s62, s35, s3
    s_sub_u32 s62, s62, 6
    s_lshl_b32 s57, s62, 7
    s_mul_i32 s63, s62, 0x199a
    s_lshr_b32 s63, s63, 16
    s_mul_i32 s63, s63, 1280
    s_sub_u32 s63, s57, s63
    v_lshrrev_b32 v72, 3, v0
    v_mul_u32_u24 v72, 5120, v72
    v_and_b32 v8, 7, v0
    v_lshl_add_u32 v72, v8, 4, v72
    s_add_u32 s62, s57, 327680
    v_add_u32 v72, s62, v72
    v_add_u32 v73, 40960, v72
    v_add_u32 v74, 81920, v72
    v_add_u32 v75, 122880, v72
    v_bfe_u32 v9, v0, 4, 1
    v_lshlrev_b32 v76, 4, v8
    v_lshl_add_u32 v76, v9, 3, v76
    s_lshl_b32 s62, s57, 1
    s_add_u32 s62, s62, 99328
    v_lshl_add_u32 v77, v76, 1, s62
    s_mov_b32 s48, s22
    s_mov_b32 s49, s23
    s_mov_b32 s50, 1280
    s_mov_b32 s51, 0x20000
    buffer_load_dwordx2 v[86:87], v76, s[48:51], s63 offen
    s_add_u32 s62, s57, 35840
    s_branch L_poll_118
L_poll_118s:
    s_sleep 32
L_poll_118:
    buffer_load_dwordx2 v[8:9], v76, s[40:43], s62 offen sc1
    s_sub_u32 s60, s60, 1
    s_cbranch_scc1 L_poll_118t
    s_waitcnt vmcnt(0)
    v_max_u32 v38, v8, v9
    v_cmp_eq_u32 vcc, -1, v38
    s_cbranch_vccnz L_poll_118s
L_poll_118e:
    v_lshlrev_b32 v78, 16, v86
    v_and_b32 v79, 0xffff0000, v86
    v_lshlrev_b32 v82, 16, v8
    v_and_b32 v83, 0xffff0000, v8
    v_lshlrev_b32 v80, 16, v87
    v_and_b32 v81, 0xffff0000, v87
    v_lshlrev_b32 v84, 16, v9
    v_and_b32 v85, 0xffff0000, v9
    v_bfe_u32 v8, v0, 1, 3
    v_and_b32 v9, 1, v0
    v_lshlrev_b32 v9, 4, v9
    v_mov_b32 v10, 0x3f80
    v_lshlrev_b32 v9, v9, v10
    v_cmp_eq_u32 vcc, 0, v8
    v_mov_b32 v100, 0
    s_nop 0
    v_cndmask_b32 v104, 0, v9, vcc
    v_cmp_eq_u32 vcc, 1, v8
    v_mov_b32 v101, 0
    s_nop 0
    v_cndmask_b32 v105, 0, v9, vcc
    v_cmp_eq_u32 vcc, 2, v8
    v_mov_b32 v102, 0
    s_nop 0
    v_cndmask_b32 v106, 0, v9, vcc
    v_cmp_eq_u32 vcc, 3, v8
    v_mov_b32 v103, 0
    s_nop 0
    v_cndmask_b32 v107, 0, v9, vcc
L_nofin_117:
    v_mov_b32 v8, 162076
L_lw_119:
    ds_read_b32 v9, v8
    s_waitcnt lgkmcnt(0)
    v_cmp_gt_u32 vcc, 4, v9
    s_cbranch_vccz L_lw_119e
    s_sleep 16
    s_sub_u32 s60, s60, 1
    s_cbranch_scc0 L_lw_119
    s_mov_b32 s60, 0
L_lw_119e:
    s_branch L_poll_120
L_poll_120s:
    s_sleep 4
L_poll_120:
    buffer_load_dwordx4 v[32:35], v20, s[40:43], s97 offen sc1
    s_sub_u32 s60, s60, 1
    s_cbranch_scc1 L_poll_120t
    s_waitcnt vmcnt(0)
    v_max3_u32 v38, v32, v33, v34
    v_max_u32 v38, v38, v35
    v_cmp_eq_u32 vcc, -1, v38
    s_cbranch_vccnz L_poll_120s
L_poll_120e:
L_pxj:
    s_cmp_ge_u32 s35, 20
    s_cbranch_scc1 L_pxk
    s_mov_b64 exec, -1
L_pxk:
    v_mov_b32 v8, 162048
L_lw_121:
    ds_read_b32 v9, v8
    s_waitcnt lgkmcnt(0)
    v_cmp_gt_u32 vcc, 3, v9
    s_cbranch_vccz L_lw_121e
    s_sleep 2
    s_sub_u32 s60, s60, 1
    s_cbranch_scc0 L_lw_121
    s_mov_b32 s60, 0
L_lw_121e:
    v_lshrrev_b32 v9, 4, v0
    v_lshl_add_u32 v8, v9, 2, v2
    s_lshl_b32 s96, s3, 9
    s_add_u32 s96, s96, 157824
    v_lshl_add_u32 v8, v8, 2, s96
    v_lshlrev_b32 v9, 3, v0
    v_add_u32 v9, 157824, v9
    v_mov_b32 v10, 162048
    v_mov_b32 v11, 1
    s_lshl_b32 s96, s38, 5
    s_add_u32 s96, s96, 161984
    v_mov_b32 v3, s96
    s_sub_u32 s62, 8, s39
    s_lshl_b32 s98, s34, 5
    s_add_u32 s98, s98, s35
    s_lshl_b32 s98, s98, 8
    s_add_u32 s98, s98, 106496
    v_lshlrev_b32 v39, 2, v0
    s_branch L_t0
L_s_role:
    s_cmp_eq_u32 s3, 7
    s_cbranch_scc1 L_t2gate
    s_cmp_gt_u32 s3, 3
    s_cbranch_scc1 L_fin_prep
    s_mov_b32 s48, s18
    s_mov_b32 s49, s19
    s_mov_b32 s50, 3456
    s_mov_b32 s51, 0x20000
    v_lshrrev_b32 v3, 4, v0
    v_and_b32 v4, 15, v0
    v_lshlrev_b32 v4, 1, v4
    s_lshl_b32 s62, s35, 7
    s_lshl_b32 s63, s3, 5
    s_add_u32 s62, s62, s63
    buffer_load_ushort v82, v4, s[48:51], s62 offen
    v_mov_b32 v72, 162064
L_lw_122:
    ds_read_b32 v73, v72
    s_waitcnt lgkmcnt(0)
    v_cmp_gt_u32 vcc, 4, v73
    s_cbranch_vccz L_lw_122e
    s_sleep 2
    s_sub_u32 s60, s60, 1
    s_cbranch_scc0 L_lw_122
    s_mov_b32 s60, 0
L_lw_122e:
    v_bfe_u32 v72, v0, 2, 1
    v_bfe_u32 v73, v0, 4, 1
    v_lshl_add_u32 v72, v73, 2, v72
    v_and_b32 v73, 8, v0
    v_add_u32 v72, v72, v73
    v_lshrrev_b32 v73, 5, v0
    v_lshl_add_u32 v72, v73, 4, v72
    v_lshlrev_b32 v72, 7, v72
    v_and_b32 v73, 3, v0
    v_lshl_add_u32 v72, v73, 3, v72
    v_and_b32 v73, 8, v0
    v_lshl_add_u32 v72, v73, 3, v72
    v_xor_b32 v72, s63, v72
    v_xor_b32 v73, 32, v72
    v_add_u32 v74, 40960, v72
    v_add_u32 v75, 40960, v73
    v_bfe_u32 v1, v0, 2, 2
    v_bfe_u32 v2, v0, 1, 1
    v_and_b32 v6, 1, v0
    v_lshlrev_b32 v7, 5, v3
    v_lshl_add_u32 v7, v6, 4, v7
    v_lshl_add_u32 v5, v2, 2, v1
    v_mul_u32_u24 v5, 1296, v5
    v_add_u32 v5, v5, v7
    v_add_u32 v5, 147456, v5
    v_bfe_u32 v87, v0, 0, 1
    v_mul_u32_u24 v87, 0xaaaa, v87
    v_add_u32 v87, 0x4444, v87
    ds_read_b64_tr_b16 v[88:89], v72 offset:0
    ds_read_b64_tr_b16 v[90:91], v73 offset:256
    ds_read_b64_tr_b16 v[92:93], v72 offset:4096
    ds_read_b64_tr_b16 v[94:95], v73 offset:4352
    ds_read_b64_tr_b16 v[96:97], v72 offset:8192
    ds_read_b64_tr_b16 v[98:99], v73 offset:8448
    ds_read_b64_tr_b16 v[100:101], v72 offset:12288
    ds_read_b64_tr_b16 v[102:103], v73 offset:12544
    ds_read_b64_tr_b16 v[104:105], v72 offset:16384
    ds_read_b64_tr_b16 v[106:107], v73 offset:16640
    ds_read_b64_tr_b16 v[108:109], v72 offset:20480
    ds_read_b64_tr_b16 v[110:111], v73 offset:20736
    ds_read_b64_tr_b16 v[112:113], v72 offset:24576
    ds_read_b64_tr_b16 v[114:115], v73 offset:24832
    ds_read_b64_tr_b16 v[116:117], v72 offset:28672
    ds_read_b64_tr_b16 v[118:119], v73 offset:28928
    ds_read_b64_tr_b16 v[120:121], v72 offset:32768
    ds_read_b64_tr_b16 v[122:123], v73 offset:33024
    ds_read_b64_tr_b16 v[124:125], v72 offset:36864
    ds_read_b64_tr_b16 v[126:127], v73 offset:37120
    ds_read_b64_tr_b16 v[128:129], v74 offset:0
    ds_read_b64_tr_b16 v[130:131], v75 offset:256
    ds_read_b64_tr_b16 v[132:133], v74 offset:4096
    ds_read_b64_tr_b16 v[134:135], v75 offset:4352
    ds_read_b64_tr_b16 v[136:137], v74 offset:8192
    ds_read_b64_tr_b16 v[138:139], v75 offset:8448
    ds_read_b64_tr_b16 v[140:141], v74 offset:12288
    ds_read_b64_tr_b16 v[142:143], v75 offset:12544
    ds_read_b64_tr_b16 v[144:145], v74 offset:16384
    ds_read_b64_tr_b16 v[146:147], v75 offset:16640
    ds_read_b64_tr_b16 v[148:149], v74 offset:20480
    ds_read_b64_tr_b16 v[150:151], v75 offset:20736
    ds_read_b64_tr_b16 v[152:153], v74 offset:24576
    ds_read_b64_tr_b16 v[154:155], v75 offset:24832
    ds_read_b64_tr_b16 v[156:157], v74 offset:28672
    ds_read_b64_tr_b16 v[158:159], v75 offset:28928
    ds_read_b64_tr_b16 v[160:161], v74 offset:32768
    ds_read_b64_tr_b16 v[162:163], v75 offset:33024
    ds_read_b64_tr_b16 v[164:165], v74 offset:36864
    ds_read_b64_tr_b16 v[166:167], v75 offset:37120
    ds_read_b128 v[8:11], v5 offset:0
    ds_read_b128 v[12:15], v5 offset:128
    ds_read_b128 v[16:19], v5 offset:256
    ds_read_b128 v[20:23], v5 offset:384
    ds_read_b128 v[24:27], v5 offset:512
    ds_read_b128 v[28:31], v5 offset:640
    ds_read_b128 v[32:35], v5 offset:768
    ds_read_b128 v[36:39], v5 offset:896
    ds_read_b128 v[40:43], v5 offset:1024
    ds_read_b128 v[44:47], v5 offset:1152
    v_mov_b32 v48, 0
    v_mov_b32 v49, 0
    v_mov_b32 v50, 0
    v_mov_b32 v51, 0
    v_mov_b32 v52, 0
    v_mov_b32 v53, 0
    v_mov_b32 v54, 0
    v_mov_b32 v55, 0
    v_mov_b32 v56, 0
    v_mov_b32 v57, 0
    v_mov_b32 v58, 0
    v_mov_b32 v59, 0
    s_waitcnt lgkmcnt(9)
    v_smfmac_f32_16x16x64_bf16 v[48:51], v[8:11], v[88:95], v87
    s_waitcnt lgkmcnt(8)
    v_smfmac_f32_16x16x64_bf16 v[48:51], v[12:15], v[96:103], v87
    s_waitcnt lgkmcnt(7)
    v_smfmac_f32_16x16x64_bf16 v[48:51], v[16:19], v[104:111], v87
    s_waitcnt lgkmcnt(6)
    v_smfmac_f32_16x16x64_bf16 v[48:51], v[20:23], v[112:119], v87
    s_waitcnt lgkmcnt(5)
    v_smfmac_f32_16x16x64_bf16 v[48:51], v[24:27], v[120:127], v87
    s_waitcnt lgkmcnt(4)
    v_smfmac_f32_16x16x64_bf16 v[48:51], v[28:31], v[128:135], v87
    s_waitcnt lgkmcnt(3)
    v_smfmac_f32_16x16x64_bf16 v[48:51], v[32:35], v[136:143], v87
    s_waitcnt lgkmcnt(2)
    v_smfmac_f32_16x16x64_bf16 v[48:51], v[36:39], v[144:151], v87
    s_waitcnt lgkmcnt(1)
    v_smfmac_f32_16x16x64_bf16 v[48:51], v[40:43], v[152:159], v87
    s_waitcnt lgkmcnt(0)
    v_smfmac_f32_16x16x64_bf16 v[48:51], v[44:47], v[160:167], v87
    v_mul_u32_u24 v79, 1296, v1
    v_lshl_add_u32 v79, v2, 7, v79
    v_add_u32 v79, v79, v7
    v_add_u32 v79, 82944, v79
    v_mul_u32_u24 v80, 144, v3
    v_add3_u32 v80, v80, v4, s63
    v_add_u32 v80, 90688, v80
    v_lshlrev_b32 v81, 3, v0
    v_add_u32 v81, 88128, v81
    v_add_f32 v84, v48, v49
    v_add_f32 v85, v50, v51
    s_mov_b32 s62, 0xbacccccd
    s_mov_b32 s63, 0xbdd2d3e8
    v_mov_b32 v86, 0xc0135761
    s_waitcnt vmcnt(0)
    v_lshlrev_b32 v82, 16, v82
    v_add_f32 v85, v85, v82
    s_branch L_ffn1
L_fin_prep:
    s_cmp_lg_u32 s3, 6
    s_cbranch_scc1 L_end
    s_cmp_ge_u32 s35, 20
    s_cbranch_scc1 L_end
    s_barrier
L_fin:
    s_mov_b32 s52, s28
    s_mov_b32 s53, s29
    s_mov_b32 s54, 5120
    s_mov_b32 s55, 0x20000
    s_mov_b64 s[4:5], -1
    s_mov_b64 s[6:7], -1
    s_mov_b64 s[8:9], -1
    s_mov_b64 s[10:11], 0xffffff
    s_barrier
    ds_read_b128 v[108:111], v77
    s_barrier
L_yg:
    s_mov_b64 exec, s[4:5]
    buffer_load_dwordx4 v[88:91], v72, s[40:43], 0 offen sc1
    s_mov_b64 exec, s[6:7]
    buffer_load_dwordx4 v[92:95], v73, s[40:43], 0 offen sc1
    s_mov_b64 exec, s[8:9]
    buffer_load_dwordx4 v[96:99], v74, s[40:43], 0 offen sc1
    s_mov_b64 exec, s[10:11]
    buffer_load_dwordx4 v[100:103], v75, s[40:43], 0 offen sc1
    s_mov_b64 exec, -1
    s_sub_u32 s60, s60, 1
    s_cbranch_scc1 L_ygt
    s_waitcnt vmcnt(3)
    v_max3_u32 v3, v88, v89, v90
    v_max_u32 v3, v3, v91
    v_cmp_eq_u32 s[4:5], -1, v3
    s_waitcnt vmcnt(2)
    v_max3_u32 v3, v92, v93, v94
    v_max_u32 v3, v3, v95
    v_cmp_eq_u32 s[6:7], -1, v3
    s_waitcnt vmcnt(1)
    v_max3_u32 v3, v96, v97, v98
    v_max_u32 v3, v3, v99
    v_cmp_eq_u32 s[8:9], -1, v3
    s_waitcnt vmcnt(0)
    v_max3_u32 v3, v100, v101, v102
    v_max_u32 v3, v3, v103
    v_cmp_eq_u32 s[10:11], -1, v3
    s_or_b64 s[16:17], s[4:5], s[6:7]
    s_or_b64 s[16:17], s[16:17], s[8:9]
    s_or_b64 s[16:17], s[16:17], s[10:11]
    s_cbranch_scc1 L_yg
L_ygd:
    v_mfma_f32_16x16x32_bf16 v[112:115], v[104:107], v[88:91], 0
    v_mfma_f32_16x16x32_bf16 v[112:115], v[104:107], v[92:95], v[112:115]
    v_mfma_f32_16x16x32_bf16 v[112:115], v[104:107], v[96:99], v[112:115]
    v_mfma_f32_16x16x32_bf16 v[112:115], v[104:107], v[100:103], v[112:115]
    s_waitcnt lgkmcnt(0)
    v_pk_fma_f32 v[108:109], v[78:79], v[82:83], v[108:109]
    v_pk_fma_f32 v[110:111], v[80:81], v[84:85], v[110:111]
    s_nop 4
    v_add_f32_dpp v112, v112, v112 row_ror:8 row_mask:0xf bank_mask:0xf
    v_add_f32_dpp v113, v113, v113 row_ror:8 row_mask:0xf bank_mask:0xf
    v_add_f32_dpp v114, v114, v114 row_ror:8 row_mask:0xf bank_mask:0xf
    v_add_f32_dpp v115, v115, v115 row_ror:8 row_mask:0xf bank_mask:0xf
    v_pk_fma_f32 v[112:113], v[112:113], v[82:83], v[108:109]
    v_pk_fma_f32 v[114:115], v[114:115], v[84:85], v[110:111]
    v_cvt_pk_bf16_f32 v112, v112, v113
    v_cvt_pk_bf16_f32 v113, v114, v115
    s_mov_b64 exec, 0x00ff00ff
    buffer_store_dwordx2 v[112:113], v76, s[52:55], s57 offen
    s_endpgm
L_t2gate:
    v_mov_b32 v8, 162048
L_lw_123:
    ds_read_b32 v9, v8
    s_waitcnt lgkmcnt(0)
    v_cmp_gt_u32 vcc, 8, v9
    s_cbranch_vccz L_lw_123e
    s_sleep 2
    s_sub_u32 s60, s60, 1
    s_cbranch_scc0 L_lw_123
    s_mov_b32 s60, 0
L_lw_123e:
    ds_read_b32 v9, v8 offset:24
    ds_read_b32 v10, v8 offset:36
    v_add_u32 v5, 212992, v5
    s_waitcnt lgkmcnt(0)
    v_readfirstlane_b32 s61, v9
    v_add_u32 v5, v5, v10
    s_mov_b32 s58, 0x3f80
    s_mov_b32 s59, 0x3f800000
    s_mov_b32 s63, 0xff
L_prb:
    s_bcnt1_i32_b32 s62, s63
    s_mov_b32 s97, s63
    s_ff1_i32_b32 s12, s97
    s_bitset0_b32 s97, s12
    s_mul_i32 s4, s12, 5120
    s_add_u32 s4, s4, s56
    s_and_b32 s96, s4, 0xffffe000
    s_add_u32 s4, s4, s96
    s_cmp_eq_u32 s62, 1
    s_cbranch_scc1 L_pi1
    s_ff1_i32_b32 s13, s97
    s_bitset0_b32 s97, s13
    s_mul_i32 s5, s13, 5120
    s_add_u32 s5, s5, s56
    s_and_b32 s96, s5, 0xffffe000
    s_add_u32 s5, s5, s96
    s_cmp_eq_u32 s62, 2
    s_cbranch_scc1 L_pi2
    s_ff1_i32_b32 s14, s97
    s_bitset0_b32 s97, s14
    s_mul_i32 s6, s14, 5120
    s_add_u32 s6, s6, s56
    s_and_b32 s96, s6, 0xffffe000
    s_add_u32 s6, s6, s96
    s_cmp_eq_u32 s62, 3
    s_cbranch_scc1 L_pi3
    s_ff1_i32_b32 s15, s97
    s_bitset0_b32 s97, s15
    s_mul_i32 s7, s15, 5120
    s_add_u32 s7, s7, s56
    s_and_b32 s96, s7, 0xffffe000
    s_add_u32 s7, s7, s96
    s_cmp_eq_u32 s62, 4
    s_cbranch_scc1 L_pi4
    s_ff1_i32_b32 s16, s97
    s_bitset0_b32 s97, s16
    s_mul_i32 s8, s16, 5120
    s_add_u32 s8, s8, s56
    s_and_b32 s96, s8, 0xffffe000
    s_add_u32 s8, s8, s96
    s_cmp_eq_u32 s62, 5
    s_cbranch_scc1 L_pi5
    s_ff1_i32_b32 s17, s97
    s_bitset0_b32 s97, s17
    s_mul_i32 s9, s17, 5120
    s_add_u32 s9, s9, s56
    s_and_b32 s96, s9, 0xffffe000
    s_add_u32 s9, s9, s96
    s_cmp_eq_u32 s62, 6
    s_cbranch_scc1 L_pi6
    s_ff1_i32_b32 s18, s97
    s_bitset0_b32 s97, s18
    s_mul_i32 s10, s18, 5120
    s_add_u32 s10, s10, s56
    s_and_b32 s96, s10, 0xffffe000
    s_add_u32 s10, s10, s96
    s_cmp_eq_u32 s62, 7
    s_cbranch_scc1 L_pi7
    s_ff1_i32_b32 s19, s97
    s_bitset0_b32 s97, s19
    s_mul_i32 s11, s19, 5120
    s_add_u32 s11, s11, s56
    s_and_b32 s96, s11, 0xffffe000
    s_add_u32 s11, s11, s96
L_pi8:
    buffer_load_dwordx4 v[36:39], v5, s[40:43], s11 offen sc1
L_pi7:
    buffer_load_dwordx4 v[32:35], v5, s[40:43], s10 offen sc1
L_pi6:
    buffer_load_dwordx4 v[28:31], v5, s[40:43], s9 offen sc1
L_pi5:
    buffer_load_dwordx4 v[24:27], v5, s[40:43], s8 offen sc1
L_pi4:
    buffer_load_dwordx4 v[20:23], v5, s[40:43], s7 offen sc1
L_pi3:
    buffer_load_dwordx4 v[16:19], v5, s[40:43], s6 offen sc1
L_pi2:
    buffer_load_dwordx4 v[12:15], v5, s[40:43], s5 offen sc1
    buffer_load_dwordx4 v[8:11], v5, s[40:43], s4 offen sc1
    s_sub_u32 s60, s60, 1
    s_cbranch_scc1 L_pto
    s_waitcnt vmcnt(0)
    v_max3_u32 v3, v8, v9, v10
    v_max_u32 v3, v3, v11
    v_cmp_eq_u32 vcc, -1, v3
    s_cbranch_vccz L_pgot0
    v_max3_u32 v3, v12, v13, v14
    v_max_u32 v3, v3, v15
    v_cmp_eq_u32 vcc, -1, v3
    s_cbranch_vccz L_pgot1
    s_cmp_eq_u32 s62, 2
    s_cbranch_scc1 L_pi2
    v_max3_u32 v3, v16, v17, v18
    v_max_u32 v3, v3, v19
    v_cmp_eq_u32 vcc, -1, v3
    s_cbranch_vccz L_pgot2
    s_cmp_eq_u32 s62, 3
    s_cbranch_scc1 L_pi3
    v_max3_u32 v3, v20, v21, v22
    v_max_u32 v3, v3, v23
    v_cmp_eq_u32 vcc, -1, v3
    s_cbranch_vccz L_pgot3
    s_cmp_eq_u32 s62, 4
    s_cbranch_scc1 L_pi4
    v_max3_u32 v3, v24, v25, v26
    v_max_u32 v3, v3, v27
    v_cmp_eq_u32 vcc, -1, v3
    s_cbranch_vccz L_pgot4
    s_cmp_eq_u32 s62, 5
    s_cbranch_scc1 L_pi5
    v_max3_u32 v3, v28, v29, v30
    v_max_u32 v3, v3, v31
    v_cmp_eq_u32 vcc, -1, v3
    s_cbranch_vccz L_pgot5
    s_cmp_eq_u32 s62, 6
    s_cbranch_scc1 L_pi6
    v_max3_u32 v3, v32, v33, v34
    v_max_u32 v3, v3, v35
    v_cmp_eq_u32 vcc, -1, v3
    s_cbranch_vccz L_pgot6
    s_cmp_eq_u32 s62, 7
    s_cbranch_scc1 L_pi7
    v_max3_u32 v3, v36, v37, v38
    v_max_u32 v3, v3, v39
    v_cmp_eq_u32 vcc, -1, v3
    s_cbranch_vccz L_pgot7
    s_branch L_pi8
L_pgot0:
    v_dot2c_f32_bf16 v64, s58, v8
    v_dot2c_f32_bf16 v65, s59, v8
    v_dot2c_f32_bf16 v66, s58, v9
    v_dot2c_f32_bf16 v67, s59, v9
    v_dot2c_f32_bf16 v68, s58, v10
    v_dot2c_f32_bf16 v69, s59, v10
    v_dot2c_f32_bf16 v70, s58, v11
    v_dot2c_f32_bf16 v71, s59, v11
    s_bitset0_b32 s63, s12
    s_cmp_eq_u32 s63, 0
    s_cbranch_scc1 L_pgd
L_pn0:
    s_cmp_eq_u32 s62, 1
    s_cbranch_scc1 L_prb
    v_max3_u32 v3, v12, v13, v14
    v_max_u32 v3, v3, v15
    v_cmp_eq_u32 vcc, -1, v3
    s_cbranch_vccnz L_pn1
L_pgot1:
    v_dot2c_f32_bf16 v64, s58, v12
    v_dot2c_f32_bf16 v65, s59, v12
    v_dot2c_f32_bf16 v66, s58, v13
    v_dot2c_f32_bf16 v67, s59, v13
    v_dot2c_f32_bf16 v68, s58, v14
    v_dot2c_f32_bf16 v69, s59, v14
    v_dot2c_f32_bf16 v70, s58, v15
    v_dot2c_f32_bf16 v71, s59, v15
    s_bitset0_b32 s63, s13
    s_cmp_eq_u32 s63, 0
    s_cbranch_scc1 L_pgd
L_pn1:
    s_cmp_eq_u32 s62, 2
    s_cbranch_scc1 L_prb
    v_max3_u32 v3, v16, v17, v18
    v_max_u32 v3, v3, v19
    v_cmp_eq_u32 vcc, -1, v3
    s_cbranch_vccnz L_pn2
L_pgot2:
    v_dot2c_f32_bf16 v64, s58, v16
    v_dot2c_f32_bf16 v65, s59, v16
    v_dot2c_f32_bf16 v66, s58, v17
    v_dot2c_f32_bf16 v67, s59, v17
    v_dot2c_f32_bf16 v68, s58, v18
    v_dot2c_f32_bf16 v69, s59, v18
    v_dot2c_f32_bf16 v70, s58, v19
    v_dot2c_f32_bf16 v71, s59, v19
    s_bitset0_b32 s63, s14
    s_cmp_eq_u32 s63, 0
    s_cbranch_scc1 L_pgd
L_pn2:
    s_cmp_eq_u32 s62, 3
    s_cbranch_scc1 L_prb
    v_max3_u32 v3, v20, v21, v22
    v_max_u32 v3, v3, v23
    v_cmp_eq_u32 vcc, -1, v3
    s_cbranch_vccnz L_pn3
L_pgot3:
    v_dot2c_f32_bf16 v64, s58, v20
    v_dot2c_f32_bf16 v65, s59, v20
    v_dot2c_f32_bf16 v66, s58, v21
    v_dot2c_f32_bf16 v67, s59, v21
    v_dot2c_f32_bf16 v68, s58, v22
    v_dot2c_f32_bf16 v69, s59, v22
    v_dot2c_f32_bf16 v70, s58, v23
    v_dot2c_f32_bf16 v71, s59, v23
    s_bitset0_b32 s63, s15
    s_cmp_eq_u32 s63, 0
    s_cbranch_scc1 L_pgd
L_pn3:
    s_cmp_eq_u32 s62, 4
    s_cbranch_scc1 L_prb
    v_max3_u32 v3, v24, v25, v26
    v_max_u32 v3, v3, v27
    v_cmp_eq_u32 vcc, -1, v3
    s_cbranch_vccnz L_pn4
L_pgot4:
    v_dot2c_f32_bf16 v64, s58, v24
    v_dot2c_f32_bf16 v65, s59, v24
    v_dot2c_f32_bf16 v66, s58, v25
    v_dot2c_f32_bf16 v67, s59, v25
    v_dot2c_f32_bf16 v68, s58, v26
    v_dot2c_f32_bf16 v69, s59, v26
    v_dot2c_f32_bf16 v70, s58, v27
    v_dot2c_f32_bf16 v71, s59, v27
    s_bitset0_b32 s63, s16
    s_cmp_eq_u32 s63, 0
    s_cbranch_scc1 L_pgd
L_pn4:
    s_cmp_eq_u32 s62, 5
    s_cbranch_scc1 L_prb
    v_max3_u32 v3, v28, v29, v30
    v_max_u32 v3, v3, v31
    v_cmp_eq_u32 vcc, -1, v3
    s_cbranch_vccnz L_pn5
L_pgot5:
    v_dot2c_f32_bf16 v64, s58, v28
    v_dot2c_f32_bf16 v65, s59, v28
    v_dot2c_f32_bf16 v66, s58, v29
    v_dot2c_f32_bf16 v67, s59, v29
    v_dot2c_f32_bf16 v68, s58, v30
    v_dot2c_f32_bf16 v69, s59, v30
    v_dot2c_f32_bf16 v70, s58, v31
    v_dot2c_f32_bf16 v71, s59, v31
    s_bitset0_b32 s63, s17
    s_cmp_eq_u32 s63, 0
    s_cbranch_scc1 L_pgd
L_pn5:
    s_cmp_eq_u32 s62, 6
    s_cbranch_scc1 L_prb
    v_max3_u32 v3, v32, v33, v34
    v_max_u32 v3, v3, v35
    v_cmp_eq_u32 vcc, -1, v3
    s_cbranch_vccnz L_pn6
L_pgot6:
    v_dot2c_f32_bf16 v64, s58, v32
    v_dot2c_f32_bf16 v65, s59, v32
    v_dot2c_f32_bf16 v66, s58, v33
    v_dot2c_f32_bf16 v67, s59, v33
    v_dot2c_f32_bf16 v68, s58, v34
    v_dot2c_f32_bf16 v69, s59, v34
    v_dot2c_f32_bf16 v70, s58, v35
    v_dot2c_f32_bf16 v71, s59, v35
    s_bitset0_b32 s63, s18
    s_cmp_eq_u32 s63, 0
    s_cbranch_scc1 L_pgd
L_pn6:
    s_cmp_eq_u32 s62, 7
    s_cbranch_scc1 L_prb
    v_max3_u32 v3, v36, v37, v38
    v_max_u32 v3, v3, v39
    v_cmp_eq_u32 vcc, -1, v3
    s_cbranch_vccnz L_pn7
L_pgot7:
    v_dot2c_f32_bf16 v64, s58, v36
    v_dot2c_f32_bf16 v65, s59, v36
    v_dot2c_f32_bf16 v66, s58, v37
    v_dot2c_f32_bf16 v67, s59, v37
    v_dot2c_f32_bf16 v68, s58, v38
    v_dot2c_f32_bf16 v69, s59, v38
    v_dot2c_f32_bf16 v70, s58, v39
    v_dot2c_f32_bf16 v71, s59, v39
    s_bitset0_b32 s63, s19
    s_cmp_eq_u32 s63, 0
    s_cbranch_scc1 L_pgd
L_pn7:
    s_branch L_prb
L_pi1:
L_poll_124:
    buffer_load_dwordx4 v[8:11], v5, s[40:43], s4 offen sc1
    s_sub_u32 s60, s60, 1
    s_cbranch_scc1 L_poll_124t
    s_waitcnt vmcnt(0)
    v_max3_u32 v3, v8, v9, v10
    v_max_u32 v3, v3, v11
    v_cmp_eq_u32 vcc, -1, v3
    s_cbranch_vccnz L_poll_124
L_poll_124e:
    v_dot2c_f32_bf16 v64, s58, v8
    v_dot2c_f32_bf16 v65, s59, v8
    v_dot2c_f32_bf16 v66, s58, v9
    v_dot2c_f32_bf16 v67, s59, v9
    v_dot2c_f32_bf16 v68, s58, v10
    v_dot2c_f32_bf16 v69, s59, v10
    v_dot2c_f32_bf16 v70, s58, v11
    v_dot2c_f32_bf16 v71, s59, v11
L_pgd:
    v_pk_fma_f32 v[64:65], v[64:65], v[48:49], v[40:41]
    v_pk_fma_f32 v[66:67], v[66:67], v[50:51], v[42:43]
    v_pk_fma_f32 v[68:69], v[68:69], v[52:53], v[44:45]
    v_pk_fma_f32 v[70:71], v[70:71], v[54:55], v[46:47]
    v_pk_mul_f32 v[56:57], v[64:65], v[56:57]
    v_pk_mul_f32 v[58:59], v[66:67], v[58:59]
    v_pk_mul_f32 v[60:61], v[68:69], v[60:61]
    v_pk_mul_f32 v[62:63], v[70:71], v[62:63]
    v_cvt_pk_bf16_f32 v8, v56, v57
    v_cvt_pk_bf16_f32 v9, v58, v59
    v_cvt_pk_bf16_f32 v10, v60, v61
    v_cvt_pk_bf16_f32 v11, v62, v63
    ds_write_b128 v4, v[8:11]
    v_pk_add_f32 v[40:41], v[64:65], v[66:67]
    v_pk_add_f32 v[42:43], v[68:69], v[70:71]
    v_pk_mul_f32 v[44:45], v[64:65], v[64:65]
    v_pk_mul_f32 v[46:47], v[66:67], v[66:67]
    v_pk_add_f32 v[40:41], v[40:41], v[42:43]
    v_pk_fma_f32 v[44:45], v[68:69], v[68:69], v[44:45]
    v_pk_fma_f32 v[46:47], v[70:71], v[70:71], v[46:47]
    v_add_f32 v40, v40, v41
    v_pk_add_f32 v[44:45], v[44:45], v[46:47]
    v_add_f32 v41, v44, v45
    ds_write_b64 v7, v[40:41]
    s_waitcnt lgkmcnt(0)
    s_barrier
    v_mov_b32 v16, 0
    v_mov_b32 v17, 0
    v_mov_b32 v18, 0
    v_mov_b32 v19, 0
    v_mov_b32 v20, 0
    v_mov_b32 v21, 0
    v_mov_b32 v22, 0
    v_mov_b32 v23, 0
    v_mov_b32 v24, 0
    v_mov_b32 v25, 0
    v_mov_b32 v26, 0
    v_mov_b32 v27, 0
    v_mov_b32 v28, 0
    v_mov_b32 v29, 0
    v_mov_b32 v30, 0
    v_mov_b32 v31, 0
    v_mov_b32 v32, 0
    v_mov_b32 v33, 0
    v_mov_b32 v34, 0
    v_mov_b32 v35, 0
    ds_write_b128 v6, v[64:67]
    ds_write_b128 v6, v[68:71] offset:16
    s_waitcnt lgkmcnt(0)
    s_cmp_lg_u32 s3, 7
    s_cbranch_scc1 L_ffn2
    s_cmp_lt_u32 s35, 20
    s_cbranch_scc1 L_fin
    s_endpgm
L_ffn1:
    s_barrier
L_ffn1b:
    ds_read_b128 v[8:11], v79
    ds_read_b64 v[30:31], v81 offset:0
    ds_read_b64 v[32:33], v81 offset:512
    ds_read_b64 v[34:35], v81 offset:1024
    ds_read_b64 v[36:37], v81 offset:1536
    ds_read_b64 v[38:39], v81 offset:2048
    ds_read_b128 v[12:15], v79 offset:256
    ds_read_b128 v[16:19], v79 offset:512
    ds_read_b128 v[20:23], v79 offset:768
    ds_read_b128 v[24:27], v79 offset:1024
    s_waitcnt lgkmcnt(9)
    v_smfmac_f32_16x16x64_bf16 v[52:55], v[8:11], v[88:95], v87
    v_smfmac_f32_16x16x64_bf16 v[56:59], v[8:11], v[96:103], v87
    s_waitcnt lgkmcnt(3)
    v_smfmac_f32_16x16x64_bf16 v[52:55], v[12:15], v[104:111], v87
    v_pk_add_f32 v[30:31], v[30:31], v[32:33]
    v_pk_add_f32 v[34:35], v[34:35], v[36:37]
    v_smfmac_f32_16x16x64_bf16 v[56:59], v[12:15], v[112:119], v87
    v_pk_add_f32 v[30:31], v[30:31], v[38:39]
    v_pk_add_f32 v[30:31], v[30:31], v[34:35]
    s_nop 0
    s_waitcnt lgkmcnt(2)
    v_smfmac_f32_16x16x64_bf16 v[52:55], v[16:19], v[120:127], v87
    v_add_f32_dpp v30, v30, v30 quad_perm:[1,0,3,2] row_mask:0xf bank_mask:0xf
    v_add_f32_dpp v31, v31, v31 quad_perm:[1,0,3,2] row_mask:0xf bank_mask:0xf
    v_smfmac_f32_16x16x64_bf16 v[56:59], v[16:19], v[128:135], v87
    v_add_f32_dpp v30, v30, v30 quad_perm:[2,3,0,1] row_mask:0xf bank_mask:0xf
    v_add_f32_dpp v31, v31, v31 quad_perm:[2,3,0,1] row_mask:0xf bank_mask:0xf
    s_waitcnt lgkmcnt(1)
    v_smfmac_f32_16x16x64_bf16 v[52:55], v[20:23], v[136:143], v87
    v_add_f32_dpp v30, v30, v30 row_ror:4 row_mask:0xf bank_mask:0xf
    v_add_f32_dpp v31, v31, v31 row_ror:4 row_mask:0xf bank_mask:0xf
    v_smfmac_f32_16x16x64_bf16 v[56:59], v[20:23], v[144:151], v87
    v_add_f32_dpp v30, v30, v30 row_ror:8 row_mask:0xf bank_mask:0xf
    v_add_f32_dpp v31, v31, v31 row_ror:8 row_mask:0xf bank_mask:0xf
    s_waitcnt lgkmcnt(0)
    v_smfmac_f32_16x16x64_bf16 v[52:55], v[24:27], v[152:159], v87
    v_mul_f32 v48, s62, v30
    v_mul_f32 v49, s62, v31
    v_smfmac_f32_16x16x64_bf16 v[56:59], v[24:27], v[160:167], v87
    v_mul_f32 v7, v84, v48
    v_fma_f32 v49, -v48, v48, -v49
    v_max_f32 v49, 0, v49
    v_add_f32 v49, 0x3727c5ac, v49
    v_rsq_f32 v49, v49
    v_add_f32 v4, v52, v53
    v_add_f32 v4, v4, v7
    s_nop 0
    v_add_f32 v5, v58, v59
    v_add_f32 v4, v4, v5
    v_fma_f32 v4, v4, v49, v85
    v_mul_f32 v5, v4, v4
    v_fma_f32 v5, v5, s63, v86
    v_mul_f32 v5, v5, v4
    v_exp_f32 v5, v5
    s_nop 0
    v_add_f32 v5, 1.0, v5
    v_rcp_f32 v5, v5
    s_nop 0
    v_mul_f32 v4, v4, v5
    v_cvt_pk_bf16_f32 v4, v4, v4
    ds_write_b16 v80, v4
    s_waitcnt lgkmcnt(0)
    s_barrier
    s_endpgm
L_h_t1:
    s_sub_u32 s63, s56, 154
    s_cmp_lt_u32 s63, 16
    s_cbranch_scc0 L_h_noclr
    s_lshl2_add_u32 s62, s63, s3
    s_mul_i32 s62, s62, 4608
    v_mov_b32 v4, -1
    v_mov_b32 v5, -1
    v_mov_b32 v6, -1
    v_mov_b32 v7, -1
    v_lshlrev_b32 v8, 4, v0
    buffer_store_dwordx4 v[4:7], v8, s[40:43], s62 offen offset:0 sc1
    buffer_store_dwordx4 v[4:7], v8, s[40:43], s62 offen offset:1024 sc1
    buffer_store_dwordx4 v[4:7], v8, s[40:43], s62 offen offset:2048 sc1
    buffer_store_dwordx4 v[4:7], v8, s[40:43], s62 offen offset:3072 sc1
    s_add_u32 s62, s62, 4096
    s_bfm_b64 exec, 32, 0
    buffer_store_dwordx4 v[4:7], v8, s[40:43], s62 offen offset:0 sc1
    s_mov_b64 exec, 1
    v_mov_b32 v9, 162100
    v_mov_b32 v10, 1
    s_and_b32 s62, s63, 1
    s_mul_i32 s62, s62, 126
    s_lshl1_add_u32 s63, s63, s62
    s_waitcnt vmcnt(0)
    ds_add_rtn_u32 v10, v9, v10
    s_waitcnt lgkmcnt(0)
    v_readfirstlane_b32 s62, v10
    s_nop 0
    s_cmp_lg_u32 s62, 3
    s_cbranch_scc1 L_h_clrd
    buffer_store_dword v4, v36, s[44:47], s63 offen sc1
L_h_clrd:
    s_mov_b64 exec, -1
L_h_noclr:
    v_lshrrev_b32 v1, 3, v0
    v_mul_u32_u24 v1, 1280, v1
    v_and_b32 v2, 7, v0
    v_lshl_add_u32 v1, v2, 4, v1
    s_lshl2_add_u32 s63, s34, s3
    s_mul_i32 s63, s63, 163840
    s_lshl_b32 s62, s35, 7
    s_add_u32 s63, s63, s62
    s_sub_u32 s63, s63, 2816
    s_lshl_b32 s62, s3, 14
    s_add_u32 s62, s62, 81920
    s_mov_b32 m0, s62
    s_mov_b32 s48, s12
    s_mov_b32 s49, s13
    s_mov_b32 s50, 5242880
    s_mov_b32 s51, 0x20000
    s_add_u32 s100, s39, 1
    s_mov_b32 s62, 8
L_dma_5:
    buffer_load_dwordx4 v1, s[48:51], s63 offen nt lds
    s_add_u32 m0, m0, 1024
    s_add_u32 s63, s63, 10240
    s_cmp_eq_u32 s100, 0
    s_cbranch_scc1 L_dma_5n0
    s_waitcnt vmcnt(7)
    s_cmp_eq_u32 s100, 2
    s_cbranch_scc1 L_dma_5n0
    s_waitcnt vmcnt(3)
L_dma_5n0:
    buffer_load_dwordx4 v1, s[48:51], s63 offen nt lds
    s_add_u32 m0, m0, 1024
    s_add_u32 s63, s63, 10240
    s_cmp_eq_u32 s100, 0
    s_cbranch_scc1 L_dma_5n1
    s_waitcnt vmcnt(7)
    s_cmp_eq_u32 s100, 2
    s_cbranch_scc1 L_dma_5n1
    s_waitcnt vmcnt(3)
L_dma_5n1:
    s_sub_u32 s62, s62, 1
    s_cmp_lg_u32 s62, 0
    s_cbranch_scc1 L_dma_5
    s_cmp_eq_u32 s39, 1
    s_cbranch_scc1 L_h_role
    s_waitcnt vmcnt(0)
    v_mov_b32 v4, 162060
    v_mov_b32 v5, 1
    s_mov_b64 exec, 1
    ds_add_u32 v4, v5
    s_mov_b64 exec, -1
    s_cmp_eq_u32 s3, 0
    s_cbranch_scc1 L_service
    s_endpgm
L_h_role:
    v_mov_b32 v72, 0
    v_mov_b32 v73, 0
    v_mov_b32 v74, 0
    v_mov_b32 v75, 0
    v_mov_b32 v76, 0
    v_lshrrev_b32 v3, 4, v0
    v_and_b32 v2, 3, v0
    v_bfe_u32 v1, v0, 2, 2
    v_mul_u32_u24 v160, 1280, v3
    v_and_b32 v4, 15, v0
    v_lshl_add_u32 v163, v4, 2, v160
    v_lshl_add_u32 v160, v4, 3, v160
    s_mul_i32 s57, s35, 5120
    s_mul_i32 s62, s3, 320
    s_add_u32 s57, s57, s62
    s_add_u32 s57, s57, 327680
    v_add_u32 v8, 0, v0
    v_mul_u32_u24 v10, 0xccd, v8
    v_lshrrev_b32 v10, 16, v10
    v_mul_u32_u24 v9, 20, v10
    v_sub_u32 v8, v8, v9
    v_mul_u32_u24 v10, 1280, v10
    v_lshl_add_u32 v10, v8, 4, v10
    v_add_u32 v8, 64, v0
    v_mul_u32_u24 v11, 0xccd, v8
    v_lshrrev_b32 v11, 16, v11
    v_mul_u32_u24 v9, 20, v11
    v_sub_u32 v8, v8, v9
    v_mul_u32_u24 v11, 1280, v11
    v_lshl_add_u32 v11, v8, 4, v11
    v_add_u32 v8, 128, v0
    v_mul_u32_u24 v12, 0xccd, v8
    v_lshrrev_b32 v12, 16, v12
    v_mul_u32_u24 v9, 20, v12
    v_sub_u32 v8, v8, v9
    v_mul_u32_u24 v12, 1280, v12
    v_lshl_add_u32 v12, v8, 4, v12
    v_add_u32 v8, 192, v0
    v_mul_u32_u24 v13, 0xccd, v8
    v_lshrrev_b32 v13, 16, v13
    v_mul_u32_u24 v9, 20, v13
    v_sub_u32 v8, v8, v9
    v_mul_u32_u24 v13, 1280, v13
    v_lshl_add_u32 v13, v8, 4, v13
    v_add_u32 v8, 256, v0
    v_mul_u32_u24 v14, 0xccd, v8
    v_lshrrev_b32 v14, 16, v14
    v_mul_u32_u24 v9, 20, v14
    v_sub_u32 v8, v8, v9
    v_mul_u32_u24 v14, 1280, v14
    v_lshl_add_u32 v14, v8, 4, v14
    s_mov_b32 s48, s20
    s_mov_b32 s49, s21
    s_mov_b32 s50, 2211840
    s_mov_b32 s51, 0x20000
    s_mul_i32 s63, s35, 81920
    s_mul_i32 s62, s3, 320
    s_add_u32 s63, s63, s62
    s_mov_b32 m0, s101
    s_mov_b32 s62, 4
L_w2dma:
    buffer_load_dwordx4 v10, s[48:51], s63 offen nt lds
    s_add_u32 m0, m0, 1024
    s_waitcnt vmcnt(7)
    s_cmp_ge_u32 s35, 22
    s_cbranch_scc1 L_w2n0
    s_waitcnt vmcnt(7)
L_w2n0:
    buffer_load_dwordx4 v11, s[48:51], s63 offen nt lds
    s_add_u32 m0, m0, 1024
    s_waitcnt vmcnt(7)
    s_cmp_ge_u32 s35, 22
    s_cbranch_scc1 L_w2n1
    s_waitcnt vmcnt(7)
L_w2n1:
    buffer_load_dwordx4 v12, s[48:51], s63 offen nt lds
    s_add_u32 m0, m0, 1024
    s_waitcnt vmcnt(7)
    s_cmp_ge_u32 s35, 22
    s_cbranch_scc1 L_w2n2
    s_waitcnt vmcnt(7)
L_w2n2:
    buffer_load_dwordx4 v13, s[48:51], s63 offen nt lds
    s_add_u32 m0, m0, 1024
    s_waitcnt vmcnt(7)
    s_cmp_ge_u32 s35, 22
    s_cbranch_scc1 L_w2n3
    s_waitcnt vmcnt(7)
L_w2n3:
    buffer_load_dwordx4 v14, s[48:51], s63 offen nt lds
    s_add_u32 m0, m0, 1024
    s_waitcnt vmcnt(7)
    s_cmp_ge_u32 s35, 22
    s_cbranch_scc1 L_w2n4
    s_waitcnt vmcnt(7)
L_w2n4:
    s_add_u32 s63, s63, 20480
    s_sub_u32 s62, s62, 1
    s_cmp_lg_u32 s62, 0
    s_cbranch_scc1 L_w2dma
    v_lshrrev_b32 v8, 5, v0
    v_lshlrev_b32 v8, 2, v8
    v_bfe_u32 v9, v0, 4, 1
    v_add_u32 v8, v8, v9
    v_mul_u32_u24 v8, 1280, v8
    v_add_u32 v8, s101, v8
    v_and_b32 v10, 15, v0
    v_lshl_add_u32 v9, v10, 2, v8
    v_lshl_add_u32 v8, v10, 3, v8
    s_mov_b32 s62, 0x05040100
    s_mov_b32 s63, 0x07060302
    s_waitcnt vmcnt(0)
    v_mov_b32 v4, 162060
    v_mov_b32 v5, 1
    s_mov_b64 exec, 1
    ds_add_u32 v4, v5
    s_mov_b64 exec, -1
    ds_read_b64 v[16:17], v8 offset:0
    ds_read_b64 v[18:19], v8 offset:320
    ds_read_b64 v[20:21], v8 offset:2560
    ds_read_b64 v[22:23], v8 offset:2880
    ds_read_b64 v[24:25], v8 offset:640
    ds_read_b64 v[26:27], v8 offset:960
    ds_read_b64 v[28:29], v8 offset:3200
    ds_read_b64 v[30:31], v8 offset:3520
    ds_read_b64 v[32:33], v8 offset:10240
    ds_read_b64 v[34:35], v8 offset:10560
    ds_read_b64 v[36:37], v8 offset:12800
    ds_read_b64 v[38:39], v8 offset:13120
    ds_read_b64 v[40:41], v8 offset:10880
    ds_read_b64 v[42:43], v8 offset:11200
    ds_read_b64 v[44:45], v8 offset:13440
    ds_read_b64 v[46:47], v8 offset:13760
    s_waitcnt lgkmcnt(0)
    v_perm_b32 v80, v18, v16, s62
    v_perm_b32 v88, v18, v16, s63
    v_perm_b32 v96, v19, v17, s62
    v_perm_b32 v104, v19, v17, s63
    v_perm_b32 v81, v22, v20, s62
    v_perm_b32 v89, v22, v20, s63
    v_perm_b32 v97, v23, v21, s62
    v_perm_b32 v105, v23, v21, s63
    v_perm_b32 v82, v26, v24, s62
    v_perm_b32 v90, v26, v24, s63
    v_perm_b32 v98, v27, v25, s62
    v_perm_b32 v106, v27, v25, s63
    v_perm_b32 v83, v30, v28, s62
    v_perm_b32 v91, v30, v28, s63
    v_perm_b32 v99, v31, v29, s62
    v_perm_b32 v107, v31, v29, s63
    v_perm_b32 v84, v34, v32, s62
    v_perm_b32 v92, v34, v32, s63
    v_perm_b32 v100, v35, v33, s62
    v_perm_b32 v108, v35, v33, s63
    v_perm_b32 v85, v38, v36, s62
    v_perm_b32 v93, v38, v36, s63
    v_perm_b32 v101, v39, v37, s62
    v_perm_b32 v109, v39, v37, s63
    v_perm_b32 v86, v42, v40, s62
    v_perm_b32 v94, v42, v40, s63
    v_perm_b32 v102, v43, v41, s62
    v_perm_b32 v110, v43, v41, s63
    v_perm_b32 v87, v46, v44, s62
    v_perm_b32 v95, v46, v44, s63
    v_perm_b32 v103, v47, v45, s62
    v_perm_b32 v111, v47, v45, s63
    ds_read_b64 v[16:17], v8 offset:128
    ds_read_b64 v[18:19], v8 offset:448
    ds_read_b64 v[20:21], v8 offset:2688
    ds_read_b64 v[22:23], v8 offset:3008
    ds_read_b64 v[24:25], v8 offset:768
    ds_read_b64 v[26:27], v8 offset:1088
    ds_read_b64 v[28:29], v8 offset:3328
    ds_read_b64 v[30:31], v8 offset:3648
    ds_read_b64 v[32:33], v8 offset:10368
    ds_read_b64 v[34:35], v8 offset:10688
    ds_read_b64 v[36:37], v8 offset:12928
    ds_read_b64 v[38:39], v8 offset:13248
    ds_read_b64 v[40:41], v8 offset:11008
    ds_read_b64 v[42:43], v8 offset:11328
    ds_read_b64 v[44:45], v8 offset:13568
    ds_read_b64 v[46:47], v8 offset:13888
    s_waitcnt lgkmcnt(0)
    v_perm_b32 v112, v18, v16, s62
    v_perm_b32 v120, v18, v16, s63
    v_perm_b32 v128, v19, v17, s62
    v_perm_b32 v136, v19, v17, s63
    v_perm_b32 v113, v22, v20, s62
    v_perm_b32 v121, v22, v20, s63
    v_perm_b32 v129, v23, v21, s62
    v_perm_b32 v137, v23, v21, s63
    v_perm_b32 v114, v26, v24, s62
    v_perm_b32 v122, v26, v24, s63
    v_perm_b32 v130, v27, v25, s62
    v_perm_b32 v138, v27, v25, s63
    v_perm_b32 v115, v30, v28, s62
    v_perm_b32 v123, v30, v28, s63
    v_perm_b32 v131, v31, v29, s62
    v_perm_b32 v139, v31, v29, s63
    v_perm_b32 v116, v34, v32, s62
    v_perm_b32 v124, v34, v32, s63
    v_perm_b32 v132, v35, v33, s62
    v_perm_b32 v140, v35, v33, s63
    v_perm_b32 v117, v38, v36, s62
    v_perm_b32 v125, v38, v36, s63
    v_perm_b32 v133, v39, v37, s62
    v_perm_b32 v141, v39, v37, s63
    v_perm_b32 v118, v42, v40, s62
    v_perm_b32 v126, v42, v40, s63
    v_perm_b32 v134, v43, v41, s62
    v_perm_b32 v142, v43, v41, s63
    v_perm_b32 v119, v46, v44, s62
    v_perm_b32 v127, v46, v44, s63
    v_perm_b32 v135, v47, v45, s62
    v_perm_b32 v143, v47, v45, s63
    ds_read_b32 v16, v9 offset:256
    ds_read_b32 v18, v9 offset:576
    ds_read_b32 v20, v9 offset:2816
    ds_read_b32 v22, v9 offset:3136
    ds_read_b32 v24, v9 offset:896
    ds_read_b32 v26, v9 offset:1216
    ds_read_b32 v28, v9 offset:3456
    ds_read_b32 v30, v9 offset:3776
    ds_read_b32 v32, v9 offset:10496
    ds_read_b32 v34, v9 offset:10816
    ds_read_b32 v36, v9 offset:13056
    ds_read_b32 v38, v9 offset:13376
    ds_read_b32 v40, v9 offset:11136
    ds_read_b32 v42, v9 offset:11456
    ds_read_b32 v44, v9 offset:13696
    ds_read_b32 v46, v9 offset:14016
    s_waitcnt lgkmcnt(0)
    v_perm_b32 v144, v18, v16, s62
    v_perm_b32 v152, v18, v16, s63
    v_perm_b32 v145, v22, v20, s62
    v_perm_b32 v153, v22, v20, s63
    v_perm_b32 v146, v26, v24, s62
    v_perm_b32 v154, v26, v24, s63
    v_perm_b32 v147, v30, v28, s62
    v_perm_b32 v155, v30, v28, s63
    v_perm_b32 v148, v34, v32, s62
    v_perm_b32 v156, v34, v32, s63
    v_perm_b32 v149, v38, v36, s62
    v_perm_b32 v157, v38, v36, s63
    v_perm_b32 v150, v42, v40, s62
    v_perm_b32 v158, v42, v40, s63
    v_perm_b32 v151, v46, v44, s62
    v_perm_b32 v159, v46, v44, s63
    s_mov_b32 s48, s16
    s_mov_b32 s49, s17
    s_mov_b32 s50, 2211840
    s_mov_b32 s51, 0x20000
    s_lshl_b32 s98, s35, 7
    s_mov_b32 s99, 3456
    v_lshrrev_b32 v9, 3, v0
    v_mul_lo_u32 v10, v9, s99
    v_and_b32 v9, 2, v9
    v_xor_b32 v9, v9, v0
    v_and_b32 v9, 7, v9
    v_lshl_add_u32 v10, v9, 4, v10
    v_add_u32 v10, s98, v10
    v_xor_b32 v11, 64, v10
    s_mul_i32 s63, s3, 552960
    s_mov_b32 m0, s101
    s_waitcnt lgkmcnt(0)
    s_cmp_ge_u32 s35, 22
    s_cselect_b32 s100, 2, 1
    s_mov_b32 s62, 10
L_dma_6:
    buffer_load_dwordx4 v10, s[48:51], s63 offen nt lds
    s_add_u32 m0, m0, 1024
    s_add_u32 s63, s63, 27648
    s_cmp_eq_u32 s100, 0
    s_cbranch_scc1 L_dma_6n0
    s_waitcnt vmcnt(7)
    s_cmp_eq_u32 s100, 2
    s_cbranch_scc1 L_dma_6n0
    s_waitcnt vmcnt(7)
L_dma_6n0:
    buffer_load_dwordx4 v11, s[48:51], s63 offen nt lds
    s_add_u32 m0, m0, 1024
    s_add_u32 s63, s63, 27648
    s_cmp_eq_u32 s100, 0
    s_cbranch_scc1 L_dma_6n1
    s_waitcnt vmcnt(7)
    s_cmp_eq_u32 s100, 2
    s_cbranch_scc1 L_dma_6n1
    s_waitcnt vmcnt(7)
L_dma_6n1:
    s_sub_u32 s62, s62, 1
    s_cmp_lg_u32 s62, 0
    s_cbranch_scc1 L_dma_6
    v_mov_b32 v8, 162068
L_lw_7:
    ds_read_b32 v9, v8
    s_waitcnt lgkmcnt(0)
    v_cmp_gt_u32 vcc, 1, v9
    s_cbranch_vccz L_lw_7e
    s_sleep 8
    s_sub_u32 s60, s60, 1
    s_cbranch_scc0 L_lw_7
    s_mov_b32 s60, 0
L_lw_7e:
    s_cmp_lg_u32 s3, 3
    s_cbranch_scc1 L_h_nomo
    v_and_b32 v4, 15, v0
    v_lshlrev_b32 v4, 4, v4
    v_mul_u32_u24 v5, 1280, v3
    v_add_u32 v5, v5, v4
    v_mul_u32_u24 v6, 1296, v3
    v_add_u32 v6, v6, v4
    v_add_u32 v6, 147456, v6
    s_mov_b32 s62, 30720
    s_mov_b32 s63, 25600
    s_branch L_poll_8
L_poll_8s:
    s_sleep 8
L_poll_8:
    buffer_load_dwordx4 v[40:43], v5, s[40:43], s62 offen offset:0 sc1
    buffer_load_dwordx4 v[44:47], v5, s[40:43], s62 offen offset:256 sc1
    buffer_load_dwordx4 v[48:51], v5, s[40:43], s62 offen offset:512 sc1
    buffer_load_dwordx4 v[52:55], v5, s[40:43], s62 offen offset:768 sc1
    buffer_load_dwordx4 v[56:59], v5, s[40:43], s62 offen offset:1024 sc1
    buffer_load_dwordx4 v[60:63], v5, s[40:43], s63 offen offset:0 sc1
    buffer_load_dwordx4 v[64:67], v5, s[40:43], s63 offen offset:256 sc1
    buffer_load_dwordx4 v[68:71], v5, s[40:43], s63 offen offset:512 sc1
    buffer_load_dwordx4 v[72:75], v5, s[40:43], s63 offen offset:768 sc1
    buffer_load_dwordx4 v[76:79], v5, s[40:43], s63 offen offset:1024 sc1
    s_sub_u32 s60, s60, 1
    s_cbranch_scc1 L_poll_8t
    s_waitcnt vmcnt(0)
    v_max3_u32 v7, v40, v41, v42
    v_max3_u32 v7, v7, v43, v44
    v_max3_u32 v7, v7, v45, v46
    v_max3_u32 v7, v7, v47, v48
    v_max3_u32 v7, v7, v49, v50
    v_max3_u32 v7, v7, v51, v52
    v_max3_u32 v7, v7, v53, v54
    v_max3_u32 v7, v7, v55, v56
    v_max3_u32 v7, v7, v57, v58
    v_max3_u32 v7, v7, v59, v60
    v_max3_u32 v7, v7, v61, v62
    v_max3_u32 v7, v7, v63, v64
    v_max3_u32 v7, v7, v65, v66
    v_max3_u32 v7, v7, v67, v68
    v_max3_u32 v7, v7, v69, v70
    v_max3_u32 v7, v7, v71, v72
    v_max3_u32 v7, v7, v73, v74
    v_max3_u32 v7, v7, v75, v76
    v_max3_u32 v7, v7, v77, v78
    v_max_u32 v7, v7, v79
    v_cmp_eq_u32 vcc, -1, v7
    s_cbranch_vccnz L_poll_8s
L_poll_8e:
    ds_write_b128 v6, v[40:43] offset:0
    ds_write_b128 v6, v[44:47] offset:256
    ds_write_b128 v6, v[48:51] offset:512
    ds_write_b128 v6, v[52:55] offset:768
    ds_write_b128 v6, v[56:59] offset:1024
    ds_write_b128 v6, v[60:63] offset:5184
    ds_write_b128 v6, v[64:67] offset:5440
    ds_write_b128 v6, v[68:71] offset:5696
    ds_write_b128 v6, v[72:75] offset:5952
    ds_write_b128 v6, v[76:79] offset:6208
L_h_nomo:
    v_mul_u32_u24 v4, 144, v1
    v_lshl_add_u32 v4, v3, 5, v4
    v_bfe_u32 v5, v0, 1, 1
    v_lshl_add_u32 v4, v5, 4, v4
    v_add_u32 v4, 90688, v4
    v_mov_b32 v5, 162112
    v_and_b32 v6, 1, v0
    v_cmp_eq_u32 vcc, 0, v6
    s_nop 1
    v_cndmask_b32 v161, v5, v4, vcc
    v_cndmask_b32 v162, v4, v5, vcc
    v_bfe_u32 v164, v0, 1, 1
    v_mul_u32_u24 v164, 0xaaaa, v164
    v_add_u32 v164, 0x4444, v164
    s_mov_b32 s100, s3
    s_lshl_b32 s63, s100, 8
    v_and_b32 v8, 15, v0
    v_lshl_add_u32 v8, v8, 4, s63
    v_lshrrev_b32 v9, 4, v0
    v_mul_u32_u24 v5, 1280, v9
    v_add_u32 v5, v5, v8
    v_mul_u32_u24 v4, 1296, v9
    v_add_u32 v4, v4, v8
    v_add_u32 v4, 82944, v4
    v_lshlrev_b32 v6, 1, v5
    v_add_u32 v6, 99328, v6
    s_lshl_b32 s62, s100, 9
    s_add_u32 s62, s62, 88128
    v_lshl_add_u32 v7, v0, 3, s62
    s_mov_b32 s48, s4
    s_mov_b32 s49, s5
    s_mov_b32 s50, 5120
    s_mov_b32 s51, 0x20000
    buffer_load_dwordx4 v[8:11], v5, s[48:51], 0 offen
    s_mov_b32 s62, 20480
    s_mov_b32 s63, 30720
    s_branch L_poll_9
L_poll_9s:
    s_sleep 8
L_poll_9:
    buffer_load_dwordx4 v[12:15], v5, s[40:43], s62 offen sc1
    buffer_load_dwordx4 v[16:19], v5, s[40:43], s63 offen sc1
    s_sub_u32 s60, s60, 1
    s_cbranch_scc1 L_poll_9t
    s_waitcnt vmcnt(0)
    v_max3_u32 v38, v12, v13, v14
    v_max3_u32 v38, v38, v15, v16
    v_max3_u32 v38, v38, v17, v18
    v_max_u32 v38, v38, v19
    v_cmp_eq_u32 vcc, -1, v38
    s_cbranch_vccnz L_poll_9s
L_poll_9e:
    v_lshlrev_b32 v40, 16, v8
    v_and_b32 v41, 0xffff0000, v8
    v_lshlrev_b32 v42, 16, v9
    v_and_b32 v43, 0xffff0000, v9
    v_lshlrev_b32 v44, 16, v10
    v_and_b32 v45, 0xffff0000, v10
    v_lshlrev_b32 v46, 16, v11
    v_and_b32 v47, 0xffff0000, v11
    v_lshlrev_b32 v48, 16, v12
    v_and_b32 v49, 0xffff0000, v12
    v_lshlrev_b32 v50, 16, v13
    v_and_b32 v51, 0xffff0000, v13
    v_lshlrev_b32 v52, 16, v14
    v_and_b32 v53, 0xffff0000, v14
    v_lshlrev_b32 v54, 16, v15
    v_and_b32 v55, 0xffff0000, v15
    v_lshlrev_b32 v56, 16, v16
    v_and_b32 v57, 0xffff0000, v16
    v_lshlrev_b32 v58, 16, v17
    v_and_b32 v59, 0xffff0000, v17
    v_lshlrev_b32 v60, 16, v18
    v_and_b32 v61, 0xffff0000, v18
    v_lshlrev_b32 v62, 16, v19
    v_and_b32 v63, 0xffff0000, v19
    v_mov_b32 v64, 0
    v_mov_b32 v65, 0
    v_mov_b32 v66, 0
    v_mov_b32 v67, 0
    v_mov_b32 v68, 0
    v_mov_b32 v69, 0
    v_mov_b32 v70, 0
    v_mov_b32 v71, 0
    v_bfe_u32 v5, v0, 2, 2
    v_lshlrev_b32 v5, 8, v5
    v_lshrrev_b32 v8, 4, v0
    v_lshl_add_u32 v5, v8, 6, v5
    v_and_b32 v8, 3, v0
    v_lshl_add_u32 v5, v8, 4, v5
    s_lshl_b32 s56, s100, 10
    s_waitcnt vmcnt(0) lgkmcnt(0)
    v_mov_b32 v8, 162064
    v_mov_b32 v9, 1
    s_mov_b64 exec, 1
    ds_add_u32 v8, v9
    s_mov_b64 exec, -1
    s_branch L_t2gate
L_ffn2:
    s_barrier
L_ffn2b:
    ds_read_b128 v[8:11], v161
    ds_read_b128 v[12:15], v162
    s_cmp_eq_u32 s61, 1
    s_cbranch_scc0 L_f2slow
    s_waitcnt lgkmcnt(1)
    v_smfmac_f32_16x16x64_bf16 v[16:19], v[8:11], v[80:87], v164
    v_smfmac_f32_16x16x64_bf16 v[20:23], v[8:11], v[96:103], v164
    s_waitcnt lgkmcnt(0)
    v_smfmac_f32_16x16x64_bf16 v[16:19], v[12:15], v[88:95], v164
    v_smfmac_f32_16x16x64_bf16 v[20:23], v[12:15], v[104:111], v164
    v_smfmac_f32_16x16x64_bf16 v[24:27], v[8:11], v[112:119], v164
    v_smfmac_f32_16x16x64_bf16 v[28:31], v[8:11], v[128:135], v164
    v_smfmac_f32_16x16x64_bf16 v[24:27], v[12:15], v[120:127], v164
    v_smfmac_f32_16x16x64_bf16 v[28:31], v[12:15], v[136:143], v164
    v_smfmac_f32_16x16x64_bf16 v[32:35], v[8:11], v[144:151], v164
    v_smfmac_f32_16x16x64_bf16 v[32:35], v[12:15], v[152:159], v164
    s_nop 0
    v_pk_add_f32 v[16:17], v[16:17], v[18:19]
    v_cvt_pk_bf16_f32 v40, v16, v17
    v_pk_add_f32 v[20:21], v[20:21], v[22:23]
    v_cvt_pk_bf16_f32 v41, v20, v21
    buffer_store_dwordx2 v[40:41], v160, s[40:43], s57 offen
    v_pk_add_f32 v[24:25], v[24:25], v[26:27]
    v_cvt_pk_bf16_f32 v42, v24, v25
    v_pk_add_f32 v[28:29], v[28:29], v[30:31]
    v_cvt_pk_bf16_f32 v43, v28, v29
    buffer_store_dwordx2 v[42:43], v160, s[40:43], s57 offen offset:128
    v_pk_add_f32 v[32:33], v[32:33], v[34:35]
    v_cvt_pk_bf16_f32 v44, v32, v33
    buffer_store_dword v44, v163, s[40:43], s57 offen offset:256
L_f2done:
    s_barrier
    s_endpgm
L_f2slow:
    s_waitcnt lgkmcnt(1)
    v_smfmac_f32_16x16x64_bf16 v[16:19], v[8:11], v[80:87], v164
    v_smfmac_f32_16x16x64_bf16 v[20:23], v[8:11], v[96:103], v164
    s_waitcnt lgkmcnt(0)
    v_smfmac_f32_16x16x64_bf16 v[16:19], v[12:15], v[88:95], v164
    v_smfmac_f32_16x16x64_bf16 v[20:23], v[12:15], v[104:111], v164
    v_smfmac_f32_16x16x64_bf16 v[24:27], v[8:11], v[112:119], v164
    v_smfmac_f32_16x16x64_bf16 v[28:31], v[8:11], v[128:135], v164
    v_smfmac_f32_16x16x64_bf16 v[24:27], v[12:15], v[120:127], v164
    v_smfmac_f32_16x16x64_bf16 v[28:31], v[12:15], v[136:143], v164
    v_smfmac_f32_16x16x64_bf16 v[32:35], v[8:11], v[144:151], v164
    v_smfmac_f32_16x16x64_bf16 v[32:35], v[12:15], v[152:159], v164
    s_nop 0
    v_pk_add_f32 v[16:17], v[16:17], v[18:19]
    v_cvt_pk_bf16_f32 v40, v16, v17
    v_pk_add_f32 v[20:21], v[20:21], v[22:23]
    v_cvt_pk_bf16_f32 v41, v20, v21
    buffer_store_dwordx2 v[40:41], v160, s[40:43], s57 offen sc1
    v_pk_add_f32 v[24:25], v[24:25], v[26:27]
    v_cvt_pk_bf16_f32 v42, v24, v25
    v_pk_add_f32 v[28:29], v[28:29], v[30:31]
    v_cvt_pk_bf16_f32 v43, v28, v29
    buffer_store_dwordx2 v[42:43], v160, s[40:43], s57 offen offset:128 sc1
    v_pk_add_f32 v[32:33], v[32:33], v[34:35]
    v_cvt_pk_bf16_f32 v44, v32, v33
    buffer_store_dword v44, v163, s[40:43], s57 offen offset:256 sc1
    s_branch L_f2done
L_poll_3t:
    s_mov_b32 s60, 0
    s_waitcnt vmcnt(0)
    s_branch L_poll_3e
L_poll_8t:
    s_mov_b32 s60, 0
    s_waitcnt vmcnt(0)
    s_branch L_poll_8e
L_poll_9t:
    s_mov_b32 s60, 0
    s_waitcnt vmcnt(0)
    s_branch L_poll_9e
L_poll_99t:
    s_mov_b32 s60, 0
    s_waitcnt vmcnt(0)
    s_branch L_poll_99e
L_pfast:
    buffer_store_dword v12, v108, s[40:43], s101 offen
    buffer_store_dword v12, v110, s[40:43], s101 offen
    s_branch L_pdone
L_poll_101t:
    s_mov_b32 s60, 0
    s_waitcnt vmcnt(0)
    s_branch L_poll_101e
L_poll_104t:
    s_mov_b32 s60, 0
    s_waitcnt vmcnt(0)
    s_branch L_poll_104e
L_poll_106t:
    s_mov_b32 s60, 0
    s_waitcnt vmcnt(0)
    s_branch L_poll_106e
L_poll_110t:
    s_mov_b32 s60, 0
    s_waitcnt vmcnt(0)
    s_branch L_poll_110e
L_poll_112t:
    s_mov_b32 s60, 0
    s_waitcnt vmcnt(0)
    s_branch L_poll_112e
L_ycs:
    buffer_store_dwordx4 v[24:27], v22, s[40:43], 0 offen offset:0 sc1
    buffer_store_dwordx4 v[24:27], v22, s[40:43], 0 offen offset:1024 sc1
    buffer_store_dwordx4 v[24:27], v22, s[40:43], 0 offen offset:2048 sc1
    buffer_store_dwordx4 v[24:27], v22, s[40:43], 0 offen offset:3072 sc1
    buffer_store_dwordx4 v[24:27], v23, s[40:43], 0 offen offset:0 sc1
    s_branch L_ycd
L_poll_113t:
    s_mov_b32 s60, 0
    s_waitcnt vmcnt(0)
    s_branch L_poll_113e
L_poll_118t:
    s_mov_b32 s60, 0
    s_waitcnt vmcnt(0)
    s_branch L_poll_118e
L_poll_120t:
    s_mov_b32 s60, 0
    s_waitcnt vmcnt(0)
    s_branch L_poll_120e
L_ygt:
    s_waitcnt vmcnt(0)
    s_branch L_ygd
L_pto:
    s_mov_b32 s60, 0
    s_waitcnt vmcnt(0)
    s_branch L_pgot0
L_poll_124t:
    s_mov_b32 s60, 0
    s_waitcnt vmcnt(0)
    s_branch L_poll_124e
L_end:
    s_endpgm
L_codeend:
.section .rodata,"a"
.p2align 6
.amdhsa_kernel adaLN_cond__sliding_block_cached__dense_activation_gelu__decode_kernel
  .amdhsa_next_free_vgpr 168
  .amdhsa_next_free_sgpr 102
  .amdhsa_accum_offset 168
  .amdhsa_group_segment_fixed_size 0
  .amdhsa_kernarg_size 120
  .amdhsa_user_sgpr_count 2
  .amdhsa_user_sgpr_kernarg_segment_ptr 1
  .amdhsa_system_sgpr_workgroup_id_x 1
.end_amdhsa_kernel
```

```asm
; @launch grid=(256,1,1) block=(768,1,1) lds=162176
.amdgcn_target "amdgcn-amd-amdhsa--gfx950"
.text
.globl adaLN_cond__sliding_block_cached__dense_activation_gelu__decode_kernel
.p2align 8
.type adaLN_cond__sliding_block_cached__dense_activation_gelu__decode_kernel,@function
adaLN_cond__sliding_block_cached__dense_activation_gelu__decode_kernel:
    s_load_dwordx16 s[4:19], s[0:1], 0
    s_load_dwordx8 s[20:27], s[0:1], 64
    s_load_dwordx4 s[28:31], s[0:1], 96
    s_load_dwordx2 s[32:33], s[0:1], 112
    s_cmp_ge_u32 s2, 256
    s_cbranch_scc1 L_end
    v_lshrrev_b32 v1, 6, v0
    v_mul_u32_u24 v2, 36, v0
    v_readfirstlane_b32 s3, v1
    v_and_b32 v0, 63, v0
    s_and_b32 s34, s2, 7
    s_lshr_b32 s35, s2, 3
    s_cmp_lg_u32 s35, 21
    s_cbranch_scc1 L_nopf
    s_getpc_b64 s[48:49]
L_pc:
    v_min_u32 v2, L_codeend-L_pc-4, v2
    v_mov_b32 v3, s49
    v_add_co_u32 v2, vcc, s48, v2
    s_nop 1
    v_addc_co_u32 v3, vcc, 0, v3, vcc
    global_load_dword v152, v[2:3], off
L_nopf:
    s_lshr_b32 s36, s35, 3
    s_lshl2_add_u32 s36, s34, s36
    s_bfe_u32 s37, s35, 0x20001
    s_and_b32 s38, s35, 1
    s_cmp_lt_u32 s35, 27
    s_cselect_b32 s39, 1, 0
    s_cmp_eq_u32 s34, 2
    s_cselect_b32 s39, s39, 0
    s_sub_u32 s62, s34, 3
    s_and_b32 s62, s62, 7
    s_mul_i32 s56, s35, 7
    s_add_u32 s56, s56, s62
    s_cmp_eq_u32 s62, 7
    s_cselect_b32 s56, 255, s56
    s_mov_b32 s60, 1000000
    s_mov_b32 s61, 0
    v_mov_b32 v36, 0
    s_cmp_lt_u32 s3, 4
    s_cbranch_scc1 L_helpers
    s_sub_u32 s3, s3, 4
    s_cmp_ge_u32 s35, 22
    s_cselect_b32 s59, 1, 0
    s_add_u32 s62, s3, s59
    s_cmp_ge_u32 s62, 6
    s_cselect_b32 s62, s39, 0
    s_cmp_eq_u32 s62, 1
    s_cbranch_scc1 L_proxy
    s_cmp_eq_u32 s59, 1
    s_cselect_b32 s100, 0, 81920
    s_lshl_b32 s62, s3, 13
    s_add_u32 s100, s100, s62
    s_and_b32 s62, s39, s59
    s_cselect_b32 s100, -1, s100
    s_mov_b32 s101, 0
L_stream:
    s_lshl_b32 s62, s37, 5
    s_add_u32 s62, s62, s36
    s_lshl_b32 s63, s62, 21
    s_lshl_b32 s96, s38, 18
    s_add_u32 s63, s63, s96
    s_add_u32 s63, s63, 1572864
    v_lshlrev_b32 v1, 4, v0
    s_lshl_b32 s96, s3, 12
    v_add_u32 v1, s96, v1
    s_mov_b32 s97, 0
    s_mov_b32 s50, 262144
    s_mov_b32 s51, 0x20000
    s_waitcnt lgkmcnt(0)
    s_add_u32 s48, s6, s63
    s_addc_u32 s49, s7, 0
    s_cmp_lt_u32 s56, 40
    s_cbranch_scc0 L_nob0
    s_barrier
L_nob0:
    buffer_load_dwordx4 v[40:43], v1, s[48:51], s97 offen offset:0 nt
    buffer_load_dwordx4 v[44:47], v1, s[48:51], s97 offen offset:1024 nt
    s_cmp_lt_u32 s56, 40
    s_cbranch_scc1 L_stream2
    s_barrier
    s_branch L_stream2
L_helpers:
    s_cmp_lg_u32 s3, 0
    s_cbranch_scc1 L_noinit
    v_lshlrev_b32 v1, 2, v0
    v_add_u32 v1, 161920, v1
    ds_write_b32 v1, v36
L_noinit:
    s_waitcnt lgkmcnt(0)
    s_mov_b32 s40, s32
    s_mov_b32 s41, s33
    s_mov_b32 s42, 589824
    s_mov_b32 s43, 0x20000
    s_mov_b32 s44, s30
    s_mov_b32 s45, s31
    s_mov_b32 s46, 256
    s_mov_b32 s47, 0x20000
    s_lshl2_add_u32 s62, s35, s3
    s_cmp_eq_u32 s62, 87
    s_cbranch_scc1 L_touch
L_notp:
    s_mul_i32 s101, s3, 20480
    s_mov_b32 s96, s56
    s_cmp_lt_u32 s56, 40
    s_cbranch_scc0 L_nothalf
    s_cmp_lt_u32 s3, 2
    s_cbranch_scc1 L_unit
    s_add_u32 s62, s56, 20
    s_cmp_eq_u32 s3, 2
    s_cbranch_scc1 L_job
    s_barrier
    s_branch L_service
L_nothalf:
    s_cmp_lt_u32 s56, 144
    s_cbranch_scc1 L_unit
    s_sub_u32 s62, s56, 144
    s_cmp_lt_u32 s62, 10
    s_cbranch_scc0 L_nojob
    s_cmp_lt_u32 s3, 2
    s_cbranch_scc0 L_nojob
    s_mul_i32 s63, s3, 10
    s_add_u32 s62, s62, s63
L_job:
    s_cmp_lt_u32 s62, 59
    s_cbranch_scc0 L_end
    s_mov_b32 s100, s101
    s_lshl_b32 s101, s62, 9
    s_add_u32 s101, s101, 172032
    s_cmp_lt_u32 s62, 27
    s_cselect_b32 s63, 0, 27
    s_cselect_b32 s3, 7, 6
    s_cmp_lt_u32 s62, 54
    s_cselect_b32 s63, s63, 32
    s_cselect_b32 s3, s3, 5
    s_sub_u32 s35, s62, s63
    s_mov_b32 s34, 2
    s_lshr_b32 s36, s35, 3
    s_add_u32 s36, s36, 8
    s_bfe_u32 s37, s35, 0x20001
    s_and_b32 s38, s35, 1
    s_mov_b32 s59, 0
    s_branch L_stream
L_nojob:
    s_barrier
    s_cmp_ge_u32 s35, 22
    s_cbranch_scc1 L_h_t1
    s_cmp_eq_u32 s39, 1
    s_cbranch_scc1 L_h_role
    s_cmp_lt_u32 s96, 144
    s_cbranch_scc1 L_unit
    s_cmp_eq_u32 s3, 3
    s_cbranch_scc1 L_service
    s_endpgm
L_unit:
    v_lshrrev_b32 v3, 4, v0
    v_and_b32 v4, 3, v0
    v_bfe_u32 v7, v0, 2, 2
    s_mov_b32 s14, s3
    s_mov_b32 s15, 3
    s_sub_u32 s62, s96, 40
    s_cmp_lt_u32 s62, 64
    s_cbranch_scc1 L_u_q
    s_mov_b32 s100, 1
    s_sub_u32 s96, s96, 84
    s_cmp_lt_u32 s56, 40
    s_cbranch_scc0 L_u_full
    s_mov_b32 s100, 0
    s_lshr_b32 s96, s56, 1
    s_and_b32 s62, s56, 1
    s_lshl1_add_u32 s14, s62, s14
    s_mov_b32 s15, 1
L_u_full:
    s_mov_b32 s97, 0
    s_mov_b32 s99, 7680
    s_mov_b32 s48, s26
    s_mov_b32 s49, s27
    s_mov_b32 s50, 4915200
    s_mov_b32 s51, 0x20000
    s_mov_b32 s52, s24
    s_mov_b32 s53, s25
    s_mov_b32 s54, 5120
    s_mov_b32 s55, 0x20000
    v_and_b32 v6, 15, v0
    v_lshlrev_b32 v6, 4, v6
    v_mul_u32_u24 v5, 1280, v3
    v_add_u32 v5, v5, v6
    s_mul_i32 s62, s14, 320
    buffer_load_dwordx4 v[8:11], v5, s[52:55], s62 offen
    s_mov_b32 exec_lo, 0x000f000f
    s_mov_b32 exec_hi, 0x000f000f
    buffer_load_dwordx4 v[12:15], v5, s[52:55], s62 offen offset:256
    s_mov_b64 exec, -1
    s_lshl_b32 s98, s96, 7
    s_mul_i32 s13, s96, 0x199a
    s_lshr_b32 s13, s13, 16
    s_cmp_lg_u32 s13, 1
    s_cbranch_scc1 L_u_go
    s_mov_b32 s52, s4
    s_mov_b32 s53, s5
    s_mov_b32 s54, 5120
    s_mov_b32 s55, 0x20000
    v_mul_u32_u24 v5, 1280, v4
    v_lshlrev_b32 v64, 5, v7
    v_lshl_add_u32 v64, v3, 3, v64
    v_add_u32 v64, v64, v5
    v_lshrrev_b32 v6, 2, v0
    v_lshl_add_u32 v6, v6, 4, v5
    s_sub_u32 s62, s98, 1280
    buffer_load_dwordx4 v[16:19], v6, s[52:55], 0 offen offset:0
    buffer_load_dwordx4 v[20:23], v6, s[52:55], 0 offen offset:256
    buffer_load_dwordx4 v[24:27], v6, s[52:55], 0 offen offset:512
    buffer_load_dwordx4 v[28:31], v6, s[52:55], 0 offen offset:768
    buffer_load_dwordx4 v[32:35], v6, s[52:55], 0 offen offset:1024
    buffer_load_dwordx2 v[66:67], v64, s[52:55], s62 offen
    s_branch L_u_go
L_u_q:
    s_mov_b32 s97, 1
    s_mov_b32 s99, 8192
    s_mov_b32 s100, 2
    s_lshl_b32 s98, s62, 7
    s_mov_b32 s48, s10
    s_mov_b32 s49, s11
    s_mov_b32 s50, 5242880
    s_mov_b32 s51, 0x20000
L_u_go:
    v_lshrrev_b32 v6, 3, v0
    v_mul_lo_u32 v1, v6, s99
    v_and_b32 v6, 2, v6
    v_xor_b32 v6, v6, v0
    v_and_b32 v6, 7, v6
    v_lshl_add_u32 v1, v6, 4, v1
    v_add_u32 v1, s98, v1
    v_xor_b32 v2, 64, v1
    s_mul_i32 s63, s99, s14
    s_mul_i32 s63, s63, 160
    s_lshl_b32 s59, s99, 3
    s_mov_b32 m0, s101
    s_mov_b32 s62, 10
L_dma_1:
    buffer_load_dwordx4 v1, s[48:51], s63 offen nt lds
    s_add_u32 m0, m0, 1024
    s_add_u32 s63, s63, s59
    s_cmp_eq_u32 s100, 0
    s_cbranch_scc1 L_dma_1n0
    s_waitcnt vmcnt(5)
    s_cmp_eq_u32 s100, 2
    s_cbranch_scc1 L_dma_1n0
    s_waitcnt vmcnt(5)
L_dma_1n0:
    buffer_load_dwordx4 v2, s[48:51], s63 offen nt lds
    s_add_u32 m0, m0, 1024
    s_add_u32 s63, s63, s59
    s_cmp_eq_u32 s100, 0
    s_cbranch_scc1 L_dma_1n1
    s_waitcnt vmcnt(5)
    s_cmp_eq_u32 s100, 2
    s_cbranch_scc1 L_dma_1n1
    s_waitcnt vmcnt(5)
L_dma_1n1:
    s_sub_u32 s62, s62, 1
    s_cmp_lg_u32 s62, 0
    s_cbranch_scc1 L_dma_1
    v_min_u32 v65, 15, v0
    v_and_b32 v6, 1, v65
    v_mul_u32_u24 v6, 126, v6
    v_lshl_add_u32 v65, v65, 1, v6
    v_mov_b32 v68, 0
    s_cmp_lt_u32 s56, 40
    s_cbranch_scc1 L_u_nofl
    buffer_load_dword v68, v65, s[44:47], 0 offen sc1
L_u_nofl:
    s_cmp_lt_u32 s56, 144
    s_cbranch_scc0 L_u_nob
    s_barrier
L_u_nob:
    v_lshrrev_b32 v60, 4, v0
    v_lshlrev_b32 v60, 10, v60
    v_bfe_u32 v6, v0, 2, 2
    v_lshl_add_u32 v60, v6, 7, v60
    v_and_b32 v6, 3, v0
    v_lshl_add_u32 v60, v6, 3, v60
    v_bfe_u32 v6, v0, 3, 2
    v_lshl_add_u32 v60, v6, 5, v60
    v_xor_b32 v61, 32, v60
    v_xor_b32 v62, 64, v60
    v_xor_b32 v63, 0x60, v60
    v_add_u32 v60, s101, v60
    v_add_u32 v61, s101, v61
    v_add_u32 v62, s101, v62
    v_add_u32 v63, s101, v63
    v_mov_b32 v56, 1.0
    v_mov_b32 v57, 1.0
    v_mov_b32 v58, 1.0
    v_mov_b32 v59, 1.0
    s_mov_b32 s58, 0
    v_lshl_add_u32 v69, v7, 2, v3
    v_lshl_add_u32 v69, v4, 4, v69
    v_and_b32 v64, 15, v0
    v_lshlrev_b32 v64, 3, v64
    s_cmp_eq_u32 s97, 1
    s_cbranch_scc1 L_u_q2
    v_mul_u32_u24 v6, 1280, v3
    v_add_u32 v64, v64, v6
    s_mul_i32 s63, s13, 3840
    s_add_u32 s57, s98, s63
    s_add_u32 s57, s57, 10240
    s_cmp_lt_u32 s56, 40
    s_cbranch_scc0 L_u_nat
    v_lshrrev_b32 v69, 1, v3
    v_lshlrev_b32 v69, 3, v69
    v_lshl_add_u32 v69, v7, 4, v69
    v_lshl_add_u32 v69, v4, 1, v69
    v_and_b32 v6, 1, v3
    v_add_u32 v69, v69, v6
    s_lshr_b32 s62, s56, 1
    s_lshl_b32 s57, s62, 11
    s_cmp_ge_u32 s62, 10
    s_cselect_b32 s62, -19968, 0
    s_add_u32 s57, s57, s62
    s_and_b32 s62, s56, 1
    s_lshl_b32 s62, s62, 8
    s_add_u32 s57, s57, s62
    v_lshrrev_b32 v64, 5, v0
    v_lshlrev_b32 v64, 10, v64
    v_and_b32 v6, 31, v0
    v_lshl_add_u32 v64, v6, 3, v64
L_u_nat:
    s_cmp_eq_u32 s13, 4
    s_cselect_b32 s58, 1.0, 0
    s_cmp_eq_u32 s13, 1
    s_cselect_b32 s58, 1.0, s58
    s_cselect_b32 s56, 1, 0
    s_cmp_eq_u32 s14, 0
    s_cselect_b32 s58, s58, 0
    s_waitcnt vmcnt(20)
    s_mov_b32 s62, 0xbfb8aa3b
    v_lshlrev_b32 v40, 16, v8
    v_and_b32 v41, 0xffff0000, v8
    v_lshlrev_b32 v42, 16, v9
    v_and_b32 v43, 0xffff0000, v9
    v_lshlrev_b32 v44, 16, v10
    v_and_b32 v45, 0xffff0000, v10
    v_lshlrev_b32 v46, 16, v11
    v_and_b32 v47, 0xffff0000, v11
    v_mul_f32 v48, s62, v40
    v_mul_f32 v49, s62, v41
    v_mul_f32 v50, s62, v42
    v_mul_f32 v51, s62, v43
    v_mul_f32 v52, s62, v44
    v_mul_f32 v53, s62, v45
    v_mul_f32 v54, s62, v46
    v_mul_f32 v55, s62, v47
    v_exp_f32 v48, v48
    v_exp_f32 v49, v49
    v_exp_f32 v50, v50
    v_exp_f32 v51, v51
    v_exp_f32 v52, v52
    v_exp_f32 v53, v53
    v_exp_f32 v54, v54
    v_exp_f32 v55, v55
    v_add_f32 v48, 1.0, v48
    v_add_f32 v49, 1.0, v49
    v_add_f32 v50, 1.0, v50
    v_add_f32 v51, 1.0, v51
    v_add_f32 v52, 1.0, v52
    v_add_f32 v53, 1.0, v53
    v_add_f32 v54, 1.0, v54
    v_add_f32 v55, 1.0, v55
    v_rcp_f32 v48, v48
    v_rcp_f32 v49, v49
    v_rcp_f32 v50, v50
    v_rcp_f32 v51, v51
    v_rcp_f32 v52, v52
    v_rcp_f32 v53, v53
    v_rcp_f32 v54, v54
    v_rcp_f32 v55, v55
    v_mul_f32 v40, v40, v48
    v_mul_f32 v41, v41, v49
    v_mul_f32 v42, v42, v50
    v_mul_f32 v43, v43, v51
    v_mul_f32 v44, v44, v52
    v_mul_f32 v45, v45, v53
    v_mul_f32 v46, v46, v54
    v_mul_f32 v47, v47, v55
    v_cvt_pk_bf16_f32 v8, v40, v41
    v_cvt_pk_bf16_f32 v9, v42, v43
    v_cvt_pk_bf16_f32 v10, v44, v45
    v_cvt_pk_bf16_f32 v11, v46, v47
    v_lshlrev_b32 v40, 16, v12
    v_and_b32 v41, 0xffff0000, v12
    v_lshlrev_b32 v42, 16, v13
    v_and_b32 v43, 0xffff0000, v13
    v_lshlrev_b32 v44, 16, v14
    v_and_b32 v45, 0xffff0000, v14
    v_lshlrev_b32 v46, 16, v15
    v_and_b32 v47, 0xffff0000, v15
    v_mul_f32 v48, s62, v40
    v_mul_f32 v49, s62, v41
    v_mul_f32 v50, s62, v42
    v_mul_f32 v51, s62, v43
    v_mul_f32 v52, s62, v44
    v_mul_f32 v53, s62, v45
    v_mul_f32 v54, s62, v46
    v_mul_f32 v55, s62, v47
    v_exp_f32 v48, v48
    v_exp_f32 v49, v49
    v_exp_f32 v50, v50
    v_exp_f32 v51, v51
    v_exp_f32 v52, v52
    v_exp_f32 v53, v53
    v_exp_f32 v54, v54
    v_exp_f32 v55, v55
    v_add_f32 v48, 1.0, v48
    v_add_f32 v49, 1.0, v49
    v_add_f32 v50, 1.0, v50
    v_add_f32 v51, 1.0, v51
    v_add_f32 v52, 1.0, v52
    v_add_f32 v53, 1.0, v53
    v_add_f32 v54, 1.0, v54
    v_add_f32 v55, 1.0, v55
    v_rcp_f32 v48, v48
    v_rcp_f32 v49, v49
    v_rcp_f32 v50, v50
    v_rcp_f32 v51, v51
    v_rcp_f32 v52, v52
    v_rcp_f32 v53, v53
    v_rcp_f32 v54, v54
    v_rcp_f32 v55, v55
    v_mul_f32 v40, v40, v48
    v_mul_f32 v41, v41, v49
    v_mul_f32 v42, v42, v50
    v_mul_f32 v43, v43, v51
    v_mul_f32 v44, v44, v52
    v_mul_f32 v45, v45, v53
    v_mul_f32 v46, v46, v54
    v_mul_f32 v47, v47, v55
    v_cvt_pk_bf16_f32 v12, v40, v41
    v_cvt_pk_bf16_f32 v13, v42, v43
    v_cvt_pk_bf16_f32 v14, v44, v45
    v_cvt_pk_bf16_f32 v15, v46, v47
    s_mul_i32 s62, s3, 1344
    s_add_u32 s62, s62, 151552
    v_mul_u32_u24 v5, 336, v3
    v_and_b32 v6, 15, v0
    v_lshl_add_u32 v5, v6, 4, v5
    v_add_u32 v5, s62, v5
    ds_write_b128 v5, v[8:11]
    s_mov_b32 exec_lo, 0x000f000f
    s_mov_b32 exec_hi, 0x000f000f
    ds_write_b128 v5, v[12:15] offset:256
    s_mov_b64 exec, -1
    v_mul_u32_u24 v5, 336, v4
    v_lshl_add_u32 v5, v3, 4, v5
    v_add_u32 v5, s62, v5
    s_mov_b32 s59, 0x3e800000
    s_cmp_eq_u32 s56, 0
    s_cbranch_scc1 L_u_nost
    v_mov_b32 v40, 0
    v_mov_b32 v41, 0
    s_mov_b32 s62, 0x3f803f80
    v_dot2c_f32_bf16 v40, s62, v16
    v_dot2c_f32_bf16 v41, v16, v16
    v_dot2c_f32_bf16 v40, s62, v17
    v_dot2c_f32_bf16 v41, v17, v17
    v_dot2c_f32_bf16 v40, s62, v18
    v_dot2c_f32_bf16 v41, v18, v18
    v_dot2c_f32_bf16 v40, s62, v19
    v_dot2c_f32_bf16 v41, v19, v19
    v_dot2c_f32_bf16 v40, s62, v20
    v_dot2c_f32_bf16 v41, v20, v20
    v_dot2c_f32_bf16 v40, s62, v21
    v_dot2c_f32_bf16 v41, v21, v21
    v_dot2c_f32_bf16 v40, s62, v22
    v_dot2c_f32_bf16 v41, v22, v22
    v_dot2c_f32_bf16 v40, s62, v23
    v_dot2c_f32_bf16 v41, v23, v23
    v_dot2c_f32_bf16 v40, s62, v24
    v_dot2c_f32_bf16 v41, v24, v24
    v_dot2c_f32_bf16 v40, s62, v25
    v_dot2c_f32_bf16 v41, v25, v25
    v_dot2c_f32_bf16 v40, s62, v26
    v_dot2c_f32_bf16 v41, v26, v26
    v_dot2c_f32_bf16 v40, s62, v27
    v_dot2c_f32_bf16 v41, v27, v27
    v_dot2c_f32_bf16 v40, s62, v28
    v_dot2c_f32_bf16 v41, v28, v28
    v_dot2c_f32_bf16 v40, s62, v29
    v_dot2c_f32_bf16 v41, v29, v29
    v_dot2c_f32_bf16 v40, s62, v30
    v_dot2c_f32_bf16 v41, v30, v30
    v_dot2c_f32_bf16 v40, s62, v31
    v_dot2c_f32_bf16 v41, v31, v31
    v_dot2c_f32_bf16 v40, s62, v32
    v_dot2c_f32_bf16 v41, v32, v32
    v_dot2c_f32_bf16 v40, s62, v33
    v_dot2c_f32_bf16 v41, v33, v33
    v_dot2c_f32_bf16 v40, s62, v34
    v_dot2c_f32_bf16 v41, v34, v34
    v_dot2c_f32_bf16 v40, s62, v35
    v_dot2c_f32_bf16 v41, v35, v35
    s_nop 1
    v_add_f32_dpp v40, v40, v40 row_ror:4 row_mask:0xf bank_mask:0xf
    v_add_f32_dpp v41, v41, v41 row_ror:4 row_mask:0xf bank_mask:0xf
    s_nop 0
    v_add_f32_dpp v40, v40, v40 row_ror:8 row_mask:0xf bank_mask:0xf
    v_add_f32_dpp v41, v41, v41 row_ror:8 row_mask:0xf bank_mask:0xf
    v_mov_b32 v42, v40
    v_mov_b32 v43, v41
    s_nop 0
    v_permlane16_swap_b32 v40, v42
    v_permlane16_swap_b32 v41, v43
    v_add_f32 v40, v40, v42
    v_add_f32 v41, v41, v43
    v_mov_b32 v42, v40
    v_mov_b32 v43, v41
    s_nop 0
    v_permlane32_swap_b32 v40, v42
    v_permlane32_swap_b32 v41, v43
    v_add_f32 v40, v40, v42
    v_add_f32 v41, v41, v43
    s_mov_b32 s62, 0x3acccccd
    v_mul_f32 v40, s62, v40
    v_mul_f32 v41, s62, v41
    v_fma_f32 v41, -v40, v40, v41
    v_max_f32 v41, 0, v41
    v_add_f32 v41, 0x3727c5ac, v41
    v_rsq_f32 v41, v41
    v_lshlrev_b32 v56, 16, v66
    v_and_b32 v57, 0xffff0000, v66
    v_lshlrev_b32 v58, 16, v67
    v_and_b32 v59, 0xffff0000, v67
    v_sub_f32 v56, v56, v40
    v_sub_f32 v57, v57, v40
    v_sub_f32 v58, v58, v40
    v_sub_f32 v59, v59, v40
    v_mul_f32 v56, v56, v41
    v_mul_f32 v57, v57, v41
    v_mul_f32 v58, v58, v41
    v_mul_f32 v59, v59, v41
L_u_nost:
    ds_read_b128 v[8:11], v5 offset:0
    ds_read_b128 v[12:15], v5 offset:64
    ds_read_b128 v[16:19], v5 offset:128
    ds_read_b128 v[20:23], v5 offset:192
    ds_read_b128 v[24:27], v5 offset:256
    s_branch L_u_frag
L_u_q2:
    v_lshl_add_u32 v64, v3, 13, v64
    s_add_u32 s57, s98, 40960
    v_lshlrev_b32 v5, 8, v7
    v_lshl_add_u32 v5, v3, 6, v5
    v_lshl_add_u32 v5, v4, 4, v5
    s_mul_i32 s63, s3, 5120
    s_add_u32 s63, s63, 0
    s_add_u32 s12, s63, 4096
    s_mov_b32 s59, 1.0
L_u_frag:
    s_waitcnt vmcnt(0)
    v_cmp_ne_u32 vcc, -1, v68
    s_cbranch_vccz L_u_yok
    s_cmp_eq_u32 s97, 1
    s_cbranch_scc1 L_u_ywait
    buffer_load_dword v68, v65, s[44:47], 0 offen sc1
    s_branch L_u_yok
L_u_ywait:
L_wy_2:
    buffer_load_dword v68, v65, s[44:47], 0 offen sc1
    s_waitcnt vmcnt(0)
    v_cmp_ne_u32 vcc, -1, v68
    s_cbranch_vccz L_wy_2e
    s_sleep 4
    s_sub_u32 s60, s60, 1
    s_cbranch_scc0 L_wy_2
    s_mov_b32 s60, 0
L_wy_2e:
L_u_yok:
    ds_read_b64_tr_b16 v[80:81], v60 offset:0
    ds_read_b64_tr_b16 v[82:83], v60 offset:512
    ds_read_b64_tr_b16 v[84:85], v61 offset:0
    ds_read_b64_tr_b16 v[86:87], v61 offset:512
    ds_read_b64_tr_b16 v[88:89], v62 offset:0
    ds_read_b64_tr_b16 v[90:91], v62 offset:512
    ds_read_b64_tr_b16 v[92:93], v63 offset:0
    ds_read_b64_tr_b16 v[94:95], v63 offset:512
    ds_read_b64_tr_b16 v[96:97], v60 offset:4096
    ds_read_b64_tr_b16 v[98:99], v60 offset:4608
    ds_read_b64_tr_b16 v[100:101], v61 offset:4096
    ds_read_b64_tr_b16 v[102:103], v61 offset:4608
    ds_read_b64_tr_b16 v[104:105], v62 offset:4096
    ds_read_b64_tr_b16 v[106:107], v62 offset:4608
    ds_read_b64_tr_b16 v[108:109], v63 offset:4096
    ds_read_b64_tr_b16 v[110:111], v63 offset:4608
    ds_read_b64_tr_b16 v[112:113], v60 offset:8192
    ds_read_b64_tr_b16 v[114:115], v60 offset:8704
    ds_read_b64_tr_b16 v[116:117], v61 offset:8192
    ds_read_b64_tr_b16 v[118:119], v61 offset:8704
    ds_read_b64_tr_b16 v[120:121], v62 offset:8192
    ds_read_b64_tr_b16 v[122:123], v62 offset:8704
    ds_read_b64_tr_b16 v[124:125], v63 offset:8192
    ds_read_b64_tr_b16 v[126:127], v63 offset:8704
    ds_read_b64_tr_b16 v[128:129], v60 offset:12288
    ds_read_b64_tr_b16 v[130:131], v60 offset:12800
    ds_read_b64_tr_b16 v[132:133], v61 offset:12288
    ds_read_b64_tr_b16 v[134:135], v61 offset:12800
    ds_read_b64_tr_b16 v[136:137], v62 offset:12288
    ds_read_b64_tr_b16 v[138:139], v62 offset:12800
    ds_read_b64_tr_b16 v[140:141], v63 offset:12288
    ds_read_b64_tr_b16 v[142:143], v63 offset:12800
    ds_read_b64_tr_b16 v[144:145], v60 offset:16384
    ds_read_b64_tr_b16 v[146:147], v60 offset:16896
    ds_read_b64_tr_b16 v[148:149], v61 offset:16384
    ds_read_b64_tr_b16 v[150:151], v61 offset:16896
    ds_read_b64_tr_b16 v[152:153], v62 offset:16384
    ds_read_b64_tr_b16 v[154:155], v62 offset:16896
    ds_read_b64_tr_b16 v[156:157], v63 offset:16384
    ds_read_b64_tr_b16 v[158:159], v63 offset:16896
    s_cmp_eq_u32 s97, 0
    s_cbranch_scc1 L_u_mm
    s_branch L_poll_3
L_poll_3s:
    s_sleep 8
L_poll_3:
    buffer_load_dwordx4 v[8:11], v5, s[40:43], s63 offen offset:0 sc1
    buffer_load_dwordx4 v[12:15], v5, s[40:43], s63 offen offset:1024 sc1
    buffer_load_dwordx4 v[16:19], v5, s[40:43], s63 offen offset:2048 sc1
    buffer_load_dwordx4 v[20:23], v5, s[40:43], s63 offen offset:3072 sc1
    buffer_load_dwordx4 v[24:27], v5, s[40:43], s12 offen offset:0 sc1
    s_sub_u32 s60, s60, 1
    s_cbranch_scc1 L_poll_3t
    s_waitcnt vmcnt(0)
    v_max3_u32 v37, v8, v9, v10
    v_max3_u32 v37, v37, v11, v12
    v_max3_u32 v37, v37, v13, v14
    v_max3_u32 v37, v37, v15, v16
    v_max3_u32 v37, v37, v17, v18
    v_max3_u32 v37, v37, v19, v20
    v_max3_u32 v37, v37, v21, v22
    v_max3_u32 v37, v37, v23, v24
    v_max3_u32 v37, v37, v25, v26
    v_max_u32 v37, v37, v27
    v_cmp_eq_u32 vcc, -1, v37
    s_cbranch_vccnz L_poll_3s
L_poll_3e:
L_u_got:
L_u_mm:
    s_waitcnt lgkmcnt(0)
    v_mfma_f32_16x16x32_bf16 v[40:43], v[80:83], v[8:11], 0
    v_mfma_f32_16x16x32_bf16 v[44:47], v[84:87], v[8:11], 0
    v_mfma_f32_16x16x32_bf16 v[48:51], v[88:91], v[8:11], 0
    v_mfma_f32_16x16x32_bf16 v[52:55], v[92:95], v[8:11], 0
    v_mfma_f32_16x16x32_bf16 v[40:43], v[96:99], v[12:15], v[40:43]
    v_mfma_f32_16x16x32_bf16 v[44:47], v[100:103], v[12:15], v[44:47]
    v_mfma_f32_16x16x32_bf16 v[48:51], v[104:107], v[12:15], v[48:51]
    v_mfma_f32_16x16x32_bf16 v[52:55], v[108:111], v[12:15], v[52:55]
    v_mfma_f32_16x16x32_bf16 v[40:43], v[112:115], v[16:19], v[40:43]
    v_mfma_f32_16x16x32_bf16 v[44:47], v[116:119], v[16:19], v[44:47]
    v_mfma_f32_16x16x32_bf16 v[48:51], v[120:123], v[16:19], v[48:51]
    v_mfma_f32_16x16x32_bf16 v[52:55], v[124:127], v[16:19], v[52:55]
    v_mfma_f32_16x16x32_bf16 v[40:43], v[128:131], v[20:23], v[40:43]
    v_mfma_f32_16x16x32_bf16 v[44:47], v[132:135], v[20:23], v[44:47]
    v_mfma_f32_16x16x32_bf16 v[48:51], v[136:139], v[20:23], v[48:51]
    v_mfma_f32_16x16x32_bf16 v[52:55], v[140:143], v[20:23], v[52:55]
    v_mfma_f32_16x16x32_bf16 v[40:43], v[144:147], v[24:27], v[40:43]
    v_mfma_f32_16x16x32_bf16 v[44:47], v[148:151], v[24:27], v[44:47]
    v_mfma_f32_16x16x32_bf16 v[48:51], v[152:155], v[24:27], v[48:51]
    v_mfma_f32_16x16x32_bf16 v[52:55], v[156:159], v[24:27], v[52:55]
    v_lshlrev_b32 v5, 4, v0
    v_add_u32 v5, 147456, v5
    s_lshl_b32 s62, s3, 10
    s_add_u32 s62, s62, 147456
    v_lshl_add_u32 v6, v69, 4, s62
    v_mov_b32 v24, s58
    v_mov_b32 v32, 162056
    v_mov_b32 v33, 1
    v_add_f32_dpp v40, v40, v40 row_ror:8 row_mask:0xf bank_mask:0xf
    v_add_f32_dpp v41, v41, v41 row_ror:8 row_mask:0xf bank_mask:0xf
    v_add_f32_dpp v42, v42, v42 row_ror:8 row_mask:0xf bank_mask:0xf
    v_add_f32_dpp v43, v43, v43 row_ror:8 row_mask:0xf bank_mask:0xf
    v_add_f32_dpp v44, v44, v44 row_ror:8 row_mask:0xf bank_mask:0xf
    v_add_f32_dpp v45, v45, v45 row_ror:8 row_mask:0xf bank_mask:0xf
    v_add_f32_dpp v46, v46, v46 row_ror:8 row_mask:0xf bank_mask:0xf
    v_add_f32_dpp v47, v47, v47 row_ror:8 row_mask:0xf bank_mask:0xf
    v_add_f32_dpp v48, v48, v48 row_ror:8 row_mask:0xf bank_mask:0xf
    v_add_f32_dpp v49, v49, v49 row_ror:8 row_mask:0xf bank_mask:0xf
    v_add_f32_dpp v50, v50, v50 row_ror:8 row_mask:0xf bank_mask:0xf
    v_add_f32_dpp v51, v51, v51 row_ror:8 row_mask:0xf bank_mask:0xf
    v_add_f32_dpp v52, v52, v52 row_ror:8 row_mask:0xf bank_mask:0xf
    v_add_f32_dpp v53, v53, v53 row_ror:8 row_mask:0xf bank_mask:0xf
    v_add_f32_dpp v54, v54, v54 row_ror:8 row_mask:0xf bank_mask:0xf
    v_add_f32_dpp v55, v55, v55 row_ror:8 row_mask:0xf bank_mask:0xf
    v_add_f32_dpp v28, v40, v40 row_ror:4 row_mask:0xf bank_mask:0x1
    v_add_f32_dpp v29, v41, v41 row_ror:4 row_mask:0xf bank_mask:0x1
    v_add_f32_dpp v30, v42, v42 row_ror:4 row_mask:0xf bank_mask:0x1
    v_add_f32_dpp v31, v43, v43 row_ror:4 row_mask:0xf bank_mask:0x1
    v_add_f32_dpp v28, v44, v44 row_ror:4 row_mask:0xf bank_mask:0x2
    v_add_f32_dpp v29, v45, v45 row_ror:4 row_mask:0xf bank_mask:0x2
    v_add_f32_dpp v30, v46, v46 row_ror:4 row_mask:0xf bank_mask:0x2
    v_add_f32_dpp v31, v47, v47 row_ror:4 row_mask:0xf bank_mask:0x2
    v_add_f32_dpp v28, v48, v48 row_ror:4 row_mask:0xf bank_mask:0x4
    v_add_f32_dpp v29, v49, v49 row_ror:4 row_mask:0xf bank_mask:0x4
    v_add_f32_dpp v30, v50, v50 row_ror:4 row_mask:0xf bank_mask:0x4
    v_add_f32_dpp v31, v51, v51 row_ror:4 row_mask:0xf bank_mask:0x4
    v_add_f32_dpp v28, v52, v52 row_ror:4 row_mask:0xf bank_mask:0x8
    v_add_f32_dpp v29, v53, v53 row_ror:4 row_mask:0xf bank_mask:0x8
    v_add_f32_dpp v30, v54, v54 row_ror:4 row_mask:0xf bank_mask:0x8
    v_add_f32_dpp v31, v55, v55 row_ror:4 row_mask:0xf bank_mask:0x8
    v_fma_f32 v28, v28, s59, v24
    v_fma_f32 v29, v29, s59, v24
    v_fma_f32 v30, v30, s59, v24
    v_fma_f32 v31, v31, s59, v24
    v_mul_f32 v28, v28, v56
    v_mul_f32 v29, v29, v57
    v_mul_f32 v30, v30, v58
    v_mul_f32 v31, v31, v59
    ds_write_b128 v6, v[28:31]
    s_mov_b64 exec, 1
    ds_add_rtn_u32 v34, v32, v33
    s_mov_b64 exec, -1
    ds_read_b128 v[8:11], v5
    ds_read_b128 v[12:15], v5 offset:1024
    ds_read_b128 v[16:19], v5 offset:2048
    ds_read_b128 v[20:23], v5 offset:3072
    s_waitcnt lgkmcnt(0)
    v_readfirstlane_b32 s62, v34
    s_nop 0
    s_cmp_eq_u32 s62, s15
    s_cbranch_scc1 L_u_last
    s_cmp_eq_u32 s62, 1
    s_cbranch_scc1 L_service
    s_endpgm
L_u_last:
    v_add_f32 v8, v8, v12
    v_add_f32 v9, v9, v13
    v_add_f32 v10, v10, v14
    v_add_f32 v11, v11, v15
    s_cmp_eq_u32 s15, 1
    s_cbranch_scc1 L_u_two
    v_add_f32 v16, v16, v20
    v_add_f32 v17, v17, v21
    v_add_f32 v18, v18, v22
    v_add_f32 v19, v19, v23
    v_add_f32 v8, v8, v16
    v_add_f32 v9, v9, v17
    v_add_f32 v10, v10, v18
    v_add_f32 v11, v11, v19
L_u_two:
    v_cvt_pk_bf16_f32 v8, v8, v9
    v_cvt_pk_bf16_f32 v9, v10, v11
    s_waitcnt vmcnt(0)
    v_cmp_ne_u32 vcc, -1, v68
    s_cbranch_vccz L_u_st
L_wy_4:
    buffer_load_dword v68, v65, s[44:47], 0 offen sc1
    s_waitcnt vmcnt(0)
    v_cmp_ne_u32 vcc, -1, v68
    s_cbranch_vccz L_wy_4e
    s_sleep 4
    s_sub_u32 s60, s60, 1
    s_cbranch_scc0 L_wy_4
    s_mov_b32 s60, 0
L_wy_4e:
L_u_st:
    buffer_store_dwordx2 v[8:9], v64, s[40:43], s57 offen sc1
    s_endpgm
L_touch:
    s_load_dword s0, s[32:33], 0
    s_load_dword s0, s[30:31], 0
    s_cmp_eq_u32 s39, 1
    s_cbranch_scc1 L_tpr
    s_mov_b32 s62, 16777216
    s_load_dword s0, s[8:9], s62
    s_mov_b32 s62, 83886080
    s_load_dword s0, s[8:9], s62
    s_mov_b32 s62, 150994944
    s_load_dword s0, s[8:9], s62
    s_mov_b32 s62, 218103808
    s_load_dword s0, s[8:9], s62
    s_branch L_tpv
L_tpr:
    s_load_dword s0, s[20:21], 0
    s_mov_b32 s62, 2211836
    s_load_dword s0, s[20:21], s62
    s_load_dword s0, s[16:17], 0
    s_mov_b32 s62, 2211836
    s_load_dword s0, s[16:17], s62
    s_load_dword s0, s[18:19], 0
    s_load_dword s0, s[22:23], 0
    s_load_dword s0, s[28:29], 0
    s_load_dword s0, s[4:5], 0
L_tpv:
    s_lshl_b32 s62, s34, 23
    s_load_dword s0, s[8:9], s62
    s_add_u32 s62, s62, 67108864
    s_load_dword s0, s[8:9], s62
    s_add_u32 s62, s62, 67108864
    s_load_dword s0, s[8:9], s62
    s_add_u32 s62, s62, 67108864
    s_load_dword s0, s[8:9], s62
    s_add_u32 s62, s62, 67108864
    s_branch L_notp
L_stream2:
    s_mov_b32 s12, s100
    s_mov_b32 s13, s101
    s_andn2_b32 s96, s59, s39
    s_cbranch_scc0 L_noua
    s_barrier
L_noua:
    s_mov_b32 s40, s32
    s_mov_b32 s41, s33
    s_mov_b32 s42, 589824
    s_mov_b32 s43, 0x20000
    s_mov_b32 s44, s30
    s_mov_b32 s45, s31
    s_mov_b32 s46, 256
    s_mov_b32 s47, 0x20000
    s_bitcmp1_b32 s3, 0
    s_mov_b32 s57, 0xffffffff
    s_mov_b32 s58, 0x0
    s_mov_b32 s14, 0xffffffff
    s_mov_b32 s15, 0x0
L_pm_10:
    s_sub_u32 s96, s56, 104
    s_cmp_lt_u32 s96, 66
    s_cbranch_scc0 L_pm_11
    s_bitcmp1_b32 s3, 0
    s_mov_b32 s57, 0xfffc000f
    s_mov_b32 s58, 0x0
    s_mov_b32 s14, 0xffffffff
    s_mov_b32 s15, 0x0
L_pm_11:
    s_sub_u32 s96, s56, 144
    s_cmp_lt_u32 s96, 10
    s_cbranch_scc0 L_pm_12
    s_bitcmp1_b32 s3, 0
    s_mov_b32 s57, 0xffffffff
    s_mov_b32 s58, 0xfff
    s_mov_b32 s14, 0xffffffff
    s_mov_b32 s15, 0x0
L_pm_12:
    s_cmp_lt_u32 s56, 104
    s_cbranch_scc0 L_pm_13
    s_bitcmp1_b32 s3, 0
    s_mov_b32 s57, 0xfc00000f
    s_mov_b32 s58, 0x0
    s_mov_b32 s14, 0xffffffff
    s_mov_b32 s15, 0x0
L_pm_13:
    s_sub_u32 s96, s56, 43
    s_and_b32 s96, s96, 0xffffffc7
    s_cmp_eq_u32 s96, 0
    s_cbranch_scc0 L_pm_14
    s_bitcmp1_b32 s3, 0
    s_mov_b32 s57, 0x0
    s_mov_b32 s58, 0x0
    s_mov_b32 s14, 0xffff0000
    s_mov_b32 s15, 0x0
L_pm_14:
    s_cmp_lt_u32 s56, 40
    s_cbranch_scc0 L_pm_15
    s_bitcmp1_b32 s3, 0
    s_mov_b32 s57, 0xffffffff
    s_mov_b32 s58, 0x3f
    s_mov_b32 s14, 0xffffffff
    s_mov_b32 s15, 0x0
L_pm_15:
    s_cmp_eq_u32 s39, 1
    s_cbranch_scc0 L_pm_16
    s_bitcmp1_b32 s3, 0
    s_mov_b32 s57, 0xff
    s_mov_b32 s58, 0xff
    s_mov_b32 s14, 0xff00ff
    s_cselect_b32 s14, 0xff00ff00, s14
    s_mov_b32 s15, 0x0
L_pm_16:
    s_cmp_lg_u32 s13, 0
    s_cbranch_scc0 L_pm_17
    s_bitcmp1_b32 s3, 0
    s_mov_b32 s57, 0xffffffff
    s_mov_b32 s58, 0x0
    s_mov_b32 s14, 0x0
    s_mov_b32 s15, 0x0
L_pm_17:
    s_and_b32 s96, s39, s59
    s_cbranch_scc0 L_pm_18
    s_bitcmp1_b32 s3, 0
    s_mov_b32 s57, 0x3ff
    s_mov_b32 s58, 0x3ff
    s_mov_b32 s14, 0x0
    s_mov_b32 s15, 0x0
L_pm_18:
    s_add_u32 s52, s8, s63
    s_addc_u32 s53, s9, 0
    s_mov_b32 s54, 262144
    s_mov_b32 s55, 0x20000
    v_and_b32 v2, 15, v0
    v_lshrrev_b32 v3, 1, v2
    v_and_b32 v37, 1, v2
    v_lshlrev_b32 v37, 4, v37
    v_mov_b32 v38, 0xffff
    v_lshlrev_b32 v37, v37, v38
    v_cmp_eq_u32 vcc, 0, v3
    v_mov_b32 v32, 0
    s_nop 0
    v_cndmask_b32 v20, 0, v37, vcc
    v_cmp_eq_u32 vcc, 1, v3
    v_mov_b32 v33, 0
    s_nop 0
    v_cndmask_b32 v21, 0, v37, vcc
    v_cmp_eq_u32 vcc, 2, v3
    v_mov_b32 v34, 0
    s_nop 0
    v_cndmask_b32 v22, 0, v37, vcc
    v_cmp_eq_u32 vcc, 3, v3
    v_mov_b32 v35, 0
    s_nop 0
    v_cndmask_b32 v23, 0, v37, vcc
    v_lshlrev_b32 v2, 4, v2
    s_lshl_b32 s98, s62, 8
    s_add_u32 s98, s98, 40960
    s_bitcmp0_b32 s57, 2
    s_cbranch_scc1 L_sf_19
    s_bitcmp0_b32 s58, 2
    s_cbranch_scc1 L_sf_19
    s_waitcnt vmcnt(1)
L_sf_19:
    buffer_load_dwordx4 v[48:51], v1, s[48:51], s97 offen offset:2048 nt
    s_bitcmp0_b32 s57, 3
    s_cbranch_scc1 L_sf_20
    s_waitcnt vmcnt(2)
    s_bitcmp0_b32 s58, 3
    s_cbranch_scc1 L_sf_20
    s_waitcnt vmcnt(1)
L_sf_20:
    buffer_load_dwordx4 v[52:55], v1, s[48:51], s97 offen offset:3072 nt
    s_add_u32 s97, s97, 32768
    v_add_u32 v1, 4096, v1
    v_and_b32 v1, 0x7fff, v1
    s_waitcnt vmcnt(3)
    s_bitcmp0_b32 s57, 4
    s_cbranch_scc1 L_sf_21
    s_waitcnt vmcnt(2)
    s_bitcmp0_b32 s58, 4
    s_cbranch_scc1 L_sf_21
    s_waitcnt vmcnt(1)
L_sf_21:
    buffer_load_dwordx4 v[56:59], v1, s[48:51], s97 offen offset:0 nt
    s_waitcnt vmcnt(3)
    s_bitcmp0_b32 s57, 5
    s_cbranch_scc1 L_sf_22
    s_waitcnt vmcnt(2)
    s_bitcmp0_b32 s58, 5
    s_cbranch_scc1 L_sf_22
    s_waitcnt vmcnt(1)
L_sf_22:
    buffer_load_dwordx4 v[60:63], v1, s[48:51], s97 offen offset:1024 nt
    s_waitcnt vmcnt(3)
    s_bitcmp0_b32 s57, 6
    s_cbranch_scc1 L_sf_23
    s_waitcnt vmcnt(2)
    s_bitcmp0_b32 s58, 6
    s_cbranch_scc1 L_sf_23
    s_waitcnt vmcnt(1)
L_sf_23:
    buffer_load_dwordx4 v[64:67], v1, s[48:51], s97 offen offset:2048 nt
    s_waitcnt vmcnt(3)
    s_bitcmp0_b32 s57, 7
    s_cbranch_scc1 L_sf_24
    s_waitcnt vmcnt(2)
    s_bitcmp0_b32 s58, 7
    s_cbranch_scc1 L_sf_24
    s_waitcnt vmcnt(1)
L_sf_24:
    buffer_load_dwordx4 v[68:71], v1, s[48:51], s97 offen offset:3072 nt
    s_add_u32 s97, s97, 32768
    v_add_u32 v1, 4096, v1
    v_and_b32 v1, 0x7fff, v1
    s_waitcnt vmcnt(3)
    s_bitcmp0_b32 s57, 8
    s_cbranch_scc1 L_sf_25
    s_waitcnt vmcnt(2)
    s_bitcmp0_b32 s58, 8
    s_cbranch_scc1 L_sf_25
    s_waitcnt vmcnt(1)
L_sf_25:
    buffer_load_dwordx4 v[72:75], v1, s[48:51], s97 offen offset:0 nt
    s_waitcnt vmcnt(3)
    s_bitcmp0_b32 s57, 9
    s_cbranch_scc1 L_sf_26
    s_waitcnt vmcnt(2)
    s_bitcmp0_b32 s58, 9
    s_cbranch_scc1 L_sf_26
    s_waitcnt vmcnt(1)
L_sf_26:
    buffer_load_dwordx4 v[76:79], v1, s[48:51], s97 offen offset:1024 nt
    s_waitcnt vmcnt(3)
    s_bitcmp0_b32 s57, 10
    s_cbranch_scc1 L_sf_27
    s_waitcnt vmcnt(2)
    s_bitcmp0_b32 s58, 10
    s_cbranch_scc1 L_sf_27
    s_waitcnt vmcnt(1)
L_sf_27:
    buffer_load_dwordx4 v[80:83], v1, s[48:51], s97 offen offset:2048 nt
    s_waitcnt vmcnt(3)
    s_bitcmp0_b32 s57, 11
    s_cbranch_scc1 L_sf_28
    s_waitcnt vmcnt(2)
    s_bitcmp0_b32 s58, 11
    s_cbranch_scc1 L_sf_28
    s_waitcnt vmcnt(1)
L_sf_28:
    buffer_load_dwordx4 v[84:87], v1, s[48:51], s97 offen offset:3072 nt
    s_add_u32 s97, s97, 32768
    v_add_u32 v1, 4096, v1
    v_and_b32 v1, 0x7fff, v1
    s_waitcnt vmcnt(3)
    s_bitcmp0_b32 s57, 12
    s_cbranch_scc1 L_sf_29
    s_waitcnt vmcnt(2)
    s_bitcmp0_b32 s58, 12
    s_cbranch_scc1 L_sf_29
    s_waitcnt vmcnt(1)
L_sf_29:
    buffer_load_dwordx4 v[88:91], v1, s[48:51], s97 offen offset:0 nt
    s_waitcnt vmcnt(3)
    s_bitcmp0_b32 s57, 13
    s_cbranch_scc1 L_sf_30
    s_waitcnt vmcnt(2)
    s_bitcmp0_b32 s58, 13
    s_cbranch_scc1 L_sf_30
    s_waitcnt vmcnt(1)
L_sf_30:
    buffer_load_dwordx4 v[92:95], v1, s[48:51], s97 offen offset:1024 nt
    s_waitcnt vmcnt(3)
    s_bitcmp0_b32 s57, 14
    s_cbranch_scc1 L_sf_31
    s_waitcnt vmcnt(2)
    s_bitcmp0_b32 s58, 14
    s_cbranch_scc1 L_sf_31
    s_waitcnt vmcnt(1)
L_sf_31:
    buffer_load_dwordx4 v[96:99], v1, s[48:51], s97 offen offset:2048 nt
    s_waitcnt vmcnt(3)
    s_bitcmp0_b32 s57, 15
    s_cbranch_scc1 L_sf_32
    s_waitcnt vmcnt(2)
    s_bitcmp0_b32 s58, 15
    s_cbranch_scc1 L_sf_32
    s_waitcnt vmcnt(1)
L_sf_32:
    buffer_load_dwordx4 v[100:103], v1, s[48:51], s97 offen offset:3072 nt
    s_add_u32 s97, s97, 32768
    v_add_u32 v1, 4096, v1
    v_and_b32 v1, 0x7fff, v1
    s_waitcnt vmcnt(3)
    s_bitcmp0_b32 s57, 16
    s_cbranch_scc1 L_sf_33
    s_waitcnt vmcnt(2)
    s_bitcmp0_b32 s58, 16
    s_cbranch_scc1 L_sf_33
    s_waitcnt vmcnt(1)
L_sf_33:
    buffer_load_dwordx4 v[104:107], v1, s[48:51], s97 offen offset:0 nt
    s_waitcnt vmcnt(3)
    s_bitcmp0_b32 s57, 17
    s_cbranch_scc1 L_sf_34
    s_waitcnt vmcnt(2)
    s_bitcmp0_b32 s58, 17
    s_cbranch_scc1 L_sf_34
    s_waitcnt vmcnt(1)
L_sf_34:
    buffer_load_dwordx4 v[108:111], v1, s[48:51], s97 offen offset:1024 nt
    s_waitcnt vmcnt(3)
    s_bitcmp0_b32 s57, 18
    s_cbranch_scc1 L_sf_35
    s_waitcnt vmcnt(2)
    s_bitcmp0_b32 s58, 18
    s_cbranch_scc1 L_sf_35
    s_waitcnt vmcnt(1)
L_sf_35:
    buffer_load_dwordx4 v[112:115], v1, s[48:51], s97 offen offset:2048 nt
    s_waitcnt vmcnt(3)
    s_bitcmp0_b32 s57, 19
    s_cbranch_scc1 L_sf_36
    s_waitcnt vmcnt(2)
    s_bitcmp0_b32 s58, 19
    s_cbranch_scc1 L_sf_36
    s_waitcnt vmcnt(1)
L_sf_36:
    buffer_load_dwordx4 v[116:119], v1, s[48:51], s97 offen offset:3072 nt
    s_add_u32 s97, s97, 32768
    v_add_u32 v1, 4096, v1
    v_and_b32 v1, 0x7fff, v1
    s_waitcnt vmcnt(3)
    s_bitcmp0_b32 s57, 20
    s_cbranch_scc1 L_sf_37
    s_waitcnt vmcnt(2)
    s_bitcmp0_b32 s58, 20
    s_cbranch_scc1 L_sf_37
    s_waitcnt vmcnt(1)
L_sf_37:
    buffer_load_dwordx4 v[120:123], v1, s[48:51], s97 offen offset:0 nt
    s_waitcnt vmcnt(3)
    s_bitcmp0_b32 s57, 21
    s_cbranch_scc1 L_sf_38
    s_waitcnt vmcnt(2)
    s_bitcmp0_b32 s58, 21
    s_cbranch_scc1 L_sf_38
    s_waitcnt vmcnt(1)
L_sf_38:
    buffer_load_dwordx4 v[124:127], v1, s[48:51], s97 offen offset:1024 nt
    s_cmp_eq_u32 s12, -1
    s_cbranch_scc1 L_k_nopf
    s_waitcnt vmcnt(3)
    s_bitcmp0_b32 s57, 22
    s_cbranch_scc1 L_sf_39
    s_waitcnt vmcnt(2)
    s_bitcmp0_b32 s58, 22
    s_cbranch_scc1 L_sf_39
    s_waitcnt vmcnt(1)
L_sf_39:
    buffer_load_dwordx4 v[128:131], v1, s[48:51], s97 offen offset:2048 nt
    s_waitcnt vmcnt(3)
    s_bitcmp0_b32 s57, 23
    s_cbranch_scc1 L_sf_40
    s_waitcnt vmcnt(2)
    s_bitcmp0_b32 s58, 23
    s_cbranch_scc1 L_sf_40
    s_waitcnt vmcnt(1)
L_sf_40:
    buffer_load_dwordx4 v[132:135], v1, s[48:51], s97 offen offset:3072 nt
    s_add_u32 s97, s97, 32768
    v_add_u32 v1, 4096, v1
    v_and_b32 v1, 0x7fff, v1
    s_waitcnt vmcnt(3)
    s_bitcmp0_b32 s57, 24
    s_cbranch_scc1 L_sf_41
    s_waitcnt vmcnt(2)
    s_bitcmp0_b32 s58, 24
    s_cbranch_scc1 L_sf_41
    s_waitcnt vmcnt(1)
L_sf_41:
    buffer_load_dwordx4 v[136:139], v1, s[48:51], s97 offen offset:0 nt
    s_waitcnt vmcnt(3)
    s_bitcmp0_b32 s57, 25
    s_cbranch_scc1 L_sf_42
    s_waitcnt vmcnt(2)
    s_bitcmp0_b32 s58, 25
    s_cbranch_scc1 L_sf_42
    s_waitcnt vmcnt(1)
L_sf_42:
    buffer_load_dwordx4 v[140:143], v1, s[48:51], s97 offen offset:1024 nt
    s_waitcnt vmcnt(3)
    s_bitcmp0_b32 s57, 26
    s_cbranch_scc1 L_sf_43
    s_waitcnt vmcnt(2)
    s_bitcmp0_b32 s58, 26
    s_cbranch_scc1 L_sf_43
    s_waitcnt vmcnt(1)
L_sf_43:
    buffer_load_dwordx4 v[144:147], v1, s[48:51], s97 offen offset:2048 nt
    s_waitcnt vmcnt(3)
    s_bitcmp0_b32 s57, 27
    s_cbranch_scc1 L_sf_44
    s_waitcnt vmcnt(2)
    s_bitcmp0_b32 s58, 27
    s_cbranch_scc1 L_sf_44
    s_waitcnt vmcnt(1)
L_sf_44:
    buffer_load_dwordx4 v[148:151], v1, s[48:51], s97 offen offset:3072 nt
    s_add_u32 s97, s97, 32768
    v_add_u32 v1, 4096, v1
    v_and_b32 v1, 0x7fff, v1
    s_waitcnt vmcnt(3)
    s_bitcmp0_b32 s57, 28
    s_cbranch_scc1 L_sf_45
    s_waitcnt vmcnt(2)
    s_bitcmp0_b32 s58, 28
    s_cbranch_scc1 L_sf_45
    s_waitcnt vmcnt(1)
L_sf_45:
    buffer_load_dwordx4 v[152:155], v1, s[48:51], s97 offen offset:0 nt
    s_waitcnt vmcnt(3)
    s_bitcmp0_b32 s57, 29
    s_cbranch_scc1 L_sf_46
    s_waitcnt vmcnt(2)
    s_bitcmp0_b32 s58, 29
    s_cbranch_scc1 L_sf_46
    s_waitcnt vmcnt(1)
L_sf_46:
    buffer_load_dwordx4 v[156:159], v1, s[48:51], s97 offen offset:1024 nt
    s_waitcnt vmcnt(3)
    s_bitcmp0_b32 s57, 30
    s_cbranch_scc1 L_sf_47
    s_waitcnt vmcnt(2)
    s_bitcmp0_b32 s58, 30
    s_cbranch_scc1 L_sf_47
    s_waitcnt vmcnt(1)
L_sf_47:
    buffer_load_dwordx4 v[160:163], v1, s[48:51], s97 offen offset:2048 nt
    v_min_u32 v39, 15, v0
    v_and_b32 v38, 1, v39
    v_mul_u32_u24 v38, 126, v38
    v_lshl_add_u32 v39, v39, 1, v38
    buffer_load_dword v37, v39, s[44:47], 0 offen sc1
    s_waitcnt vmcnt(4)
    s_bitcmp0_b32 s57, 31
    s_cbranch_scc1 L_sf_48
    s_waitcnt vmcnt(3)
    s_bitcmp0_b32 s58, 31
    s_cbranch_scc1 L_sf_48
    s_waitcnt vmcnt(2)
L_sf_48:
    buffer_load_dwordx4 v[164:167], v1, s[48:51], s97 offen offset:3072 nt
    s_mov_b32 s97, 0
    v_add_u32 v1, 4096, v1
    v_and_b32 v1, 0x7fff, v1
    s_waitcnt vmcnt(4)
    s_bitcmp0_b32 s14, 0
    s_cbranch_scc1 L_sf_49
    s_waitcnt vmcnt(3)
    s_bitcmp0_b32 s15, 0
    s_cbranch_scc1 L_sf_49
    s_waitcnt vmcnt(2)
L_sf_49:
    s_add_u32 m0, s12, 0
    s_nop 0
    buffer_load_dwordx4 v1, s[52:55], s97 offen offset:0 nt lds
    s_waitcnt vmcnt(4)
    s_bitcmp0_b32 s14, 1
    s_cbranch_scc1 L_sf_50
    s_waitcnt vmcnt(3)
    s_bitcmp0_b32 s15, 1
    s_cbranch_scc1 L_sf_50
    s_waitcnt vmcnt(1)
L_sf_50:
    buffer_load_dwordx4 v1, s[52:55], s97 offen offset:1024 nt lds
    s_waitcnt vmcnt(4)
    s_bitcmp0_b32 s14, 2
    s_cbranch_scc1 L_sf_51
    s_waitcnt vmcnt(2)
    s_bitcmp0_b32 s15, 2
    s_cbranch_scc1 L_sf_51
    s_waitcnt vmcnt(1)
L_sf_51:
    buffer_load_dwordx4 v1, s[52:55], s97 offen offset:2048 nt lds
    s_waitcnt vmcnt(3)
    s_bitcmp0_b32 s14, 3
    s_cbranch_scc1 L_sf_52
    s_waitcnt vmcnt(2)
    s_bitcmp0_b32 s15, 3
    s_cbranch_scc1 L_sf_52
    s_waitcnt vmcnt(1)
L_sf_52:
    buffer_load_dwordx4 v1, s[52:55], s97 offen offset:3072 nt lds
    s_add_u32 s97, s97, 32768
    v_add_u32 v1, 4096, v1
    v_and_b32 v1, 0x7fff, v1
    v_cmp_eq_u32 vcc, 0, v37
    s_nop 0
    s_or_b32 s96, vcc_lo, vcc_hi
    buffer_load_dwordx4 v[4:7], v2, s[40:43], s98 offen sc1
    s_waitcnt vmcnt(4)
    s_bitcmp0_b32 s14, 4
    s_cbranch_scc1 L_sf_53
    s_waitcnt vmcnt(3)
    s_bitcmp0_b32 s15, 4
    s_cbranch_scc1 L_sf_53
    s_waitcnt vmcnt(2)
L_sf_53:
    s_add_u32 m0, s12, 4096
    s_nop 0
    buffer_load_dwordx4 v1, s[52:55], s97 offen offset:0 nt lds
    s_waitcnt vmcnt(4)
    s_bitcmp0_b32 s14, 5
    s_cbranch_scc1 L_sf_54
    s_waitcnt vmcnt(3)
    s_bitcmp0_b32 s15, 5
    s_cbranch_scc1 L_sf_54
    s_waitcnt vmcnt(2)
L_sf_54:
    buffer_load_dwordx4 v1, s[52:55], s97 offen offset:1024 nt lds
    s_waitcnt vmcnt(4)
    s_bitcmp0_b32 s14, 6
    s_cbranch_scc1 L_sf_55
    s_waitcnt vmcnt(3)
    s_bitcmp0_b32 s15, 6
    s_cbranch_scc1 L_sf_55
    s_waitcnt vmcnt(1)
L_sf_55:
    buffer_load_dwordx4 v1, s[52:55], s97 offen offset:2048 nt lds
    s_waitcnt vmcnt(4)
    s_bitcmp0_b32 s14, 7
    s_cbranch_scc1 L_sf_56
    s_waitcnt vmcnt(2)
    s_bitcmp0_b32 s15, 7
    s_cbranch_scc1 L_sf_56
    s_waitcnt vmcnt(1)
L_sf_56:
    buffer_load_dwordx4 v1, s[52:55], s97 offen offset:3072 nt lds
    s_add_u32 s97, s97, 32768
    v_add_u32 v1, 4096, v1
    v_and_b32 v1, 0x7fff, v1
L_k_join:
    s_waitcnt vmcnt(4)
    v_max3_u32 v38, v4, v5, v6
    v_max_u32 v38, v38, v7
    v_cmp_eq_u32 vcc, -1, v38
    s_cmp_lg_u32 s96, 0
    s_cbranch_scc1 L_qslow
    s_cbranch_vccnz L_qslow2
L_qok:
    v_dot2_f32_bf16 v8, v72, v4, 0
    v_dot2_f32_bf16 v9, v76, v4, 0
    v_dot2_f32_bf16 v10, v80, v4, 0
    v_dot2_f32_bf16 v11, v84, v4, 0
    v_dot2_f32_bf16 v24, v88, v4, 0
    v_dot2_f32_bf16 v25, v92, v4, 0
    v_dot2_f32_bf16 v26, v96, v4, 0
    v_dot2_f32_bf16 v27, v100, v4, 0
    v_dot2_f32_bf16 v8, v73, v5, v8
    v_dot2_f32_bf16 v9, v77, v5, v9
    v_dot2_f32_bf16 v10, v81, v5, v10
    v_dot2_f32_bf16 v11, v85, v5, v11
    v_dot2_f32_bf16 v24, v89, v5, v24
    v_dot2_f32_bf16 v25, v93, v5, v25
    v_dot2_f32_bf16 v26, v97, v5, v26
    v_dot2_f32_bf16 v27, v101, v5, v27
    v_dot2_f32_bf16 v8, v74, v6, v8
    v_dot2_f32_bf16 v9, v78, v6, v9
    v_dot2_f32_bf16 v10, v82, v6, v10
    v_dot2_f32_bf16 v11, v86, v6, v11
    v_dot2_f32_bf16 v24, v90, v6, v24
    v_dot2_f32_bf16 v25, v94, v6, v25
    v_dot2_f32_bf16 v26, v98, v6, v26
    v_dot2_f32_bf16 v27, v102, v6, v27
    v_dot2_f32_bf16 v8, v75, v7, v8
    v_dot2_f32_bf16 v9, v79, v7, v9
    v_dot2_f32_bf16 v10, v83, v7, v10
    v_dot2_f32_bf16 v11, v87, v7, v11
    v_dot2_f32_bf16 v24, v91, v7, v24
    v_dot2_f32_bf16 v25, v95, v7, v25
    v_dot2_f32_bf16 v26, v99, v7, v26
    v_dot2_f32_bf16 v27, v103, v7, v27
    v_add_f32_dpp v8, v8, v8 row_ror:8 row_mask:0xf bank_mask:0x3
    v_add_f32_dpp v10, v10, v10 row_ror:8 row_mask:0xf bank_mask:0x3
    v_add_f32_dpp v24, v24, v24 row_ror:8 row_mask:0xf bank_mask:0x3
    v_add_f32_dpp v26, v26, v26 row_ror:8 row_mask:0xf bank_mask:0x3
    v_add_f32_dpp v8, v9, v9 row_ror:8 row_mask:0xf bank_mask:0xc
    v_add_f32_dpp v10, v11, v11 row_ror:8 row_mask:0xf bank_mask:0xc
    v_add_f32_dpp v24, v25, v25 row_ror:8 row_mask:0xf bank_mask:0xc
    v_add_f32_dpp v26, v27, v27 row_ror:8 row_mask:0xf bank_mask:0xc
    v_add_f32_dpp v14, v8, v8 row_half_mirror row_mask:0xf bank_mask:0x5
    v_add_f32_dpp v15, v24, v24 row_half_mirror row_mask:0xf bank_mask:0x5
    v_add_f32_dpp v14, v10, v10 row_half_mirror row_mask:0xf bank_mask:0xa
    v_add_f32_dpp v15, v26, v26 row_half_mirror row_mask:0xf bank_mask:0xa
    s_nop 0
    v_add_f32_dpp v14, v14, v14 quad_perm:[1,0,3,2] row_mask:0xf bank_mask:0xf
    v_add_f32_dpp v15, v15, v15 quad_perm:[1,0,3,2] row_mask:0xf bank_mask:0xf
    s_nop 0
    v_add_f32_dpp v14, v14, v14 quad_perm:[2,3,0,1] row_mask:0xf bank_mask:0xf
    v_add_f32_dpp v15, v15, v15 quad_perm:[2,3,0,1] row_mask:0xf bank_mask:0xf
    s_waitcnt vmcnt(3)
    s_bitcmp0_b32 s14, 8
    s_cbranch_scc1 L_sf_67
    s_waitcnt vmcnt(2)
    s_bitcmp0_b32 s15, 8
    s_cbranch_scc1 L_sf_67
    s_waitcnt vmcnt(1)
L_sf_67:
    buffer_load_dwordx4 v[72:75], v1, s[52:55], s97 offen offset:0 nt
    v_dot2_f32_bf16 v8, v40, v4, 0
    v_dot2_f32_bf16 v9, v44, v4, 0
    v_dot2_f32_bf16 v10, v48, v4, 0
    v_dot2_f32_bf16 v11, v52, v4, 0
    v_dot2_f32_bf16 v24, v56, v4, 0
    v_dot2_f32_bf16 v25, v60, v4, 0
    v_dot2_f32_bf16 v26, v64, v4, 0
    v_dot2_f32_bf16 v27, v68, v4, 0
    v_dot2_f32_bf16 v28, v104, v4, 0
    v_dot2_f32_bf16 v29, v108, v4, 0
    v_dot2_f32_bf16 v30, v112, v4, 0
    v_dot2_f32_bf16 v31, v116, v4, 0
    v_dot2_f32_bf16 v8, v41, v5, v8
    v_dot2_f32_bf16 v9, v45, v5, v9
    v_dot2_f32_bf16 v10, v49, v5, v10
    v_dot2_f32_bf16 v11, v53, v5, v11
    v_dot2_f32_bf16 v24, v57, v5, v24
    v_dot2_f32_bf16 v25, v61, v5, v25
    v_dot2_f32_bf16 v26, v65, v5, v26
    v_dot2_f32_bf16 v27, v69, v5, v27
    v_dot2_f32_bf16 v28, v105, v5, v28
    v_dot2_f32_bf16 v29, v109, v5, v29
    v_dot2_f32_bf16 v30, v113, v5, v30
    v_dot2_f32_bf16 v31, v117, v5, v31
    v_dot2_f32_bf16 v8, v42, v6, v8
    v_dot2_f32_bf16 v9, v46, v6, v9
    v_dot2_f32_bf16 v10, v50, v6, v10
    v_dot2_f32_bf16 v11, v54, v6, v11
    v_dot2_f32_bf16 v24, v58, v6, v24
    v_dot2_f32_bf16 v25, v62, v6, v25
    v_dot2_f32_bf16 v26, v66, v6, v26
    v_dot2_f32_bf16 v27, v70, v6, v27
    v_dot2_f32_bf16 v28, v106, v6, v28
    v_dot2_f32_bf16 v29, v110, v6, v29
    v_dot2_f32_bf16 v30, v114, v6, v30
    v_dot2_f32_bf16 v31, v118, v6, v31
    v_dot2_f32_bf16 v8, v43, v7, v8
    v_dot2_f32_bf16 v9, v47, v7, v9
    v_dot2_f32_bf16 v10, v51, v7, v10
    v_dot2_f32_bf16 v11, v55, v7, v11
    v_dot2_f32_bf16 v24, v59, v7, v24
    v_dot2_f32_bf16 v25, v63, v7, v25
    v_dot2_f32_bf16 v26, v67, v7, v26
    v_dot2_f32_bf16 v27, v71, v7, v27
    v_dot2_f32_bf16 v28, v107, v7, v28
    v_dot2_f32_bf16 v29, v111, v7, v29
    v_dot2_f32_bf16 v30, v115, v7, v30
    v_dot2_f32_bf16 v31, v119, v7, v31
    v_add_f32_dpp v8, v8, v8 row_ror:8 row_mask:0xf bank_mask:0x3
    v_add_f32_dpp v10, v10, v10 row_ror:8 row_mask:0xf bank_mask:0x3
    v_add_f32_dpp v24, v24, v24 row_ror:8 row_mask:0xf bank_mask:0x3
    v_add_f32_dpp v26, v26, v26 row_ror:8 row_mask:0xf bank_mask:0x3
    v_add_f32_dpp v28, v28, v28 row_ror:8 row_mask:0xf bank_mask:0x3
    v_add_f32_dpp v30, v30, v30 row_ror:8 row_mask:0xf bank_mask:0x3
    v_add_f32_dpp v8, v9, v9 row_ror:8 row_mask:0xf bank_mask:0xc
    v_add_f32_dpp v10, v11, v11 row_ror:8 row_mask:0xf bank_mask:0xc
    v_add_f32_dpp v24, v25, v25 row_ror:8 row_mask:0xf bank_mask:0xc
    v_add_f32_dpp v26, v27, v27 row_ror:8 row_mask:0xf bank_mask:0xc
    v_add_f32_dpp v28, v29, v29 row_ror:8 row_mask:0xf bank_mask:0xc
    v_add_f32_dpp v30, v31, v31 row_ror:8 row_mask:0xf bank_mask:0xc
    v_add_f32_dpp v12, v8, v8 row_half_mirror row_mask:0xf bank_mask:0x5
    v_add_f32_dpp v13, v24, v24 row_half_mirror row_mask:0xf bank_mask:0x5
    v_add_f32_dpp v16, v28, v28 row_half_mirror row_mask:0xf bank_mask:0x5
    v_add_f32_dpp v12, v10, v10 row_half_mirror row_mask:0xf bank_mask:0xa
    v_add_f32_dpp v13, v26, v26 row_half_mirror row_mask:0xf bank_mask:0xa
    v_add_f32_dpp v16, v30, v30 row_half_mirror row_mask:0xf bank_mask:0xa
    v_add_f32_dpp v12, v12, v12 quad_perm:[1,0,3,2] row_mask:0xf bank_mask:0xf
    v_add_f32_dpp v13, v13, v13 quad_perm:[1,0,3,2] row_mask:0xf bank_mask:0xf
    v_add_f32_dpp v16, v16, v16 quad_perm:[1,0,3,2] row_mask:0xf bank_mask:0xf
    v_add_f32_dpp v12, v12, v12 quad_perm:[2,3,0,1] row_mask:0xf bank_mask:0xf
    v_add_f32_dpp v13, v13, v13 quad_perm:[2,3,0,1] row_mask:0xf bank_mask:0xf
    v_add_f32_dpp v16, v16, v16 quad_perm:[2,3,0,1] row_mask:0xf bank_mask:0xf
    s_waitcnt vmcnt(3)
    s_bitcmp0_b32 s14, 9
    s_cbranch_scc1 L_sf_68
    s_waitcnt vmcnt(2)
    s_bitcmp0_b32 s15, 9
    s_cbranch_scc1 L_sf_68
    s_waitcnt vmcnt(1)
L_sf_68:
    buffer_load_dwordx4 v[76:79], v1, s[52:55], s97 offen offset:1024 nt
    v_dot2_f32_bf16 v8, v120, v4, 0
    v_dot2_f32_bf16 v9, v124, v4, 0
    v_dot2_f32_bf16 v10, v128, v4, 0
    v_dot2_f32_bf16 v11, v132, v4, 0
    v_dot2_f32_bf16 v24, v136, v4, 0
    v_dot2_f32_bf16 v25, v140, v4, 0
    v_dot2_f32_bf16 v26, v144, v4, 0
    v_dot2_f32_bf16 v27, v148, v4, 0
    v_dot2_f32_bf16 v8, v121, v5, v8
    v_dot2_f32_bf16 v9, v125, v5, v9
    v_dot2_f32_bf16 v10, v129, v5, v10
    v_dot2_f32_bf16 v11, v133, v5, v11
    v_dot2_f32_bf16 v24, v137, v5, v24
    v_dot2_f32_bf16 v25, v141, v5, v25
    v_dot2_f32_bf16 v26, v145, v5, v26
    v_dot2_f32_bf16 v27, v149, v5, v27
    v_dot2_f32_bf16 v8, v122, v6, v8
    v_dot2_f32_bf16 v9, v126, v6, v9
    v_dot2_f32_bf16 v10, v130, v6, v10
    v_dot2_f32_bf16 v11, v134, v6, v11
    v_dot2_f32_bf16 v24, v138, v6, v24
    v_dot2_f32_bf16 v25, v142, v6, v25
    v_dot2_f32_bf16 v26, v146, v6, v26
    v_dot2_f32_bf16 v27, v150, v6, v27
    v_dot2_f32_bf16 v8, v123, v7, v8
    v_dot2_f32_bf16 v9, v127, v7, v9
    v_dot2_f32_bf16 v10, v131, v7, v10
    v_dot2_f32_bf16 v11, v135, v7, v11
    v_dot2_f32_bf16 v24, v139, v7, v24
    v_dot2_f32_bf16 v25, v143, v7, v25
    v_dot2_f32_bf16 v26, v147, v7, v26
    v_dot2_f32_bf16 v27, v151, v7, v27
    v_add_f32_dpp v8, v8, v8 row_ror:8 row_mask:0xf bank_mask:0x3
    v_add_f32_dpp v10, v10, v10 row_ror:8 row_mask:0xf bank_mask:0x3
    v_add_f32_dpp v24, v24, v24 row_ror:8 row_mask:0xf bank_mask:0x3
    v_add_f32_dpp v26, v26, v26 row_ror:8 row_mask:0xf bank_mask:0x3
    v_add_f32_dpp v8, v9, v9 row_ror:8 row_mask:0xf bank_mask:0xc
    v_add_f32_dpp v10, v11, v11 row_ror:8 row_mask:0xf bank_mask:0xc
    v_add_f32_dpp v24, v25, v25 row_ror:8 row_mask:0xf bank_mask:0xc
    v_add_f32_dpp v26, v27, v27 row_ror:8 row_mask:0xf bank_mask:0xc
    v_add_f32_dpp v17, v8, v8 row_half_mirror row_mask:0xf bank_mask:0x5
    v_add_f32_dpp v18, v24, v24 row_half_mirror row_mask:0xf bank_mask:0x5
    v_add_f32_dpp v17, v10, v10 row_half_mirror row_mask:0xf bank_mask:0xa
    v_add_f32_dpp v18, v26, v26 row_half_mirror row_mask:0xf bank_mask:0xa
    s_nop 0
    v_add_f32_dpp v17, v17, v17 quad_perm:[1,0,3,2] row_mask:0xf bank_mask:0xf
    v_add_f32_dpp v18, v18, v18 quad_perm:[1,0,3,2] row_mask:0xf bank_mask:0xf
    s_nop 0
    v_add_f32_dpp v17, v17, v17 quad_perm:[2,3,0,1] row_mask:0xf bank_mask:0xf
    v_add_f32_dpp v18, v18, v18 quad_perm:[2,3,0,1] row_mask:0xf bank_mask:0xf
    s_waitcnt vmcnt(3)
    s_bitcmp0_b32 s14, 10
    s_cbranch_scc1 L_sf_69
    s_waitcnt vmcnt(2)
    s_bitcmp0_b32 s15, 10
    s_cbranch_scc1 L_sf_69
    s_waitcnt vmcnt(1)
L_sf_69:
    buffer_load_dwordx4 v[80:83], v1, s[52:55], s97 offen offset:2048 nt
    s_waitcnt vmcnt(3)
    s_bitcmp0_b32 s14, 11
    s_cbranch_scc1 L_sf_70
    s_waitcnt vmcnt(2)
    s_bitcmp0_b32 s15, 11
    s_cbranch_scc1 L_sf_70
    s_waitcnt vmcnt(1)
L_sf_70:
    buffer_load_dwordx4 v[84:87], v1, s[52:55], s97 offen offset:3072 nt
    s_add_u32 s97, s97, 32768
    v_add_u32 v1, 4096, v1
    v_and_b32 v1, 0x7fff, v1
    s_cmp_eq_u32 s12, -1
    s_cbranch_scc1 L_nopfrd
    v_lshl_add_u32 v38, v0, 4, s12
    ds_read_b128 v[40:43], v38 offset:0
    ds_read_b128 v[44:47], v38 offset:1024
    ds_read_b128 v[48:51], v38 offset:2048
    ds_read_b128 v[52:55], v38 offset:3072
    ds_read_b128 v[56:59], v38 offset:4096
    ds_read_b128 v[60:63], v38 offset:5120
    ds_read_b128 v[64:67], v38 offset:6144
    ds_read_b128 v[68:71], v38 offset:7168
L_nopfrd:
    v_dot2_f32_bf16 v8, v152, v4, 0
    v_dot2_f32_bf16 v9, v156, v4, 0
    v_dot2_f32_bf16 v10, v160, v4, 0
    v_dot2_f32_bf16 v11, v164, v4, 0
    v_dot2_f32_bf16 v8, v153, v5, v8
    v_dot2_f32_bf16 v9, v157, v5, v9
    v_dot2_f32_bf16 v10, v161, v5, v10
    v_dot2_f32_bf16 v11, v165, v5, v11
    v_dot2_f32_bf16 v8, v154, v6, v8
    v_dot2_f32_bf16 v9, v158, v6, v9
    v_dot2_f32_bf16 v10, v162, v6, v10
    v_dot2_f32_bf16 v11, v166, v6, v11
    v_dot2_f32_bf16 v8, v155, v7, v8
    v_dot2_f32_bf16 v9, v159, v7, v9
    v_dot2_f32_bf16 v10, v163, v7, v10
    v_dot2_f32_bf16 v11, v167, v7, v11
    v_add_f32_dpp v8, v8, v8 row_ror:8 row_mask:0xf bank_mask:0x3
    s_nop 0
    v_add_f32_dpp v10, v10, v10 row_ror:8 row_mask:0xf bank_mask:0x3
    v_add_f32_dpp v8, v9, v9 row_ror:8 row_mask:0xf bank_mask:0xc
    v_add_f32_dpp v10, v11, v11 row_ror:8 row_mask:0xf bank_mask:0xc
    s_nop 0
    v_add_f32_dpp v19, v8, v8 row_half_mirror row_mask:0xf bank_mask:0x5
    v_add_f32_dpp v19, v10, v10 row_half_mirror row_mask:0xf bank_mask:0xa
    s_nop 1
    v_add_f32_dpp v19, v19, v19 quad_perm:[1,0,3,2] row_mask:0xf bank_mask:0xf
    s_nop 1
    v_add_f32_dpp v19, v19, v19 quad_perm:[2,3,0,1] row_mask:0xf bank_mask:0xf
    v_max3_f32 v3, v12, v13, v14
    v_max3_f32 v8, v15, v16, v17
    v_max3_f32 v3, v3, v18, v19
    v_max_f32 v3, v3, v8
    s_nop 1
    v_max_f32_dpp v3, v3, v3 row_ror:4 row_mask:0xf bank_mask:0xf
    s_nop 1
    v_max_f32_dpp v3, v3, v3 row_ror:8 row_mask:0xf bank_mask:0xf
    v_mov_b32 v8, v3
    s_nop 1
    v_permlane16_swap_b32 v3, v8
    v_max_f32 v3, v3, v8
    v_mov_b32 v8, v3
    s_nop 1
    v_permlane32_swap_b32 v3, v8
    v_max_f32 v3, v3, v8
    s_mov_b32 s96, 0x3e0293ee
    v_mul_f32 v8, s96, v3
    v_fma_f32 v12, v12, s96, -v8
    v_fma_f32 v13, v13, s96, -v8
    v_fma_f32 v14, v14, s96, -v8
    v_fma_f32 v15, v15, s96, -v8
    v_fma_f32 v16, v16, s96, -v8
    v_fma_f32 v17, v17, s96, -v8
    v_fma_f32 v18, v18, s96, -v8
    v_fma_f32 v19, v19, s96, -v8
    v_exp_f32 v12, v12
    v_exp_f32 v13, v13
    v_exp_f32 v14, v14
    v_exp_f32 v15, v15
    v_exp_f32 v16, v16
    v_exp_f32 v17, v17
    v_exp_f32 v18, v18
    v_exp_f32 v19, v19
    v_add_f32 v9, v12, v13
    v_add_f32 v10, v14, v15
    v_add_f32 v11, v16, v17
    v_add_f32 v3, v18, v19
    v_add_f32 v9, v9, v10
    v_add_f32 v3, v3, v11
    v_add_f32 v9, v9, v3
    v_cvt_pk_bf16_f32 v12, v12, v12
    v_cvt_pk_bf16_f32 v13, v13, v13
    v_cvt_pk_bf16_f32 v14, v14, v14
    v_cvt_pk_bf16_f32 v15, v15, v15
    v_cvt_pk_bf16_f32 v16, v16, v16
    v_cvt_pk_bf16_f32 v17, v17, v17
    v_cvt_pk_bf16_f32 v18, v18, v18
    v_cvt_pk_bf16_f32 v19, v19, v19
    v_add_f32_dpp v9, v9, v9 row_ror:4 row_mask:0xf bank_mask:0xf
    s_nop 1
    v_add_f32_dpp v9, v9, v9 row_ror:8 row_mask:0xf bank_mask:0xf
    v_mov_b32 v10, v9
    s_nop 1
    v_permlane16_swap_b32 v9, v10
    v_add_f32 v9, v9, v10
    v_mov_b32 v10, v9
    s_nop 1
    v_permlane32_swap_b32 v9, v10
    v_add_f32 v9, v9, v10
    s_mov_b64 exec, 1
    s_cmp_lg_u32 s13, 0
    s_cbranch_scc1 L_mljob
    s_lshl_b32 s96, s3, 3
    s_add_u32 s96, s96, 161920
    v_mov_b32 v10, s96
    v_mov_b32 v11, 162068
    v_mov_b32 v3, 1
    ds_write_b64 v10, v[8:9]
    ds_add_u32 v11, v3
L_mldone:
    s_mov_b64 exec, -1
    v_lshrrev_b32 v2, 1, v2
    v_and_b32_dpp v24, v14, v20 row_newbcast:0 row_mask:0xf bank_mask:0xf
    v_and_b32_dpp v25, v14, v21 row_newbcast:0 row_mask:0xf bank_mask:0xf
    v_and_b32_dpp v26, v14, v22 row_newbcast:0 row_mask:0xf bank_mask:0xf
    v_and_b32_dpp v27, v14, v23 row_newbcast:0 row_mask:0xf bank_mask:0xf
    s_waitcnt vmcnt(3)
    s_bitcmp0_b32 s14, 12
    s_cbranch_scc1 L_sf_71
    s_waitcnt vmcnt(2)
    s_bitcmp0_b32 s15, 12
    s_cbranch_scc1 L_sf_71
    s_waitcnt vmcnt(1)
L_sf_71:
    buffer_load_dwordx4 v[88:91], v1, s[52:55], s97 offen offset:0 nt
    v_mfma_f32_16x16x32_bf16 v[32:35], v[24:27], v[72:75], v[32:35]
    s_cmp_eq_u32 s12, -1
    s_cbranch_scc1 L_nopfpv8
    s_waitcnt lgkmcnt(0)
    v_and_b32_dpp v24, v12, v20 row_newbcast:0 row_mask:0xf bank_mask:0xf
    v_and_b32_dpp v25, v12, v21 row_newbcast:0 row_mask:0xf bank_mask:0xf
    v_and_b32_dpp v26, v12, v22 row_newbcast:0 row_mask:0xf bank_mask:0xf
    v_and_b32_dpp v27, v12, v23 row_newbcast:0 row_mask:0xf bank_mask:0xf
    s_nop 1
    v_mfma_f32_16x16x32_bf16 v[32:35], v[24:27], v[40:43], v[32:35]
    v_and_b32_dpp v28, v12, v20 row_newbcast:8 row_mask:0xf bank_mask:0xf
    v_and_b32_dpp v29, v12, v21 row_newbcast:8 row_mask:0xf bank_mask:0xf
    v_and_b32_dpp v30, v12, v22 row_newbcast:8 row_mask:0xf bank_mask:0xf
    v_and_b32_dpp v31, v12, v23 row_newbcast:8 row_mask:0xf bank_mask:0xf
    s_nop 1
    v_mfma_f32_16x16x32_bf16 v[32:35], v[28:31], v[44:47], v[32:35]
    v_and_b32_dpp v24, v12, v20 row_newbcast:4 row_mask:0xf bank_mask:0xf
    v_and_b32_dpp v25, v12, v21 row_newbcast:4 row_mask:0xf bank_mask:0xf
    v_and_b32_dpp v26, v12, v22 row_newbcast:4 row_mask:0xf bank_mask:0xf
    v_and_b32_dpp v27, v12, v23 row_newbcast:4 row_mask:0xf bank_mask:0xf
    s_nop 1
    v_mfma_f32_16x16x32_bf16 v[32:35], v[24:27], v[48:51], v[32:35]
    v_and_b32_dpp v28, v12, v20 row_newbcast:12 row_mask:0xf bank_mask:0xf
    v_and_b32_dpp v29, v12, v21 row_newbcast:12 row_mask:0xf bank_mask:0xf
    v_and_b32_dpp v30, v12, v22 row_newbcast:12 row_mask:0xf bank_mask:0xf
    v_and_b32_dpp v31, v12, v23 row_newbcast:12 row_mask:0xf bank_mask:0xf
    s_nop 1
    v_mfma_f32_16x16x32_bf16 v[32:35], v[28:31], v[52:55], v[32:35]
L_nopfpv8:
    v_and_b32_dpp v28, v14, v20 row_newbcast:8 row_mask:0xf bank_mask:0xf
    v_and_b32_dpp v29, v14, v21 row_newbcast:8 row_mask:0xf bank_mask:0xf
    v_and_b32_dpp v30, v14, v22 row_newbcast:8 row_mask:0xf bank_mask:0xf
    v_and_b32_dpp v31, v14, v23 row_newbcast:8 row_mask:0xf bank_mask:0xf
    s_waitcnt vmcnt(3)
    s_bitcmp0_b32 s14, 13
    s_cbranch_scc1 L_sf_72
    s_waitcnt vmcnt(2)
    s_bitcmp0_b32 s15, 13
    s_cbranch_scc1 L_sf_72
    s_waitcnt vmcnt(1)
L_sf_72:
    buffer_load_dwordx4 v[92:95], v1, s[52:55], s97 offen offset:1024 nt
    v_mfma_f32_16x16x32_bf16 v[32:35], v[28:31], v[76:79], v[32:35]
    s_cmp_eq_u32 s12, -1
    s_cbranch_scc1 L_nopfpv9
    s_waitcnt lgkmcnt(0)
    v_and_b32_dpp v24, v13, v20 row_newbcast:0 row_mask:0xf bank_mask:0xf
    v_and_b32_dpp v25, v13, v21 row_newbcast:0 row_mask:0xf bank_mask:0xf
    v_and_b32_dpp v26, v13, v22 row_newbcast:0 row_mask:0xf bank_mask:0xf
    v_and_b32_dpp v27, v13, v23 row_newbcast:0 row_mask:0xf bank_mask:0xf
    s_nop 1
    v_mfma_f32_16x16x32_bf16 v[32:35], v[24:27], v[56:59], v[32:35]
    v_and_b32_dpp v28, v13, v20 row_newbcast:8 row_mask:0xf bank_mask:0xf
    v_and_b32_dpp v29, v13, v21 row_newbcast:8 row_mask:0xf bank_mask:0xf
    v_and_b32_dpp v30, v13, v22 row_newbcast:8 row_mask:0xf bank_mask:0xf
    v_and_b32_dpp v31, v13, v23 row_newbcast:8 row_mask:0xf bank_mask:0xf
    s_nop 1
    v_mfma_f32_16x16x32_bf16 v[32:35], v[28:31], v[60:63], v[32:35]
    v_and_b32_dpp v24, v13, v20 row_newbcast:4 row_mask:0xf bank_mask:0xf
    v_and_b32_dpp v25, v13, v21 row_newbcast:4 row_mask:0xf bank_mask:0xf
    v_and_b32_dpp v26, v13, v22 row_newbcast:4 row_mask:0xf bank_mask:0xf
    v_and_b32_dpp v27, v13, v23 row_newbcast:4 row_mask:0xf bank_mask:0xf
    s_nop 1
    v_mfma_f32_16x16x32_bf16 v[32:35], v[24:27], v[64:67], v[32:35]
    v_and_b32_dpp v28, v13, v20 row_newbcast:12 row_mask:0xf bank_mask:0xf
    v_and_b32_dpp v29, v13, v21 row_newbcast:12 row_mask:0xf bank_mask:0xf
    v_and_b32_dpp v30, v13, v22 row_newbcast:12 row_mask:0xf bank_mask:0xf
    v_and_b32_dpp v31, v13, v23 row_newbcast:12 row_mask:0xf bank_mask:0xf
    s_nop 1
    v_mfma_f32_16x16x32_bf16 v[32:35], v[28:31], v[68:71], v[32:35]
L_nopfpv9:
    v_and_b32_dpp v24, v14, v20 row_newbcast:4 row_mask:0xf bank_mask:0xf
    v_and_b32_dpp v25, v14, v21 row_newbcast:4 row_mask:0xf bank_mask:0xf
    v_and_b32_dpp v26, v14, v22 row_newbcast:4 row_mask:0xf bank_mask:0xf
    v_and_b32_dpp v27, v14, v23 row_newbcast:4 row_mask:0xf bank_mask:0xf
    s_waitcnt vmcnt(3)
    s_bitcmp0_b32 s14, 14
    s_cbranch_scc1 L_sf_73
    s_waitcnt vmcnt(2)
    s_bitcmp0_b32 s15, 14
    s_cbranch_scc1 L_sf_73
    s_waitcnt vmcnt(1)
L_sf_73:
    buffer_load_dwordx4 v[96:99], v1, s[52:55], s97 offen offset:2048 nt
    v_mfma_f32_16x16x32_bf16 v[32:35], v[24:27], v[80:83], v[32:35]
    v_and_b32_dpp v28, v14, v20 row_newbcast:12 row_mask:0xf bank_mask:0xf
    v_and_b32_dpp v29, v14, v21 row_newbcast:12 row_mask:0xf bank_mask:0xf
    v_and_b32_dpp v30, v14, v22 row_newbcast:12 row_mask:0xf bank_mask:0xf
    v_and_b32_dpp v31, v14, v23 row_newbcast:12 row_mask:0xf bank_mask:0xf
    s_waitcnt vmcnt(3)
    s_bitcmp0_b32 s14, 15
    s_cbranch_scc1 L_sf_74
    s_waitcnt vmcnt(2)
    s_bitcmp0_b32 s15, 15
    s_cbranch_scc1 L_sf_74
    s_waitcnt vmcnt(1)
L_sf_74:
    buffer_load_dwordx4 v[100:103], v1, s[52:55], s97 offen offset:3072 nt
    s_add_u32 s97, s97, 32768
    v_add_u32 v1, 4096, v1
    v_and_b32 v1, 0x7fff, v1
    v_mfma_f32_16x16x32_bf16 v[32:35], v[28:31], v[84:87], v[32:35]
    v_and_b32_dpp v24, v15, v20 row_newbcast:0 row_mask:0xf bank_mask:0xf
    v_and_b32_dpp v25, v15, v21 row_newbcast:0 row_mask:0xf bank_mask:0xf
    v_and_b32_dpp v26, v15, v22 row_newbcast:0 row_mask:0xf bank_mask:0xf
    v_and_b32_dpp v27, v15, v23 row_newbcast:0 row_mask:0xf bank_mask:0xf
    s_waitcnt vmcnt(3)
    s_bitcmp0_b32 s14, 16
    s_cbranch_scc1 L_sf_75
    s_waitcnt vmcnt(2)
    s_bitcmp0_b32 s15, 16
    s_cbranch_scc1 L_sf_75
    s_waitcnt vmcnt(1)
L_sf_75:
    buffer_load_dwordx4 v[104:107], v1, s[52:55], s97 offen offset:0 nt
    v_mfma_f32_16x16x32_bf16 v[32:35], v[24:27], v[88:91], v[32:35]
    v_and_b32_dpp v28, v15, v20 row_newbcast:8 row_mask:0xf bank_mask:0xf
    v_and_b32_dpp v29, v15, v21 row_newbcast:8 row_mask:0xf bank_mask:0xf
    v_and_b32_dpp v30, v15, v22 row_newbcast:8 row_mask:0xf bank_mask:0xf
    v_and_b32_dpp v31, v15, v23 row_newbcast:8 row_mask:0xf bank_mask:0xf
    s_waitcnt vmcnt(3)
    s_bitcmp0_b32 s14, 17
    s_cbranch_scc1 L_sf_76
    s_waitcnt vmcnt(2)
    s_bitcmp0_b32 s15, 17
    s_cbranch_scc1 L_sf_76
    s_waitcnt vmcnt(1)
L_sf_76:
    buffer_load_dwordx4 v[108:111], v1, s[52:55], s97 offen offset:1024 nt
    v_mfma_f32_16x16x32_bf16 v[32:35], v[28:31], v[92:95], v[32:35]
    v_and_b32_dpp v24, v15, v20 row_newbcast:4 row_mask:0xf bank_mask:0xf
    v_and_b32_dpp v25, v15, v21 row_newbcast:4 row_mask:0xf bank_mask:0xf
    v_and_b32_dpp v26, v15, v22 row_newbcast:4 row_mask:0xf bank_mask:0xf
    v_and_b32_dpp v27, v15, v23 row_newbcast:4 row_mask:0xf bank_mask:0xf
    s_waitcnt vmcnt(3)
    s_bitcmp0_b32 s14, 18
    s_cbranch_scc1 L_sf_77
    s_waitcnt vmcnt(2)
    s_bitcmp0_b32 s15, 18
    s_cbranch_scc1 L_sf_77
    s_waitcnt vmcnt(1)
L_sf_77:
    buffer_load_dwordx4 v[112:115], v1, s[52:55], s97 offen offset:2048 nt
    v_mfma_f32_16x16x32_bf16 v[32:35], v[24:27], v[96:99], v[32:35]
    v_and_b32_dpp v28, v15, v20 row_newbcast:12 row_mask:0xf bank_mask:0xf
    v_and_b32_dpp v29, v15, v21 row_newbcast:12 row_mask:0xf bank_mask:0xf
    v_and_b32_dpp v30, v15, v22 row_newbcast:12 row_mask:0xf bank_mask:0xf
    v_and_b32_dpp v31, v15, v23 row_newbcast:12 row_mask:0xf bank_mask:0xf
    s_waitcnt vmcnt(3)
    s_bitcmp0_b32 s14, 19
    s_cbranch_scc1 L_sf_78
    s_waitcnt vmcnt(2)
    s_bitcmp0_b32 s15, 19
    s_cbranch_scc1 L_sf_78
    s_waitcnt vmcnt(1)
L_sf_78:
    buffer_load_dwordx4 v[116:119], v1, s[52:55], s97 offen offset:3072 nt
    s_add_u32 s97, s97, 32768
    v_add_u32 v1, 4096, v1
    v_and_b32 v1, 0x7fff, v1
    v_mfma_f32_16x16x32_bf16 v[32:35], v[28:31], v[100:103], v[32:35]
    v_and_b32_dpp v24, v16, v20 row_newbcast:0 row_mask:0xf bank_mask:0xf
    v_and_b32_dpp v25, v16, v21 row_newbcast:0 row_mask:0xf bank_mask:0xf
    v_and_b32_dpp v26, v16, v22 row_newbcast:0 row_mask:0xf bank_mask:0xf
    v_and_b32_dpp v27, v16, v23 row_newbcast:0 row_mask:0xf bank_mask:0xf
    s_waitcnt vmcnt(3)
    s_bitcmp0_b32 s14, 20
    s_cbranch_scc1 L_sf_79
    s_waitcnt vmcnt(2)
    s_bitcmp0_b32 s15, 20
    s_cbranch_scc1 L_sf_79
    s_waitcnt vmcnt(1)
L_sf_79:
    buffer_load_dwordx4 v[120:123], v1, s[52:55], s97 offen offset:0 nt
    v_mfma_f32_16x16x32_bf16 v[32:35], v[24:27], v[104:107], v[32:35]
    v_and_b32_dpp v28, v16, v20 row_newbcast:8 row_mask:0xf bank_mask:0xf
    v_and_b32_dpp v29, v16, v21 row_newbcast:8 row_mask:0xf bank_mask:0xf
    v_and_b32_dpp v30, v16, v22 row_newbcast:8 row_mask:0xf bank_mask:0xf
    v_and_b32_dpp v31, v16, v23 row_newbcast:8 row_mask:0xf bank_mask:0xf
    s_waitcnt vmcnt(3)
    s_bitcmp0_b32 s14, 21
    s_cbranch_scc1 L_sf_80
    s_waitcnt vmcnt(2)
    s_bitcmp0_b32 s15, 21
    s_cbranch_scc1 L_sf_80
    s_waitcnt vmcnt(1)
L_sf_80:
    buffer_load_dwordx4 v[124:127], v1, s[52:55], s97 offen offset:1024 nt
    v_mfma_f32_16x16x32_bf16 v[32:35], v[28:31], v[108:111], v[32:35]
    v_and_b32_dpp v24, v16, v20 row_newbcast:4 row_mask:0xf bank_mask:0xf
    v_and_b32_dpp v25, v16, v21 row_newbcast:4 row_mask:0xf bank_mask:0xf
    v_and_b32_dpp v26, v16, v22 row_newbcast:4 row_mask:0xf bank_mask:0xf
    v_and_b32_dpp v27, v16, v23 row_newbcast:4 row_mask:0xf bank_mask:0xf
    s_waitcnt vmcnt(3)
    s_bitcmp0_b32 s14, 22
    s_cbranch_scc1 L_sf_81
    s_waitcnt vmcnt(2)
    s_bitcmp0_b32 s15, 22
    s_cbranch_scc1 L_sf_81
    s_waitcnt vmcnt(1)
L_sf_81:
    buffer_load_dwordx4 v[128:131], v1, s[52:55], s97 offen offset:2048 nt
    v_mfma_f32_16x16x32_bf16 v[32:35], v[24:27], v[112:115], v[32:35]
    v_and_b32_dpp v28, v16, v20 row_newbcast:12 row_mask:0xf bank_mask:0xf
    v_and_b32_dpp v29, v16, v21 row_newbcast:12 row_mask:0xf bank_mask:0xf
    v_and_b32_dpp v30, v16, v22 row_newbcast:12 row_mask:0xf bank_mask:0xf
    v_and_b32_dpp v31, v16, v23 row_newbcast:12 row_mask:0xf bank_mask:0xf
    s_waitcnt vmcnt(3)
    s_bitcmp0_b32 s14, 23
    s_cbranch_scc1 L_sf_82
    s_waitcnt vmcnt(2)
    s_bitcmp0_b32 s15, 23
    s_cbranch_scc1 L_sf_82
    s_waitcnt vmcnt(1)
L_sf_82:
    buffer_load_dwordx4 v[132:135], v1, s[52:55], s97 offen offset:3072 nt
    s_add_u32 s97, s97, 32768
    v_add_u32 v1, 4096, v1
    v_and_b32 v1, 0x7fff, v1
    v_mfma_f32_16x16x32_bf16 v[32:35], v[28:31], v[116:119], v[32:35]
    v_and_b32_dpp v24, v17, v20 row_newbcast:0 row_mask:0xf bank_mask:0xf
    v_and_b32_dpp v25, v17, v21 row_newbcast:0 row_mask:0xf bank_mask:0xf
    v_and_b32_dpp v26, v17, v22 row_newbcast:0 row_mask:0xf bank_mask:0xf
    v_and_b32_dpp v27, v17, v23 row_newbcast:0 row_mask:0xf bank_mask:0xf
    s_waitcnt vmcnt(3)
    s_bitcmp0_b32 s14, 24
    s_cbranch_scc1 L_sf_83
    s_waitcnt vmcnt(2)
    s_bitcmp0_b32 s15, 24
    s_cbranch_scc1 L_sf_83
    s_waitcnt vmcnt(1)
L_sf_83:
    buffer_load_dwordx4 v[136:139], v1, s[52:55], s97 offen offset:0 nt
    v_mfma_f32_16x16x32_bf16 v[32:35], v[24:27], v[120:123], v[32:35]
    s_or_b32 s96, s59, 0
    s_cbranch_scc0 L_nofrag_84
    v_mov_b32 v104, 162060
L_lw_85:
    ds_read_b32 v105, v104
    s_waitcnt lgkmcnt(0)
    v_cmp_gt_u32 vcc, 4, v105
    s_cbranch_vccz L_lw_85e
    s_sleep 2
    s_sub_u32 s60, s60, 1
    s_cbranch_scc0 L_lw_85
    s_mov_b32 s60, 0
L_lw_85e:
    s_cmp_eq_u32 s59, 0
    s_cbranch_scc1 L_nofrag_84
    v_bfe_u32 v104, v0, 2, 1
    v_bfe_u32 v110, v0, 4, 1
    v_lshl_add_u32 v104, v110, 2, v104
    v_and_b32 v110, 8, v0
    v_add_u32 v104, v104, v110
    v_lshrrev_b32 v110, 5, v0
    v_lshl_add_u32 v104, v110, 4, v104
    v_bfe_u32 v111, v0, 0, 1
    v_mul_u32_u24 v111, 0xaaaa, v111
    v_add_u32 v111, 0x4444, v111
    v_mov_b32 v112, 0
    v_mov_b32 v113, 0
    v_mov_b32 v114, 0
    v_mov_b32 v115, 0
    v_mov_b32 v116, 0
    v_mov_b32 v117, 0
    v_mov_b32 v118, 0
    v_mov_b32 v119, 0
    v_lshlrev_b32 v104, 7, v104
    v_and_b32 v110, 3, v0
    v_lshl_add_u32 v104, v110, 3, v104
    v_lshrrev_b32 v109, 4, v0
    v_and_b32 v110, 1, v0
    s_lshr_b32 s63, s3, 1
    s_and_b32 s62, s3, 1
    s_lshl_b32 s96, s63, 14
    s_lshl_b32 s100, s62, 6
    s_add_u32 s100, s100, 81920
    s_add_u32 s96, s96, s100
    v_add_u32 v104, s96, v104
    ds_read_b64_tr_b16 v[72:73], v104 offset:0
    ds_read_b64_tr_b16 v[74:75], v104 offset:256
    ds_read_b64_tr_b16 v[76:77], v104 offset:4096
    ds_read_b64_tr_b16 v[78:79], v104 offset:4352
    ds_read_b64_tr_b16 v[80:81], v104 offset:32
    ds_read_b64_tr_b16 v[82:83], v104 offset:288
    ds_read_b64_tr_b16 v[84:85], v104 offset:4128
    ds_read_b64_tr_b16 v[86:87], v104 offset:4384
    ds_read_b64_tr_b16 v[88:89], v104 offset:8192
    ds_read_b64_tr_b16 v[90:91], v104 offset:8448
    ds_read_b64_tr_b16 v[92:93], v104 offset:12288
    ds_read_b64_tr_b16 v[94:95], v104 offset:12544
    ds_read_b64_tr_b16 v[96:97], v104 offset:8224
    ds_read_b64_tr_b16 v[98:99], v104 offset:8480
    ds_read_b64_tr_b16 v[100:101], v104 offset:12320
    ds_read_b64_tr_b16 v[102:103], v104 offset:12576
    v_bfe_u32 v105, v0, 1, 3
    v_lshlrev_b32 v105, 8, v105
    v_lshl_add_u32 v105, v109, 5, v105
    v_lshl_add_u32 v105, v110, 4, v105
    v_lshrrev_b32 v106, 3, v0
    v_lshlrev_b32 v106, 7, v106
    v_and_b32 v110, 7, v0
    v_lshl_add_u32 v107, v110, 3, v106
    v_add_u32 v107, s100, v107
    v_lshlrev_b32 v106, 8, v109
    v_and_b32 v110, 15, v0
    v_lshl_add_u32 v106, v110, 2, v106
    v_add_u32 v106, s96, v106
    v_lshlrev_b32 v108, 2, v0
    s_lshl_b32 s96, s62, 2
    s_add_u32 s96, s96, 162088
    v_mov_b32 v109, s96
    s_lshl_b32 s100, s63, 11
    s_lshl_b32 s96, s34, 13
    s_add_u32 s100, s100, s96
    s_add_u32 s100, s100, 106496
    s_mul_i32 s101, s34, 5120
    s_lshl_b32 s96, s35, 9
    s_add_u32 s101, s101, s96
    s_lshl_b32 s96, s62, 8
    s_add_u32 s101, s101, s96
    s_sub_u32 s101, s101, 11264
    s_and_b32 s96, s101, 0xffffe000
    s_add_u32 s101, s101, s96
    s_add_u32 s101, s101, 212992
    v_add_u32 v110, 8192, v108
L_nofrag_84:
    v_and_b32_dpp v28, v17, v20 row_newbcast:8 row_mask:0xf bank_mask:0xf
    v_and_b32_dpp v29, v17, v21 row_newbcast:8 row_mask:0xf bank_mask:0xf
    v_and_b32_dpp v30, v17, v22 row_newbcast:8 row_mask:0xf bank_mask:0xf
    v_and_b32_dpp v31, v17, v23 row_newbcast:8 row_mask:0xf bank_mask:0xf
    s_waitcnt vmcnt(3)
    s_bitcmp0_b32 s14, 25
    s_cbranch_scc1 L_sf_86
    s_waitcnt vmcnt(2)
    s_bitcmp0_b32 s15, 25
    s_cbranch_scc1 L_sf_86
    s_waitcnt vmcnt(1)
L_sf_86:
    buffer_load_dwordx4 v[140:143], v1, s[52:55], s97 offen offset:1024 nt
    v_mfma_f32_16x16x32_bf16 v[32:35], v[28:31], v[124:127], v[32:35]
    v_and_b32_dpp v24, v17, v20 row_newbcast:4 row_mask:0xf bank_mask:0xf
    v_and_b32_dpp v25, v17, v21 row_newbcast:4 row_mask:0xf bank_mask:0xf
    v_and_b32_dpp v26, v17, v22 row_newbcast:4 row_mask:0xf bank_mask:0xf
    v_and_b32_dpp v27, v17, v23 row_newbcast:4 row_mask:0xf bank_mask:0xf
    s_waitcnt vmcnt(3)
    s_bitcmp0_b32 s14, 26
    s_cbranch_scc1 L_sf_87
    s_waitcnt vmcnt(2)
    s_bitcmp0_b32 s15, 26
    s_cbranch_scc1 L_sf_87
    s_waitcnt vmcnt(1)
L_sf_87:
    buffer_load_dwordx4 v[144:147], v1, s[52:55], s97 offen offset:2048 nt
    v_mfma_f32_16x16x32_bf16 v[32:35], v[24:27], v[128:131], v[32:35]
    v_and_b32_dpp v28, v17, v20 row_newbcast:12 row_mask:0xf bank_mask:0xf
    v_and_b32_dpp v29, v17, v21 row_newbcast:12 row_mask:0xf bank_mask:0xf
    v_and_b32_dpp v30, v17, v22 row_newbcast:12 row_mask:0xf bank_mask:0xf
    v_and_b32_dpp v31, v17, v23 row_newbcast:12 row_mask:0xf bank_mask:0xf
    s_waitcnt vmcnt(3)
    s_bitcmp0_b32 s14, 27
    s_cbranch_scc1 L_sf_88
    s_waitcnt vmcnt(2)
    s_bitcmp0_b32 s15, 27
    s_cbranch_scc1 L_sf_88
    s_waitcnt vmcnt(1)
L_sf_88:
    buffer_load_dwordx4 v[148:151], v1, s[52:55], s97 offen offset:3072 nt
    s_add_u32 s97, s97, 32768
    v_add_u32 v1, 4096, v1
    v_and_b32 v1, 0x7fff, v1
    v_mfma_f32_16x16x32_bf16 v[32:35], v[28:31], v[132:135], v[32:35]
    v_and_b32_dpp v24, v18, v20 row_newbcast:0 row_mask:0xf bank_mask:0xf
    v_and_b32_dpp v25, v18, v21 row_newbcast:0 row_mask:0xf bank_mask:0xf
    v_and_b32_dpp v26, v18, v22 row_newbcast:0 row_mask:0xf bank_mask:0xf
    v_and_b32_dpp v27, v18, v23 row_newbcast:0 row_mask:0xf bank_mask:0xf
    s_waitcnt vmcnt(3)
    s_bitcmp0_b32 s14, 28
    s_cbranch_scc1 L_sf_89
    s_waitcnt vmcnt(2)
    s_bitcmp0_b32 s15, 28
    s_cbranch_scc1 L_sf_89
    s_waitcnt vmcnt(1)
L_sf_89:
    buffer_load_dwordx4 v[152:155], v1, s[52:55], s97 offen offset:0 nt
    v_mfma_f32_16x16x32_bf16 v[32:35], v[24:27], v[136:139], v[32:35]
    v_mov_b32 v10, 162076
    v_mov_b32 v11, 1
    s_mov_b64 exec, 1
    ds_add_u32 v10, v11
    s_mov_b64 exec, -1
    v_and_b32_dpp v28, v18, v20 row_newbcast:8 row_mask:0xf bank_mask:0xf
    v_and_b32_dpp v29, v18, v21 row_newbcast:8 row_mask:0xf bank_mask:0xf
    v_and_b32_dpp v30, v18, v22 row_newbcast:8 row_mask:0xf bank_mask:0xf
    v_and_b32_dpp v31, v18, v23 row_newbcast:8 row_mask:0xf bank_mask:0xf
    s_waitcnt vmcnt(3)
    s_bitcmp0_b32 s14, 29
    s_cbranch_scc1 L_sf_90
    s_waitcnt vmcnt(2)
    s_bitcmp0_b32 s15, 29
    s_cbranch_scc1 L_sf_90
    s_waitcnt vmcnt(1)
L_sf_90:
    buffer_load_dwordx4 v[156:159], v1, s[52:55], s97 offen offset:1024 nt
    v_mfma_f32_16x16x32_bf16 v[32:35], v[28:31], v[140:143], v[32:35]
    v_and_b32_dpp v24, v18, v20 row_newbcast:4 row_mask:0xf bank_mask:0xf
    v_and_b32_dpp v25, v18, v21 row_newbcast:4 row_mask:0xf bank_mask:0xf
    v_and_b32_dpp v26, v18, v22 row_newbcast:4 row_mask:0xf bank_mask:0xf
    v_and_b32_dpp v27, v18, v23 row_newbcast:4 row_mask:0xf bank_mask:0xf
    s_waitcnt vmcnt(3)
    s_bitcmp0_b32 s14, 30
    s_cbranch_scc1 L_sf_91
    s_waitcnt vmcnt(2)
    s_bitcmp0_b32 s15, 30
    s_cbranch_scc1 L_sf_91
    s_waitcnt vmcnt(1)
L_sf_91:
    buffer_load_dwordx4 v[160:163], v1, s[52:55], s97 offen offset:2048 nt
    v_mfma_f32_16x16x32_bf16 v[32:35], v[24:27], v[144:147], v[32:35]
    v_lshrrev_b32 v9, 4, v0
    v_lshl_add_u32 v8, v9, 2, v2
    s_lshl_b32 s96, s3, 9
    s_add_u32 s96, s96, 157824
    v_lshl_add_u32 v8, v8, 2, s96
    v_lshlrev_b32 v9, 3, v0
    v_add_u32 v9, 157824, v9
    v_mov_b32 v10, 162048
    v_mov_b32 v11, 1
    s_lshl_b32 s96, s38, 5
    s_add_u32 s96, s96, 161984
    v_mov_b32 v3, s96
    s_sub_u32 s62, 8, s39
    s_lshl_b32 s98, s34, 5
    s_add_u32 s98, s98, s35
    s_lshl_b32 s98, s98, 8
    s_add_u32 s98, s98, 106496
    v_lshlrev_b32 v39, 2, v0
    v_and_b32_dpp v28, v18, v20 row_newbcast:12 row_mask:0xf bank_mask:0xf
    v_and_b32_dpp v29, v18, v21 row_newbcast:12 row_mask:0xf bank_mask:0xf
    v_and_b32_dpp v30, v18, v22 row_newbcast:12 row_mask:0xf bank_mask:0xf
    v_and_b32_dpp v31, v18, v23 row_newbcast:12 row_mask:0xf bank_mask:0xf
    s_waitcnt vmcnt(3)
    s_bitcmp0_b32 s14, 31
    s_cbranch_scc1 L_sf_92
    s_waitcnt vmcnt(2)
    s_bitcmp0_b32 s15, 31
    s_cbranch_scc1 L_sf_92
    s_waitcnt vmcnt(1)
L_sf_92:
    buffer_load_dwordx4 v[164:167], v1, s[52:55], s97 offen offset:3072 nt
    s_mov_b32 s97, 0
    v_add_u32 v1, 4096, v1
    v_and_b32 v1, 0x7fff, v1
    v_mfma_f32_16x16x32_bf16 v[32:35], v[28:31], v[148:151], v[32:35]
    s_cmp_eq_u32 s12, -1
    s_cbranch_scc1 L_v_nopf
    v_and_b32_dpp v24, v19, v20 row_newbcast:0 row_mask:0xf bank_mask:0xf
    v_and_b32_dpp v25, v19, v21 row_newbcast:0 row_mask:0xf bank_mask:0xf
    v_and_b32_dpp v26, v19, v22 row_newbcast:0 row_mask:0xf bank_mask:0xf
    v_and_b32_dpp v27, v19, v23 row_newbcast:0 row_mask:0xf bank_mask:0xf
    s_waitcnt vmcnt(3)
    s_nop 0
    v_mfma_f32_16x16x32_bf16 v[32:35], v[24:27], v[152:155], v[32:35]
    v_and_b32_dpp v28, v19, v20 row_newbcast:8 row_mask:0xf bank_mask:0xf
    v_and_b32_dpp v29, v19, v21 row_newbcast:8 row_mask:0xf bank_mask:0xf
    v_and_b32_dpp v30, v19, v22 row_newbcast:8 row_mask:0xf bank_mask:0xf
    v_and_b32_dpp v31, v19, v23 row_newbcast:8 row_mask:0xf bank_mask:0xf
    s_waitcnt vmcnt(2)
    s_nop 0
    v_mfma_f32_16x16x32_bf16 v[32:35], v[28:31], v[156:159], v[32:35]
    v_and_b32_dpp v24, v19, v20 row_newbcast:4 row_mask:0xf bank_mask:0xf
    v_and_b32_dpp v25, v19, v21 row_newbcast:4 row_mask:0xf bank_mask:0xf
    v_and_b32_dpp v26, v19, v22 row_newbcast:4 row_mask:0xf bank_mask:0xf
    v_and_b32_dpp v27, v19, v23 row_newbcast:4 row_mask:0xf bank_mask:0xf
    s_waitcnt vmcnt(1)
    s_nop 0
    v_mfma_f32_16x16x32_bf16 v[32:35], v[24:27], v[160:163], v[32:35]
    v_and_b32_dpp v28, v19, v20 row_newbcast:12 row_mask:0xf bank_mask:0xf
    v_and_b32_dpp v29, v19, v21 row_newbcast:12 row_mask:0xf bank_mask:0xf
    v_and_b32_dpp v30, v19, v22 row_newbcast:12 row_mask:0xf bank_mask:0xf
    v_and_b32_dpp v31, v19, v23 row_newbcast:12 row_mask:0xf bank_mask:0xf
    s_waitcnt vmcnt(0)
    s_nop 0
    v_mfma_f32_16x16x32_bf16 v[32:35], v[28:31], v[164:167], v[32:35]
L_v_join:
    s_cmp_lg_u32 s13, 0
    s_cbranch_scc1 L_jobend
L_t0:
    s_mov_b32 exec_hi, 0
    s_nop 4
    ds_write_b128 v8, v[32:35]
L_t0b:
    s_mov_b64 exec, 1
    ds_add_rtn_u32 v37, v10, v11
    s_mov_b64 exec, -1
    ds_read_b32 v38, v10 offset:24
    ds_read_b128 v[24:27], v3
    ds_read_b128 v[28:31], v3 offset:16
    ds_read_b64 v[144:145], v9 offset:0
    ds_read_b64 v[146:147], v9 offset:512
    ds_read_b64 v[148:149], v9 offset:1024
    ds_read_b64 v[150:151], v9 offset:1536
    ds_read_b64 v[152:153], v9 offset:2048
    ds_read_b64 v[154:155], v9 offset:2560
    ds_read_b64 v[156:157], v9 offset:3072
    ds_read_b64 v[158:159], v9 offset:3584
    s_waitcnt lgkmcnt(10)
    v_readfirstlane_b32 s96, v37
    v_readfirstlane_b32 s61, v38
    s_cmp_lg_u32 s96, s62
    s_cbranch_scc1 L_nopub
    s_waitcnt lgkmcnt(6)
    v_pk_mul_f32 v[144:145], v[144:145], v[24:25] op_sel:[0,0] op_sel_hi:[1,0]
    v_pk_mul_f32 v[146:147], v[146:147], v[24:25] op_sel:[0,1] op_sel_hi:[1,1]
    s_waitcnt lgkmcnt(4)
    v_pk_fma_f32 v[144:145], v[148:149], v[26:27], v[144:145] op_sel:[0,0,0] op_sel_hi:[1,0,1]
    v_pk_fma_f32 v[146:147], v[150:151], v[26:27], v[146:147] op_sel:[0,1,0] op_sel_hi:[1,1,1]
    s_waitcnt lgkmcnt(2)
    v_pk_fma_f32 v[144:145], v[152:153], v[28:29], v[144:145] op_sel:[0,0,0] op_sel_hi:[1,0,1]
    v_pk_fma_f32 v[146:147], v[154:155], v[28:29], v[146:147] op_sel:[0,1,0] op_sel_hi:[1,1,1]
    s_waitcnt lgkmcnt(0)
    v_pk_fma_f32 v[144:145], v[156:157], v[30:31], v[144:145] op_sel:[0,0,0] op_sel_hi:[1,0,1]
    v_pk_fma_f32 v[146:147], v[158:159], v[30:31], v[146:147] op_sel:[0,1,0] op_sel_hi:[1,1,1]
    s_cmp_eq_u32 s61, 1
    v_pk_add_f32 v[144:145], v[144:145], v[146:147]
    v_cvt_pk_bf16_f32 v32, v144, v145
    s_cbranch_scc0 L_oslow
    buffer_store_dword v32, v39, s[40:43], s98 offen
L_odone:
L_nopub:
    s_cmp_eq_u32 s59, 0
    s_cbranch_scc1 L_not1
L_poll_101:
    buffer_load_dwordx4 v[16:19], v105, s[40:43], s100 offen sc1
    buffer_load_dwordx4 v[20:23], v105, s[40:43], s100 offen offset:128 sc1
    s_sub_u32 s60, s60, 1
    s_cbranch_scc1 L_poll_101t
    s_waitcnt vmcnt(0)
    v_max3_u32 v38, v16, v17, v18
    v_max3_u32 v38, v38, v19, v20
    v_max3_u32 v38, v38, v21, v22
    v_max_u32 v38, v38, v23
    v_cmp_eq_u32 vcc, -1, v38
    s_cbranch_vccnz L_poll_101
L_poll_101e:
    v_smfmac_f32_16x16x64_bf16 v[112:115], v[16:19], v[72:79], v111
    v_smfmac_f32_16x16x64_bf16 v[116:119], v[16:19], v[80:87], v111
    v_smfmac_f32_16x16x64_bf16 v[112:115], v[20:23], v[88:95], v111
    v_smfmac_f32_16x16x64_bf16 v[116:119], v[20:23], v[96:103], v111
    s_nop 6
    v_pk_add_f32 v[112:113], v[112:113], v[114:115]
    v_pk_add_f32 v[116:117], v[116:117], v[118:119]
    v_add_f32 v12, v112, v113
    v_add_f32 v13, v116, v117
    ds_write2_b32 v106, v12, v13 offset0:0 offset1:32
    s_mov_b64 exec, 1
    ds_add_rtn_u32 v37, v109, v11
    s_mov_b64 exec, -1
    ds_read_b64 v[72:73], v107 offset:0
    ds_read_b64 v[74:75], v107 offset:16384
    ds_read_b64 v[76:77], v107 offset:32768
    ds_read_b64 v[78:79], v107 offset:49152
    s_cmp_eq_u32 s34, 2
    s_cselect_b32 s97, s61, 0
    s_waitcnt lgkmcnt(4)
    v_readfirstlane_b32 s96, v37
    s_waitcnt lgkmcnt(2)
    v_pk_add_f32 v[72:73], v[72:73], v[74:75]
    s_cmp_lg_u32 s96, 3
    s_cbranch_scc1 L_not1
    s_cmp_eq_u32 s97, 1
    s_waitcnt lgkmcnt(0)
    v_pk_add_f32 v[76:77], v[76:77], v[78:79]
    v_pk_add_f32 v[72:73], v[72:73], v[76:77]
    v_cvt_pk_bf16_f32 v12, v72, v73
    s_cbranch_scc1 L_pfast
    buffer_store_dword v12, v108, s[40:43], s101 offen sc1
    buffer_store_dword v12, v110, s[40:43], s101 offen sc1
L_pdone:
L_not1:
    s_waitcnt lgkmcnt(0)
    s_cmp_eq_u32 s39, 1
    s_cbranch_scc1 L_s_role
    s_endpgm
L_k_nopf:
    s_waitcnt vmcnt(3)
    s_bitcmp0_b32 s57, 22
    s_cbranch_scc1 L_sf_57
    s_waitcnt vmcnt(2)
    s_bitcmp0_b32 s58, 22
    s_cbranch_scc1 L_sf_57
    s_waitcnt vmcnt(1)
L_sf_57:
    buffer_load_dwordx4 v[128:131], v1, s[48:51], s97 offen offset:2048 nt
    v_min_u32 v39, 15, v0
    v_and_b32 v38, 1, v39
    v_mul_u32_u24 v38, 126, v38
    v_lshl_add_u32 v39, v39, 1, v38
    buffer_load_dword v37, v39, s[44:47], 0 offen sc1
    s_waitcnt vmcnt(4)
    s_bitcmp0_b32 s57, 23
    s_cbranch_scc1 L_sf_58
    s_waitcnt vmcnt(3)
    s_bitcmp0_b32 s58, 23
    s_cbranch_scc1 L_sf_58
    s_waitcnt vmcnt(2)
L_sf_58:
    buffer_load_dwordx4 v[132:135], v1, s[48:51], s97 offen offset:3072 nt
    s_add_u32 s97, s97, 32768
    v_add_u32 v1, 4096, v1
    v_and_b32 v1, 0x7fff, v1
    s_waitcnt vmcnt(4)
    s_bitcmp0_b32 s57, 24
    s_cbranch_scc1 L_sf_59
    s_waitcnt vmcnt(3)
    s_bitcmp0_b32 s58, 24
    s_cbranch_scc1 L_sf_59
    s_waitcnt vmcnt(2)
L_sf_59:
    buffer_load_dwordx4 v[136:139], v1, s[48:51], s97 offen offset:0 nt
    s_waitcnt vmcnt(4)
    s_bitcmp0_b32 s57, 25
    s_cbranch_scc1 L_sf_60
    s_waitcnt vmcnt(3)
    s_bitcmp0_b32 s58, 25
    s_cbranch_scc1 L_sf_60
    s_waitcnt vmcnt(1)
L_sf_60:
    buffer_load_dwordx4 v[140:143], v1, s[48:51], s97 offen offset:1024 nt
    s_waitcnt vmcnt(4)
    s_bitcmp0_b32 s57, 26
    s_cbranch_scc1 L_sf_61
    s_waitcnt vmcnt(2)
    s_bitcmp0_b32 s58, 26
    s_cbranch_scc1 L_sf_61
    s_waitcnt vmcnt(1)
L_sf_61:
    buffer_load_dwordx4 v[144:147], v1, s[48:51], s97 offen offset:2048 nt
    s_waitcnt vmcnt(3)
    s_bitcmp0_b32 s57, 27
    s_cbranch_scc1 L_sf_62
    s_waitcnt vmcnt(2)
    s_bitcmp0_b32 s58, 27
    s_cbranch_scc1 L_sf_62
    s_waitcnt vmcnt(1)
L_sf_62:
    buffer_load_dwordx4 v[148:151], v1, s[48:51], s97 offen offset:3072 nt
    s_add_u32 s97, s97, 32768
    v_add_u32 v1, 4096, v1
    v_and_b32 v1, 0x7fff, v1
    v_cmp_eq_u32 vcc, 0, v37
    s_nop 0
    s_or_b32 s96, vcc_lo, vcc_hi
    buffer_load_dwordx4 v[4:7], v2, s[40:43], s98 offen sc1
    s_waitcnt vmcnt(4)
    s_bitcmp0_b32 s57, 28
    s_cbranch_scc1 L_sf_63
    s_waitcnt vmcnt(3)
    s_bitcmp0_b32 s58, 28
    s_cbranch_scc1 L_sf_63
    s_waitcnt vmcnt(2)
L_sf_63:
    buffer_load_dwordx4 v[152:155], v1, s[48:51], s97 offen offset:0 nt
    s_waitcnt vmcnt(4)
    s_bitcmp0_b32 s57, 29
    s_cbranch_scc1 L_sf_64
    s_waitcnt vmcnt(3)
    s_bitcmp0_b32 s58, 29
    s_cbranch_scc1 L_sf_64
    s_waitcnt vmcnt(2)
L_sf_64:
    buffer_load_dwordx4 v[156:159], v1, s[48:51], s97 offen offset:1024 nt
    s_waitcnt vmcnt(4)
    s_bitcmp0_b32 s57, 30
    s_cbranch_scc1 L_sf_65
    s_waitcnt vmcnt(3)
    s_bitcmp0_b32 s58, 30
    s_cbranch_scc1 L_sf_65
    s_waitcnt vmcnt(1)
L_sf_65:
    buffer_load_dwordx4 v[160:163], v1, s[48:51], s97 offen offset:2048 nt
    s_waitcnt vmcnt(4)
    s_bitcmp0_b32 s57, 31
    s_cbranch_scc1 L_sf_66
    s_waitcnt vmcnt(2)
    s_bitcmp0_b32 s58, 31
    s_cbranch_scc1 L_sf_66
    s_waitcnt vmcnt(1)
L_sf_66:
    buffer_load_dwordx4 v[164:167], v1, s[48:51], s97 offen offset:3072 nt
    s_mov_b32 s97, 0
    v_add_u32 v1, 4096, v1
    v_and_b32 v1, 0x7fff, v1
    v_add_u32 v1, 8192, v1
    v_and_b32 v1, 0x7fff, v1
    s_mov_b32 s97, 65536
    s_branch L_k_join
L_v_nopf:
    v_and_b32_dpp v24, v19, v20 row_newbcast:0 row_mask:0xf bank_mask:0xf
    v_and_b32_dpp v25, v19, v21 row_newbcast:0 row_mask:0xf bank_mask:0xf
    v_and_b32_dpp v26, v19, v22 row_newbcast:0 row_mask:0xf bank_mask:0xf
    v_and_b32_dpp v27, v19, v23 row_newbcast:0 row_mask:0xf bank_mask:0xf
    s_waitcnt vmcnt(3)
    s_bitcmp0_b32 s14, 0
    s_cbranch_scc1 L_sf_93
    s_waitcnt vmcnt(2)
    s_bitcmp0_b32 s15, 0
    s_cbranch_scc1 L_sf_93
    s_waitcnt vmcnt(1)
L_sf_93:
    buffer_load_dwordx4 v[40:43], v1, s[52:55], s97 offen offset:0 nt
    v_mfma_f32_16x16x32_bf16 v[32:35], v[24:27], v[152:155], v[32:35]
    v_and_b32_dpp v28, v19, v20 row_newbcast:8 row_mask:0xf bank_mask:0xf
    v_and_b32_dpp v29, v19, v21 row_newbcast:8 row_mask:0xf bank_mask:0xf
    v_and_b32_dpp v30, v19, v22 row_newbcast:8 row_mask:0xf bank_mask:0xf
    v_and_b32_dpp v31, v19, v23 row_newbcast:8 row_mask:0xf bank_mask:0xf
    s_waitcnt vmcnt(3)
    s_bitcmp0_b32 s14, 1
    s_cbranch_scc1 L_sf_94
    s_waitcnt vmcnt(2)
    s_bitcmp0_b32 s15, 1
    s_cbranch_scc1 L_sf_94
    s_waitcnt vmcnt(1)
L_sf_94:
    buffer_load_dwordx4 v[44:47], v1, s[52:55], s97 offen offset:1024 nt
    v_mfma_f32_16x16x32_bf16 v[32:35], v[28:31], v[156:159], v[32:35]
    v_and_b32_dpp v24, v19, v20 row_newbcast:4 row_mask:0xf bank_mask:0xf
    v_and_b32_dpp v25, v19, v21 row_newbcast:4 row_mask:0xf bank_mask:0xf
    v_and_b32_dpp v26, v19, v22 row_newbcast:4 row_mask:0xf bank_mask:0xf
    v_and_b32_dpp v27, v19, v23 row_newbcast:4 row_mask:0xf bank_mask:0xf
    s_waitcnt vmcnt(3)
    s_bitcmp0_b32 s14, 2
    s_cbranch_scc1 L_sf_95
    s_waitcnt vmcnt(2)
    s_bitcmp0_b32 s15, 2
    s_cbranch_scc1 L_sf_95
    s_waitcnt vmcnt(1)
L_sf_95:
    buffer_load_dwordx4 v[48:51], v1, s[52:55], s97 offen offset:2048 nt
    v_mfma_f32_16x16x32_bf16 v[32:35], v[24:27], v[160:163], v[32:35]
    v_and_b32_dpp v28, v19, v20 row_newbcast:12 row_mask:0xf bank_mask:0xf
    v_and_b32_dpp v29, v19, v21 row_newbcast:12 row_mask:0xf bank_mask:0xf
    v_and_b32_dpp v30, v19, v22 row_newbcast:12 row_mask:0xf bank_mask:0xf
    v_and_b32_dpp v31, v19, v23 row_newbcast:12 row_mask:0xf bank_mask:0xf
    s_waitcnt vmcnt(3)
    s_bitcmp0_b32 s14, 3
    s_cbranch_scc1 L_sf_96
    s_waitcnt vmcnt(2)
    s_bitcmp0_b32 s15, 3
    s_cbranch_scc1 L_sf_96
    s_waitcnt vmcnt(1)
L_sf_96:
    buffer_load_dwordx4 v[52:55], v1, s[52:55], s97 offen offset:3072 nt
    s_add_u32 s97, s97, 32768
    v_add_u32 v1, 4096, v1
    v_and_b32 v1, 0x7fff, v1
    v_mfma_f32_16x16x32_bf16 v[32:35], v[28:31], v[164:167], v[32:35]
    v_and_b32_dpp v24, v12, v20 row_newbcast:0 row_mask:0xf bank_mask:0xf
    v_and_b32_dpp v25, v12, v21 row_newbcast:0 row_mask:0xf bank_mask:0xf
    v_and_b32_dpp v26, v12, v22 row_newbcast:0 row_mask:0xf bank_mask:0xf
    v_and_b32_dpp v27, v12, v23 row_newbcast:0 row_mask:0xf bank_mask:0xf
    s_waitcnt vmcnt(3)
    s_bitcmp0_b32 s14, 4
    s_cbranch_scc1 L_sf_97
    s_waitcnt vmcnt(2)
    s_bitcmp0_b32 s15, 4
    s_cbranch_scc1 L_sf_97
    s_waitcnt vmcnt(1)
L_sf_97:
    buffer_load_dwordx4 v[56:59], v1, s[52:55], s97 offen offset:0 nt
    v_mfma_f32_16x16x32_bf16 v[32:35], v[24:27], v[40:43], v[32:35]
    v_and_b32_dpp v28, v12, v20 row_newbcast:8 row_mask:0xf bank_mask:0xf
    v_and_b32_dpp v29, v12, v21 row_newbcast:8 row_mask:0xf bank_mask:0xf
    v_and_b32_dpp v30, v12, v22 row_newbcast:8 row_mask:0xf bank_mask:0xf
    v_and_b32_dpp v31, v12, v23 row_newbcast:8 row_mask:0xf bank_mask:0xf
    s_waitcnt vmcnt(3)
    s_bitcmp0_b32 s14, 5
    s_cbranch_scc1 L_sf_98
    s_waitcnt vmcnt(2)
    s_bitcmp0_b32 s15, 5
    s_cbranch_scc1 L_sf_98
    s_waitcnt vmcnt(1)
L_sf_98:
    buffer_load_dwordx4 v[60:63], v1, s[52:55], s97 offen offset:1024 nt
    v_mfma_f32_16x16x32_bf16 v[32:35], v[28:31], v[44:47], v[32:35]
    v_and_b32_dpp v24, v12, v20 row_newbcast:4 row_mask:0xf bank_mask:0xf
    v_and_b32_dpp v25, v12, v21 row_newbcast:4 row_mask:0xf bank_mask:0xf
    v_and_b32_dpp v26, v12, v22 row_newbcast:4 row_mask:0xf bank_mask:0xf
    v_and_b32_dpp v27, v12, v23 row_newbcast:4 row_mask:0xf bank_mask:0xf
    s_waitcnt vmcnt(3)
    s_bitcmp0_b32 s14, 6
    s_cbranch_scc1 L_sf_99
    s_waitcnt vmcnt(2)
    s_bitcmp0_b32 s15, 6
    s_cbranch_scc1 L_sf_99
    s_waitcnt vmcnt(1)
L_sf_99:
    buffer_load_dwordx4 v[64:67], v1, s[52:55], s97 offen offset:2048 nt
    v_mfma_f32_16x16x32_bf16 v[32:35], v[24:27], v[48:51], v[32:35]
    v_and_b32_dpp v28, v12, v20 row_newbcast:12 row_mask:0xf bank_mask:0xf
    v_and_b32_dpp v29, v12, v21 row_newbcast:12 row_mask:0xf bank_mask:0xf
    v_and_b32_dpp v30, v12, v22 row_newbcast:12 row_mask:0xf bank_mask:0xf
    v_and_b32_dpp v31, v12, v23 row_newbcast:12 row_mask:0xf bank_mask:0xf
    s_waitcnt vmcnt(3)
    s_bitcmp0_b32 s14, 7
    s_cbranch_scc1 L_sf_100
    s_waitcnt vmcnt(2)
    s_bitcmp0_b32 s15, 7
    s_cbranch_scc1 L_sf_100
    s_waitcnt vmcnt(1)
L_sf_100:
    buffer_load_dwordx4 v[68:71], v1, s[52:55], s97 offen offset:3072 nt
    s_add_u32 s97, s97, 32768
    v_add_u32 v1, 4096, v1
    v_and_b32 v1, 0x7fff, v1
    v_mfma_f32_16x16x32_bf16 v[32:35], v[28:31], v[52:55], v[32:35]
    v_and_b32_dpp v24, v13, v20 row_newbcast:0 row_mask:0xf bank_mask:0xf
    v_and_b32_dpp v25, v13, v21 row_newbcast:0 row_mask:0xf bank_mask:0xf
    v_and_b32_dpp v26, v13, v22 row_newbcast:0 row_mask:0xf bank_mask:0xf
    v_and_b32_dpp v27, v13, v23 row_newbcast:0 row_mask:0xf bank_mask:0xf
    s_waitcnt vmcnt(3)
    s_nop 0
    v_mfma_f32_16x16x32_bf16 v[32:35], v[24:27], v[56:59], v[32:35]
    v_and_b32_dpp v28, v13, v20 row_newbcast:8 row_mask:0xf bank_mask:0xf
    v_and_b32_dpp v29, v13, v21 row_newbcast:8 row_mask:0xf bank_mask:0xf
    v_and_b32_dpp v30, v13, v22 row_newbcast:8 row_mask:0xf bank_mask:0xf
    v_and_b32_dpp v31, v13, v23 row_newbcast:8 row_mask:0xf bank_mask:0xf
    s_waitcnt vmcnt(2)
    s_nop 0
    v_mfma_f32_16x16x32_bf16 v[32:35], v[28:31], v[60:63], v[32:35]
    v_and_b32_dpp v24, v13, v20 row_newbcast:4 row_mask:0xf bank_mask:0xf
    v_and_b32_dpp v25, v13, v21 row_newbcast:4 row_mask:0xf bank_mask:0xf
    v_and_b32_dpp v26, v13, v22 row_newbcast:4 row_mask:0xf bank_mask:0xf
    v_and_b32_dpp v27, v13, v23 row_newbcast:4 row_mask:0xf bank_mask:0xf
    s_waitcnt vmcnt(1)
    s_nop 0
    v_mfma_f32_16x16x32_bf16 v[32:35], v[24:27], v[64:67], v[32:35]
    v_and_b32_dpp v28, v13, v20 row_newbcast:12 row_mask:0xf bank_mask:0xf
    v_and_b32_dpp v29, v13, v21 row_newbcast:12 row_mask:0xf bank_mask:0xf
    v_and_b32_dpp v30, v13, v22 row_newbcast:12 row_mask:0xf bank_mask:0xf
    v_and_b32_dpp v31, v13, v23 row_newbcast:12 row_mask:0xf bank_mask:0xf
    s_waitcnt vmcnt(0)
    s_nop 0
    v_mfma_f32_16x16x32_bf16 v[32:35], v[28:31], v[68:71], v[32:35]
    s_branch L_v_join
L_oslow:
    buffer_store_dword v32, v39, s[40:43], s98 offen sc1
    s_branch L_odone
L_qslow:
L_wy_102:
    buffer_load_dword v37, v39, s[44:47], 0 offen sc1
    s_waitcnt vmcnt(0)
    v_cmp_ne_u32 vcc, -1, v37
    s_cbranch_vccz L_wy_102e
    s_sleep 4
    s_sub_u32 s60, s60, 1
    s_cbranch_scc0 L_wy_102
    s_mov_b32 s60, 0
L_wy_102e:
L_qslow2:
    s_branch L_poll_103
L_poll_103s:
    s_sleep 2
L_poll_103:
    buffer_load_dwordx4 v[4:7], v2, s[40:43], s98 offen sc1
    s_sub_u32 s60, s60, 1
    s_cbranch_scc1 L_poll_103t
    s_waitcnt vmcnt(0)
    v_max3_u32 v38, v4, v5, v6
    v_max_u32 v38, v38, v7
    v_cmp_eq_u32 vcc, -1, v38
    s_cbranch_vccnz L_poll_103s
L_poll_103e:
    s_branch L_qok
L_mljob:
    s_lshl4_add_u32 s96, s35, s3
    s_lshl_b32 s96, s96, 3
    s_add_u32 s96, s96, 81920
    buffer_store_dwordx2 v[8:9], v36, s[40:43], s96 offen sc1
    s_branch L_mldone
L_service:
    v_mov_b32 v72, 0
    v_mov_b32 v73, 0
    v_mov_b32 v74, 0
    v_mov_b32 v75, 0
    v_mov_b32 v76, 0
    s_mov_b32 s59, 0
    v_mov_b32 v5, 0
    v_mov_b32 v105, 0
    v_mov_b32 v108, 0
    v_mov_b32 v110, 0
    v_mov_b32 v160, 0
    v_mov_b32 v163, 0
    v_mov_b32 v8, 162068
L_lw_104:
    ds_read_b32 v9, v8
    s_waitcnt lgkmcnt(0)
    v_cmp_gt_u32 vcc, 8, v9
    s_cbranch_vccz L_lw_104e
    s_sleep 8
    s_sub_u32 s60, s60, 1
    s_cbranch_scc0 L_lw_104
    s_mov_b32 s60, 0
L_lw_104e:
    v_and_b32 v2, 15, v0
    v_lshlrev_b32 v2, 3, v2
    v_add_u32 v3, 161920, v2
    ds_read_b64 v[8:9], v3
    v_mov_b32 v11, 162096
    ds_read_b32 v11, v11
    s_getreg_b32 s58, hwreg(HW_REG_XCC_ID, 0, 4)
    s_lshl_b32 s98, s34, 5
    s_add_u32 s98, s98, s35
    s_lshl_b32 s62, s98, 7
    s_add_u32 s62, s62, 73728
    s_and_b32 s99, s62, 0xffffff00
    s_lshl_b32 s98, s98, 8
    s_add_u32 s98, s98, 106496
    v_lshlrev_b32 v39, 2, v0
    v_and_b32 v21, 64, v2
    v_add_u32 v21, v21, v2
    v_cmp_eq_u32 vcc, 8, v0
    s_bfm_b64 exec, 8, 0
    s_bitset1_b32 exec_lo, 8
    s_waitcnt lgkmcnt(0)
    v_lshl_add_u32 v10, v11, 8, s58
    v_cndmask_b32 v8, v8, v10, vcc
    buffer_store_dwordx2 v[8:9], v2, s[40:43], s62 offen sc1
    s_mov_b64 exec, -1
    v_mov_b32 v12, 162076
L_lw_105:
    ds_read_b32 v13, v12
    s_waitcnt lgkmcnt(0)
    v_cmp_gt_u32 vcc, 4, v13
    s_cbranch_vccz L_lw_105e
    s_sleep 4
    s_sub_u32 s60, s60, 1
    s_cbranch_scc0 L_lw_105
    s_mov_b32 s60, 0
L_lw_105e:
    v_and_b32 v11, 31, v0
    v_lshlrev_b32 v11, 7, v11
    s_lshl_b32 s63, s34, 12
    s_add_u32 s63, s63, 73792
    buffer_load_dword v12, v39, s[40:43], s98 offen sc1
    s_branch L_poll_106
L_poll_106s:
    s_sleep 16
L_poll_106:
    buffer_load_dwordx2 v[8:9], v21, s[40:43], s99 offen sc1
    buffer_load_dword v10, v11, s[40:43], s63 offen sc1
    s_sub_u32 s60, s60, 1
    s_cbranch_scc1 L_poll_106t
    s_waitcnt vmcnt(0)
    v_max3_u32 v38, v8, v9, v10
    v_cmp_eq_u32 vcc, -1, v38
    s_cbranch_vccnz L_poll_106s
L_poll_106e:
    v_mov_b32 v37, v8
    s_nop 1
    v_max_f32_dpp v37, v37, v37 quad_perm:[1,0,3,2] row_mask:0xf bank_mask:0xf
    s_nop 1
    v_max_f32_dpp v37, v37, v37 quad_perm:[2,3,0,1] row_mask:0xf bank_mask:0xf
    s_nop 1
    v_max_f32_dpp v37, v37, v37 row_ror:4 row_mask:0xf bank_mask:0xf
    s_nop 1
    v_max_f32_dpp v37, v37, v37 row_ror:8 row_mask:0xf bank_mask:0xf
    v_sub_f32 v8, v8, v37
    v_exp_f32 v8, v8
    s_nop 0
    v_mul_f32 v9, v8, v9
    s_nop 1
    v_add_f32_dpp v9, v9, v9 quad_perm:[1,0,3,2] row_mask:0xf bank_mask:0xf
    s_nop 1
    v_add_f32_dpp v9, v9, v9 quad_perm:[2,3,0,1] row_mask:0xf bank_mask:0xf
    s_nop 1
    v_add_f32_dpp v9, v9, v9 row_ror:4 row_mask:0xf bank_mask:0xf
    s_nop 1
    v_add_f32_dpp v9, v9, v9 row_ror:8 row_mask:0xf bank_mask:0xf
    v_and_b32 v10, 0xff, v10
    s_getreg_b32 s62, hwreg(HW_REG_XCC_ID, 0, 4)
    v_cmp_ne_u32 vcc, s62, v10
    s_nop 0
    s_cmp_eq_u64 vcc, 0
    s_cselect_b32 s61, 1, 0
    v_rcp_f32 v9, v9
    v_lshrrev_b32 v3, 1, v2
    v_add_u32 v3, 161984, v3
    v_mul_f32 v8, v8, v9
    v_mov_b32 v10, 162072
    v_mov_b32 v11, s61
    ds_write_b32 v3, v8
    ds_write_b32 v10, v11
    s_mov_b32 s3, 1
    v_lshrrev_b32 v9, 4, v0
    v_lshl_add_u32 v8, v9, 2, v2
    s_lshl_b32 s96, s3, 9
    s_add_u32 s96, s96, 157824
    v_lshl_add_u32 v8, v8, 2, s96
    v_lshlrev_b32 v9, 3, v0
    v_add_u32 v9, 157824, v9
    v_mov_b32 v10, 162048
    v_mov_b32 v11, 1
    s_lshl_b32 s96, s38, 5
    s_add_u32 s96, s96, 161984
    v_mov_b32 v3, s96
    s_sub_u32 s62, 8, s39
    s_lshl_b32 s98, s34, 5
    s_add_u32 s98, s98, s35
    s_lshl_b32 s98, s98, 8
    s_add_u32 s98, s98, 106496
    v_lshlrev_b32 v39, 2, v0
    s_branch L_t0b
L_jobend:
    v_lshlrev_b32 v9, 4, v0
    s_mov_b32 exec_hi, 0
    s_nop 3
    buffer_store_dwordx4 v[32:35], v9, s[40:43], s13 offen sc1
    s_endpgm
L_proxy:
    v_mov_b32 v72, 0
    v_mov_b32 v73, 0
    v_mov_b32 v74, 0
    v_mov_b32 v75, 0
    v_mov_b32 v76, 0
    v_mov_b32 v5, 0
    v_mov_b32 v105, 0
    v_mov_b32 v108, 0
    v_mov_b32 v110, 0
    v_mov_b32 v160, 0
    v_mov_b32 v163, 0
    s_barrier
    s_waitcnt lgkmcnt(0)
    s_mov_b32 s40, s32
    s_mov_b32 s41, s33
    s_mov_b32 s42, 589824
    s_mov_b32 s43, 0x20000
    s_mov_b32 s44, s30
    s_mov_b32 s45, s31
    s_mov_b32 s46, 256
    s_mov_b32 s47, 0x20000
    s_sub_u32 s97, 7, s3
    s_mul_i32 s97, s97, 27
    s_cmp_eq_u32 s3, 5
    s_cselect_b32 s97, 32, s97
    s_add_u32 s97, s97, s35
    s_lshl_b32 s97, s97, 9
    s_add_u32 s97, s97, 172032
    v_and_b32 v2, 15, v0
    v_lshlrev_b32 v2, 3, v2
    v_and_b32 v20, 31, v0
    v_lshlrev_b32 v20, 4, v20
    s_cmp_lg_u32 s3, 7
    s_cbranch_scc1 L_px6
    s_sub_u32 s96, 6, s59
    s_mul_i32 s62, s35, 5120
    s_add_u32 s62, s62, 327680
    v_lshl_add_u32 v22, v0, 4, s62
    v_add_u32 v23, 4096, v22
    v_mov_b32 v24, -1
    v_mov_b32 v25, -1
    v_mov_b32 v26, -1
    v_mov_b32 v27, -1
    v_mov_b32 v8, 162068
L_lw_107:
    ds_read_b32 v9, v8
    s_waitcnt lgkmcnt(0)
    v_cmp_gt_u32 vcc, s96, v9
    s_cbranch_vccz L_lw_107e
    s_sleep 8
    s_sub_u32 s60, s60, 1
    s_cbranch_scc0 L_lw_107
    s_mov_b32 s60, 0
L_lw_107e:
    v_and_b32 v2, 15, v0
    v_lshlrev_b32 v2, 3, v2
    v_add_u32 v3, 161920, v2
    ds_read_b64 v[8:9], v3
    v_mov_b32 v11, 162096
    ds_read_b32 v11, v11
    s_getreg_b32 s58, hwreg(HW_REG_XCC_ID, 0, 4)
    s_lshl_b32 s98, s34, 5
    s_add_u32 s98, s98, s35
    s_lshl_b32 s62, s98, 7
    s_add_u32 s62, s62, 73728
    s_and_b32 s99, s62, 0xffffff00
    s_lshl_b32 s98, s98, 8
    s_add_u32 s98, s98, 106496
    v_lshlrev_b32 v39, 2, v0
    v_and_b32 v21, 64, v2
    v_add_u32 v21, v21, v2
    v_cmp_eq_u32 vcc, 8, v0
    s_bfm_b64 exec, s96, 0
    s_bitset1_b32 exec_lo, 8
    s_waitcnt lgkmcnt(0)
    v_lshl_add_u32 v10, v11, 8, s58
    v_cndmask_b32 v8, v8, v10, vcc
    buffer_store_dwordx2 v[8:9], v2, s[40:43], s62 offen sc1
    s_mov_b64 exec, -1
    buffer_load_dwordx4 v[120:123], v22, s[40:43], 0 offen offset:0 sc1
    buffer_load_dwordx4 v[124:127], v22, s[40:43], 0 offen offset:1024 sc1
    buffer_load_dwordx4 v[128:131], v22, s[40:43], 0 offen offset:2048 sc1
    buffer_load_dwordx4 v[132:135], v22, s[40:43], 0 offen offset:3072 sc1
    buffer_load_dwordx4 v[136:139], v23, s[40:43], 0 offen offset:0 sc1
    s_mov_b32 s100, 4
    s_lshl_b32 s63, s100, 8
    v_and_b32 v8, 15, v0
    v_lshl_add_u32 v8, v8, 4, s63
    v_lshrrev_b32 v9, 4, v0
    v_mul_u32_u24 v5, 1280, v9
    v_add_u32 v5, v5, v8
    v_mul_u32_u24 v4, 1296, v9
    v_add_u32 v4, v4, v8
    v_add_u32 v4, 82944, v4
    v_lshlrev_b32 v6, 1, v5
    v_add_u32 v6, 99328, v6
    s_lshl_b32 s62, s100, 9
    s_add_u32 s62, s62, 88128
    v_lshl_add_u32 v7, v0, 3, s62
    s_mov_b32 s48, s4
    s_mov_b32 s49, s5
    s_mov_b32 s50, 5120
    s_mov_b32 s51, 0x20000
    buffer_load_dwordx4 v[8:11], v5, s[48:51], 0 offen
    s_mov_b32 s62, 20480
    s_mov_b32 s63, 30720
    s_branch L_poll_108
L_poll_108s:
    s_sleep 32
L_poll_108:
    buffer_load_dwordx4 v[12:15], v5, s[40:43], s62 offen sc1
    buffer_load_dwordx4 v[16:19], v5, s[40:43], s63 offen sc1
    s_sub_u32 s60, s60, 1
    s_cbranch_scc1 L_poll_108t
    s_waitcnt vmcnt(0)
    v_max3_u32 v38, v12, v13, v14
    v_max3_u32 v38, v38, v15, v16
    v_max3_u32 v38, v38, v17, v18
    v_max_u32 v38, v38, v19
    v_cmp_eq_u32 vcc, -1, v38
    s_cbranch_vccnz L_poll_108s
L_poll_108e:
    v_lshlrev_b32 v40, 16, v8
    v_and_b32 v41, 0xffff0000, v8
    v_lshlrev_b32 v42, 16, v9
    v_and_b32 v43, 0xffff0000, v9
    v_lshlrev_b32 v44, 16, v10
    v_and_b32 v45, 0xffff0000, v10
    v_lshlrev_b32 v46, 16, v11
    v_and_b32 v47, 0xffff0000, v11
    v_lshlrev_b32 v48, 16, v12
    v_and_b32 v49, 0xffff0000, v12
    v_lshlrev_b32 v50, 16, v13
    v_and_b32 v51, 0xffff0000, v13
    v_lshlrev_b32 v52, 16, v14
    v_and_b32 v53, 0xffff0000, v14
    v_lshlrev_b32 v54, 16, v15
    v_and_b32 v55, 0xffff0000, v15
    v_lshlrev_b32 v56, 16, v16
    v_and_b32 v57, 0xffff0000, v16
    v_lshlrev_b32 v58, 16, v17
    v_and_b32 v59, 0xffff0000, v17
    v_lshlrev_b32 v60, 16, v18
    v_and_b32 v61, 0xffff0000, v18
    v_lshlrev_b32 v62, 16, v19
    v_and_b32 v63, 0xffff0000, v19
    v_mov_b32 v64, 0
    v_mov_b32 v65, 0
    v_mov_b32 v66, 0
    v_mov_b32 v67, 0
    v_mov_b32 v68, 0
    v_mov_b32 v69, 0
    v_mov_b32 v70, 0
    v_mov_b32 v71, 0
    v_bfe_u32 v5, v0, 2, 2
    v_lshlrev_b32 v5, 8, v5
    v_lshrrev_b32 v8, 4, v0
    v_lshl_add_u32 v5, v8, 6, v5
    v_and_b32 v8, 3, v0
    v_lshl_add_u32 v5, v8, 4, v5
    s_lshl_b32 s56, s100, 10
    s_or_b32 s96, s59, 0
    s_cbranch_scc0 L_nofrag_109
    v_mov_b32 v104, 162060
L_lw_110:
    ds_read_b32 v105, v104
    s_waitcnt lgkmcnt(0)
    v_cmp_gt_u32 vcc, 4, v105
    s_cbranch_vccz L_lw_110e
    s_sleep 2
    s_sub_u32 s60, s60, 1
    s_cbranch_scc0 L_lw_110
    s_mov_b32 s60, 0
L_lw_110e:
    s_cmp_eq_u32 s59, 0
    s_cbranch_scc1 L_nofrag_109
    v_bfe_u32 v104, v0, 2, 1
    v_bfe_u32 v110, v0, 4, 1
    v_lshl_add_u32 v104, v110, 2, v104
    v_and_b32 v110, 8, v0
    v_add_u32 v104, v104, v110
    v_lshrrev_b32 v110, 5, v0
    v_lshl_add_u32 v104, v110, 4, v104
    v_bfe_u32 v111, v0, 0, 1
    v_mul_u32_u24 v111, 0xaaaa, v111
    v_add_u32 v111, 0x4444, v111
    v_mov_b32 v112, 0
    v_mov_b32 v113, 0
    v_mov_b32 v114, 0
    v_mov_b32 v115, 0
    v_mov_b32 v116, 0
    v_mov_b32 v117, 0
    v_mov_b32 v118, 0
    v_mov_b32 v119, 0
    v_lshlrev_b32 v104, 7, v104
    v_and_b32 v110, 3, v0
    v_lshl_add_u32 v104, v110, 3, v104
    v_lshrrev_b32 v109, 4, v0
    v_and_b32 v110, 1, v0
    s_lshr_b32 s63, s3, 1
    s_and_b32 s62, s3, 1
    s_lshl_b32 s96, s63, 14
    s_lshl_b32 s100, s62, 6
    s_add_u32 s100, s100, 81920
    s_add_u32 s96, s96, s100
    v_add_u32 v104, s96, v104
    ds_read_b64_tr_b16 v[72:73], v104 offset:0
    ds_read_b64_tr_b16 v[74:75], v104 offset:256
    ds_read_b64_tr_b16 v[76:77], v104 offset:4096
    ds_read_b64_tr_b16 v[78:79], v104 offset:4352
    ds_read_b64_tr_b16 v[80:81], v104 offset:32
    ds_read_b64_tr_b16 v[82:83], v104 offset:288
    ds_read_b64_tr_b16 v[84:85], v104 offset:4128
    ds_read_b64_tr_b16 v[86:87], v104 offset:4384
    ds_read_b64_tr_b16 v[88:89], v104 offset:8192
    ds_read_b64_tr_b16 v[90:91], v104 offset:8448
    ds_read_b64_tr_b16 v[92:93], v104 offset:12288
    ds_read_b64_tr_b16 v[94:95], v104 offset:12544
    ds_read_b64_tr_b16 v[96:97], v104 offset:8224
    ds_read_b64_tr_b16 v[98:99], v104 offset:8480
    ds_read_b64_tr_b16 v[100:101], v104 offset:12320
    ds_read_b64_tr_b16 v[102:103], v104 offset:12576
    v_bfe_u32 v105, v0, 1, 3
    v_lshlrev_b32 v105, 8, v105
    v_lshl_add_u32 v105, v109, 5, v105
    v_lshl_add_u32 v105, v110, 4, v105
    v_lshrrev_b32 v106, 3, v0
    v_lshlrev_b32 v106, 7, v106
    v_and_b32 v110, 7, v0
    v_lshl_add_u32 v107, v110, 3, v106
    v_add_u32 v107, s100, v107
    v_lshlrev_b32 v106, 8, v109
    v_and_b32 v110, 15, v0
    v_lshl_add_u32 v106, v110, 2, v106
    v_add_u32 v106, s96, v106
    v_lshlrev_b32 v108, 2, v0
    s_lshl_b32 s96, s62, 2
    s_add_u32 s96, s96, 162088
    v_mov_b32 v109, s96
    s_lshl_b32 s100, s63, 11
    s_lshl_b32 s96, s34, 13
    s_add_u32 s100, s100, s96
    s_add_u32 s100, s100, 106496
    s_mul_i32 s101, s34, 5120
    s_lshl_b32 s96, s35, 9
    s_add_u32 s101, s101, s96
    s_lshl_b32 s96, s62, 8
    s_add_u32 s101, s101, s96
    s_sub_u32 s101, s101, 11264
    s_and_b32 s96, s101, 0xffffe000
    s_add_u32 s101, s101, s96
    s_add_u32 s101, s101, 212992
    v_add_u32 v110, 8192, v108
L_nofrag_109:
    s_cmp_ge_u32 s35, 20
    s_cbranch_scc1 L_nofin_111
    s_lshl1_add_u32 s62, s35, s3
    s_sub_u32 s62, s62, 6
    s_lshl_b32 s57, s62, 7
    s_mul_i32 s63, s62, 0x199a
    s_lshr_b32 s63, s63, 16
    s_mul_i32 s63, s63, 1280
    s_sub_u32 s63, s57, s63
    v_lshrrev_b32 v72, 3, v0
    v_mul_u32_u24 v72, 5120, v72
    v_and_b32 v8, 7, v0
    v_lshl_add_u32 v72, v8, 4, v72
    s_add_u32 s62, s57, 327680
    v_add_u32 v72, s62, v72
    v_add_u32 v73, 40960, v72
    v_add_u32 v74, 81920, v72
    v_add_u32 v75, 122880, v72
    v_bfe_u32 v9, v0, 4, 1
    v_lshlrev_b32 v76, 4, v8
    v_lshl_add_u32 v76, v9, 3, v76
    s_lshl_b32 s62, s57, 1
    s_add_u32 s62, s62, 99328
    v_lshl_add_u32 v77, v76, 1, s62
    s_mov_b32 s48, s22
    s_mov_b32 s49, s23
    s_mov_b32 s50, 1280
    s_mov_b32 s51, 0x20000
    buffer_load_dwordx2 v[86:87], v76, s[48:51], s63 offen
    s_add_u32 s62, s57, 35840
    s_branch L_poll_112
L_poll_112s:
    s_sleep 32
L_poll_112:
    buffer_load_dwordx2 v[8:9], v76, s[40:43], s62 offen sc1
    s_sub_u32 s60, s60, 1
    s_cbranch_scc1 L_poll_112t
    s_waitcnt vmcnt(0)
    v_max_u32 v38, v8, v9
    v_cmp_eq_u32 vcc, -1, v38
    s_cbranch_vccnz L_poll_112s
L_poll_112e:
    v_lshlrev_b32 v78, 16, v86
    v_and_b32 v79, 0xffff0000, v86
    v_lshlrev_b32 v82, 16, v8
    v_and_b32 v83, 0xffff0000, v8
    v_lshlrev_b32 v80, 16, v87
    v_and_b32 v81, 0xffff0000, v87
    v_lshlrev_b32 v84, 16, v9
    v_and_b32 v85, 0xffff0000, v9
    v_bfe_u32 v8, v0, 1, 3
    v_and_b32 v9, 1, v0
    v_lshlrev_b32 v9, 4, v9
    v_mov_b32 v10, 0x3f80
    v_lshlrev_b32 v9, v9, v10
    v_cmp_eq_u32 vcc, 0, v8
    v_mov_b32 v100, 0
    s_nop 0
    v_cndmask_b32 v104, 0, v9, vcc
    v_cmp_eq_u32 vcc, 1, v8
    v_mov_b32 v101, 0
    s_nop 0
    v_cndmask_b32 v105, 0, v9, vcc
    v_cmp_eq_u32 vcc, 2, v8
    v_mov_b32 v102, 0
    s_nop 0
    v_cndmask_b32 v106, 0, v9, vcc
    v_cmp_eq_u32 vcc, 3, v8
    v_mov_b32 v103, 0
    s_nop 0
    v_cndmask_b32 v107, 0, v9, vcc
L_nofin_111:
    v_mov_b32 v12, 162076
L_lw_113:
    ds_read_b32 v13, v12
    s_waitcnt lgkmcnt(0)
    v_cmp_gt_u32 vcc, 4, v13
    s_cbranch_vccz L_lw_113e
    s_sleep 4
    s_sub_u32 s60, s60, 1
    s_cbranch_scc0 L_lw_113
    s_mov_b32 s60, 0
L_lw_113e:
    v_and_b32 v11, 31, v0
    v_lshlrev_b32 v11, 7, v11
    s_lshl_b32 s63, s34, 12
    s_add_u32 s63, s63, 73792
    buffer_load_dword v12, v39, s[40:43], s98 offen sc1
    s_branch L_poll_114
L_poll_114s:
    s_sleep 4
L_poll_114:
    buffer_load_dwordx2 v[8:9], v21, s[40:43], s99 offen sc1
    buffer_load_dword v10, v11, s[40:43], s63 offen sc1
    s_sub_u32 s60, s60, 1
    s_cbranch_scc1 L_poll_114t
    s_waitcnt vmcnt(0)
    v_max3_u32 v38, v8, v9, v10
    v_cmp_eq_u32 vcc, -1, v38
    s_cbranch_vccnz L_poll_114s
L_poll_114e:
    v_mov_b32 v37, v8
    s_nop 1
    v_max_f32_dpp v37, v37, v37 quad_perm:[1,0,3,2] row_mask:0xf bank_mask:0xf
    s_nop 1
    v_max_f32_dpp v37, v37, v37 quad_perm:[2,3,0,1] row_mask:0xf bank_mask:0xf
    s_nop 1
    v_max_f32_dpp v37, v37, v37 row_ror:4 row_mask:0xf bank_mask:0xf
    s_nop 1
    v_max_f32_dpp v37, v37, v37 row_ror:8 row_mask:0xf bank_mask:0xf
    v_sub_f32 v8, v8, v37
    v_exp_f32 v8, v8
    s_nop 0
    v_mul_f32 v9, v8, v9
    s_nop 1
    v_add_f32_dpp v9, v9, v9 quad_perm:[1,0,3,2] row_mask:0xf bank_mask:0xf
    s_nop 1
    v_add_f32_dpp v9, v9, v9 quad_perm:[2,3,0,1] row_mask:0xf bank_mask:0xf
    s_nop 1
    v_add_f32_dpp v9, v9, v9 row_ror:4 row_mask:0xf bank_mask:0xf
    s_nop 1
    v_add_f32_dpp v9, v9, v9 row_ror:8 row_mask:0xf bank_mask:0xf
    v_ashrrev_i32 v12, 8, v10
    s_nop 1
    v_add_u32_dpp v12, v12, v12 quad_perm:[1,0,3,2] row_mask:0xf bank_mask:0xf
    s_nop 1
    v_add_u32_dpp v12, v12, v12 quad_perm:[2,3,0,1] row_mask:0xf bank_mask:0xf
    s_nop 1
    v_add_u32_dpp v12, v12, v12 row_ror:4 row_mask:0xf bank_mask:0xf
    s_nop 1
    v_add_u32_dpp v12, v12, v12 row_ror:8 row_mask:0xf bank_mask:0xf
    v_mov_b32 v13, v12
    s_nop 1
    v_permlane16_swap_b32 v12, v13
    v_add_u32 v12, v12, v13
    v_mov_b32 v13, v12
    s_nop 1
    v_permlane32_swap_b32 v12, v13
    v_add_u32 v12, v12, v13
    v_ashrrev_i32 v12, 31, v12
    v_and_b32 v12, 8192, v12
    v_mov_b32 v13, 162084
    ds_write_b32 v13, v12
    v_and_b32 v10, 0xff, v10
    s_getreg_b32 s62, hwreg(HW_REG_XCC_ID, 0, 4)
    v_cmp_ne_u32 vcc, s62, v10
    s_nop 0
    s_cmp_eq_u64 vcc, 0
    s_cselect_b32 s61, 1, 0
    v_rcp_f32 v9, v9
    v_lshrrev_b32 v3, 1, v2
    v_add_u32 v3, 161984, v3
    v_mul_f32 v8, v8, v9
    v_mov_b32 v10, 162072
    v_mov_b32 v11, s61
    ds_write_b32 v3, v8
    ds_write_b32 v10, v11
    s_cmp_eq_u32 s61, 1
    s_cbranch_scc0 L_ycs
    buffer_store_dwordx4 v[24:27], v22, s[40:43], 0 offen offset:0
    buffer_store_dwordx4 v[24:27], v22, s[40:43], 0 offen offset:1024
    buffer_store_dwordx4 v[24:27], v22, s[40:43], 0 offen offset:2048
    buffer_store_dwordx4 v[24:27], v22, s[40:43], 0 offen offset:3072
    buffer_store_dwordx4 v[24:27], v23, s[40:43], 0 offen offset:0
L_ycd:
    s_branch L_poll_115
L_poll_115s:
    s_sleep 4
L_poll_115:
    buffer_load_dwordx4 v[32:35], v20, s[40:43], s97 offen sc1
    s_sub_u32 s60, s60, 1
    s_cbranch_scc1 L_poll_115t
    s_waitcnt vmcnt(0)
    v_max3_u32 v38, v32, v33, v34
    v_max_u32 v38, v38, v35
    v_cmp_eq_u32 vcc, -1, v38
    s_cbranch_vccnz L_poll_115s
L_poll_115e:
    s_branch L_pxj
L_px6:
    s_or_b32 s96, s59, s39
    s_cbranch_scc0 L_nofrag_116
    v_mov_b32 v104, 162060
L_lw_117:
    ds_read_b32 v105, v104
    s_waitcnt lgkmcnt(0)
    v_cmp_gt_u32 vcc, 4, v105
    s_cbranch_vccz L_lw_117e
    s_sleep 2
    s_sub_u32 s60, s60, 1
    s_cbranch_scc0 L_lw_117
    s_mov_b32 s60, 0
L_lw_117e:
    s_cmp_eq_u32 s59, 0
    s_cbranch_scc1 L_nofrag_116
    v_bfe_u32 v104, v0, 2, 1
    v_bfe_u32 v110, v0, 4, 1
    v_lshl_add_u32 v104, v110, 2, v104
    v_and_b32 v110, 8, v0
    v_add_u32 v104, v104, v110
    v_lshrrev_b32 v110, 5, v0
    v_lshl_add_u32 v104, v110, 4, v104
    v_bfe_u32 v111, v0, 0, 1
    v_mul_u32_u24 v111, 0xaaaa, v111
    v_add_u32 v111, 0x4444, v111
    v_mov_b32 v112, 0
    v_mov_b32 v113, 0
    v_mov_b32 v114, 0
    v_mov_b32 v115, 0
    v_mov_b32 v116, 0
    v_mov_b32 v117, 0
    v_mov_b32 v118, 0
    v_mov_b32 v119, 0
    v_lshlrev_b32 v104, 7, v104
    v_and_b32 v110, 3, v0
    v_lshl_add_u32 v104, v110, 3, v104
    v_lshrrev_b32 v109, 4, v0
    v_and_b32 v110, 1, v0
    s_lshr_b32 s63, s3, 1
    s_and_b32 s62, s3, 1
    s_lshl_b32 s96, s63, 14
    s_lshl_b32 s100, s62, 6
    s_add_u32 s100, s100, 81920
    s_add_u32 s96, s96, s100
    v_add_u32 v104, s96, v104
    ds_read_b64_tr_b16 v[72:73], v104 offset:0
    ds_read_b64_tr_b16 v[74:75], v104 offset:256
    ds_read_b64_tr_b16 v[76:77], v104 offset:4096
    ds_read_b64_tr_b16 v[78:79], v104 offset:4352
    ds_read_b64_tr_b16 v[80:81], v104 offset:32
    ds_read_b64_tr_b16 v[82:83], v104 offset:288
    ds_read_b64_tr_b16 v[84:85], v104 offset:4128
    ds_read_b64_tr_b16 v[86:87], v104 offset:4384
    ds_read_b64_tr_b16 v[88:89], v104 offset:8192
    ds_read_b64_tr_b16 v[90:91], v104 offset:8448
    ds_read_b64_tr_b16 v[92:93], v104 offset:12288
    ds_read_b64_tr_b16 v[94:95], v104 offset:12544
    ds_read_b64_tr_b16 v[96:97], v104 offset:8224
    ds_read_b64_tr_b16 v[98:99], v104 offset:8480
    ds_read_b64_tr_b16 v[100:101], v104 offset:12320
    ds_read_b64_tr_b16 v[102:103], v104 offset:12576
    v_bfe_u32 v105, v0, 1, 3
    v_lshlrev_b32 v105, 8, v105
    v_lshl_add_u32 v105, v109, 5, v105
    v_lshl_add_u32 v105, v110, 4, v105
    v_lshrrev_b32 v106, 3, v0
    v_lshlrev_b32 v106, 7, v106
    v_and_b32 v110, 7, v0
    v_lshl_add_u32 v107, v110, 3, v106
    v_add_u32 v107, s100, v107
    v_lshlrev_b32 v106, 8, v109
    v_and_b32 v110, 15, v0
    v_lshl_add_u32 v106, v110, 2, v106
    v_add_u32 v106, s96, v106
    v_lshlrev_b32 v108, 2, v0
    s_lshl_b32 s96, s62, 2
    s_add_u32 s96, s96, 162088
    v_mov_b32 v109, s96
    s_lshl_b32 s100, s63, 11
    s_lshl_b32 s96, s34, 13
    s_add_u32 s100, s100, s96
    s_add_u32 s100, s100, 106496
    s_mul_i32 s101, s34, 5120
    s_lshl_b32 s96, s35, 9
    s_add_u32 s101, s101, s96
    s_lshl_b32 s96, s62, 8
    s_add_u32 s101, s101, s96
    s_sub_u32 s101, s101, 11264
    s_and_b32 s96, s101, 0xffffe000
    s_add_u32 s101, s101, s96
    s_add_u32 s101, s101, 212992
    v_add_u32 v110, 8192, v108
L_nofrag_116:
    s_mov_b32 s62, 3
    s_lshl1_add_u32 s96, s35, s3
    s_and_b32 s63, s96, 7
    s_lshl_b32 s63, s63, 14
    s_lshl_b32 s96, s96, 7
    s_add_u32 s96, s96, s63
    s_add_u32 s96, s96, 475136
    s_add_u32 s98, s32, s96
    s_addc_u32 s99, s33, 0
    s_load_dword s4, s[98:99], 0 glc
    s_load_dword s5, s[98:99], 8192 glc
    s_mov_b32 s63, 0
    s_waitcnt lgkmcnt(0)
L_np:
    s_not_b32 s4, s4
    s_mov_b32 s6, s4
    s_mov_b32 s7, 0
    s_load_dword s4, s[98:99], 0 glc
L_npc0:
    s_add_u32 s7, s7, 1
    s_cmp_eq_u32 s4, s6
    s_cselect_b32 s8, s7, 1000
    s_cmp_lt_u32 s8, 60
    s_cbranch_scc1 L_npc0
    s_waitcnt lgkmcnt(0)
    s_sub_u32 s63, s63, s7
    s_not_b32 s5, s5
    s_mov_b32 s6, s5
    s_mov_b32 s7, 0
    s_load_dword s5, s[98:99], 8192 glc
L_npc1:
    s_add_u32 s7, s7, 1
    s_cmp_eq_u32 s5, s6
    s_cselect_b32 s8, s7, 1000
    s_cmp_lt_u32 s8, 60
    s_cbranch_scc1 L_npc1
    s_waitcnt lgkmcnt(0)
    s_add_u32 s63, s63, s7
    s_sub_u32 s62, s62, 1
    s_cmp_lg_u32 s62, 0
    s_cbranch_scc1 L_np
    v_mov_b32 v8, 162096
    v_mov_b32 v9, s63
    s_mov_b64 exec, 1
    ds_add_u32 v8, v9
    s_mov_b64 exec, -1
    v_mov_b32 v8, 162068
L_lw_118:
    ds_read_b32 v9, v8
    s_waitcnt lgkmcnt(0)
    v_cmp_gt_u32 vcc, 1, v9
    s_cbranch_vccz L_lw_118e
    s_sleep 32
    s_sub_u32 s60, s60, 1
    s_cbranch_scc0 L_lw_118
    s_mov_b32 s60, 0
L_lw_118e:
    s_cmp_ge_u32 s35, 20
    s_cbranch_scc1 L_nofin_119
    s_lshl1_add_u32 s62, s35, s3
    s_sub_u32 s62, s62, 6
    s_lshl_b32 s57, s62, 7
    s_mul_i32 s63, s62, 0x199a
    s_lshr_b32 s63, s63, 16
    s_mul_i32 s63, s63, 1280
    s_sub_u32 s63, s57, s63
    v_lshrrev_b32 v72, 3, v0
    v_mul_u32_u24 v72, 5120, v72
    v_and_b32 v8, 7, v0
    v_lshl_add_u32 v72, v8, 4, v72
    s_add_u32 s62, s57, 327680
    v_add_u32 v72, s62, v72
    v_add_u32 v73, 40960, v72
    v_add_u32 v74, 81920, v72
    v_add_u32 v75, 122880, v72
    v_bfe_u32 v9, v0, 4, 1
    v_lshlrev_b32 v76, 4, v8
    v_lshl_add_u32 v76, v9, 3, v76
    s_lshl_b32 s62, s57, 1
    s_add_u32 s62, s62, 99328
    v_lshl_add_u32 v77, v76, 1, s62
    s_mov_b32 s48, s22
    s_mov_b32 s49, s23
    s_mov_b32 s50, 1280
    s_mov_b32 s51, 0x20000
    buffer_load_dwordx2 v[86:87], v76, s[48:51], s63 offen
    s_add_u32 s62, s57, 35840
    s_branch L_poll_120
L_poll_120s:
    s_sleep 32
L_poll_120:
    buffer_load_dwordx2 v[8:9], v76, s[40:43], s62 offen sc1
    s_sub_u32 s60, s60, 1
    s_cbranch_scc1 L_poll_120t
    s_waitcnt vmcnt(0)
    v_max_u32 v38, v8, v9
    v_cmp_eq_u32 vcc, -1, v38
    s_cbranch_vccnz L_poll_120s
L_poll_120e:
    v_lshlrev_b32 v78, 16, v86
    v_and_b32 v79, 0xffff0000, v86
    v_lshlrev_b32 v82, 16, v8
    v_and_b32 v83, 0xffff0000, v8
    v_lshlrev_b32 v80, 16, v87
    v_and_b32 v81, 0xffff0000, v87
    v_lshlrev_b32 v84, 16, v9
    v_and_b32 v85, 0xffff0000, v9
    v_bfe_u32 v8, v0, 1, 3
    v_and_b32 v9, 1, v0
    v_lshlrev_b32 v9, 4, v9
    v_mov_b32 v10, 0x3f80
    v_lshlrev_b32 v9, v9, v10
    v_cmp_eq_u32 vcc, 0, v8
    v_mov_b32 v100, 0
    s_nop 0
    v_cndmask_b32 v104, 0, v9, vcc
    v_cmp_eq_u32 vcc, 1, v8
    v_mov_b32 v101, 0
    s_nop 0
    v_cndmask_b32 v105, 0, v9, vcc
    v_cmp_eq_u32 vcc, 2, v8
    v_mov_b32 v102, 0
    s_nop 0
    v_cndmask_b32 v106, 0, v9, vcc
    v_cmp_eq_u32 vcc, 3, v8
    v_mov_b32 v103, 0
    s_nop 0
    v_cndmask_b32 v107, 0, v9, vcc
L_nofin_119:
    v_mov_b32 v8, 162076
L_lw_121:
    ds_read_b32 v9, v8
    s_waitcnt lgkmcnt(0)
    v_cmp_gt_u32 vcc, 4, v9
    s_cbranch_vccz L_lw_121e
    s_sleep 16
    s_sub_u32 s60, s60, 1
    s_cbranch_scc0 L_lw_121
    s_mov_b32 s60, 0
L_lw_121e:
    s_branch L_poll_122
L_poll_122s:
    s_sleep 4
L_poll_122:
    buffer_load_dwordx4 v[32:35], v20, s[40:43], s97 offen sc1
    s_sub_u32 s60, s60, 1
    s_cbranch_scc1 L_poll_122t
    s_waitcnt vmcnt(0)
    v_max3_u32 v38, v32, v33, v34
    v_max_u32 v38, v38, v35
    v_cmp_eq_u32 vcc, -1, v38
    s_cbranch_vccnz L_poll_122s
L_poll_122e:
L_pxj:
    s_cmp_ge_u32 s35, 20
    s_cbranch_scc1 L_pxk
    s_mov_b64 exec, -1
L_pxk:
    v_mov_b32 v8, 162048
L_lw_123:
    ds_read_b32 v9, v8
    s_waitcnt lgkmcnt(0)
    v_cmp_gt_u32 vcc, 3, v9
    s_cbranch_vccz L_lw_123e
    s_sleep 2
    s_sub_u32 s60, s60, 1
    s_cbranch_scc0 L_lw_123
    s_mov_b32 s60, 0
L_lw_123e:
    v_lshrrev_b32 v9, 4, v0
    v_lshl_add_u32 v8, v9, 2, v2
    s_lshl_b32 s96, s3, 9
    s_add_u32 s96, s96, 157824
    v_lshl_add_u32 v8, v8, 2, s96
    v_lshlrev_b32 v9, 3, v0
    v_add_u32 v9, 157824, v9
    v_mov_b32 v10, 162048
    v_mov_b32 v11, 1
    s_lshl_b32 s96, s38, 5
    s_add_u32 s96, s96, 161984
    v_mov_b32 v3, s96
    s_sub_u32 s62, 8, s39
    s_lshl_b32 s98, s34, 5
    s_add_u32 s98, s98, s35
    s_lshl_b32 s98, s98, 8
    s_add_u32 s98, s98, 106496
    v_lshlrev_b32 v39, 2, v0
    s_branch L_t0
L_s_role:
    s_cmp_eq_u32 s3, 7
    s_cbranch_scc1 L_t2gate
    s_cmp_gt_u32 s3, 3
    s_cbranch_scc1 L_fin_prep
    s_mov_b32 s48, s18
    s_mov_b32 s49, s19
    s_mov_b32 s50, 3456
    s_mov_b32 s51, 0x20000
    v_lshrrev_b32 v3, 4, v0
    v_and_b32 v4, 15, v0
    v_lshlrev_b32 v4, 1, v4
    s_lshl_b32 s62, s35, 7
    s_lshl_b32 s63, s3, 5
    s_add_u32 s62, s62, s63
    buffer_load_ushort v82, v4, s[48:51], s62 offen
    v_mov_b32 v72, 162064
L_lw_124:
    ds_read_b32 v73, v72
    s_waitcnt lgkmcnt(0)
    v_cmp_gt_u32 vcc, 4, v73
    s_cbranch_vccz L_lw_124e
    s_sleep 2
    s_sub_u32 s60, s60, 1
    s_cbranch_scc0 L_lw_124
    s_mov_b32 s60, 0
L_lw_124e:
    v_bfe_u32 v72, v0, 2, 1
    v_bfe_u32 v73, v0, 4, 1
    v_lshl_add_u32 v72, v73, 2, v72
    v_and_b32 v73, 8, v0
    v_add_u32 v72, v72, v73
    v_lshrrev_b32 v73, 5, v0
    v_lshl_add_u32 v72, v73, 4, v72
    v_lshlrev_b32 v72, 7, v72
    v_and_b32 v73, 3, v0
    v_lshl_add_u32 v72, v73, 3, v72
    v_and_b32 v73, 8, v0
    v_lshl_add_u32 v72, v73, 3, v72
    v_xor_b32 v72, s63, v72
    v_xor_b32 v73, 32, v72
    v_add_u32 v74, 40960, v72
    v_add_u32 v75, 40960, v73
    v_bfe_u32 v1, v0, 2, 2
    v_bfe_u32 v2, v0, 1, 1
    v_and_b32 v6, 1, v0
    v_lshlrev_b32 v7, 5, v3
    v_lshl_add_u32 v7, v6, 4, v7
    v_lshl_add_u32 v5, v2, 2, v1
    v_mul_u32_u24 v5, 1296, v5
    v_add_u32 v5, v5, v7
    v_add_u32 v5, 147456, v5
    v_bfe_u32 v87, v0, 0, 1
    v_mul_u32_u24 v87, 0xaaaa, v87
    v_add_u32 v87, 0x4444, v87
    ds_read_b64_tr_b16 v[88:89], v72 offset:0
    ds_read_b64_tr_b16 v[90:91], v73 offset:256
    ds_read_b64_tr_b16 v[92:93], v72 offset:4096
    ds_read_b64_tr_b16 v[94:95], v73 offset:4352
    ds_read_b64_tr_b16 v[96:97], v72 offset:8192
    ds_read_b64_tr_b16 v[98:99], v73 offset:8448
    ds_read_b64_tr_b16 v[100:101], v72 offset:12288
    ds_read_b64_tr_b16 v[102:103], v73 offset:12544
    ds_read_b64_tr_b16 v[104:105], v72 offset:16384
    ds_read_b64_tr_b16 v[106:107], v73 offset:16640
    ds_read_b64_tr_b16 v[108:109], v72 offset:20480
    ds_read_b64_tr_b16 v[110:111], v73 offset:20736
    ds_read_b64_tr_b16 v[112:113], v72 offset:24576
    ds_read_b64_tr_b16 v[114:115], v73 offset:24832
    ds_read_b64_tr_b16 v[116:117], v72 offset:28672
    ds_read_b64_tr_b16 v[118:119], v73 offset:28928
    ds_read_b64_tr_b16 v[120:121], v72 offset:32768
    ds_read_b64_tr_b16 v[122:123], v73 offset:33024
    ds_read_b64_tr_b16 v[124:125], v72 offset:36864
    ds_read_b64_tr_b16 v[126:127], v73 offset:37120
    ds_read_b64_tr_b16 v[128:129], v74 offset:0
    ds_read_b64_tr_b16 v[130:131], v75 offset:256
    ds_read_b64_tr_b16 v[132:133], v74 offset:4096
    ds_read_b64_tr_b16 v[134:135], v75 offset:4352
    ds_read_b64_tr_b16 v[136:137], v74 offset:8192
    ds_read_b64_tr_b16 v[138:139], v75 offset:8448
    ds_read_b64_tr_b16 v[140:141], v74 offset:12288
    ds_read_b64_tr_b16 v[142:143], v75 offset:12544
    ds_read_b64_tr_b16 v[144:145], v74 offset:16384
    ds_read_b64_tr_b16 v[146:147], v75 offset:16640
    ds_read_b64_tr_b16 v[148:149], v74 offset:20480
    ds_read_b64_tr_b16 v[150:151], v75 offset:20736
    ds_read_b64_tr_b16 v[152:153], v74 offset:24576
    ds_read_b64_tr_b16 v[154:155], v75 offset:24832
    ds_read_b64_tr_b16 v[156:157], v74 offset:28672
    ds_read_b64_tr_b16 v[158:159], v75 offset:28928
    ds_read_b64_tr_b16 v[160:161], v74 offset:32768
    ds_read_b64_tr_b16 v[162:163], v75 offset:33024
    ds_read_b64_tr_b16 v[164:165], v74 offset:36864
    ds_read_b64_tr_b16 v[166:167], v75 offset:37120
    ds_read_b128 v[8:11], v5 offset:0
    ds_read_b128 v[12:15], v5 offset:128
    ds_read_b128 v[16:19], v5 offset:256
    ds_read_b128 v[20:23], v5 offset:384
    ds_read_b128 v[24:27], v5 offset:512
    ds_read_b128 v[28:31], v5 offset:640
    ds_read_b128 v[32:35], v5 offset:768
    ds_read_b128 v[36:39], v5 offset:896
    ds_read_b128 v[40:43], v5 offset:1024
    ds_read_b128 v[44:47], v5 offset:1152
    v_mov_b32 v48, 0
    v_mov_b32 v49, 0
    v_mov_b32 v50, 0
    v_mov_b32 v51, 0
    v_mov_b32 v52, 0
    v_mov_b32 v53, 0
    v_mov_b32 v54, 0
    v_mov_b32 v55, 0
    v_mov_b32 v56, 0
    v_mov_b32 v57, 0
    v_mov_b32 v58, 0
    v_mov_b32 v59, 0
    s_waitcnt lgkmcnt(9)
    v_smfmac_f32_16x16x64_bf16 v[48:51], v[8:11], v[88:95], v87
    s_waitcnt lgkmcnt(8)
    v_smfmac_f32_16x16x64_bf16 v[48:51], v[12:15], v[96:103], v87
    s_waitcnt lgkmcnt(7)
    v_smfmac_f32_16x16x64_bf16 v[48:51], v[16:19], v[104:111], v87
    s_waitcnt lgkmcnt(6)
    v_smfmac_f32_16x16x64_bf16 v[48:51], v[20:23], v[112:119], v87
    s_waitcnt lgkmcnt(5)
    v_smfmac_f32_16x16x64_bf16 v[48:51], v[24:27], v[120:127], v87
    s_waitcnt lgkmcnt(4)
    v_smfmac_f32_16x16x64_bf16 v[48:51], v[28:31], v[128:135], v87
    s_waitcnt lgkmcnt(3)
    v_smfmac_f32_16x16x64_bf16 v[48:51], v[32:35], v[136:143], v87
    s_waitcnt lgkmcnt(2)
    v_smfmac_f32_16x16x64_bf16 v[48:51], v[36:39], v[144:151], v87
    s_waitcnt lgkmcnt(1)
    v_smfmac_f32_16x16x64_bf16 v[48:51], v[40:43], v[152:159], v87
    s_waitcnt lgkmcnt(0)
    v_smfmac_f32_16x16x64_bf16 v[48:51], v[44:47], v[160:167], v87
    v_mul_u32_u24 v79, 1296, v1
    v_lshl_add_u32 v79, v2, 7, v79
    v_add_u32 v79, v79, v7
    v_add_u32 v79, 82944, v79
    v_mul_u32_u24 v80, 144, v3
    v_add3_u32 v80, v80, v4, s63
    v_add_u32 v80, 90688, v80
    v_lshlrev_b32 v81, 3, v0
    v_add_u32 v81, 88128, v81
    v_add_f32 v84, v48, v49
    v_add_f32 v85, v50, v51
    s_mov_b32 s62, 0xbacccccd
    s_mov_b32 s63, 0xbdd2d3e8
    v_mov_b32 v86, 0xc0135761
    s_waitcnt vmcnt(0)
    v_lshlrev_b32 v82, 16, v82
    v_add_f32 v85, v85, v82
    s_branch L_ffn1
L_fin_prep:
    s_cmp_lg_u32 s3, 6
    s_cbranch_scc1 L_end
    s_cmp_ge_u32 s35, 20
    s_cbranch_scc1 L_end
    s_barrier
L_fin:
    s_mov_b32 s52, s28
    s_mov_b32 s53, s29
    s_mov_b32 s54, 5120
    s_mov_b32 s55, 0x20000
    s_mov_b64 s[4:5], -1
    s_mov_b64 s[6:7], -1
    s_mov_b64 s[8:9], -1
    s_mov_b64 s[10:11], 0xffffff
    s_barrier
    ds_read_b128 v[108:111], v77
    s_barrier
L_yg:
    s_mov_b64 exec, s[4:5]
    buffer_load_dwordx4 v[88:91], v72, s[40:43], 0 offen sc1
    s_mov_b64 exec, s[6:7]
    buffer_load_dwordx4 v[92:95], v73, s[40:43], 0 offen sc1
    s_mov_b64 exec, s[8:9]
    buffer_load_dwordx4 v[96:99], v74, s[40:43], 0 offen sc1
    s_mov_b64 exec, s[10:11]
    buffer_load_dwordx4 v[100:103], v75, s[40:43], 0 offen sc1
    s_mov_b64 exec, -1
    s_sub_u32 s60, s60, 1
    s_cbranch_scc1 L_ygt
    s_waitcnt vmcnt(3)
    v_max3_u32 v3, v88, v89, v90
    v_max_u32 v3, v3, v91
    v_cmp_eq_u32 s[4:5], -1, v3
    s_waitcnt vmcnt(2)
    v_max3_u32 v3, v92, v93, v94
    v_max_u32 v3, v3, v95
    v_cmp_eq_u32 s[6:7], -1, v3
    s_waitcnt vmcnt(1)
    v_max3_u32 v3, v96, v97, v98
    v_max_u32 v3, v3, v99
    v_cmp_eq_u32 s[8:9], -1, v3
    s_waitcnt vmcnt(0)
    v_max3_u32 v3, v100, v101, v102
    v_max_u32 v3, v3, v103
    v_cmp_eq_u32 s[10:11], -1, v3
    s_or_b64 s[16:17], s[4:5], s[6:7]
    s_or_b64 s[16:17], s[16:17], s[8:9]
    s_or_b64 s[16:17], s[16:17], s[10:11]
    s_cbranch_scc1 L_yg
L_ygd:
    v_mfma_f32_16x16x32_bf16 v[112:115], v[104:107], v[88:91], 0
    v_mfma_f32_16x16x32_bf16 v[112:115], v[104:107], v[92:95], v[112:115]
    v_mfma_f32_16x16x32_bf16 v[112:115], v[104:107], v[96:99], v[112:115]
    v_mfma_f32_16x16x32_bf16 v[112:115], v[104:107], v[100:103], v[112:115]
    s_waitcnt lgkmcnt(0)
    v_pk_fma_f32 v[108:109], v[78:79], v[82:83], v[108:109]
    v_pk_fma_f32 v[110:111], v[80:81], v[84:85], v[110:111]
    s_nop 4
    v_add_f32_dpp v112, v112, v112 row_ror:8 row_mask:0xf bank_mask:0xf
    v_add_f32_dpp v113, v113, v113 row_ror:8 row_mask:0xf bank_mask:0xf
    v_add_f32_dpp v114, v114, v114 row_ror:8 row_mask:0xf bank_mask:0xf
    v_add_f32_dpp v115, v115, v115 row_ror:8 row_mask:0xf bank_mask:0xf
    v_pk_fma_f32 v[112:113], v[112:113], v[82:83], v[108:109]
    v_pk_fma_f32 v[114:115], v[114:115], v[84:85], v[110:111]
    v_cvt_pk_bf16_f32 v112, v112, v113
    v_cvt_pk_bf16_f32 v113, v114, v115
    s_mov_b64 exec, 0x00ff00ff
    buffer_store_dwordx2 v[112:113], v76, s[52:55], s57 offen
    s_endpgm
L_t2gate:
    v_mov_b32 v8, 162048
L_lw_125:
    ds_read_b32 v9, v8
    s_waitcnt lgkmcnt(0)
    v_cmp_gt_u32 vcc, 8, v9
    s_cbranch_vccz L_lw_125e
    s_sleep 2
    s_sub_u32 s60, s60, 1
    s_cbranch_scc0 L_lw_125
    s_mov_b32 s60, 0
L_lw_125e:
    ds_read_b32 v9, v8 offset:24
    ds_read_b32 v10, v8 offset:36
    v_add_u32 v5, 212992, v5
    s_waitcnt lgkmcnt(0)
    v_readfirstlane_b32 s61, v9
    v_add_u32 v5, v5, v10
    s_mov_b32 s58, 0x3f80
    s_mov_b32 s59, 0x3f800000
    s_mov_b32 s63, 0xff
L_prb:
    s_bcnt1_i32_b32 s62, s63
    s_mov_b32 s97, s63
    s_ff1_i32_b32 s12, s97
    s_bitset0_b32 s97, s12
    s_mul_i32 s4, s12, 5120
    s_add_u32 s4, s4, s56
    s_and_b32 s96, s4, 0xffffe000
    s_add_u32 s4, s4, s96
    s_cmp_eq_u32 s62, 1
    s_cbranch_scc1 L_pi1
    s_ff1_i32_b32 s13, s97
    s_bitset0_b32 s97, s13
    s_mul_i32 s5, s13, 5120
    s_add_u32 s5, s5, s56
    s_and_b32 s96, s5, 0xffffe000
    s_add_u32 s5, s5, s96
    s_cmp_eq_u32 s62, 2
    s_cbranch_scc1 L_pi2
    s_ff1_i32_b32 s14, s97
    s_bitset0_b32 s97, s14
    s_mul_i32 s6, s14, 5120
    s_add_u32 s6, s6, s56
    s_and_b32 s96, s6, 0xffffe000
    s_add_u32 s6, s6, s96
    s_cmp_eq_u32 s62, 3
    s_cbranch_scc1 L_pi3
    s_ff1_i32_b32 s15, s97
    s_bitset0_b32 s97, s15
    s_mul_i32 s7, s15, 5120
    s_add_u32 s7, s7, s56
    s_and_b32 s96, s7, 0xffffe000
    s_add_u32 s7, s7, s96
    s_cmp_eq_u32 s62, 4
    s_cbranch_scc1 L_pi4
    s_ff1_i32_b32 s16, s97
    s_bitset0_b32 s97, s16
    s_mul_i32 s8, s16, 5120
    s_add_u32 s8, s8, s56
    s_and_b32 s96, s8, 0xffffe000
    s_add_u32 s8, s8, s96
    s_cmp_eq_u32 s62, 5
    s_cbranch_scc1 L_pi5
    s_ff1_i32_b32 s17, s97
    s_bitset0_b32 s97, s17
    s_mul_i32 s9, s17, 5120
    s_add_u32 s9, s9, s56
    s_and_b32 s96, s9, 0xffffe000
    s_add_u32 s9, s9, s96
    s_cmp_eq_u32 s62, 6
    s_cbranch_scc1 L_pi6
    s_ff1_i32_b32 s18, s97
    s_bitset0_b32 s97, s18
    s_mul_i32 s10, s18, 5120
    s_add_u32 s10, s10, s56
    s_and_b32 s96, s10, 0xffffe000
    s_add_u32 s10, s10, s96
    s_cmp_eq_u32 s62, 7
    s_cbranch_scc1 L_pi7
    s_ff1_i32_b32 s19, s97
    s_bitset0_b32 s97, s19
    s_mul_i32 s11, s19, 5120
    s_add_u32 s11, s11, s56
    s_and_b32 s96, s11, 0xffffe000
    s_add_u32 s11, s11, s96
L_pi8:
    buffer_load_dwordx4 v[36:39], v5, s[40:43], s11 offen sc1
L_pi7:
    buffer_load_dwordx4 v[32:35], v5, s[40:43], s10 offen sc1
L_pi6:
    buffer_load_dwordx4 v[28:31], v5, s[40:43], s9 offen sc1
L_pi5:
    buffer_load_dwordx4 v[24:27], v5, s[40:43], s8 offen sc1
L_pi4:
    buffer_load_dwordx4 v[20:23], v5, s[40:43], s7 offen sc1
L_pi3:
    buffer_load_dwordx4 v[16:19], v5, s[40:43], s6 offen sc1
L_pi2:
    buffer_load_dwordx4 v[12:15], v5, s[40:43], s5 offen sc1
    buffer_load_dwordx4 v[8:11], v5, s[40:43], s4 offen sc1
    s_sub_u32 s60, s60, 1
    s_cbranch_scc1 L_pto
    s_waitcnt vmcnt(0)
    v_max3_u32 v3, v8, v9, v10
    v_max_u32 v3, v3, v11
    v_cmp_eq_u32 vcc, -1, v3
    s_cbranch_vccz L_pgot0
    v_max3_u32 v3, v12, v13, v14
    v_max_u32 v3, v3, v15
    v_cmp_eq_u32 vcc, -1, v3
    s_cbranch_vccz L_pgot1
    s_cmp_eq_u32 s62, 2
    s_cbranch_scc1 L_pi2
    v_max3_u32 v3, v16, v17, v18
    v_max_u32 v3, v3, v19
    v_cmp_eq_u32 vcc, -1, v3
    s_cbranch_vccz L_pgot2
    s_cmp_eq_u32 s62, 3
    s_cbranch_scc1 L_pi3
    v_max3_u32 v3, v20, v21, v22
    v_max_u32 v3, v3, v23
    v_cmp_eq_u32 vcc, -1, v3
    s_cbranch_vccz L_pgot3
    s_cmp_eq_u32 s62, 4
    s_cbranch_scc1 L_pi4
    v_max3_u32 v3, v24, v25, v26
    v_max_u32 v3, v3, v27
    v_cmp_eq_u32 vcc, -1, v3
    s_cbranch_vccz L_pgot4
    s_cmp_eq_u32 s62, 5
    s_cbranch_scc1 L_pi5
    v_max3_u32 v3, v28, v29, v30
    v_max_u32 v3, v3, v31
    v_cmp_eq_u32 vcc, -1, v3
    s_cbranch_vccz L_pgot5
    s_cmp_eq_u32 s62, 6
    s_cbranch_scc1 L_pi6
    v_max3_u32 v3, v32, v33, v34
    v_max_u32 v3, v3, v35
    v_cmp_eq_u32 vcc, -1, v3
    s_cbranch_vccz L_pgot6
    s_cmp_eq_u32 s62, 7
    s_cbranch_scc1 L_pi7
    v_max3_u32 v3, v36, v37, v38
    v_max_u32 v3, v3, v39
    v_cmp_eq_u32 vcc, -1, v3
    s_cbranch_vccz L_pgot7
    s_branch L_pi8
L_pgot0:
    v_dot2c_f32_bf16 v64, s58, v8
    v_dot2c_f32_bf16 v65, s59, v8
    v_dot2c_f32_bf16 v66, s58, v9
    v_dot2c_f32_bf16 v67, s59, v9
    v_dot2c_f32_bf16 v68, s58, v10
    v_dot2c_f32_bf16 v69, s59, v10
    v_dot2c_f32_bf16 v70, s58, v11
    v_dot2c_f32_bf16 v71, s59, v11
    s_bitset0_b32 s63, s12
    s_cmp_eq_u32 s63, 0
    s_cbranch_scc1 L_pgd
L_pn0:
    s_cmp_eq_u32 s62, 1
    s_cbranch_scc1 L_prb
    v_max3_u32 v3, v12, v13, v14
    v_max_u32 v3, v3, v15
    v_cmp_eq_u32 vcc, -1, v3
    s_cbranch_vccnz L_pn1
L_pgot1:
    v_dot2c_f32_bf16 v64, s58, v12
    v_dot2c_f32_bf16 v65, s59, v12
    v_dot2c_f32_bf16 v66, s58, v13
    v_dot2c_f32_bf16 v67, s59, v13
    v_dot2c_f32_bf16 v68, s58, v14
    v_dot2c_f32_bf16 v69, s59, v14
    v_dot2c_f32_bf16 v70, s58, v15
    v_dot2c_f32_bf16 v71, s59, v15
    s_bitset0_b32 s63, s13
    s_cmp_eq_u32 s63, 0
    s_cbranch_scc1 L_pgd
L_pn1:
    s_cmp_eq_u32 s62, 2
    s_cbranch_scc1 L_prb
    v_max3_u32 v3, v16, v17, v18
    v_max_u32 v3, v3, v19
    v_cmp_eq_u32 vcc, -1, v3
    s_cbranch_vccnz L_pn2
L_pgot2:
    v_dot2c_f32_bf16 v64, s58, v16
    v_dot2c_f32_bf16 v65, s59, v16
    v_dot2c_f32_bf16 v66, s58, v17
    v_dot2c_f32_bf16 v67, s59, v17
    v_dot2c_f32_bf16 v68, s58, v18
    v_dot2c_f32_bf16 v69, s59, v18
    v_dot2c_f32_bf16 v70, s58, v19
    v_dot2c_f32_bf16 v71, s59, v19
    s_bitset0_b32 s63, s14
    s_cmp_eq_u32 s63, 0
    s_cbranch_scc1 L_pgd
L_pn2:
    s_cmp_eq_u32 s62, 3
    s_cbranch_scc1 L_prb
    v_max3_u32 v3, v20, v21, v22
    v_max_u32 v3, v3, v23
    v_cmp_eq_u32 vcc, -1, v3
    s_cbranch_vccnz L_pn3
L_pgot3:
    v_dot2c_f32_bf16 v64, s58, v20
    v_dot2c_f32_bf16 v65, s59, v20
    v_dot2c_f32_bf16 v66, s58, v21
    v_dot2c_f32_bf16 v67, s59, v21
    v_dot2c_f32_bf16 v68, s58, v22
    v_dot2c_f32_bf16 v69, s59, v22
    v_dot2c_f32_bf16 v70, s58, v23
    v_dot2c_f32_bf16 v71, s59, v23
    s_bitset0_b32 s63, s15
    s_cmp_eq_u32 s63, 0
    s_cbranch_scc1 L_pgd
L_pn3:
    s_cmp_eq_u32 s62, 4
    s_cbranch_scc1 L_prb
    v_max3_u32 v3, v24, v25, v26
    v_max_u32 v3, v3, v27
    v_cmp_eq_u32 vcc, -1, v3
    s_cbranch_vccnz L_pn4
L_pgot4:
    v_dot2c_f32_bf16 v64, s58, v24
    v_dot2c_f32_bf16 v65, s59, v24
    v_dot2c_f32_bf16 v66, s58, v25
    v_dot2c_f32_bf16 v67, s59, v25
    v_dot2c_f32_bf16 v68, s58, v26
    v_dot2c_f32_bf16 v69, s59, v26
    v_dot2c_f32_bf16 v70, s58, v27
    v_dot2c_f32_bf16 v71, s59, v27
    s_bitset0_b32 s63, s16
    s_cmp_eq_u32 s63, 0
    s_cbranch_scc1 L_pgd
L_pn4:
    s_cmp_eq_u32 s62, 5
    s_cbranch_scc1 L_prb
    v_max3_u32 v3, v28, v29, v30
    v_max_u32 v3, v3, v31
    v_cmp_eq_u32 vcc, -1, v3
    s_cbranch_vccnz L_pn5
L_pgot5:
    v_dot2c_f32_bf16 v64, s58, v28
    v_dot2c_f32_bf16 v65, s59, v28
    v_dot2c_f32_bf16 v66, s58, v29
    v_dot2c_f32_bf16 v67, s59, v29
    v_dot2c_f32_bf16 v68, s58, v30
    v_dot2c_f32_bf16 v69, s59, v30
    v_dot2c_f32_bf16 v70, s58, v31
    v_dot2c_f32_bf16 v71, s59, v31
    s_bitset0_b32 s63, s17
    s_cmp_eq_u32 s63, 0
    s_cbranch_scc1 L_pgd
L_pn5:
    s_cmp_eq_u32 s62, 6
    s_cbranch_scc1 L_prb
    v_max3_u32 v3, v32, v33, v34
    v_max_u32 v3, v3, v35
    v_cmp_eq_u32 vcc, -1, v3
    s_cbranch_vccnz L_pn6
L_pgot6:
    v_dot2c_f32_bf16 v64, s58, v32
    v_dot2c_f32_bf16 v65, s59, v32
    v_dot2c_f32_bf16 v66, s58, v33
    v_dot2c_f32_bf16 v67, s59, v33
    v_dot2c_f32_bf16 v68, s58, v34
    v_dot2c_f32_bf16 v69, s59, v34
    v_dot2c_f32_bf16 v70, s58, v35
    v_dot2c_f32_bf16 v71, s59, v35
    s_bitset0_b32 s63, s18
    s_cmp_eq_u32 s63, 0
    s_cbranch_scc1 L_pgd
L_pn6:
    s_cmp_eq_u32 s62, 7
    s_cbranch_scc1 L_prb
    v_max3_u32 v3, v36, v37, v38
    v_max_u32 v3, v3, v39
    v_cmp_eq_u32 vcc, -1, v3
    s_cbranch_vccnz L_pn7
L_pgot7:
    v_dot2c_f32_bf16 v64, s58, v36
    v_dot2c_f32_bf16 v65, s59, v36
    v_dot2c_f32_bf16 v66, s58, v37
    v_dot2c_f32_bf16 v67, s59, v37
    v_dot2c_f32_bf16 v68, s58, v38
    v_dot2c_f32_bf16 v69, s59, v38
    v_dot2c_f32_bf16 v70, s58, v39
    v_dot2c_f32_bf16 v71, s59, v39
    s_bitset0_b32 s63, s19
    s_cmp_eq_u32 s63, 0
    s_cbranch_scc1 L_pgd
L_pn7:
    s_branch L_prb
L_pi1:
L_poll_126:
    buffer_load_dwordx4 v[8:11], v5, s[40:43], s4 offen sc1
    s_sub_u32 s60, s60, 1
    s_cbranch_scc1 L_poll_126t
    s_waitcnt vmcnt(0)
    v_max3_u32 v3, v8, v9, v10
    v_max_u32 v3, v3, v11
    v_cmp_eq_u32 vcc, -1, v3
    s_cbranch_vccnz L_poll_126
L_poll_126e:
    v_dot2c_f32_bf16 v64, s58, v8
    v_dot2c_f32_bf16 v65, s59, v8
    v_dot2c_f32_bf16 v66, s58, v9
    v_dot2c_f32_bf16 v67, s59, v9
    v_dot2c_f32_bf16 v68, s58, v10
    v_dot2c_f32_bf16 v69, s59, v10
    v_dot2c_f32_bf16 v70, s58, v11
    v_dot2c_f32_bf16 v71, s59, v11
L_pgd:
    v_pk_fma_f32 v[64:65], v[64:65], v[48:49], v[40:41]
    v_pk_fma_f32 v[66:67], v[66:67], v[50:51], v[42:43]
    v_pk_fma_f32 v[68:69], v[68:69], v[52:53], v[44:45]
    v_pk_fma_f32 v[70:71], v[70:71], v[54:55], v[46:47]
    v_pk_mul_f32 v[56:57], v[64:65], v[56:57]
    v_pk_mul_f32 v[58:59], v[66:67], v[58:59]
    v_pk_mul_f32 v[60:61], v[68:69], v[60:61]
    v_pk_mul_f32 v[62:63], v[70:71], v[62:63]
    v_cvt_pk_bf16_f32 v8, v56, v57
    v_cvt_pk_bf16_f32 v9, v58, v59
    v_cvt_pk_bf16_f32 v10, v60, v61
    v_cvt_pk_bf16_f32 v11, v62, v63
    ds_write_b128 v4, v[8:11]
    v_pk_add_f32 v[40:41], v[64:65], v[66:67]
    v_pk_add_f32 v[42:43], v[68:69], v[70:71]
    v_pk_mul_f32 v[44:45], v[64:65], v[64:65]
    v_pk_mul_f32 v[46:47], v[66:67], v[66:67]
    v_pk_add_f32 v[40:41], v[40:41], v[42:43]
    v_pk_fma_f32 v[44:45], v[68:69], v[68:69], v[44:45]
    v_pk_fma_f32 v[46:47], v[70:71], v[70:71], v[46:47]
    v_add_f32 v40, v40, v41
    v_pk_add_f32 v[44:45], v[44:45], v[46:47]
    v_add_f32 v41, v44, v45
    ds_write_b64 v7, v[40:41]
    s_waitcnt lgkmcnt(0)
    s_barrier
    v_mov_b32 v16, 0
    v_mov_b32 v17, 0
    v_mov_b32 v18, 0
    v_mov_b32 v19, 0
    v_mov_b32 v20, 0
    v_mov_b32 v21, 0
    v_mov_b32 v22, 0
    v_mov_b32 v23, 0
    v_mov_b32 v24, 0
    v_mov_b32 v25, 0
    v_mov_b32 v26, 0
    v_mov_b32 v27, 0
    v_mov_b32 v28, 0
    v_mov_b32 v29, 0
    v_mov_b32 v30, 0
    v_mov_b32 v31, 0
    v_mov_b32 v32, 0
    v_mov_b32 v33, 0
    v_mov_b32 v34, 0
    v_mov_b32 v35, 0
    ds_write_b128 v6, v[64:67]
    ds_write_b128 v6, v[68:71] offset:16
    s_waitcnt lgkmcnt(0)
    s_cmp_lg_u32 s3, 7
    s_cbranch_scc1 L_ffn2
    s_cmp_lt_u32 s35, 20
    s_cbranch_scc1 L_fin
    s_endpgm
L_ffn1:
    s_barrier
L_ffn1b:
    ds_read_b128 v[8:11], v79
    ds_read_b64 v[30:31], v81 offset:0
    ds_read_b64 v[32:33], v81 offset:512
    ds_read_b64 v[34:35], v81 offset:1024
    ds_read_b64 v[36:37], v81 offset:1536
    ds_read_b64 v[38:39], v81 offset:2048
    ds_read_b128 v[12:15], v79 offset:256
    ds_read_b128 v[16:19], v79 offset:512
    ds_read_b128 v[20:23], v79 offset:768
    ds_read_b128 v[24:27], v79 offset:1024
    s_waitcnt lgkmcnt(9)
    v_smfmac_f32_16x16x64_bf16 v[52:55], v[8:11], v[88:95], v87
    v_smfmac_f32_16x16x64_bf16 v[56:59], v[8:11], v[96:103], v87
    s_waitcnt lgkmcnt(3)
    v_smfmac_f32_16x16x64_bf16 v[52:55], v[12:15], v[104:111], v87
    v_pk_add_f32 v[30:31], v[30:31], v[32:33]
    v_pk_add_f32 v[34:35], v[34:35], v[36:37]
    v_smfmac_f32_16x16x64_bf16 v[56:59], v[12:15], v[112:119], v87
    v_pk_add_f32 v[30:31], v[30:31], v[38:39]
    v_pk_add_f32 v[30:31], v[30:31], v[34:35]
    s_nop 0
    s_waitcnt lgkmcnt(2)
    v_smfmac_f32_16x16x64_bf16 v[52:55], v[16:19], v[120:127], v87
    v_add_f32_dpp v30, v30, v30 quad_perm:[1,0,3,2] row_mask:0xf bank_mask:0xf
    v_add_f32_dpp v31, v31, v31 quad_perm:[1,0,3,2] row_mask:0xf bank_mask:0xf
    v_smfmac_f32_16x16x64_bf16 v[56:59], v[16:19], v[128:135], v87
    v_add_f32_dpp v30, v30, v30 quad_perm:[2,3,0,1] row_mask:0xf bank_mask:0xf
    v_add_f32_dpp v31, v31, v31 quad_perm:[2,3,0,1] row_mask:0xf bank_mask:0xf
    s_waitcnt lgkmcnt(1)
    v_smfmac_f32_16x16x64_bf16 v[52:55], v[20:23], v[136:143], v87
    v_add_f32_dpp v30, v30, v30 row_ror:4 row_mask:0xf bank_mask:0xf
    v_add_f32_dpp v31, v31, v31 row_ror:4 row_mask:0xf bank_mask:0xf
    v_smfmac_f32_16x16x64_bf16 v[56:59], v[20:23], v[144:151], v87
    v_add_f32_dpp v30, v30, v30 row_ror:8 row_mask:0xf bank_mask:0xf
    v_add_f32_dpp v31, v31, v31 row_ror:8 row_mask:0xf bank_mask:0xf
    s_waitcnt lgkmcnt(0)
    v_smfmac_f32_16x16x64_bf16 v[52:55], v[24:27], v[152:159], v87
    v_mul_f32 v48, s62, v30
    v_mul_f32 v49, s62, v31
    v_smfmac_f32_16x16x64_bf16 v[56:59], v[24:27], v[160:167], v87
    v_mul_f32 v7, v84, v48
    v_fma_f32 v49, -v48, v48, -v49
    v_max_f32 v49, 0, v49
    v_add_f32 v49, 0x3727c5ac, v49
    v_rsq_f32 v49, v49
    v_add_f32 v4, v52, v53
    v_add_f32 v4, v4, v7
    s_nop 0
    v_add_f32 v5, v58, v59
    v_add_f32 v4, v4, v5
    v_fma_f32 v4, v4, v49, v85
    v_mul_f32 v5, v4, v4
    v_fma_f32 v5, v5, s63, v86
    v_mul_f32 v5, v5, v4
    v_exp_f32 v5, v5
    s_nop 0
    v_add_f32 v5, 1.0, v5
    v_rcp_f32 v5, v5
    s_nop 0
    v_mul_f32 v4, v4, v5
    v_cvt_pk_bf16_f32 v4, v4, v4
    ds_write_b16 v80, v4
    s_waitcnt lgkmcnt(0)
    s_barrier
    s_endpgm
L_h_t1:
    s_sub_u32 s63, s56, 154
    s_cmp_lt_u32 s63, 16
    s_cbranch_scc0 L_h_noclr
    s_lshl2_add_u32 s62, s63, s3
    s_mul_i32 s62, s62, 4608
    v_mov_b32 v4, -1
    v_mov_b32 v5, -1
    v_mov_b32 v6, -1
    v_mov_b32 v7, -1
    v_lshlrev_b32 v8, 4, v0
    buffer_store_dwordx4 v[4:7], v8, s[40:43], s62 offen offset:0 sc1
    buffer_store_dwordx4 v[4:7], v8, s[40:43], s62 offen offset:1024 sc1
    buffer_store_dwordx4 v[4:7], v8, s[40:43], s62 offen offset:2048 sc1
    buffer_store_dwordx4 v[4:7], v8, s[40:43], s62 offen offset:3072 sc1
    s_add_u32 s62, s62, 4096
    s_bfm_b64 exec, 32, 0
    buffer_store_dwordx4 v[4:7], v8, s[40:43], s62 offen offset:0 sc1
    s_mov_b64 exec, 1
    v_mov_b32 v9, 162100
    v_mov_b32 v10, 1
    s_and_b32 s62, s63, 1
    s_mul_i32 s62, s62, 126
    s_lshl1_add_u32 s63, s63, s62
    s_waitcnt vmcnt(0)
    ds_add_rtn_u32 v10, v9, v10
    s_waitcnt lgkmcnt(0)
    v_readfirstlane_b32 s62, v10
    s_nop 0
    s_cmp_lg_u32 s62, 3
    s_cbranch_scc1 L_h_clrd
    buffer_store_dword v4, v36, s[44:47], s63 offen sc1
L_h_clrd:
    s_mov_b64 exec, -1
L_h_noclr:
    v_lshrrev_b32 v1, 3, v0
    v_mul_u32_u24 v1, 1280, v1
    v_and_b32 v2, 7, v0
    v_lshl_add_u32 v1, v2, 4, v1
    s_lshl2_add_u32 s63, s34, s3
    s_mul_i32 s63, s63, 163840
    s_lshl_b32 s62, s35, 7
    s_add_u32 s63, s63, s62
    s_sub_u32 s63, s63, 2816
    s_lshl_b32 s62, s3, 14
    s_add_u32 s62, s62, 81920
    s_mov_b32 m0, s62
    s_mov_b32 s48, s12
    s_mov_b32 s49, s13
    s_mov_b32 s50, 5242880
    s_mov_b32 s51, 0x20000
    s_add_u32 s100, s39, 1
    s_mov_b32 s62, 8
L_dma_5:
    buffer_load_dwordx4 v1, s[48:51], s63 offen nt lds
    s_add_u32 m0, m0, 1024
    s_add_u32 s63, s63, 10240
    s_cmp_eq_u32 s100, 0
    s_cbranch_scc1 L_dma_5n0
    s_waitcnt vmcnt(7)
    s_cmp_eq_u32 s100, 2
    s_cbranch_scc1 L_dma_5n0
    s_waitcnt vmcnt(5)
L_dma_5n0:
    buffer_load_dwordx4 v1, s[48:51], s63 offen nt lds
    s_add_u32 m0, m0, 1024
    s_add_u32 s63, s63, 10240
    s_cmp_eq_u32 s100, 0
    s_cbranch_scc1 L_dma_5n1
    s_waitcnt vmcnt(7)
    s_cmp_eq_u32 s100, 2
    s_cbranch_scc1 L_dma_5n1
    s_waitcnt vmcnt(5)
L_dma_5n1:
    s_sub_u32 s62, s62, 1
    s_cmp_lg_u32 s62, 0
    s_cbranch_scc1 L_dma_5
    s_cmp_eq_u32 s39, 1
    s_cbranch_scc1 L_h_role
    s_barrier
    s_waitcnt vmcnt(0)
    v_mov_b32 v4, 162060
    v_mov_b32 v5, 1
    s_mov_b64 exec, 1
    ds_add_u32 v4, v5
    s_mov_b64 exec, -1
    s_cmp_eq_u32 s3, 0
    s_cbranch_scc1 L_service
    s_endpgm
L_h_role:
    v_mov_b32 v72, 0
    v_mov_b32 v73, 0
    v_mov_b32 v74, 0
    v_mov_b32 v75, 0
    v_mov_b32 v76, 0
    v_lshrrev_b32 v3, 4, v0
    v_and_b32 v2, 3, v0
    v_bfe_u32 v1, v0, 2, 2
    v_mul_u32_u24 v160, 1280, v3
    v_and_b32 v4, 15, v0
    v_lshl_add_u32 v163, v4, 2, v160
    v_lshl_add_u32 v160, v4, 3, v160
    s_mul_i32 s57, s35, 5120
    s_mul_i32 s62, s3, 320
    s_add_u32 s57, s57, s62
    s_add_u32 s57, s57, 327680
    v_add_u32 v8, 0, v0
    v_mul_u32_u24 v10, 0xccd, v8
    v_lshrrev_b32 v10, 16, v10
    v_mul_u32_u24 v9, 20, v10
    v_sub_u32 v8, v8, v9
    v_mul_u32_u24 v10, 1280, v10
    v_lshl_add_u32 v10, v8, 4, v10
    v_add_u32 v8, 64, v0
    v_mul_u32_u24 v11, 0xccd, v8
    v_lshrrev_b32 v11, 16, v11
    v_mul_u32_u24 v9, 20, v11
    v_sub_u32 v8, v8, v9
    v_mul_u32_u24 v11, 1280, v11
    v_lshl_add_u32 v11, v8, 4, v11
    v_add_u32 v8, 128, v0
    v_mul_u32_u24 v12, 0xccd, v8
    v_lshrrev_b32 v12, 16, v12
    v_mul_u32_u24 v9, 20, v12
    v_sub_u32 v8, v8, v9
    v_mul_u32_u24 v12, 1280, v12
    v_lshl_add_u32 v12, v8, 4, v12
    v_add_u32 v8, 192, v0
    v_mul_u32_u24 v13, 0xccd, v8
    v_lshrrev_b32 v13, 16, v13
    v_mul_u32_u24 v9, 20, v13
    v_sub_u32 v8, v8, v9
    v_mul_u32_u24 v13, 1280, v13
    v_lshl_add_u32 v13, v8, 4, v13
    v_add_u32 v8, 256, v0
    v_mul_u32_u24 v14, 0xccd, v8
    v_lshrrev_b32 v14, 16, v14
    v_mul_u32_u24 v9, 20, v14
    v_sub_u32 v8, v8, v9
    v_mul_u32_u24 v14, 1280, v14
    v_lshl_add_u32 v14, v8, 4, v14
    s_mov_b32 s48, s20
    s_mov_b32 s49, s21
    s_mov_b32 s50, 2211840
    s_mov_b32 s51, 0x20000
    s_mul_i32 s63, s35, 81920
    s_mul_i32 s62, s3, 320
    s_add_u32 s63, s63, s62
    s_mov_b32 m0, s101
    s_mov_b32 s62, 4
L_w2dma:
    buffer_load_dwordx4 v10, s[48:51], s63 offen nt lds
    s_add_u32 m0, m0, 1024
    s_waitcnt vmcnt(7)
    s_cmp_ge_u32 s35, 22
    s_cbranch_scc1 L_w2n0
    s_waitcnt vmcnt(7)
L_w2n0:
    buffer_load_dwordx4 v11, s[48:51], s63 offen nt lds
    s_add_u32 m0, m0, 1024
    s_waitcnt vmcnt(7)
    s_cmp_ge_u32 s35, 22
    s_cbranch_scc1 L_w2n1
    s_waitcnt vmcnt(7)
L_w2n1:
    buffer_load_dwordx4 v12, s[48:51], s63 offen nt lds
    s_add_u32 m0, m0, 1024
    s_waitcnt vmcnt(7)
    s_cmp_ge_u32 s35, 22
    s_cbranch_scc1 L_w2n2
    s_waitcnt vmcnt(7)
L_w2n2:
    buffer_load_dwordx4 v13, s[48:51], s63 offen nt lds
    s_add_u32 m0, m0, 1024
    s_waitcnt vmcnt(7)
    s_cmp_ge_u32 s35, 22
    s_cbranch_scc1 L_w2n3
    s_waitcnt vmcnt(7)
L_w2n3:
    buffer_load_dwordx4 v14, s[48:51], s63 offen nt lds
    s_add_u32 m0, m0, 1024
    s_waitcnt vmcnt(7)
    s_cmp_ge_u32 s35, 22
    s_cbranch_scc1 L_w2n4
    s_waitcnt vmcnt(7)
L_w2n4:
    s_add_u32 s63, s63, 20480
    s_sub_u32 s62, s62, 1
    s_cmp_lg_u32 s62, 0
    s_cbranch_scc1 L_w2dma
    v_lshrrev_b32 v8, 5, v0
    v_lshlrev_b32 v8, 2, v8
    v_bfe_u32 v9, v0, 4, 1
    v_add_u32 v8, v8, v9
    v_mul_u32_u24 v8, 1280, v8
    v_add_u32 v8, s101, v8
    v_and_b32 v10, 15, v0
    v_lshl_add_u32 v9, v10, 2, v8
    v_lshl_add_u32 v8, v10, 3, v8
    s_mov_b32 s62, 0x05040100
    s_mov_b32 s63, 0x07060302
    s_waitcnt vmcnt(0)
    v_mov_b32 v4, 162060
    v_mov_b32 v5, 1
    s_mov_b64 exec, 1
    ds_add_u32 v4, v5
    s_mov_b64 exec, -1
    ds_read_b64 v[16:17], v8 offset:0
    ds_read_b64 v[18:19], v8 offset:320
    ds_read_b64 v[20:21], v8 offset:2560
    ds_read_b64 v[22:23], v8 offset:2880
    ds_read_b64 v[24:25], v8 offset:640
    ds_read_b64 v[26:27], v8 offset:960
    ds_read_b64 v[28:29], v8 offset:3200
    ds_read_b64 v[30:31], v8 offset:3520
    ds_read_b64 v[32:33], v8 offset:10240
    ds_read_b64 v[34:35], v8 offset:10560
    ds_read_b64 v[36:37], v8 offset:12800
    ds_read_b64 v[38:39], v8 offset:13120
    ds_read_b64 v[40:41], v8 offset:10880
    ds_read_b64 v[42:43], v8 offset:11200
    ds_read_b64 v[44:45], v8 offset:13440
    ds_read_b64 v[46:47], v8 offset:13760
    s_waitcnt lgkmcnt(0)
    v_perm_b32 v80, v18, v16, s62
    v_perm_b32 v88, v18, v16, s63
    v_perm_b32 v96, v19, v17, s62
    v_perm_b32 v104, v19, v17, s63
    v_perm_b32 v81, v22, v20, s62
    v_perm_b32 v89, v22, v20, s63
    v_perm_b32 v97, v23, v21, s62
    v_perm_b32 v105, v23, v21, s63
    v_perm_b32 v82, v26, v24, s62
    v_perm_b32 v90, v26, v24, s63
    v_perm_b32 v98, v27, v25, s62
    v_perm_b32 v106, v27, v25, s63
    v_perm_b32 v83, v30, v28, s62
    v_perm_b32 v91, v30, v28, s63
    v_perm_b32 v99, v31, v29, s62
    v_perm_b32 v107, v31, v29, s63
    v_perm_b32 v84, v34, v32, s62
    v_perm_b32 v92, v34, v32, s63
    v_perm_b32 v100, v35, v33, s62
    v_perm_b32 v108, v35, v33, s63
    v_perm_b32 v85, v38, v36, s62
    v_perm_b32 v93, v38, v36, s63
    v_perm_b32 v101, v39, v37, s62
    v_perm_b32 v109, v39, v37, s63
    v_perm_b32 v86, v42, v40, s62
    v_perm_b32 v94, v42, v40, s63
    v_perm_b32 v102, v43, v41, s62
    v_perm_b32 v110, v43, v41, s63
    v_perm_b32 v87, v46, v44, s62
    v_perm_b32 v95, v46, v44, s63
    v_perm_b32 v103, v47, v45, s62
    v_perm_b32 v111, v47, v45, s63
    ds_read_b64 v[16:17], v8 offset:128
    ds_read_b64 v[18:19], v8 offset:448
    ds_read_b64 v[20:21], v8 offset:2688
    ds_read_b64 v[22:23], v8 offset:3008
    ds_read_b64 v[24:25], v8 offset:768
    ds_read_b64 v[26:27], v8 offset:1088
    ds_read_b64 v[28:29], v8 offset:3328
    ds_read_b64 v[30:31], v8 offset:3648
    ds_read_b64 v[32:33], v8 offset:10368
    ds_read_b64 v[34:35], v8 offset:10688
    ds_read_b64 v[36:37], v8 offset:12928
    ds_read_b64 v[38:39], v8 offset:13248
    ds_read_b64 v[40:41], v8 offset:11008
    ds_read_b64 v[42:43], v8 offset:11328
    ds_read_b64 v[44:45], v8 offset:13568
    ds_read_b64 v[46:47], v8 offset:13888
    s_waitcnt lgkmcnt(0)
    v_perm_b32 v112, v18, v16, s62
    v_perm_b32 v120, v18, v16, s63
    v_perm_b32 v128, v19, v17, s62
    v_perm_b32 v136, v19, v17, s63
    v_perm_b32 v113, v22, v20, s62
    v_perm_b32 v121, v22, v20, s63
    v_perm_b32 v129, v23, v21, s62
    v_perm_b32 v137, v23, v21, s63
    v_perm_b32 v114, v26, v24, s62
    v_perm_b32 v122, v26, v24, s63
    v_perm_b32 v130, v27, v25, s62
    v_perm_b32 v138, v27, v25, s63
    v_perm_b32 v115, v30, v28, s62
    v_perm_b32 v123, v30, v28, s63
    v_perm_b32 v131, v31, v29, s62
    v_perm_b32 v139, v31, v29, s63
    v_perm_b32 v116, v34, v32, s62
    v_perm_b32 v124, v34, v32, s63
    v_perm_b32 v132, v35, v33, s62
    v_perm_b32 v140, v35, v33, s63
    v_perm_b32 v117, v38, v36, s62
    v_perm_b32 v125, v38, v36, s63
    v_perm_b32 v133, v39, v37, s62
    v_perm_b32 v141, v39, v37, s63
    v_perm_b32 v118, v42, v40, s62
    v_perm_b32 v126, v42, v40, s63
    v_perm_b32 v134, v43, v41, s62
    v_perm_b32 v142, v43, v41, s63
    v_perm_b32 v119, v46, v44, s62
    v_perm_b32 v127, v46, v44, s63
    v_perm_b32 v135, v47, v45, s62
    v_perm_b32 v143, v47, v45, s63
    ds_read_b32 v16, v9 offset:256
    ds_read_b32 v18, v9 offset:576
    ds_read_b32 v20, v9 offset:2816
    ds_read_b32 v22, v9 offset:3136
    ds_read_b32 v24, v9 offset:896
    ds_read_b32 v26, v9 offset:1216
    ds_read_b32 v28, v9 offset:3456
    ds_read_b32 v30, v9 offset:3776
    ds_read_b32 v32, v9 offset:10496
    ds_read_b32 v34, v9 offset:10816
    ds_read_b32 v36, v9 offset:13056
    ds_read_b32 v38, v9 offset:13376
    ds_read_b32 v40, v9 offset:11136
    ds_read_b32 v42, v9 offset:11456
    ds_read_b32 v44, v9 offset:13696
    ds_read_b32 v46, v9 offset:14016
    s_waitcnt lgkmcnt(0)
    v_perm_b32 v144, v18, v16, s62
    v_perm_b32 v152, v18, v16, s63
    v_perm_b32 v145, v22, v20, s62
    v_perm_b32 v153, v22, v20, s63
    v_perm_b32 v146, v26, v24, s62
    v_perm_b32 v154, v26, v24, s63
    v_perm_b32 v147, v30, v28, s62
    v_perm_b32 v155, v30, v28, s63
    v_perm_b32 v148, v34, v32, s62
    v_perm_b32 v156, v34, v32, s63
    v_perm_b32 v149, v38, v36, s62
    v_perm_b32 v157, v38, v36, s63
    v_perm_b32 v150, v42, v40, s62
    v_perm_b32 v158, v42, v40, s63
    v_perm_b32 v151, v46, v44, s62
    v_perm_b32 v159, v46, v44, s63
    s_mov_b32 s48, s16
    s_mov_b32 s49, s17
    s_mov_b32 s50, 2211840
    s_mov_b32 s51, 0x20000
    s_lshl_b32 s98, s35, 7
    s_mov_b32 s99, 3456
    v_lshrrev_b32 v9, 3, v0
    v_mul_lo_u32 v10, v9, s99
    v_and_b32 v9, 2, v9
    v_xor_b32 v9, v9, v0
    v_and_b32 v9, 7, v9
    v_lshl_add_u32 v10, v9, 4, v10
    v_add_u32 v10, s98, v10
    v_xor_b32 v11, 64, v10
    s_mul_i32 s63, s3, 552960
    s_mov_b32 m0, s101
    s_waitcnt lgkmcnt(0)
    s_cmp_ge_u32 s35, 22
    s_cselect_b32 s100, 2, 1
    s_mov_b32 s62, 10
L_dma_6:
    buffer_load_dwordx4 v10, s[48:51], s63 offen nt lds
    s_add_u32 m0, m0, 1024
    s_add_u32 s63, s63, 27648
    s_cmp_eq_u32 s100, 0
    s_cbranch_scc1 L_dma_6n0
    s_waitcnt vmcnt(7)
    s_cmp_eq_u32 s100, 2
    s_cbranch_scc1 L_dma_6n0
    s_waitcnt vmcnt(7)
L_dma_6n0:
    buffer_load_dwordx4 v11, s[48:51], s63 offen nt lds
    s_add_u32 m0, m0, 1024
    s_add_u32 s63, s63, 27648
    s_cmp_eq_u32 s100, 0
    s_cbranch_scc1 L_dma_6n1
    s_waitcnt vmcnt(7)
    s_cmp_eq_u32 s100, 2
    s_cbranch_scc1 L_dma_6n1
    s_waitcnt vmcnt(7)
L_dma_6n1:
    s_sub_u32 s62, s62, 1
    s_cmp_lg_u32 s62, 0
    s_cbranch_scc1 L_dma_6
    v_mov_b32 v8, 162068
L_lw_7:
    ds_read_b32 v9, v8
    s_waitcnt lgkmcnt(0)
    v_cmp_gt_u32 vcc, 1, v9
    s_cbranch_vccz L_lw_7e
    s_sleep 8
    s_sub_u32 s60, s60, 1
    s_cbranch_scc0 L_lw_7
    s_mov_b32 s60, 0
L_lw_7e:
    s_cmp_lg_u32 s3, 3
    s_cbranch_scc1 L_h_nomo
    v_and_b32 v4, 15, v0
    v_lshlrev_b32 v4, 4, v4
    v_mul_u32_u24 v5, 1280, v3
    v_add_u32 v5, v5, v4
    v_mul_u32_u24 v6, 1296, v3
    v_add_u32 v6, v6, v4
    v_add_u32 v6, 147456, v6
    s_mov_b32 s62, 30720
    s_mov_b32 s63, 25600
    s_branch L_poll_8
L_poll_8s:
    s_sleep 8
L_poll_8:
    buffer_load_dwordx4 v[40:43], v5, s[40:43], s62 offen offset:0 sc1
    buffer_load_dwordx4 v[44:47], v5, s[40:43], s62 offen offset:256 sc1
    buffer_load_dwordx4 v[48:51], v5, s[40:43], s62 offen offset:512 sc1
    buffer_load_dwordx4 v[52:55], v5, s[40:43], s62 offen offset:768 sc1
    buffer_load_dwordx4 v[56:59], v5, s[40:43], s62 offen offset:1024 sc1
    buffer_load_dwordx4 v[60:63], v5, s[40:43], s63 offen offset:0 sc1
    buffer_load_dwordx4 v[64:67], v5, s[40:43], s63 offen offset:256 sc1
    buffer_load_dwordx4 v[68:71], v5, s[40:43], s63 offen offset:512 sc1
    buffer_load_dwordx4 v[72:75], v5, s[40:43], s63 offen offset:768 sc1
    buffer_load_dwordx4 v[76:79], v5, s[40:43], s63 offen offset:1024 sc1
    s_sub_u32 s60, s60, 1
    s_cbranch_scc1 L_poll_8t
    s_waitcnt vmcnt(0)
    v_max3_u32 v7, v40, v41, v42
    v_max3_u32 v7, v7, v43, v44
    v_max3_u32 v7, v7, v45, v46
    v_max3_u32 v7, v7, v47, v48
    v_max3_u32 v7, v7, v49, v50
    v_max3_u32 v7, v7, v51, v52
    v_max3_u32 v7, v7, v53, v54
    v_max3_u32 v7, v7, v55, v56
    v_max3_u32 v7, v7, v57, v58
    v_max3_u32 v7, v7, v59, v60
    v_max3_u32 v7, v7, v61, v62
    v_max3_u32 v7, v7, v63, v64
    v_max3_u32 v7, v7, v65, v66
    v_max3_u32 v7, v7, v67, v68
    v_max3_u32 v7, v7, v69, v70
    v_max3_u32 v7, v7, v71, v72
    v_max3_u32 v7, v7, v73, v74
    v_max3_u32 v7, v7, v75, v76
    v_max3_u32 v7, v7, v77, v78
    v_max_u32 v7, v7, v79
    v_cmp_eq_u32 vcc, -1, v7
    s_cbranch_vccnz L_poll_8s
L_poll_8e:
    ds_write_b128 v6, v[40:43] offset:0
    ds_write_b128 v6, v[44:47] offset:256
    ds_write_b128 v6, v[48:51] offset:512
    ds_write_b128 v6, v[52:55] offset:768
    ds_write_b128 v6, v[56:59] offset:1024
    ds_write_b128 v6, v[60:63] offset:5184
    ds_write_b128 v6, v[64:67] offset:5440
    ds_write_b128 v6, v[68:71] offset:5696
    ds_write_b128 v6, v[72:75] offset:5952
    ds_write_b128 v6, v[76:79] offset:6208
L_h_nomo:
    v_mul_u32_u24 v4, 144, v1
    v_lshl_add_u32 v4, v3, 5, v4
    v_bfe_u32 v5, v0, 1, 1
    v_lshl_add_u32 v4, v5, 4, v4
    v_add_u32 v4, 90688, v4
    v_mov_b32 v5, 162112
    v_and_b32 v6, 1, v0
    v_cmp_eq_u32 vcc, 0, v6
    s_nop 1
    v_cndmask_b32 v161, v5, v4, vcc
    v_cndmask_b32 v162, v4, v5, vcc
    v_bfe_u32 v164, v0, 1, 1
    v_mul_u32_u24 v164, 0xaaaa, v164
    v_add_u32 v164, 0x4444, v164
    s_mov_b32 s100, s3
    s_lshl_b32 s63, s100, 8
    v_and_b32 v8, 15, v0
    v_lshl_add_u32 v8, v8, 4, s63
    v_lshrrev_b32 v9, 4, v0
    v_mul_u32_u24 v5, 1280, v9
    v_add_u32 v5, v5, v8
    v_mul_u32_u24 v4, 1296, v9
    v_add_u32 v4, v4, v8
    v_add_u32 v4, 82944, v4
    v_lshlrev_b32 v6, 1, v5
    v_add_u32 v6, 99328, v6
    s_lshl_b32 s62, s100, 9
    s_add_u32 s62, s62, 88128
    v_lshl_add_u32 v7, v0, 3, s62
    s_mov_b32 s48, s4
    s_mov_b32 s49, s5
    s_mov_b32 s50, 5120
    s_mov_b32 s51, 0x20000
    buffer_load_dwordx4 v[8:11], v5, s[48:51], 0 offen
    s_mov_b32 s62, 20480
    s_mov_b32 s63, 30720
    s_branch L_poll_9
L_poll_9s:
    s_sleep 8
L_poll_9:
    buffer_load_dwordx4 v[12:15], v5, s[40:43], s62 offen sc1
    buffer_load_dwordx4 v[16:19], v5, s[40:43], s63 offen sc1
    s_sub_u32 s60, s60, 1
    s_cbranch_scc1 L_poll_9t
    s_waitcnt vmcnt(0)
    v_max3_u32 v38, v12, v13, v14
    v_max3_u32 v38, v38, v15, v16
    v_max3_u32 v38, v38, v17, v18
    v_max_u32 v38, v38, v19
    v_cmp_eq_u32 vcc, -1, v38
    s_cbranch_vccnz L_poll_9s
L_poll_9e:
    v_lshlrev_b32 v40, 16, v8
    v_and_b32 v41, 0xffff0000, v8
    v_lshlrev_b32 v42, 16, v9
    v_and_b32 v43, 0xffff0000, v9
    v_lshlrev_b32 v44, 16, v10
    v_and_b32 v45, 0xffff0000, v10
    v_lshlrev_b32 v46, 16, v11
    v_and_b32 v47, 0xffff0000, v11
    v_lshlrev_b32 v48, 16, v12
    v_and_b32 v49, 0xffff0000, v12
    v_lshlrev_b32 v50, 16, v13
    v_and_b32 v51, 0xffff0000, v13
    v_lshlrev_b32 v52, 16, v14
    v_and_b32 v53, 0xffff0000, v14
    v_lshlrev_b32 v54, 16, v15
    v_and_b32 v55, 0xffff0000, v15
    v_lshlrev_b32 v56, 16, v16
    v_and_b32 v57, 0xffff0000, v16
    v_lshlrev_b32 v58, 16, v17
    v_and_b32 v59, 0xffff0000, v17
    v_lshlrev_b32 v60, 16, v18
    v_and_b32 v61, 0xffff0000, v18
    v_lshlrev_b32 v62, 16, v19
    v_and_b32 v63, 0xffff0000, v19
    v_mov_b32 v64, 0
    v_mov_b32 v65, 0
    v_mov_b32 v66, 0
    v_mov_b32 v67, 0
    v_mov_b32 v68, 0
    v_mov_b32 v69, 0
    v_mov_b32 v70, 0
    v_mov_b32 v71, 0
    v_bfe_u32 v5, v0, 2, 2
    v_lshlrev_b32 v5, 8, v5
    v_lshrrev_b32 v8, 4, v0
    v_lshl_add_u32 v5, v8, 6, v5
    v_and_b32 v8, 3, v0
    v_lshl_add_u32 v5, v8, 4, v5
    s_lshl_b32 s56, s100, 10
    s_waitcnt vmcnt(0) lgkmcnt(0)
    v_mov_b32 v8, 162064
    v_mov_b32 v9, 1
    s_mov_b64 exec, 1
    ds_add_u32 v8, v9
    s_mov_b64 exec, -1
    s_branch L_t2gate
L_ffn2:
    s_barrier
L_ffn2b:
    ds_read_b128 v[8:11], v161
    ds_read_b128 v[12:15], v162
    s_cmp_eq_u32 s61, 1
    s_cbranch_scc0 L_f2slow
    s_waitcnt lgkmcnt(1)
    v_smfmac_f32_16x16x64_bf16 v[16:19], v[8:11], v[80:87], v164
    v_smfmac_f32_16x16x64_bf16 v[20:23], v[8:11], v[96:103], v164
    s_waitcnt lgkmcnt(0)
    v_smfmac_f32_16x16x64_bf16 v[16:19], v[12:15], v[88:95], v164
    v_smfmac_f32_16x16x64_bf16 v[20:23], v[12:15], v[104:111], v164
    v_smfmac_f32_16x16x64_bf16 v[24:27], v[8:11], v[112:119], v164
    v_smfmac_f32_16x16x64_bf16 v[28:31], v[8:11], v[128:135], v164
    v_smfmac_f32_16x16x64_bf16 v[24:27], v[12:15], v[120:127], v164
    v_smfmac_f32_16x16x64_bf16 v[28:31], v[12:15], v[136:143], v164
    v_smfmac_f32_16x16x64_bf16 v[32:35], v[8:11], v[144:151], v164
    v_smfmac_f32_16x16x64_bf16 v[32:35], v[12:15], v[152:159], v164
    s_nop 0
    v_pk_add_f32 v[16:17], v[16:17], v[18:19]
    v_cvt_pk_bf16_f32 v40, v16, v17
    v_pk_add_f32 v[20:21], v[20:21], v[22:23]
    v_cvt_pk_bf16_f32 v41, v20, v21
    buffer_store_dwordx2 v[40:41], v160, s[40:43], s57 offen
    v_pk_add_f32 v[24:25], v[24:25], v[26:27]
    v_cvt_pk_bf16_f32 v42, v24, v25
    v_pk_add_f32 v[28:29], v[28:29], v[30:31]
    v_cvt_pk_bf16_f32 v43, v28, v29
    buffer_store_dwordx2 v[42:43], v160, s[40:43], s57 offen offset:128
    v_pk_add_f32 v[32:33], v[32:33], v[34:35]
    v_cvt_pk_bf16_f32 v44, v32, v33
    buffer_store_dword v44, v163, s[40:43], s57 offen offset:256
L_f2done:
    s_barrier
    s_endpgm
L_f2slow:
    s_waitcnt lgkmcnt(1)
    v_smfmac_f32_16x16x64_bf16 v[16:19], v[8:11], v[80:87], v164
    v_smfmac_f32_16x16x64_bf16 v[20:23], v[8:11], v[96:103], v164
    s_waitcnt lgkmcnt(0)
    v_smfmac_f32_16x16x64_bf16 v[16:19], v[12:15], v[88:95], v164
    v_smfmac_f32_16x16x64_bf16 v[20:23], v[12:15], v[104:111], v164
    v_smfmac_f32_16x16x64_bf16 v[24:27], v[8:11], v[112:119], v164
    v_smfmac_f32_16x16x64_bf16 v[28:31], v[8:11], v[128:135], v164
    v_smfmac_f32_16x16x64_bf16 v[24:27], v[12:15], v[120:127], v164
    v_smfmac_f32_16x16x64_bf16 v[28:31], v[12:15], v[136:143], v164
    v_smfmac_f32_16x16x64_bf16 v[32:35], v[8:11], v[144:151], v164
    v_smfmac_f32_16x16x64_bf16 v[32:35], v[12:15], v[152:159], v164
    s_nop 0
    v_pk_add_f32 v[16:17], v[16:17], v[18:19]
    v_cvt_pk_bf16_f32 v40, v16, v17
    v_pk_add_f32 v[20:21], v[20:21], v[22:23]
    v_cvt_pk_bf16_f32 v41, v20, v21
    buffer_store_dwordx2 v[40:41], v160, s[40:43], s57 offen sc1
    v_pk_add_f32 v[24:25], v[24:25], v[26:27]
    v_cvt_pk_bf16_f32 v42, v24, v25
    v_pk_add_f32 v[28:29], v[28:29], v[30:31]
    v_cvt_pk_bf16_f32 v43, v28, v29
    buffer_store_dwordx2 v[42:43], v160, s[40:43], s57 offen offset:128 sc1
    v_pk_add_f32 v[32:33], v[32:33], v[34:35]
    v_cvt_pk_bf16_f32 v44, v32, v33
    buffer_store_dword v44, v163, s[40:43], s57 offen offset:256 sc1
    s_branch L_f2done
L_poll_3t:
    s_mov_b32 s60, 0
    s_waitcnt vmcnt(0)
    s_branch L_poll_3e
L_poll_8t:
    s_mov_b32 s60, 0
    s_waitcnt vmcnt(0)
    s_branch L_poll_8e
L_poll_9t:
    s_mov_b32 s60, 0
    s_waitcnt vmcnt(0)
    s_branch L_poll_9e
L_poll_101t:
    s_mov_b32 s60, 0
    s_waitcnt vmcnt(0)
    s_branch L_poll_101e
L_pfast:
    buffer_store_dword v12, v108, s[40:43], s101 offen
    buffer_store_dword v12, v110, s[40:43], s101 offen
    s_branch L_pdone
L_poll_103t:
    s_mov_b32 s60, 0
    s_waitcnt vmcnt(0)
    s_branch L_poll_103e
L_poll_106t:
    s_mov_b32 s60, 0
    s_waitcnt vmcnt(0)
    s_branch L_poll_106e
L_poll_108t:
    s_mov_b32 s60, 0
    s_waitcnt vmcnt(0)
    s_branch L_poll_108e
L_poll_112t:
    s_mov_b32 s60, 0
    s_waitcnt vmcnt(0)
    s_branch L_poll_112e
L_poll_114t:
    s_mov_b32 s60, 0
    s_waitcnt vmcnt(0)
    s_branch L_poll_114e
L_ycs:
    buffer_store_dwordx4 v[24:27], v22, s[40:43], 0 offen offset:0 sc1
    buffer_store_dwordx4 v[24:27], v22, s[40:43], 0 offen offset:1024 sc1
    buffer_store_dwordx4 v[24:27], v22, s[40:43], 0 offen offset:2048 sc1
    buffer_store_dwordx4 v[24:27], v22, s[40:43], 0 offen offset:3072 sc1
    buffer_store_dwordx4 v[24:27], v23, s[40:43], 0 offen offset:0 sc1
    s_branch L_ycd
L_poll_115t:
    s_mov_b32 s60, 0
    s_waitcnt vmcnt(0)
    s_branch L_poll_115e
L_poll_120t:
    s_mov_b32 s60, 0
    s_waitcnt vmcnt(0)
    s_branch L_poll_120e
L_poll_122t:
    s_mov_b32 s60, 0
    s_waitcnt vmcnt(0)
    s_branch L_poll_122e
L_ygt:
    s_waitcnt vmcnt(0)
    s_branch L_ygd
L_pto:
    s_mov_b32 s60, 0
    s_waitcnt vmcnt(0)
    s_branch L_pgot0
L_poll_126t:
    s_mov_b32 s60, 0
    s_waitcnt vmcnt(0)
    s_branch L_poll_126e
L_end:
    s_endpgm
L_codeend:
.section .rodata,"a"
.p2align 6
.amdhsa_kernel adaLN_cond__sliding_block_cached__dense_activation_gelu__decode_kernel
  .amdhsa_next_free_vgpr 168
  .amdhsa_next_free_sgpr 102
  .amdhsa_accum_offset 168
  .amdhsa_group_segment_fixed_size 0
  .amdhsa_kernarg_size 120
  .amdhsa_user_sgpr_count 2
  .amdhsa_user_sgpr_kernarg_segment_ptr 1
  .amdhsa_system_sgpr_workgroup_id_x 1
.end_amdhsa_kernel
```

```asm
; @launch grid=(256,1,1) block=(768,1,1) lds=162176
.amdgcn_target "amdgcn-amd-amdhsa--gfx950"
.text
.globl adaLN_cond__sliding_block_cached__dense_activation_gelu__decode_kernel
.p2align 8
.type adaLN_cond__sliding_block_cached__dense_activation_gelu__decode_kernel,@function
adaLN_cond__sliding_block_cached__dense_activation_gelu__decode_kernel:
    s_load_dwordx16 s[4:19], s[0:1], 0
    s_load_dwordx8 s[20:27], s[0:1], 64
    s_load_dwordx4 s[28:31], s[0:1], 96
    s_load_dwordx2 s[32:33], s[0:1], 112
    s_cmp_ge_u32 s2, 256
    s_cbranch_scc1 L_end
    v_lshrrev_b32 v1, 6, v0
    v_mul_u32_u24 v2, 36, v0
    v_readfirstlane_b32 s3, v1
    v_and_b32 v0, 63, v0
    s_and_b32 s34, s2, 7
    s_lshr_b32 s35, s2, 3
    s_cmp_lg_u32 s35, 21
    s_cbranch_scc1 L_nopf
    s_getpc_b64 s[48:49]
L_pc:
    v_min_u32 v2, L_codeend-L_pc-4, v2
    v_mov_b32 v3, s49
    v_add_co_u32 v2, vcc, s48, v2
    s_nop 1
    v_addc_co_u32 v3, vcc, 0, v3, vcc
    global_load_dword v152, v[2:3], off
L_nopf:
    s_lshr_b32 s36, s35, 3
    s_lshl2_add_u32 s36, s34, s36
    s_bfe_u32 s37, s35, 0x20001
    s_and_b32 s38, s35, 1
    s_cmp_lt_u32 s35, 27
    s_cselect_b32 s39, 1, 0
    s_cmp_eq_u32 s34, 2
    s_cselect_b32 s39, s39, 0
    s_sub_u32 s62, s34, 3
    s_and_b32 s62, s62, 7
    s_mul_i32 s56, s35, 7
    s_add_u32 s56, s56, s62
    s_cmp_eq_u32 s62, 7
    s_cselect_b32 s56, 255, s56
    s_mov_b32 s60, 1000000
    s_mov_b32 s61, 0
    v_mov_b32 v36, 0
    s_cmp_lt_u32 s3, 4
    s_cbranch_scc1 L_helpers
    s_sub_u32 s3, s3, 4
    s_cmp_ge_u32 s35, 22
    s_cselect_b32 s59, 1, 0
    s_add_u32 s62, s3, s59
    s_cmp_ge_u32 s62, 6
    s_cselect_b32 s62, s39, 0
    s_cmp_eq_u32 s62, 1
    s_cbranch_scc1 L_proxy
    s_cmp_eq_u32 s59, 1
    s_cselect_b32 s100, 0, 81920
    s_lshl_b32 s62, s3, 13
    s_add_u32 s100, s100, s62
    s_and_b32 s62, s39, s59
    s_cselect_b32 s100, -1, s100
    s_mov_b32 s101, 0
L_stream:
    s_lshl_b32 s62, s37, 5
    s_add_u32 s62, s62, s36
    s_lshl_b32 s63, s62, 21
    s_lshl_b32 s96, s38, 18
    s_add_u32 s63, s63, s96
    s_add_u32 s63, s63, 1572864
    v_lshlrev_b32 v1, 4, v0
    s_lshl_b32 s96, s3, 12
    v_add_u32 v1, s96, v1
    s_mov_b32 s97, 0
    s_mov_b32 s50, 262144
    s_mov_b32 s51, 0x20000
    s_waitcnt lgkmcnt(0)
    s_add_u32 s48, s6, s63
    s_addc_u32 s49, s7, 0
    s_cmp_lt_u32 s56, 40
    s_cbranch_scc0 L_nob0
    s_barrier
L_nob0:
    buffer_load_dwordx4 v[40:43], v1, s[48:51], s97 offen offset:0 nt
    buffer_load_dwordx4 v[44:47], v1, s[48:51], s97 offen offset:1024 nt
    s_cmp_lt_u32 s56, 40
    s_cbranch_scc1 L_stream2
    s_barrier
    s_branch L_stream2
L_helpers:
    s_cmp_lg_u32 s3, 0
    s_cbranch_scc1 L_noinit
    v_lshlrev_b32 v1, 2, v0
    v_add_u32 v1, 161920, v1
    ds_write_b32 v1, v36
L_noinit:
    s_waitcnt lgkmcnt(0)
    s_mov_b32 s40, s32
    s_mov_b32 s41, s33
    s_mov_b32 s42, 589824
    s_mov_b32 s43, 0x20000
    s_mov_b32 s44, s30
    s_mov_b32 s45, s31
    s_mov_b32 s46, 256
    s_mov_b32 s47, 0x20000
    s_lshl2_add_u32 s62, s35, s3
    s_cmp_eq_u32 s62, 87
    s_cbranch_scc1 L_touch
L_notp:
    s_mul_i32 s101, s3, 20480
    s_mov_b32 s96, s56
    s_cmp_lt_u32 s56, 40
    s_cbranch_scc0 L_nothalf
    s_cmp_lt_u32 s3, 2
    s_cbranch_scc1 L_unit
    s_add_u32 s62, s56, 20
    s_cmp_eq_u32 s3, 2
    s_cbranch_scc1 L_job
    s_barrier
    s_branch L_service
L_nothalf:
    s_cmp_lt_u32 s56, 144
    s_cbranch_scc1 L_unit
    s_sub_u32 s62, s56, 144
    s_cmp_lt_u32 s62, 10
    s_cbranch_scc0 L_nojob
    s_cmp_lt_u32 s3, 2
    s_cbranch_scc0 L_nojob
    s_mul_i32 s63, s3, 10
    s_add_u32 s62, s62, s63
L_job:
    s_cmp_lt_u32 s62, 59
    s_cbranch_scc0 L_end
    s_mov_b32 s100, s101
    s_lshl_b32 s101, s62, 9
    s_add_u32 s101, s101, 172032
    s_cmp_lt_u32 s62, 27
    s_cselect_b32 s63, 0, 27
    s_cselect_b32 s3, 7, 6
    s_cmp_lt_u32 s62, 54
    s_cselect_b32 s63, s63, 32
    s_cselect_b32 s3, s3, 5
    s_sub_u32 s35, s62, s63
    s_mov_b32 s34, 2
    s_lshr_b32 s36, s35, 3
    s_add_u32 s36, s36, 8
    s_bfe_u32 s37, s35, 0x20001
    s_and_b32 s38, s35, 1
    s_mov_b32 s59, 0
    s_branch L_stream
L_nojob:
    s_barrier
    s_cmp_ge_u32 s35, 22
    s_cbranch_scc1 L_h_t1
    s_cmp_eq_u32 s39, 1
    s_cbranch_scc1 L_h_role
    s_cmp_lt_u32 s96, 144
    s_cbranch_scc1 L_unit
    s_cmp_eq_u32 s3, 3
    s_cbranch_scc1 L_service
    s_endpgm
L_unit:
    v_lshrrev_b32 v3, 4, v0
    v_and_b32 v4, 3, v0
    v_bfe_u32 v7, v0, 2, 2
    s_mov_b32 s14, s3
    s_mov_b32 s15, 3
    s_sub_u32 s62, s96, 40
    s_cmp_lt_u32 s62, 64
    s_cbranch_scc1 L_u_q
    s_mov_b32 s100, 1
    s_sub_u32 s96, s96, 84
    s_cmp_lt_u32 s56, 40
    s_cbranch_scc0 L_u_full
    s_mov_b32 s100, 0
    s_lshr_b32 s96, s56, 1
    s_and_b32 s62, s56, 1
    s_lshl1_add_u32 s14, s62, s14
    s_mov_b32 s15, 1
L_u_full:
    s_mov_b32 s97, 0
    s_mov_b32 s99, 7680
    s_mov_b32 s48, s26
    s_mov_b32 s49, s27
    s_mov_b32 s50, 4915200
    s_mov_b32 s51, 0x20000
    s_mov_b32 s52, s24
    s_mov_b32 s53, s25
    s_mov_b32 s54, 5120
    s_mov_b32 s55, 0x20000
    v_and_b32 v6, 15, v0
    v_lshlrev_b32 v6, 4, v6
    v_mul_u32_u24 v5, 1280, v3
    v_add_u32 v5, v5, v6
    s_mul_i32 s62, s14, 320
    buffer_load_dwordx4 v[8:11], v5, s[52:55], s62 offen
    s_mov_b32 exec_lo, 0x000f000f
    s_mov_b32 exec_hi, 0x000f000f
    buffer_load_dwordx4 v[12:15], v5, s[52:55], s62 offen offset:256
    s_mov_b64 exec, -1
    s_lshl_b32 s98, s96, 7
    s_mul_i32 s13, s96, 0x199a
    s_lshr_b32 s13, s13, 16
    s_cmp_lg_u32 s13, 1
    s_cbranch_scc1 L_u_go
    s_mov_b32 s52, s4
    s_mov_b32 s53, s5
    s_mov_b32 s54, 5120
    s_mov_b32 s55, 0x20000
    v_mul_u32_u24 v5, 1280, v4
    v_lshlrev_b32 v64, 5, v7
    v_lshl_add_u32 v64, v3, 3, v64
    v_add_u32 v64, v64, v5
    v_lshrrev_b32 v6, 2, v0
    v_lshl_add_u32 v6, v6, 4, v5
    s_sub_u32 s62, s98, 1280
    buffer_load_dwordx4 v[16:19], v6, s[52:55], 0 offen offset:0
    buffer_load_dwordx4 v[20:23], v6, s[52:55], 0 offen offset:256
    buffer_load_dwordx4 v[24:27], v6, s[52:55], 0 offen offset:512
    buffer_load_dwordx4 v[28:31], v6, s[52:55], 0 offen offset:768
    buffer_load_dwordx4 v[32:35], v6, s[52:55], 0 offen offset:1024
    buffer_load_dwordx2 v[66:67], v64, s[52:55], s62 offen
    s_branch L_u_go
L_u_q:
    s_mov_b32 s97, 1
    s_mov_b32 s99, 8192
    s_mov_b32 s100, 2
    s_lshl_b32 s98, s62, 7
    s_mov_b32 s48, s10
    s_mov_b32 s49, s11
    s_mov_b32 s50, 5242880
    s_mov_b32 s51, 0x20000
L_u_go:
    v_lshrrev_b32 v6, 3, v0
    v_mul_lo_u32 v1, v6, s99
    v_and_b32 v6, 2, v6
    v_xor_b32 v6, v6, v0
    v_and_b32 v6, 7, v6
    v_lshl_add_u32 v1, v6, 4, v1
    v_add_u32 v1, s98, v1
    v_xor_b32 v2, 64, v1
    s_mul_i32 s63, s99, s14
    s_mul_i32 s63, s63, 160
    s_lshl_b32 s59, s99, 3
    s_mov_b32 m0, s101
    s_mov_b32 s62, 10
L_dma_1:
    buffer_load_dwordx4 v1, s[48:51], s63 offen nt lds
    s_add_u32 m0, m0, 1024
    s_add_u32 s63, s63, s59
    s_cmp_eq_u32 s100, 0
    s_cbranch_scc1 L_dma_1n0
    s_waitcnt vmcnt(5)
    s_cmp_eq_u32 s100, 2
    s_cbranch_scc1 L_dma_1n0
    s_waitcnt vmcnt(5)
L_dma_1n0:
    buffer_load_dwordx4 v2, s[48:51], s63 offen nt lds
    s_add_u32 m0, m0, 1024
    s_add_u32 s63, s63, s59
    s_cmp_eq_u32 s100, 0
    s_cbranch_scc1 L_dma_1n1
    s_waitcnt vmcnt(5)
    s_cmp_eq_u32 s100, 2
    s_cbranch_scc1 L_dma_1n1
    s_waitcnt vmcnt(5)
L_dma_1n1:
    s_sub_u32 s62, s62, 1
    s_cmp_lg_u32 s62, 0
    s_cbranch_scc1 L_dma_1
    v_min_u32 v65, 15, v0
    v_and_b32 v6, 1, v65
    v_mul_u32_u24 v6, 126, v6
    v_lshl_add_u32 v65, v65, 1, v6
    v_mov_b32 v68, 0
    s_cmp_lt_u32 s56, 40
    s_cbranch_scc1 L_u_nofl
    buffer_load_dword v68, v65, s[44:47], 0 offen sc1
L_u_nofl:
    s_cmp_lt_u32 s56, 144
    s_cbranch_scc0 L_u_nob
    s_barrier
L_u_nob:
    v_lshrrev_b32 v60, 4, v0
    v_lshlrev_b32 v60, 10, v60
    v_bfe_u32 v6, v0, 2, 2
    v_lshl_add_u32 v60, v6, 7, v60
    v_and_b32 v6, 3, v0
    v_lshl_add_u32 v60, v6, 3, v60
    v_bfe_u32 v6, v0, 3, 2
    v_lshl_add_u32 v60, v6, 5, v60
    v_xor_b32 v61, 32, v60
    v_xor_b32 v62, 64, v60
    v_xor_b32 v63, 0x60, v60
    v_add_u32 v60, s101, v60
    v_add_u32 v61, s101, v61
    v_add_u32 v62, s101, v62
    v_add_u32 v63, s101, v63
    v_mov_b32 v56, 1.0
    v_mov_b32 v57, 1.0
    v_mov_b32 v58, 1.0
    v_mov_b32 v59, 1.0
    s_mov_b32 s58, 0
    v_lshl_add_u32 v69, v7, 2, v3
    v_lshl_add_u32 v69, v4, 4, v69
    v_and_b32 v64, 15, v0
    v_lshlrev_b32 v64, 3, v64
    s_cmp_eq_u32 s97, 1
    s_cbranch_scc1 L_u_q2
    v_mul_u32_u24 v6, 1280, v3
    v_add_u32 v64, v64, v6
    s_mul_i32 s63, s13, 3840
    s_add_u32 s57, s98, s63
    s_add_u32 s57, s57, 10240
    s_cmp_lt_u32 s56, 40
    s_cbranch_scc0 L_u_nat
    v_lshrrev_b32 v69, 1, v3
    v_lshlrev_b32 v69, 3, v69
    v_lshl_add_u32 v69, v7, 4, v69
    v_lshl_add_u32 v69, v4, 1, v69
    v_and_b32 v6, 1, v3
    v_add_u32 v69, v69, v6
    s_lshr_b32 s62, s56, 1
    s_lshl_b32 s57, s62, 11
    s_cmp_ge_u32 s62, 10
    s_cselect_b32 s62, -19968, 0
    s_add_u32 s57, s57, s62
    s_and_b32 s62, s56, 1
    s_lshl_b32 s62, s62, 8
    s_add_u32 s57, s57, s62
    v_lshrrev_b32 v64, 5, v0
    v_lshlrev_b32 v64, 10, v64
    v_and_b32 v6, 31, v0
    v_lshl_add_u32 v64, v6, 3, v64
L_u_nat:
    s_cmp_eq_u32 s13, 4
    s_cselect_b32 s58, 1.0, 0
    s_cmp_eq_u32 s13, 1
    s_cselect_b32 s58, 1.0, s58
    s_cselect_b32 s56, 1, 0
    s_cmp_eq_u32 s14, 0
    s_cselect_b32 s58, s58, 0
    s_waitcnt vmcnt(20)
    s_mov_b32 s62, 0xbfb8aa3b
    v_lshlrev_b32 v40, 16, v8
    v_and_b32 v41, 0xffff0000, v8
    v_lshlrev_b32 v42, 16, v9
    v_and_b32 v43, 0xffff0000, v9
    v_lshlrev_b32 v44, 16, v10
    v_and_b32 v45, 0xffff0000, v10
    v_lshlrev_b32 v46, 16, v11
    v_and_b32 v47, 0xffff0000, v11
    v_mul_f32 v48, s62, v40
    v_mul_f32 v49, s62, v41
    v_mul_f32 v50, s62, v42
    v_mul_f32 v51, s62, v43
    v_mul_f32 v52, s62, v44
    v_mul_f32 v53, s62, v45
    v_mul_f32 v54, s62, v46
    v_mul_f32 v55, s62, v47
    v_exp_f32 v48, v48
    v_exp_f32 v49, v49
    v_exp_f32 v50, v50
    v_exp_f32 v51, v51
    v_exp_f32 v52, v52
    v_exp_f32 v53, v53
    v_exp_f32 v54, v54
    v_exp_f32 v55, v55
    v_add_f32 v48, 1.0, v48
    v_add_f32 v49, 1.0, v49
    v_add_f32 v50, 1.0, v50
    v_add_f32 v51, 1.0, v51
    v_add_f32 v52, 1.0, v52
    v_add_f32 v53, 1.0, v53
    v_add_f32 v54, 1.0, v54
    v_add_f32 v55, 1.0, v55
    v_rcp_f32 v48, v48
    v_rcp_f32 v49, v49
    v_rcp_f32 v50, v50
    v_rcp_f32 v51, v51
    v_rcp_f32 v52, v52
    v_rcp_f32 v53, v53
    v_rcp_f32 v54, v54
    v_rcp_f32 v55, v55
    v_mul_f32 v40, v40, v48
    v_mul_f32 v41, v41, v49
    v_mul_f32 v42, v42, v50
    v_mul_f32 v43, v43, v51
    v_mul_f32 v44, v44, v52
    v_mul_f32 v45, v45, v53
    v_mul_f32 v46, v46, v54
    v_mul_f32 v47, v47, v55
    v_cvt_pk_bf16_f32 v8, v40, v41
    v_cvt_pk_bf16_f32 v9, v42, v43
    v_cvt_pk_bf16_f32 v10, v44, v45
    v_cvt_pk_bf16_f32 v11, v46, v47
    v_lshlrev_b32 v40, 16, v12
    v_and_b32 v41, 0xffff0000, v12
    v_lshlrev_b32 v42, 16, v13
    v_and_b32 v43, 0xffff0000, v13
    v_lshlrev_b32 v44, 16, v14
    v_and_b32 v45, 0xffff0000, v14
    v_lshlrev_b32 v46, 16, v15
    v_and_b32 v47, 0xffff0000, v15
    v_mul_f32 v48, s62, v40
    v_mul_f32 v49, s62, v41
    v_mul_f32 v50, s62, v42
    v_mul_f32 v51, s62, v43
    v_mul_f32 v52, s62, v44
    v_mul_f32 v53, s62, v45
    v_mul_f32 v54, s62, v46
    v_mul_f32 v55, s62, v47
    v_exp_f32 v48, v48
    v_exp_f32 v49, v49
    v_exp_f32 v50, v50
    v_exp_f32 v51, v51
    v_exp_f32 v52, v52
    v_exp_f32 v53, v53
    v_exp_f32 v54, v54
    v_exp_f32 v55, v55
    v_add_f32 v48, 1.0, v48
    v_add_f32 v49, 1.0, v49
    v_add_f32 v50, 1.0, v50
    v_add_f32 v51, 1.0, v51
    v_add_f32 v52, 1.0, v52
    v_add_f32 v53, 1.0, v53
    v_add_f32 v54, 1.0, v54
    v_add_f32 v55, 1.0, v55
    v_rcp_f32 v48, v48
    v_rcp_f32 v49, v49
    v_rcp_f32 v50, v50
    v_rcp_f32 v51, v51
    v_rcp_f32 v52, v52
    v_rcp_f32 v53, v53
    v_rcp_f32 v54, v54
    v_rcp_f32 v55, v55
    v_mul_f32 v40, v40, v48
    v_mul_f32 v41, v41, v49
    v_mul_f32 v42, v42, v50
    v_mul_f32 v43, v43, v51
    v_mul_f32 v44, v44, v52
    v_mul_f32 v45, v45, v53
    v_mul_f32 v46, v46, v54
    v_mul_f32 v47, v47, v55
    v_cvt_pk_bf16_f32 v12, v40, v41
    v_cvt_pk_bf16_f32 v13, v42, v43
    v_cvt_pk_bf16_f32 v14, v44, v45
    v_cvt_pk_bf16_f32 v15, v46, v47
    s_mul_i32 s62, s3, 1344
    s_add_u32 s62, s62, 151552
    v_mul_u32_u24 v5, 336, v3
    v_and_b32 v6, 15, v0
    v_lshl_add_u32 v5, v6, 4, v5
    v_add_u32 v5, s62, v5
    ds_write_b128 v5, v[8:11]
    s_mov_b32 exec_lo, 0x000f000f
    s_mov_b32 exec_hi, 0x000f000f
    ds_write_b128 v5, v[12:15] offset:256
    s_mov_b64 exec, -1
    v_mul_u32_u24 v5, 336, v4
    v_lshl_add_u32 v5, v3, 4, v5
    v_add_u32 v5, s62, v5
    s_mov_b32 s59, 0x3e800000
    s_cmp_eq_u32 s56, 0
    s_cbranch_scc1 L_u_nost
    v_mov_b32 v40, 0
    v_mov_b32 v41, 0
    s_mov_b32 s62, 0x3f803f80
    v_dot2c_f32_bf16 v40, s62, v16
    v_dot2c_f32_bf16 v41, v16, v16
    v_dot2c_f32_bf16 v40, s62, v17
    v_dot2c_f32_bf16 v41, v17, v17
    v_dot2c_f32_bf16 v40, s62, v18
    v_dot2c_f32_bf16 v41, v18, v18
    v_dot2c_f32_bf16 v40, s62, v19
    v_dot2c_f32_bf16 v41, v19, v19
    v_dot2c_f32_bf16 v40, s62, v20
    v_dot2c_f32_bf16 v41, v20, v20
    v_dot2c_f32_bf16 v40, s62, v21
    v_dot2c_f32_bf16 v41, v21, v21
    v_dot2c_f32_bf16 v40, s62, v22
    v_dot2c_f32_bf16 v41, v22, v22
    v_dot2c_f32_bf16 v40, s62, v23
    v_dot2c_f32_bf16 v41, v23, v23
    v_dot2c_f32_bf16 v40, s62, v24
    v_dot2c_f32_bf16 v41, v24, v24
    v_dot2c_f32_bf16 v40, s62, v25
    v_dot2c_f32_bf16 v41, v25, v25
    v_dot2c_f32_bf16 v40, s62, v26
    v_dot2c_f32_bf16 v41, v26, v26
    v_dot2c_f32_bf16 v40, s62, v27
    v_dot2c_f32_bf16 v41, v27, v27
    v_dot2c_f32_bf16 v40, s62, v28
    v_dot2c_f32_bf16 v41, v28, v28
    v_dot2c_f32_bf16 v40, s62, v29
    v_dot2c_f32_bf16 v41, v29, v29
    v_dot2c_f32_bf16 v40, s62, v30
    v_dot2c_f32_bf16 v41, v30, v30
    v_dot2c_f32_bf16 v40, s62, v31
    v_dot2c_f32_bf16 v41, v31, v31
    v_dot2c_f32_bf16 v40, s62, v32
    v_dot2c_f32_bf16 v41, v32, v32
    v_dot2c_f32_bf16 v40, s62, v33
    v_dot2c_f32_bf16 v41, v33, v33
    v_dot2c_f32_bf16 v40, s62, v34
    v_dot2c_f32_bf16 v41, v34, v34
    v_dot2c_f32_bf16 v40, s62, v35
    v_dot2c_f32_bf16 v41, v35, v35
    s_nop 1
    v_add_f32_dpp v40, v40, v40 row_ror:4 row_mask:0xf bank_mask:0xf
    v_add_f32_dpp v41, v41, v41 row_ror:4 row_mask:0xf bank_mask:0xf
    s_nop 0
    v_add_f32_dpp v40, v40, v40 row_ror:8 row_mask:0xf bank_mask:0xf
    v_add_f32_dpp v41, v41, v41 row_ror:8 row_mask:0xf bank_mask:0xf
    v_mov_b32 v42, v40
    v_mov_b32 v43, v41
    s_nop 0
    v_permlane16_swap_b32 v40, v42
    v_permlane16_swap_b32 v41, v43
    v_add_f32 v40, v40, v42
    v_add_f32 v41, v41, v43
    v_mov_b32 v42, v40
    v_mov_b32 v43, v41
    s_nop 0
    v_permlane32_swap_b32 v40, v42
    v_permlane32_swap_b32 v41, v43
    v_add_f32 v40, v40, v42
    v_add_f32 v41, v41, v43
    s_mov_b32 s62, 0x3acccccd
    v_mul_f32 v40, s62, v40
    v_mul_f32 v41, s62, v41
    v_fma_f32 v41, -v40, v40, v41
    v_max_f32 v41, 0, v41
    v_add_f32 v41, 0x3727c5ac, v41
    v_rsq_f32 v41, v41
    v_lshlrev_b32 v56, 16, v66
    v_and_b32 v57, 0xffff0000, v66
    v_lshlrev_b32 v58, 16, v67
    v_and_b32 v59, 0xffff0000, v67
    v_sub_f32 v56, v56, v40
    v_sub_f32 v57, v57, v40
    v_sub_f32 v58, v58, v40
    v_sub_f32 v59, v59, v40
    v_mul_f32 v56, v56, v41
    v_mul_f32 v57, v57, v41
    v_mul_f32 v58, v58, v41
    v_mul_f32 v59, v59, v41
L_u_nost:
    ds_read_b128 v[8:11], v5 offset:0
    ds_read_b128 v[12:15], v5 offset:64
    ds_read_b128 v[16:19], v5 offset:128
    ds_read_b128 v[20:23], v5 offset:192
    ds_read_b128 v[24:27], v5 offset:256
    s_branch L_u_frag
L_u_q2:
    v_lshl_add_u32 v64, v3, 13, v64
    s_add_u32 s57, s98, 40960
    v_lshlrev_b32 v5, 8, v7
    v_lshl_add_u32 v5, v3, 6, v5
    v_lshl_add_u32 v5, v4, 4, v5
    s_mul_i32 s63, s3, 5120
    s_add_u32 s63, s63, 0
    s_add_u32 s12, s63, 4096
    s_mov_b32 s59, 1.0
L_u_frag:
    s_waitcnt vmcnt(0)
    v_cmp_ne_u32 vcc, -1, v68
    s_cbranch_vccz L_u_yok
    s_cmp_eq_u32 s97, 1
    s_cbranch_scc1 L_u_ywait
    buffer_load_dword v68, v65, s[44:47], 0 offen sc1
    s_branch L_u_yok
L_u_ywait:
L_wy_2:
    buffer_load_dword v68, v65, s[44:47], 0 offen sc1
    s_waitcnt vmcnt(0)
    v_cmp_ne_u32 vcc, -1, v68
    s_cbranch_vccz L_wy_2e
    s_sleep 4
    s_sub_u32 s60, s60, 1
    s_cbranch_scc0 L_wy_2
    s_mov_b32 s60, 0
L_wy_2e:
L_u_yok:
    ds_read_b64_tr_b16 v[80:81], v60 offset:0
    ds_read_b64_tr_b16 v[82:83], v60 offset:512
    ds_read_b64_tr_b16 v[84:85], v61 offset:0
    ds_read_b64_tr_b16 v[86:87], v61 offset:512
    ds_read_b64_tr_b16 v[88:89], v62 offset:0
    ds_read_b64_tr_b16 v[90:91], v62 offset:512
    ds_read_b64_tr_b16 v[92:93], v63 offset:0
    ds_read_b64_tr_b16 v[94:95], v63 offset:512
    ds_read_b64_tr_b16 v[96:97], v60 offset:4096
    ds_read_b64_tr_b16 v[98:99], v60 offset:4608
    ds_read_b64_tr_b16 v[100:101], v61 offset:4096
    ds_read_b64_tr_b16 v[102:103], v61 offset:4608
    ds_read_b64_tr_b16 v[104:105], v62 offset:4096
    ds_read_b64_tr_b16 v[106:107], v62 offset:4608
    ds_read_b64_tr_b16 v[108:109], v63 offset:4096
    ds_read_b64_tr_b16 v[110:111], v63 offset:4608
    ds_read_b64_tr_b16 v[112:113], v60 offset:8192
    ds_read_b64_tr_b16 v[114:115], v60 offset:8704
    ds_read_b64_tr_b16 v[116:117], v61 offset:8192
    ds_read_b64_tr_b16 v[118:119], v61 offset:8704
    ds_read_b64_tr_b16 v[120:121], v62 offset:8192
    ds_read_b64_tr_b16 v[122:123], v62 offset:8704
    ds_read_b64_tr_b16 v[124:125], v63 offset:8192
    ds_read_b64_tr_b16 v[126:127], v63 offset:8704
    ds_read_b64_tr_b16 v[128:129], v60 offset:12288
    ds_read_b64_tr_b16 v[130:131], v60 offset:12800
    ds_read_b64_tr_b16 v[132:133], v61 offset:12288
    ds_read_b64_tr_b16 v[134:135], v61 offset:12800
    ds_read_b64_tr_b16 v[136:137], v62 offset:12288
    ds_read_b64_tr_b16 v[138:139], v62 offset:12800
    ds_read_b64_tr_b16 v[140:141], v63 offset:12288
    ds_read_b64_tr_b16 v[142:143], v63 offset:12800
    ds_read_b64_tr_b16 v[144:145], v60 offset:16384
    ds_read_b64_tr_b16 v[146:147], v60 offset:16896
    ds_read_b64_tr_b16 v[148:149], v61 offset:16384
    ds_read_b64_tr_b16 v[150:151], v61 offset:16896
    ds_read_b64_tr_b16 v[152:153], v62 offset:16384
    ds_read_b64_tr_b16 v[154:155], v62 offset:16896
    ds_read_b64_tr_b16 v[156:157], v63 offset:16384
    ds_read_b64_tr_b16 v[158:159], v63 offset:16896
    s_cmp_eq_u32 s97, 0
    s_cbranch_scc1 L_u_mm
    s_branch L_poll_3
L_poll_3s:
    s_sleep 8
L_poll_3:
    buffer_load_dwordx4 v[8:11], v5, s[40:43], s63 offen offset:0 sc1
    buffer_load_dwordx4 v[12:15], v5, s[40:43], s63 offen offset:1024 sc1
    buffer_load_dwordx4 v[16:19], v5, s[40:43], s63 offen offset:2048 sc1
    buffer_load_dwordx4 v[20:23], v5, s[40:43], s63 offen offset:3072 sc1
    buffer_load_dwordx4 v[24:27], v5, s[40:43], s12 offen offset:0 sc1
    s_sub_u32 s60, s60, 1
    s_cbranch_scc1 L_poll_3t
    s_waitcnt vmcnt(0)
    v_max3_u32 v37, v8, v9, v10
    v_max3_u32 v37, v37, v11, v12
    v_max3_u32 v37, v37, v13, v14
    v_max3_u32 v37, v37, v15, v16
    v_max3_u32 v37, v37, v17, v18
    v_max3_u32 v37, v37, v19, v20
    v_max3_u32 v37, v37, v21, v22
    v_max3_u32 v37, v37, v23, v24
    v_max3_u32 v37, v37, v25, v26
    v_max_u32 v37, v37, v27
    v_cmp_eq_u32 vcc, -1, v37
    s_cbranch_vccnz L_poll_3s
L_poll_3e:
L_u_got:
L_u_mm:
    s_waitcnt lgkmcnt(0)
    v_mfma_f32_16x16x32_bf16 v[40:43], v[80:83], v[8:11], 0
    v_mfma_f32_16x16x32_bf16 v[44:47], v[84:87], v[8:11], 0
    v_mfma_f32_16x16x32_bf16 v[48:51], v[88:91], v[8:11], 0
    v_mfma_f32_16x16x32_bf16 v[52:55], v[92:95], v[8:11], 0
    v_mfma_f32_16x16x32_bf16 v[40:43], v[96:99], v[12:15], v[40:43]
    v_mfma_f32_16x16x32_bf16 v[44:47], v[100:103], v[12:15], v[44:47]
    v_mfma_f32_16x16x32_bf16 v[48:51], v[104:107], v[12:15], v[48:51]
    v_mfma_f32_16x16x32_bf16 v[52:55], v[108:111], v[12:15], v[52:55]
    v_mfma_f32_16x16x32_bf16 v[40:43], v[112:115], v[16:19], v[40:43]
    v_mfma_f32_16x16x32_bf16 v[44:47], v[116:119], v[16:19], v[44:47]
    v_mfma_f32_16x16x32_bf16 v[48:51], v[120:123], v[16:19], v[48:51]
    v_mfma_f32_16x16x32_bf16 v[52:55], v[124:127], v[16:19], v[52:55]
    v_mfma_f32_16x16x32_bf16 v[40:43], v[128:131], v[20:23], v[40:43]
    v_mfma_f32_16x16x32_bf16 v[44:47], v[132:135], v[20:23], v[44:47]
    v_mfma_f32_16x16x32_bf16 v[48:51], v[136:139], v[20:23], v[48:51]
    v_mfma_f32_16x16x32_bf16 v[52:55], v[140:143], v[20:23], v[52:55]
    v_mfma_f32_16x16x32_bf16 v[40:43], v[144:147], v[24:27], v[40:43]
    v_mfma_f32_16x16x32_bf16 v[44:47], v[148:151], v[24:27], v[44:47]
    v_mfma_f32_16x16x32_bf16 v[48:51], v[152:155], v[24:27], v[48:51]
    v_mfma_f32_16x16x32_bf16 v[52:55], v[156:159], v[24:27], v[52:55]
    v_lshlrev_b32 v5, 4, v0
    v_add_u32 v5, 147456, v5
    s_lshl_b32 s62, s3, 10
    s_add_u32 s62, s62, 147456
    v_lshl_add_u32 v6, v69, 4, s62
    v_mov_b32 v24, s58
    v_mov_b32 v32, 162056
    v_mov_b32 v33, 1
    v_add_f32_dpp v40, v40, v40 row_ror:8 row_mask:0xf bank_mask:0xf
    v_add_f32_dpp v41, v41, v41 row_ror:8 row_mask:0xf bank_mask:0xf
    v_add_f32_dpp v42, v42, v42 row_ror:8 row_mask:0xf bank_mask:0xf
    v_add_f32_dpp v43, v43, v43 row_ror:8 row_mask:0xf bank_mask:0xf
    v_add_f32_dpp v44, v44, v44 row_ror:8 row_mask:0xf bank_mask:0xf
    v_add_f32_dpp v45, v45, v45 row_ror:8 row_mask:0xf bank_mask:0xf
    v_add_f32_dpp v46, v46, v46 row_ror:8 row_mask:0xf bank_mask:0xf
    v_add_f32_dpp v47, v47, v47 row_ror:8 row_mask:0xf bank_mask:0xf
    v_add_f32_dpp v48, v48, v48 row_ror:8 row_mask:0xf bank_mask:0xf
    v_add_f32_dpp v49, v49, v49 row_ror:8 row_mask:0xf bank_mask:0xf
    v_add_f32_dpp v50, v50, v50 row_ror:8 row_mask:0xf bank_mask:0xf
    v_add_f32_dpp v51, v51, v51 row_ror:8 row_mask:0xf bank_mask:0xf
    v_add_f32_dpp v52, v52, v52 row_ror:8 row_mask:0xf bank_mask:0xf
    v_add_f32_dpp v53, v53, v53 row_ror:8 row_mask:0xf bank_mask:0xf
    v_add_f32_dpp v54, v54, v54 row_ror:8 row_mask:0xf bank_mask:0xf
    v_add_f32_dpp v55, v55, v55 row_ror:8 row_mask:0xf bank_mask:0xf
    v_add_f32_dpp v28, v40, v40 row_ror:4 row_mask:0xf bank_mask:0x1
    v_add_f32_dpp v29, v41, v41 row_ror:4 row_mask:0xf bank_mask:0x1
    v_add_f32_dpp v30, v42, v42 row_ror:4 row_mask:0xf bank_mask:0x1
    v_add_f32_dpp v31, v43, v43 row_ror:4 row_mask:0xf bank_mask:0x1
    v_add_f32_dpp v28, v44, v44 row_ror:4 row_mask:0xf bank_mask:0x2
    v_add_f32_dpp v29, v45, v45 row_ror:4 row_mask:0xf bank_mask:0x2
    v_add_f32_dpp v30, v46, v46 row_ror:4 row_mask:0xf bank_mask:0x2
    v_add_f32_dpp v31, v47, v47 row_ror:4 row_mask:0xf bank_mask:0x2
    v_add_f32_dpp v28, v48, v48 row_ror:4 row_mask:0xf bank_mask:0x4
    v_add_f32_dpp v29, v49, v49 row_ror:4 row_mask:0xf bank_mask:0x4
    v_add_f32_dpp v30, v50, v50 row_ror:4 row_mask:0xf bank_mask:0x4
    v_add_f32_dpp v31, v51, v51 row_ror:4 row_mask:0xf bank_mask:0x4
    v_add_f32_dpp v28, v52, v52 row_ror:4 row_mask:0xf bank_mask:0x8
    v_add_f32_dpp v29, v53, v53 row_ror:4 row_mask:0xf bank_mask:0x8
    v_add_f32_dpp v30, v54, v54 row_ror:4 row_mask:0xf bank_mask:0x8
    v_add_f32_dpp v31, v55, v55 row_ror:4 row_mask:0xf bank_mask:0x8
    v_fma_f32 v28, v28, s59, v24
    v_fma_f32 v29, v29, s59, v24
    v_fma_f32 v30, v30, s59, v24
    v_fma_f32 v31, v31, s59, v24
    v_mul_f32 v28, v28, v56
    v_mul_f32 v29, v29, v57
    v_mul_f32 v30, v30, v58
    v_mul_f32 v31, v31, v59
    ds_write_b128 v6, v[28:31]
    s_mov_b64 exec, 1
    ds_add_rtn_u32 v34, v32, v33
    s_mov_b64 exec, -1
    ds_read_b128 v[8:11], v5
    ds_read_b128 v[12:15], v5 offset:1024
    ds_read_b128 v[16:19], v5 offset:2048
    ds_read_b128 v[20:23], v5 offset:3072
    s_waitcnt lgkmcnt(0)
    v_readfirstlane_b32 s62, v34
    s_nop 0
    s_cmp_eq_u32 s62, s15
    s_cbranch_scc1 L_u_last
    s_cmp_eq_u32 s62, 1
    s_cbranch_scc1 L_service
    s_endpgm
L_u_last:
    v_add_f32 v8, v8, v12
    v_add_f32 v9, v9, v13
    v_add_f32 v10, v10, v14
    v_add_f32 v11, v11, v15
    s_cmp_eq_u32 s15, 1
    s_cbranch_scc1 L_u_two
    v_add_f32 v16, v16, v20
    v_add_f32 v17, v17, v21
    v_add_f32 v18, v18, v22
    v_add_f32 v19, v19, v23
    v_add_f32 v8, v8, v16
    v_add_f32 v9, v9, v17
    v_add_f32 v10, v10, v18
    v_add_f32 v11, v11, v19
L_u_two:
    v_cvt_pk_bf16_f32 v8, v8, v9
    v_cvt_pk_bf16_f32 v9, v10, v11
    s_waitcnt vmcnt(0)
    v_cmp_ne_u32 vcc, -1, v68
    s_cbranch_vccz L_u_st
L_wy_4:
    buffer_load_dword v68, v65, s[44:47], 0 offen sc1
    s_waitcnt vmcnt(0)
    v_cmp_ne_u32 vcc, -1, v68
    s_cbranch_vccz L_wy_4e
    s_sleep 4
    s_sub_u32 s60, s60, 1
    s_cbranch_scc0 L_wy_4
    s_mov_b32 s60, 0
L_wy_4e:
L_u_st:
    buffer_store_dwordx2 v[8:9], v64, s[40:43], s57 offen sc1
    s_endpgm
L_touch:
    s_load_dword s0, s[32:33], 0
    s_load_dword s0, s[30:31], 0
    s_cmp_eq_u32 s39, 1
    s_cbranch_scc1 L_tpr
    s_mov_b32 s62, 16777216
    s_load_dword s0, s[8:9], s62
    s_mov_b32 s62, 83886080
    s_load_dword s0, s[8:9], s62
    s_mov_b32 s62, 150994944
    s_load_dword s0, s[8:9], s62
    s_mov_b32 s62, 218103808
    s_load_dword s0, s[8:9], s62
    s_branch L_tpv
L_tpr:
    s_load_dword s0, s[20:21], 0
    s_mov_b32 s62, 2211836
    s_load_dword s0, s[20:21], s62
    s_load_dword s0, s[16:17], 0
    s_mov_b32 s62, 2211836
    s_load_dword s0, s[16:17], s62
    s_load_dword s0, s[18:19], 0
    s_load_dword s0, s[22:23], 0
    s_load_dword s0, s[28:29], 0
    s_load_dword s0, s[4:5], 0
L_tpv:
    s_lshl_b32 s62, s34, 23
    s_load_dword s0, s[8:9], s62
    s_add_u32 s62, s62, 67108864
    s_load_dword s0, s[8:9], s62
    s_add_u32 s62, s62, 67108864
    s_load_dword s0, s[8:9], s62
    s_add_u32 s62, s62, 67108864
    s_load_dword s0, s[8:9], s62
    s_add_u32 s62, s62, 67108864
    s_branch L_notp
L_stream2:
    s_mov_b32 s12, s100
    s_mov_b32 s13, s101
    s_andn2_b32 s96, s59, s39
    s_cbranch_scc0 L_noua
    s_barrier
L_noua:
    s_mov_b32 s40, s32
    s_mov_b32 s41, s33
    s_mov_b32 s42, 589824
    s_mov_b32 s43, 0x20000
    s_mov_b32 s44, s30
    s_mov_b32 s45, s31
    s_mov_b32 s46, 256
    s_mov_b32 s47, 0x20000
    s_bitcmp1_b32 s3, 0
    s_mov_b32 s57, 0xffffffff
    s_mov_b32 s58, 0x0
    s_mov_b32 s14, 0xffffffff
    s_mov_b32 s15, 0x0
L_pm_10:
    s_sub_u32 s96, s56, 104
    s_cmp_lt_u32 s96, 66
    s_cbranch_scc0 L_pm_11
    s_bitcmp1_b32 s3, 0
    s_mov_b32 s57, 0xff00000f
    s_mov_b32 s58, 0x0
    s_mov_b32 s14, 0xffffffff
    s_mov_b32 s15, 0x0
L_pm_11:
    s_sub_u32 s96, s56, 144
    s_cmp_lt_u32 s96, 10
    s_cbranch_scc0 L_pm_12
    s_bitcmp1_b32 s3, 0
    s_mov_b32 s57, 0xffffffff
    s_mov_b32 s58, 0xfff
    s_mov_b32 s14, 0xffffffff
    s_mov_b32 s15, 0x0
L_pm_12:
    s_cmp_lt_u32 s56, 104
    s_cbranch_scc0 L_pm_13
    s_bitcmp1_b32 s3, 0
    s_mov_b32 s57, 0xf
    s_mov_b32 s58, 0x0
    s_mov_b32 s14, 0xffffffff
    s_mov_b32 s15, 0x0
L_pm_13:
    s_sub_u32 s96, s56, 43
    s_and_b32 s96, s96, 0xffffffc7
    s_cmp_eq_u32 s96, 0
    s_cbranch_scc0 L_pm_14
    s_bitcmp1_b32 s3, 0
    s_mov_b32 s57, 0x0
    s_mov_b32 s58, 0x0
    s_mov_b32 s14, 0xff000000
    s_mov_b32 s15, 0x0
L_pm_14:
    s_cmp_lt_u32 s56, 40
    s_cbranch_scc0 L_pm_15
    s_bitcmp1_b32 s3, 0
    s_mov_b32 s57, 0xffffffff
    s_mov_b32 s58, 0xf
    s_mov_b32 s14, 0xffffffff
    s_mov_b32 s15, 0x0
L_pm_15:
    s_cmp_eq_u32 s39, 1
    s_cbranch_scc0 L_pm_16
    s_bitcmp1_b32 s3, 0
    s_mov_b32 s57, 0xff
    s_mov_b32 s58, 0xff
    s_mov_b32 s14, 0x0
    s_mov_b32 s15, 0x0
L_pm_16:
    s_cmp_lg_u32 s13, 0
    s_cbranch_scc0 L_pm_17
    s_bitcmp1_b32 s3, 0
    s_mov_b32 s57, 0xffffffff
    s_mov_b32 s58, 0x0
    s_mov_b32 s14, 0x0
    s_mov_b32 s15, 0x0
L_pm_17:
    s_and_b32 s96, s39, s59
    s_cbranch_scc0 L_pm_18
    s_bitcmp1_b32 s3, 0
    s_mov_b32 s57, 0x3ff
    s_mov_b32 s58, 0x3ff
    s_mov_b32 s14, 0x0
    s_mov_b32 s15, 0x0
L_pm_18:
    s_add_u32 s52, s8, s63
    s_addc_u32 s53, s9, 0
    s_mov_b32 s54, 262144
    s_mov_b32 s55, 0x20000
    v_and_b32 v2, 15, v0
    v_lshrrev_b32 v3, 1, v2
    v_and_b32 v37, 1, v2
    v_lshlrev_b32 v37, 4, v37
    v_mov_b32 v38, 0xffff
    v_lshlrev_b32 v37, v37, v38
    v_cmp_eq_u32 vcc, 0, v3
    v_mov_b32 v32, 0
    s_nop 0
    v_cndmask_b32 v20, 0, v37, vcc
    v_cmp_eq_u32 vcc, 1, v3
    v_mov_b32 v33, 0
    s_nop 0
    v_cndmask_b32 v21, 0, v37, vcc
    v_cmp_eq_u32 vcc, 2, v3
    v_mov_b32 v34, 0
    s_nop 0
    v_cndmask_b32 v22, 0, v37, vcc
    v_cmp_eq_u32 vcc, 3, v3
    v_mov_b32 v35, 0
    s_nop 0
    v_cndmask_b32 v23, 0, v37, vcc
    v_lshlrev_b32 v2, 4, v2
    s_lshl_b32 s98, s62, 8
    s_add_u32 s98, s98, 40960
    s_bitcmp0_b32 s57, 2
    s_cbranch_scc1 L_sf_19
    s_bitcmp0_b32 s58, 2
    s_cbranch_scc1 L_sf_19
    s_waitcnt vmcnt(1)
L_sf_19:
    buffer_load_dwordx4 v[48:51], v1, s[48:51], s97 offen offset:2048 nt
    s_bitcmp0_b32 s57, 3
    s_cbranch_scc1 L_sf_20
    s_waitcnt vmcnt(2)
    s_bitcmp0_b32 s58, 3
    s_cbranch_scc1 L_sf_20
    s_waitcnt vmcnt(1)
L_sf_20:
    buffer_load_dwordx4 v[52:55], v1, s[48:51], s97 offen offset:3072 nt
    s_add_u32 s97, s97, 32768
    v_add_u32 v1, 4096, v1
    v_and_b32 v1, 0x7fff, v1
    s_waitcnt vmcnt(3)
    s_bitcmp0_b32 s57, 4
    s_cbranch_scc1 L_sf_21
    s_waitcnt vmcnt(2)
    s_bitcmp0_b32 s58, 4
    s_cbranch_scc1 L_sf_21
    s_waitcnt vmcnt(1)
L_sf_21:
    buffer_load_dwordx4 v[56:59], v1, s[48:51], s97 offen offset:0 nt
    s_waitcnt vmcnt(3)
    s_bitcmp0_b32 s57, 5
    s_cbranch_scc1 L_sf_22
    s_waitcnt vmcnt(2)
    s_bitcmp0_b32 s58, 5
    s_cbranch_scc1 L_sf_22
    s_waitcnt vmcnt(1)
L_sf_22:
    buffer_load_dwordx4 v[60:63], v1, s[48:51], s97 offen offset:1024 nt
    s_waitcnt vmcnt(3)
    s_bitcmp0_b32 s57, 6
    s_cbranch_scc1 L_sf_23
    s_waitcnt vmcnt(2)
    s_bitcmp0_b32 s58, 6
    s_cbranch_scc1 L_sf_23
    s_waitcnt vmcnt(1)
L_sf_23:
    buffer_load_dwordx4 v[64:67], v1, s[48:51], s97 offen offset:2048 nt
    s_waitcnt vmcnt(3)
    s_bitcmp0_b32 s57, 7
    s_cbranch_scc1 L_sf_24
    s_waitcnt vmcnt(2)
    s_bitcmp0_b32 s58, 7
    s_cbranch_scc1 L_sf_24
    s_waitcnt vmcnt(1)
L_sf_24:
    buffer_load_dwordx4 v[68:71], v1, s[48:51], s97 offen offset:3072 nt
    s_add_u32 s97, s97, 32768
    v_add_u32 v1, 4096, v1
    v_and_b32 v1, 0x7fff, v1
    s_waitcnt vmcnt(3)
    s_bitcmp0_b32 s57, 8
    s_cbranch_scc1 L_sf_25
    s_waitcnt vmcnt(2)
    s_bitcmp0_b32 s58, 8
    s_cbranch_scc1 L_sf_25
    s_waitcnt vmcnt(1)
L_sf_25:
    buffer_load_dwordx4 v[72:75], v1, s[48:51], s97 offen offset:0 nt
    s_waitcnt vmcnt(3)
    s_bitcmp0_b32 s57, 9
    s_cbranch_scc1 L_sf_26
    s_waitcnt vmcnt(2)
    s_bitcmp0_b32 s58, 9
    s_cbranch_scc1 L_sf_26
    s_waitcnt vmcnt(1)
L_sf_26:
    buffer_load_dwordx4 v[76:79], v1, s[48:51], s97 offen offset:1024 nt
    s_waitcnt vmcnt(3)
    s_bitcmp0_b32 s57, 10
    s_cbranch_scc1 L_sf_27
    s_waitcnt vmcnt(2)
    s_bitcmp0_b32 s58, 10
    s_cbranch_scc1 L_sf_27
    s_waitcnt vmcnt(1)
L_sf_27:
    buffer_load_dwordx4 v[80:83], v1, s[48:51], s97 offen offset:2048 nt
    s_waitcnt vmcnt(3)
    s_bitcmp0_b32 s57, 11
    s_cbranch_scc1 L_sf_28
    s_waitcnt vmcnt(2)
    s_bitcmp0_b32 s58, 11
    s_cbranch_scc1 L_sf_28
    s_waitcnt vmcnt(1)
L_sf_28:
    buffer_load_dwordx4 v[84:87], v1, s[48:51], s97 offen offset:3072 nt
    s_add_u32 s97, s97, 32768
    v_add_u32 v1, 4096, v1
    v_and_b32 v1, 0x7fff, v1
    s_waitcnt vmcnt(3)
    s_bitcmp0_b32 s57, 12
    s_cbranch_scc1 L_sf_29
    s_waitcnt vmcnt(2)
    s_bitcmp0_b32 s58, 12
    s_cbranch_scc1 L_sf_29
    s_waitcnt vmcnt(1)
L_sf_29:
    buffer_load_dwordx4 v[88:91], v1, s[48:51], s97 offen offset:0 nt
    s_waitcnt vmcnt(3)
    s_bitcmp0_b32 s57, 13
    s_cbranch_scc1 L_sf_30
    s_waitcnt vmcnt(2)
    s_bitcmp0_b32 s58, 13
    s_cbranch_scc1 L_sf_30
    s_waitcnt vmcnt(1)
L_sf_30:
    buffer_load_dwordx4 v[92:95], v1, s[48:51], s97 offen offset:1024 nt
    s_waitcnt vmcnt(3)
    s_bitcmp0_b32 s57, 14
    s_cbranch_scc1 L_sf_31
    s_waitcnt vmcnt(2)
    s_bitcmp0_b32 s58, 14
    s_cbranch_scc1 L_sf_31
    s_waitcnt vmcnt(1)
L_sf_31:
    buffer_load_dwordx4 v[96:99], v1, s[48:51], s97 offen offset:2048 nt
    s_waitcnt vmcnt(3)
    s_bitcmp0_b32 s57, 15
    s_cbranch_scc1 L_sf_32
    s_waitcnt vmcnt(2)
    s_bitcmp0_b32 s58, 15
    s_cbranch_scc1 L_sf_32
    s_waitcnt vmcnt(1)
L_sf_32:
    buffer_load_dwordx4 v[100:103], v1, s[48:51], s97 offen offset:3072 nt
    s_add_u32 s97, s97, 32768
    v_add_u32 v1, 4096, v1
    v_and_b32 v1, 0x7fff, v1
    s_waitcnt vmcnt(3)
    s_bitcmp0_b32 s57, 16
    s_cbranch_scc1 L_sf_33
    s_waitcnt vmcnt(2)
    s_bitcmp0_b32 s58, 16
    s_cbranch_scc1 L_sf_33
    s_waitcnt vmcnt(1)
L_sf_33:
    buffer_load_dwordx4 v[104:107], v1, s[48:51], s97 offen offset:0 nt
    s_waitcnt vmcnt(3)
    s_bitcmp0_b32 s57, 17
    s_cbranch_scc1 L_sf_34
    s_waitcnt vmcnt(2)
    s_bitcmp0_b32 s58, 17
    s_cbranch_scc1 L_sf_34
    s_waitcnt vmcnt(1)
L_sf_34:
    buffer_load_dwordx4 v[108:111], v1, s[48:51], s97 offen offset:1024 nt
    s_waitcnt vmcnt(3)
    s_bitcmp0_b32 s57, 18
    s_cbranch_scc1 L_sf_35
    s_waitcnt vmcnt(2)
    s_bitcmp0_b32 s58, 18
    s_cbranch_scc1 L_sf_35
    s_waitcnt vmcnt(1)
L_sf_35:
    buffer_load_dwordx4 v[112:115], v1, s[48:51], s97 offen offset:2048 nt
    s_waitcnt vmcnt(3)
    s_bitcmp0_b32 s57, 19
    s_cbranch_scc1 L_sf_36
    s_waitcnt vmcnt(2)
    s_bitcmp0_b32 s58, 19
    s_cbranch_scc1 L_sf_36
    s_waitcnt vmcnt(1)
L_sf_36:
    buffer_load_dwordx4 v[116:119], v1, s[48:51], s97 offen offset:3072 nt
    s_add_u32 s97, s97, 32768
    v_add_u32 v1, 4096, v1
    v_and_b32 v1, 0x7fff, v1
    s_waitcnt vmcnt(3)
    s_bitcmp0_b32 s57, 20
    s_cbranch_scc1 L_sf_37
    s_waitcnt vmcnt(2)
    s_bitcmp0_b32 s58, 20
    s_cbranch_scc1 L_sf_37
    s_waitcnt vmcnt(1)
L_sf_37:
    buffer_load_dwordx4 v[120:123], v1, s[48:51], s97 offen offset:0 nt
    s_waitcnt vmcnt(3)
    s_bitcmp0_b32 s57, 21
    s_cbranch_scc1 L_sf_38
    s_waitcnt vmcnt(2)
    s_bitcmp0_b32 s58, 21
    s_cbranch_scc1 L_sf_38
    s_waitcnt vmcnt(1)
L_sf_38:
    buffer_load_dwordx4 v[124:127], v1, s[48:51], s97 offen offset:1024 nt
    s_cmp_eq_u32 s12, -1
    s_cbranch_scc1 L_k_nopf
    s_waitcnt vmcnt(3)
    s_bitcmp0_b32 s57, 22
    s_cbranch_scc1 L_sf_39
    s_waitcnt vmcnt(2)
    s_bitcmp0_b32 s58, 22
    s_cbranch_scc1 L_sf_39
    s_waitcnt vmcnt(1)
L_sf_39:
    buffer_load_dwordx4 v[128:131], v1, s[48:51], s97 offen offset:2048 nt
    s_waitcnt vmcnt(3)
    s_bitcmp0_b32 s57, 23
    s_cbranch_scc1 L_sf_40
    s_waitcnt vmcnt(2)
    s_bitcmp0_b32 s58, 23
    s_cbranch_scc1 L_sf_40
    s_waitcnt vmcnt(1)
L_sf_40:
    buffer_load_dwordx4 v[132:135], v1, s[48:51], s97 offen offset:3072 nt
    s_add_u32 s97, s97, 32768
    v_add_u32 v1, 4096, v1
    v_and_b32 v1, 0x7fff, v1
    s_waitcnt vmcnt(3)
    s_bitcmp0_b32 s57, 24
    s_cbranch_scc1 L_sf_41
    s_waitcnt vmcnt(2)
    s_bitcmp0_b32 s58, 24
    s_cbranch_scc1 L_sf_41
    s_waitcnt vmcnt(1)
L_sf_41:
    buffer_load_dwordx4 v[136:139], v1, s[48:51], s97 offen offset:0 nt
    s_waitcnt vmcnt(3)
    s_bitcmp0_b32 s57, 25
    s_cbranch_scc1 L_sf_42
    s_waitcnt vmcnt(2)
    s_bitcmp0_b32 s58, 25
    s_cbranch_scc1 L_sf_42
    s_waitcnt vmcnt(1)
L_sf_42:
    buffer_load_dwordx4 v[140:143], v1, s[48:51], s97 offen offset:1024 nt
    s_waitcnt vmcnt(3)
    s_bitcmp0_b32 s57, 26
    s_cbranch_scc1 L_sf_43
    s_waitcnt vmcnt(2)
    s_bitcmp0_b32 s58, 26
    s_cbranch_scc1 L_sf_43
    s_waitcnt vmcnt(1)
L_sf_43:
    buffer_load_dwordx4 v[144:147], v1, s[48:51], s97 offen offset:2048 nt
    s_waitcnt vmcnt(3)
    s_bitcmp0_b32 s57, 27
    s_cbranch_scc1 L_sf_44
    s_waitcnt vmcnt(2)
    s_bitcmp0_b32 s58, 27
    s_cbranch_scc1 L_sf_44
    s_waitcnt vmcnt(1)
L_sf_44:
    buffer_load_dwordx4 v[148:151], v1, s[48:51], s97 offen offset:3072 nt
    s_add_u32 s97, s97, 32768
    v_add_u32 v1, 4096, v1
    v_and_b32 v1, 0x7fff, v1
    s_waitcnt vmcnt(3)
    s_bitcmp0_b32 s57, 28
    s_cbranch_scc1 L_sf_45
    s_waitcnt vmcnt(2)
    s_bitcmp0_b32 s58, 28
    s_cbranch_scc1 L_sf_45
    s_waitcnt vmcnt(1)
L_sf_45:
    buffer_load_dwordx4 v[152:155], v1, s[48:51], s97 offen offset:0 nt
    s_waitcnt vmcnt(3)
    s_bitcmp0_b32 s57, 29
    s_cbranch_scc1 L_sf_46
    s_waitcnt vmcnt(2)
    s_bitcmp0_b32 s58, 29
    s_cbranch_scc1 L_sf_46
    s_waitcnt vmcnt(1)
L_sf_46:
    buffer_load_dwordx4 v[156:159], v1, s[48:51], s97 offen offset:1024 nt
    s_waitcnt vmcnt(3)
    s_bitcmp0_b32 s57, 30
    s_cbranch_scc1 L_sf_47
    s_waitcnt vmcnt(2)
    s_bitcmp0_b32 s58, 30
    s_cbranch_scc1 L_sf_47
    s_waitcnt vmcnt(1)
L_sf_47:
    buffer_load_dwordx4 v[160:163], v1, s[48:51], s97 offen offset:2048 nt
    v_min_u32 v39, 15, v0
    v_and_b32 v38, 1, v39
    v_mul_u32_u24 v38, 126, v38
    v_lshl_add_u32 v39, v39, 1, v38
    buffer_load_dword v37, v39, s[44:47], 0 offen sc1
    s_waitcnt vmcnt(4)
    s_bitcmp0_b32 s57, 31
    s_cbranch_scc1 L_sf_48
    s_waitcnt vmcnt(3)
    s_bitcmp0_b32 s58, 31
    s_cbranch_scc1 L_sf_48
    s_waitcnt vmcnt(2)
L_sf_48:
    buffer_load_dwordx4 v[164:167], v1, s[48:51], s97 offen offset:3072 nt
    s_mov_b32 s97, 0
    v_add_u32 v1, 4096, v1
    v_and_b32 v1, 0x7fff, v1
    s_waitcnt vmcnt(4)
    s_bitcmp0_b32 s14, 0
    s_cbranch_scc1 L_sf_49
    s_waitcnt vmcnt(3)
    s_bitcmp0_b32 s15, 0
    s_cbranch_scc1 L_sf_49
    s_waitcnt vmcnt(2)
L_sf_49:
    s_add_u32 m0, s12, 0
    s_nop 0
    buffer_load_dwordx4 v1, s[52:55], s97 offen offset:0 nt lds
    s_waitcnt vmcnt(4)
    s_bitcmp0_b32 s14, 1
    s_cbranch_scc1 L_sf_50
    s_waitcnt vmcnt(3)
    s_bitcmp0_b32 s15, 1
    s_cbranch_scc1 L_sf_50
    s_waitcnt vmcnt(1)
L_sf_50:
    buffer_load_dwordx4 v1, s[52:55], s97 offen offset:1024 nt lds
    s_waitcnt vmcnt(4)
    s_bitcmp0_b32 s14, 2
    s_cbranch_scc1 L_sf_51
    s_waitcnt vmcnt(2)
    s_bitcmp0_b32 s15, 2
    s_cbranch_scc1 L_sf_51
    s_waitcnt vmcnt(1)
L_sf_51:
    buffer_load_dwordx4 v1, s[52:55], s97 offen offset:2048 nt lds
    s_waitcnt vmcnt(3)
    s_bitcmp0_b32 s14, 3
    s_cbranch_scc1 L_sf_52
    s_waitcnt vmcnt(2)
    s_bitcmp0_b32 s15, 3
    s_cbranch_scc1 L_sf_52
    s_waitcnt vmcnt(1)
L_sf_52:
    buffer_load_dwordx4 v1, s[52:55], s97 offen offset:3072 nt lds
    s_add_u32 s97, s97, 32768
    v_add_u32 v1, 4096, v1
    v_and_b32 v1, 0x7fff, v1
    v_cmp_eq_u32 vcc, 0, v37
    s_nop 0
    s_or_b32 s96, vcc_lo, vcc_hi
    buffer_load_dwordx4 v[4:7], v2, s[40:43], s98 offen sc1
    s_waitcnt vmcnt(4)
    s_bitcmp0_b32 s14, 4
    s_cbranch_scc1 L_sf_53
    s_waitcnt vmcnt(3)
    s_bitcmp0_b32 s15, 4
    s_cbranch_scc1 L_sf_53
    s_waitcnt vmcnt(2)
L_sf_53:
    s_add_u32 m0, s12, 4096
    s_nop 0
    buffer_load_dwordx4 v1, s[52:55], s97 offen offset:0 nt lds
    s_waitcnt vmcnt(4)
    s_bitcmp0_b32 s14, 5
    s_cbranch_scc1 L_sf_54
    s_waitcnt vmcnt(3)
    s_bitcmp0_b32 s15, 5
    s_cbranch_scc1 L_sf_54
    s_waitcnt vmcnt(2)
L_sf_54:
    buffer_load_dwordx4 v1, s[52:55], s97 offen offset:1024 nt lds
    s_waitcnt vmcnt(4)
    s_bitcmp0_b32 s14, 6
    s_cbranch_scc1 L_sf_55
    s_waitcnt vmcnt(3)
    s_bitcmp0_b32 s15, 6
    s_cbranch_scc1 L_sf_55
    s_waitcnt vmcnt(1)
L_sf_55:
    buffer_load_dwordx4 v1, s[52:55], s97 offen offset:2048 nt lds
    s_waitcnt vmcnt(4)
    s_bitcmp0_b32 s14, 7
    s_cbranch_scc1 L_sf_56
    s_waitcnt vmcnt(2)
    s_bitcmp0_b32 s15, 7
    s_cbranch_scc1 L_sf_56
    s_waitcnt vmcnt(1)
L_sf_56:
    buffer_load_dwordx4 v1, s[52:55], s97 offen offset:3072 nt lds
    s_add_u32 s97, s97, 32768
    v_add_u32 v1, 4096, v1
    v_and_b32 v1, 0x7fff, v1
L_k_join:
    s_waitcnt vmcnt(4)
    v_max3_u32 v38, v4, v5, v6
    v_max_u32 v38, v38, v7
    v_cmp_eq_u32 vcc, -1, v38
    s_cmp_lg_u32 s96, 0
    s_cbranch_scc1 L_qslow
    s_cbranch_vccnz L_qslow2
L_qok:
    v_dot2_f32_bf16 v8, v72, v4, 0
    v_dot2_f32_bf16 v9, v76, v4, 0
    v_dot2_f32_bf16 v10, v80, v4, 0
    v_dot2_f32_bf16 v11, v84, v4, 0
    v_dot2_f32_bf16 v24, v88, v4, 0
    v_dot2_f32_bf16 v25, v92, v4, 0
    v_dot2_f32_bf16 v26, v96, v4, 0
    v_dot2_f32_bf16 v27, v100, v4, 0
    v_dot2_f32_bf16 v8, v73, v5, v8
    v_dot2_f32_bf16 v9, v77, v5, v9
    v_dot2_f32_bf16 v10, v81, v5, v10
    v_dot2_f32_bf16 v11, v85, v5, v11
    v_dot2_f32_bf16 v24, v89, v5, v24
    v_dot2_f32_bf16 v25, v93, v5, v25
    v_dot2_f32_bf16 v26, v97, v5, v26
    v_dot2_f32_bf16 v27, v101, v5, v27
    v_dot2_f32_bf16 v8, v74, v6, v8
    v_dot2_f32_bf16 v9, v78, v6, v9
    v_dot2_f32_bf16 v10, v82, v6, v10
    v_dot2_f32_bf16 v11, v86, v6, v11
    v_dot2_f32_bf16 v24, v90, v6, v24
    v_dot2_f32_bf16 v25, v94, v6, v25
    v_dot2_f32_bf16 v26, v98, v6, v26
    v_dot2_f32_bf16 v27, v102, v6, v27
    v_dot2_f32_bf16 v8, v75, v7, v8
    v_dot2_f32_bf16 v9, v79, v7, v9
    v_dot2_f32_bf16 v10, v83, v7, v10
    v_dot2_f32_bf16 v11, v87, v7, v11
    v_dot2_f32_bf16 v24, v91, v7, v24
    v_dot2_f32_bf16 v25, v95, v7, v25
    v_dot2_f32_bf16 v26, v99, v7, v26
    v_dot2_f32_bf16 v27, v103, v7, v27
    v_add_f32_dpp v8, v8, v8 row_ror:8 row_mask:0xf bank_mask:0x3
    v_add_f32_dpp v10, v10, v10 row_ror:8 row_mask:0xf bank_mask:0x3
    v_add_f32_dpp v24, v24, v24 row_ror:8 row_mask:0xf bank_mask:0x3
    v_add_f32_dpp v26, v26, v26 row_ror:8 row_mask:0xf bank_mask:0x3
    v_add_f32_dpp v8, v9, v9 row_ror:8 row_mask:0xf bank_mask:0xc
    v_add_f32_dpp v10, v11, v11 row_ror:8 row_mask:0xf bank_mask:0xc
    v_add_f32_dpp v24, v25, v25 row_ror:8 row_mask:0xf bank_mask:0xc
    v_add_f32_dpp v26, v27, v27 row_ror:8 row_mask:0xf bank_mask:0xc
    v_add_f32_dpp v14, v8, v8 row_half_mirror row_mask:0xf bank_mask:0x5
    v_add_f32_dpp v15, v24, v24 row_half_mirror row_mask:0xf bank_mask:0x5
    v_add_f32_dpp v14, v10, v10 row_half_mirror row_mask:0xf bank_mask:0xa
    v_add_f32_dpp v15, v26, v26 row_half_mirror row_mask:0xf bank_mask:0xa
    s_nop 0
    v_add_f32_dpp v14, v14, v14 quad_perm:[1,0,3,2] row_mask:0xf bank_mask:0xf
    v_add_f32_dpp v15, v15, v15 quad_perm:[1,0,3,2] row_mask:0xf bank_mask:0xf
    s_nop 0
    v_add_f32_dpp v14, v14, v14 quad_perm:[2,3,0,1] row_mask:0xf bank_mask:0xf
    v_add_f32_dpp v15, v15, v15 quad_perm:[2,3,0,1] row_mask:0xf bank_mask:0xf
    s_waitcnt vmcnt(3)
    s_bitcmp0_b32 s14, 8
    s_cbranch_scc1 L_sf_67
    s_waitcnt vmcnt(2)
    s_bitcmp0_b32 s15, 8
    s_cbranch_scc1 L_sf_67
    s_waitcnt vmcnt(1)
L_sf_67:
    buffer_load_dwordx4 v[72:75], v1, s[52:55], s97 offen offset:0 nt
    v_dot2_f32_bf16 v8, v40, v4, 0
    v_dot2_f32_bf16 v9, v44, v4, 0
    v_dot2_f32_bf16 v10, v48, v4, 0
    v_dot2_f32_bf16 v11, v52, v4, 0
    v_dot2_f32_bf16 v24, v56, v4, 0
    v_dot2_f32_bf16 v25, v60, v4, 0
    v_dot2_f32_bf16 v26, v64, v4, 0
    v_dot2_f32_bf16 v27, v68, v4, 0
    v_dot2_f32_bf16 v28, v104, v4, 0
    v_dot2_f32_bf16 v29, v108, v4, 0
    v_dot2_f32_bf16 v30, v112, v4, 0
    v_dot2_f32_bf16 v31, v116, v4, 0
    v_dot2_f32_bf16 v8, v41, v5, v8
    v_dot2_f32_bf16 v9, v45, v5, v9
    v_dot2_f32_bf16 v10, v49, v5, v10
    v_dot2_f32_bf16 v11, v53, v5, v11
    v_dot2_f32_bf16 v24, v57, v5, v24
    v_dot2_f32_bf16 v25, v61, v5, v25
    v_dot2_f32_bf16 v26, v65, v5, v26
    v_dot2_f32_bf16 v27, v69, v5, v27
    v_dot2_f32_bf16 v28, v105, v5, v28
    v_dot2_f32_bf16 v29, v109, v5, v29
    v_dot2_f32_bf16 v30, v113, v5, v30
    v_dot2_f32_bf16 v31, v117, v5, v31
    v_dot2_f32_bf16 v8, v42, v6, v8
    v_dot2_f32_bf16 v9, v46, v6, v9
    v_dot2_f32_bf16 v10, v50, v6, v10
    v_dot2_f32_bf16 v11, v54, v6, v11
    v_dot2_f32_bf16 v24, v58, v6, v24
    v_dot2_f32_bf16 v25, v62, v6, v25
    v_dot2_f32_bf16 v26, v66, v6, v26
    v_dot2_f32_bf16 v27, v70, v6, v27
    v_dot2_f32_bf16 v28, v106, v6, v28
    v_dot2_f32_bf16 v29, v110, v6, v29
    v_dot2_f32_bf16 v30, v114, v6, v30
    v_dot2_f32_bf16 v31, v118, v6, v31
    v_dot2_f32_bf16 v8, v43, v7, v8
    v_dot2_f32_bf16 v9, v47, v7, v9
    v_dot2_f32_bf16 v10, v51, v7, v10
    v_dot2_f32_bf16 v11, v55, v7, v11
    v_dot2_f32_bf16 v24, v59, v7, v24
    v_dot2_f32_bf16 v25, v63, v7, v25
    v_dot2_f32_bf16 v26, v67, v7, v26
    v_dot2_f32_bf16 v27, v71, v7, v27
    v_dot2_f32_bf16 v28, v107, v7, v28
    v_dot2_f32_bf16 v29, v111, v7, v29
    v_dot2_f32_bf16 v30, v115, v7, v30
    v_dot2_f32_bf16 v31, v119, v7, v31
    v_add_f32_dpp v8, v8, v8 row_ror:8 row_mask:0xf bank_mask:0x3
    v_add_f32_dpp v10, v10, v10 row_ror:8 row_mask:0xf bank_mask:0x3
    v_add_f32_dpp v24, v24, v24 row_ror:8 row_mask:0xf bank_mask:0x3
    v_add_f32_dpp v26, v26, v26 row_ror:8 row_mask:0xf bank_mask:0x3
    v_add_f32_dpp v28, v28, v28 row_ror:8 row_mask:0xf bank_mask:0x3
    v_add_f32_dpp v30, v30, v30 row_ror:8 row_mask:0xf bank_mask:0x3
    v_add_f32_dpp v8, v9, v9 row_ror:8 row_mask:0xf bank_mask:0xc
    v_add_f32_dpp v10, v11, v11 row_ror:8 row_mask:0xf bank_mask:0xc
    v_add_f32_dpp v24, v25, v25 row_ror:8 row_mask:0xf bank_mask:0xc
    v_add_f32_dpp v26, v27, v27 row_ror:8 row_mask:0xf bank_mask:0xc
    v_add_f32_dpp v28, v29, v29 row_ror:8 row_mask:0xf bank_mask:0xc
    v_add_f32_dpp v30, v31, v31 row_ror:8 row_mask:0xf bank_mask:0xc
    v_add_f32_dpp v12, v8, v8 row_half_mirror row_mask:0xf bank_mask:0x5
    v_add_f32_dpp v13, v24, v24 row_half_mirror row_mask:0xf bank_mask:0x5
    v_add_f32_dpp v16, v28, v28 row_half_mirror row_mask:0xf bank_mask:0x5
    v_add_f32_dpp v12, v10, v10 row_half_mirror row_mask:0xf bank_mask:0xa
    v_add_f32_dpp v13, v26, v26 row_half_mirror row_mask:0xf bank_mask:0xa
    v_add_f32_dpp v16, v30, v30 row_half_mirror row_mask:0xf bank_mask:0xa
    v_add_f32_dpp v12, v12, v12 quad_perm:[1,0,3,2] row_mask:0xf bank_mask:0xf
    v_add_f32_dpp v13, v13, v13 quad_perm:[1,0,3,2] row_mask:0xf bank_mask:0xf
    v_add_f32_dpp v16, v16, v16 quad_perm:[1,0,3,2] row_mask:0xf bank_mask:0xf
    v_add_f32_dpp v12, v12, v12 quad_perm:[2,3,0,1] row_mask:0xf bank_mask:0xf
    v_add_f32_dpp v13, v13, v13 quad_perm:[2,3,0,1] row_mask:0xf bank_mask:0xf
    v_add_f32_dpp v16, v16, v16 quad_perm:[2,3,0,1] row_mask:0xf bank_mask:0xf
    s_waitcnt vmcnt(3)
    s_bitcmp0_b32 s14, 9
    s_cbranch_scc1 L_sf_68
    s_waitcnt vmcnt(2)
    s_bitcmp0_b32 s15, 9
    s_cbranch_scc1 L_sf_68
    s_waitcnt vmcnt(1)
L_sf_68:
    buffer_load_dwordx4 v[76:79], v1, s[52:55], s97 offen offset:1024 nt
    v_dot2_f32_bf16 v8, v120, v4, 0
    v_dot2_f32_bf16 v9, v124, v4, 0
    v_dot2_f32_bf16 v10, v128, v4, 0
    v_dot2_f32_bf16 v11, v132, v4, 0
    v_dot2_f32_bf16 v24, v136, v4, 0
    v_dot2_f32_bf16 v25, v140, v4, 0
    v_dot2_f32_bf16 v26, v144, v4, 0
    v_dot2_f32_bf16 v27, v148, v4, 0
    v_dot2_f32_bf16 v8, v121, v5, v8
    v_dot2_f32_bf16 v9, v125, v5, v9
    v_dot2_f32_bf16 v10, v129, v5, v10
    v_dot2_f32_bf16 v11, v133, v5, v11
    v_dot2_f32_bf16 v24, v137, v5, v24
    v_dot2_f32_bf16 v25, v141, v5, v25
    v_dot2_f32_bf16 v26, v145, v5, v26
    v_dot2_f32_bf16 v27, v149, v5, v27
    v_dot2_f32_bf16 v8, v122, v6, v8
    v_dot2_f32_bf16 v9, v126, v6, v9
    v_dot2_f32_bf16 v10, v130, v6, v10
    v_dot2_f32_bf16 v11, v134, v6, v11
    v_dot2_f32_bf16 v24, v138, v6, v24
    v_dot2_f32_bf16 v25, v142, v6, v25
    v_dot2_f32_bf16 v26, v146, v6, v26
    v_dot2_f32_bf16 v27, v150, v6, v27
    v_dot2_f32_bf16 v8, v123, v7, v8
    v_dot2_f32_bf16 v9, v127, v7, v9
    v_dot2_f32_bf16 v10, v131, v7, v10
    v_dot2_f32_bf16 v11, v135, v7, v11
    v_dot2_f32_bf16 v24, v139, v7, v24
    v_dot2_f32_bf16 v25, v143, v7, v25
    v_dot2_f32_bf16 v26, v147, v7, v26
    v_dot2_f32_bf16 v27, v151, v7, v27
    v_add_f32_dpp v8, v8, v8 row_ror:8 row_mask:0xf bank_mask:0x3
    v_add_f32_dpp v10, v10, v10 row_ror:8 row_mask:0xf bank_mask:0x3
    v_add_f32_dpp v24, v24, v24 row_ror:8 row_mask:0xf bank_mask:0x3
    v_add_f32_dpp v26, v26, v26 row_ror:8 row_mask:0xf bank_mask:0x3
    v_add_f32_dpp v8, v9, v9 row_ror:8 row_mask:0xf bank_mask:0xc
    v_add_f32_dpp v10, v11, v11 row_ror:8 row_mask:0xf bank_mask:0xc
    v_add_f32_dpp v24, v25, v25 row_ror:8 row_mask:0xf bank_mask:0xc
    v_add_f32_dpp v26, v27, v27 row_ror:8 row_mask:0xf bank_mask:0xc
    v_add_f32_dpp v17, v8, v8 row_half_mirror row_mask:0xf bank_mask:0x5
    v_add_f32_dpp v18, v24, v24 row_half_mirror row_mask:0xf bank_mask:0x5
    v_add_f32_dpp v17, v10, v10 row_half_mirror row_mask:0xf bank_mask:0xa
    v_add_f32_dpp v18, v26, v26 row_half_mirror row_mask:0xf bank_mask:0xa
    s_nop 0
    v_add_f32_dpp v17, v17, v17 quad_perm:[1,0,3,2] row_mask:0xf bank_mask:0xf
    v_add_f32_dpp v18, v18, v18 quad_perm:[1,0,3,2] row_mask:0xf bank_mask:0xf
    s_nop 0
    v_add_f32_dpp v17, v17, v17 quad_perm:[2,3,0,1] row_mask:0xf bank_mask:0xf
    v_add_f32_dpp v18, v18, v18 quad_perm:[2,3,0,1] row_mask:0xf bank_mask:0xf
    s_waitcnt vmcnt(3)
    s_bitcmp0_b32 s14, 10
    s_cbranch_scc1 L_sf_69
    s_waitcnt vmcnt(2)
    s_bitcmp0_b32 s15, 10
    s_cbranch_scc1 L_sf_69
    s_waitcnt vmcnt(1)
L_sf_69:
    buffer_load_dwordx4 v[80:83], v1, s[52:55], s97 offen offset:2048 nt
    s_waitcnt vmcnt(3)
    s_bitcmp0_b32 s14, 11
    s_cbranch_scc1 L_sf_70
    s_waitcnt vmcnt(2)
    s_bitcmp0_b32 s15, 11
    s_cbranch_scc1 L_sf_70
    s_waitcnt vmcnt(1)
L_sf_70:
    buffer_load_dwordx4 v[84:87], v1, s[52:55], s97 offen offset:3072 nt
    s_add_u32 s97, s97, 32768
    v_add_u32 v1, 4096, v1
    v_and_b32 v1, 0x7fff, v1
    s_cmp_eq_u32 s12, -1
    s_cbranch_scc1 L_nopfrd
    v_lshl_add_u32 v38, v0, 4, s12
    ds_read_b128 v[40:43], v38 offset:0
    ds_read_b128 v[44:47], v38 offset:1024
    ds_read_b128 v[48:51], v38 offset:2048
    ds_read_b128 v[52:55], v38 offset:3072
    ds_read_b128 v[56:59], v38 offset:4096
    ds_read_b128 v[60:63], v38 offset:5120
    ds_read_b128 v[64:67], v38 offset:6144
    ds_read_b128 v[68:71], v38 offset:7168
L_nopfrd:
    v_dot2_f32_bf16 v8, v152, v4, 0
    v_dot2_f32_bf16 v9, v156, v4, 0
    v_dot2_f32_bf16 v10, v160, v4, 0
    v_dot2_f32_bf16 v11, v164, v4, 0
    v_dot2_f32_bf16 v8, v153, v5, v8
    v_dot2_f32_bf16 v9, v157, v5, v9
    v_dot2_f32_bf16 v10, v161, v5, v10
    v_dot2_f32_bf16 v11, v165, v5, v11
    v_dot2_f32_bf16 v8, v154, v6, v8
    v_dot2_f32_bf16 v9, v158, v6, v9
    v_dot2_f32_bf16 v10, v162, v6, v10
    v_dot2_f32_bf16 v11, v166, v6, v11
    v_dot2_f32_bf16 v8, v155, v7, v8
    v_dot2_f32_bf16 v9, v159, v7, v9
    v_dot2_f32_bf16 v10, v163, v7, v10
    v_dot2_f32_bf16 v11, v167, v7, v11
    v_add_f32_dpp v8, v8, v8 row_ror:8 row_mask:0xf bank_mask:0x3
    s_nop 0
    v_add_f32_dpp v10, v10, v10 row_ror:8 row_mask:0xf bank_mask:0x3
    v_add_f32_dpp v8, v9, v9 row_ror:8 row_mask:0xf bank_mask:0xc
    v_add_f32_dpp v10, v11, v11 row_ror:8 row_mask:0xf bank_mask:0xc
    s_nop 0
    v_add_f32_dpp v19, v8, v8 row_half_mirror row_mask:0xf bank_mask:0x5
    v_add_f32_dpp v19, v10, v10 row_half_mirror row_mask:0xf bank_mask:0xa
    s_nop 1
    v_add_f32_dpp v19, v19, v19 quad_perm:[1,0,3,2] row_mask:0xf bank_mask:0xf
    s_nop 1
    v_add_f32_dpp v19, v19, v19 quad_perm:[2,3,0,1] row_mask:0xf bank_mask:0xf
    v_max3_f32 v3, v12, v13, v14
    v_max3_f32 v8, v15, v16, v17
    v_max3_f32 v3, v3, v18, v19
    v_max_f32 v3, v3, v8
    s_nop 1
    v_max_f32_dpp v3, v3, v3 row_ror:4 row_mask:0xf bank_mask:0xf
    s_nop 1
    v_max_f32_dpp v3, v3, v3 row_ror:8 row_mask:0xf bank_mask:0xf
    v_mov_b32 v8, v3
    s_nop 1
    v_permlane16_swap_b32 v3, v8
    v_max_f32 v3, v3, v8
    v_mov_b32 v8, v3
    s_nop 1
    v_permlane32_swap_b32 v3, v8
    v_max_f32 v3, v3, v8
    s_mov_b32 s96, 0x3e0293ee
    v_mul_f32 v8, s96, v3
    v_fma_f32 v12, v12, s96, -v8
    v_fma_f32 v13, v13, s96, -v8
    v_fma_f32 v14, v14, s96, -v8
    v_fma_f32 v15, v15, s96, -v8
    v_fma_f32 v16, v16, s96, -v8
    v_fma_f32 v17, v17, s96, -v8
    v_fma_f32 v18, v18, s96, -v8
    v_fma_f32 v19, v19, s96, -v8
    v_exp_f32 v12, v12
    v_exp_f32 v13, v13
    v_exp_f32 v14, v14
    v_exp_f32 v15, v15
    v_exp_f32 v16, v16
    v_exp_f32 v17, v17
    v_exp_f32 v18, v18
    v_exp_f32 v19, v19
    v_add_f32 v9, v12, v13
    v_add_f32 v10, v14, v15
    v_add_f32 v11, v16, v17
    v_add_f32 v3, v18, v19
    v_add_f32 v9, v9, v10
    v_add_f32 v3, v3, v11
    v_add_f32 v9, v9, v3
    v_cvt_pk_bf16_f32 v12, v12, v12
    v_cvt_pk_bf16_f32 v13, v13, v13
    v_cvt_pk_bf16_f32 v14, v14, v14
    v_cvt_pk_bf16_f32 v15, v15, v15
    v_cvt_pk_bf16_f32 v16, v16, v16
    v_cvt_pk_bf16_f32 v17, v17, v17
    v_cvt_pk_bf16_f32 v18, v18, v18
    v_cvt_pk_bf16_f32 v19, v19, v19
    v_add_f32_dpp v9, v9, v9 row_ror:4 row_mask:0xf bank_mask:0xf
    s_nop 1
    v_add_f32_dpp v9, v9, v9 row_ror:8 row_mask:0xf bank_mask:0xf
    v_mov_b32 v10, v9
    s_nop 1
    v_permlane16_swap_b32 v9, v10
    v_add_f32 v9, v9, v10
    v_mov_b32 v10, v9
    s_nop 1
    v_permlane32_swap_b32 v9, v10
    v_add_f32 v9, v9, v10
    s_mov_b64 exec, 1
    s_cmp_lg_u32 s13, 0
    s_cbranch_scc1 L_mljob
    s_lshl_b32 s96, s3, 3
    s_add_u32 s96, s96, 161920
    v_mov_b32 v10, s96
    v_mov_b32 v11, 162068
    v_mov_b32 v3, 1
    ds_write_b64 v10, v[8:9]
    ds_add_u32 v11, v3
L_mldone:
    s_mov_b64 exec, -1
    v_lshrrev_b32 v2, 1, v2
    v_and_b32_dpp v24, v14, v20 row_newbcast:0 row_mask:0xf bank_mask:0xf
    v_and_b32_dpp v25, v14, v21 row_newbcast:0 row_mask:0xf bank_mask:0xf
    v_and_b32_dpp v26, v14, v22 row_newbcast:0 row_mask:0xf bank_mask:0xf
    v_and_b32_dpp v27, v14, v23 row_newbcast:0 row_mask:0xf bank_mask:0xf
    s_waitcnt vmcnt(3)
    s_bitcmp0_b32 s14, 12
    s_cbranch_scc1 L_sf_71
    s_waitcnt vmcnt(2)
    s_bitcmp0_b32 s15, 12
    s_cbranch_scc1 L_sf_71
    s_waitcnt vmcnt(1)
L_sf_71:
    buffer_load_dwordx4 v[88:91], v1, s[52:55], s97 offen offset:0 nt
    v_mfma_f32_16x16x32_bf16 v[32:35], v[24:27], v[72:75], v[32:35]
    s_cmp_eq_u32 s12, -1
    s_cbranch_scc1 L_nopfpv8
    s_waitcnt lgkmcnt(0)
    v_and_b32_dpp v24, v12, v20 row_newbcast:0 row_mask:0xf bank_mask:0xf
    v_and_b32_dpp v25, v12, v21 row_newbcast:0 row_mask:0xf bank_mask:0xf
    v_and_b32_dpp v26, v12, v22 row_newbcast:0 row_mask:0xf bank_mask:0xf
    v_and_b32_dpp v27, v12, v23 row_newbcast:0 row_mask:0xf bank_mask:0xf
    s_nop 1
    v_mfma_f32_16x16x32_bf16 v[32:35], v[24:27], v[40:43], v[32:35]
    v_and_b32_dpp v28, v12, v20 row_newbcast:8 row_mask:0xf bank_mask:0xf
    v_and_b32_dpp v29, v12, v21 row_newbcast:8 row_mask:0xf bank_mask:0xf
    v_and_b32_dpp v30, v12, v22 row_newbcast:8 row_mask:0xf bank_mask:0xf
    v_and_b32_dpp v31, v12, v23 row_newbcast:8 row_mask:0xf bank_mask:0xf
    s_nop 1
    v_mfma_f32_16x16x32_bf16 v[32:35], v[28:31], v[44:47], v[32:35]
    v_and_b32_dpp v24, v12, v20 row_newbcast:4 row_mask:0xf bank_mask:0xf
    v_and_b32_dpp v25, v12, v21 row_newbcast:4 row_mask:0xf bank_mask:0xf
    v_and_b32_dpp v26, v12, v22 row_newbcast:4 row_mask:0xf bank_mask:0xf
    v_and_b32_dpp v27, v12, v23 row_newbcast:4 row_mask:0xf bank_mask:0xf
    s_nop 1
    v_mfma_f32_16x16x32_bf16 v[32:35], v[24:27], v[48:51], v[32:35]
    v_and_b32_dpp v28, v12, v20 row_newbcast:12 row_mask:0xf bank_mask:0xf
    v_and_b32_dpp v29, v12, v21 row_newbcast:12 row_mask:0xf bank_mask:0xf
    v_and_b32_dpp v30, v12, v22 row_newbcast:12 row_mask:0xf bank_mask:0xf
    v_and_b32_dpp v31, v12, v23 row_newbcast:12 row_mask:0xf bank_mask:0xf
    s_nop 1
    v_mfma_f32_16x16x32_bf16 v[32:35], v[28:31], v[52:55], v[32:35]
L_nopfpv8:
    v_and_b32_dpp v28, v14, v20 row_newbcast:8 row_mask:0xf bank_mask:0xf
    v_and_b32_dpp v29, v14, v21 row_newbcast:8 row_mask:0xf bank_mask:0xf
    v_and_b32_dpp v30, v14, v22 row_newbcast:8 row_mask:0xf bank_mask:0xf
    v_and_b32_dpp v31, v14, v23 row_newbcast:8 row_mask:0xf bank_mask:0xf
    s_waitcnt vmcnt(3)
    s_bitcmp0_b32 s14, 13
    s_cbranch_scc1 L_sf_72
    s_waitcnt vmcnt(2)
    s_bitcmp0_b32 s15, 13
    s_cbranch_scc1 L_sf_72
    s_waitcnt vmcnt(1)
L_sf_72:
    buffer_load_dwordx4 v[92:95], v1, s[52:55], s97 offen offset:1024 nt
    v_mfma_f32_16x16x32_bf16 v[32:35], v[28:31], v[76:79], v[32:35]
    s_cmp_eq_u32 s12, -1
    s_cbranch_scc1 L_nopfpv9
    s_waitcnt lgkmcnt(0)
    v_and_b32_dpp v24, v13, v20 row_newbcast:0 row_mask:0xf bank_mask:0xf
    v_and_b32_dpp v25, v13, v21 row_newbcast:0 row_mask:0xf bank_mask:0xf
    v_and_b32_dpp v26, v13, v22 row_newbcast:0 row_mask:0xf bank_mask:0xf
    v_and_b32_dpp v27, v13, v23 row_newbcast:0 row_mask:0xf bank_mask:0xf
    s_nop 1
    v_mfma_f32_16x16x32_bf16 v[32:35], v[24:27], v[56:59], v[32:35]
    v_and_b32_dpp v28, v13, v20 row_newbcast:8 row_mask:0xf bank_mask:0xf
    v_and_b32_dpp v29, v13, v21 row_newbcast:8 row_mask:0xf bank_mask:0xf
    v_and_b32_dpp v30, v13, v22 row_newbcast:8 row_mask:0xf bank_mask:0xf
    v_and_b32_dpp v31, v13, v23 row_newbcast:8 row_mask:0xf bank_mask:0xf
    s_nop 1
    v_mfma_f32_16x16x32_bf16 v[32:35], v[28:31], v[60:63], v[32:35]
    v_and_b32_dpp v24, v13, v20 row_newbcast:4 row_mask:0xf bank_mask:0xf
    v_and_b32_dpp v25, v13, v21 row_newbcast:4 row_mask:0xf bank_mask:0xf
    v_and_b32_dpp v26, v13, v22 row_newbcast:4 row_mask:0xf bank_mask:0xf
    v_and_b32_dpp v27, v13, v23 row_newbcast:4 row_mask:0xf bank_mask:0xf
    s_nop 1
    v_mfma_f32_16x16x32_bf16 v[32:35], v[24:27], v[64:67], v[32:35]
    v_and_b32_dpp v28, v13, v20 row_newbcast:12 row_mask:0xf bank_mask:0xf
    v_and_b32_dpp v29, v13, v21 row_newbcast:12 row_mask:0xf bank_mask:0xf
    v_and_b32_dpp v30, v13, v22 row_newbcast:12 row_mask:0xf bank_mask:0xf
    v_and_b32_dpp v31, v13, v23 row_newbcast:12 row_mask:0xf bank_mask:0xf
    s_nop 1
    v_mfma_f32_16x16x32_bf16 v[32:35], v[28:31], v[68:71], v[32:35]
L_nopfpv9:
    v_and_b32_dpp v24, v14, v20 row_newbcast:4 row_mask:0xf bank_mask:0xf
    v_and_b32_dpp v25, v14, v21 row_newbcast:4 row_mask:0xf bank_mask:0xf
    v_and_b32_dpp v26, v14, v22 row_newbcast:4 row_mask:0xf bank_mask:0xf
    v_and_b32_dpp v27, v14, v23 row_newbcast:4 row_mask:0xf bank_mask:0xf
    s_waitcnt vmcnt(3)
    s_bitcmp0_b32 s14, 14
    s_cbranch_scc1 L_sf_73
    s_waitcnt vmcnt(2)
    s_bitcmp0_b32 s15, 14
    s_cbranch_scc1 L_sf_73
    s_waitcnt vmcnt(1)
L_sf_73:
    buffer_load_dwordx4 v[96:99], v1, s[52:55], s97 offen offset:2048 nt
    v_mfma_f32_16x16x32_bf16 v[32:35], v[24:27], v[80:83], v[32:35]
    v_and_b32_dpp v28, v14, v20 row_newbcast:12 row_mask:0xf bank_mask:0xf
    v_and_b32_dpp v29, v14, v21 row_newbcast:12 row_mask:0xf bank_mask:0xf
    v_and_b32_dpp v30, v14, v22 row_newbcast:12 row_mask:0xf bank_mask:0xf
    v_and_b32_dpp v31, v14, v23 row_newbcast:12 row_mask:0xf bank_mask:0xf
    s_waitcnt vmcnt(3)
    s_bitcmp0_b32 s14, 15
    s_cbranch_scc1 L_sf_74
    s_waitcnt vmcnt(2)
    s_bitcmp0_b32 s15, 15
    s_cbranch_scc1 L_sf_74
    s_waitcnt vmcnt(1)
L_sf_74:
    buffer_load_dwordx4 v[100:103], v1, s[52:55], s97 offen offset:3072 nt
    s_add_u32 s97, s97, 32768
    v_add_u32 v1, 4096, v1
    v_and_b32 v1, 0x7fff, v1
    v_mfma_f32_16x16x32_bf16 v[32:35], v[28:31], v[84:87], v[32:35]
    v_and_b32_dpp v24, v15, v20 row_newbcast:0 row_mask:0xf bank_mask:0xf
    v_and_b32_dpp v25, v15, v21 row_newbcast:0 row_mask:0xf bank_mask:0xf
    v_and_b32_dpp v26, v15, v22 row_newbcast:0 row_mask:0xf bank_mask:0xf
    v_and_b32_dpp v27, v15, v23 row_newbcast:0 row_mask:0xf bank_mask:0xf
    s_waitcnt vmcnt(3)
    s_bitcmp0_b32 s14, 16
    s_cbranch_scc1 L_sf_75
    s_waitcnt vmcnt(2)
    s_bitcmp0_b32 s15, 16
    s_cbranch_scc1 L_sf_75
    s_waitcnt vmcnt(1)
L_sf_75:
    buffer_load_dwordx4 v[104:107], v1, s[52:55], s97 offen offset:0 nt
    v_mfma_f32_16x16x32_bf16 v[32:35], v[24:27], v[88:91], v[32:35]
    v_and_b32_dpp v28, v15, v20 row_newbcast:8 row_mask:0xf bank_mask:0xf
    v_and_b32_dpp v29, v15, v21 row_newbcast:8 row_mask:0xf bank_mask:0xf
    v_and_b32_dpp v30, v15, v22 row_newbcast:8 row_mask:0xf bank_mask:0xf
    v_and_b32_dpp v31, v15, v23 row_newbcast:8 row_mask:0xf bank_mask:0xf
    s_waitcnt vmcnt(3)
    s_bitcmp0_b32 s14, 17
    s_cbranch_scc1 L_sf_76
    s_waitcnt vmcnt(2)
    s_bitcmp0_b32 s15, 17
    s_cbranch_scc1 L_sf_76
    s_waitcnt vmcnt(1)
L_sf_76:
    buffer_load_dwordx4 v[108:111], v1, s[52:55], s97 offen offset:1024 nt
    v_mfma_f32_16x16x32_bf16 v[32:35], v[28:31], v[92:95], v[32:35]
    v_and_b32_dpp v24, v15, v20 row_newbcast:4 row_mask:0xf bank_mask:0xf
    v_and_b32_dpp v25, v15, v21 row_newbcast:4 row_mask:0xf bank_mask:0xf
    v_and_b32_dpp v26, v15, v22 row_newbcast:4 row_mask:0xf bank_mask:0xf
    v_and_b32_dpp v27, v15, v23 row_newbcast:4 row_mask:0xf bank_mask:0xf
    s_waitcnt vmcnt(3)
    s_bitcmp0_b32 s14, 18
    s_cbranch_scc1 L_sf_77
    s_waitcnt vmcnt(2)
    s_bitcmp0_b32 s15, 18
    s_cbranch_scc1 L_sf_77
    s_waitcnt vmcnt(1)
L_sf_77:
    buffer_load_dwordx4 v[112:115], v1, s[52:55], s97 offen offset:2048 nt
    v_mfma_f32_16x16x32_bf16 v[32:35], v[24:27], v[96:99], v[32:35]
    v_and_b32_dpp v28, v15, v20 row_newbcast:12 row_mask:0xf bank_mask:0xf
    v_and_b32_dpp v29, v15, v21 row_newbcast:12 row_mask:0xf bank_mask:0xf
    v_and_b32_dpp v30, v15, v22 row_newbcast:12 row_mask:0xf bank_mask:0xf
    v_and_b32_dpp v31, v15, v23 row_newbcast:12 row_mask:0xf bank_mask:0xf
    s_waitcnt vmcnt(3)
    s_bitcmp0_b32 s14, 19
    s_cbranch_scc1 L_sf_78
    s_waitcnt vmcnt(2)
    s_bitcmp0_b32 s15, 19
    s_cbranch_scc1 L_sf_78
    s_waitcnt vmcnt(1)
L_sf_78:
    buffer_load_dwordx4 v[116:119], v1, s[52:55], s97 offen offset:3072 nt
    s_add_u32 s97, s97, 32768
    v_add_u32 v1, 4096, v1
    v_and_b32 v1, 0x7fff, v1
    v_mfma_f32_16x16x32_bf16 v[32:35], v[28:31], v[100:103], v[32:35]
    v_and_b32_dpp v24, v16, v20 row_newbcast:0 row_mask:0xf bank_mask:0xf
    v_and_b32_dpp v25, v16, v21 row_newbcast:0 row_mask:0xf bank_mask:0xf
    v_and_b32_dpp v26, v16, v22 row_newbcast:0 row_mask:0xf bank_mask:0xf
    v_and_b32_dpp v27, v16, v23 row_newbcast:0 row_mask:0xf bank_mask:0xf
    s_waitcnt vmcnt(3)
    s_bitcmp0_b32 s14, 20
    s_cbranch_scc1 L_sf_79
    s_waitcnt vmcnt(2)
    s_bitcmp0_b32 s15, 20
    s_cbranch_scc1 L_sf_79
    s_waitcnt vmcnt(1)
L_sf_79:
    buffer_load_dwordx4 v[120:123], v1, s[52:55], s97 offen offset:0 nt
    v_mfma_f32_16x16x32_bf16 v[32:35], v[24:27], v[104:107], v[32:35]
    v_and_b32_dpp v28, v16, v20 row_newbcast:8 row_mask:0xf bank_mask:0xf
    v_and_b32_dpp v29, v16, v21 row_newbcast:8 row_mask:0xf bank_mask:0xf
    v_and_b32_dpp v30, v16, v22 row_newbcast:8 row_mask:0xf bank_mask:0xf
    v_and_b32_dpp v31, v16, v23 row_newbcast:8 row_mask:0xf bank_mask:0xf
    s_waitcnt vmcnt(3)
    s_bitcmp0_b32 s14, 21
    s_cbranch_scc1 L_sf_80
    s_waitcnt vmcnt(2)
    s_bitcmp0_b32 s15, 21
    s_cbranch_scc1 L_sf_80
    s_waitcnt vmcnt(1)
L_sf_80:
    buffer_load_dwordx4 v[124:127], v1, s[52:55], s97 offen offset:1024 nt
    v_mfma_f32_16x16x32_bf16 v[32:35], v[28:31], v[108:111], v[32:35]
    v_and_b32_dpp v24, v16, v20 row_newbcast:4 row_mask:0xf bank_mask:0xf
    v_and_b32_dpp v25, v16, v21 row_newbcast:4 row_mask:0xf bank_mask:0xf
    v_and_b32_dpp v26, v16, v22 row_newbcast:4 row_mask:0xf bank_mask:0xf
    v_and_b32_dpp v27, v16, v23 row_newbcast:4 row_mask:0xf bank_mask:0xf
    s_waitcnt vmcnt(3)
    s_bitcmp0_b32 s14, 22
    s_cbranch_scc1 L_sf_81
    s_waitcnt vmcnt(2)
    s_bitcmp0_b32 s15, 22
    s_cbranch_scc1 L_sf_81
    s_waitcnt vmcnt(1)
L_sf_81:
    buffer_load_dwordx4 v[128:131], v1, s[52:55], s97 offen offset:2048 nt
    v_mfma_f32_16x16x32_bf16 v[32:35], v[24:27], v[112:115], v[32:35]
    v_and_b32_dpp v28, v16, v20 row_newbcast:12 row_mask:0xf bank_mask:0xf
    v_and_b32_dpp v29, v16, v21 row_newbcast:12 row_mask:0xf bank_mask:0xf
    v_and_b32_dpp v30, v16, v22 row_newbcast:12 row_mask:0xf bank_mask:0xf
    v_and_b32_dpp v31, v16, v23 row_newbcast:12 row_mask:0xf bank_mask:0xf
    s_waitcnt vmcnt(3)
    s_bitcmp0_b32 s14, 23
    s_cbranch_scc1 L_sf_82
    s_waitcnt vmcnt(2)
    s_bitcmp0_b32 s15, 23
    s_cbranch_scc1 L_sf_82
    s_waitcnt vmcnt(1)
L_sf_82:
    buffer_load_dwordx4 v[132:135], v1, s[52:55], s97 offen offset:3072 nt
    s_add_u32 s97, s97, 32768
    v_add_u32 v1, 4096, v1
    v_and_b32 v1, 0x7fff, v1
    v_mfma_f32_16x16x32_bf16 v[32:35], v[28:31], v[116:119], v[32:35]
    v_and_b32_dpp v24, v17, v20 row_newbcast:0 row_mask:0xf bank_mask:0xf
    v_and_b32_dpp v25, v17, v21 row_newbcast:0 row_mask:0xf bank_mask:0xf
    v_and_b32_dpp v26, v17, v22 row_newbcast:0 row_mask:0xf bank_mask:0xf
    v_and_b32_dpp v27, v17, v23 row_newbcast:0 row_mask:0xf bank_mask:0xf
    s_waitcnt vmcnt(3)
    s_bitcmp0_b32 s14, 24
    s_cbranch_scc1 L_sf_83
    s_waitcnt vmcnt(2)
    s_bitcmp0_b32 s15, 24
    s_cbranch_scc1 L_sf_83
    s_waitcnt vmcnt(1)
L_sf_83:
    buffer_load_dwordx4 v[136:139], v1, s[52:55], s97 offen offset:0 nt
    v_mfma_f32_16x16x32_bf16 v[32:35], v[24:27], v[120:123], v[32:35]
    s_or_b32 s96, s59, 0
    s_cbranch_scc0 L_nofrag_84
    v_mov_b32 v104, 162060
L_lw_85:
    ds_read_b32 v105, v104
    s_waitcnt lgkmcnt(0)
    v_cmp_gt_u32 vcc, 4, v105
    s_cbranch_vccz L_lw_85e
    s_sleep 2
    s_sub_u32 s60, s60, 1
    s_cbranch_scc0 L_lw_85
    s_mov_b32 s60, 0
L_lw_85e:
    s_cmp_eq_u32 s59, 0
    s_cbranch_scc1 L_nofrag_84
    v_bfe_u32 v104, v0, 2, 1
    v_bfe_u32 v110, v0, 4, 1
    v_lshl_add_u32 v104, v110, 2, v104
    v_and_b32 v110, 8, v0
    v_add_u32 v104, v104, v110
    v_lshrrev_b32 v110, 5, v0
    v_lshl_add_u32 v104, v110, 4, v104
    v_bfe_u32 v111, v0, 0, 1
    v_mul_u32_u24 v111, 0xaaaa, v111
    v_add_u32 v111, 0x4444, v111
    v_mov_b32 v112, 0
    v_mov_b32 v113, 0
    v_mov_b32 v114, 0
    v_mov_b32 v115, 0
    v_mov_b32 v116, 0
    v_mov_b32 v117, 0
    v_mov_b32 v118, 0
    v_mov_b32 v119, 0
    v_lshlrev_b32 v104, 7, v104
    v_and_b32 v110, 3, v0
    v_lshl_add_u32 v104, v110, 3, v104
    v_lshrrev_b32 v109, 4, v0
    v_and_b32 v110, 1, v0
    s_lshr_b32 s63, s3, 1
    s_and_b32 s62, s3, 1
    s_lshl_b32 s96, s63, 14
    s_lshl_b32 s100, s62, 6
    s_add_u32 s100, s100, 81920
    s_add_u32 s96, s96, s100
    v_add_u32 v104, s96, v104
    ds_read_b64_tr_b16 v[72:73], v104 offset:0
    ds_read_b64_tr_b16 v[74:75], v104 offset:256
    ds_read_b64_tr_b16 v[76:77], v104 offset:4096
    ds_read_b64_tr_b16 v[78:79], v104 offset:4352
    ds_read_b64_tr_b16 v[80:81], v104 offset:32
    ds_read_b64_tr_b16 v[82:83], v104 offset:288
    ds_read_b64_tr_b16 v[84:85], v104 offset:4128
    ds_read_b64_tr_b16 v[86:87], v104 offset:4384
    ds_read_b64_tr_b16 v[88:89], v104 offset:8192
    ds_read_b64_tr_b16 v[90:91], v104 offset:8448
    ds_read_b64_tr_b16 v[92:93], v104 offset:12288
    ds_read_b64_tr_b16 v[94:95], v104 offset:12544
    ds_read_b64_tr_b16 v[96:97], v104 offset:8224
    ds_read_b64_tr_b16 v[98:99], v104 offset:8480
    ds_read_b64_tr_b16 v[100:101], v104 offset:12320
    ds_read_b64_tr_b16 v[102:103], v104 offset:12576
    v_bfe_u32 v105, v0, 1, 3
    v_lshlrev_b32 v105, 8, v105
    v_lshl_add_u32 v105, v109, 5, v105
    v_lshl_add_u32 v105, v110, 4, v105
    v_lshrrev_b32 v106, 3, v0
    v_lshlrev_b32 v106, 7, v106
    v_and_b32 v110, 7, v0
    v_lshl_add_u32 v107, v110, 3, v106
    v_add_u32 v107, s100, v107
    v_lshlrev_b32 v106, 8, v109
    v_and_b32 v110, 15, v0
    v_lshl_add_u32 v106, v110, 2, v106
    v_add_u32 v106, s96, v106
    v_lshlrev_b32 v108, 2, v0
    s_lshl_b32 s96, s62, 2
    s_add_u32 s96, s96, 162088
    v_mov_b32 v109, s96
    s_lshl_b32 s100, s63, 11
    s_lshl_b32 s96, s34, 13
    s_add_u32 s100, s100, s96
    s_add_u32 s100, s100, 106496
    s_mul_i32 s101, s34, 5120
    s_lshl_b32 s96, s35, 9
    s_add_u32 s101, s101, s96
    s_lshl_b32 s96, s62, 8
    s_add_u32 s101, s101, s96
    s_sub_u32 s101, s101, 11264
    s_and_b32 s96, s101, 0xffffe000
    s_add_u32 s101, s101, s96
    s_add_u32 s101, s101, 212992
    v_add_u32 v110, 8192, v108
L_nofrag_84:
    v_and_b32_dpp v28, v17, v20 row_newbcast:8 row_mask:0xf bank_mask:0xf
    v_and_b32_dpp v29, v17, v21 row_newbcast:8 row_mask:0xf bank_mask:0xf
    v_and_b32_dpp v30, v17, v22 row_newbcast:8 row_mask:0xf bank_mask:0xf
    v_and_b32_dpp v31, v17, v23 row_newbcast:8 row_mask:0xf bank_mask:0xf
    s_waitcnt vmcnt(3)
    s_bitcmp0_b32 s14, 25
    s_cbranch_scc1 L_sf_86
    s_waitcnt vmcnt(2)
    s_bitcmp0_b32 s15, 25
    s_cbranch_scc1 L_sf_86
    s_waitcnt vmcnt(1)
L_sf_86:
    buffer_load_dwordx4 v[140:143], v1, s[52:55], s97 offen offset:1024 nt
    v_mfma_f32_16x16x32_bf16 v[32:35], v[28:31], v[124:127], v[32:35]
    v_and_b32_dpp v24, v17, v20 row_newbcast:4 row_mask:0xf bank_mask:0xf
    v_and_b32_dpp v25, v17, v21 row_newbcast:4 row_mask:0xf bank_mask:0xf
    v_and_b32_dpp v26, v17, v22 row_newbcast:4 row_mask:0xf bank_mask:0xf
    v_and_b32_dpp v27, v17, v23 row_newbcast:4 row_mask:0xf bank_mask:0xf
    s_waitcnt vmcnt(3)
    s_bitcmp0_b32 s14, 26
    s_cbranch_scc1 L_sf_87
    s_waitcnt vmcnt(2)
    s_bitcmp0_b32 s15, 26
    s_cbranch_scc1 L_sf_87
    s_waitcnt vmcnt(1)
L_sf_87:
    buffer_load_dwordx4 v[144:147], v1, s[52:55], s97 offen offset:2048 nt
    v_mfma_f32_16x16x32_bf16 v[32:35], v[24:27], v[128:131], v[32:35]
    v_and_b32_dpp v28, v17, v20 row_newbcast:12 row_mask:0xf bank_mask:0xf
    v_and_b32_dpp v29, v17, v21 row_newbcast:12 row_mask:0xf bank_mask:0xf
    v_and_b32_dpp v30, v17, v22 row_newbcast:12 row_mask:0xf bank_mask:0xf
    v_and_b32_dpp v31, v17, v23 row_newbcast:12 row_mask:0xf bank_mask:0xf
    s_waitcnt vmcnt(3)
    s_bitcmp0_b32 s14, 27
    s_cbranch_scc1 L_sf_88
    s_waitcnt vmcnt(2)
    s_bitcmp0_b32 s15, 27
    s_cbranch_scc1 L_sf_88
    s_waitcnt vmcnt(1)
L_sf_88:
    buffer_load_dwordx4 v[148:151], v1, s[52:55], s97 offen offset:3072 nt
    s_add_u32 s97, s97, 32768
    v_add_u32 v1, 4096, v1
    v_and_b32 v1, 0x7fff, v1
    v_mfma_f32_16x16x32_bf16 v[32:35], v[28:31], v[132:135], v[32:35]
    v_and_b32_dpp v24, v18, v20 row_newbcast:0 row_mask:0xf bank_mask:0xf
    v_and_b32_dpp v25, v18, v21 row_newbcast:0 row_mask:0xf bank_mask:0xf
    v_and_b32_dpp v26, v18, v22 row_newbcast:0 row_mask:0xf bank_mask:0xf
    v_and_b32_dpp v27, v18, v23 row_newbcast:0 row_mask:0xf bank_mask:0xf
    s_waitcnt vmcnt(3)
    s_bitcmp0_b32 s14, 28
    s_cbranch_scc1 L_sf_89
    s_waitcnt vmcnt(2)
    s_bitcmp0_b32 s15, 28
    s_cbranch_scc1 L_sf_89
    s_waitcnt vmcnt(1)
L_sf_89:
    buffer_load_dwordx4 v[152:155], v1, s[52:55], s97 offen offset:0 nt
    v_mfma_f32_16x16x32_bf16 v[32:35], v[24:27], v[136:139], v[32:35]
    v_mov_b32 v10, 162076
    v_mov_b32 v11, 1
    s_mov_b64 exec, 1
    ds_add_u32 v10, v11
    s_mov_b64 exec, -1
    v_and_b32_dpp v28, v18, v20 row_newbcast:8 row_mask:0xf bank_mask:0xf
    v_and_b32_dpp v29, v18, v21 row_newbcast:8 row_mask:0xf bank_mask:0xf
    v_and_b32_dpp v30, v18, v22 row_newbcast:8 row_mask:0xf bank_mask:0xf
    v_and_b32_dpp v31, v18, v23 row_newbcast:8 row_mask:0xf bank_mask:0xf
    s_waitcnt vmcnt(3)
    s_bitcmp0_b32 s14, 29
    s_cbranch_scc1 L_sf_90
    s_waitcnt vmcnt(2)
    s_bitcmp0_b32 s15, 29
    s_cbranch_scc1 L_sf_90
    s_waitcnt vmcnt(1)
L_sf_90:
    buffer_load_dwordx4 v[156:159], v1, s[52:55], s97 offen offset:1024 nt
    v_mfma_f32_16x16x32_bf16 v[32:35], v[28:31], v[140:143], v[32:35]
    v_and_b32_dpp v24, v18, v20 row_newbcast:4 row_mask:0xf bank_mask:0xf
    v_and_b32_dpp v25, v18, v21 row_newbcast:4 row_mask:0xf bank_mask:0xf
    v_and_b32_dpp v26, v18, v22 row_newbcast:4 row_mask:0xf bank_mask:0xf
    v_and_b32_dpp v27, v18, v23 row_newbcast:4 row_mask:0xf bank_mask:0xf
    s_waitcnt vmcnt(3)
    s_bitcmp0_b32 s14, 30
    s_cbranch_scc1 L_sf_91
    s_waitcnt vmcnt(2)
    s_bitcmp0_b32 s15, 30
    s_cbranch_scc1 L_sf_91
    s_waitcnt vmcnt(1)
L_sf_91:
    buffer_load_dwordx4 v[160:163], v1, s[52:55], s97 offen offset:2048 nt
    v_mfma_f32_16x16x32_bf16 v[32:35], v[24:27], v[144:147], v[32:35]
    v_lshrrev_b32 v9, 4, v0
    v_lshl_add_u32 v8, v9, 2, v2
    s_lshl_b32 s96, s3, 9
    s_add_u32 s96, s96, 157824
    v_lshl_add_u32 v8, v8, 2, s96
    v_lshlrev_b32 v9, 3, v0
    v_add_u32 v9, 157824, v9
    v_mov_b32 v10, 162048
    v_mov_b32 v11, 1
    s_lshl_b32 s96, s38, 5
    s_add_u32 s96, s96, 161984
    v_mov_b32 v3, s96
    s_sub_u32 s62, 8, s39
    s_lshl_b32 s98, s34, 5
    s_add_u32 s98, s98, s35
    s_lshl_b32 s98, s98, 8
    s_add_u32 s98, s98, 106496
    v_lshlrev_b32 v39, 2, v0
    v_and_b32_dpp v28, v18, v20 row_newbcast:12 row_mask:0xf bank_mask:0xf
    v_and_b32_dpp v29, v18, v21 row_newbcast:12 row_mask:0xf bank_mask:0xf
    v_and_b32_dpp v30, v18, v22 row_newbcast:12 row_mask:0xf bank_mask:0xf
    v_and_b32_dpp v31, v18, v23 row_newbcast:12 row_mask:0xf bank_mask:0xf
    s_waitcnt vmcnt(3)
    s_bitcmp0_b32 s14, 31
    s_cbranch_scc1 L_sf_92
    s_waitcnt vmcnt(2)
    s_bitcmp0_b32 s15, 31
    s_cbranch_scc1 L_sf_92
    s_waitcnt vmcnt(1)
L_sf_92:
    buffer_load_dwordx4 v[164:167], v1, s[52:55], s97 offen offset:3072 nt
    s_mov_b32 s97, 0
    v_add_u32 v1, 4096, v1
    v_and_b32 v1, 0x7fff, v1
    v_mfma_f32_16x16x32_bf16 v[32:35], v[28:31], v[148:151], v[32:35]
    s_cmp_eq_u32 s12, -1
    s_cbranch_scc1 L_v_nopf
    v_and_b32_dpp v24, v19, v20 row_newbcast:0 row_mask:0xf bank_mask:0xf
    v_and_b32_dpp v25, v19, v21 row_newbcast:0 row_mask:0xf bank_mask:0xf
    v_and_b32_dpp v26, v19, v22 row_newbcast:0 row_mask:0xf bank_mask:0xf
    v_and_b32_dpp v27, v19, v23 row_newbcast:0 row_mask:0xf bank_mask:0xf
    s_waitcnt vmcnt(3)
    s_nop 0
    v_mfma_f32_16x16x32_bf16 v[32:35], v[24:27], v[152:155], v[32:35]
    v_and_b32_dpp v28, v19, v20 row_newbcast:8 row_mask:0xf bank_mask:0xf
    v_and_b32_dpp v29, v19, v21 row_newbcast:8 row_mask:0xf bank_mask:0xf
    v_and_b32_dpp v30, v19, v22 row_newbcast:8 row_mask:0xf bank_mask:0xf
    v_and_b32_dpp v31, v19, v23 row_newbcast:8 row_mask:0xf bank_mask:0xf
    s_waitcnt vmcnt(2)
    s_nop 0
    v_mfma_f32_16x16x32_bf16 v[32:35], v[28:31], v[156:159], v[32:35]
    v_and_b32_dpp v24, v19, v20 row_newbcast:4 row_mask:0xf bank_mask:0xf
    v_and_b32_dpp v25, v19, v21 row_newbcast:4 row_mask:0xf bank_mask:0xf
    v_and_b32_dpp v26, v19, v22 row_newbcast:4 row_mask:0xf bank_mask:0xf
    v_and_b32_dpp v27, v19, v23 row_newbcast:4 row_mask:0xf bank_mask:0xf
    s_waitcnt vmcnt(1)
    s_nop 0
    v_mfma_f32_16x16x32_bf16 v[32:35], v[24:27], v[160:163], v[32:35]
    v_and_b32_dpp v28, v19, v20 row_newbcast:12 row_mask:0xf bank_mask:0xf
    v_and_b32_dpp v29, v19, v21 row_newbcast:12 row_mask:0xf bank_mask:0xf
    v_and_b32_dpp v30, v19, v22 row_newbcast:12 row_mask:0xf bank_mask:0xf
    v_and_b32_dpp v31, v19, v23 row_newbcast:12 row_mask:0xf bank_mask:0xf
    s_waitcnt vmcnt(0)
    s_nop 0
    v_mfma_f32_16x16x32_bf16 v[32:35], v[28:31], v[164:167], v[32:35]
L_v_join:
    s_cmp_lg_u32 s13, 0
    s_cbranch_scc1 L_jobend
L_t0:
    s_mov_b32 exec_hi, 0
    s_nop 4
    ds_write_b128 v8, v[32:35]
L_t0b:
    s_mov_b64 exec, 1
    ds_add_rtn_u32 v37, v10, v11
    s_mov_b64 exec, -1
    ds_read_b32 v38, v10 offset:24
    ds_read_b128 v[24:27], v3
    ds_read_b128 v[28:31], v3 offset:16
    ds_read_b64 v[144:145], v9 offset:0
    ds_read_b64 v[146:147], v9 offset:512
    ds_read_b64 v[148:149], v9 offset:1024
    ds_read_b64 v[150:151], v9 offset:1536
    ds_read_b64 v[152:153], v9 offset:2048
    ds_read_b64 v[154:155], v9 offset:2560
    ds_read_b64 v[156:157], v9 offset:3072
    ds_read_b64 v[158:159], v9 offset:3584
    s_waitcnt lgkmcnt(10)
    v_readfirstlane_b32 s96, v37
    v_readfirstlane_b32 s61, v38
    s_cmp_lg_u32 s96, s62
    s_cbranch_scc1 L_nopub
    s_waitcnt lgkmcnt(6)
    v_pk_mul_f32 v[144:145], v[144:145], v[24:25] op_sel:[0,0] op_sel_hi:[1,0]
    v_pk_mul_f32 v[146:147], v[146:147], v[24:25] op_sel:[0,1] op_sel_hi:[1,1]
    s_waitcnt lgkmcnt(4)
    v_pk_fma_f32 v[144:145], v[148:149], v[26:27], v[144:145] op_sel:[0,0,0] op_sel_hi:[1,0,1]
    v_pk_fma_f32 v[146:147], v[150:151], v[26:27], v[146:147] op_sel:[0,1,0] op_sel_hi:[1,1,1]
    s_waitcnt lgkmcnt(2)
    v_pk_fma_f32 v[144:145], v[152:153], v[28:29], v[144:145] op_sel:[0,0,0] op_sel_hi:[1,0,1]
    v_pk_fma_f32 v[146:147], v[154:155], v[28:29], v[146:147] op_sel:[0,1,0] op_sel_hi:[1,1,1]
    s_waitcnt lgkmcnt(0)
    v_pk_fma_f32 v[144:145], v[156:157], v[30:31], v[144:145] op_sel:[0,0,0] op_sel_hi:[1,0,1]
    v_pk_fma_f32 v[146:147], v[158:159], v[30:31], v[146:147] op_sel:[0,1,0] op_sel_hi:[1,1,1]
    s_cmp_eq_u32 s61, 1
    v_pk_add_f32 v[144:145], v[144:145], v[146:147]
    v_cvt_pk_bf16_f32 v32, v144, v145
    s_cbranch_scc0 L_oslow
    buffer_store_dword v32, v39, s[40:43], s98 offen
L_odone:
L_nopub:
    s_cmp_eq_u32 s59, 0
    s_cbranch_scc1 L_not1
L_poll_101:
    buffer_load_dwordx4 v[16:19], v105, s[40:43], s100 offen sc1
    buffer_load_dwordx4 v[20:23], v105, s[40:43], s100 offen offset:128 sc1
    s_sub_u32 s60, s60, 1
    s_cbranch_scc1 L_poll_101t
    s_waitcnt vmcnt(0)
    v_max3_u32 v38, v16, v17, v18
    v_max3_u32 v38, v38, v19, v20
    v_max3_u32 v38, v38, v21, v22
    v_max_u32 v38, v38, v23
    v_cmp_eq_u32 vcc, -1, v38
    s_cbranch_vccnz L_poll_101
L_poll_101e:
    v_smfmac_f32_16x16x64_bf16 v[112:115], v[16:19], v[72:79], v111
    v_smfmac_f32_16x16x64_bf16 v[116:119], v[16:19], v[80:87], v111
    v_smfmac_f32_16x16x64_bf16 v[112:115], v[20:23], v[88:95], v111
    v_smfmac_f32_16x16x64_bf16 v[116:119], v[20:23], v[96:103], v111
    s_nop 6
    v_pk_add_f32 v[112:113], v[112:113], v[114:115]
    v_pk_add_f32 v[116:117], v[116:117], v[118:119]
    v_add_f32 v12, v112, v113
    v_add_f32 v13, v116, v117
    ds_write2_b32 v106, v12, v13 offset0:0 offset1:32
    s_mov_b64 exec, 1
    ds_add_rtn_u32 v37, v109, v11
    s_mov_b64 exec, -1
    ds_read_b64 v[72:73], v107 offset:0
    ds_read_b64 v[74:75], v107 offset:16384
    ds_read_b64 v[76:77], v107 offset:32768
    ds_read_b64 v[78:79], v107 offset:49152
    s_cmp_eq_u32 s34, 2
    s_cselect_b32 s97, s61, 0
    s_waitcnt lgkmcnt(4)
    v_readfirstlane_b32 s96, v37
    s_waitcnt lgkmcnt(2)
    v_pk_add_f32 v[72:73], v[72:73], v[74:75]
    s_cmp_lg_u32 s96, 3
    s_cbranch_scc1 L_not1
    s_cmp_eq_u32 s97, 1
    s_waitcnt lgkmcnt(0)
    v_pk_add_f32 v[76:77], v[76:77], v[78:79]
    v_pk_add_f32 v[72:73], v[72:73], v[76:77]
    v_cvt_pk_bf16_f32 v12, v72, v73
    s_cbranch_scc1 L_pfast
    buffer_store_dword v12, v108, s[40:43], s101 offen sc1
    buffer_store_dword v12, v110, s[40:43], s101 offen sc1
L_pdone:
L_not1:
    s_waitcnt lgkmcnt(0)
    s_cmp_eq_u32 s39, 1
    s_cbranch_scc1 L_s_role
    s_endpgm
L_k_nopf:
    s_waitcnt vmcnt(3)
    s_bitcmp0_b32 s57, 22
    s_cbranch_scc1 L_sf_57
    s_waitcnt vmcnt(2)
    s_bitcmp0_b32 s58, 22
    s_cbranch_scc1 L_sf_57
    s_waitcnt vmcnt(1)
L_sf_57:
    buffer_load_dwordx4 v[128:131], v1, s[48:51], s97 offen offset:2048 nt
    v_min_u32 v39, 15, v0
    v_and_b32 v38, 1, v39
    v_mul_u32_u24 v38, 126, v38
    v_lshl_add_u32 v39, v39, 1, v38
    buffer_load_dword v37, v39, s[44:47], 0 offen sc1
    s_waitcnt vmcnt(4)
    s_bitcmp0_b32 s57, 23
    s_cbranch_scc1 L_sf_58
    s_waitcnt vmcnt(3)
    s_bitcmp0_b32 s58, 23
    s_cbranch_scc1 L_sf_58
    s_waitcnt vmcnt(2)
L_sf_58:
    buffer_load_dwordx4 v[132:135], v1, s[48:51], s97 offen offset:3072 nt
    s_add_u32 s97, s97, 32768
    v_add_u32 v1, 4096, v1
    v_and_b32 v1, 0x7fff, v1
    s_waitcnt vmcnt(4)
    s_bitcmp0_b32 s57, 24
    s_cbranch_scc1 L_sf_59
    s_waitcnt vmcnt(3)
    s_bitcmp0_b32 s58, 24
    s_cbranch_scc1 L_sf_59
    s_waitcnt vmcnt(2)
L_sf_59:
    buffer_load_dwordx4 v[136:139], v1, s[48:51], s97 offen offset:0 nt
    s_waitcnt vmcnt(4)
    s_bitcmp0_b32 s57, 25
    s_cbranch_scc1 L_sf_60
    s_waitcnt vmcnt(3)
    s_bitcmp0_b32 s58, 25
    s_cbranch_scc1 L_sf_60
    s_waitcnt vmcnt(1)
L_sf_60:
    buffer_load_dwordx4 v[140:143], v1, s[48:51], s97 offen offset:1024 nt
    s_waitcnt vmcnt(4)
    s_bitcmp0_b32 s57, 26
    s_cbranch_scc1 L_sf_61
    s_waitcnt vmcnt(2)
    s_bitcmp0_b32 s58, 26
    s_cbranch_scc1 L_sf_61
    s_waitcnt vmcnt(1)
L_sf_61:
    buffer_load_dwordx4 v[144:147], v1, s[48:51], s97 offen offset:2048 nt
    s_waitcnt vmcnt(3)
    s_bitcmp0_b32 s57, 27
    s_cbranch_scc1 L_sf_62
    s_waitcnt vmcnt(2)
    s_bitcmp0_b32 s58, 27
    s_cbranch_scc1 L_sf_62
    s_waitcnt vmcnt(1)
L_sf_62:
    buffer_load_dwordx4 v[148:151], v1, s[48:51], s97 offen offset:3072 nt
    s_add_u32 s97, s97, 32768
    v_add_u32 v1, 4096, v1
    v_and_b32 v1, 0x7fff, v1
    v_cmp_eq_u32 vcc, 0, v37
    s_nop 0
    s_or_b32 s96, vcc_lo, vcc_hi
    buffer_load_dwordx4 v[4:7], v2, s[40:43], s98 offen sc1
    s_waitcnt vmcnt(4)
    s_bitcmp0_b32 s57, 28
    s_cbranch_scc1 L_sf_63
    s_waitcnt vmcnt(3)
    s_bitcmp0_b32 s58, 28
    s_cbranch_scc1 L_sf_63
    s_waitcnt vmcnt(2)
L_sf_63:
    buffer_load_dwordx4 v[152:155], v1, s[48:51], s97 offen offset:0 nt
    s_waitcnt vmcnt(4)
    s_bitcmp0_b32 s57, 29
    s_cbranch_scc1 L_sf_64
    s_waitcnt vmcnt(3)
    s_bitcmp0_b32 s58, 29
    s_cbranch_scc1 L_sf_64
    s_waitcnt vmcnt(2)
L_sf_64:
    buffer_load_dwordx4 v[156:159], v1, s[48:51], s97 offen offset:1024 nt
    s_waitcnt vmcnt(4)
    s_bitcmp0_b32 s57, 30
    s_cbranch_scc1 L_sf_65
    s_waitcnt vmcnt(3)
    s_bitcmp0_b32 s58, 30
    s_cbranch_scc1 L_sf_65
    s_waitcnt vmcnt(1)
L_sf_65:
    buffer_load_dwordx4 v[160:163], v1, s[48:51], s97 offen offset:2048 nt
    s_waitcnt vmcnt(4)
    s_bitcmp0_b32 s57, 31
    s_cbranch_scc1 L_sf_66
    s_waitcnt vmcnt(2)
    s_bitcmp0_b32 s58, 31
    s_cbranch_scc1 L_sf_66
    s_waitcnt vmcnt(1)
L_sf_66:
    buffer_load_dwordx4 v[164:167], v1, s[48:51], s97 offen offset:3072 nt
    s_mov_b32 s97, 0
    v_add_u32 v1, 4096, v1
    v_and_b32 v1, 0x7fff, v1
    v_add_u32 v1, 8192, v1
    v_and_b32 v1, 0x7fff, v1
    s_mov_b32 s97, 65536
    s_branch L_k_join
L_v_nopf:
    v_and_b32_dpp v24, v19, v20 row_newbcast:0 row_mask:0xf bank_mask:0xf
    v_and_b32_dpp v25, v19, v21 row_newbcast:0 row_mask:0xf bank_mask:0xf
    v_and_b32_dpp v26, v19, v22 row_newbcast:0 row_mask:0xf bank_mask:0xf
    v_and_b32_dpp v27, v19, v23 row_newbcast:0 row_mask:0xf bank_mask:0xf
    s_waitcnt vmcnt(3)
    s_bitcmp0_b32 s14, 0
    s_cbranch_scc1 L_sf_93
    s_waitcnt vmcnt(2)
    s_bitcmp0_b32 s15, 0
    s_cbranch_scc1 L_sf_93
    s_waitcnt vmcnt(1)
L_sf_93:
    buffer_load_dwordx4 v[40:43], v1, s[52:55], s97 offen offset:0 nt
    v_mfma_f32_16x16x32_bf16 v[32:35], v[24:27], v[152:155], v[32:35]
    v_and_b32_dpp v28, v19, v20 row_newbcast:8 row_mask:0xf bank_mask:0xf
    v_and_b32_dpp v29, v19, v21 row_newbcast:8 row_mask:0xf bank_mask:0xf
    v_and_b32_dpp v30, v19, v22 row_newbcast:8 row_mask:0xf bank_mask:0xf
    v_and_b32_dpp v31, v19, v23 row_newbcast:8 row_mask:0xf bank_mask:0xf
    s_waitcnt vmcnt(3)
    s_bitcmp0_b32 s14, 1
    s_cbranch_scc1 L_sf_94
    s_waitcnt vmcnt(2)
    s_bitcmp0_b32 s15, 1
    s_cbranch_scc1 L_sf_94
    s_waitcnt vmcnt(1)
L_sf_94:
    buffer_load_dwordx4 v[44:47], v1, s[52:55], s97 offen offset:1024 nt
    v_mfma_f32_16x16x32_bf16 v[32:35], v[28:31], v[156:159], v[32:35]
    v_and_b32_dpp v24, v19, v20 row_newbcast:4 row_mask:0xf bank_mask:0xf
    v_and_b32_dpp v25, v19, v21 row_newbcast:4 row_mask:0xf bank_mask:0xf
    v_and_b32_dpp v26, v19, v22 row_newbcast:4 row_mask:0xf bank_mask:0xf
    v_and_b32_dpp v27, v19, v23 row_newbcast:4 row_mask:0xf bank_mask:0xf
    s_waitcnt vmcnt(3)
    s_bitcmp0_b32 s14, 2
    s_cbranch_scc1 L_sf_95
    s_waitcnt vmcnt(2)
    s_bitcmp0_b32 s15, 2
    s_cbranch_scc1 L_sf_95
    s_waitcnt vmcnt(1)
L_sf_95:
    buffer_load_dwordx4 v[48:51], v1, s[52:55], s97 offen offset:2048 nt
    v_mfma_f32_16x16x32_bf16 v[32:35], v[24:27], v[160:163], v[32:35]
    v_and_b32_dpp v28, v19, v20 row_newbcast:12 row_mask:0xf bank_mask:0xf
    v_and_b32_dpp v29, v19, v21 row_newbcast:12 row_mask:0xf bank_mask:0xf
    v_and_b32_dpp v30, v19, v22 row_newbcast:12 row_mask:0xf bank_mask:0xf
    v_and_b32_dpp v31, v19, v23 row_newbcast:12 row_mask:0xf bank_mask:0xf
    s_waitcnt vmcnt(3)
    s_bitcmp0_b32 s14, 3
    s_cbranch_scc1 L_sf_96
    s_waitcnt vmcnt(2)
    s_bitcmp0_b32 s15, 3
    s_cbranch_scc1 L_sf_96
    s_waitcnt vmcnt(1)
L_sf_96:
    buffer_load_dwordx4 v[52:55], v1, s[52:55], s97 offen offset:3072 nt
    s_add_u32 s97, s97, 32768
    v_add_u32 v1, 4096, v1
    v_and_b32 v1, 0x7fff, v1
    v_mfma_f32_16x16x32_bf16 v[32:35], v[28:31], v[164:167], v[32:35]
    v_and_b32_dpp v24, v12, v20 row_newbcast:0 row_mask:0xf bank_mask:0xf
    v_and_b32_dpp v25, v12, v21 row_newbcast:0 row_mask:0xf bank_mask:0xf
    v_and_b32_dpp v26, v12, v22 row_newbcast:0 row_mask:0xf bank_mask:0xf
    v_and_b32_dpp v27, v12, v23 row_newbcast:0 row_mask:0xf bank_mask:0xf
    s_waitcnt vmcnt(3)
    s_bitcmp0_b32 s14, 4
    s_cbranch_scc1 L_sf_97
    s_waitcnt vmcnt(2)
    s_bitcmp0_b32 s15, 4
    s_cbranch_scc1 L_sf_97
    s_waitcnt vmcnt(1)
L_sf_97:
    buffer_load_dwordx4 v[56:59], v1, s[52:55], s97 offen offset:0 nt
    v_mfma_f32_16x16x32_bf16 v[32:35], v[24:27], v[40:43], v[32:35]
    v_and_b32_dpp v28, v12, v20 row_newbcast:8 row_mask:0xf bank_mask:0xf
    v_and_b32_dpp v29, v12, v21 row_newbcast:8 row_mask:0xf bank_mask:0xf
    v_and_b32_dpp v30, v12, v22 row_newbcast:8 row_mask:0xf bank_mask:0xf
    v_and_b32_dpp v31, v12, v23 row_newbcast:8 row_mask:0xf bank_mask:0xf
    s_waitcnt vmcnt(3)
    s_bitcmp0_b32 s14, 5
    s_cbranch_scc1 L_sf_98
    s_waitcnt vmcnt(2)
    s_bitcmp0_b32 s15, 5
    s_cbranch_scc1 L_sf_98
    s_waitcnt vmcnt(1)
L_sf_98:
    buffer_load_dwordx4 v[60:63], v1, s[52:55], s97 offen offset:1024 nt
    v_mfma_f32_16x16x32_bf16 v[32:35], v[28:31], v[44:47], v[32:35]
    v_and_b32_dpp v24, v12, v20 row_newbcast:4 row_mask:0xf bank_mask:0xf
    v_and_b32_dpp v25, v12, v21 row_newbcast:4 row_mask:0xf bank_mask:0xf
    v_and_b32_dpp v26, v12, v22 row_newbcast:4 row_mask:0xf bank_mask:0xf
    v_and_b32_dpp v27, v12, v23 row_newbcast:4 row_mask:0xf bank_mask:0xf
    s_waitcnt vmcnt(3)
    s_bitcmp0_b32 s14, 6
    s_cbranch_scc1 L_sf_99
    s_waitcnt vmcnt(2)
    s_bitcmp0_b32 s15, 6
    s_cbranch_scc1 L_sf_99
    s_waitcnt vmcnt(1)
L_sf_99:
    buffer_load_dwordx4 v[64:67], v1, s[52:55], s97 offen offset:2048 nt
    v_mfma_f32_16x16x32_bf16 v[32:35], v[24:27], v[48:51], v[32:35]
    v_and_b32_dpp v28, v12, v20 row_newbcast:12 row_mask:0xf bank_mask:0xf
    v_and_b32_dpp v29, v12, v21 row_newbcast:12 row_mask:0xf bank_mask:0xf
    v_and_b32_dpp v30, v12, v22 row_newbcast:12 row_mask:0xf bank_mask:0xf
    v_and_b32_dpp v31, v12, v23 row_newbcast:12 row_mask:0xf bank_mask:0xf
    s_waitcnt vmcnt(3)
    s_bitcmp0_b32 s14, 7
    s_cbranch_scc1 L_sf_100
    s_waitcnt vmcnt(2)
    s_bitcmp0_b32 s15, 7
    s_cbranch_scc1 L_sf_100
    s_waitcnt vmcnt(1)
L_sf_100:
    buffer_load_dwordx4 v[68:71], v1, s[52:55], s97 offen offset:3072 nt
    s_add_u32 s97, s97, 32768
    v_add_u32 v1, 4096, v1
    v_and_b32 v1, 0x7fff, v1
    v_mfma_f32_16x16x32_bf16 v[32:35], v[28:31], v[52:55], v[32:35]
    v_and_b32_dpp v24, v13, v20 row_newbcast:0 row_mask:0xf bank_mask:0xf
    v_and_b32_dpp v25, v13, v21 row_newbcast:0 row_mask:0xf bank_mask:0xf
    v_and_b32_dpp v26, v13, v22 row_newbcast:0 row_mask:0xf bank_mask:0xf
    v_and_b32_dpp v27, v13, v23 row_newbcast:0 row_mask:0xf bank_mask:0xf
    s_waitcnt vmcnt(3)
    s_nop 0
    v_mfma_f32_16x16x32_bf16 v[32:35], v[24:27], v[56:59], v[32:35]
    v_and_b32_dpp v28, v13, v20 row_newbcast:8 row_mask:0xf bank_mask:0xf
    v_and_b32_dpp v29, v13, v21 row_newbcast:8 row_mask:0xf bank_mask:0xf
    v_and_b32_dpp v30, v13, v22 row_newbcast:8 row_mask:0xf bank_mask:0xf
    v_and_b32_dpp v31, v13, v23 row_newbcast:8 row_mask:0xf bank_mask:0xf
    s_waitcnt vmcnt(2)
    s_nop 0
    v_mfma_f32_16x16x32_bf16 v[32:35], v[28:31], v[60:63], v[32:35]
    v_and_b32_dpp v24, v13, v20 row_newbcast:4 row_mask:0xf bank_mask:0xf
    v_and_b32_dpp v25, v13, v21 row_newbcast:4 row_mask:0xf bank_mask:0xf
    v_and_b32_dpp v26, v13, v22 row_newbcast:4 row_mask:0xf bank_mask:0xf
    v_and_b32_dpp v27, v13, v23 row_newbcast:4 row_mask:0xf bank_mask:0xf
    s_waitcnt vmcnt(1)
    s_nop 0
    v_mfma_f32_16x16x32_bf16 v[32:35], v[24:27], v[64:67], v[32:35]
    v_and_b32_dpp v28, v13, v20 row_newbcast:12 row_mask:0xf bank_mask:0xf
    v_and_b32_dpp v29, v13, v21 row_newbcast:12 row_mask:0xf bank_mask:0xf
    v_and_b32_dpp v30, v13, v22 row_newbcast:12 row_mask:0xf bank_mask:0xf
    v_and_b32_dpp v31, v13, v23 row_newbcast:12 row_mask:0xf bank_mask:0xf
    s_waitcnt vmcnt(0)
    s_nop 0
    v_mfma_f32_16x16x32_bf16 v[32:35], v[28:31], v[68:71], v[32:35]
    s_branch L_v_join
L_oslow:
    buffer_store_dword v32, v39, s[40:43], s98 offen sc1
    s_branch L_odone
L_qslow:
L_wy_102:
    buffer_load_dword v37, v39, s[44:47], 0 offen sc1
    s_waitcnt vmcnt(0)
    v_cmp_ne_u32 vcc, -1, v37
    s_cbranch_vccz L_wy_102e
    s_sleep 4
    s_sub_u32 s60, s60, 1
    s_cbranch_scc0 L_wy_102
    s_mov_b32 s60, 0
L_wy_102e:
L_qslow2:
    s_branch L_poll_103
L_poll_103s:
    s_sleep 2
L_poll_103:
    buffer_load_dwordx4 v[4:7], v2, s[40:43], s98 offen sc1
    s_sub_u32 s60, s60, 1
    s_cbranch_scc1 L_poll_103t
    s_waitcnt vmcnt(0)
    v_max3_u32 v38, v4, v5, v6
    v_max_u32 v38, v38, v7
    v_cmp_eq_u32 vcc, -1, v38
    s_cbranch_vccnz L_poll_103s
L_poll_103e:
    s_branch L_qok
L_mljob:
    s_lshl4_add_u32 s96, s35, s3
    s_lshl_b32 s96, s96, 3
    s_add_u32 s96, s96, 81920
    buffer_store_dwordx2 v[8:9], v36, s[40:43], s96 offen sc1
    s_branch L_mldone
L_service:
    v_mov_b32 v72, 0
    v_mov_b32 v73, 0
    v_mov_b32 v74, 0
    v_mov_b32 v75, 0
    v_mov_b32 v76, 0
    s_mov_b32 s59, 0
    v_mov_b32 v5, 0
    v_mov_b32 v105, 0
    v_mov_b32 v108, 0
    v_mov_b32 v110, 0
    v_mov_b32 v160, 0
    v_mov_b32 v163, 0
    v_mov_b32 v8, 162068
L_lw_104:
    ds_read_b32 v9, v8
    s_waitcnt lgkmcnt(0)
    v_cmp_gt_u32 vcc, 8, v9
    s_cbranch_vccz L_lw_104e
    s_sleep 8
    s_sub_u32 s60, s60, 1
    s_cbranch_scc0 L_lw_104
    s_mov_b32 s60, 0
L_lw_104e:
    v_and_b32 v2, 15, v0
    v_lshlrev_b32 v2, 3, v2
    v_add_u32 v3, 161920, v2
    ds_read_b64 v[8:9], v3
    v_mov_b32 v11, 162096
    ds_read_b32 v11, v11
    s_getreg_b32 s58, hwreg(HW_REG_XCC_ID, 0, 4)
    s_lshl_b32 s98, s34, 5
    s_add_u32 s98, s98, s35
    s_lshl_b32 s62, s98, 7
    s_add_u32 s62, s62, 73728
    s_and_b32 s99, s62, 0xffffff00
    s_lshl_b32 s98, s98, 8
    s_add_u32 s98, s98, 106496
    v_lshlrev_b32 v39, 2, v0
    v_and_b32 v21, 64, v2
    v_add_u32 v21, v21, v2
    v_cmp_eq_u32 vcc, 8, v0
    s_bfm_b64 exec, 8, 0
    s_bitset1_b32 exec_lo, 8
    s_waitcnt lgkmcnt(0)
    v_lshl_add_u32 v10, v11, 8, s58
    v_cndmask_b32 v8, v8, v10, vcc
    buffer_store_dwordx2 v[8:9], v2, s[40:43], s62 offen sc1
    s_mov_b64 exec, -1
    v_mov_b32 v12, 162076
L_lw_105:
    ds_read_b32 v13, v12
    s_waitcnt lgkmcnt(0)
    v_cmp_gt_u32 vcc, 4, v13
    s_cbranch_vccz L_lw_105e
    s_sleep 4
    s_sub_u32 s60, s60, 1
    s_cbranch_scc0 L_lw_105
    s_mov_b32 s60, 0
L_lw_105e:
    v_and_b32 v11, 31, v0
    v_lshlrev_b32 v11, 7, v11
    s_lshl_b32 s63, s34, 12
    s_add_u32 s63, s63, 73792
    buffer_load_dword v12, v39, s[40:43], s98 offen sc1
    s_branch L_poll_106
L_poll_106s:
    s_sleep 16
L_poll_106:
    buffer_load_dwordx2 v[8:9], v21, s[40:43], s99 offen sc1
    buffer_load_dword v10, v11, s[40:43], s63 offen sc1
    s_sub_u32 s60, s60, 1
    s_cbranch_scc1 L_poll_106t
    s_waitcnt vmcnt(0)
    v_max3_u32 v38, v8, v9, v10
    v_cmp_eq_u32 vcc, -1, v38
    s_cbranch_vccnz L_poll_106s
L_poll_106e:
    v_mov_b32 v37, v8
    s_nop 1
    v_max_f32_dpp v37, v37, v37 quad_perm:[1,0,3,2] row_mask:0xf bank_mask:0xf
    s_nop 1
    v_max_f32_dpp v37, v37, v37 quad_perm:[2,3,0,1] row_mask:0xf bank_mask:0xf
    s_nop 1
    v_max_f32_dpp v37, v37, v37 row_ror:4 row_mask:0xf bank_mask:0xf
    s_nop 1
    v_max_f32_dpp v37, v37, v37 row_ror:8 row_mask:0xf bank_mask:0xf
    v_sub_f32 v8, v8, v37
    v_exp_f32 v8, v8
    s_nop 0
    v_mul_f32 v9, v8, v9
    s_nop 1
    v_add_f32_dpp v9, v9, v9 quad_perm:[1,0,3,2] row_mask:0xf bank_mask:0xf
    s_nop 1
    v_add_f32_dpp v9, v9, v9 quad_perm:[2,3,0,1] row_mask:0xf bank_mask:0xf
    s_nop 1
    v_add_f32_dpp v9, v9, v9 row_ror:4 row_mask:0xf bank_mask:0xf
    s_nop 1
    v_add_f32_dpp v9, v9, v9 row_ror:8 row_mask:0xf bank_mask:0xf
    v_and_b32 v10, 0xff, v10
    s_getreg_b32 s62, hwreg(HW_REG_XCC_ID, 0, 4)
    v_cmp_ne_u32 vcc, s62, v10
    s_nop 0
    s_cmp_eq_u64 vcc, 0
    s_cselect_b32 s61, 1, 0
    v_rcp_f32 v9, v9
    v_lshrrev_b32 v3, 1, v2
    v_add_u32 v3, 161984, v3
    v_mul_f32 v8, v8, v9
    v_mov_b32 v10, 162072
    v_mov_b32 v11, s61
    ds_write_b32 v3, v8
    ds_write_b32 v10, v11
    s_mov_b32 s3, 1
    v_lshrrev_b32 v9, 4, v0
    v_lshl_add_u32 v8, v9, 2, v2
    s_lshl_b32 s96, s3, 9
    s_add_u32 s96, s96, 157824
    v_lshl_add_u32 v8, v8, 2, s96
    v_lshlrev_b32 v9, 3, v0
    v_add_u32 v9, 157824, v9
    v_mov_b32 v10, 162048
    v_mov_b32 v11, 1
    s_lshl_b32 s96, s38, 5
    s_add_u32 s96, s96, 161984
    v_mov_b32 v3, s96
    s_sub_u32 s62, 8, s39
    s_lshl_b32 s98, s34, 5
    s_add_u32 s98, s98, s35
    s_lshl_b32 s98, s98, 8
    s_add_u32 s98, s98, 106496
    v_lshlrev_b32 v39, 2, v0
    s_branch L_t0b
L_jobend:
    v_lshlrev_b32 v9, 4, v0
    s_mov_b32 exec_hi, 0
    s_nop 3
    buffer_store_dwordx4 v[32:35], v9, s[40:43], s13 offen sc1
    s_endpgm
L_proxy:
    v_mov_b32 v72, 0
    v_mov_b32 v73, 0
    v_mov_b32 v74, 0
    v_mov_b32 v75, 0
    v_mov_b32 v76, 0
    v_mov_b32 v5, 0
    v_mov_b32 v105, 0
    v_mov_b32 v108, 0
    v_mov_b32 v110, 0
    v_mov_b32 v160, 0
    v_mov_b32 v163, 0
    s_barrier
    s_waitcnt lgkmcnt(0)
    s_mov_b32 s40, s32
    s_mov_b32 s41, s33
    s_mov_b32 s42, 589824
    s_mov_b32 s43, 0x20000
    s_mov_b32 s44, s30
    s_mov_b32 s45, s31
    s_mov_b32 s46, 256
    s_mov_b32 s47, 0x20000
    s_sub_u32 s97, 7, s3
    s_mul_i32 s97, s97, 27
    s_cmp_eq_u32 s3, 5
    s_cselect_b32 s97, 32, s97
    s_add_u32 s97, s97, s35
    s_lshl_b32 s97, s97, 9
    s_add_u32 s97, s97, 172032
    v_and_b32 v2, 15, v0
    v_lshlrev_b32 v2, 3, v2
    v_and_b32 v20, 31, v0
    v_lshlrev_b32 v20, 4, v20
    s_cmp_lg_u32 s3, 7
    s_cbranch_scc1 L_px6
    s_sub_u32 s96, 6, s59
    s_mul_i32 s62, s35, 5120
    s_add_u32 s62, s62, 327680
    v_lshl_add_u32 v22, v0, 4, s62
    v_add_u32 v23, 4096, v22
    v_mov_b32 v24, -1
    v_mov_b32 v25, -1
    v_mov_b32 v26, -1
    v_mov_b32 v27, -1
    v_mov_b32 v8, 162068
L_lw_107:
    ds_read_b32 v9, v8
    s_waitcnt lgkmcnt(0)
    v_cmp_gt_u32 vcc, s96, v9
    s_cbranch_vccz L_lw_107e
    s_sleep 8
    s_sub_u32 s60, s60, 1
    s_cbranch_scc0 L_lw_107
    s_mov_b32 s60, 0
L_lw_107e:
    v_and_b32 v2, 15, v0
    v_lshlrev_b32 v2, 3, v2
    v_add_u32 v3, 161920, v2
    ds_read_b64 v[8:9], v3
    v_mov_b32 v11, 162096
    ds_read_b32 v11, v11
    s_getreg_b32 s58, hwreg(HW_REG_XCC_ID, 0, 4)
    s_lshl_b32 s98, s34, 5
    s_add_u32 s98, s98, s35
    s_lshl_b32 s62, s98, 7
    s_add_u32 s62, s62, 73728
    s_and_b32 s99, s62, 0xffffff00
    s_lshl_b32 s98, s98, 8
    s_add_u32 s98, s98, 106496
    v_lshlrev_b32 v39, 2, v0
    v_and_b32 v21, 64, v2
    v_add_u32 v21, v21, v2
    v_cmp_eq_u32 vcc, 8, v0
    s_bfm_b64 exec, s96, 0
    s_bitset1_b32 exec_lo, 8
    s_waitcnt lgkmcnt(0)
    v_lshl_add_u32 v10, v11, 8, s58
    v_cndmask_b32 v8, v8, v10, vcc
    buffer_store_dwordx2 v[8:9], v2, s[40:43], s62 offen sc1
    s_mov_b64 exec, -1
    buffer_load_dwordx4 v[120:123], v22, s[40:43], 0 offen offset:0 sc1
    buffer_load_dwordx4 v[124:127], v22, s[40:43], 0 offen offset:1024 sc1
    buffer_load_dwordx4 v[128:131], v22, s[40:43], 0 offen offset:2048 sc1
    buffer_load_dwordx4 v[132:135], v22, s[40:43], 0 offen offset:3072 sc1
    buffer_load_dwordx4 v[136:139], v23, s[40:43], 0 offen offset:0 sc1
    s_mov_b32 s100, 4
    s_lshl_b32 s63, s100, 8
    v_and_b32 v8, 15, v0
    v_lshl_add_u32 v8, v8, 4, s63
    v_lshrrev_b32 v9, 4, v0
    v_mul_u32_u24 v5, 1280, v9
    v_add_u32 v5, v5, v8
    v_mul_u32_u24 v4, 1296, v9
    v_add_u32 v4, v4, v8
    v_add_u32 v4, 82944, v4
    v_lshlrev_b32 v6, 1, v5
    v_add_u32 v6, 99328, v6
    s_lshl_b32 s62, s100, 9
    s_add_u32 s62, s62, 88128
    v_lshl_add_u32 v7, v0, 3, s62
    s_mov_b32 s48, s4
    s_mov_b32 s49, s5
    s_mov_b32 s50, 5120
    s_mov_b32 s51, 0x20000
    buffer_load_dwordx4 v[8:11], v5, s[48:51], 0 offen
    s_mov_b32 s62, 20480
    s_mov_b32 s63, 30720
    s_branch L_poll_108
L_poll_108s:
    s_sleep 32
L_poll_108:
    buffer_load_dwordx4 v[12:15], v5, s[40:43], s62 offen sc1
    buffer_load_dwordx4 v[16:19], v5, s[40:43], s63 offen sc1
    s_sub_u32 s60, s60, 1
    s_cbranch_scc1 L_poll_108t
    s_waitcnt vmcnt(0)
    v_max3_u32 v38, v12, v13, v14
    v_max3_u32 v38, v38, v15, v16
    v_max3_u32 v38, v38, v17, v18
    v_max_u32 v38, v38, v19
    v_cmp_eq_u32 vcc, -1, v38
    s_cbranch_vccnz L_poll_108s
L_poll_108e:
    v_lshlrev_b32 v40, 16, v8
    v_and_b32 v41, 0xffff0000, v8
    v_lshlrev_b32 v42, 16, v9
    v_and_b32 v43, 0xffff0000, v9
    v_lshlrev_b32 v44, 16, v10
    v_and_b32 v45, 0xffff0000, v10
    v_lshlrev_b32 v46, 16, v11
    v_and_b32 v47, 0xffff0000, v11
    v_lshlrev_b32 v48, 16, v12
    v_and_b32 v49, 0xffff0000, v12
    v_lshlrev_b32 v50, 16, v13
    v_and_b32 v51, 0xffff0000, v13
    v_lshlrev_b32 v52, 16, v14
    v_and_b32 v53, 0xffff0000, v14
    v_lshlrev_b32 v54, 16, v15
    v_and_b32 v55, 0xffff0000, v15
    v_lshlrev_b32 v56, 16, v16
    v_and_b32 v57, 0xffff0000, v16
    v_lshlrev_b32 v58, 16, v17
    v_and_b32 v59, 0xffff0000, v17
    v_lshlrev_b32 v60, 16, v18
    v_and_b32 v61, 0xffff0000, v18
    v_lshlrev_b32 v62, 16, v19
    v_and_b32 v63, 0xffff0000, v19
    v_mov_b32 v64, 0
    v_mov_b32 v65, 0
    v_mov_b32 v66, 0
    v_mov_b32 v67, 0
    v_mov_b32 v68, 0
    v_mov_b32 v69, 0
    v_mov_b32 v70, 0
    v_mov_b32 v71, 0
    v_bfe_u32 v5, v0, 2, 2
    v_lshlrev_b32 v5, 8, v5
    v_lshrrev_b32 v8, 4, v0
    v_lshl_add_u32 v5, v8, 6, v5
    v_and_b32 v8, 3, v0
    v_lshl_add_u32 v5, v8, 4, v5
    s_lshl_b32 s56, s100, 10
    s_or_b32 s96, s59, 0
    s_cbranch_scc0 L_nofrag_109
    v_mov_b32 v104, 162060
L_lw_110:
    ds_read_b32 v105, v104
    s_waitcnt lgkmcnt(0)
    v_cmp_gt_u32 vcc, 4, v105
    s_cbranch_vccz L_lw_110e
    s_sleep 2
    s_sub_u32 s60, s60, 1
    s_cbranch_scc0 L_lw_110
    s_mov_b32 s60, 0
L_lw_110e:
    s_cmp_eq_u32 s59, 0
    s_cbranch_scc1 L_nofrag_109
    v_bfe_u32 v104, v0, 2, 1
    v_bfe_u32 v110, v0, 4, 1
    v_lshl_add_u32 v104, v110, 2, v104
    v_and_b32 v110, 8, v0
    v_add_u32 v104, v104, v110
    v_lshrrev_b32 v110, 5, v0
    v_lshl_add_u32 v104, v110, 4, v104
    v_bfe_u32 v111, v0, 0, 1
    v_mul_u32_u24 v111, 0xaaaa, v111
    v_add_u32 v111, 0x4444, v111
    v_mov_b32 v112, 0
    v_mov_b32 v113, 0
    v_mov_b32 v114, 0
    v_mov_b32 v115, 0
    v_mov_b32 v116, 0
    v_mov_b32 v117, 0
    v_mov_b32 v118, 0
    v_mov_b32 v119, 0
    v_lshlrev_b32 v104, 7, v104
    v_and_b32 v110, 3, v0
    v_lshl_add_u32 v104, v110, 3, v104
    v_lshrrev_b32 v109, 4, v0
    v_and_b32 v110, 1, v0
    s_lshr_b32 s63, s3, 1
    s_and_b32 s62, s3, 1
    s_lshl_b32 s96, s63, 14
    s_lshl_b32 s100, s62, 6
    s_add_u32 s100, s100, 81920
    s_add_u32 s96, s96, s100
    v_add_u32 v104, s96, v104
    ds_read_b64_tr_b16 v[72:73], v104 offset:0
    ds_read_b64_tr_b16 v[74:75], v104 offset:256
    ds_read_b64_tr_b16 v[76:77], v104 offset:4096
    ds_read_b64_tr_b16 v[78:79], v104 offset:4352
    ds_read_b64_tr_b16 v[80:81], v104 offset:32
    ds_read_b64_tr_b16 v[82:83], v104 offset:288
    ds_read_b64_tr_b16 v[84:85], v104 offset:4128
    ds_read_b64_tr_b16 v[86:87], v104 offset:4384
    ds_read_b64_tr_b16 v[88:89], v104 offset:8192
    ds_read_b64_tr_b16 v[90:91], v104 offset:8448
    ds_read_b64_tr_b16 v[92:93], v104 offset:12288
    ds_read_b64_tr_b16 v[94:95], v104 offset:12544
    ds_read_b64_tr_b16 v[96:97], v104 offset:8224
    ds_read_b64_tr_b16 v[98:99], v104 offset:8480
    ds_read_b64_tr_b16 v[100:101], v104 offset:12320
    ds_read_b64_tr_b16 v[102:103], v104 offset:12576
    v_bfe_u32 v105, v0, 1, 3
    v_lshlrev_b32 v105, 8, v105
    v_lshl_add_u32 v105, v109, 5, v105
    v_lshl_add_u32 v105, v110, 4, v105
    v_lshrrev_b32 v106, 3, v0
    v_lshlrev_b32 v106, 7, v106
    v_and_b32 v110, 7, v0
    v_lshl_add_u32 v107, v110, 3, v106
    v_add_u32 v107, s100, v107
    v_lshlrev_b32 v106, 8, v109
    v_and_b32 v110, 15, v0
    v_lshl_add_u32 v106, v110, 2, v106
    v_add_u32 v106, s96, v106
    v_lshlrev_b32 v108, 2, v0
    s_lshl_b32 s96, s62, 2
    s_add_u32 s96, s96, 162088
    v_mov_b32 v109, s96
    s_lshl_b32 s100, s63, 11
    s_lshl_b32 s96, s34, 13
    s_add_u32 s100, s100, s96
    s_add_u32 s100, s100, 106496
    s_mul_i32 s101, s34, 5120
    s_lshl_b32 s96, s35, 9
    s_add_u32 s101, s101, s96
    s_lshl_b32 s96, s62, 8
    s_add_u32 s101, s101, s96
    s_sub_u32 s101, s101, 11264
    s_and_b32 s96, s101, 0xffffe000
    s_add_u32 s101, s101, s96
    s_add_u32 s101, s101, 212992
    v_add_u32 v110, 8192, v108
L_nofrag_109:
    s_cmp_ge_u32 s35, 20
    s_cbranch_scc1 L_nofin_111
    s_lshl1_add_u32 s62, s35, s3
    s_sub_u32 s62, s62, 6
    s_lshl_b32 s57, s62, 7
    s_mul_i32 s63, s62, 0x199a
    s_lshr_b32 s63, s63, 16
    s_mul_i32 s63, s63, 1280
    s_sub_u32 s63, s57, s63
    v_lshrrev_b32 v72, 3, v0
    v_mul_u32_u24 v72, 5120, v72
    v_and_b32 v8, 7, v0
    v_lshl_add_u32 v72, v8, 4, v72
    s_add_u32 s62, s57, 327680
    v_add_u32 v72, s62, v72
    v_add_u32 v73, 40960, v72
    v_add_u32 v74, 81920, v72
    v_add_u32 v75, 122880, v72
    v_bfe_u32 v9, v0, 4, 1
    v_lshlrev_b32 v76, 4, v8
    v_lshl_add_u32 v76, v9, 3, v76
    s_lshl_b32 s62, s57, 1
    s_add_u32 s62, s62, 99328
    v_lshl_add_u32 v77, v76, 1, s62
    s_mov_b32 s48, s22
    s_mov_b32 s49, s23
    s_mov_b32 s50, 1280
    s_mov_b32 s51, 0x20000
    buffer_load_dwordx2 v[86:87], v76, s[48:51], s63 offen
    s_add_u32 s62, s57, 35840
    s_branch L_poll_112
L_poll_112s:
    s_sleep 32
L_poll_112:
    buffer_load_dwordx2 v[8:9], v76, s[40:43], s62 offen sc1
    s_sub_u32 s60, s60, 1
    s_cbranch_scc1 L_poll_112t
    s_waitcnt vmcnt(0)
    v_max_u32 v38, v8, v9
    v_cmp_eq_u32 vcc, -1, v38
    s_cbranch_vccnz L_poll_112s
L_poll_112e:
    v_lshlrev_b32 v78, 16, v86
    v_and_b32 v79, 0xffff0000, v86
    v_lshlrev_b32 v82, 16, v8
    v_and_b32 v83, 0xffff0000, v8
    v_lshlrev_b32 v80, 16, v87
    v_and_b32 v81, 0xffff0000, v87
    v_lshlrev_b32 v84, 16, v9
    v_and_b32 v85, 0xffff0000, v9
    v_bfe_u32 v8, v0, 1, 3
    v_and_b32 v9, 1, v0
    v_lshlrev_b32 v9, 4, v9
    v_mov_b32 v10, 0x3f80
    v_lshlrev_b32 v9, v9, v10
    v_cmp_eq_u32 vcc, 0, v8
    v_mov_b32 v100, 0
    s_nop 0
    v_cndmask_b32 v104, 0, v9, vcc
    v_cmp_eq_u32 vcc, 1, v8
    v_mov_b32 v101, 0
    s_nop 0
    v_cndmask_b32 v105, 0, v9, vcc
    v_cmp_eq_u32 vcc, 2, v8
    v_mov_b32 v102, 0
    s_nop 0
    v_cndmask_b32 v106, 0, v9, vcc
    v_cmp_eq_u32 vcc, 3, v8
    v_mov_b32 v103, 0
    s_nop 0
    v_cndmask_b32 v107, 0, v9, vcc
L_nofin_111:
    v_mov_b32 v12, 162076
L_lw_113:
    ds_read_b32 v13, v12
    s_waitcnt lgkmcnt(0)
    v_cmp_gt_u32 vcc, 4, v13
    s_cbranch_vccz L_lw_113e
    s_sleep 4
    s_sub_u32 s60, s60, 1
    s_cbranch_scc0 L_lw_113
    s_mov_b32 s60, 0
L_lw_113e:
    v_and_b32 v11, 31, v0
    v_lshlrev_b32 v11, 7, v11
    s_lshl_b32 s63, s34, 12
    s_add_u32 s63, s63, 73792
    buffer_load_dword v12, v39, s[40:43], s98 offen sc1
    s_branch L_poll_114
L_poll_114s:
    s_sleep 4
L_poll_114:
    buffer_load_dwordx2 v[8:9], v21, s[40:43], s99 offen sc1
    buffer_load_dword v10, v11, s[40:43], s63 offen sc1
    s_sub_u32 s60, s60, 1
    s_cbranch_scc1 L_poll_114t
    s_waitcnt vmcnt(0)
    v_max3_u32 v38, v8, v9, v10
    v_cmp_eq_u32 vcc, -1, v38
    s_cbranch_vccnz L_poll_114s
L_poll_114e:
    v_mov_b32 v37, v8
    s_nop 1
    v_max_f32_dpp v37, v37, v37 quad_perm:[1,0,3,2] row_mask:0xf bank_mask:0xf
    s_nop 1
    v_max_f32_dpp v37, v37, v37 quad_perm:[2,3,0,1] row_mask:0xf bank_mask:0xf
    s_nop 1
    v_max_f32_dpp v37, v37, v37 row_ror:4 row_mask:0xf bank_mask:0xf
    s_nop 1
    v_max_f32_dpp v37, v37, v37 row_ror:8 row_mask:0xf bank_mask:0xf
    v_sub_f32 v8, v8, v37
    v_exp_f32 v8, v8
    s_nop 0
    v_mul_f32 v9, v8, v9
    s_nop 1
    v_add_f32_dpp v9, v9, v9 quad_perm:[1,0,3,2] row_mask:0xf bank_mask:0xf
    s_nop 1
    v_add_f32_dpp v9, v9, v9 quad_perm:[2,3,0,1] row_mask:0xf bank_mask:0xf
    s_nop 1
    v_add_f32_dpp v9, v9, v9 row_ror:4 row_mask:0xf bank_mask:0xf
    s_nop 1
    v_add_f32_dpp v9, v9, v9 row_ror:8 row_mask:0xf bank_mask:0xf
    v_ashrrev_i32 v12, 8, v10
    s_nop 1
    v_add_u32_dpp v12, v12, v12 quad_perm:[1,0,3,2] row_mask:0xf bank_mask:0xf
    s_nop 1
    v_add_u32_dpp v12, v12, v12 quad_perm:[2,3,0,1] row_mask:0xf bank_mask:0xf
    s_nop 1
    v_add_u32_dpp v12, v12, v12 row_ror:4 row_mask:0xf bank_mask:0xf
    s_nop 1
    v_add_u32_dpp v12, v12, v12 row_ror:8 row_mask:0xf bank_mask:0xf
    v_mov_b32 v13, v12
    s_nop 1
    v_permlane16_swap_b32 v12, v13
    v_add_u32 v12, v12, v13
    v_mov_b32 v13, v12
    s_nop 1
    v_permlane32_swap_b32 v12, v13
    v_add_u32 v12, v12, v13
    v_ashrrev_i32 v12, 31, v12
    v_and_b32 v12, 8192, v12
    v_mov_b32 v13, 162084
    ds_write_b32 v13, v12
    v_and_b32 v10, 0xff, v10
    s_getreg_b32 s62, hwreg(HW_REG_XCC_ID, 0, 4)
    v_cmp_ne_u32 vcc, s62, v10
    s_nop 0
    s_cmp_eq_u64 vcc, 0
    s_cselect_b32 s61, 1, 0
    v_rcp_f32 v9, v9
    v_lshrrev_b32 v3, 1, v2
    v_add_u32 v3, 161984, v3
    v_mul_f32 v8, v8, v9
    v_mov_b32 v10, 162072
    v_mov_b32 v11, s61
    ds_write_b32 v3, v8
    ds_write_b32 v10, v11
    s_cmp_eq_u32 s61, 1
    s_cbranch_scc0 L_ycs
    buffer_store_dwordx4 v[24:27], v22, s[40:43], 0 offen offset:0
    buffer_store_dwordx4 v[24:27], v22, s[40:43], 0 offen offset:1024
    buffer_store_dwordx4 v[24:27], v22, s[40:43], 0 offen offset:2048
    buffer_store_dwordx4 v[24:27], v22, s[40:43], 0 offen offset:3072
    buffer_store_dwordx4 v[24:27], v23, s[40:43], 0 offen offset:0
L_ycd:
    s_branch L_poll_115
L_poll_115s:
    s_sleep 4
L_poll_115:
    buffer_load_dwordx4 v[32:35], v20, s[40:43], s97 offen sc1
    s_sub_u32 s60, s60, 1
    s_cbranch_scc1 L_poll_115t
    s_waitcnt vmcnt(0)
    v_max3_u32 v38, v32, v33, v34
    v_max_u32 v38, v38, v35
    v_cmp_eq_u32 vcc, -1, v38
    s_cbranch_vccnz L_poll_115s
L_poll_115e:
    s_branch L_pxj
L_px6:
    s_or_b32 s96, s59, s39
    s_cbranch_scc0 L_nofrag_116
    v_mov_b32 v104, 162060
L_lw_117:
    ds_read_b32 v105, v104
    s_waitcnt lgkmcnt(0)
    v_cmp_gt_u32 vcc, 4, v105
    s_cbranch_vccz L_lw_117e
    s_sleep 2
    s_sub_u32 s60, s60, 1
    s_cbranch_scc0 L_lw_117
    s_mov_b32 s60, 0
L_lw_117e:
    s_cmp_eq_u32 s59, 0
    s_cbranch_scc1 L_nofrag_116
    v_bfe_u32 v104, v0, 2, 1
    v_bfe_u32 v110, v0, 4, 1
    v_lshl_add_u32 v104, v110, 2, v104
    v_and_b32 v110, 8, v0
    v_add_u32 v104, v104, v110
    v_lshrrev_b32 v110, 5, v0
    v_lshl_add_u32 v104, v110, 4, v104
    v_bfe_u32 v111, v0, 0, 1
    v_mul_u32_u24 v111, 0xaaaa, v111
    v_add_u32 v111, 0x4444, v111
    v_mov_b32 v112, 0
    v_mov_b32 v113, 0
    v_mov_b32 v114, 0
    v_mov_b32 v115, 0
    v_mov_b32 v116, 0
    v_mov_b32 v117, 0
    v_mov_b32 v118, 0
    v_mov_b32 v119, 0
    v_lshlrev_b32 v104, 7, v104
    v_and_b32 v110, 3, v0
    v_lshl_add_u32 v104, v110, 3, v104
    v_lshrrev_b32 v109, 4, v0
    v_and_b32 v110, 1, v0
    s_lshr_b32 s63, s3, 1
    s_and_b32 s62, s3, 1
    s_lshl_b32 s96, s63, 14
    s_lshl_b32 s100, s62, 6
    s_add_u32 s100, s100, 81920
    s_add_u32 s96, s96, s100
    v_add_u32 v104, s96, v104
    ds_read_b64_tr_b16 v[72:73], v104 offset:0
    ds_read_b64_tr_b16 v[74:75], v104 offset:256
    ds_read_b64_tr_b16 v[76:77], v104 offset:4096
    ds_read_b64_tr_b16 v[78:79], v104 offset:4352
    ds_read_b64_tr_b16 v[80:81], v104 offset:32
    ds_read_b64_tr_b16 v[82:83], v104 offset:288
    ds_read_b64_tr_b16 v[84:85], v104 offset:4128
    ds_read_b64_tr_b16 v[86:87], v104 offset:4384
    ds_read_b64_tr_b16 v[88:89], v104 offset:8192
    ds_read_b64_tr_b16 v[90:91], v104 offset:8448
    ds_read_b64_tr_b16 v[92:93], v104 offset:12288
    ds_read_b64_tr_b16 v[94:95], v104 offset:12544
    ds_read_b64_tr_b16 v[96:97], v104 offset:8224
    ds_read_b64_tr_b16 v[98:99], v104 offset:8480
    ds_read_b64_tr_b16 v[100:101], v104 offset:12320
    ds_read_b64_tr_b16 v[102:103], v104 offset:12576
    v_bfe_u32 v105, v0, 1, 3
    v_lshlrev_b32 v105, 8, v105
    v_lshl_add_u32 v105, v109, 5, v105
    v_lshl_add_u32 v105, v110, 4, v105
    v_lshrrev_b32 v106, 3, v0
    v_lshlrev_b32 v106, 7, v106
    v_and_b32 v110, 7, v0
    v_lshl_add_u32 v107, v110, 3, v106
    v_add_u32 v107, s100, v107
    v_lshlrev_b32 v106, 8, v109
    v_and_b32 v110, 15, v0
    v_lshl_add_u32 v106, v110, 2, v106
    v_add_u32 v106, s96, v106
    v_lshlrev_b32 v108, 2, v0
    s_lshl_b32 s96, s62, 2
    s_add_u32 s96, s96, 162088
    v_mov_b32 v109, s96
    s_lshl_b32 s100, s63, 11
    s_lshl_b32 s96, s34, 13
    s_add_u32 s100, s100, s96
    s_add_u32 s100, s100, 106496
    s_mul_i32 s101, s34, 5120
    s_lshl_b32 s96, s35, 9
    s_add_u32 s101, s101, s96
    s_lshl_b32 s96, s62, 8
    s_add_u32 s101, s101, s96
    s_sub_u32 s101, s101, 11264
    s_and_b32 s96, s101, 0xffffe000
    s_add_u32 s101, s101, s96
    s_add_u32 s101, s101, 212992
    v_add_u32 v110, 8192, v108
L_nofrag_116:
    s_mov_b32 s62, 3
    s_lshl1_add_u32 s96, s35, s3
    s_and_b32 s63, s96, 7
    s_lshl_b32 s63, s63, 14
    s_lshl_b32 s96, s96, 7
    s_add_u32 s96, s96, s63
    s_add_u32 s96, s96, 475136
    s_add_u32 s98, s32, s96
    s_addc_u32 s99, s33, 0
    s_load_dword s4, s[98:99], 0 glc
    s_load_dword s5, s[98:99], 8192 glc
    s_mov_b32 s63, 0
    s_waitcnt lgkmcnt(0)
L_np:
    s_not_b32 s4, s4
    s_mov_b32 s6, s4
    s_mov_b32 s7, 0
    s_load_dword s4, s[98:99], 0 glc
L_npc0:
    s_add_u32 s7, s7, 1
    s_cmp_eq_u32 s4, s6
    s_cselect_b32 s8, s7, 1000
    s_cmp_lt_u32 s8, 60
    s_cbranch_scc1 L_npc0
    s_waitcnt lgkmcnt(0)
    s_sub_u32 s63, s63, s7
    s_not_b32 s5, s5
    s_mov_b32 s6, s5
    s_mov_b32 s7, 0
    s_load_dword s5, s[98:99], 8192 glc
L_npc1:
    s_add_u32 s7, s7, 1
    s_cmp_eq_u32 s5, s6
    s_cselect_b32 s8, s7, 1000
    s_cmp_lt_u32 s8, 60
    s_cbranch_scc1 L_npc1
    s_waitcnt lgkmcnt(0)
    s_add_u32 s63, s63, s7
    s_sub_u32 s62, s62, 1
    s_cmp_lg_u32 s62, 0
    s_cbranch_scc1 L_np
    v_mov_b32 v8, 162096
    v_mov_b32 v9, s63
    s_mov_b64 exec, 1
    ds_add_u32 v8, v9
    s_mov_b64 exec, -1
    v_mov_b32 v8, 162068
L_lw_118:
    ds_read_b32 v9, v8
    s_waitcnt lgkmcnt(0)
    v_cmp_gt_u32 vcc, 1, v9
    s_cbranch_vccz L_lw_118e
    s_sleep 32
    s_sub_u32 s60, s60, 1
    s_cbranch_scc0 L_lw_118
    s_mov_b32 s60, 0
L_lw_118e:
    s_cmp_ge_u32 s35, 20
    s_cbranch_scc1 L_nofin_119
    s_lshl1_add_u32 s62, s35, s3
    s_sub_u32 s62, s62, 6
    s_lshl_b32 s57, s62, 7
    s_mul_i32 s63, s62, 0x199a
    s_lshr_b32 s63, s63, 16
    s_mul_i32 s63, s63, 1280
    s_sub_u32 s63, s57, s63
    v_lshrrev_b32 v72, 3, v0
    v_mul_u32_u24 v72, 5120, v72
    v_and_b32 v8, 7, v0
    v_lshl_add_u32 v72, v8, 4, v72
    s_add_u32 s62, s57, 327680
    v_add_u32 v72, s62, v72
    v_add_u32 v73, 40960, v72
    v_add_u32 v74, 81920, v72
    v_add_u32 v75, 122880, v72
    v_bfe_u32 v9, v0, 4, 1
    v_lshlrev_b32 v76, 4, v8
    v_lshl_add_u32 v76, v9, 3, v76
    s_lshl_b32 s62, s57, 1
    s_add_u32 s62, s62, 99328
    v_lshl_add_u32 v77, v76, 1, s62
    s_mov_b32 s48, s22
    s_mov_b32 s49, s23
    s_mov_b32 s50, 1280
    s_mov_b32 s51, 0x20000
    buffer_load_dwordx2 v[86:87], v76, s[48:51], s63 offen
    s_add_u32 s62, s57, 35840
    s_branch L_poll_120
L_poll_120s:
    s_sleep 32
L_poll_120:
    buffer_load_dwordx2 v[8:9], v76, s[40:43], s62 offen sc1
    s_sub_u32 s60, s60, 1
    s_cbranch_scc1 L_poll_120t
    s_waitcnt vmcnt(0)
    v_max_u32 v38, v8, v9
    v_cmp_eq_u32 vcc, -1, v38
    s_cbranch_vccnz L_poll_120s
L_poll_120e:
    v_lshlrev_b32 v78, 16, v86
    v_and_b32 v79, 0xffff0000, v86
    v_lshlrev_b32 v82, 16, v8
    v_and_b32 v83, 0xffff0000, v8
    v_lshlrev_b32 v80, 16, v87
    v_and_b32 v81, 0xffff0000, v87
    v_lshlrev_b32 v84, 16, v9
    v_and_b32 v85, 0xffff0000, v9
    v_bfe_u32 v8, v0, 1, 3
    v_and_b32 v9, 1, v0
    v_lshlrev_b32 v9, 4, v9
    v_mov_b32 v10, 0x3f80
    v_lshlrev_b32 v9, v9, v10
    v_cmp_eq_u32 vcc, 0, v8
    v_mov_b32 v100, 0
    s_nop 0
    v_cndmask_b32 v104, 0, v9, vcc
    v_cmp_eq_u32 vcc, 1, v8
    v_mov_b32 v101, 0
    s_nop 0
    v_cndmask_b32 v105, 0, v9, vcc
    v_cmp_eq_u32 vcc, 2, v8
    v_mov_b32 v102, 0
    s_nop 0
    v_cndmask_b32 v106, 0, v9, vcc
    v_cmp_eq_u32 vcc, 3, v8
    v_mov_b32 v103, 0
    s_nop 0
    v_cndmask_b32 v107, 0, v9, vcc
L_nofin_119:
    v_mov_b32 v8, 162076
L_lw_121:
    ds_read_b32 v9, v8
    s_waitcnt lgkmcnt(0)
    v_cmp_gt_u32 vcc, 4, v9
    s_cbranch_vccz L_lw_121e
    s_sleep 16
    s_sub_u32 s60, s60, 1
    s_cbranch_scc0 L_lw_121
    s_mov_b32 s60, 0
L_lw_121e:
    s_branch L_poll_122
L_poll_122s:
    s_sleep 4
L_poll_122:
    buffer_load_dwordx4 v[32:35], v20, s[40:43], s97 offen sc1
    s_sub_u32 s60, s60, 1
    s_cbranch_scc1 L_poll_122t
    s_waitcnt vmcnt(0)
    v_max3_u32 v38, v32, v33, v34
    v_max_u32 v38, v38, v35
    v_cmp_eq_u32 vcc, -1, v38
    s_cbranch_vccnz L_poll_122s
L_poll_122e:
L_pxj:
    s_cmp_ge_u32 s35, 20
    s_cbranch_scc1 L_pxk
    s_mov_b64 exec, -1
L_pxk:
    v_mov_b32 v8, 162048
L_lw_123:
    ds_read_b32 v9, v8
    s_waitcnt lgkmcnt(0)
    v_cmp_gt_u32 vcc, 3, v9
    s_cbranch_vccz L_lw_123e
    s_sleep 2
    s_sub_u32 s60, s60, 1
    s_cbranch_scc0 L_lw_123
    s_mov_b32 s60, 0
L_lw_123e:
    v_lshrrev_b32 v9, 4, v0
    v_lshl_add_u32 v8, v9, 2, v2
    s_lshl_b32 s96, s3, 9
    s_add_u32 s96, s96, 157824
    v_lshl_add_u32 v8, v8, 2, s96
    v_lshlrev_b32 v9, 3, v0
    v_add_u32 v9, 157824, v9
    v_mov_b32 v10, 162048
    v_mov_b32 v11, 1
    s_lshl_b32 s96, s38, 5
    s_add_u32 s96, s96, 161984
    v_mov_b32 v3, s96
    s_sub_u32 s62, 8, s39
    s_lshl_b32 s98, s34, 5
    s_add_u32 s98, s98, s35
    s_lshl_b32 s98, s98, 8
    s_add_u32 s98, s98, 106496
    v_lshlrev_b32 v39, 2, v0
    s_branch L_t0
L_s_role:
    s_cmp_eq_u32 s3, 7
    s_cbranch_scc1 L_t2gate
    s_cmp_gt_u32 s3, 3
    s_cbranch_scc1 L_fin_prep
    s_mov_b32 s48, s18
    s_mov_b32 s49, s19
    s_mov_b32 s50, 3456
    s_mov_b32 s51, 0x20000
    v_lshrrev_b32 v3, 4, v0
    v_and_b32 v4, 15, v0
    v_lshlrev_b32 v4, 1, v4
    s_lshl_b32 s62, s35, 7
    s_lshl_b32 s63, s3, 5
    s_add_u32 s62, s62, s63
    buffer_load_ushort v82, v4, s[48:51], s62 offen
    v_mov_b32 v72, 162064
L_lw_124:
    ds_read_b32 v73, v72
    s_waitcnt lgkmcnt(0)
    v_cmp_gt_u32 vcc, 4, v73
    s_cbranch_vccz L_lw_124e
    s_sleep 2
    s_sub_u32 s60, s60, 1
    s_cbranch_scc0 L_lw_124
    s_mov_b32 s60, 0
L_lw_124e:
    v_bfe_u32 v72, v0, 2, 1
    v_bfe_u32 v73, v0, 4, 1
    v_lshl_add_u32 v72, v73, 2, v72
    v_and_b32 v73, 8, v0
    v_add_u32 v72, v72, v73
    v_lshrrev_b32 v73, 5, v0
    v_lshl_add_u32 v72, v73, 4, v72
    v_lshlrev_b32 v72, 7, v72
    v_and_b32 v73, 3, v0
    v_lshl_add_u32 v72, v73, 3, v72
    v_and_b32 v73, 8, v0
    v_lshl_add_u32 v72, v73, 3, v72
    v_xor_b32 v72, s63, v72
    v_xor_b32 v73, 32, v72
    v_add_u32 v74, 40960, v72
    v_add_u32 v75, 40960, v73
    v_bfe_u32 v1, v0, 2, 2
    v_bfe_u32 v2, v0, 1, 1
    v_and_b32 v6, 1, v0
    v_lshlrev_b32 v7, 5, v3
    v_lshl_add_u32 v7, v6, 4, v7
    v_lshl_add_u32 v5, v2, 2, v1
    v_mul_u32_u24 v5, 1296, v5
    v_add_u32 v5, v5, v7
    v_add_u32 v5, 147456, v5
    v_bfe_u32 v87, v0, 0, 1
    v_mul_u32_u24 v87, 0xaaaa, v87
    v_add_u32 v87, 0x4444, v87
    ds_read_b64_tr_b16 v[88:89], v72 offset:0
    ds_read_b64_tr_b16 v[90:91], v73 offset:256
    ds_read_b64_tr_b16 v[92:93], v72 offset:4096
    ds_read_b64_tr_b16 v[94:95], v73 offset:4352
    ds_read_b64_tr_b16 v[96:97], v72 offset:8192
    ds_read_b64_tr_b16 v[98:99], v73 offset:8448
    ds_read_b64_tr_b16 v[100:101], v72 offset:12288
    ds_read_b64_tr_b16 v[102:103], v73 offset:12544
    ds_read_b64_tr_b16 v[104:105], v72 offset:16384
    ds_read_b64_tr_b16 v[106:107], v73 offset:16640
    ds_read_b64_tr_b16 v[108:109], v72 offset:20480
    ds_read_b64_tr_b16 v[110:111], v73 offset:20736
    ds_read_b64_tr_b16 v[112:113], v72 offset:24576
    ds_read_b64_tr_b16 v[114:115], v73 offset:24832
    ds_read_b64_tr_b16 v[116:117], v72 offset:28672
    ds_read_b64_tr_b16 v[118:119], v73 offset:28928
    ds_read_b64_tr_b16 v[120:121], v72 offset:32768
    ds_read_b64_tr_b16 v[122:123], v73 offset:33024
    ds_read_b64_tr_b16 v[124:125], v72 offset:36864
    ds_read_b64_tr_b16 v[126:127], v73 offset:37120
    ds_read_b64_tr_b16 v[128:129], v74 offset:0
    ds_read_b64_tr_b16 v[130:131], v75 offset:256
    ds_read_b64_tr_b16 v[132:133], v74 offset:4096
    ds_read_b64_tr_b16 v[134:135], v75 offset:4352
    ds_read_b64_tr_b16 v[136:137], v74 offset:8192
    ds_read_b64_tr_b16 v[138:139], v75 offset:8448
    ds_read_b64_tr_b16 v[140:141], v74 offset:12288
    ds_read_b64_tr_b16 v[142:143], v75 offset:12544
    ds_read_b64_tr_b16 v[144:145], v74 offset:16384
    ds_read_b64_tr_b16 v[146:147], v75 offset:16640
    ds_read_b64_tr_b16 v[148:149], v74 offset:20480
    ds_read_b64_tr_b16 v[150:151], v75 offset:20736
    ds_read_b64_tr_b16 v[152:153], v74 offset:24576
    ds_read_b64_tr_b16 v[154:155], v75 offset:24832
    ds_read_b64_tr_b16 v[156:157], v74 offset:28672
    ds_read_b64_tr_b16 v[158:159], v75 offset:28928
    ds_read_b64_tr_b16 v[160:161], v74 offset:32768
    ds_read_b64_tr_b16 v[162:163], v75 offset:33024
    ds_read_b64_tr_b16 v[164:165], v74 offset:36864
    ds_read_b64_tr_b16 v[166:167], v75 offset:37120
    ds_read_b128 v[8:11], v5 offset:0
    ds_read_b128 v[12:15], v5 offset:128
    ds_read_b128 v[16:19], v5 offset:256
    ds_read_b128 v[20:23], v5 offset:384
    ds_read_b128 v[24:27], v5 offset:512
    ds_read_b128 v[28:31], v5 offset:640
    ds_read_b128 v[32:35], v5 offset:768
    ds_read_b128 v[36:39], v5 offset:896
    ds_read_b128 v[40:43], v5 offset:1024
    ds_read_b128 v[44:47], v5 offset:1152
    v_mov_b32 v48, 0
    v_mov_b32 v49, 0
    v_mov_b32 v50, 0
    v_mov_b32 v51, 0
    v_mov_b32 v52, 0
    v_mov_b32 v53, 0
    v_mov_b32 v54, 0
    v_mov_b32 v55, 0
    v_mov_b32 v56, 0
    v_mov_b32 v57, 0
    v_mov_b32 v58, 0
    v_mov_b32 v59, 0
    s_waitcnt lgkmcnt(9)
    v_smfmac_f32_16x16x64_bf16 v[48:51], v[8:11], v[88:95], v87
    s_waitcnt lgkmcnt(8)
    v_smfmac_f32_16x16x64_bf16 v[48:51], v[12:15], v[96:103], v87
    s_waitcnt lgkmcnt(7)
    v_smfmac_f32_16x16x64_bf16 v[48:51], v[16:19], v[104:111], v87
    s_waitcnt lgkmcnt(6)
    v_smfmac_f32_16x16x64_bf16 v[48:51], v[20:23], v[112:119], v87
    s_waitcnt lgkmcnt(5)
    v_smfmac_f32_16x16x64_bf16 v[48:51], v[24:27], v[120:127], v87
    s_waitcnt lgkmcnt(4)
    v_smfmac_f32_16x16x64_bf16 v[48:51], v[28:31], v[128:135], v87
    s_waitcnt lgkmcnt(3)
    v_smfmac_f32_16x16x64_bf16 v[48:51], v[32:35], v[136:143], v87
    s_waitcnt lgkmcnt(2)
    v_smfmac_f32_16x16x64_bf16 v[48:51], v[36:39], v[144:151], v87
    s_waitcnt lgkmcnt(1)
    v_smfmac_f32_16x16x64_bf16 v[48:51], v[40:43], v[152:159], v87
    s_waitcnt lgkmcnt(0)
    v_smfmac_f32_16x16x64_bf16 v[48:51], v[44:47], v[160:167], v87
    v_mul_u32_u24 v79, 1296, v1
    v_lshl_add_u32 v79, v2, 7, v79
    v_add_u32 v79, v79, v7
    v_add_u32 v79, 82944, v79
    v_mul_u32_u24 v80, 144, v3
    v_add3_u32 v80, v80, v4, s63
    v_add_u32 v80, 90688, v80
    v_lshlrev_b32 v81, 3, v0
    v_add_u32 v81, 88128, v81
    v_add_f32 v84, v48, v49
    v_add_f32 v85, v50, v51
    s_mov_b32 s62, 0xbacccccd
    s_mov_b32 s63, 0xbdd2d3e8
    v_mov_b32 v86, 0xc0135761
    s_waitcnt vmcnt(0)
    v_lshlrev_b32 v82, 16, v82
    v_add_f32 v85, v85, v82
    s_branch L_ffn1
L_fin_prep:
    s_cmp_lg_u32 s3, 6
    s_cbranch_scc1 L_end
    s_cmp_ge_u32 s35, 20
    s_cbranch_scc1 L_end
    s_barrier
L_fin:
    s_mov_b32 s52, s28
    s_mov_b32 s53, s29
    s_mov_b32 s54, 5120
    s_mov_b32 s55, 0x20000
    s_mov_b64 s[4:5], -1
    s_mov_b64 s[6:7], -1
    s_mov_b64 s[8:9], -1
    s_mov_b64 s[10:11], 0xffffff
    s_barrier
    ds_read_b128 v[108:111], v77
    s_barrier
L_yg:
    s_mov_b64 exec, s[4:5]
    buffer_load_dwordx4 v[88:91], v72, s[40:43], 0 offen sc1
    s_mov_b64 exec, s[6:7]
    buffer_load_dwordx4 v[92:95], v73, s[40:43], 0 offen sc1
    s_mov_b64 exec, s[8:9]
    buffer_load_dwordx4 v[96:99], v74, s[40:43], 0 offen sc1
    s_mov_b64 exec, s[10:11]
    buffer_load_dwordx4 v[100:103], v75, s[40:43], 0 offen sc1
    s_mov_b64 exec, -1
    s_sub_u32 s60, s60, 1
    s_cbranch_scc1 L_ygt
    s_waitcnt vmcnt(3)
    v_max3_u32 v3, v88, v89, v90
    v_max_u32 v3, v3, v91
    v_cmp_eq_u32 s[4:5], -1, v3
    s_waitcnt vmcnt(2)
    v_max3_u32 v3, v92, v93, v94
    v_max_u32 v3, v3, v95
    v_cmp_eq_u32 s[6:7], -1, v3
    s_waitcnt vmcnt(1)
    v_max3_u32 v3, v96, v97, v98
    v_max_u32 v3, v3, v99
    v_cmp_eq_u32 s[8:9], -1, v3
    s_waitcnt vmcnt(0)
    v_max3_u32 v3, v100, v101, v102
    v_max_u32 v3, v3, v103
    v_cmp_eq_u32 s[10:11], -1, v3
    s_or_b64 s[16:17], s[4:5], s[6:7]
    s_or_b64 s[16:17], s[16:17], s[8:9]
    s_or_b64 s[16:17], s[16:17], s[10:11]
    s_cbranch_scc1 L_yg
L_ygd:
    v_mfma_f32_16x16x32_bf16 v[112:115], v[104:107], v[88:91], 0
    v_mfma_f32_16x16x32_bf16 v[112:115], v[104:107], v[92:95], v[112:115]
    v_mfma_f32_16x16x32_bf16 v[112:115], v[104:107], v[96:99], v[112:115]
    v_mfma_f32_16x16x32_bf16 v[112:115], v[104:107], v[100:103], v[112:115]
    s_waitcnt lgkmcnt(0)
    v_pk_fma_f32 v[108:109], v[78:79], v[82:83], v[108:109]
    v_pk_fma_f32 v[110:111], v[80:81], v[84:85], v[110:111]
    s_nop 4
    v_add_f32_dpp v112, v112, v112 row_ror:8 row_mask:0xf bank_mask:0xf
    v_add_f32_dpp v113, v113, v113 row_ror:8 row_mask:0xf bank_mask:0xf
    v_add_f32_dpp v114, v114, v114 row_ror:8 row_mask:0xf bank_mask:0xf
    v_add_f32_dpp v115, v115, v115 row_ror:8 row_mask:0xf bank_mask:0xf
    v_pk_fma_f32 v[112:113], v[112:113], v[82:83], v[108:109]
    v_pk_fma_f32 v[114:115], v[114:115], v[84:85], v[110:111]
    v_cvt_pk_bf16_f32 v112, v112, v113
    v_cvt_pk_bf16_f32 v113, v114, v115
    s_mov_b64 exec, 0x00ff00ff
    buffer_store_dwordx2 v[112:113], v76, s[52:55], s57 offen
    s_endpgm
L_t2gate:
    v_mov_b32 v8, 162048
L_lw_125:
    ds_read_b32 v9, v8
    s_waitcnt lgkmcnt(0)
    v_cmp_gt_u32 vcc, 8, v9
    s_cbranch_vccz L_lw_125e
    s_sleep 2
    s_sub_u32 s60, s60, 1
    s_cbranch_scc0 L_lw_125
    s_mov_b32 s60, 0
L_lw_125e:
    ds_read_b32 v9, v8 offset:24
    ds_read_b32 v10, v8 offset:36
    v_add_u32 v5, 212992, v5
    s_waitcnt lgkmcnt(0)
    v_readfirstlane_b32 s61, v9
    v_add_u32 v5, v5, v10
    s_mov_b32 s58, 0x3f80
    s_mov_b32 s59, 0x3f800000
    s_mov_b32 s63, 0xff
L_prb:
    s_bcnt1_i32_b32 s62, s63
    s_mov_b32 s97, s63
    s_ff1_i32_b32 s12, s97
    s_bitset0_b32 s97, s12
    s_mul_i32 s4, s12, 5120
    s_add_u32 s4, s4, s56
    s_and_b32 s96, s4, 0xffffe000
    s_add_u32 s4, s4, s96
    s_cmp_eq_u32 s62, 1
    s_cbranch_scc1 L_pi1
    s_ff1_i32_b32 s13, s97
    s_bitset0_b32 s97, s13
    s_mul_i32 s5, s13, 5120
    s_add_u32 s5, s5, s56
    s_and_b32 s96, s5, 0xffffe000
    s_add_u32 s5, s5, s96
    s_cmp_eq_u32 s62, 2
    s_cbranch_scc1 L_pi2
    s_ff1_i32_b32 s14, s97
    s_bitset0_b32 s97, s14
    s_mul_i32 s6, s14, 5120
    s_add_u32 s6, s6, s56
    s_and_b32 s96, s6, 0xffffe000
    s_add_u32 s6, s6, s96
    s_cmp_eq_u32 s62, 3
    s_cbranch_scc1 L_pi3
    s_ff1_i32_b32 s15, s97
    s_bitset0_b32 s97, s15
    s_mul_i32 s7, s15, 5120
    s_add_u32 s7, s7, s56
    s_and_b32 s96, s7, 0xffffe000
    s_add_u32 s7, s7, s96
    s_cmp_eq_u32 s62, 4
    s_cbranch_scc1 L_pi4
    s_ff1_i32_b32 s16, s97
    s_bitset0_b32 s97, s16
    s_mul_i32 s8, s16, 5120
    s_add_u32 s8, s8, s56
    s_and_b32 s96, s8, 0xffffe000
    s_add_u32 s8, s8, s96
    s_cmp_eq_u32 s62, 5
    s_cbranch_scc1 L_pi5
    s_ff1_i32_b32 s17, s97
    s_bitset0_b32 s97, s17
    s_mul_i32 s9, s17, 5120
    s_add_u32 s9, s9, s56
    s_and_b32 s96, s9, 0xffffe000
    s_add_u32 s9, s9, s96
    s_cmp_eq_u32 s62, 6
    s_cbranch_scc1 L_pi6
    s_ff1_i32_b32 s18, s97
    s_bitset0_b32 s97, s18
    s_mul_i32 s10, s18, 5120
    s_add_u32 s10, s10, s56
    s_and_b32 s96, s10, 0xffffe000
    s_add_u32 s10, s10, s96
    s_cmp_eq_u32 s62, 7
    s_cbranch_scc1 L_pi7
    s_ff1_i32_b32 s19, s97
    s_bitset0_b32 s97, s19
    s_mul_i32 s11, s19, 5120
    s_add_u32 s11, s11, s56
    s_and_b32 s96, s11, 0xffffe000
    s_add_u32 s11, s11, s96
L_pi8:
    buffer_load_dwordx4 v[36:39], v5, s[40:43], s11 offen sc1
L_pi7:
    buffer_load_dwordx4 v[32:35], v5, s[40:43], s10 offen sc1
L_pi6:
    buffer_load_dwordx4 v[28:31], v5, s[40:43], s9 offen sc1
L_pi5:
    buffer_load_dwordx4 v[24:27], v5, s[40:43], s8 offen sc1
L_pi4:
    buffer_load_dwordx4 v[20:23], v5, s[40:43], s7 offen sc1
L_pi3:
    buffer_load_dwordx4 v[16:19], v5, s[40:43], s6 offen sc1
L_pi2:
    buffer_load_dwordx4 v[12:15], v5, s[40:43], s5 offen sc1
    buffer_load_dwordx4 v[8:11], v5, s[40:43], s4 offen sc1
    s_sub_u32 s60, s60, 1
    s_cbranch_scc1 L_pto
    s_waitcnt vmcnt(0)
    v_max3_u32 v3, v8, v9, v10
    v_max_u32 v3, v3, v11
    v_cmp_eq_u32 vcc, -1, v3
    s_cbranch_vccz L_pgot0
    v_max3_u32 v3, v12, v13, v14
    v_max_u32 v3, v3, v15
    v_cmp_eq_u32 vcc, -1, v3
    s_cbranch_vccz L_pgot1
    s_cmp_eq_u32 s62, 2
    s_cbranch_scc1 L_pi2
    v_max3_u32 v3, v16, v17, v18
    v_max_u32 v3, v3, v19
    v_cmp_eq_u32 vcc, -1, v3
    s_cbranch_vccz L_pgot2
    s_cmp_eq_u32 s62, 3
    s_cbranch_scc1 L_pi3
    v_max3_u32 v3, v20, v21, v22
    v_max_u32 v3, v3, v23
    v_cmp_eq_u32 vcc, -1, v3
    s_cbranch_vccz L_pgot3
    s_cmp_eq_u32 s62, 4
    s_cbranch_scc1 L_pi4
    v_max3_u32 v3, v24, v25, v26
    v_max_u32 v3, v3, v27
    v_cmp_eq_u32 vcc, -1, v3
    s_cbranch_vccz L_pgot4
    s_cmp_eq_u32 s62, 5
    s_cbranch_scc1 L_pi5
    v_max3_u32 v3, v28, v29, v30
    v_max_u32 v3, v3, v31
    v_cmp_eq_u32 vcc, -1, v3
    s_cbranch_vccz L_pgot5
    s_cmp_eq_u32 s62, 6
    s_cbranch_scc1 L_pi6
    v_max3_u32 v3, v32, v33, v34
    v_max_u32 v3, v3, v35
    v_cmp_eq_u32 vcc, -1, v3
    s_cbranch_vccz L_pgot6
    s_cmp_eq_u32 s62, 7
    s_cbranch_scc1 L_pi7
    v_max3_u32 v3, v36, v37, v38
    v_max_u32 v3, v3, v39
    v_cmp_eq_u32 vcc, -1, v3
    s_cbranch_vccz L_pgot7
    s_branch L_pi8
L_pgot0:
    v_dot2c_f32_bf16 v64, s58, v8
    v_dot2c_f32_bf16 v65, s59, v8
    v_dot2c_f32_bf16 v66, s58, v9
    v_dot2c_f32_bf16 v67, s59, v9
    v_dot2c_f32_bf16 v68, s58, v10
    v_dot2c_f32_bf16 v69, s59, v10
    v_dot2c_f32_bf16 v70, s58, v11
    v_dot2c_f32_bf16 v71, s59, v11
    s_bitset0_b32 s63, s12
    s_cmp_eq_u32 s63, 0
    s_cbranch_scc1 L_pgd
L_pn0:
    s_cmp_eq_u32 s62, 1
    s_cbranch_scc1 L_prb
    v_max3_u32 v3, v12, v13, v14
    v_max_u32 v3, v3, v15
    v_cmp_eq_u32 vcc, -1, v3
    s_cbranch_vccnz L_pn1
L_pgot1:
    v_dot2c_f32_bf16 v64, s58, v12
    v_dot2c_f32_bf16 v65, s59, v12
    v_dot2c_f32_bf16 v66, s58, v13
    v_dot2c_f32_bf16 v67, s59, v13
    v_dot2c_f32_bf16 v68, s58, v14
    v_dot2c_f32_bf16 v69, s59, v14
    v_dot2c_f32_bf16 v70, s58, v15
    v_dot2c_f32_bf16 v71, s59, v15
    s_bitset0_b32 s63, s13
    s_cmp_eq_u32 s63, 0
    s_cbranch_scc1 L_pgd
L_pn1:
    s_cmp_eq_u32 s62, 2
    s_cbranch_scc1 L_prb
    v_max3_u32 v3, v16, v17, v18
    v_max_u32 v3, v3, v19
    v_cmp_eq_u32 vcc, -1, v3
    s_cbranch_vccnz L_pn2
L_pgot2:
    v_dot2c_f32_bf16 v64, s58, v16
    v_dot2c_f32_bf16 v65, s59, v16
    v_dot2c_f32_bf16 v66, s58, v17
    v_dot2c_f32_bf16 v67, s59, v17
    v_dot2c_f32_bf16 v68, s58, v18
    v_dot2c_f32_bf16 v69, s59, v18
    v_dot2c_f32_bf16 v70, s58, v19
    v_dot2c_f32_bf16 v71, s59, v19
    s_bitset0_b32 s63, s14
    s_cmp_eq_u32 s63, 0
    s_cbranch_scc1 L_pgd
L_pn2:
    s_cmp_eq_u32 s62, 3
    s_cbranch_scc1 L_prb
    v_max3_u32 v3, v20, v21, v22
    v_max_u32 v3, v3, v23
    v_cmp_eq_u32 vcc, -1, v3
    s_cbranch_vccnz L_pn3
L_pgot3:
    v_dot2c_f32_bf16 v64, s58, v20
    v_dot2c_f32_bf16 v65, s59, v20
    v_dot2c_f32_bf16 v66, s58, v21
    v_dot2c_f32_bf16 v67, s59, v21
    v_dot2c_f32_bf16 v68, s58, v22
    v_dot2c_f32_bf16 v69, s59, v22
    v_dot2c_f32_bf16 v70, s58, v23
    v_dot2c_f32_bf16 v71, s59, v23
    s_bitset0_b32 s63, s15
    s_cmp_eq_u32 s63, 0
    s_cbranch_scc1 L_pgd
L_pn3:
    s_cmp_eq_u32 s62, 4
    s_cbranch_scc1 L_prb
    v_max3_u32 v3, v24, v25, v26
    v_max_u32 v3, v3, v27
    v_cmp_eq_u32 vcc, -1, v3
    s_cbranch_vccnz L_pn4
L_pgot4:
    v_dot2c_f32_bf16 v64, s58, v24
    v_dot2c_f32_bf16 v65, s59, v24
    v_dot2c_f32_bf16 v66, s58, v25
    v_dot2c_f32_bf16 v67, s59, v25
    v_dot2c_f32_bf16 v68, s58, v26
    v_dot2c_f32_bf16 v69, s59, v26
    v_dot2c_f32_bf16 v70, s58, v27
    v_dot2c_f32_bf16 v71, s59, v27
    s_bitset0_b32 s63, s16
    s_cmp_eq_u32 s63, 0
    s_cbranch_scc1 L_pgd
L_pn4:
    s_cmp_eq_u32 s62, 5
    s_cbranch_scc1 L_prb
    v_max3_u32 v3, v28, v29, v30
    v_max_u32 v3, v3, v31
    v_cmp_eq_u32 vcc, -1, v3
    s_cbranch_vccnz L_pn5
L_pgot5:
    v_dot2c_f32_bf16 v64, s58, v28
    v_dot2c_f32_bf16 v65, s59, v28
    v_dot2c_f32_bf16 v66, s58, v29
    v_dot2c_f32_bf16 v67, s59, v29
    v_dot2c_f32_bf16 v68, s58, v30
    v_dot2c_f32_bf16 v69, s59, v30
    v_dot2c_f32_bf16 v70, s58, v31
    v_dot2c_f32_bf16 v71, s59, v31
    s_bitset0_b32 s63, s17
    s_cmp_eq_u32 s63, 0
    s_cbranch_scc1 L_pgd
L_pn5:
    s_cmp_eq_u32 s62, 6
    s_cbranch_scc1 L_prb
    v_max3_u32 v3, v32, v33, v34
    v_max_u32 v3, v3, v35
    v_cmp_eq_u32 vcc, -1, v3
    s_cbranch_vccnz L_pn6
L_pgot6:
    v_dot2c_f32_bf16 v64, s58, v32
    v_dot2c_f32_bf16 v65, s59, v32
    v_dot2c_f32_bf16 v66, s58, v33
    v_dot2c_f32_bf16 v67, s59, v33
    v_dot2c_f32_bf16 v68, s58, v34
    v_dot2c_f32_bf16 v69, s59, v34
    v_dot2c_f32_bf16 v70, s58, v35
    v_dot2c_f32_bf16 v71, s59, v35
    s_bitset0_b32 s63, s18
    s_cmp_eq_u32 s63, 0
    s_cbranch_scc1 L_pgd
L_pn6:
    s_cmp_eq_u32 s62, 7
    s_cbranch_scc1 L_prb
    v_max3_u32 v3, v36, v37, v38
    v_max_u32 v3, v3, v39
    v_cmp_eq_u32 vcc, -1, v3
    s_cbranch_vccnz L_pn7
L_pgot7:
    v_dot2c_f32_bf16 v64, s58, v36
    v_dot2c_f32_bf16 v65, s59, v36
    v_dot2c_f32_bf16 v66, s58, v37
    v_dot2c_f32_bf16 v67, s59, v37
    v_dot2c_f32_bf16 v68, s58, v38
    v_dot2c_f32_bf16 v69, s59, v38
    v_dot2c_f32_bf16 v70, s58, v39
    v_dot2c_f32_bf16 v71, s59, v39
    s_bitset0_b32 s63, s19
    s_cmp_eq_u32 s63, 0
    s_cbranch_scc1 L_pgd
L_pn7:
    s_branch L_prb
L_pi1:
L_poll_126:
    buffer_load_dwordx4 v[8:11], v5, s[40:43], s4 offen sc1
    s_sub_u32 s60, s60, 1
    s_cbranch_scc1 L_poll_126t
    s_waitcnt vmcnt(0)
    v_max3_u32 v3, v8, v9, v10
    v_max_u32 v3, v3, v11
    v_cmp_eq_u32 vcc, -1, v3
    s_cbranch_vccnz L_poll_126
L_poll_126e:
    v_dot2c_f32_bf16 v64, s58, v8
    v_dot2c_f32_bf16 v65, s59, v8
    v_dot2c_f32_bf16 v66, s58, v9
    v_dot2c_f32_bf16 v67, s59, v9
    v_dot2c_f32_bf16 v68, s58, v10
    v_dot2c_f32_bf16 v69, s59, v10
    v_dot2c_f32_bf16 v70, s58, v11
    v_dot2c_f32_bf16 v71, s59, v11
L_pgd:
    v_pk_fma_f32 v[64:65], v[64:65], v[48:49], v[40:41]
    v_pk_fma_f32 v[66:67], v[66:67], v[50:51], v[42:43]
    v_pk_fma_f32 v[68:69], v[68:69], v[52:53], v[44:45]
    v_pk_fma_f32 v[70:71], v[70:71], v[54:55], v[46:47]
    v_pk_mul_f32 v[56:57], v[64:65], v[56:57]
    v_pk_mul_f32 v[58:59], v[66:67], v[58:59]
    v_pk_mul_f32 v[60:61], v[68:69], v[60:61]
    v_pk_mul_f32 v[62:63], v[70:71], v[62:63]
    v_cvt_pk_bf16_f32 v8, v56, v57
    v_cvt_pk_bf16_f32 v9, v58, v59
    v_cvt_pk_bf16_f32 v10, v60, v61
    v_cvt_pk_bf16_f32 v11, v62, v63
    ds_write_b128 v4, v[8:11]
    v_pk_add_f32 v[40:41], v[64:65], v[66:67]
    v_pk_add_f32 v[42:43], v[68:69], v[70:71]
    v_pk_mul_f32 v[44:45], v[64:65], v[64:65]
    v_pk_mul_f32 v[46:47], v[66:67], v[66:67]
    v_pk_add_f32 v[40:41], v[40:41], v[42:43]
    v_pk_fma_f32 v[44:45], v[68:69], v[68:69], v[44:45]
    v_pk_fma_f32 v[46:47], v[70:71], v[70:71], v[46:47]
    v_add_f32 v40, v40, v41
    v_pk_add_f32 v[44:45], v[44:45], v[46:47]
    v_add_f32 v41, v44, v45
    ds_write_b64 v7, v[40:41]
    s_waitcnt lgkmcnt(0)
    s_barrier
    v_mov_b32 v16, 0
    v_mov_b32 v17, 0
    v_mov_b32 v18, 0
    v_mov_b32 v19, 0
    v_mov_b32 v20, 0
    v_mov_b32 v21, 0
    v_mov_b32 v22, 0
    v_mov_b32 v23, 0
    v_mov_b32 v24, 0
    v_mov_b32 v25, 0
    v_mov_b32 v26, 0
    v_mov_b32 v27, 0
    v_mov_b32 v28, 0
    v_mov_b32 v29, 0
    v_mov_b32 v30, 0
    v_mov_b32 v31, 0
    v_mov_b32 v32, 0
    v_mov_b32 v33, 0
    v_mov_b32 v34, 0
    v_mov_b32 v35, 0
    ds_write_b128 v6, v[64:67]
    ds_write_b128 v6, v[68:71] offset:16
    s_waitcnt lgkmcnt(0)
    s_cmp_lg_u32 s3, 7
    s_cbranch_scc1 L_ffn2
    s_cmp_lt_u32 s35, 20
    s_cbranch_scc1 L_fin
    s_endpgm
L_ffn1:
    s_barrier
L_ffn1b:
    ds_read_b128 v[8:11], v79
    ds_read_b64 v[30:31], v81 offset:0
    ds_read_b64 v[32:33], v81 offset:512
    ds_read_b64 v[34:35], v81 offset:1024
    ds_read_b64 v[36:37], v81 offset:1536
    ds_read_b64 v[38:39], v81 offset:2048
    ds_read_b128 v[12:15], v79 offset:256
    ds_read_b128 v[16:19], v79 offset:512
    ds_read_b128 v[20:23], v79 offset:768
    ds_read_b128 v[24:27], v79 offset:1024
    s_waitcnt lgkmcnt(9)
    v_smfmac_f32_16x16x64_bf16 v[52:55], v[8:11], v[88:95], v87
    v_smfmac_f32_16x16x64_bf16 v[56:59], v[8:11], v[96:103], v87
    s_waitcnt lgkmcnt(3)
    v_smfmac_f32_16x16x64_bf16 v[52:55], v[12:15], v[104:111], v87
    v_pk_add_f32 v[30:31], v[30:31], v[32:33]
    v_pk_add_f32 v[34:35], v[34:35], v[36:37]
    v_smfmac_f32_16x16x64_bf16 v[56:59], v[12:15], v[112:119], v87
    v_pk_add_f32 v[30:31], v[30:31], v[38:39]
    v_pk_add_f32 v[30:31], v[30:31], v[34:35]
    s_nop 0
    s_waitcnt lgkmcnt(2)
    v_smfmac_f32_16x16x64_bf16 v[52:55], v[16:19], v[120:127], v87
    v_add_f32_dpp v30, v30, v30 quad_perm:[1,0,3,2] row_mask:0xf bank_mask:0xf
    v_add_f32_dpp v31, v31, v31 quad_perm:[1,0,3,2] row_mask:0xf bank_mask:0xf
    v_smfmac_f32_16x16x64_bf16 v[56:59], v[16:19], v[128:135], v87
    v_add_f32_dpp v30, v30, v30 quad_perm:[2,3,0,1] row_mask:0xf bank_mask:0xf
    v_add_f32_dpp v31, v31, v31 quad_perm:[2,3,0,1] row_mask:0xf bank_mask:0xf
    s_waitcnt lgkmcnt(1)
    v_smfmac_f32_16x16x64_bf16 v[52:55], v[20:23], v[136:143], v87
    v_add_f32_dpp v30, v30, v30 row_ror:4 row_mask:0xf bank_mask:0xf
    v_add_f32_dpp v31, v31, v31 row_ror:4 row_mask:0xf bank_mask:0xf
    v_smfmac_f32_16x16x64_bf16 v[56:59], v[20:23], v[144:151], v87
    v_add_f32_dpp v30, v30, v30 row_ror:8 row_mask:0xf bank_mask:0xf
    v_add_f32_dpp v31, v31, v31 row_ror:8 row_mask:0xf bank_mask:0xf
    s_waitcnt lgkmcnt(0)
    v_smfmac_f32_16x16x64_bf16 v[52:55], v[24:27], v[152:159], v87
    v_mul_f32 v48, s62, v30
    v_mul_f32 v49, s62, v31
    v_smfmac_f32_16x16x64_bf16 v[56:59], v[24:27], v[160:167], v87
    v_mul_f32 v7, v84, v48
    v_fma_f32 v49, -v48, v48, -v49
    v_max_f32 v49, 0, v49
    v_add_f32 v49, 0x3727c5ac, v49
    v_rsq_f32 v49, v49
    v_add_f32 v4, v52, v53
    v_add_f32 v4, v4, v7
    s_nop 0
    v_add_f32 v5, v58, v59
    v_add_f32 v4, v4, v5
    v_fma_f32 v4, v4, v49, v85
    v_mul_f32 v5, v4, v4
    v_fma_f32 v5, v5, s63, v86
    v_mul_f32 v5, v5, v4
    v_exp_f32 v5, v5
    s_nop 0
    v_add_f32 v5, 1.0, v5
    v_rcp_f32 v5, v5
    s_nop 0
    v_mul_f32 v4, v4, v5
    v_cvt_pk_bf16_f32 v4, v4, v4
    ds_write_b16 v80, v4
    s_waitcnt lgkmcnt(0)
    s_barrier
    s_endpgm
L_h_t1:
    s_sub_u32 s63, s56, 154
    s_cmp_lt_u32 s63, 16
    s_cbranch_scc0 L_h_noclr
    s_lshl2_add_u32 s62, s63, s3
    s_mul_i32 s62, s62, 4608
    v_mov_b32 v4, -1
    v_mov_b32 v5, -1
    v_mov_b32 v6, -1
    v_mov_b32 v7, -1
    v_lshlrev_b32 v8, 4, v0
    buffer_store_dwordx4 v[4:7], v8, s[40:43], s62 offen offset:0 sc1
    buffer_store_dwordx4 v[4:7], v8, s[40:43], s62 offen offset:1024 sc1
    buffer_store_dwordx4 v[4:7], v8, s[40:43], s62 offen offset:2048 sc1
    buffer_store_dwordx4 v[4:7], v8, s[40:43], s62 offen offset:3072 sc1
    s_add_u32 s62, s62, 4096
    s_bfm_b64 exec, 32, 0
    buffer_store_dwordx4 v[4:7], v8, s[40:43], s62 offen offset:0 sc1
    s_mov_b64 exec, 1
    v_mov_b32 v9, 162100
    v_mov_b32 v10, 1
    s_and_b32 s62, s63, 1
    s_mul_i32 s62, s62, 126
    s_lshl1_add_u32 s63, s63, s62
    s_waitcnt vmcnt(0)
    ds_add_rtn_u32 v10, v9, v10
    s_waitcnt lgkmcnt(0)
    v_readfirstlane_b32 s62, v10
    s_nop 0
    s_cmp_lg_u32 s62, 3
    s_cbranch_scc1 L_h_clrd
    buffer_store_dword v4, v36, s[44:47], s63 offen sc1
L_h_clrd:
    s_mov_b64 exec, -1
L_h_noclr:
    v_lshrrev_b32 v1, 3, v0
    v_mul_u32_u24 v1, 1280, v1
    v_and_b32 v2, 7, v0
    v_lshl_add_u32 v1, v2, 4, v1
    s_lshl2_add_u32 s63, s34, s3
    s_mul_i32 s63, s63, 163840
    s_lshl_b32 s62, s35, 7
    s_add_u32 s63, s63, s62
    s_sub_u32 s63, s63, 2816
    s_lshl_b32 s62, s3, 14
    s_add_u32 s62, s62, 81920
    s_mov_b32 m0, s62
    s_mov_b32 s48, s12
    s_mov_b32 s49, s13
    s_mov_b32 s50, 5242880
    s_mov_b32 s51, 0x20000
    s_add_u32 s100, s39, 1
    s_mov_b32 s62, 8
L_dma_5:
    buffer_load_dwordx4 v1, s[48:51], s63 offen nt lds
    s_add_u32 m0, m0, 1024
    s_add_u32 s63, s63, 10240
    s_cmp_eq_u32 s100, 0
    s_cbranch_scc1 L_dma_5n0
    s_waitcnt vmcnt(7)
    s_cmp_eq_u32 s100, 2
    s_cbranch_scc1 L_dma_5n0
    s_waitcnt vmcnt(5)
L_dma_5n0:
    buffer_load_dwordx4 v1, s[48:51], s63 offen nt lds
    s_add_u32 m0, m0, 1024
    s_add_u32 s63, s63, 10240
    s_cmp_eq_u32 s100, 0
    s_cbranch_scc1 L_dma_5n1
    s_waitcnt vmcnt(7)
    s_cmp_eq_u32 s100, 2
    s_cbranch_scc1 L_dma_5n1
    s_waitcnt vmcnt(5)
L_dma_5n1:
    s_sub_u32 s62, s62, 1
    s_cmp_lg_u32 s62, 0
    s_cbranch_scc1 L_dma_5
    s_cmp_eq_u32 s39, 1
    s_cbranch_scc1 L_h_role
    s_barrier
    s_waitcnt vmcnt(0)
    v_mov_b32 v4, 162060
    v_mov_b32 v5, 1
    s_mov_b64 exec, 1
    ds_add_u32 v4, v5
    s_mov_b64 exec, -1
    s_cmp_eq_u32 s3, 0
    s_cbranch_scc1 L_service
    s_endpgm
L_h_role:
    v_mov_b32 v72, 0
    v_mov_b32 v73, 0
    v_mov_b32 v74, 0
    v_mov_b32 v75, 0
    v_mov_b32 v76, 0
    v_lshrrev_b32 v3, 4, v0
    v_and_b32 v2, 3, v0
    v_bfe_u32 v1, v0, 2, 2
    v_mul_u32_u24 v160, 1280, v3
    v_and_b32 v4, 15, v0
    v_lshl_add_u32 v163, v4, 2, v160
    v_lshl_add_u32 v160, v4, 3, v160
    s_mul_i32 s57, s35, 5120
    s_mul_i32 s62, s3, 320
    s_add_u32 s57, s57, s62
    s_add_u32 s57, s57, 327680
    v_add_u32 v8, 0, v0
    v_mul_u32_u24 v10, 0xccd, v8
    v_lshrrev_b32 v10, 16, v10
    v_mul_u32_u24 v9, 20, v10
    v_sub_u32 v8, v8, v9
    v_mul_u32_u24 v10, 1280, v10
    v_lshl_add_u32 v10, v8, 4, v10
    v_add_u32 v8, 64, v0
    v_mul_u32_u24 v11, 0xccd, v8
    v_lshrrev_b32 v11, 16, v11
    v_mul_u32_u24 v9, 20, v11
    v_sub_u32 v8, v8, v9
    v_mul_u32_u24 v11, 1280, v11
    v_lshl_add_u32 v11, v8, 4, v11
    v_add_u32 v8, 128, v0
    v_mul_u32_u24 v12, 0xccd, v8
    v_lshrrev_b32 v12, 16, v12
    v_mul_u32_u24 v9, 20, v12
    v_sub_u32 v8, v8, v9
    v_mul_u32_u24 v12, 1280, v12
    v_lshl_add_u32 v12, v8, 4, v12
    v_add_u32 v8, 192, v0
    v_mul_u32_u24 v13, 0xccd, v8
    v_lshrrev_b32 v13, 16, v13
    v_mul_u32_u24 v9, 20, v13
    v_sub_u32 v8, v8, v9
    v_mul_u32_u24 v13, 1280, v13
    v_lshl_add_u32 v13, v8, 4, v13
    v_add_u32 v8, 256, v0
    v_mul_u32_u24 v14, 0xccd, v8
    v_lshrrev_b32 v14, 16, v14
    v_mul_u32_u24 v9, 20, v14
    v_sub_u32 v8, v8, v9
    v_mul_u32_u24 v14, 1280, v14
    v_lshl_add_u32 v14, v8, 4, v14
    s_mov_b32 s48, s20
    s_mov_b32 s49, s21
    s_mov_b32 s50, 2211840
    s_mov_b32 s51, 0x20000
    s_mul_i32 s63, s35, 81920
    s_mul_i32 s62, s3, 320
    s_add_u32 s63, s63, s62
    s_mov_b32 m0, s101
    s_mov_b32 s62, 4
L_w2dma:
    buffer_load_dwordx4 v10, s[48:51], s63 offen nt lds
    s_add_u32 m0, m0, 1024
    s_waitcnt vmcnt(7)
    s_cmp_ge_u32 s35, 22
    s_cbranch_scc1 L_w2n0
    s_waitcnt vmcnt(7)
L_w2n0:
    buffer_load_dwordx4 v11, s[48:51], s63 offen nt lds
    s_add_u32 m0, m0, 1024
    s_waitcnt vmcnt(7)
    s_cmp_ge_u32 s35, 22
    s_cbranch_scc1 L_w2n1
    s_waitcnt vmcnt(7)
L_w2n1:
    buffer_load_dwordx4 v12, s[48:51], s63 offen nt lds
    s_add_u32 m0, m0, 1024
    s_waitcnt vmcnt(7)
    s_cmp_ge_u32 s35, 22
    s_cbranch_scc1 L_w2n2
    s_waitcnt vmcnt(7)
L_w2n2:
    buffer_load_dwordx4 v13, s[48:51], s63 offen nt lds
    s_add_u32 m0, m0, 1024
    s_waitcnt vmcnt(7)
    s_cmp_ge_u32 s35, 22
    s_cbranch_scc1 L_w2n3
    s_waitcnt vmcnt(7)
L_w2n3:
    buffer_load_dwordx4 v14, s[48:51], s63 offen nt lds
    s_add_u32 m0, m0, 1024
    s_waitcnt vmcnt(7)
    s_cmp_ge_u32 s35, 22
    s_cbranch_scc1 L_w2n4
    s_waitcnt vmcnt(7)
L_w2n4:
    s_add_u32 s63, s63, 20480
    s_sub_u32 s62, s62, 1
    s_cmp_lg_u32 s62, 0
    s_cbranch_scc1 L_w2dma
    v_lshrrev_b32 v8, 5, v0
    v_lshlrev_b32 v8, 2, v8
    v_bfe_u32 v9, v0, 4, 1
    v_add_u32 v8, v8, v9
    v_mul_u32_u24 v8, 1280, v8
    v_add_u32 v8, s101, v8
    v_and_b32 v10, 15, v0
    v_lshl_add_u32 v9, v10, 2, v8
    v_lshl_add_u32 v8, v10, 3, v8
    s_mov_b32 s62, 0x05040100
    s_mov_b32 s63, 0x07060302
    s_waitcnt vmcnt(0)
    v_mov_b32 v4, 162060
    v_mov_b32 v5, 1
    s_mov_b64 exec, 1
    ds_add_u32 v4, v5
    s_mov_b64 exec, -1
    ds_read_b64 v[16:17], v8 offset:0
    ds_read_b64 v[18:19], v8 offset:320
    ds_read_b64 v[20:21], v8 offset:2560
    ds_read_b64 v[22:23], v8 offset:2880
    ds_read_b64 v[24:25], v8 offset:640
    ds_read_b64 v[26:27], v8 offset:960
    ds_read_b64 v[28:29], v8 offset:3200
    ds_read_b64 v[30:31], v8 offset:3520
    ds_read_b64 v[32:33], v8 offset:10240
    ds_read_b64 v[34:35], v8 offset:10560
    ds_read_b64 v[36:37], v8 offset:12800
    ds_read_b64 v[38:39], v8 offset:13120
    ds_read_b64 v[40:41], v8 offset:10880
    ds_read_b64 v[42:43], v8 offset:11200
    ds_read_b64 v[44:45], v8 offset:13440
    ds_read_b64 v[46:47], v8 offset:13760
    s_waitcnt lgkmcnt(0)
    v_perm_b32 v80, v18, v16, s62
    v_perm_b32 v88, v18, v16, s63
    v_perm_b32 v96, v19, v17, s62
    v_perm_b32 v104, v19, v17, s63
    v_perm_b32 v81, v22, v20, s62
    v_perm_b32 v89, v22, v20, s63
    v_perm_b32 v97, v23, v21, s62
    v_perm_b32 v105, v23, v21, s63
    v_perm_b32 v82, v26, v24, s62
    v_perm_b32 v90, v26, v24, s63
    v_perm_b32 v98, v27, v25, s62
    v_perm_b32 v106, v27, v25, s63
    v_perm_b32 v83, v30, v28, s62
    v_perm_b32 v91, v30, v28, s63
    v_perm_b32 v99, v31, v29, s62
    v_perm_b32 v107, v31, v29, s63
    v_perm_b32 v84, v34, v32, s62
    v_perm_b32 v92, v34, v32, s63
    v_perm_b32 v100, v35, v33, s62
    v_perm_b32 v108, v35, v33, s63
    v_perm_b32 v85, v38, v36, s62
    v_perm_b32 v93, v38, v36, s63
    v_perm_b32 v101, v39, v37, s62
    v_perm_b32 v109, v39, v37, s63
    v_perm_b32 v86, v42, v40, s62
    v_perm_b32 v94, v42, v40, s63
    v_perm_b32 v102, v43, v41, s62
    v_perm_b32 v110, v43, v41, s63
    v_perm_b32 v87, v46, v44, s62
    v_perm_b32 v95, v46, v44, s63
    v_perm_b32 v103, v47, v45, s62
    v_perm_b32 v111, v47, v45, s63
    ds_read_b64 v[16:17], v8 offset:128
    ds_read_b64 v[18:19], v8 offset:448
    ds_read_b64 v[20:21], v8 offset:2688
    ds_read_b64 v[22:23], v8 offset:3008
    ds_read_b64 v[24:25], v8 offset:768
    ds_read_b64 v[26:27], v8 offset:1088
    ds_read_b64 v[28:29], v8 offset:3328
    ds_read_b64 v[30:31], v8 offset:3648
    ds_read_b64 v[32:33], v8 offset:10368
    ds_read_b64 v[34:35], v8 offset:10688
    ds_read_b64 v[36:37], v8 offset:12928
    ds_read_b64 v[38:39], v8 offset:13248
    ds_read_b64 v[40:41], v8 offset:11008
    ds_read_b64 v[42:43], v8 offset:11328
    ds_read_b64 v[44:45], v8 offset:13568
    ds_read_b64 v[46:47], v8 offset:13888
    s_waitcnt lgkmcnt(0)
    v_perm_b32 v112, v18, v16, s62
    v_perm_b32 v120, v18, v16, s63
    v_perm_b32 v128, v19, v17, s62
    v_perm_b32 v136, v19, v17, s63
    v_perm_b32 v113, v22, v20, s62
    v_perm_b32 v121, v22, v20, s63
    v_perm_b32 v129, v23, v21, s62
    v_perm_b32 v137, v23, v21, s63
    v_perm_b32 v114, v26, v24, s62
    v_perm_b32 v122, v26, v24, s63
    v_perm_b32 v130, v27, v25, s62
    v_perm_b32 v138, v27, v25, s63
    v_perm_b32 v115, v30, v28, s62
    v_perm_b32 v123, v30, v28, s63
    v_perm_b32 v131, v31, v29, s62
    v_perm_b32 v139, v31, v29, s63
    v_perm_b32 v116, v34, v32, s62
    v_perm_b32 v124, v34, v32, s63
    v_perm_b32 v132, v35, v33, s62
    v_perm_b32 v140, v35, v33, s63
    v_perm_b32 v117, v38, v36, s62
    v_perm_b32 v125, v38, v36, s63
    v_perm_b32 v133, v39, v37, s62
    v_perm_b32 v141, v39, v37, s63
    v_perm_b32 v118, v42, v40, s62
    v_perm_b32 v126, v42, v40, s63
    v_perm_b32 v134, v43, v41, s62
    v_perm_b32 v142, v43, v41, s63
    v_perm_b32 v119, v46, v44, s62
    v_perm_b32 v127, v46, v44, s63
    v_perm_b32 v135, v47, v45, s62
    v_perm_b32 v143, v47, v45, s63
    ds_read_b32 v16, v9 offset:256
    ds_read_b32 v18, v9 offset:576
    ds_read_b32 v20, v9 offset:2816
    ds_read_b32 v22, v9 offset:3136
    ds_read_b32 v24, v9 offset:896
    ds_read_b32 v26, v9 offset:1216
    ds_read_b32 v28, v9 offset:3456
    ds_read_b32 v30, v9 offset:3776
    ds_read_b32 v32, v9 offset:10496
    ds_read_b32 v34, v9 offset:10816
    ds_read_b32 v36, v9 offset:13056
    ds_read_b32 v38, v9 offset:13376
    ds_read_b32 v40, v9 offset:11136
    ds_read_b32 v42, v9 offset:11456
    ds_read_b32 v44, v9 offset:13696
    ds_read_b32 v46, v9 offset:14016
    s_waitcnt lgkmcnt(0)
    v_perm_b32 v144, v18, v16, s62
    v_perm_b32 v152, v18, v16, s63
    v_perm_b32 v145, v22, v20, s62
    v_perm_b32 v153, v22, v20, s63
    v_perm_b32 v146, v26, v24, s62
    v_perm_b32 v154, v26, v24, s63
    v_perm_b32 v147, v30, v28, s62
    v_perm_b32 v155, v30, v28, s63
    v_perm_b32 v148, v34, v32, s62
    v_perm_b32 v156, v34, v32, s63
    v_perm_b32 v149, v38, v36, s62
    v_perm_b32 v157, v38, v36, s63
    v_perm_b32 v150, v42, v40, s62
    v_perm_b32 v158, v42, v40, s63
    v_perm_b32 v151, v46, v44, s62
    v_perm_b32 v159, v46, v44, s63
    s_mov_b32 s48, s16
    s_mov_b32 s49, s17
    s_mov_b32 s50, 2211840
    s_mov_b32 s51, 0x20000
    s_lshl_b32 s98, s35, 7
    s_mov_b32 s99, 3456
    v_lshrrev_b32 v9, 3, v0
    v_mul_lo_u32 v10, v9, s99
    v_and_b32 v9, 2, v9
    v_xor_b32 v9, v9, v0
    v_and_b32 v9, 7, v9
    v_lshl_add_u32 v10, v9, 4, v10
    v_add_u32 v10, s98, v10
    v_xor_b32 v11, 64, v10
    s_mul_i32 s63, s3, 552960
    s_mov_b32 m0, s101
    s_waitcnt lgkmcnt(0)
    s_cmp_ge_u32 s35, 22
    s_cselect_b32 s100, 2, 1
    s_mov_b32 s62, 10
L_dma_6:
    buffer_load_dwordx4 v10, s[48:51], s63 offen nt lds
    s_add_u32 m0, m0, 1024
    s_add_u32 s63, s63, 27648
    s_cmp_eq_u32 s100, 0
    s_cbranch_scc1 L_dma_6n0
    s_waitcnt vmcnt(7)
    s_cmp_eq_u32 s100, 2
    s_cbranch_scc1 L_dma_6n0
    s_waitcnt vmcnt(7)
L_dma_6n0:
    buffer_load_dwordx4 v11, s[48:51], s63 offen nt lds
    s_add_u32 m0, m0, 1024
    s_add_u32 s63, s63, 27648
    s_cmp_eq_u32 s100, 0
    s_cbranch_scc1 L_dma_6n1
    s_waitcnt vmcnt(7)
    s_cmp_eq_u32 s100, 2
    s_cbranch_scc1 L_dma_6n1
    s_waitcnt vmcnt(7)
L_dma_6n1:
    s_sub_u32 s62, s62, 1
    s_cmp_lg_u32 s62, 0
    s_cbranch_scc1 L_dma_6
    v_mov_b32 v8, 162068
L_lw_7:
    ds_read_b32 v9, v8
    s_waitcnt lgkmcnt(0)
    v_cmp_gt_u32 vcc, 1, v9
    s_cbranch_vccz L_lw_7e
    s_sleep 8
    s_sub_u32 s60, s60, 1
    s_cbranch_scc0 L_lw_7
    s_mov_b32 s60, 0
L_lw_7e:
    s_cmp_lg_u32 s3, 3
    s_cbranch_scc1 L_h_nomo
    v_and_b32 v4, 15, v0
    v_lshlrev_b32 v4, 4, v4
    v_mul_u32_u24 v5, 1280, v3
    v_add_u32 v5, v5, v4
    v_mul_u32_u24 v6, 1296, v3
    v_add_u32 v6, v6, v4
    v_add_u32 v6, 147456, v6
    s_mov_b32 s62, 30720
    s_mov_b32 s63, 25600
    s_branch L_poll_8
L_poll_8s:
    s_sleep 8
L_poll_8:
    buffer_load_dwordx4 v[40:43], v5, s[40:43], s62 offen offset:0 sc1
    buffer_load_dwordx4 v[44:47], v5, s[40:43], s62 offen offset:256 sc1
    buffer_load_dwordx4 v[48:51], v5, s[40:43], s62 offen offset:512 sc1
    buffer_load_dwordx4 v[52:55], v5, s[40:43], s62 offen offset:768 sc1
    buffer_load_dwordx4 v[56:59], v5, s[40:43], s62 offen offset:1024 sc1
    buffer_load_dwordx4 v[60:63], v5, s[40:43], s63 offen offset:0 sc1
    buffer_load_dwordx4 v[64:67], v5, s[40:43], s63 offen offset:256 sc1
    buffer_load_dwordx4 v[68:71], v5, s[40:43], s63 offen offset:512 sc1
    buffer_load_dwordx4 v[72:75], v5, s[40:43], s63 offen offset:768 sc1
    buffer_load_dwordx4 v[76:79], v5, s[40:43], s63 offen offset:1024 sc1
    s_sub_u32 s60, s60, 1
    s_cbranch_scc1 L_poll_8t
    s_waitcnt vmcnt(0)
    v_max3_u32 v7, v40, v41, v42
    v_max3_u32 v7, v7, v43, v44
    v_max3_u32 v7, v7, v45, v46
    v_max3_u32 v7, v7, v47, v48
    v_max3_u32 v7, v7, v49, v50
    v_max3_u32 v7, v7, v51, v52
    v_max3_u32 v7, v7, v53, v54
    v_max3_u32 v7, v7, v55, v56
    v_max3_u32 v7, v7, v57, v58
    v_max3_u32 v7, v7, v59, v60
    v_max3_u32 v7, v7, v61, v62
    v_max3_u32 v7, v7, v63, v64
    v_max3_u32 v7, v7, v65, v66
    v_max3_u32 v7, v7, v67, v68
    v_max3_u32 v7, v7, v69, v70
    v_max3_u32 v7, v7, v71, v72
    v_max3_u32 v7, v7, v73, v74
    v_max3_u32 v7, v7, v75, v76
    v_max3_u32 v7, v7, v77, v78
    v_max_u32 v7, v7, v79
    v_cmp_eq_u32 vcc, -1, v7
    s_cbranch_vccnz L_poll_8s
L_poll_8e:
    ds_write_b128 v6, v[40:43] offset:0
    ds_write_b128 v6, v[44:47] offset:256
    ds_write_b128 v6, v[48:51] offset:512
    ds_write_b128 v6, v[52:55] offset:768
    ds_write_b128 v6, v[56:59] offset:1024
    ds_write_b128 v6, v[60:63] offset:5184
    ds_write_b128 v6, v[64:67] offset:5440
    ds_write_b128 v6, v[68:71] offset:5696
    ds_write_b128 v6, v[72:75] offset:5952
    ds_write_b128 v6, v[76:79] offset:6208
L_h_nomo:
    v_mul_u32_u24 v4, 144, v1
    v_lshl_add_u32 v4, v3, 5, v4
    v_bfe_u32 v5, v0, 1, 1
    v_lshl_add_u32 v4, v5, 4, v4
    v_add_u32 v4, 90688, v4
    v_mov_b32 v5, 162112
    v_and_b32 v6, 1, v0
    v_cmp_eq_u32 vcc, 0, v6
    s_nop 1
    v_cndmask_b32 v161, v5, v4, vcc
    v_cndmask_b32 v162, v4, v5, vcc
    v_bfe_u32 v164, v0, 1, 1
    v_mul_u32_u24 v164, 0xaaaa, v164
    v_add_u32 v164, 0x4444, v164
    s_mov_b32 s100, s3
    s_lshl_b32 s63, s100, 8
    v_and_b32 v8, 15, v0
    v_lshl_add_u32 v8, v8, 4, s63
    v_lshrrev_b32 v9, 4, v0
    v_mul_u32_u24 v5, 1280, v9
    v_add_u32 v5, v5, v8
    v_mul_u32_u24 v4, 1296, v9
    v_add_u32 v4, v4, v8
    v_add_u32 v4, 82944, v4
    v_lshlrev_b32 v6, 1, v5
    v_add_u32 v6, 99328, v6
    s_lshl_b32 s62, s100, 9
    s_add_u32 s62, s62, 88128
    v_lshl_add_u32 v7, v0, 3, s62
    s_mov_b32 s48, s4
    s_mov_b32 s49, s5
    s_mov_b32 s50, 5120
    s_mov_b32 s51, 0x20000
    buffer_load_dwordx4 v[8:11], v5, s[48:51], 0 offen
    s_mov_b32 s62, 20480
    s_mov_b32 s63, 30720
    s_branch L_poll_9
L_poll_9s:
    s_sleep 8
L_poll_9:
    buffer_load_dwordx4 v[12:15], v5, s[40:43], s62 offen sc1
    buffer_load_dwordx4 v[16:19], v5, s[40:43], s63 offen sc1
    s_sub_u32 s60, s60, 1
    s_cbranch_scc1 L_poll_9t
    s_waitcnt vmcnt(0)
    v_max3_u32 v38, v12, v13, v14
    v_max3_u32 v38, v38, v15, v16
    v_max3_u32 v38, v38, v17, v18
    v_max_u32 v38, v38, v19
    v_cmp_eq_u32 vcc, -1, v38
    s_cbranch_vccnz L_poll_9s
L_poll_9e:
    v_lshlrev_b32 v40, 16, v8
    v_and_b32 v41, 0xffff0000, v8
    v_lshlrev_b32 v42, 16, v9
    v_and_b32 v43, 0xffff0000, v9
    v_lshlrev_b32 v44, 16, v10
    v_and_b32 v45, 0xffff0000, v10
    v_lshlrev_b32 v46, 16, v11
    v_and_b32 v47, 0xffff0000, v11
    v_lshlrev_b32 v48, 16, v12
    v_and_b32 v49, 0xffff0000, v12
    v_lshlrev_b32 v50, 16, v13
    v_and_b32 v51, 0xffff0000, v13
    v_lshlrev_b32 v52, 16, v14
    v_and_b32 v53, 0xffff0000, v14
    v_lshlrev_b32 v54, 16, v15
    v_and_b32 v55, 0xffff0000, v15
    v_lshlrev_b32 v56, 16, v16
    v_and_b32 v57, 0xffff0000, v16
    v_lshlrev_b32 v58, 16, v17
    v_and_b32 v59, 0xffff0000, v17
    v_lshlrev_b32 v60, 16, v18
    v_and_b32 v61, 0xffff0000, v18
    v_lshlrev_b32 v62, 16, v19
    v_and_b32 v63, 0xffff0000, v19
    v_mov_b32 v64, 0
    v_mov_b32 v65, 0
    v_mov_b32 v66, 0
    v_mov_b32 v67, 0
    v_mov_b32 v68, 0
    v_mov_b32 v69, 0
    v_mov_b32 v70, 0
    v_mov_b32 v71, 0
    v_bfe_u32 v5, v0, 2, 2
    v_lshlrev_b32 v5, 8, v5
    v_lshrrev_b32 v8, 4, v0
    v_lshl_add_u32 v5, v8, 6, v5
    v_and_b32 v8, 3, v0
    v_lshl_add_u32 v5, v8, 4, v5
    s_lshl_b32 s56, s100, 10
    s_waitcnt vmcnt(0) lgkmcnt(0)
    v_mov_b32 v8, 162064
    v_mov_b32 v9, 1
    s_mov_b64 exec, 1
    ds_add_u32 v8, v9
    s_mov_b64 exec, -1
    s_branch L_t2gate
L_ffn2:
    s_barrier
L_ffn2b:
    ds_read_b128 v[8:11], v161
    ds_read_b128 v[12:15], v162
    s_cmp_eq_u32 s61, 1
    s_cbranch_scc0 L_f2slow
    s_waitcnt lgkmcnt(1)
    v_smfmac_f32_16x16x64_bf16 v[16:19], v[8:11], v[80:87], v164
    v_smfmac_f32_16x16x64_bf16 v[20:23], v[8:11], v[96:103], v164
    s_waitcnt lgkmcnt(0)
    v_smfmac_f32_16x16x64_bf16 v[16:19], v[12:15], v[88:95], v164
    v_smfmac_f32_16x16x64_bf16 v[20:23], v[12:15], v[104:111], v164
    v_smfmac_f32_16x16x64_bf16 v[24:27], v[8:11], v[112:119], v164
    v_smfmac_f32_16x16x64_bf16 v[28:31], v[8:11], v[128:135], v164
    v_smfmac_f32_16x16x64_bf16 v[24:27], v[12:15], v[120:127], v164
    v_smfmac_f32_16x16x64_bf16 v[28:31], v[12:15], v[136:143], v164
    v_smfmac_f32_16x16x64_bf16 v[32:35], v[8:11], v[144:151], v164
    v_smfmac_f32_16x16x64_bf16 v[32:35], v[12:15], v[152:159], v164
    s_nop 0
    v_pk_add_f32 v[16:17], v[16:17], v[18:19]
    v_cvt_pk_bf16_f32 v40, v16, v17
    v_pk_add_f32 v[20:21], v[20:21], v[22:23]
    v_cvt_pk_bf16_f32 v41, v20, v21
    buffer_store_dwordx2 v[40:41], v160, s[40:43], s57 offen
    v_pk_add_f32 v[24:25], v[24:25], v[26:27]
    v_cvt_pk_bf16_f32 v42, v24, v25
    v_pk_add_f32 v[28:29], v[28:29], v[30:31]
    v_cvt_pk_bf16_f32 v43, v28, v29
    buffer_store_dwordx2 v[42:43], v160, s[40:43], s57 offen offset:128
    v_pk_add_f32 v[32:33], v[32:33], v[34:35]
    v_cvt_pk_bf16_f32 v44, v32, v33
    buffer_store_dword v44, v163, s[40:43], s57 offen offset:256
L_f2done:
    s_barrier
    s_endpgm
L_f2slow:
    s_waitcnt lgkmcnt(1)
    v_smfmac_f32_16x16x64_bf16 v[16:19], v[8:11], v[80:87], v164
    v_smfmac_f32_16x16x64_bf16 v[20:23], v[8:11], v[96:103], v164
    s_waitcnt lgkmcnt(0)
    v_smfmac_f32_16x16x64_bf16 v[16:19], v[12:15], v[88:95], v164
    v_smfmac_f32_16x16x64_bf16 v[20:23], v[12:15], v[104:111], v164
    v_smfmac_f32_16x16x64_bf16 v[24:27], v[8:11], v[112:119], v164
    v_smfmac_f32_16x16x64_bf16 v[28:31], v[8:11], v[128:135], v164
    v_smfmac_f32_16x16x64_bf16 v[24:27], v[12:15], v[120:127], v164
    v_smfmac_f32_16x16x64_bf16 v[28:31], v[12:15], v[136:143], v164
    v_smfmac_f32_16x16x64_bf16 v[32:35], v[8:11], v[144:151], v164
    v_smfmac_f32_16x16x64_bf16 v[32:35], v[12:15], v[152:159], v164
    s_nop 0
    v_pk_add_f32 v[16:17], v[16:17], v[18:19]
    v_cvt_pk_bf16_f32 v40, v16, v17
    v_pk_add_f32 v[20:21], v[20:21], v[22:23]
    v_cvt_pk_bf16_f32 v41, v20, v21
    buffer_store_dwordx2 v[40:41], v160, s[40:43], s57 offen sc1
    v_pk_add_f32 v[24:25], v[24:25], v[26:27]
    v_cvt_pk_bf16_f32 v42, v24, v25
    v_pk_add_f32 v[28:29], v[28:29], v[30:31]
    v_cvt_pk_bf16_f32 v43, v28, v29
    buffer_store_dwordx2 v[42:43], v160, s[40:43], s57 offen offset:128 sc1
    v_pk_add_f32 v[32:33], v[32:33], v[34:35]
    v_cvt_pk_bf16_f32 v44, v32, v33
    buffer_store_dword v44, v163, s[40:43], s57 offen offset:256 sc1
    s_branch L_f2done
L_poll_3t:
    s_mov_b32 s60, 0
    s_waitcnt vmcnt(0)
    s_branch L_poll_3e
L_poll_8t:
    s_mov_b32 s60, 0
    s_waitcnt vmcnt(0)
    s_branch L_poll_8e
L_poll_9t:
    s_mov_b32 s60, 0
    s_waitcnt vmcnt(0)
    s_branch L_poll_9e
L_poll_101t:
    s_mov_b32 s60, 0
    s_waitcnt vmcnt(0)
    s_branch L_poll_101e
L_pfast:
    buffer_store_dword v12, v108, s[40:43], s101 offen
    buffer_store_dword v12, v110, s[40:43], s101 offen
    s_branch L_pdone
L_poll_103t:
    s_mov_b32 s60, 0
    s_waitcnt vmcnt(0)
    s_branch L_poll_103e
L_poll_106t:
    s_mov_b32 s60, 0
    s_waitcnt vmcnt(0)
    s_branch L_poll_106e
L_poll_108t:
    s_mov_b32 s60, 0
    s_waitcnt vmcnt(0)
    s_branch L_poll_108e
L_poll_112t:
    s_mov_b32 s60, 0
    s_waitcnt vmcnt(0)
    s_branch L_poll_112e
L_poll_114t:
    s_mov_b32 s60, 0
    s_waitcnt vmcnt(0)
    s_branch L_poll_114e
L_ycs:
    buffer_store_dwordx4 v[24:27], v22, s[40:43], 0 offen offset:0 sc1
    buffer_store_dwordx4 v[24:27], v22, s[40:43], 0 offen offset:1024 sc1
    buffer_store_dwordx4 v[24:27], v22, s[40:43], 0 offen offset:2048 sc1
    buffer_store_dwordx4 v[24:27], v22, s[40:43], 0 offen offset:3072 sc1
    buffer_store_dwordx4 v[24:27], v23, s[40:43], 0 offen offset:0 sc1
    s_branch L_ycd
L_poll_115t:
    s_mov_b32 s60, 0
    s_waitcnt vmcnt(0)
    s_branch L_poll_115e
L_poll_120t:
    s_mov_b32 s60, 0
    s_waitcnt vmcnt(0)
    s_branch L_poll_120e
L_poll_122t:
    s_mov_b32 s60, 0
    s_waitcnt vmcnt(0)
    s_branch L_poll_122e
L_ygt:
    s_waitcnt vmcnt(0)
    s_branch L_ygd
L_pto:
    s_mov_b32 s60, 0
    s_waitcnt vmcnt(0)
    s_branch L_pgot0
L_poll_126t:
    s_mov_b32 s60, 0
    s_waitcnt vmcnt(0)
    s_branch L_poll_126e
L_end:
    s_endpgm
L_codeend:
.section .rodata,"a"
.p2align 6
.amdhsa_kernel adaLN_cond__sliding_block_cached__dense_activation_gelu__decode_kernel
  .amdhsa_next_free_vgpr 168
  .amdhsa_next_free_sgpr 102
  .amdhsa_accum_offset 168
  .amdhsa_group_segment_fixed_size 0
  .amdhsa_kernarg_size 120
  .amdhsa_user_sgpr_count 2
  .amdhsa_user_sgpr_kernarg_segment_ptr 1
  .amdhsa_system_sgpr_workgroup_id_x 1
.end_amdhsa_kernel
```

```asm
; @launch grid=(256,1,1) block=(768,1,1) lds=162176
.amdgcn_target "amdgcn-amd-amdhsa--gfx950"
.text
.globl adaLN_cond__sliding_block_cached__dense_activation_gelu__decode_kernel
.p2align 8
.type adaLN_cond__sliding_block_cached__dense_activation_gelu__decode_kernel,@function
adaLN_cond__sliding_block_cached__dense_activation_gelu__decode_kernel:
    s_load_dwordx16 s[4:19], s[0:1], 0
    s_load_dwordx8 s[20:27], s[0:1], 64
    s_load_dwordx4 s[28:31], s[0:1], 96
    s_load_dwordx2 s[32:33], s[0:1], 112
    s_cmp_ge_u32 s2, 256
    s_cbranch_scc1 L_end
    v_lshrrev_b32 v1, 6, v0
    v_mul_u32_u24 v2, 36, v0
    v_readfirstlane_b32 s3, v1
    v_and_b32 v0, 63, v0
    s_and_b32 s34, s2, 7
    s_lshr_b32 s35, s2, 3
    s_cmp_lg_u32 s35, 21
    s_cbranch_scc1 L_nopf
    s_getpc_b64 s[48:49]
L_pc:
    v_min_u32 v2, L_codeend-L_pc-4, v2
    v_mov_b32 v3, s49
    v_add_co_u32 v2, vcc, s48, v2
    s_nop 1
    v_addc_co_u32 v3, vcc, 0, v3, vcc
    global_load_dword v152, v[2:3], off
L_nopf:
    s_lshr_b32 s36, s35, 3
    s_lshl2_add_u32 s36, s34, s36
    s_bfe_u32 s37, s35, 0x20001
    s_and_b32 s38, s35, 1
    s_cmp_lt_u32 s35, 27
    s_cselect_b32 s39, 1, 0
    s_cmp_eq_u32 s34, 2
    s_cselect_b32 s39, s39, 0
    s_sub_u32 s62, s34, 3
    s_and_b32 s62, s62, 7
    s_mul_i32 s56, s35, 7
    s_add_u32 s56, s56, s62
    s_cmp_eq_u32 s62, 7
    s_cselect_b32 s56, 255, s56
    s_mov_b32 s60, 1000000
    s_mov_b32 s61, 0
    v_mov_b32 v36, 0
    s_cmp_lt_u32 s3, 4
    s_cbranch_scc1 L_helpers
    s_sub_u32 s3, s3, 4
    s_cmp_ge_u32 s35, 22
    s_cselect_b32 s59, 1, 0
    s_add_u32 s62, s3, s59
    s_cmp_ge_u32 s62, 6
    s_cselect_b32 s62, s39, 0
    s_cmp_eq_u32 s62, 1
    s_cbranch_scc1 L_proxy
    s_cmp_eq_u32 s59, 1
    s_cselect_b32 s100, 0, 81920
    s_lshl_b32 s62, s3, 13
    s_add_u32 s100, s100, s62
    s_and_b32 s62, s39, s59
    s_cselect_b32 s100, -1, s100
    s_mov_b32 s101, 0
L_stream:
    s_lshl_b32 s62, s37, 5
    s_add_u32 s62, s62, s36
    s_lshl_b32 s63, s62, 21
    s_lshl_b32 s96, s38, 18
    s_add_u32 s63, s63, s96
    s_add_u32 s63, s63, 1572864
    v_lshlrev_b32 v1, 4, v0
    s_lshl_b32 s96, s3, 12
    v_add_u32 v1, s96, v1
    s_mov_b32 s97, 0
    s_mov_b32 s50, 262144
    s_mov_b32 s51, 0x20000
    s_waitcnt lgkmcnt(0)
    s_add_u32 s48, s6, s63
    s_addc_u32 s49, s7, 0
    s_cmp_lt_u32 s56, 40
    s_cbranch_scc0 L_nob0
    s_barrier
L_nob0:
    buffer_load_dwordx4 v[40:43], v1, s[48:51], s97 offen offset:0 nt
    buffer_load_dwordx4 v[44:47], v1, s[48:51], s97 offen offset:1024 nt
    s_cmp_lt_u32 s56, 40
    s_cbranch_scc1 L_stream2
    s_barrier
    s_branch L_stream2
L_helpers:
    s_cmp_lg_u32 s3, 0
    s_cbranch_scc1 L_noinit
    v_lshlrev_b32 v1, 2, v0
    v_add_u32 v1, 161920, v1
    ds_write_b32 v1, v36
L_noinit:
    s_waitcnt lgkmcnt(0)
    s_mov_b32 s40, s32
    s_mov_b32 s41, s33
    s_mov_b32 s42, 589824
    s_mov_b32 s43, 0x20000
    s_mov_b32 s44, s30
    s_mov_b32 s45, s31
    s_mov_b32 s46, 256
    s_mov_b32 s47, 0x20000
    s_lshl2_add_u32 s62, s35, s3
    s_cmp_eq_u32 s62, 87
    s_cbranch_scc1 L_touch
L_notp:
    s_mul_i32 s101, s3, 20480
    s_mov_b32 s96, s56
    s_cmp_lt_u32 s56, 40
    s_cbranch_scc0 L_nothalf
    s_cmp_lt_u32 s3, 2
    s_cbranch_scc1 L_unit
    s_add_u32 s62, s56, 20
    s_cmp_eq_u32 s3, 2
    s_cbranch_scc1 L_job
    s_barrier
    s_branch L_service
L_nothalf:
    s_cmp_lt_u32 s56, 144
    s_cbranch_scc1 L_unit
    s_sub_u32 s62, s56, 144
    s_cmp_lt_u32 s62, 10
    s_cbranch_scc0 L_nojob
    s_cmp_lt_u32 s3, 2
    s_cbranch_scc0 L_nojob
    s_mul_i32 s63, s3, 10
    s_add_u32 s62, s62, s63
L_job:
    s_cmp_lt_u32 s62, 59
    s_cbranch_scc0 L_end
    s_mov_b32 s100, s101
    s_lshl_b32 s101, s62, 9
    s_add_u32 s101, s101, 172032
    s_cmp_lt_u32 s62, 27
    s_cselect_b32 s63, 0, 27
    s_cselect_b32 s3, 7, 6
    s_cmp_lt_u32 s62, 54
    s_cselect_b32 s63, s63, 32
    s_cselect_b32 s3, s3, 5
    s_sub_u32 s35, s62, s63
    s_mov_b32 s34, 2
    s_lshr_b32 s36, s35, 3
    s_add_u32 s36, s36, 8
    s_bfe_u32 s37, s35, 0x20001
    s_and_b32 s38, s35, 1
    s_mov_b32 s59, 0
    s_branch L_stream
L_nojob:
    s_barrier
    s_cmp_ge_u32 s35, 22
    s_cbranch_scc1 L_h_t1
    s_cmp_eq_u32 s39, 1
    s_cbranch_scc1 L_h_role
    s_cmp_lt_u32 s96, 144
    s_cbranch_scc1 L_unit
    s_cmp_eq_u32 s3, 3
    s_cbranch_scc1 L_service
    s_endpgm
L_unit:
    v_lshrrev_b32 v3, 4, v0
    v_and_b32 v4, 3, v0
    v_bfe_u32 v7, v0, 2, 2
    s_mov_b32 s14, s3
    s_mov_b32 s15, 3
    s_sub_u32 s62, s96, 40
    s_cmp_lt_u32 s62, 64
    s_cbranch_scc1 L_u_q
    s_mov_b32 s100, 1
    s_sub_u32 s96, s96, 84
    s_cmp_lt_u32 s56, 40
    s_cbranch_scc0 L_u_full
    s_mov_b32 s100, 0
    s_lshr_b32 s96, s56, 1
    s_and_b32 s62, s56, 1
    s_lshl1_add_u32 s14, s62, s14
    s_mov_b32 s15, 1
L_u_full:
    s_mov_b32 s97, 0
    s_mov_b32 s99, 7680
    s_mov_b32 s48, s26
    s_mov_b32 s49, s27
    s_mov_b32 s50, 4915200
    s_mov_b32 s51, 0x20000
    s_mov_b32 s52, s24
    s_mov_b32 s53, s25
    s_mov_b32 s54, 5120
    s_mov_b32 s55, 0x20000
    v_and_b32 v6, 15, v0
    v_lshlrev_b32 v6, 4, v6
    v_mul_u32_u24 v5, 1280, v3
    v_add_u32 v5, v5, v6
    s_mul_i32 s62, s14, 320
    buffer_load_dwordx4 v[8:11], v5, s[52:55], s62 offen
    s_mov_b32 exec_lo, 0x000f000f
    s_mov_b32 exec_hi, 0x000f000f
    buffer_load_dwordx4 v[12:15], v5, s[52:55], s62 offen offset:256
    s_mov_b64 exec, -1
    s_lshl_b32 s98, s96, 7
    s_mul_i32 s13, s96, 0x199a
    s_lshr_b32 s13, s13, 16
    s_cmp_lg_u32 s13, 1
    s_cbranch_scc1 L_u_go
    s_mov_b32 s52, s4
    s_mov_b32 s53, s5
    s_mov_b32 s54, 5120
    s_mov_b32 s55, 0x20000
    v_mul_u32_u24 v5, 1280, v4
    v_lshlrev_b32 v64, 5, v7
    v_lshl_add_u32 v64, v3, 3, v64
    v_add_u32 v64, v64, v5
    v_lshrrev_b32 v6, 2, v0
    v_lshl_add_u32 v6, v6, 4, v5
    s_sub_u32 s62, s98, 1280
    buffer_load_dwordx4 v[16:19], v6, s[52:55], 0 offen offset:0
    buffer_load_dwordx4 v[20:23], v6, s[52:55], 0 offen offset:256
    buffer_load_dwordx4 v[24:27], v6, s[52:55], 0 offen offset:512
    buffer_load_dwordx4 v[28:31], v6, s[52:55], 0 offen offset:768
    buffer_load_dwordx4 v[32:35], v6, s[52:55], 0 offen offset:1024
    buffer_load_dwordx2 v[66:67], v64, s[52:55], s62 offen
    s_branch L_u_go
L_u_q:
    s_mov_b32 s97, 1
    s_mov_b32 s99, 8192
    s_mov_b32 s100, 2
    s_lshl_b32 s98, s62, 7
    s_mov_b32 s48, s10
    s_mov_b32 s49, s11
    s_mov_b32 s50, 5242880
    s_mov_b32 s51, 0x20000
L_u_go:
    v_lshrrev_b32 v6, 3, v0
    v_mul_lo_u32 v1, v6, s99
    v_and_b32 v6, 2, v6
    v_xor_b32 v6, v6, v0
    v_and_b32 v6, 7, v6
    v_lshl_add_u32 v1, v6, 4, v1
    v_add_u32 v1, s98, v1
    v_xor_b32 v2, 64, v1
    s_mul_i32 s63, s99, s14
    s_mul_i32 s63, s63, 160
    s_lshl_b32 s59, s99, 3
    s_mov_b32 m0, s101
    s_mov_b32 s62, 10
L_dma_1:
    buffer_load_dwordx4 v1, s[48:51], s63 offen nt lds
    s_add_u32 m0, m0, 1024
    s_add_u32 s63, s63, s59
    s_cmp_eq_u32 s100, 0
    s_cbranch_scc1 L_dma_1n0
    s_waitcnt vmcnt(5)
    s_cmp_eq_u32 s100, 2
    s_cbranch_scc1 L_dma_1n0
    s_waitcnt vmcnt(5)
L_dma_1n0:
    buffer_load_dwordx4 v2, s[48:51], s63 offen nt lds
    s_add_u32 m0, m0, 1024
    s_add_u32 s63, s63, s59
    s_cmp_eq_u32 s100, 0
    s_cbranch_scc1 L_dma_1n1
    s_waitcnt vmcnt(5)
    s_cmp_eq_u32 s100, 2
    s_cbranch_scc1 L_dma_1n1
    s_waitcnt vmcnt(5)
L_dma_1n1:
    s_sub_u32 s62, s62, 1
    s_cmp_lg_u32 s62, 0
    s_cbranch_scc1 L_dma_1
    v_min_u32 v65, 15, v0
    v_and_b32 v6, 1, v65
    v_mul_u32_u24 v6, 126, v6
    v_lshl_add_u32 v65, v65, 1, v6
    v_mov_b32 v68, 0
    s_cmp_lt_u32 s56, 40
    s_cbranch_scc1 L_u_nofl
    buffer_load_dword v68, v65, s[44:47], 0 offen sc1
L_u_nofl:
    s_cmp_lt_u32 s56, 144
    s_cbranch_scc0 L_u_nob
    s_barrier
L_u_nob:
    v_lshrrev_b32 v60, 4, v0
    v_lshlrev_b32 v60, 10, v60
    v_bfe_u32 v6, v0, 2, 2
    v_lshl_add_u32 v60, v6, 7, v60
    v_and_b32 v6, 3, v0
    v_lshl_add_u32 v60, v6, 3, v60
    v_bfe_u32 v6, v0, 3, 2
    v_lshl_add_u32 v60, v6, 5, v60
    v_xor_b32 v61, 32, v60
    v_xor_b32 v62, 64, v60
    v_xor_b32 v63, 0x60, v60
    v_add_u32 v60, s101, v60
    v_add_u32 v61, s101, v61
    v_add_u32 v62, s101, v62
    v_add_u32 v63, s101, v63
    v_mov_b32 v56, 1.0
    v_mov_b32 v57, 1.0
    v_mov_b32 v58, 1.0
    v_mov_b32 v59, 1.0
    s_mov_b32 s58, 0
    v_lshl_add_u32 v69, v7, 2, v3
    v_lshl_add_u32 v69, v4, 4, v69
    v_and_b32 v64, 15, v0
    v_lshlrev_b32 v64, 3, v64
    s_cmp_eq_u32 s97, 1
    s_cbranch_scc1 L_u_q2
    v_mul_u32_u24 v6, 1280, v3
    v_add_u32 v64, v64, v6
    s_mul_i32 s63, s13, 3840
    s_add_u32 s57, s98, s63
    s_add_u32 s57, s57, 10240
    s_cmp_lt_u32 s56, 40
    s_cbranch_scc0 L_u_nat
    v_lshrrev_b32 v69, 1, v3
    v_lshlrev_b32 v69, 3, v69
    v_lshl_add_u32 v69, v7, 4, v69
    v_lshl_add_u32 v69, v4, 1, v69
    v_and_b32 v6, 1, v3
    v_add_u32 v69, v69, v6
    s_lshr_b32 s62, s56, 1
    s_lshl_b32 s57, s62, 11
    s_cmp_ge_u32 s62, 10
    s_cselect_b32 s62, -19968, 0
    s_add_u32 s57, s57, s62
    s_and_b32 s62, s56, 1
    s_lshl_b32 s62, s62, 8
    s_add_u32 s57, s57, s62
    v_lshrrev_b32 v64, 5, v0
    v_lshlrev_b32 v64, 10, v64
    v_and_b32 v6, 31, v0
    v_lshl_add_u32 v64, v6, 3, v64
L_u_nat:
    s_cmp_eq_u32 s13, 4
    s_cselect_b32 s58, 1.0, 0
    s_cmp_eq_u32 s13, 1
    s_cselect_b32 s58, 1.0, s58
    s_cselect_b32 s56, 1, 0
    s_cmp_eq_u32 s14, 0
    s_cselect_b32 s58, s58, 0
    s_waitcnt vmcnt(20)
    s_mov_b32 s62, 0xbfb8aa3b
    v_lshlrev_b32 v40, 16, v8
    v_and_b32 v41, 0xffff0000, v8
    v_lshlrev_b32 v42, 16, v9
    v_and_b32 v43, 0xffff0000, v9
    v_lshlrev_b32 v44, 16, v10
    v_and_b32 v45, 0xffff0000, v10
    v_lshlrev_b32 v46, 16, v11
    v_and_b32 v47, 0xffff0000, v11
    v_mul_f32 v48, s62, v40
    v_mul_f32 v49, s62, v41
    v_mul_f32 v50, s62, v42
    v_mul_f32 v51, s62, v43
    v_mul_f32 v52, s62, v44
    v_mul_f32 v53, s62, v45
    v_mul_f32 v54, s62, v46
    v_mul_f32 v55, s62, v47
    v_exp_f32 v48, v48
    v_exp_f32 v49, v49
    v_exp_f32 v50, v50
    v_exp_f32 v51, v51
    v_exp_f32 v52, v52
    v_exp_f32 v53, v53
    v_exp_f32 v54, v54
    v_exp_f32 v55, v55
    v_add_f32 v48, 1.0, v48
    v_add_f32 v49, 1.0, v49
    v_add_f32 v50, 1.0, v50
    v_add_f32 v51, 1.0, v51
    v_add_f32 v52, 1.0, v52
    v_add_f32 v53, 1.0, v53
    v_add_f32 v54, 1.0, v54
    v_add_f32 v55, 1.0, v55
    v_rcp_f32 v48, v48
    v_rcp_f32 v49, v49
    v_rcp_f32 v50, v50
    v_rcp_f32 v51, v51
    v_rcp_f32 v52, v52
    v_rcp_f32 v53, v53
    v_rcp_f32 v54, v54
    v_rcp_f32 v55, v55
    v_mul_f32 v40, v40, v48
    v_mul_f32 v41, v41, v49
    v_mul_f32 v42, v42, v50
    v_mul_f32 v43, v43, v51
    v_mul_f32 v44, v44, v52
    v_mul_f32 v45, v45, v53
    v_mul_f32 v46, v46, v54
    v_mul_f32 v47, v47, v55
    v_cvt_pk_bf16_f32 v8, v40, v41
    v_cvt_pk_bf16_f32 v9, v42, v43
    v_cvt_pk_bf16_f32 v10, v44, v45
    v_cvt_pk_bf16_f32 v11, v46, v47
    v_lshlrev_b32 v40, 16, v12
    v_and_b32 v41, 0xffff0000, v12
    v_lshlrev_b32 v42, 16, v13
    v_and_b32 v43, 0xffff0000, v13
    v_lshlrev_b32 v44, 16, v14
    v_and_b32 v45, 0xffff0000, v14
    v_lshlrev_b32 v46, 16, v15
    v_and_b32 v47, 0xffff0000, v15
    v_mul_f32 v48, s62, v40
    v_mul_f32 v49, s62, v41
    v_mul_f32 v50, s62, v42
    v_mul_f32 v51, s62, v43
    v_mul_f32 v52, s62, v44
    v_mul_f32 v53, s62, v45
    v_mul_f32 v54, s62, v46
    v_mul_f32 v55, s62, v47
    v_exp_f32 v48, v48
    v_exp_f32 v49, v49
    v_exp_f32 v50, v50
    v_exp_f32 v51, v51
    v_exp_f32 v52, v52
    v_exp_f32 v53, v53
    v_exp_f32 v54, v54
    v_exp_f32 v55, v55
    v_add_f32 v48, 1.0, v48
    v_add_f32 v49, 1.0, v49
    v_add_f32 v50, 1.0, v50
    v_add_f32 v51, 1.0, v51
    v_add_f32 v52, 1.0, v52
    v_add_f32 v53, 1.0, v53
    v_add_f32 v54, 1.0, v54
    v_add_f32 v55, 1.0, v55
    v_rcp_f32 v48, v48
    v_rcp_f32 v49, v49
    v_rcp_f32 v50, v50
    v_rcp_f32 v51, v51
    v_rcp_f32 v52, v52
    v_rcp_f32 v53, v53
    v_rcp_f32 v54, v54
    v_rcp_f32 v55, v55
    v_mul_f32 v40, v40, v48
    v_mul_f32 v41, v41, v49
    v_mul_f32 v42, v42, v50
    v_mul_f32 v43, v43, v51
    v_mul_f32 v44, v44, v52
    v_mul_f32 v45, v45, v53
    v_mul_f32 v46, v46, v54
    v_mul_f32 v47, v47, v55
    v_cvt_pk_bf16_f32 v12, v40, v41
    v_cvt_pk_bf16_f32 v13, v42, v43
    v_cvt_pk_bf16_f32 v14, v44, v45
    v_cvt_pk_bf16_f32 v15, v46, v47
    s_mul_i32 s62, s3, 1344
    s_add_u32 s62, s62, 151552
    v_mul_u32_u24 v5, 336, v3
    v_and_b32 v6, 15, v0
    v_lshl_add_u32 v5, v6, 4, v5
    v_add_u32 v5, s62, v5
    ds_write_b128 v5, v[8:11]
    s_mov_b32 exec_lo, 0x000f000f
    s_mov_b32 exec_hi, 0x000f000f
    ds_write_b128 v5, v[12:15] offset:256
    s_mov_b64 exec, -1
    v_mul_u32_u24 v5, 336, v4
    v_lshl_add_u32 v5, v3, 4, v5
    v_add_u32 v5, s62, v5
    s_mov_b32 s59, 0x3e800000
    s_cmp_eq_u32 s56, 0
    s_cbranch_scc1 L_u_nost
    v_mov_b32 v40, 0
    v_mov_b32 v41, 0
    s_mov_b32 s62, 0x3f803f80
    v_dot2c_f32_bf16 v40, s62, v16
    v_dot2c_f32_bf16 v41, v16, v16
    v_dot2c_f32_bf16 v40, s62, v17
    v_dot2c_f32_bf16 v41, v17, v17
    v_dot2c_f32_bf16 v40, s62, v18
    v_dot2c_f32_bf16 v41, v18, v18
    v_dot2c_f32_bf16 v40, s62, v19
    v_dot2c_f32_bf16 v41, v19, v19
    v_dot2c_f32_bf16 v40, s62, v20
    v_dot2c_f32_bf16 v41, v20, v20
    v_dot2c_f32_bf16 v40, s62, v21
    v_dot2c_f32_bf16 v41, v21, v21
    v_dot2c_f32_bf16 v40, s62, v22
    v_dot2c_f32_bf16 v41, v22, v22
    v_dot2c_f32_bf16 v40, s62, v23
    v_dot2c_f32_bf16 v41, v23, v23
    v_dot2c_f32_bf16 v40, s62, v24
    v_dot2c_f32_bf16 v41, v24, v24
    v_dot2c_f32_bf16 v40, s62, v25
    v_dot2c_f32_bf16 v41, v25, v25
    v_dot2c_f32_bf16 v40, s62, v26
    v_dot2c_f32_bf16 v41, v26, v26
    v_dot2c_f32_bf16 v40, s62, v27
    v_dot2c_f32_bf16 v41, v27, v27
    v_dot2c_f32_bf16 v40, s62, v28
    v_dot2c_f32_bf16 v41, v28, v28
    v_dot2c_f32_bf16 v40, s62, v29
    v_dot2c_f32_bf16 v41, v29, v29
    v_dot2c_f32_bf16 v40, s62, v30
    v_dot2c_f32_bf16 v41, v30, v30
    v_dot2c_f32_bf16 v40, s62, v31
    v_dot2c_f32_bf16 v41, v31, v31
    v_dot2c_f32_bf16 v40, s62, v32
    v_dot2c_f32_bf16 v41, v32, v32
    v_dot2c_f32_bf16 v40, s62, v33
    v_dot2c_f32_bf16 v41, v33, v33
    v_dot2c_f32_bf16 v40, s62, v34
    v_dot2c_f32_bf16 v41, v34, v34
    v_dot2c_f32_bf16 v40, s62, v35
    v_dot2c_f32_bf16 v41, v35, v35
    s_nop 1
    v_add_f32_dpp v40, v40, v40 row_ror:4 row_mask:0xf bank_mask:0xf
    v_add_f32_dpp v41, v41, v41 row_ror:4 row_mask:0xf bank_mask:0xf
    s_nop 0
    v_add_f32_dpp v40, v40, v40 row_ror:8 row_mask:0xf bank_mask:0xf
    v_add_f32_dpp v41, v41, v41 row_ror:8 row_mask:0xf bank_mask:0xf
    v_mov_b32 v42, v40
    v_mov_b32 v43, v41
    s_nop 0
    v_permlane16_swap_b32 v40, v42
    v_permlane16_swap_b32 v41, v43
    v_add_f32 v40, v40, v42
    v_add_f32 v41, v41, v43
    v_mov_b32 v42, v40
    v_mov_b32 v43, v41
    s_nop 0
    v_permlane32_swap_b32 v40, v42
    v_permlane32_swap_b32 v41, v43
    v_add_f32 v40, v40, v42
    v_add_f32 v41, v41, v43
    s_mov_b32 s62, 0x3acccccd
    v_mul_f32 v40, s62, v40
    v_mul_f32 v41, s62, v41
    v_fma_f32 v41, -v40, v40, v41
    v_max_f32 v41, 0, v41
    v_add_f32 v41, 0x3727c5ac, v41
    v_rsq_f32 v41, v41
    v_lshlrev_b32 v56, 16, v66
    v_and_b32 v57, 0xffff0000, v66
    v_lshlrev_b32 v58, 16, v67
    v_and_b32 v59, 0xffff0000, v67
    v_sub_f32 v56, v56, v40
    v_sub_f32 v57, v57, v40
    v_sub_f32 v58, v58, v40
    v_sub_f32 v59, v59, v40
    v_mul_f32 v56, v56, v41
    v_mul_f32 v57, v57, v41
    v_mul_f32 v58, v58, v41
    v_mul_f32 v59, v59, v41
L_u_nost:
    ds_read_b128 v[8:11], v5 offset:0
    ds_read_b128 v[12:15], v5 offset:64
    ds_read_b128 v[16:19], v5 offset:128
    ds_read_b128 v[20:23], v5 offset:192
    ds_read_b128 v[24:27], v5 offset:256
    s_branch L_u_frag
L_u_q2:
    v_lshl_add_u32 v64, v3, 13, v64
    s_add_u32 s57, s98, 40960
    v_lshlrev_b32 v5, 8, v7
    v_lshl_add_u32 v5, v3, 6, v5
    v_lshl_add_u32 v5, v4, 4, v5
    s_mul_i32 s63, s3, 5120
    s_add_u32 s63, s63, 0
    s_add_u32 s12, s63, 4096
    s_mov_b32 s59, 1.0
L_u_frag:
    s_waitcnt vmcnt(0)
    v_cmp_ne_u32 vcc, -1, v68
    s_cbranch_vccz L_u_yok
    s_cmp_eq_u32 s97, 1
    s_cbranch_scc1 L_u_ywait
    buffer_load_dword v68, v65, s[44:47], 0 offen sc1
    s_branch L_u_yok
L_u_ywait:
L_wy_2:
    buffer_load_dword v68, v65, s[44:47], 0 offen sc1
    s_waitcnt vmcnt(0)
    v_cmp_ne_u32 vcc, -1, v68
    s_cbranch_vccz L_wy_2e
    s_sleep 4
    s_sub_u32 s60, s60, 1
    s_cbranch_scc0 L_wy_2
    s_mov_b32 s60, 0
L_wy_2e:
L_u_yok:
    ds_read_b64_tr_b16 v[80:81], v60 offset:0
    ds_read_b64_tr_b16 v[82:83], v60 offset:512
    ds_read_b64_tr_b16 v[84:85], v61 offset:0
    ds_read_b64_tr_b16 v[86:87], v61 offset:512
    ds_read_b64_tr_b16 v[88:89], v62 offset:0
    ds_read_b64_tr_b16 v[90:91], v62 offset:512
    ds_read_b64_tr_b16 v[92:93], v63 offset:0
    ds_read_b64_tr_b16 v[94:95], v63 offset:512
    ds_read_b64_tr_b16 v[96:97], v60 offset:4096
    ds_read_b64_tr_b16 v[98:99], v60 offset:4608
    ds_read_b64_tr_b16 v[100:101], v61 offset:4096
    ds_read_b64_tr_b16 v[102:103], v61 offset:4608
    ds_read_b64_tr_b16 v[104:105], v62 offset:4096
    ds_read_b64_tr_b16 v[106:107], v62 offset:4608
    ds_read_b64_tr_b16 v[108:109], v63 offset:4096
    ds_read_b64_tr_b16 v[110:111], v63 offset:4608
    ds_read_b64_tr_b16 v[112:113], v60 offset:8192
    ds_read_b64_tr_b16 v[114:115], v60 offset:8704
    ds_read_b64_tr_b16 v[116:117], v61 offset:8192
    ds_read_b64_tr_b16 v[118:119], v61 offset:8704
    ds_read_b64_tr_b16 v[120:121], v62 offset:8192
    ds_read_b64_tr_b16 v[122:123], v62 offset:8704
    ds_read_b64_tr_b16 v[124:125], v63 offset:8192
    ds_read_b64_tr_b16 v[126:127], v63 offset:8704
    ds_read_b64_tr_b16 v[128:129], v60 offset:12288
    ds_read_b64_tr_b16 v[130:131], v60 offset:12800
    ds_read_b64_tr_b16 v[132:133], v61 offset:12288
    ds_read_b64_tr_b16 v[134:135], v61 offset:12800
    ds_read_b64_tr_b16 v[136:137], v62 offset:12288
    ds_read_b64_tr_b16 v[138:139], v62 offset:12800
    ds_read_b64_tr_b16 v[140:141], v63 offset:12288
    ds_read_b64_tr_b16 v[142:143], v63 offset:12800
    ds_read_b64_tr_b16 v[144:145], v60 offset:16384
    ds_read_b64_tr_b16 v[146:147], v60 offset:16896
    ds_read_b64_tr_b16 v[148:149], v61 offset:16384
    ds_read_b64_tr_b16 v[150:151], v61 offset:16896
    ds_read_b64_tr_b16 v[152:153], v62 offset:16384
    ds_read_b64_tr_b16 v[154:155], v62 offset:16896
    ds_read_b64_tr_b16 v[156:157], v63 offset:16384
    ds_read_b64_tr_b16 v[158:159], v63 offset:16896
    s_cmp_eq_u32 s97, 0
    s_cbranch_scc1 L_u_mm
    s_branch L_poll_3
L_poll_3s:
    s_sleep 8
L_poll_3:
    buffer_load_dwordx4 v[8:11], v5, s[40:43], s63 offen offset:0 sc1
    buffer_load_dwordx4 v[12:15], v5, s[40:43], s63 offen offset:1024 sc1
    buffer_load_dwordx4 v[16:19], v5, s[40:43], s63 offen offset:2048 sc1
    buffer_load_dwordx4 v[20:23], v5, s[40:43], s63 offen offset:3072 sc1
    buffer_load_dwordx4 v[24:27], v5, s[40:43], s12 offen offset:0 sc1
    s_sub_u32 s60, s60, 1
    s_cbranch_scc1 L_poll_3t
    s_waitcnt vmcnt(0)
    v_max3_u32 v37, v8, v9, v10
    v_max3_u32 v37, v37, v11, v12
    v_max3_u32 v37, v37, v13, v14
    v_max3_u32 v37, v37, v15, v16
    v_max3_u32 v37, v37, v17, v18
    v_max3_u32 v37, v37, v19, v20
    v_max3_u32 v37, v37, v21, v22
    v_max3_u32 v37, v37, v23, v24
    v_max3_u32 v37, v37, v25, v26
    v_max_u32 v37, v37, v27
    v_cmp_eq_u32 vcc, -1, v37
    s_cbranch_vccnz L_poll_3s
L_poll_3e:
L_u_got:
L_u_mm:
    s_waitcnt lgkmcnt(0)
    v_mfma_f32_16x16x32_bf16 v[40:43], v[80:83], v[8:11], 0
    v_mfma_f32_16x16x32_bf16 v[44:47], v[84:87], v[8:11], 0
    v_mfma_f32_16x16x32_bf16 v[48:51], v[88:91], v[8:11], 0
    v_mfma_f32_16x16x32_bf16 v[52:55], v[92:95], v[8:11], 0
    v_mfma_f32_16x16x32_bf16 v[40:43], v[96:99], v[12:15], v[40:43]
    v_mfma_f32_16x16x32_bf16 v[44:47], v[100:103], v[12:15], v[44:47]
    v_mfma_f32_16x16x32_bf16 v[48:51], v[104:107], v[12:15], v[48:51]
    v_mfma_f32_16x16x32_bf16 v[52:55], v[108:111], v[12:15], v[52:55]
    v_mfma_f32_16x16x32_bf16 v[40:43], v[112:115], v[16:19], v[40:43]
    v_mfma_f32_16x16x32_bf16 v[44:47], v[116:119], v[16:19], v[44:47]
    v_mfma_f32_16x16x32_bf16 v[48:51], v[120:123], v[16:19], v[48:51]
    v_mfma_f32_16x16x32_bf16 v[52:55], v[124:127], v[16:19], v[52:55]
    v_mfma_f32_16x16x32_bf16 v[40:43], v[128:131], v[20:23], v[40:43]
    v_mfma_f32_16x16x32_bf16 v[44:47], v[132:135], v[20:23], v[44:47]
    v_mfma_f32_16x16x32_bf16 v[48:51], v[136:139], v[20:23], v[48:51]
    v_mfma_f32_16x16x32_bf16 v[52:55], v[140:143], v[20:23], v[52:55]
    v_mfma_f32_16x16x32_bf16 v[40:43], v[144:147], v[24:27], v[40:43]
    v_mfma_f32_16x16x32_bf16 v[44:47], v[148:151], v[24:27], v[44:47]
    v_mfma_f32_16x16x32_bf16 v[48:51], v[152:155], v[24:27], v[48:51]
    v_mfma_f32_16x16x32_bf16 v[52:55], v[156:159], v[24:27], v[52:55]
    v_lshlrev_b32 v5, 4, v0
    v_add_u32 v5, 147456, v5
    s_lshl_b32 s62, s3, 10
    s_add_u32 s62, s62, 147456
    v_lshl_add_u32 v6, v69, 4, s62
    v_mov_b32 v24, s58
    v_mov_b32 v32, 162056
    v_mov_b32 v33, 1
    v_add_f32_dpp v40, v40, v40 row_ror:8 row_mask:0xf bank_mask:0xf
    v_add_f32_dpp v41, v41, v41 row_ror:8 row_mask:0xf bank_mask:0xf
    v_add_f32_dpp v42, v42, v42 row_ror:8 row_mask:0xf bank_mask:0xf
    v_add_f32_dpp v43, v43, v43 row_ror:8 row_mask:0xf bank_mask:0xf
    v_add_f32_dpp v44, v44, v44 row_ror:8 row_mask:0xf bank_mask:0xf
    v_add_f32_dpp v45, v45, v45 row_ror:8 row_mask:0xf bank_mask:0xf
    v_add_f32_dpp v46, v46, v46 row_ror:8 row_mask:0xf bank_mask:0xf
    v_add_f32_dpp v47, v47, v47 row_ror:8 row_mask:0xf bank_mask:0xf
    v_add_f32_dpp v48, v48, v48 row_ror:8 row_mask:0xf bank_mask:0xf
    v_add_f32_dpp v49, v49, v49 row_ror:8 row_mask:0xf bank_mask:0xf
    v_add_f32_dpp v50, v50, v50 row_ror:8 row_mask:0xf bank_mask:0xf
    v_add_f32_dpp v51, v51, v51 row_ror:8 row_mask:0xf bank_mask:0xf
    v_add_f32_dpp v52, v52, v52 row_ror:8 row_mask:0xf bank_mask:0xf
    v_add_f32_dpp v53, v53, v53 row_ror:8 row_mask:0xf bank_mask:0xf
    v_add_f32_dpp v54, v54, v54 row_ror:8 row_mask:0xf bank_mask:0xf
    v_add_f32_dpp v55, v55, v55 row_ror:8 row_mask:0xf bank_mask:0xf
    v_add_f32_dpp v28, v40, v40 row_ror:4 row_mask:0xf bank_mask:0x1
    v_add_f32_dpp v29, v41, v41 row_ror:4 row_mask:0xf bank_mask:0x1
    v_add_f32_dpp v30, v42, v42 row_ror:4 row_mask:0xf bank_mask:0x1
    v_add_f32_dpp v31, v43, v43 row_ror:4 row_mask:0xf bank_mask:0x1
    v_add_f32_dpp v28, v44, v44 row_ror:4 row_mask:0xf bank_mask:0x2
    v_add_f32_dpp v29, v45, v45 row_ror:4 row_mask:0xf bank_mask:0x2
    v_add_f32_dpp v30, v46, v46 row_ror:4 row_mask:0xf bank_mask:0x2
    v_add_f32_dpp v31, v47, v47 row_ror:4 row_mask:0xf bank_mask:0x2
    v_add_f32_dpp v28, v48, v48 row_ror:4 row_mask:0xf bank_mask:0x4
    v_add_f32_dpp v29, v49, v49 row_ror:4 row_mask:0xf bank_mask:0x4
    v_add_f32_dpp v30, v50, v50 row_ror:4 row_mask:0xf bank_mask:0x4
    v_add_f32_dpp v31, v51, v51 row_ror:4 row_mask:0xf bank_mask:0x4
    v_add_f32_dpp v28, v52, v52 row_ror:4 row_mask:0xf bank_mask:0x8
    v_add_f32_dpp v29, v53, v53 row_ror:4 row_mask:0xf bank_mask:0x8
    v_add_f32_dpp v30, v54, v54 row_ror:4 row_mask:0xf bank_mask:0x8
    v_add_f32_dpp v31, v55, v55 row_ror:4 row_mask:0xf bank_mask:0x8
    v_fma_f32 v28, v28, s59, v24
    v_fma_f32 v29, v29, s59, v24
    v_fma_f32 v30, v30, s59, v24
    v_fma_f32 v31, v31, s59, v24
    v_mul_f32 v28, v28, v56
    v_mul_f32 v29, v29, v57
    v_mul_f32 v30, v30, v58
    v_mul_f32 v31, v31, v59
    ds_write_b128 v6, v[28:31]
    s_mov_b64 exec, 1
    ds_add_rtn_u32 v34, v32, v33
    s_mov_b64 exec, -1
    ds_read_b128 v[8:11], v5
    ds_read_b128 v[12:15], v5 offset:1024
    ds_read_b128 v[16:19], v5 offset:2048
    ds_read_b128 v[20:23], v5 offset:3072
    s_waitcnt lgkmcnt(0)
    v_readfirstlane_b32 s62, v34
    s_nop 0
    s_cmp_eq_u32 s62, s15
    s_cbranch_scc1 L_u_last
    s_cmp_eq_u32 s62, 1
    s_cbranch_scc1 L_service
    s_endpgm
L_u_last:
    v_add_f32 v8, v8, v12
    v_add_f32 v9, v9, v13
    v_add_f32 v10, v10, v14
    v_add_f32 v11, v11, v15
    s_cmp_eq_u32 s15, 1
    s_cbranch_scc1 L_u_two
    v_add_f32 v16, v16, v20
    v_add_f32 v17, v17, v21
    v_add_f32 v18, v18, v22
    v_add_f32 v19, v19, v23
    v_add_f32 v8, v8, v16
    v_add_f32 v9, v9, v17
    v_add_f32 v10, v10, v18
    v_add_f32 v11, v11, v19
L_u_two:
    v_cvt_pk_bf16_f32 v8, v8, v9
    v_cvt_pk_bf16_f32 v9, v10, v11
    s_waitcnt vmcnt(0)
    v_cmp_ne_u32 vcc, -1, v68
    s_cbranch_vccz L_u_st
L_wy_4:
    buffer_load_dword v68, v65, s[44:47], 0 offen sc1
    s_waitcnt vmcnt(0)
    v_cmp_ne_u32 vcc, -1, v68
    s_cbranch_vccz L_wy_4e
    s_sleep 4
    s_sub_u32 s60, s60, 1
    s_cbranch_scc0 L_wy_4
    s_mov_b32 s60, 0
L_wy_4e:
L_u_st:
    buffer_store_dwordx2 v[8:9], v64, s[40:43], s57 offen sc1
    s_endpgm
L_touch:
    s_load_dword s0, s[32:33], 0
    s_load_dword s0, s[30:31], 0
    s_cmp_eq_u32 s39, 1
    s_cbranch_scc1 L_tpr
    s_mov_b32 s62, 16777216
    s_load_dword s0, s[8:9], s62
    s_mov_b32 s62, 83886080
    s_load_dword s0, s[8:9], s62
    s_mov_b32 s62, 150994944
    s_load_dword s0, s[8:9], s62
    s_mov_b32 s62, 218103808
    s_load_dword s0, s[8:9], s62
    s_branch L_tpv
L_tpr:
    s_load_dword s0, s[20:21], 0
    s_mov_b32 s62, 2211836
    s_load_dword s0, s[20:21], s62
    s_load_dword s0, s[16:17], 0
    s_mov_b32 s62, 2211836
    s_load_dword s0, s[16:17], s62
    s_load_dword s0, s[18:19], 0
    s_load_dword s0, s[22:23], 0
    s_load_dword s0, s[28:29], 0
    s_load_dword s0, s[4:5], 0
L_tpv:
    s_lshl_b32 s62, s34, 23
    s_load_dword s0, s[8:9], s62
    s_add_u32 s62, s62, 67108864
    s_load_dword s0, s[8:9], s62
    s_add_u32 s62, s62, 67108864
    s_load_dword s0, s[8:9], s62
    s_add_u32 s62, s62, 67108864
    s_load_dword s0, s[8:9], s62
    s_add_u32 s62, s62, 67108864
    s_branch L_notp
L_stream2:
    s_mov_b32 s12, s100
    s_mov_b32 s13, s101
    s_andn2_b32 s96, s59, s39
    s_cbranch_scc0 L_noua
    s_barrier
L_noua:
    s_mov_b32 s40, s32
    s_mov_b32 s41, s33
    s_mov_b32 s42, 589824
    s_mov_b32 s43, 0x20000
    s_mov_b32 s44, s30
    s_mov_b32 s45, s31
    s_mov_b32 s46, 256
    s_mov_b32 s47, 0x20000
    s_bitcmp1_b32 s3, 0
    s_mov_b32 s57, 0xffffffff
    s_mov_b32 s58, 0x0
    s_mov_b32 s14, 0xffffffff
    s_mov_b32 s15, 0x0
L_pm_10:
    s_sub_u32 s96, s56, 104
    s_cmp_lt_u32 s96, 66
    s_cbranch_scc0 L_pm_11
    s_bitcmp1_b32 s3, 0
    s_mov_b32 s57, 0xff00000f
    s_mov_b32 s58, 0x0
    s_mov_b32 s14, 0xffffffff
    s_mov_b32 s15, 0x0
L_pm_11:
    s_sub_u32 s96, s56, 144
    s_cmp_lt_u32 s96, 10
    s_cbranch_scc0 L_pm_12
    s_bitcmp1_b32 s3, 0
    s_mov_b32 s57, 0xffffffff
    s_mov_b32 s58, 0xfff
    s_mov_b32 s14, 0xffffffff
    s_mov_b32 s15, 0x0
L_pm_12:
    s_cmp_lt_u32 s56, 104
    s_cbranch_scc0 L_pm_13
    s_bitcmp1_b32 s3, 0
    s_mov_b32 s57, 0xf
    s_mov_b32 s58, 0x0
    s_mov_b32 s14, 0xffffffff
    s_mov_b32 s15, 0x0
L_pm_13:
    s_sub_u32 s96, s56, 43
    s_and_b32 s96, s96, 0xffffffc7
    s_cmp_eq_u32 s96, 0
    s_cbranch_scc0 L_pm_14
    s_bitcmp1_b32 s3, 0
    s_mov_b32 s57, 0x0
    s_mov_b32 s58, 0x0
    s_mov_b32 s14, 0xff000000
    s_mov_b32 s15, 0x0
L_pm_14:
    s_cmp_lt_u32 s56, 40
    s_cbranch_scc0 L_pm_15
    s_bitcmp1_b32 s3, 0
    s_mov_b32 s57, 0xffffffff
    s_mov_b32 s58, 0xf
    s_mov_b32 s14, 0xffffffff
    s_mov_b32 s15, 0x0
L_pm_15:
    s_cmp_eq_u32 s39, 1
    s_cbranch_scc0 L_pm_16
    s_bitcmp1_b32 s3, 0
    s_mov_b32 s57, 0xff
    s_mov_b32 s58, 0xff
    s_mov_b32 s14, 0x0
    s_mov_b32 s15, 0x0
L_pm_16:
    s_cmp_lg_u32 s13, 0
    s_cbranch_scc0 L_pm_17
    s_bitcmp1_b32 s3, 0
    s_mov_b32 s57, 0xffffffff
    s_mov_b32 s58, 0x0
    s_mov_b32 s14, 0x0
    s_mov_b32 s15, 0x0
L_pm_17:
    s_and_b32 s96, s39, s59
    s_cbranch_scc0 L_pm_18
    s_bitcmp1_b32 s3, 0
    s_mov_b32 s57, 0x3ff
    s_mov_b32 s58, 0x3ff
    s_mov_b32 s14, 0x0
    s_mov_b32 s15, 0x0
L_pm_18:
    s_add_u32 s52, s8, s63
    s_addc_u32 s53, s9, 0
    s_mov_b32 s54, 262144
    s_mov_b32 s55, 0x20000
    v_and_b32 v2, 15, v0
    v_lshrrev_b32 v3, 1, v2
    v_and_b32 v37, 1, v2
    v_lshlrev_b32 v37, 4, v37
    v_mov_b32 v38, 0xffff
    v_lshlrev_b32 v37, v37, v38
    v_cmp_eq_u32 vcc, 0, v3
    v_mov_b32 v32, 0
    s_nop 0
    v_cndmask_b32 v20, 0, v37, vcc
    v_cmp_eq_u32 vcc, 1, v3
    v_mov_b32 v33, 0
    s_nop 0
    v_cndmask_b32 v21, 0, v37, vcc
    v_cmp_eq_u32 vcc, 2, v3
    v_mov_b32 v34, 0
    s_nop 0
    v_cndmask_b32 v22, 0, v37, vcc
    v_cmp_eq_u32 vcc, 3, v3
    v_mov_b32 v35, 0
    s_nop 0
    v_cndmask_b32 v23, 0, v37, vcc
    v_lshlrev_b32 v2, 4, v2
    s_lshl_b32 s98, s62, 8
    s_add_u32 s98, s98, 40960
    s_bitcmp0_b32 s57, 2
    s_cbranch_scc1 L_sf_19
    s_bitcmp0_b32 s58, 2
    s_cbranch_scc1 L_sf_19
    s_waitcnt vmcnt(1)
L_sf_19:
    buffer_load_dwordx4 v[48:51], v1, s[48:51], s97 offen offset:2048 nt
    s_bitcmp0_b32 s57, 3
    s_cbranch_scc1 L_sf_20
    s_waitcnt vmcnt(2)
    s_bitcmp0_b32 s58, 3
    s_cbranch_scc1 L_sf_20
    s_waitcnt vmcnt(1)
L_sf_20:
    buffer_load_dwordx4 v[52:55], v1, s[48:51], s97 offen offset:3072 nt
    s_add_u32 s97, s97, 32768
    v_add_u32 v1, 4096, v1
    v_and_b32 v1, 0x7fff, v1
    s_waitcnt vmcnt(3)
    s_bitcmp0_b32 s57, 4
    s_cbranch_scc1 L_sf_21
    s_waitcnt vmcnt(2)
    s_bitcmp0_b32 s58, 4
    s_cbranch_scc1 L_sf_21
    s_waitcnt vmcnt(1)
L_sf_21:
    buffer_load_dwordx4 v[56:59], v1, s[48:51], s97 offen offset:0 nt
    s_waitcnt vmcnt(3)
    s_bitcmp0_b32 s57, 5
    s_cbranch_scc1 L_sf_22
    s_waitcnt vmcnt(2)
    s_bitcmp0_b32 s58, 5
    s_cbranch_scc1 L_sf_22
    s_waitcnt vmcnt(1)
L_sf_22:
    buffer_load_dwordx4 v[60:63], v1, s[48:51], s97 offen offset:1024 nt
    s_waitcnt vmcnt(3)
    s_bitcmp0_b32 s57, 6
    s_cbranch_scc1 L_sf_23
    s_waitcnt vmcnt(2)
    s_bitcmp0_b32 s58, 6
    s_cbranch_scc1 L_sf_23
    s_waitcnt vmcnt(1)
L_sf_23:
    buffer_load_dwordx4 v[64:67], v1, s[48:51], s97 offen offset:2048 nt
    s_waitcnt vmcnt(3)
    s_bitcmp0_b32 s57, 7
    s_cbranch_scc1 L_sf_24
    s_waitcnt vmcnt(2)
    s_bitcmp0_b32 s58, 7
    s_cbranch_scc1 L_sf_24
    s_waitcnt vmcnt(1)
L_sf_24:
    buffer_load_dwordx4 v[68:71], v1, s[48:51], s97 offen offset:3072 nt
    s_add_u32 s97, s97, 32768
    v_add_u32 v1, 4096, v1
    v_and_b32 v1, 0x7fff, v1
    s_waitcnt vmcnt(3)
    s_bitcmp0_b32 s57, 8
    s_cbranch_scc1 L_sf_25
    s_waitcnt vmcnt(2)
    s_bitcmp0_b32 s58, 8
    s_cbranch_scc1 L_sf_25
    s_waitcnt vmcnt(1)
L_sf_25:
    buffer_load_dwordx4 v[72:75], v1, s[48:51], s97 offen offset:0 nt
    s_waitcnt vmcnt(3)
    s_bitcmp0_b32 s57, 9
    s_cbranch_scc1 L_sf_26
    s_waitcnt vmcnt(2)
    s_bitcmp0_b32 s58, 9
    s_cbranch_scc1 L_sf_26
    s_waitcnt vmcnt(1)
L_sf_26:
    buffer_load_dwordx4 v[76:79], v1, s[48:51], s97 offen offset:1024 nt
    s_waitcnt vmcnt(3)
    s_bitcmp0_b32 s57, 10
    s_cbranch_scc1 L_sf_27
    s_waitcnt vmcnt(2)
    s_bitcmp0_b32 s58, 10
    s_cbranch_scc1 L_sf_27
    s_waitcnt vmcnt(1)
L_sf_27:
    buffer_load_dwordx4 v[80:83], v1, s[48:51], s97 offen offset:2048 nt
    s_waitcnt vmcnt(3)
    s_bitcmp0_b32 s57, 11
    s_cbranch_scc1 L_sf_28
    s_waitcnt vmcnt(2)
    s_bitcmp0_b32 s58, 11
    s_cbranch_scc1 L_sf_28
    s_waitcnt vmcnt(1)
L_sf_28:
    buffer_load_dwordx4 v[84:87], v1, s[48:51], s97 offen offset:3072 nt
    s_add_u32 s97, s97, 32768
    v_add_u32 v1, 4096, v1
    v_and_b32 v1, 0x7fff, v1
    s_waitcnt vmcnt(3)
    s_bitcmp0_b32 s57, 12
    s_cbranch_scc1 L_sf_29
    s_waitcnt vmcnt(2)
    s_bitcmp0_b32 s58, 12
    s_cbranch_scc1 L_sf_29
    s_waitcnt vmcnt(1)
L_sf_29:
    buffer_load_dwordx4 v[88:91], v1, s[48:51], s97 offen offset:0 nt
    s_waitcnt vmcnt(3)
    s_bitcmp0_b32 s57, 13
    s_cbranch_scc1 L_sf_30
    s_waitcnt vmcnt(2)
    s_bitcmp0_b32 s58, 13
    s_cbranch_scc1 L_sf_30
    s_waitcnt vmcnt(1)
L_sf_30:
    buffer_load_dwordx4 v[92:95], v1, s[48:51], s97 offen offset:1024 nt
    s_waitcnt vmcnt(3)
    s_bitcmp0_b32 s57, 14
    s_cbranch_scc1 L_sf_31
    s_waitcnt vmcnt(2)
    s_bitcmp0_b32 s58, 14
    s_cbranch_scc1 L_sf_31
    s_waitcnt vmcnt(1)
L_sf_31:
    buffer_load_dwordx4 v[96:99], v1, s[48:51], s97 offen offset:2048 nt
    s_waitcnt vmcnt(3)
    s_bitcmp0_b32 s57, 15
    s_cbranch_scc1 L_sf_32
    s_waitcnt vmcnt(2)
    s_bitcmp0_b32 s58, 15
    s_cbranch_scc1 L_sf_32
    s_waitcnt vmcnt(1)
L_sf_32:
    buffer_load_dwordx4 v[100:103], v1, s[48:51], s97 offen offset:3072 nt
    s_add_u32 s97, s97, 32768
    v_add_u32 v1, 4096, v1
    v_and_b32 v1, 0x7fff, v1
    s_waitcnt vmcnt(3)
    s_bitcmp0_b32 s57, 16
    s_cbranch_scc1 L_sf_33
    s_waitcnt vmcnt(2)
    s_bitcmp0_b32 s58, 16
    s_cbranch_scc1 L_sf_33
    s_waitcnt vmcnt(1)
L_sf_33:
    buffer_load_dwordx4 v[104:107], v1, s[48:51], s97 offen offset:0 nt
    s_waitcnt vmcnt(3)
    s_bitcmp0_b32 s57, 17
    s_cbranch_scc1 L_sf_34
    s_waitcnt vmcnt(2)
    s_bitcmp0_b32 s58, 17
    s_cbranch_scc1 L_sf_34
    s_waitcnt vmcnt(1)
L_sf_34:
    buffer_load_dwordx4 v[108:111], v1, s[48:51], s97 offen offset:1024 nt
    s_waitcnt vmcnt(3)
    s_bitcmp0_b32 s57, 18
    s_cbranch_scc1 L_sf_35
    s_waitcnt vmcnt(2)
    s_bitcmp0_b32 s58, 18
    s_cbranch_scc1 L_sf_35
    s_waitcnt vmcnt(1)
L_sf_35:
    buffer_load_dwordx4 v[112:115], v1, s[48:51], s97 offen offset:2048 nt
    s_waitcnt vmcnt(3)
    s_bitcmp0_b32 s57, 19
    s_cbranch_scc1 L_sf_36
    s_waitcnt vmcnt(2)
    s_bitcmp0_b32 s58, 19
    s_cbranch_scc1 L_sf_36
    s_waitcnt vmcnt(1)
L_sf_36:
    buffer_load_dwordx4 v[116:119], v1, s[48:51], s97 offen offset:3072 nt
    s_add_u32 s97, s97, 32768
    v_add_u32 v1, 4096, v1
    v_and_b32 v1, 0x7fff, v1
    s_waitcnt vmcnt(3)
    s_bitcmp0_b32 s57, 20
    s_cbranch_scc1 L_sf_37
    s_waitcnt vmcnt(2)
    s_bitcmp0_b32 s58, 20
    s_cbranch_scc1 L_sf_37
    s_waitcnt vmcnt(1)
L_sf_37:
    buffer_load_dwordx4 v[120:123], v1, s[48:51], s97 offen offset:0 nt
    s_waitcnt vmcnt(3)
    s_bitcmp0_b32 s57, 21
    s_cbranch_scc1 L_sf_38
    s_waitcnt vmcnt(2)
    s_bitcmp0_b32 s58, 21
    s_cbranch_scc1 L_sf_38
    s_waitcnt vmcnt(1)
L_sf_38:
    buffer_load_dwordx4 v[124:127], v1, s[48:51], s97 offen offset:1024 nt
    s_cmp_eq_u32 s12, -1
    s_cbranch_scc1 L_k_nopf
    s_waitcnt vmcnt(3)
    s_bitcmp0_b32 s57, 22
    s_cbranch_scc1 L_sf_39
    s_waitcnt vmcnt(2)
    s_bitcmp0_b32 s58, 22
    s_cbranch_scc1 L_sf_39
    s_waitcnt vmcnt(1)
L_sf_39:
    buffer_load_dwordx4 v[128:131], v1, s[48:51], s97 offen offset:2048 nt
    s_waitcnt vmcnt(3)
    s_bitcmp0_b32 s57, 23
    s_cbranch_scc1 L_sf_40
    s_waitcnt vmcnt(2)
    s_bitcmp0_b32 s58, 23
    s_cbranch_scc1 L_sf_40
    s_waitcnt vmcnt(1)
L_sf_40:
    buffer_load_dwordx4 v[132:135], v1, s[48:51], s97 offen offset:3072 nt
    s_add_u32 s97, s97, 32768
    v_add_u32 v1, 4096, v1
    v_and_b32 v1, 0x7fff, v1
    s_waitcnt vmcnt(3)
    s_bitcmp0_b32 s57, 24
    s_cbranch_scc1 L_sf_41
    s_waitcnt vmcnt(2)
    s_bitcmp0_b32 s58, 24
    s_cbranch_scc1 L_sf_41
    s_waitcnt vmcnt(1)
L_sf_41:
    buffer_load_dwordx4 v[136:139], v1, s[48:51], s97 offen offset:0 nt
    s_waitcnt vmcnt(3)
    s_bitcmp0_b32 s57, 25
    s_cbranch_scc1 L_sf_42
    s_waitcnt vmcnt(2)
    s_bitcmp0_b32 s58, 25
    s_cbranch_scc1 L_sf_42
    s_waitcnt vmcnt(1)
L_sf_42:
    buffer_load_dwordx4 v[140:143], v1, s[48:51], s97 offen offset:1024 nt
    s_waitcnt vmcnt(3)
    s_bitcmp0_b32 s57, 26
    s_cbranch_scc1 L_sf_43
    s_waitcnt vmcnt(2)
    s_bitcmp0_b32 s58, 26
    s_cbranch_scc1 L_sf_43
    s_waitcnt vmcnt(1)
L_sf_43:
    buffer_load_dwordx4 v[144:147], v1, s[48:51], s97 offen offset:2048 nt
    s_waitcnt vmcnt(3)
    s_bitcmp0_b32 s57, 27
    s_cbranch_scc1 L_sf_44
    s_waitcnt vmcnt(2)
    s_bitcmp0_b32 s58, 27
    s_cbranch_scc1 L_sf_44
    s_waitcnt vmcnt(1)
L_sf_44:
    buffer_load_dwordx4 v[148:151], v1, s[48:51], s97 offen offset:3072 nt
    s_add_u32 s97, s97, 32768
    v_add_u32 v1, 4096, v1
    v_and_b32 v1, 0x7fff, v1
    s_waitcnt vmcnt(3)
    s_bitcmp0_b32 s57, 28
    s_cbranch_scc1 L_sf_45
    s_waitcnt vmcnt(2)
    s_bitcmp0_b32 s58, 28
    s_cbranch_scc1 L_sf_45
    s_waitcnt vmcnt(1)
L_sf_45:
    buffer_load_dwordx4 v[152:155], v1, s[48:51], s97 offen offset:0 nt
    s_waitcnt vmcnt(3)
    s_bitcmp0_b32 s57, 29
    s_cbranch_scc1 L_sf_46
    s_waitcnt vmcnt(2)
    s_bitcmp0_b32 s58, 29
    s_cbranch_scc1 L_sf_46
    s_waitcnt vmcnt(1)
L_sf_46:
    buffer_load_dwordx4 v[156:159], v1, s[48:51], s97 offen offset:1024 nt
    s_waitcnt vmcnt(3)
    s_bitcmp0_b32 s57, 30
    s_cbranch_scc1 L_sf_47
    s_waitcnt vmcnt(2)
    s_bitcmp0_b32 s58, 30
    s_cbranch_scc1 L_sf_47
    s_waitcnt vmcnt(1)
L_sf_47:
    buffer_load_dwordx4 v[160:163], v1, s[48:51], s97 offen offset:2048 nt
    v_min_u32 v39, 15, v0
    v_and_b32 v38, 1, v39
    v_mul_u32_u24 v38, 126, v38
    v_lshl_add_u32 v39, v39, 1, v38
    buffer_load_dword v37, v39, s[44:47], 0 offen sc1
    s_waitcnt vmcnt(4)
    s_bitcmp0_b32 s57, 31
    s_cbranch_scc1 L_sf_48
    s_waitcnt vmcnt(3)
    s_bitcmp0_b32 s58, 31
    s_cbranch_scc1 L_sf_48
    s_waitcnt vmcnt(2)
L_sf_48:
    buffer_load_dwordx4 v[164:167], v1, s[48:51], s97 offen offset:3072 nt
    s_mov_b32 s97, 0
    v_add_u32 v1, 4096, v1
    v_and_b32 v1, 0x7fff, v1
    s_waitcnt vmcnt(4)
    s_bitcmp0_b32 s14, 0
    s_cbranch_scc1 L_sf_49
    s_waitcnt vmcnt(3)
    s_bitcmp0_b32 s15, 0
    s_cbranch_scc1 L_sf_49
    s_waitcnt vmcnt(2)
L_sf_49:
    s_add_u32 m0, s12, 0
    s_nop 0
    buffer_load_dwordx4 v1, s[52:55], s97 offen offset:0 nt lds
    s_waitcnt vmcnt(4)
    s_bitcmp0_b32 s14, 1
    s_cbranch_scc1 L_sf_50
    s_waitcnt vmcnt(3)
    s_bitcmp0_b32 s15, 1
    s_cbranch_scc1 L_sf_50
    s_waitcnt vmcnt(1)
L_sf_50:
    buffer_load_dwordx4 v1, s[52:55], s97 offen offset:1024 nt lds
    s_waitcnt vmcnt(4)
    s_bitcmp0_b32 s14, 2
    s_cbranch_scc1 L_sf_51
    s_waitcnt vmcnt(2)
    s_bitcmp0_b32 s15, 2
    s_cbranch_scc1 L_sf_51
    s_waitcnt vmcnt(1)
L_sf_51:
    buffer_load_dwordx4 v1, s[52:55], s97 offen offset:2048 nt lds
    s_waitcnt vmcnt(3)
    s_bitcmp0_b32 s14, 3
    s_cbranch_scc1 L_sf_52
    s_waitcnt vmcnt(2)
    s_bitcmp0_b32 s15, 3
    s_cbranch_scc1 L_sf_52
    s_waitcnt vmcnt(1)
L_sf_52:
    buffer_load_dwordx4 v1, s[52:55], s97 offen offset:3072 nt lds
    s_add_u32 s97, s97, 32768
    v_add_u32 v1, 4096, v1
    v_and_b32 v1, 0x7fff, v1
    v_cmp_eq_u32 vcc, 0, v37
    s_nop 0
    s_or_b32 s96, vcc_lo, vcc_hi
    buffer_load_dwordx4 v[4:7], v2, s[40:43], s98 offen sc1
    s_waitcnt vmcnt(4)
    s_bitcmp0_b32 s14, 4
    s_cbranch_scc1 L_sf_53
    s_waitcnt vmcnt(3)
    s_bitcmp0_b32 s15, 4
    s_cbranch_scc1 L_sf_53
    s_waitcnt vmcnt(2)
L_sf_53:
    s_add_u32 m0, s12, 4096
    s_nop 0
    buffer_load_dwordx4 v1, s[52:55], s97 offen offset:0 nt lds
    s_waitcnt vmcnt(4)
    s_bitcmp0_b32 s14, 5
    s_cbranch_scc1 L_sf_54
    s_waitcnt vmcnt(3)
    s_bitcmp0_b32 s15, 5
    s_cbranch_scc1 L_sf_54
    s_waitcnt vmcnt(2)
L_sf_54:
    buffer_load_dwordx4 v1, s[52:55], s97 offen offset:1024 nt lds
    s_waitcnt vmcnt(4)
    s_bitcmp0_b32 s14, 6
    s_cbranch_scc1 L_sf_55
    s_waitcnt vmcnt(3)
    s_bitcmp0_b32 s15, 6
    s_cbranch_scc1 L_sf_55
    s_waitcnt vmcnt(1)
L_sf_55:
    buffer_load_dwordx4 v1, s[52:55], s97 offen offset:2048 nt lds
    s_waitcnt vmcnt(4)
    s_bitcmp0_b32 s14, 7
    s_cbranch_scc1 L_sf_56
    s_waitcnt vmcnt(2)
    s_bitcmp0_b32 s15, 7
    s_cbranch_scc1 L_sf_56
    s_waitcnt vmcnt(1)
L_sf_56:
    buffer_load_dwordx4 v1, s[52:55], s97 offen offset:3072 nt lds
    s_add_u32 s97, s97, 32768
    v_add_u32 v1, 4096, v1
    v_and_b32 v1, 0x7fff, v1
L_k_join:
    s_waitcnt vmcnt(4)
    v_max3_u32 v38, v4, v5, v6
    v_max_u32 v38, v38, v7
    v_cmp_eq_u32 vcc, -1, v38
    s_cmp_lg_u32 s96, 0
    s_cbranch_scc1 L_qslow
    s_cbranch_vccnz L_qslow2
L_qok:
    v_dot2_f32_bf16 v8, v72, v4, 0
    v_dot2_f32_bf16 v9, v76, v4, 0
    v_dot2_f32_bf16 v10, v80, v4, 0
    v_dot2_f32_bf16 v11, v84, v4, 0
    v_dot2_f32_bf16 v24, v88, v4, 0
    v_dot2_f32_bf16 v25, v92, v4, 0
    v_dot2_f32_bf16 v26, v96, v4, 0
    v_dot2_f32_bf16 v27, v100, v4, 0
    v_dot2_f32_bf16 v8, v73, v5, v8
    v_dot2_f32_bf16 v9, v77, v5, v9
    v_dot2_f32_bf16 v10, v81, v5, v10
    v_dot2_f32_bf16 v11, v85, v5, v11
    v_dot2_f32_bf16 v24, v89, v5, v24
    v_dot2_f32_bf16 v25, v93, v5, v25
    v_dot2_f32_bf16 v26, v97, v5, v26
    v_dot2_f32_bf16 v27, v101, v5, v27
    v_dot2_f32_bf16 v8, v74, v6, v8
    v_dot2_f32_bf16 v9, v78, v6, v9
    v_dot2_f32_bf16 v10, v82, v6, v10
    v_dot2_f32_bf16 v11, v86, v6, v11
    v_dot2_f32_bf16 v24, v90, v6, v24
    v_dot2_f32_bf16 v25, v94, v6, v25
    v_dot2_f32_bf16 v26, v98, v6, v26
    v_dot2_f32_bf16 v27, v102, v6, v27
    v_dot2_f32_bf16 v8, v75, v7, v8
    v_dot2_f32_bf16 v9, v79, v7, v9
    v_dot2_f32_bf16 v10, v83, v7, v10
    v_dot2_f32_bf16 v11, v87, v7, v11
    v_dot2_f32_bf16 v24, v91, v7, v24
    v_dot2_f32_bf16 v25, v95, v7, v25
    v_dot2_f32_bf16 v26, v99, v7, v26
    v_dot2_f32_bf16 v27, v103, v7, v27
    v_add_f32_dpp v8, v8, v8 row_ror:8 row_mask:0xf bank_mask:0x3
    v_add_f32_dpp v10, v10, v10 row_ror:8 row_mask:0xf bank_mask:0x3
    v_add_f32_dpp v24, v24, v24 row_ror:8 row_mask:0xf bank_mask:0x3
    v_add_f32_dpp v26, v26, v26 row_ror:8 row_mask:0xf bank_mask:0x3
    v_add_f32_dpp v8, v9, v9 row_ror:8 row_mask:0xf bank_mask:0xc
    v_add_f32_dpp v10, v11, v11 row_ror:8 row_mask:0xf bank_mask:0xc
    v_add_f32_dpp v24, v25, v25 row_ror:8 row_mask:0xf bank_mask:0xc
    v_add_f32_dpp v26, v27, v27 row_ror:8 row_mask:0xf bank_mask:0xc
    v_add_f32_dpp v14, v8, v8 row_half_mirror row_mask:0xf bank_mask:0x5
    v_add_f32_dpp v15, v24, v24 row_half_mirror row_mask:0xf bank_mask:0x5
    v_add_f32_dpp v14, v10, v10 row_half_mirror row_mask:0xf bank_mask:0xa
    v_add_f32_dpp v15, v26, v26 row_half_mirror row_mask:0xf bank_mask:0xa
    s_nop 0
    v_add_f32_dpp v14, v14, v14 quad_perm:[1,0,3,2] row_mask:0xf bank_mask:0xf
    v_add_f32_dpp v15, v15, v15 quad_perm:[1,0,3,2] row_mask:0xf bank_mask:0xf
    s_nop 0
    v_add_f32_dpp v14, v14, v14 quad_perm:[2,3,0,1] row_mask:0xf bank_mask:0xf
    v_add_f32_dpp v15, v15, v15 quad_perm:[2,3,0,1] row_mask:0xf bank_mask:0xf
    s_waitcnt vmcnt(3)
    s_bitcmp0_b32 s14, 8
    s_cbranch_scc1 L_sf_67
    s_waitcnt vmcnt(2)
    s_bitcmp0_b32 s15, 8
    s_cbranch_scc1 L_sf_67
    s_waitcnt vmcnt(1)
L_sf_67:
    buffer_load_dwordx4 v[72:75], v1, s[52:55], s97 offen offset:0 nt
    v_dot2_f32_bf16 v8, v40, v4, 0
    v_dot2_f32_bf16 v9, v44, v4, 0
    v_dot2_f32_bf16 v10, v48, v4, 0
    v_dot2_f32_bf16 v11, v52, v4, 0
    v_dot2_f32_bf16 v24, v56, v4, 0
    v_dot2_f32_bf16 v25, v60, v4, 0
    v_dot2_f32_bf16 v26, v64, v4, 0
    v_dot2_f32_bf16 v27, v68, v4, 0
    v_dot2_f32_bf16 v28, v104, v4, 0
    v_dot2_f32_bf16 v29, v108, v4, 0
    v_dot2_f32_bf16 v30, v112, v4, 0
    v_dot2_f32_bf16 v31, v116, v4, 0
    v_dot2_f32_bf16 v8, v41, v5, v8
    v_dot2_f32_bf16 v9, v45, v5, v9
    v_dot2_f32_bf16 v10, v49, v5, v10
    v_dot2_f32_bf16 v11, v53, v5, v11
    v_dot2_f32_bf16 v24, v57, v5, v24
    v_dot2_f32_bf16 v25, v61, v5, v25
    v_dot2_f32_bf16 v26, v65, v5, v26
    v_dot2_f32_bf16 v27, v69, v5, v27
    v_dot2_f32_bf16 v28, v105, v5, v28
    v_dot2_f32_bf16 v29, v109, v5, v29
    v_dot2_f32_bf16 v30, v113, v5, v30
    v_dot2_f32_bf16 v31, v117, v5, v31
    v_dot2_f32_bf16 v8, v42, v6, v8
    v_dot2_f32_bf16 v9, v46, v6, v9
    v_dot2_f32_bf16 v10, v50, v6, v10
    v_dot2_f32_bf16 v11, v54, v6, v11
    v_dot2_f32_bf16 v24, v58, v6, v24
    v_dot2_f32_bf16 v25, v62, v6, v25
    v_dot2_f32_bf16 v26, v66, v6, v26
    v_dot2_f32_bf16 v27, v70, v6, v27
    v_dot2_f32_bf16 v28, v106, v6, v28
    v_dot2_f32_bf16 v29, v110, v6, v29
    v_dot2_f32_bf16 v30, v114, v6, v30
    v_dot2_f32_bf16 v31, v118, v6, v31
    v_dot2_f32_bf16 v8, v43, v7, v8
    v_dot2_f32_bf16 v9, v47, v7, v9
    v_dot2_f32_bf16 v10, v51, v7, v10
    v_dot2_f32_bf16 v11, v55, v7, v11
    v_dot2_f32_bf16 v24, v59, v7, v24
    v_dot2_f32_bf16 v25, v63, v7, v25
    v_dot2_f32_bf16 v26, v67, v7, v26
    v_dot2_f32_bf16 v27, v71, v7, v27
    v_dot2_f32_bf16 v28, v107, v7, v28
    v_dot2_f32_bf16 v29, v111, v7, v29
    v_dot2_f32_bf16 v30, v115, v7, v30
    v_dot2_f32_bf16 v31, v119, v7, v31
    v_add_f32_dpp v8, v8, v8 row_ror:8 row_mask:0xf bank_mask:0x3
    v_add_f32_dpp v10, v10, v10 row_ror:8 row_mask:0xf bank_mask:0x3
    v_add_f32_dpp v24, v24, v24 row_ror:8 row_mask:0xf bank_mask:0x3
    v_add_f32_dpp v26, v26, v26 row_ror:8 row_mask:0xf bank_mask:0x3
    v_add_f32_dpp v28, v28, v28 row_ror:8 row_mask:0xf bank_mask:0x3
    v_add_f32_dpp v30, v30, v30 row_ror:8 row_mask:0xf bank_mask:0x3
    v_add_f32_dpp v8, v9, v9 row_ror:8 row_mask:0xf bank_mask:0xc
    v_add_f32_dpp v10, v11, v11 row_ror:8 row_mask:0xf bank_mask:0xc
    v_add_f32_dpp v24, v25, v25 row_ror:8 row_mask:0xf bank_mask:0xc
    v_add_f32_dpp v26, v27, v27 row_ror:8 row_mask:0xf bank_mask:0xc
    v_add_f32_dpp v28, v29, v29 row_ror:8 row_mask:0xf bank_mask:0xc
    v_add_f32_dpp v30, v31, v31 row_ror:8 row_mask:0xf bank_mask:0xc
    v_add_f32_dpp v12, v8, v8 row_half_mirror row_mask:0xf bank_mask:0x5
    v_add_f32_dpp v13, v24, v24 row_half_mirror row_mask:0xf bank_mask:0x5
    v_add_f32_dpp v16, v28, v28 row_half_mirror row_mask:0xf bank_mask:0x5
    v_add_f32_dpp v12, v10, v10 row_half_mirror row_mask:0xf bank_mask:0xa
    v_add_f32_dpp v13, v26, v26 row_half_mirror row_mask:0xf bank_mask:0xa
    v_add_f32_dpp v16, v30, v30 row_half_mirror row_mask:0xf bank_mask:0xa
    v_add_f32_dpp v12, v12, v12 quad_perm:[1,0,3,2] row_mask:0xf bank_mask:0xf
    v_add_f32_dpp v13, v13, v13 quad_perm:[1,0,3,2] row_mask:0xf bank_mask:0xf
    v_add_f32_dpp v16, v16, v16 quad_perm:[1,0,3,2] row_mask:0xf bank_mask:0xf
    v_add_f32_dpp v12, v12, v12 quad_perm:[2,3,0,1] row_mask:0xf bank_mask:0xf
    v_add_f32_dpp v13, v13, v13 quad_perm:[2,3,0,1] row_mask:0xf bank_mask:0xf
    v_add_f32_dpp v16, v16, v16 quad_perm:[2,3,0,1] row_mask:0xf bank_mask:0xf
    s_waitcnt vmcnt(3)
    s_bitcmp0_b32 s14, 9
    s_cbranch_scc1 L_sf_68
    s_waitcnt vmcnt(2)
    s_bitcmp0_b32 s15, 9
    s_cbranch_scc1 L_sf_68
    s_waitcnt vmcnt(1)
L_sf_68:
    buffer_load_dwordx4 v[76:79], v1, s[52:55], s97 offen offset:1024 nt
    v_dot2_f32_bf16 v8, v120, v4, 0
    v_dot2_f32_bf16 v9, v124, v4, 0
    v_dot2_f32_bf16 v10, v128, v4, 0
    v_dot2_f32_bf16 v11, v132, v4, 0
    v_dot2_f32_bf16 v24, v136, v4, 0
    v_dot2_f32_bf16 v25, v140, v4, 0
    v_dot2_f32_bf16 v26, v144, v4, 0
    v_dot2_f32_bf16 v27, v148, v4, 0
    v_dot2_f32_bf16 v8, v121, v5, v8
    v_dot2_f32_bf16 v9, v125, v5, v9
    v_dot2_f32_bf16 v10, v129, v5, v10
    v_dot2_f32_bf16 v11, v133, v5, v11
    v_dot2_f32_bf16 v24, v137, v5, v24
    v_dot2_f32_bf16 v25, v141, v5, v25
    v_dot2_f32_bf16 v26, v145, v5, v26
    v_dot2_f32_bf16 v27, v149, v5, v27
    v_dot2_f32_bf16 v8, v122, v6, v8
    v_dot2_f32_bf16 v9, v126, v6, v9
    v_dot2_f32_bf16 v10, v130, v6, v10
    v_dot2_f32_bf16 v11, v134, v6, v11
    v_dot2_f32_bf16 v24, v138, v6, v24
    v_dot2_f32_bf16 v25, v142, v6, v25
    v_dot2_f32_bf16 v26, v146, v6, v26
    v_dot2_f32_bf16 v27, v150, v6, v27
    v_dot2_f32_bf16 v8, v123, v7, v8
    v_dot2_f32_bf16 v9, v127, v7, v9
    v_dot2_f32_bf16 v10, v131, v7, v10
    v_dot2_f32_bf16 v11, v135, v7, v11
    v_dot2_f32_bf16 v24, v139, v7, v24
    v_dot2_f32_bf16 v25, v143, v7, v25
    v_dot2_f32_bf16 v26, v147, v7, v26
    v_dot2_f32_bf16 v27, v151, v7, v27
    v_add_f32_dpp v8, v8, v8 row_ror:8 row_mask:0xf bank_mask:0x3
    v_add_f32_dpp v10, v10, v10 row_ror:8 row_mask:0xf bank_mask:0x3
    v_add_f32_dpp v24, v24, v24 row_ror:8 row_mask:0xf bank_mask:0x3
    v_add_f32_dpp v26, v26, v26 row_ror:8 row_mask:0xf bank_mask:0x3
    v_add_f32_dpp v8, v9, v9 row_ror:8 row_mask:0xf bank_mask:0xc
    v_add_f32_dpp v10, v11, v11 row_ror:8 row_mask:0xf bank_mask:0xc
    v_add_f32_dpp v24, v25, v25 row_ror:8 row_mask:0xf bank_mask:0xc
    v_add_f32_dpp v26, v27, v27 row_ror:8 row_mask:0xf bank_mask:0xc
    v_add_f32_dpp v17, v8, v8 row_half_mirror row_mask:0xf bank_mask:0x5
    v_add_f32_dpp v18, v24, v24 row_half_mirror row_mask:0xf bank_mask:0x5
    v_add_f32_dpp v17, v10, v10 row_half_mirror row_mask:0xf bank_mask:0xa
    v_add_f32_dpp v18, v26, v26 row_half_mirror row_mask:0xf bank_mask:0xa
    s_nop 0
    v_add_f32_dpp v17, v17, v17 quad_perm:[1,0,3,2] row_mask:0xf bank_mask:0xf
    v_add_f32_dpp v18, v18, v18 quad_perm:[1,0,3,2] row_mask:0xf bank_mask:0xf
    s_nop 0
    v_add_f32_dpp v17, v17, v17 quad_perm:[2,3,0,1] row_mask:0xf bank_mask:0xf
    v_add_f32_dpp v18, v18, v18 quad_perm:[2,3,0,1] row_mask:0xf bank_mask:0xf
    s_waitcnt vmcnt(3)
    s_bitcmp0_b32 s14, 10
    s_cbranch_scc1 L_sf_69
    s_waitcnt vmcnt(2)
    s_bitcmp0_b32 s15, 10
    s_cbranch_scc1 L_sf_69
    s_waitcnt vmcnt(1)
L_sf_69:
    buffer_load_dwordx4 v[80:83], v1, s[52:55], s97 offen offset:2048 nt
    s_waitcnt vmcnt(3)
    s_bitcmp0_b32 s14, 11
    s_cbranch_scc1 L_sf_70
    s_waitcnt vmcnt(2)
    s_bitcmp0_b32 s15, 11
    s_cbranch_scc1 L_sf_70
    s_waitcnt vmcnt(1)
L_sf_70:
    buffer_load_dwordx4 v[84:87], v1, s[52:55], s97 offen offset:3072 nt
    s_add_u32 s97, s97, 32768
    v_add_u32 v1, 4096, v1
    v_and_b32 v1, 0x7fff, v1
    s_cmp_eq_u32 s12, -1
    s_cbranch_scc1 L_nopfrd
    v_lshl_add_u32 v38, v0, 4, s12
    ds_read_b128 v[40:43], v38 offset:0
    ds_read_b128 v[44:47], v38 offset:1024
    ds_read_b128 v[48:51], v38 offset:2048
    ds_read_b128 v[52:55], v38 offset:3072
    ds_read_b128 v[56:59], v38 offset:4096
    ds_read_b128 v[60:63], v38 offset:5120
    ds_read_b128 v[64:67], v38 offset:6144
    ds_read_b128 v[68:71], v38 offset:7168
L_nopfrd:
    v_dot2_f32_bf16 v8, v152, v4, 0
    v_dot2_f32_bf16 v9, v156, v4, 0
    v_dot2_f32_bf16 v10, v160, v4, 0
    v_dot2_f32_bf16 v11, v164, v4, 0
    v_dot2_f32_bf16 v8, v153, v5, v8
    v_dot2_f32_bf16 v9, v157, v5, v9
    v_dot2_f32_bf16 v10, v161, v5, v10
    v_dot2_f32_bf16 v11, v165, v5, v11
    v_dot2_f32_bf16 v8, v154, v6, v8
    v_dot2_f32_bf16 v9, v158, v6, v9
    v_dot2_f32_bf16 v10, v162, v6, v10
    v_dot2_f32_bf16 v11, v166, v6, v11
    v_dot2_f32_bf16 v8, v155, v7, v8
    v_dot2_f32_bf16 v9, v159, v7, v9
    v_dot2_f32_bf16 v10, v163, v7, v10
    v_dot2_f32_bf16 v11, v167, v7, v11
    v_add_f32_dpp v8, v8, v8 row_ror:8 row_mask:0xf bank_mask:0x3
    s_nop 0
    v_add_f32_dpp v10, v10, v10 row_ror:8 row_mask:0xf bank_mask:0x3
    v_add_f32_dpp v8, v9, v9 row_ror:8 row_mask:0xf bank_mask:0xc
    v_add_f32_dpp v10, v11, v11 row_ror:8 row_mask:0xf bank_mask:0xc
    s_nop 0
    v_add_f32_dpp v19, v8, v8 row_half_mirror row_mask:0xf bank_mask:0x5
    v_add_f32_dpp v19, v10, v10 row_half_mirror row_mask:0xf bank_mask:0xa
    s_nop 1
    v_add_f32_dpp v19, v19, v19 quad_perm:[1,0,3,2] row_mask:0xf bank_mask:0xf
    s_nop 1
    v_add_f32_dpp v19, v19, v19 quad_perm:[2,3,0,1] row_mask:0xf bank_mask:0xf
    v_max3_f32 v3, v12, v13, v14
    v_max3_f32 v8, v15, v16, v17
    v_max3_f32 v3, v3, v18, v19
    v_max_f32 v3, v3, v8
    s_nop 1
    v_max_f32_dpp v3, v3, v3 row_ror:4 row_mask:0xf bank_mask:0xf
    s_nop 1
    v_max_f32_dpp v3, v3, v3 row_ror:8 row_mask:0xf bank_mask:0xf
    v_mov_b32 v8, v3
    s_nop 1
    v_permlane16_swap_b32 v3, v8
    v_max_f32 v3, v3, v8
    v_mov_b32 v8, v3
    s_nop 1
    v_permlane32_swap_b32 v3, v8
    v_max_f32 v3, v3, v8
    s_mov_b32 s96, 0x3e0293ee
    v_mul_f32 v8, s96, v3
    v_fma_f32 v12, v12, s96, -v8
    v_fma_f32 v13, v13, s96, -v8
    v_fma_f32 v14, v14, s96, -v8
    v_fma_f32 v15, v15, s96, -v8
    v_fma_f32 v16, v16, s96, -v8
    v_fma_f32 v17, v17, s96, -v8
    v_fma_f32 v18, v18, s96, -v8
    v_fma_f32 v19, v19, s96, -v8
    v_exp_f32 v12, v12
    v_exp_f32 v13, v13
    v_exp_f32 v14, v14
    v_exp_f32 v15, v15
    v_exp_f32 v16, v16
    v_exp_f32 v17, v17
    v_exp_f32 v18, v18
    v_exp_f32 v19, v19
    v_add_f32 v9, v12, v13
    v_add_f32 v10, v14, v15
    v_add_f32 v11, v16, v17
    v_add_f32 v3, v18, v19
    v_add_f32 v9, v9, v10
    v_add_f32 v3, v3, v11
    v_add_f32 v9, v9, v3
    v_cvt_pk_bf16_f32 v12, v12, v12
    v_cvt_pk_bf16_f32 v13, v13, v13
    v_cvt_pk_bf16_f32 v14, v14, v14
    v_cvt_pk_bf16_f32 v15, v15, v15
    v_cvt_pk_bf16_f32 v16, v16, v16
    v_cvt_pk_bf16_f32 v17, v17, v17
    v_cvt_pk_bf16_f32 v18, v18, v18
    v_cvt_pk_bf16_f32 v19, v19, v19
    v_add_f32_dpp v9, v9, v9 row_ror:4 row_mask:0xf bank_mask:0xf
    s_nop 1
    v_add_f32_dpp v9, v9, v9 row_ror:8 row_mask:0xf bank_mask:0xf
    v_mov_b32 v10, v9
    s_nop 1
    v_permlane16_swap_b32 v9, v10
    v_add_f32 v9, v9, v10
    v_mov_b32 v10, v9
    s_nop 1
    v_permlane32_swap_b32 v9, v10
    v_add_f32 v9, v9, v10
    s_mov_b64 exec, 1
    s_cmp_lg_u32 s13, 0
    s_cbranch_scc1 L_mljob
    s_lshl_b32 s96, s3, 3
    s_add_u32 s96, s96, 161920
    v_mov_b32 v10, s96
    v_mov_b32 v11, 162068
    v_mov_b32 v3, 1
    ds_write_b64 v10, v[8:9]
    ds_add_u32 v11, v3
L_mldone:
    s_mov_b64 exec, -1
    v_lshrrev_b32 v2, 1, v2
    v_and_b32_dpp v24, v14, v20 row_newbcast:0 row_mask:0xf bank_mask:0xf
    v_and_b32_dpp v25, v14, v21 row_newbcast:0 row_mask:0xf bank_mask:0xf
    v_and_b32_dpp v26, v14, v22 row_newbcast:0 row_mask:0xf bank_mask:0xf
    v_and_b32_dpp v27, v14, v23 row_newbcast:0 row_mask:0xf bank_mask:0xf
    s_waitcnt vmcnt(3)
    s_bitcmp0_b32 s14, 12
    s_cbranch_scc1 L_sf_71
    s_waitcnt vmcnt(2)
    s_bitcmp0_b32 s15, 12
    s_cbranch_scc1 L_sf_71
    s_waitcnt vmcnt(1)
L_sf_71:
    buffer_load_dwordx4 v[88:91], v1, s[52:55], s97 offen offset:0 nt
    v_mfma_f32_16x16x32_bf16 v[32:35], v[24:27], v[72:75], v[32:35]
    s_cmp_eq_u32 s12, -1
    s_cbranch_scc1 L_nopfpv8
    s_waitcnt lgkmcnt(0)
    v_and_b32_dpp v24, v12, v20 row_newbcast:0 row_mask:0xf bank_mask:0xf
    v_and_b32_dpp v25, v12, v21 row_newbcast:0 row_mask:0xf bank_mask:0xf
    v_and_b32_dpp v26, v12, v22 row_newbcast:0 row_mask:0xf bank_mask:0xf
    v_and_b32_dpp v27, v12, v23 row_newbcast:0 row_mask:0xf bank_mask:0xf
    s_nop 1
    v_mfma_f32_16x16x32_bf16 v[32:35], v[24:27], v[40:43], v[32:35]
    v_and_b32_dpp v28, v12, v20 row_newbcast:8 row_mask:0xf bank_mask:0xf
    v_and_b32_dpp v29, v12, v21 row_newbcast:8 row_mask:0xf bank_mask:0xf
    v_and_b32_dpp v30, v12, v22 row_newbcast:8 row_mask:0xf bank_mask:0xf
    v_and_b32_dpp v31, v12, v23 row_newbcast:8 row_mask:0xf bank_mask:0xf
    s_nop 1
    v_mfma_f32_16x16x32_bf16 v[32:35], v[28:31], v[44:47], v[32:35]
    v_and_b32_dpp v24, v12, v20 row_newbcast:4 row_mask:0xf bank_mask:0xf
    v_and_b32_dpp v25, v12, v21 row_newbcast:4 row_mask:0xf bank_mask:0xf
    v_and_b32_dpp v26, v12, v22 row_newbcast:4 row_mask:0xf bank_mask:0xf
    v_and_b32_dpp v27, v12, v23 row_newbcast:4 row_mask:0xf bank_mask:0xf
    s_nop 1
    v_mfma_f32_16x16x32_bf16 v[32:35], v[24:27], v[48:51], v[32:35]
    v_and_b32_dpp v28, v12, v20 row_newbcast:12 row_mask:0xf bank_mask:0xf
    v_and_b32_dpp v29, v12, v21 row_newbcast:12 row_mask:0xf bank_mask:0xf
    v_and_b32_dpp v30, v12, v22 row_newbcast:12 row_mask:0xf bank_mask:0xf
    v_and_b32_dpp v31, v12, v23 row_newbcast:12 row_mask:0xf bank_mask:0xf
    s_nop 1
    v_mfma_f32_16x16x32_bf16 v[32:35], v[28:31], v[52:55], v[32:35]
L_nopfpv8:
    v_and_b32_dpp v28, v14, v20 row_newbcast:8 row_mask:0xf bank_mask:0xf
    v_and_b32_dpp v29, v14, v21 row_newbcast:8 row_mask:0xf bank_mask:0xf
    v_and_b32_dpp v30, v14, v22 row_newbcast:8 row_mask:0xf bank_mask:0xf
    v_and_b32_dpp v31, v14, v23 row_newbcast:8 row_mask:0xf bank_mask:0xf
    s_waitcnt vmcnt(3)
    s_bitcmp0_b32 s14, 13
    s_cbranch_scc1 L_sf_72
    s_waitcnt vmcnt(2)
    s_bitcmp0_b32 s15, 13
    s_cbranch_scc1 L_sf_72
    s_waitcnt vmcnt(1)
L_sf_72:
    buffer_load_dwordx4 v[92:95], v1, s[52:55], s97 offen offset:1024 nt
    v_mfma_f32_16x16x32_bf16 v[32:35], v[28:31], v[76:79], v[32:35]
    s_cmp_eq_u32 s12, -1
    s_cbranch_scc1 L_nopfpv9
    s_waitcnt lgkmcnt(0)
    v_and_b32_dpp v24, v13, v20 row_newbcast:0 row_mask:0xf bank_mask:0xf
    v_and_b32_dpp v25, v13, v21 row_newbcast:0 row_mask:0xf bank_mask:0xf
    v_and_b32_dpp v26, v13, v22 row_newbcast:0 row_mask:0xf bank_mask:0xf
    v_and_b32_dpp v27, v13, v23 row_newbcast:0 row_mask:0xf bank_mask:0xf
    s_nop 1
    v_mfma_f32_16x16x32_bf16 v[32:35], v[24:27], v[56:59], v[32:35]
    v_and_b32_dpp v28, v13, v20 row_newbcast:8 row_mask:0xf bank_mask:0xf
    v_and_b32_dpp v29, v13, v21 row_newbcast:8 row_mask:0xf bank_mask:0xf
    v_and_b32_dpp v30, v13, v22 row_newbcast:8 row_mask:0xf bank_mask:0xf
    v_and_b32_dpp v31, v13, v23 row_newbcast:8 row_mask:0xf bank_mask:0xf
    s_nop 1
    v_mfma_f32_16x16x32_bf16 v[32:35], v[28:31], v[60:63], v[32:35]
    v_and_b32_dpp v24, v13, v20 row_newbcast:4 row_mask:0xf bank_mask:0xf
    v_and_b32_dpp v25, v13, v21 row_newbcast:4 row_mask:0xf bank_mask:0xf
    v_and_b32_dpp v26, v13, v22 row_newbcast:4 row_mask:0xf bank_mask:0xf
    v_and_b32_dpp v27, v13, v23 row_newbcast:4 row_mask:0xf bank_mask:0xf
    s_nop 1
    v_mfma_f32_16x16x32_bf16 v[32:35], v[24:27], v[64:67], v[32:35]
    v_and_b32_dpp v28, v13, v20 row_newbcast:12 row_mask:0xf bank_mask:0xf
    v_and_b32_dpp v29, v13, v21 row_newbcast:12 row_mask:0xf bank_mask:0xf
    v_and_b32_dpp v30, v13, v22 row_newbcast:12 row_mask:0xf bank_mask:0xf
    v_and_b32_dpp v31, v13, v23 row_newbcast:12 row_mask:0xf bank_mask:0xf
    s_nop 1
    v_mfma_f32_16x16x32_bf16 v[32:35], v[28:31], v[68:71], v[32:35]
L_nopfpv9:
    v_and_b32_dpp v24, v14, v20 row_newbcast:4 row_mask:0xf bank_mask:0xf
    v_and_b32_dpp v25, v14, v21 row_newbcast:4 row_mask:0xf bank_mask:0xf
    v_and_b32_dpp v26, v14, v22 row_newbcast:4 row_mask:0xf bank_mask:0xf
    v_and_b32_dpp v27, v14, v23 row_newbcast:4 row_mask:0xf bank_mask:0xf
    s_waitcnt vmcnt(3)
    s_bitcmp0_b32 s14, 14
    s_cbranch_scc1 L_sf_73
    s_waitcnt vmcnt(2)
    s_bitcmp0_b32 s15, 14
    s_cbranch_scc1 L_sf_73
    s_waitcnt vmcnt(1)
L_sf_73:
    buffer_load_dwordx4 v[96:99], v1, s[52:55], s97 offen offset:2048 nt
    v_mfma_f32_16x16x32_bf16 v[32:35], v[24:27], v[80:83], v[32:35]
    v_and_b32_dpp v28, v14, v20 row_newbcast:12 row_mask:0xf bank_mask:0xf
    v_and_b32_dpp v29, v14, v21 row_newbcast:12 row_mask:0xf bank_mask:0xf
    v_and_b32_dpp v30, v14, v22 row_newbcast:12 row_mask:0xf bank_mask:0xf
    v_and_b32_dpp v31, v14, v23 row_newbcast:12 row_mask:0xf bank_mask:0xf
    s_waitcnt vmcnt(3)
    s_bitcmp0_b32 s14, 15
    s_cbranch_scc1 L_sf_74
    s_waitcnt vmcnt(2)
    s_bitcmp0_b32 s15, 15
    s_cbranch_scc1 L_sf_74
    s_waitcnt vmcnt(1)
L_sf_74:
    buffer_load_dwordx4 v[100:103], v1, s[52:55], s97 offen offset:3072 nt
    s_add_u32 s97, s97, 32768
    v_add_u32 v1, 4096, v1
    v_and_b32 v1, 0x7fff, v1
    v_mfma_f32_16x16x32_bf16 v[32:35], v[28:31], v[84:87], v[32:35]
    v_and_b32_dpp v24, v15, v20 row_newbcast:0 row_mask:0xf bank_mask:0xf
    v_and_b32_dpp v25, v15, v21 row_newbcast:0 row_mask:0xf bank_mask:0xf
    v_and_b32_dpp v26, v15, v22 row_newbcast:0 row_mask:0xf bank_mask:0xf
    v_and_b32_dpp v27, v15, v23 row_newbcast:0 row_mask:0xf bank_mask:0xf
    s_waitcnt vmcnt(3)
    s_bitcmp0_b32 s14, 16
    s_cbranch_scc1 L_sf_75
    s_waitcnt vmcnt(2)
    s_bitcmp0_b32 s15, 16
    s_cbranch_scc1 L_sf_75
    s_waitcnt vmcnt(1)
L_sf_75:
    buffer_load_dwordx4 v[104:107], v1, s[52:55], s97 offen offset:0 nt
    v_mfma_f32_16x16x32_bf16 v[32:35], v[24:27], v[88:91], v[32:35]
    v_and_b32_dpp v28, v15, v20 row_newbcast:8 row_mask:0xf bank_mask:0xf
    v_and_b32_dpp v29, v15, v21 row_newbcast:8 row_mask:0xf bank_mask:0xf
    v_and_b32_dpp v30, v15, v22 row_newbcast:8 row_mask:0xf bank_mask:0xf
    v_and_b32_dpp v31, v15, v23 row_newbcast:8 row_mask:0xf bank_mask:0xf
    s_waitcnt vmcnt(3)
    s_bitcmp0_b32 s14, 17
    s_cbranch_scc1 L_sf_76
    s_waitcnt vmcnt(2)
    s_bitcmp0_b32 s15, 17
    s_cbranch_scc1 L_sf_76
    s_waitcnt vmcnt(1)
L_sf_76:
    buffer_load_dwordx4 v[108:111], v1, s[52:55], s97 offen offset:1024 nt
    v_mfma_f32_16x16x32_bf16 v[32:35], v[28:31], v[92:95], v[32:35]
    v_and_b32_dpp v24, v15, v20 row_newbcast:4 row_mask:0xf bank_mask:0xf
    v_and_b32_dpp v25, v15, v21 row_newbcast:4 row_mask:0xf bank_mask:0xf
    v_and_b32_dpp v26, v15, v22 row_newbcast:4 row_mask:0xf bank_mask:0xf
    v_and_b32_dpp v27, v15, v23 row_newbcast:4 row_mask:0xf bank_mask:0xf
    s_waitcnt vmcnt(3)
    s_bitcmp0_b32 s14, 18
    s_cbranch_scc1 L_sf_77
    s_waitcnt vmcnt(2)
    s_bitcmp0_b32 s15, 18
    s_cbranch_scc1 L_sf_77
    s_waitcnt vmcnt(1)
L_sf_77:
    buffer_load_dwordx4 v[112:115], v1, s[52:55], s97 offen offset:2048 nt
    v_mfma_f32_16x16x32_bf16 v[32:35], v[24:27], v[96:99], v[32:35]
    v_and_b32_dpp v28, v15, v20 row_newbcast:12 row_mask:0xf bank_mask:0xf
    v_and_b32_dpp v29, v15, v21 row_newbcast:12 row_mask:0xf bank_mask:0xf
    v_and_b32_dpp v30, v15, v22 row_newbcast:12 row_mask:0xf bank_mask:0xf
    v_and_b32_dpp v31, v15, v23 row_newbcast:12 row_mask:0xf bank_mask:0xf
    s_waitcnt vmcnt(3)
    s_bitcmp0_b32 s14, 19
    s_cbranch_scc1 L_sf_78
    s_waitcnt vmcnt(2)
    s_bitcmp0_b32 s15, 19
    s_cbranch_scc1 L_sf_78
    s_waitcnt vmcnt(1)
L_sf_78:
    buffer_load_dwordx4 v[116:119], v1, s[52:55], s97 offen offset:3072 nt
    s_add_u32 s97, s97, 32768
    v_add_u32 v1, 4096, v1
    v_and_b32 v1, 0x7fff, v1
    v_mfma_f32_16x16x32_bf16 v[32:35], v[28:31], v[100:103], v[32:35]
    v_and_b32_dpp v24, v16, v20 row_newbcast:0 row_mask:0xf bank_mask:0xf
    v_and_b32_dpp v25, v16, v21 row_newbcast:0 row_mask:0xf bank_mask:0xf
    v_and_b32_dpp v26, v16, v22 row_newbcast:0 row_mask:0xf bank_mask:0xf
    v_and_b32_dpp v27, v16, v23 row_newbcast:0 row_mask:0xf bank_mask:0xf
    s_waitcnt vmcnt(3)
    s_bitcmp0_b32 s14, 20
    s_cbranch_scc1 L_sf_79
    s_waitcnt vmcnt(2)
    s_bitcmp0_b32 s15, 20
    s_cbranch_scc1 L_sf_79
    s_waitcnt vmcnt(1)
L_sf_79:
    buffer_load_dwordx4 v[120:123], v1, s[52:55], s97 offen offset:0 nt
    v_mfma_f32_16x16x32_bf16 v[32:35], v[24:27], v[104:107], v[32:35]
    v_and_b32_dpp v28, v16, v20 row_newbcast:8 row_mask:0xf bank_mask:0xf
    v_and_b32_dpp v29, v16, v21 row_newbcast:8 row_mask:0xf bank_mask:0xf
    v_and_b32_dpp v30, v16, v22 row_newbcast:8 row_mask:0xf bank_mask:0xf
    v_and_b32_dpp v31, v16, v23 row_newbcast:8 row_mask:0xf bank_mask:0xf
    s_waitcnt vmcnt(3)
    s_bitcmp0_b32 s14, 21
    s_cbranch_scc1 L_sf_80
    s_waitcnt vmcnt(2)
    s_bitcmp0_b32 s15, 21
    s_cbranch_scc1 L_sf_80
    s_waitcnt vmcnt(1)
L_sf_80:
    buffer_load_dwordx4 v[124:127], v1, s[52:55], s97 offen offset:1024 nt
    v_mfma_f32_16x16x32_bf16 v[32:35], v[28:31], v[108:111], v[32:35]
    v_and_b32_dpp v24, v16, v20 row_newbcast:4 row_mask:0xf bank_mask:0xf
    v_and_b32_dpp v25, v16, v21 row_newbcast:4 row_mask:0xf bank_mask:0xf
    v_and_b32_dpp v26, v16, v22 row_newbcast:4 row_mask:0xf bank_mask:0xf
    v_and_b32_dpp v27, v16, v23 row_newbcast:4 row_mask:0xf bank_mask:0xf
    s_waitcnt vmcnt(3)
    s_bitcmp0_b32 s14, 22
    s_cbranch_scc1 L_sf_81
    s_waitcnt vmcnt(2)
    s_bitcmp0_b32 s15, 22
    s_cbranch_scc1 L_sf_81
    s_waitcnt vmcnt(1)
L_sf_81:
    buffer_load_dwordx4 v[128:131], v1, s[52:55], s97 offen offset:2048 nt
    v_mfma_f32_16x16x32_bf16 v[32:35], v[24:27], v[112:115], v[32:35]
    v_and_b32_dpp v28, v16, v20 row_newbcast:12 row_mask:0xf bank_mask:0xf
    v_and_b32_dpp v29, v16, v21 row_newbcast:12 row_mask:0xf bank_mask:0xf
    v_and_b32_dpp v30, v16, v22 row_newbcast:12 row_mask:0xf bank_mask:0xf
    v_and_b32_dpp v31, v16, v23 row_newbcast:12 row_mask:0xf bank_mask:0xf
    s_waitcnt vmcnt(3)
    s_bitcmp0_b32 s14, 23
    s_cbranch_scc1 L_sf_82
    s_waitcnt vmcnt(2)
    s_bitcmp0_b32 s15, 23
    s_cbranch_scc1 L_sf_82
    s_waitcnt vmcnt(1)
L_sf_82:
    buffer_load_dwordx4 v[132:135], v1, s[52:55], s97 offen offset:3072 nt
    s_add_u32 s97, s97, 32768
    v_add_u32 v1, 4096, v1
    v_and_b32 v1, 0x7fff, v1
    v_mfma_f32_16x16x32_bf16 v[32:35], v[28:31], v[116:119], v[32:35]
    v_and_b32_dpp v24, v17, v20 row_newbcast:0 row_mask:0xf bank_mask:0xf
    v_and_b32_dpp v25, v17, v21 row_newbcast:0 row_mask:0xf bank_mask:0xf
    v_and_b32_dpp v26, v17, v22 row_newbcast:0 row_mask:0xf bank_mask:0xf
    v_and_b32_dpp v27, v17, v23 row_newbcast:0 row_mask:0xf bank_mask:0xf
    s_waitcnt vmcnt(3)
    s_bitcmp0_b32 s14, 24
    s_cbranch_scc1 L_sf_83
    s_waitcnt vmcnt(2)
    s_bitcmp0_b32 s15, 24
    s_cbranch_scc1 L_sf_83
    s_waitcnt vmcnt(1)
L_sf_83:
    buffer_load_dwordx4 v[136:139], v1, s[52:55], s97 offen offset:0 nt
    v_mfma_f32_16x16x32_bf16 v[32:35], v[24:27], v[120:123], v[32:35]
    s_or_b32 s96, s59, 0
    s_cbranch_scc0 L_nofrag_84
    v_mov_b32 v104, 162060
L_lw_85:
    ds_read_b32 v105, v104
    s_waitcnt lgkmcnt(0)
    v_cmp_gt_u32 vcc, 4, v105
    s_cbranch_vccz L_lw_85e
    s_sleep 2
    s_sub_u32 s60, s60, 1
    s_cbranch_scc0 L_lw_85
    s_mov_b32 s60, 0
L_lw_85e:
    s_cmp_eq_u32 s59, 0
    s_cbranch_scc1 L_nofrag_84
    v_bfe_u32 v104, v0, 2, 1
    v_bfe_u32 v110, v0, 4, 1
    v_lshl_add_u32 v104, v110, 2, v104
    v_and_b32 v110, 8, v0
    v_add_u32 v104, v104, v110
    v_lshrrev_b32 v110, 5, v0
    v_lshl_add_u32 v104, v110, 4, v104
    v_bfe_u32 v111, v0, 0, 1
    v_mul_u32_u24 v111, 0xaaaa, v111
    v_add_u32 v111, 0x4444, v111
    v_mov_b32 v112, 0
    v_mov_b32 v113, 0
    v_mov_b32 v114, 0
    v_mov_b32 v115, 0
    v_mov_b32 v116, 0
    v_mov_b32 v117, 0
    v_mov_b32 v118, 0
    v_mov_b32 v119, 0
    v_lshlrev_b32 v104, 7, v104
    v_and_b32 v110, 3, v0
    v_lshl_add_u32 v104, v110, 3, v104
    v_lshrrev_b32 v109, 4, v0
    v_and_b32 v110, 1, v0
    s_lshr_b32 s63, s3, 1
    s_and_b32 s62, s3, 1
    s_lshl_b32 s96, s63, 14
    s_lshl_b32 s100, s62, 6
    s_add_u32 s100, s100, 81920
    s_add_u32 s96, s96, s100
    v_add_u32 v104, s96, v104
    ds_read_b64_tr_b16 v[72:73], v104 offset:0
    ds_read_b64_tr_b16 v[74:75], v104 offset:256
    ds_read_b64_tr_b16 v[76:77], v104 offset:4096
    ds_read_b64_tr_b16 v[78:79], v104 offset:4352
    ds_read_b64_tr_b16 v[80:81], v104 offset:32
    ds_read_b64_tr_b16 v[82:83], v104 offset:288
    ds_read_b64_tr_b16 v[84:85], v104 offset:4128
    ds_read_b64_tr_b16 v[86:87], v104 offset:4384
    ds_read_b64_tr_b16 v[88:89], v104 offset:8192
    ds_read_b64_tr_b16 v[90:91], v104 offset:8448
    ds_read_b64_tr_b16 v[92:93], v104 offset:12288
    ds_read_b64_tr_b16 v[94:95], v104 offset:12544
    ds_read_b64_tr_b16 v[96:97], v104 offset:8224
    ds_read_b64_tr_b16 v[98:99], v104 offset:8480
    ds_read_b64_tr_b16 v[100:101], v104 offset:12320
    ds_read_b64_tr_b16 v[102:103], v104 offset:12576
    v_bfe_u32 v105, v0, 1, 3
    v_lshlrev_b32 v105, 8, v105
    v_lshl_add_u32 v105, v109, 5, v105
    v_lshl_add_u32 v105, v110, 4, v105
    v_lshrrev_b32 v106, 3, v0
    v_lshlrev_b32 v106, 7, v106
    v_and_b32 v110, 7, v0
    v_lshl_add_u32 v107, v110, 3, v106
    v_add_u32 v107, s100, v107
    v_lshlrev_b32 v106, 8, v109
    v_and_b32 v110, 15, v0
    v_lshl_add_u32 v106, v110, 2, v106
    v_add_u32 v106, s96, v106
    v_lshlrev_b32 v108, 2, v0
    s_lshl_b32 s96, s62, 2
    s_add_u32 s96, s96, 162088
    v_mov_b32 v109, s96
    s_lshl_b32 s100, s63, 11
    s_lshl_b32 s96, s34, 13
    s_add_u32 s100, s100, s96
    s_add_u32 s100, s100, 106496
    s_mul_i32 s101, s34, 5120
    s_lshl_b32 s96, s35, 9
    s_add_u32 s101, s101, s96
    s_lshl_b32 s96, s62, 8
    s_add_u32 s101, s101, s96
    s_sub_u32 s101, s101, 11264
    s_and_b32 s96, s101, 0xffffe000
    s_add_u32 s101, s101, s96
    s_add_u32 s101, s101, 212992
    v_add_u32 v110, 8192, v108
L_nofrag_84:
    v_and_b32_dpp v28, v17, v20 row_newbcast:8 row_mask:0xf bank_mask:0xf
    v_and_b32_dpp v29, v17, v21 row_newbcast:8 row_mask:0xf bank_mask:0xf
    v_and_b32_dpp v30, v17, v22 row_newbcast:8 row_mask:0xf bank_mask:0xf
    v_and_b32_dpp v31, v17, v23 row_newbcast:8 row_mask:0xf bank_mask:0xf
    s_waitcnt vmcnt(3)
    s_bitcmp0_b32 s14, 25
    s_cbranch_scc1 L_sf_86
    s_waitcnt vmcnt(2)
    s_bitcmp0_b32 s15, 25
    s_cbranch_scc1 L_sf_86
    s_waitcnt vmcnt(1)
L_sf_86:
    buffer_load_dwordx4 v[140:143], v1, s[52:55], s97 offen offset:1024 nt
    v_mfma_f32_16x16x32_bf16 v[32:35], v[28:31], v[124:127], v[32:35]
    v_and_b32_dpp v24, v17, v20 row_newbcast:4 row_mask:0xf bank_mask:0xf
    v_and_b32_dpp v25, v17, v21 row_newbcast:4 row_mask:0xf bank_mask:0xf
    v_and_b32_dpp v26, v17, v22 row_newbcast:4 row_mask:0xf bank_mask:0xf
    v_and_b32_dpp v27, v17, v23 row_newbcast:4 row_mask:0xf bank_mask:0xf
    s_waitcnt vmcnt(3)
    s_bitcmp0_b32 s14, 26
    s_cbranch_scc1 L_sf_87
    s_waitcnt vmcnt(2)
    s_bitcmp0_b32 s15, 26
    s_cbranch_scc1 L_sf_87
    s_waitcnt vmcnt(1)
L_sf_87:
    buffer_load_dwordx4 v[144:147], v1, s[52:55], s97 offen offset:2048 nt
    v_mfma_f32_16x16x32_bf16 v[32:35], v[24:27], v[128:131], v[32:35]
    v_and_b32_dpp v28, v17, v20 row_newbcast:12 row_mask:0xf bank_mask:0xf
    v_and_b32_dpp v29, v17, v21 row_newbcast:12 row_mask:0xf bank_mask:0xf
    v_and_b32_dpp v30, v17, v22 row_newbcast:12 row_mask:0xf bank_mask:0xf
    v_and_b32_dpp v31, v17, v23 row_newbcast:12 row_mask:0xf bank_mask:0xf
    s_waitcnt vmcnt(3)
    s_bitcmp0_b32 s14, 27
    s_cbranch_scc1 L_sf_88
    s_waitcnt vmcnt(2)
    s_bitcmp0_b32 s15, 27
    s_cbranch_scc1 L_sf_88
    s_waitcnt vmcnt(1)
L_sf_88:
    buffer_load_dwordx4 v[148:151], v1, s[52:55], s97 offen offset:3072 nt
    s_add_u32 s97, s97, 32768
    v_add_u32 v1, 4096, v1
    v_and_b32 v1, 0x7fff, v1
    v_mfma_f32_16x16x32_bf16 v[32:35], v[28:31], v[132:135], v[32:35]
    v_and_b32_dpp v24, v18, v20 row_newbcast:0 row_mask:0xf bank_mask:0xf
    v_and_b32_dpp v25, v18, v21 row_newbcast:0 row_mask:0xf bank_mask:0xf
    v_and_b32_dpp v26, v18, v22 row_newbcast:0 row_mask:0xf bank_mask:0xf
    v_and_b32_dpp v27, v18, v23 row_newbcast:0 row_mask:0xf bank_mask:0xf
    s_waitcnt vmcnt(3)
    s_bitcmp0_b32 s14, 28
    s_cbranch_scc1 L_sf_89
    s_waitcnt vmcnt(2)
    s_bitcmp0_b32 s15, 28
    s_cbranch_scc1 L_sf_89
    s_waitcnt vmcnt(1)
L_sf_89:
    buffer_load_dwordx4 v[152:155], v1, s[52:55], s97 offen offset:0 nt
    v_mfma_f32_16x16x32_bf16 v[32:35], v[24:27], v[136:139], v[32:35]
    v_mov_b32 v10, 162076
    v_mov_b32 v11, 1
    s_mov_b64 exec, 1
    ds_add_u32 v10, v11
    s_mov_b64 exec, -1
    v_and_b32_dpp v28, v18, v20 row_newbcast:8 row_mask:0xf bank_mask:0xf
    v_and_b32_dpp v29, v18, v21 row_newbcast:8 row_mask:0xf bank_mask:0xf
    v_and_b32_dpp v30, v18, v22 row_newbcast:8 row_mask:0xf bank_mask:0xf
    v_and_b32_dpp v31, v18, v23 row_newbcast:8 row_mask:0xf bank_mask:0xf
    s_waitcnt vmcnt(3)
    s_bitcmp0_b32 s14, 29
    s_cbranch_scc1 L_sf_90
    s_waitcnt vmcnt(2)
    s_bitcmp0_b32 s15, 29
    s_cbranch_scc1 L_sf_90
    s_waitcnt vmcnt(1)
L_sf_90:
    buffer_load_dwordx4 v[156:159], v1, s[52:55], s97 offen offset:1024 nt
    v_mfma_f32_16x16x32_bf16 v[32:35], v[28:31], v[140:143], v[32:35]
    v_and_b32_dpp v24, v18, v20 row_newbcast:4 row_mask:0xf bank_mask:0xf
    v_and_b32_dpp v25, v18, v21 row_newbcast:4 row_mask:0xf bank_mask:0xf
    v_and_b32_dpp v26, v18, v22 row_newbcast:4 row_mask:0xf bank_mask:0xf
    v_and_b32_dpp v27, v18, v23 row_newbcast:4 row_mask:0xf bank_mask:0xf
    s_waitcnt vmcnt(3)
    s_bitcmp0_b32 s14, 30
    s_cbranch_scc1 L_sf_91
    s_waitcnt vmcnt(2)
    s_bitcmp0_b32 s15, 30
    s_cbranch_scc1 L_sf_91
    s_waitcnt vmcnt(1)
L_sf_91:
    buffer_load_dwordx4 v[160:163], v1, s[52:55], s97 offen offset:2048 nt
    v_mfma_f32_16x16x32_bf16 v[32:35], v[24:27], v[144:147], v[32:35]
    v_lshrrev_b32 v9, 4, v0
    v_lshl_add_u32 v8, v9, 2, v2
    s_lshl_b32 s96, s3, 9
    s_add_u32 s96, s96, 157824
    v_lshl_add_u32 v8, v8, 2, s96
    v_lshlrev_b32 v9, 3, v0
    v_add_u32 v9, 157824, v9
    v_mov_b32 v10, 162048
    v_mov_b32 v11, 1
    s_lshl_b32 s96, s38, 5
    s_add_u32 s96, s96, 161984
    v_mov_b32 v3, s96
    s_sub_u32 s62, 8, s39
    s_lshl_b32 s98, s34, 5
    s_add_u32 s98, s98, s35
    s_lshl_b32 s98, s98, 8
    s_add_u32 s98, s98, 106496
    v_lshlrev_b32 v39, 2, v0
    v_and_b32_dpp v28, v18, v20 row_newbcast:12 row_mask:0xf bank_mask:0xf
    v_and_b32_dpp v29, v18, v21 row_newbcast:12 row_mask:0xf bank_mask:0xf
    v_and_b32_dpp v30, v18, v22 row_newbcast:12 row_mask:0xf bank_mask:0xf
    v_and_b32_dpp v31, v18, v23 row_newbcast:12 row_mask:0xf bank_mask:0xf
    s_waitcnt vmcnt(3)
    s_bitcmp0_b32 s14, 31
    s_cbranch_scc1 L_sf_92
    s_waitcnt vmcnt(2)
    s_bitcmp0_b32 s15, 31
    s_cbranch_scc1 L_sf_92
    s_waitcnt vmcnt(1)
L_sf_92:
    buffer_load_dwordx4 v[164:167], v1, s[52:55], s97 offen offset:3072 nt
    s_mov_b32 s97, 0
    v_add_u32 v1, 4096, v1
    v_and_b32 v1, 0x7fff, v1
    v_mfma_f32_16x16x32_bf16 v[32:35], v[28:31], v[148:151], v[32:35]
    s_cmp_eq_u32 s12, -1
    s_cbranch_scc1 L_v_nopf
    v_and_b32_dpp v24, v19, v20 row_newbcast:0 row_mask:0xf bank_mask:0xf
    v_and_b32_dpp v25, v19, v21 row_newbcast:0 row_mask:0xf bank_mask:0xf
    v_and_b32_dpp v26, v19, v22 row_newbcast:0 row_mask:0xf bank_mask:0xf
    v_and_b32_dpp v27, v19, v23 row_newbcast:0 row_mask:0xf bank_mask:0xf
    s_waitcnt vmcnt(3)
    s_nop 0
    v_mfma_f32_16x16x32_bf16 v[32:35], v[24:27], v[152:155], v[32:35]
    v_and_b32_dpp v28, v19, v20 row_newbcast:8 row_mask:0xf bank_mask:0xf
    v_and_b32_dpp v29, v19, v21 row_newbcast:8 row_mask:0xf bank_mask:0xf
    v_and_b32_dpp v30, v19, v22 row_newbcast:8 row_mask:0xf bank_mask:0xf
    v_and_b32_dpp v31, v19, v23 row_newbcast:8 row_mask:0xf bank_mask:0xf
    s_waitcnt vmcnt(2)
    s_nop 0
    v_mfma_f32_16x16x32_bf16 v[32:35], v[28:31], v[156:159], v[32:35]
    v_and_b32_dpp v24, v19, v20 row_newbcast:4 row_mask:0xf bank_mask:0xf
    v_and_b32_dpp v25, v19, v21 row_newbcast:4 row_mask:0xf bank_mask:0xf
    v_and_b32_dpp v26, v19, v22 row_newbcast:4 row_mask:0xf bank_mask:0xf
    v_and_b32_dpp v27, v19, v23 row_newbcast:4 row_mask:0xf bank_mask:0xf
    s_waitcnt vmcnt(1)
    s_nop 0
    v_mfma_f32_16x16x32_bf16 v[32:35], v[24:27], v[160:163], v[32:35]
    v_and_b32_dpp v28, v19, v20 row_newbcast:12 row_mask:0xf bank_mask:0xf
    v_and_b32_dpp v29, v19, v21 row_newbcast:12 row_mask:0xf bank_mask:0xf
    v_and_b32_dpp v30, v19, v22 row_newbcast:12 row_mask:0xf bank_mask:0xf
    v_and_b32_dpp v31, v19, v23 row_newbcast:12 row_mask:0xf bank_mask:0xf
    s_waitcnt vmcnt(0)
    s_nop 0
    v_mfma_f32_16x16x32_bf16 v[32:35], v[28:31], v[164:167], v[32:35]
L_v_join:
    s_cmp_lg_u32 s13, 0
    s_cbranch_scc1 L_jobend
L_t0:
    s_mov_b32 exec_hi, 0
    s_nop 4
    ds_write_b128 v8, v[32:35]
L_t0b:
    s_mov_b64 exec, 1
    ds_add_rtn_u32 v37, v10, v11
    s_mov_b64 exec, -1
    ds_read_b32 v38, v10 offset:24
    ds_read_b128 v[24:27], v3
    ds_read_b128 v[28:31], v3 offset:16
    ds_read_b64 v[144:145], v9 offset:0
    ds_read_b64 v[146:147], v9 offset:512
    ds_read_b64 v[148:149], v9 offset:1024
    ds_read_b64 v[150:151], v9 offset:1536
    ds_read_b64 v[152:153], v9 offset:2048
    ds_read_b64 v[154:155], v9 offset:2560
    ds_read_b64 v[156:157], v9 offset:3072
    ds_read_b64 v[158:159], v9 offset:3584
    s_waitcnt lgkmcnt(10)
    v_readfirstlane_b32 s96, v37
    v_readfirstlane_b32 s61, v38
    s_cmp_lg_u32 s96, s62
    s_cbranch_scc1 L_nopub
    s_waitcnt lgkmcnt(6)
    v_pk_mul_f32 v[144:145], v[144:145], v[24:25] op_sel:[0,0] op_sel_hi:[1,0]
    v_pk_mul_f32 v[146:147], v[146:147], v[24:25] op_sel:[0,1] op_sel_hi:[1,1]
    s_waitcnt lgkmcnt(4)
    v_pk_fma_f32 v[144:145], v[148:149], v[26:27], v[144:145] op_sel:[0,0,0] op_sel_hi:[1,0,1]
    v_pk_fma_f32 v[146:147], v[150:151], v[26:27], v[146:147] op_sel:[0,1,0] op_sel_hi:[1,1,1]
    s_waitcnt lgkmcnt(2)
    v_pk_fma_f32 v[144:145], v[152:153], v[28:29], v[144:145] op_sel:[0,0,0] op_sel_hi:[1,0,1]
    v_pk_fma_f32 v[146:147], v[154:155], v[28:29], v[146:147] op_sel:[0,1,0] op_sel_hi:[1,1,1]
    s_waitcnt lgkmcnt(0)
    v_pk_fma_f32 v[144:145], v[156:157], v[30:31], v[144:145] op_sel:[0,0,0] op_sel_hi:[1,0,1]
    v_pk_fma_f32 v[146:147], v[158:159], v[30:31], v[146:147] op_sel:[0,1,0] op_sel_hi:[1,1,1]
    s_cmp_eq_u32 s61, 1
    v_pk_add_f32 v[144:145], v[144:145], v[146:147]
    v_cvt_pk_bf16_f32 v32, v144, v145
    s_cbranch_scc0 L_oslow
    buffer_store_dword v32, v39, s[40:43], s98 offen
L_odone:
L_nopub:
    s_cmp_eq_u32 s59, 0
    s_cbranch_scc1 L_not1
L_poll_101:
    buffer_load_dwordx4 v[16:19], v105, s[40:43], s100 offen sc1
    buffer_load_dwordx4 v[20:23], v105, s[40:43], s100 offen offset:128 sc1
    s_sub_u32 s60, s60, 1
    s_cbranch_scc1 L_poll_101t
    s_waitcnt vmcnt(0)
    v_max3_u32 v38, v16, v17, v18
    v_max3_u32 v38, v38, v19, v20
    v_max3_u32 v38, v38, v21, v22
    v_max_u32 v38, v38, v23
    v_cmp_eq_u32 vcc, -1, v38
    s_cbranch_vccnz L_poll_101
L_poll_101e:
    v_smfmac_f32_16x16x64_bf16 v[112:115], v[16:19], v[72:79], v111
    v_smfmac_f32_16x16x64_bf16 v[116:119], v[16:19], v[80:87], v111
    v_smfmac_f32_16x16x64_bf16 v[112:115], v[20:23], v[88:95], v111
    v_smfmac_f32_16x16x64_bf16 v[116:119], v[20:23], v[96:103], v111
    s_nop 6
    v_pk_add_f32 v[112:113], v[112:113], v[114:115]
    v_pk_add_f32 v[116:117], v[116:117], v[118:119]
    v_add_f32 v12, v112, v113
    v_add_f32 v13, v116, v117
    ds_write2_b32 v106, v12, v13 offset0:0 offset1:32
    s_mov_b64 exec, 1
    ds_add_rtn_u32 v37, v109, v11
    s_mov_b64 exec, -1
    ds_read_b64 v[72:73], v107 offset:0
    ds_read_b64 v[74:75], v107 offset:16384
    ds_read_b64 v[76:77], v107 offset:32768
    ds_read_b64 v[78:79], v107 offset:49152
    s_cmp_eq_u32 s34, 2
    s_cselect_b32 s97, s61, 0
    s_waitcnt lgkmcnt(4)
    v_readfirstlane_b32 s96, v37
    s_waitcnt lgkmcnt(2)
    v_pk_add_f32 v[72:73], v[72:73], v[74:75]
    s_cmp_lg_u32 s96, 3
    s_cbranch_scc1 L_not1
    s_cmp_eq_u32 s97, 1
    s_waitcnt lgkmcnt(0)
    v_pk_add_f32 v[76:77], v[76:77], v[78:79]
    v_pk_add_f32 v[72:73], v[72:73], v[76:77]
    v_cvt_pk_bf16_f32 v12, v72, v73
    s_cbranch_scc1 L_pfast
    buffer_store_dword v12, v108, s[40:43], s101 offen sc1
    buffer_store_dword v12, v110, s[40:43], s101 offen sc1
L_pdone:
L_not1:
    s_waitcnt lgkmcnt(0)
    s_cmp_eq_u32 s39, 1
    s_cbranch_scc1 L_s_role
    s_cmp_eq_u32 s34, 2
    s_cselect_b32 s62, s59, 0
    s_cmp_eq_u32 s62, 1
    s_cbranch_scc1 L_refetch
L_norf:
    s_endpgm
L_k_nopf:
    s_waitcnt vmcnt(3)
    s_bitcmp0_b32 s57, 22
    s_cbranch_scc1 L_sf_57
    s_waitcnt vmcnt(2)
    s_bitcmp0_b32 s58, 22
    s_cbranch_scc1 L_sf_57
    s_waitcnt vmcnt(1)
L_sf_57:
    buffer_load_dwordx4 v[128:131], v1, s[48:51], s97 offen offset:2048 nt
    v_min_u32 v39, 15, v0
    v_and_b32 v38, 1, v39
    v_mul_u32_u24 v38, 126, v38
    v_lshl_add_u32 v39, v39, 1, v38
    buffer_load_dword v37, v39, s[44:47], 0 offen sc1
    s_waitcnt vmcnt(4)
    s_bitcmp0_b32 s57, 23
    s_cbranch_scc1 L_sf_58
    s_waitcnt vmcnt(3)
    s_bitcmp0_b32 s58, 23
    s_cbranch_scc1 L_sf_58
    s_waitcnt vmcnt(2)
L_sf_58:
    buffer_load_dwordx4 v[132:135], v1, s[48:51], s97 offen offset:3072 nt
    s_add_u32 s97, s97, 32768
    v_add_u32 v1, 4096, v1
    v_and_b32 v1, 0x7fff, v1
    s_waitcnt vmcnt(4)
    s_bitcmp0_b32 s57, 24
    s_cbranch_scc1 L_sf_59
    s_waitcnt vmcnt(3)
    s_bitcmp0_b32 s58, 24
    s_cbranch_scc1 L_sf_59
    s_waitcnt vmcnt(2)
L_sf_59:
    buffer_load_dwordx4 v[136:139], v1, s[48:51], s97 offen offset:0 nt
    s_waitcnt vmcnt(4)
    s_bitcmp0_b32 s57, 25
    s_cbranch_scc1 L_sf_60
    s_waitcnt vmcnt(3)
    s_bitcmp0_b32 s58, 25
    s_cbranch_scc1 L_sf_60
    s_waitcnt vmcnt(1)
L_sf_60:
    buffer_load_dwordx4 v[140:143], v1, s[48:51], s97 offen offset:1024 nt
    s_waitcnt vmcnt(4)
    s_bitcmp0_b32 s57, 26
    s_cbranch_scc1 L_sf_61
    s_waitcnt vmcnt(2)
    s_bitcmp0_b32 s58, 26
    s_cbranch_scc1 L_sf_61
    s_waitcnt vmcnt(1)
L_sf_61:
    buffer_load_dwordx4 v[144:147], v1, s[48:51], s97 offen offset:2048 nt
    s_waitcnt vmcnt(3)
    s_bitcmp0_b32 s57, 27
    s_cbranch_scc1 L_sf_62
    s_waitcnt vmcnt(2)
    s_bitcmp0_b32 s58, 27
    s_cbranch_scc1 L_sf_62
    s_waitcnt vmcnt(1)
L_sf_62:
    buffer_load_dwordx4 v[148:151], v1, s[48:51], s97 offen offset:3072 nt
    s_add_u32 s97, s97, 32768
    v_add_u32 v1, 4096, v1
    v_and_b32 v1, 0x7fff, v1
    v_cmp_eq_u32 vcc, 0, v37
    s_nop 0
    s_or_b32 s96, vcc_lo, vcc_hi
    buffer_load_dwordx4 v[4:7], v2, s[40:43], s98 offen sc1
    s_waitcnt vmcnt(4)
    s_bitcmp0_b32 s57, 28
    s_cbranch_scc1 L_sf_63
    s_waitcnt vmcnt(3)
    s_bitcmp0_b32 s58, 28
    s_cbranch_scc1 L_sf_63
    s_waitcnt vmcnt(2)
L_sf_63:
    buffer_load_dwordx4 v[152:155], v1, s[48:51], s97 offen offset:0 nt
    s_waitcnt vmcnt(4)
    s_bitcmp0_b32 s57, 29
    s_cbranch_scc1 L_sf_64
    s_waitcnt vmcnt(3)
    s_bitcmp0_b32 s58, 29
    s_cbranch_scc1 L_sf_64
    s_waitcnt vmcnt(2)
L_sf_64:
    buffer_load_dwordx4 v[156:159], v1, s[48:51], s97 offen offset:1024 nt
    s_waitcnt vmcnt(4)
    s_bitcmp0_b32 s57, 30
    s_cbranch_scc1 L_sf_65
    s_waitcnt vmcnt(3)
    s_bitcmp0_b32 s58, 30
    s_cbranch_scc1 L_sf_65
    s_waitcnt vmcnt(1)
L_sf_65:
    buffer_load_dwordx4 v[160:163], v1, s[48:51], s97 offen offset:2048 nt
    s_waitcnt vmcnt(4)
    s_bitcmp0_b32 s57, 31
    s_cbranch_scc1 L_sf_66
    s_waitcnt vmcnt(2)
    s_bitcmp0_b32 s58, 31
    s_cbranch_scc1 L_sf_66
    s_waitcnt vmcnt(1)
L_sf_66:
    buffer_load_dwordx4 v[164:167], v1, s[48:51], s97 offen offset:3072 nt
    s_mov_b32 s97, 0
    v_add_u32 v1, 4096, v1
    v_and_b32 v1, 0x7fff, v1
    v_add_u32 v1, 8192, v1
    v_and_b32 v1, 0x7fff, v1
    s_mov_b32 s97, 65536
    s_branch L_k_join
L_v_nopf:
    v_and_b32_dpp v24, v19, v20 row_newbcast:0 row_mask:0xf bank_mask:0xf
    v_and_b32_dpp v25, v19, v21 row_newbcast:0 row_mask:0xf bank_mask:0xf
    v_and_b32_dpp v26, v19, v22 row_newbcast:0 row_mask:0xf bank_mask:0xf
    v_and_b32_dpp v27, v19, v23 row_newbcast:0 row_mask:0xf bank_mask:0xf
    s_waitcnt vmcnt(3)
    s_bitcmp0_b32 s14, 0
    s_cbranch_scc1 L_sf_93
    s_waitcnt vmcnt(2)
    s_bitcmp0_b32 s15, 0
    s_cbranch_scc1 L_sf_93
    s_waitcnt vmcnt(1)
L_sf_93:
    buffer_load_dwordx4 v[40:43], v1, s[52:55], s97 offen offset:0 nt
    v_mfma_f32_16x16x32_bf16 v[32:35], v[24:27], v[152:155], v[32:35]
    v_and_b32_dpp v28, v19, v20 row_newbcast:8 row_mask:0xf bank_mask:0xf
    v_and_b32_dpp v29, v19, v21 row_newbcast:8 row_mask:0xf bank_mask:0xf
    v_and_b32_dpp v30, v19, v22 row_newbcast:8 row_mask:0xf bank_mask:0xf
    v_and_b32_dpp v31, v19, v23 row_newbcast:8 row_mask:0xf bank_mask:0xf
    s_waitcnt vmcnt(3)
    s_bitcmp0_b32 s14, 1
    s_cbranch_scc1 L_sf_94
    s_waitcnt vmcnt(2)
    s_bitcmp0_b32 s15, 1
    s_cbranch_scc1 L_sf_94
    s_waitcnt vmcnt(1)
L_sf_94:
    buffer_load_dwordx4 v[44:47], v1, s[52:55], s97 offen offset:1024 nt
    v_mfma_f32_16x16x32_bf16 v[32:35], v[28:31], v[156:159], v[32:35]
    v_and_b32_dpp v24, v19, v20 row_newbcast:4 row_mask:0xf bank_mask:0xf
    v_and_b32_dpp v25, v19, v21 row_newbcast:4 row_mask:0xf bank_mask:0xf
    v_and_b32_dpp v26, v19, v22 row_newbcast:4 row_mask:0xf bank_mask:0xf
    v_and_b32_dpp v27, v19, v23 row_newbcast:4 row_mask:0xf bank_mask:0xf
    s_waitcnt vmcnt(3)
    s_bitcmp0_b32 s14, 2
    s_cbranch_scc1 L_sf_95
    s_waitcnt vmcnt(2)
    s_bitcmp0_b32 s15, 2
    s_cbranch_scc1 L_sf_95
    s_waitcnt vmcnt(1)
L_sf_95:
    buffer_load_dwordx4 v[48:51], v1, s[52:55], s97 offen offset:2048 nt
    v_mfma_f32_16x16x32_bf16 v[32:35], v[24:27], v[160:163], v[32:35]
    v_and_b32_dpp v28, v19, v20 row_newbcast:12 row_mask:0xf bank_mask:0xf
    v_and_b32_dpp v29, v19, v21 row_newbcast:12 row_mask:0xf bank_mask:0xf
    v_and_b32_dpp v30, v19, v22 row_newbcast:12 row_mask:0xf bank_mask:0xf
    v_and_b32_dpp v31, v19, v23 row_newbcast:12 row_mask:0xf bank_mask:0xf
    s_waitcnt vmcnt(3)
    s_bitcmp0_b32 s14, 3
    s_cbranch_scc1 L_sf_96
    s_waitcnt vmcnt(2)
    s_bitcmp0_b32 s15, 3
    s_cbranch_scc1 L_sf_96
    s_waitcnt vmcnt(1)
L_sf_96:
    buffer_load_dwordx4 v[52:55], v1, s[52:55], s97 offen offset:3072 nt
    s_add_u32 s97, s97, 32768
    v_add_u32 v1, 4096, v1
    v_and_b32 v1, 0x7fff, v1
    v_mfma_f32_16x16x32_bf16 v[32:35], v[28:31], v[164:167], v[32:35]
    v_and_b32_dpp v24, v12, v20 row_newbcast:0 row_mask:0xf bank_mask:0xf
    v_and_b32_dpp v25, v12, v21 row_newbcast:0 row_mask:0xf bank_mask:0xf
    v_and_b32_dpp v26, v12, v22 row_newbcast:0 row_mask:0xf bank_mask:0xf
    v_and_b32_dpp v27, v12, v23 row_newbcast:0 row_mask:0xf bank_mask:0xf
    s_waitcnt vmcnt(3)
    s_bitcmp0_b32 s14, 4
    s_cbranch_scc1 L_sf_97
    s_waitcnt vmcnt(2)
    s_bitcmp0_b32 s15, 4
    s_cbranch_scc1 L_sf_97
    s_waitcnt vmcnt(1)
L_sf_97:
    buffer_load_dwordx4 v[56:59], v1, s[52:55], s97 offen offset:0 nt
    v_mfma_f32_16x16x32_bf16 v[32:35], v[24:27], v[40:43], v[32:35]
    v_and_b32_dpp v28, v12, v20 row_newbcast:8 row_mask:0xf bank_mask:0xf
    v_and_b32_dpp v29, v12, v21 row_newbcast:8 row_mask:0xf bank_mask:0xf
    v_and_b32_dpp v30, v12, v22 row_newbcast:8 row_mask:0xf bank_mask:0xf
    v_and_b32_dpp v31, v12, v23 row_newbcast:8 row_mask:0xf bank_mask:0xf
    s_waitcnt vmcnt(3)
    s_bitcmp0_b32 s14, 5
    s_cbranch_scc1 L_sf_98
    s_waitcnt vmcnt(2)
    s_bitcmp0_b32 s15, 5
    s_cbranch_scc1 L_sf_98
    s_waitcnt vmcnt(1)
L_sf_98:
    buffer_load_dwordx4 v[60:63], v1, s[52:55], s97 offen offset:1024 nt
    v_mfma_f32_16x16x32_bf16 v[32:35], v[28:31], v[44:47], v[32:35]
    v_and_b32_dpp v24, v12, v20 row_newbcast:4 row_mask:0xf bank_mask:0xf
    v_and_b32_dpp v25, v12, v21 row_newbcast:4 row_mask:0xf bank_mask:0xf
    v_and_b32_dpp v26, v12, v22 row_newbcast:4 row_mask:0xf bank_mask:0xf
    v_and_b32_dpp v27, v12, v23 row_newbcast:4 row_mask:0xf bank_mask:0xf
    s_waitcnt vmcnt(3)
    s_bitcmp0_b32 s14, 6
    s_cbranch_scc1 L_sf_99
    s_waitcnt vmcnt(2)
    s_bitcmp0_b32 s15, 6
    s_cbranch_scc1 L_sf_99
    s_waitcnt vmcnt(1)
L_sf_99:
    buffer_load_dwordx4 v[64:67], v1, s[52:55], s97 offen offset:2048 nt
    v_mfma_f32_16x16x32_bf16 v[32:35], v[24:27], v[48:51], v[32:35]
    v_and_b32_dpp v28, v12, v20 row_newbcast:12 row_mask:0xf bank_mask:0xf
    v_and_b32_dpp v29, v12, v21 row_newbcast:12 row_mask:0xf bank_mask:0xf
    v_and_b32_dpp v30, v12, v22 row_newbcast:12 row_mask:0xf bank_mask:0xf
    v_and_b32_dpp v31, v12, v23 row_newbcast:12 row_mask:0xf bank_mask:0xf
    s_waitcnt vmcnt(3)
    s_bitcmp0_b32 s14, 7
    s_cbranch_scc1 L_sf_100
    s_waitcnt vmcnt(2)
    s_bitcmp0_b32 s15, 7
    s_cbranch_scc1 L_sf_100
    s_waitcnt vmcnt(1)
L_sf_100:
    buffer_load_dwordx4 v[68:71], v1, s[52:55], s97 offen offset:3072 nt
    s_add_u32 s97, s97, 32768
    v_add_u32 v1, 4096, v1
    v_and_b32 v1, 0x7fff, v1
    v_mfma_f32_16x16x32_bf16 v[32:35], v[28:31], v[52:55], v[32:35]
    v_and_b32_dpp v24, v13, v20 row_newbcast:0 row_mask:0xf bank_mask:0xf
    v_and_b32_dpp v25, v13, v21 row_newbcast:0 row_mask:0xf bank_mask:0xf
    v_and_b32_dpp v26, v13, v22 row_newbcast:0 row_mask:0xf bank_mask:0xf
    v_and_b32_dpp v27, v13, v23 row_newbcast:0 row_mask:0xf bank_mask:0xf
    s_waitcnt vmcnt(3)
    s_nop 0
    v_mfma_f32_16x16x32_bf16 v[32:35], v[24:27], v[56:59], v[32:35]
    v_and_b32_dpp v28, v13, v20 row_newbcast:8 row_mask:0xf bank_mask:0xf
    v_and_b32_dpp v29, v13, v21 row_newbcast:8 row_mask:0xf bank_mask:0xf
    v_and_b32_dpp v30, v13, v22 row_newbcast:8 row_mask:0xf bank_mask:0xf
    v_and_b32_dpp v31, v13, v23 row_newbcast:8 row_mask:0xf bank_mask:0xf
    s_waitcnt vmcnt(2)
    s_nop 0
    v_mfma_f32_16x16x32_bf16 v[32:35], v[28:31], v[60:63], v[32:35]
    v_and_b32_dpp v24, v13, v20 row_newbcast:4 row_mask:0xf bank_mask:0xf
    v_and_b32_dpp v25, v13, v21 row_newbcast:4 row_mask:0xf bank_mask:0xf
    v_and_b32_dpp v26, v13, v22 row_newbcast:4 row_mask:0xf bank_mask:0xf
    v_and_b32_dpp v27, v13, v23 row_newbcast:4 row_mask:0xf bank_mask:0xf
    s_waitcnt vmcnt(1)
    s_nop 0
    v_mfma_f32_16x16x32_bf16 v[32:35], v[24:27], v[64:67], v[32:35]
    v_and_b32_dpp v28, v13, v20 row_newbcast:12 row_mask:0xf bank_mask:0xf
    v_and_b32_dpp v29, v13, v21 row_newbcast:12 row_mask:0xf bank_mask:0xf
    v_and_b32_dpp v30, v13, v22 row_newbcast:12 row_mask:0xf bank_mask:0xf
    v_and_b32_dpp v31, v13, v23 row_newbcast:12 row_mask:0xf bank_mask:0xf
    s_waitcnt vmcnt(0)
    s_nop 0
    v_mfma_f32_16x16x32_bf16 v[32:35], v[28:31], v[68:71], v[32:35]
    s_branch L_v_join
L_oslow:
    buffer_store_dword v32, v39, s[40:43], s98 offen sc1
    s_branch L_odone
L_refetch:
    s_lshr_b32 s62, s3, 0
    s_mul_i32 s62, s62, 5
    s_add_u32 s62, s62, s35
    s_sub_u32 s62, s62, 27
    s_cmp_ge_u32 s62, 7
    s_cbranch_scc1 L_norf
    s_add_u32 s62, s62, 3
    s_and_b32 s62, s62, 7
    s_mul_i32 s62, s62, 5120
    v_mov_b32 v8, 162048
L_lw_102:
    ds_read_b32 v9, v8
    s_waitcnt lgkmcnt(0)
    v_cmp_gt_u32 vcc, 9, v9
    s_cbranch_vccz L_lw_102e
    s_sleep 2
    s_sub_u32 s60, s60, 1
    s_cbranch_scc0 L_lw_102
    s_mov_b32 s60, 0
L_lw_102e:
    ds_read_b32 v9, v8 offset:36
    v_lshlrev_b32 v5, 4, v0
    v_add_u32 v5, 212992, v5
    s_add_u32 s4, s62, 0
    s_and_b32 s63, s4, 0xffffe000
    s_add_u32 s4, s4, s63
    s_add_u32 s5, s62, 1024
    s_and_b32 s63, s5, 0xffffe000
    s_add_u32 s5, s5, s63
    s_add_u32 s6, s62, 2048
    s_and_b32 s63, s6, 0xffffe000
    s_add_u32 s6, s6, s63
    s_add_u32 s7, s62, 3072
    s_and_b32 s63, s7, 0xffffe000
    s_add_u32 s7, s7, s63
    s_add_u32 s8, s62, 4096
    s_and_b32 s63, s8, 0xffffe000
    s_add_u32 s8, s8, s63
    s_waitcnt lgkmcnt(0)
    v_add_u32 v5, v5, v9
L_poll_103:
    buffer_load_dwordx4 v[12:15], v5, s[40:43], s4 offen sc1
    buffer_load_dwordx4 v[16:19], v5, s[40:43], s5 offen sc1
    buffer_load_dwordx4 v[20:23], v5, s[40:43], s6 offen sc1
    buffer_load_dwordx4 v[24:27], v5, s[40:43], s7 offen sc1
    buffer_load_dwordx4 v[28:31], v5, s[40:43], s8 offen sc1
    s_sub_u32 s60, s60, 1
    s_cbranch_scc1 L_poll_103t
    s_waitcnt vmcnt(0)
    v_max3_u32 v3, v12, v16, v20
    v_max3_u32 v3, v3, v24, v28
    v_cmp_eq_u32 vcc, -1, v3
    s_cbranch_vccnz L_poll_103
L_poll_103e:
    s_branch L_norf
L_qslow:
L_wy_104:
    buffer_load_dword v37, v39, s[44:47], 0 offen sc1
    s_waitcnt vmcnt(0)
    v_cmp_ne_u32 vcc, -1, v37
    s_cbranch_vccz L_wy_104e
    s_sleep 4
    s_sub_u32 s60, s60, 1
    s_cbranch_scc0 L_wy_104
    s_mov_b32 s60, 0
L_wy_104e:
L_qslow2:
    s_branch L_poll_105
L_poll_105s:
    s_sleep 2
L_poll_105:
    buffer_load_dwordx4 v[4:7], v2, s[40:43], s98 offen sc1
    s_sub_u32 s60, s60, 1
    s_cbranch_scc1 L_poll_105t
    s_waitcnt vmcnt(0)
    v_max3_u32 v38, v4, v5, v6
    v_max_u32 v38, v38, v7
    v_cmp_eq_u32 vcc, -1, v38
    s_cbranch_vccnz L_poll_105s
L_poll_105e:
    s_branch L_qok
L_mljob:
    s_lshl4_add_u32 s96, s35, s3
    s_lshl_b32 s96, s96, 3
    s_add_u32 s96, s96, 81920
    buffer_store_dwordx2 v[8:9], v36, s[40:43], s96 offen sc1
    s_branch L_mldone
L_service:
    v_mov_b32 v72, 0
    v_mov_b32 v73, 0
    v_mov_b32 v74, 0
    v_mov_b32 v75, 0
    v_mov_b32 v76, 0
    s_mov_b32 s59, 0
    v_mov_b32 v5, 0
    v_mov_b32 v105, 0
    v_mov_b32 v108, 0
    v_mov_b32 v110, 0
    v_mov_b32 v160, 0
    v_mov_b32 v163, 0
    v_mov_b32 v8, 162068
L_lw_106:
    ds_read_b32 v9, v8
    s_waitcnt lgkmcnt(0)
    v_cmp_gt_u32 vcc, 8, v9
    s_cbranch_vccz L_lw_106e
    s_sleep 8
    s_sub_u32 s60, s60, 1
    s_cbranch_scc0 L_lw_106
    s_mov_b32 s60, 0
L_lw_106e:
    v_and_b32 v2, 15, v0
    v_lshlrev_b32 v2, 3, v2
    v_add_u32 v3, 161920, v2
    ds_read_b64 v[8:9], v3
    v_mov_b32 v11, 162096
    ds_read_b32 v11, v11
    s_getreg_b32 s58, hwreg(HW_REG_XCC_ID, 0, 4)
    s_lshl_b32 s98, s34, 5
    s_add_u32 s98, s98, s35
    s_lshl_b32 s62, s98, 7
    s_add_u32 s62, s62, 73728
    s_and_b32 s99, s62, 0xffffff00
    s_lshl_b32 s98, s98, 8
    s_add_u32 s98, s98, 106496
    v_lshlrev_b32 v39, 2, v0
    v_and_b32 v21, 64, v2
    v_add_u32 v21, v21, v2
    v_cmp_eq_u32 vcc, 8, v0
    s_bfm_b64 exec, 8, 0
    s_bitset1_b32 exec_lo, 8
    s_waitcnt lgkmcnt(0)
    v_lshl_add_u32 v10, v11, 8, s58
    v_cndmask_b32 v8, v8, v10, vcc
    buffer_store_dwordx2 v[8:9], v2, s[40:43], s62 offen sc1
    s_mov_b64 exec, -1
    v_mov_b32 v12, 162076
L_lw_107:
    ds_read_b32 v13, v12
    s_waitcnt lgkmcnt(0)
    v_cmp_gt_u32 vcc, 4, v13
    s_cbranch_vccz L_lw_107e
    s_sleep 4
    s_sub_u32 s60, s60, 1
    s_cbranch_scc0 L_lw_107
    s_mov_b32 s60, 0
L_lw_107e:
    v_and_b32 v11, 31, v0
    v_lshlrev_b32 v11, 7, v11
    s_lshl_b32 s63, s34, 12
    s_add_u32 s63, s63, 73792
    buffer_load_dword v12, v39, s[40:43], s98 offen sc1
    s_branch L_poll_108
L_poll_108s:
    s_sleep 16
L_poll_108:
    buffer_load_dwordx2 v[8:9], v21, s[40:43], s99 offen sc1
    buffer_load_dword v10, v11, s[40:43], s63 offen sc1
    s_sub_u32 s60, s60, 1
    s_cbranch_scc1 L_poll_108t
    s_waitcnt vmcnt(0)
    v_max3_u32 v38, v8, v9, v10
    v_cmp_eq_u32 vcc, -1, v38
    s_cbranch_vccnz L_poll_108s
L_poll_108e:
    v_mov_b32 v37, v8
    s_nop 1
    v_max_f32_dpp v37, v37, v37 quad_perm:[1,0,3,2] row_mask:0xf bank_mask:0xf
    s_nop 1
    v_max_f32_dpp v37, v37, v37 quad_perm:[2,3,0,1] row_mask:0xf bank_mask:0xf
    s_nop 1
    v_max_f32_dpp v37, v37, v37 row_ror:4 row_mask:0xf bank_mask:0xf
    s_nop 1
    v_max_f32_dpp v37, v37, v37 row_ror:8 row_mask:0xf bank_mask:0xf
    v_sub_f32 v8, v8, v37
    v_exp_f32 v8, v8
    s_nop 0
    v_mul_f32 v9, v8, v9
    s_nop 1
    v_add_f32_dpp v9, v9, v9 quad_perm:[1,0,3,2] row_mask:0xf bank_mask:0xf
    s_nop 1
    v_add_f32_dpp v9, v9, v9 quad_perm:[2,3,0,1] row_mask:0xf bank_mask:0xf
    s_nop 1
    v_add_f32_dpp v9, v9, v9 row_ror:4 row_mask:0xf bank_mask:0xf
    s_nop 1
    v_add_f32_dpp v9, v9, v9 row_ror:8 row_mask:0xf bank_mask:0xf
    v_ashrrev_i32 v12, 8, v10
    s_nop 1
    v_add_u32_dpp v12, v12, v12 quad_perm:[1,0,3,2] row_mask:0xf bank_mask:0xf
    s_nop 1
    v_add_u32_dpp v12, v12, v12 quad_perm:[2,3,0,1] row_mask:0xf bank_mask:0xf
    s_nop 1
    v_add_u32_dpp v12, v12, v12 row_ror:4 row_mask:0xf bank_mask:0xf
    s_nop 1
    v_add_u32_dpp v12, v12, v12 row_ror:8 row_mask:0xf bank_mask:0xf
    v_mov_b32 v13, v12
    s_nop 1
    v_permlane16_swap_b32 v12, v13
    v_add_u32 v12, v12, v13
    v_mov_b32 v13, v12
    s_nop 1
    v_permlane32_swap_b32 v12, v13
    v_add_u32 v12, v12, v13
    v_ashrrev_i32 v12, 31, v12
    v_and_b32 v12, 8192, v12
    v_mov_b32 v13, 162084
    ds_write_b32 v13, v12
    v_and_b32 v10, 0xff, v10
    s_getreg_b32 s62, hwreg(HW_REG_XCC_ID, 0, 4)
    v_cmp_ne_u32 vcc, s62, v10
    s_nop 0
    s_cmp_eq_u64 vcc, 0
    s_cselect_b32 s61, 1, 0
    v_rcp_f32 v9, v9
    v_lshrrev_b32 v3, 1, v2
    v_add_u32 v3, 161984, v3
    v_mul_f32 v8, v8, v9
    v_mov_b32 v10, 162072
    v_mov_b32 v11, s61
    ds_write_b32 v3, v8
    ds_write_b32 v10, v11
    s_mov_b32 s3, 1
    v_lshrrev_b32 v9, 4, v0
    v_lshl_add_u32 v8, v9, 2, v2
    s_lshl_b32 s96, s3, 9
    s_add_u32 s96, s96, 157824
    v_lshl_add_u32 v8, v8, 2, s96
    v_lshlrev_b32 v9, 3, v0
    v_add_u32 v9, 157824, v9
    v_mov_b32 v10, 162048
    v_mov_b32 v11, 1
    s_lshl_b32 s96, s38, 5
    s_add_u32 s96, s96, 161984
    v_mov_b32 v3, s96
    s_sub_u32 s62, 8, s39
    s_lshl_b32 s98, s34, 5
    s_add_u32 s98, s98, s35
    s_lshl_b32 s98, s98, 8
    s_add_u32 s98, s98, 106496
    v_lshlrev_b32 v39, 2, v0
    s_branch L_t0b
L_jobend:
    v_lshlrev_b32 v9, 4, v0
    s_mov_b32 exec_hi, 0
    s_nop 3
    buffer_store_dwordx4 v[32:35], v9, s[40:43], s13 offen sc1
    s_endpgm
L_proxy:
    v_mov_b32 v72, 0
    v_mov_b32 v73, 0
    v_mov_b32 v74, 0
    v_mov_b32 v75, 0
    v_mov_b32 v76, 0
    v_mov_b32 v5, 0
    v_mov_b32 v105, 0
    v_mov_b32 v108, 0
    v_mov_b32 v110, 0
    v_mov_b32 v160, 0
    v_mov_b32 v163, 0
    s_barrier
    s_waitcnt lgkmcnt(0)
    s_mov_b32 s40, s32
    s_mov_b32 s41, s33
    s_mov_b32 s42, 589824
    s_mov_b32 s43, 0x20000
    s_mov_b32 s44, s30
    s_mov_b32 s45, s31
    s_mov_b32 s46, 256
    s_mov_b32 s47, 0x20000
    s_sub_u32 s97, 7, s3
    s_mul_i32 s97, s97, 27
    s_cmp_eq_u32 s3, 5
    s_cselect_b32 s97, 32, s97
    s_add_u32 s97, s97, s35
    s_lshl_b32 s97, s97, 9
    s_add_u32 s97, s97, 172032
    v_and_b32 v2, 15, v0
    v_lshlrev_b32 v2, 3, v2
    v_and_b32 v20, 31, v0
    v_lshlrev_b32 v20, 4, v20
    s_cmp_lg_u32 s3, 7
    s_cbranch_scc1 L_px6
    s_sub_u32 s96, 6, s59
    s_mul_i32 s62, s35, 5120
    s_add_u32 s62, s62, 327680
    v_lshl_add_u32 v22, v0, 4, s62
    v_add_u32 v23, 4096, v22
    v_mov_b32 v24, -1
    v_mov_b32 v25, -1
    v_mov_b32 v26, -1
    v_mov_b32 v27, -1
    v_mov_b32 v8, 162068
L_lw_109:
    ds_read_b32 v9, v8
    s_waitcnt lgkmcnt(0)
    v_cmp_gt_u32 vcc, s96, v9
    s_cbranch_vccz L_lw_109e
    s_sleep 8
    s_sub_u32 s60, s60, 1
    s_cbranch_scc0 L_lw_109
    s_mov_b32 s60, 0
L_lw_109e:
    v_and_b32 v2, 15, v0
    v_lshlrev_b32 v2, 3, v2
    v_add_u32 v3, 161920, v2
    ds_read_b64 v[8:9], v3
    v_mov_b32 v11, 162096
    ds_read_b32 v11, v11
    s_getreg_b32 s58, hwreg(HW_REG_XCC_ID, 0, 4)
    s_lshl_b32 s98, s34, 5
    s_add_u32 s98, s98, s35
    s_lshl_b32 s62, s98, 7
    s_add_u32 s62, s62, 73728
    s_and_b32 s99, s62, 0xffffff00
    s_lshl_b32 s98, s98, 8
    s_add_u32 s98, s98, 106496
    v_lshlrev_b32 v39, 2, v0
    v_and_b32 v21, 64, v2
    v_add_u32 v21, v21, v2
    v_cmp_eq_u32 vcc, 8, v0
    s_bfm_b64 exec, s96, 0
    s_bitset1_b32 exec_lo, 8
    s_waitcnt lgkmcnt(0)
    v_lshl_add_u32 v10, v11, 8, s58
    v_cndmask_b32 v8, v8, v10, vcc
    buffer_store_dwordx2 v[8:9], v2, s[40:43], s62 offen sc1
    s_mov_b64 exec, -1
    buffer_load_dwordx4 v[120:123], v22, s[40:43], 0 offen offset:0 sc1
    buffer_load_dwordx4 v[124:127], v22, s[40:43], 0 offen offset:1024 sc1
    buffer_load_dwordx4 v[128:131], v22, s[40:43], 0 offen offset:2048 sc1
    buffer_load_dwordx4 v[132:135], v22, s[40:43], 0 offen offset:3072 sc1
    buffer_load_dwordx4 v[136:139], v23, s[40:43], 0 offen offset:0 sc1
    s_mov_b32 s100, 4
    s_lshl_b32 s63, s100, 8
    v_and_b32 v8, 15, v0
    v_lshl_add_u32 v8, v8, 4, s63
    v_lshrrev_b32 v9, 4, v0
    v_mul_u32_u24 v5, 1280, v9
    v_add_u32 v5, v5, v8
    v_mul_u32_u24 v4, 1296, v9
    v_add_u32 v4, v4, v8
    v_add_u32 v4, 82944, v4
    v_lshlrev_b32 v6, 1, v5
    v_add_u32 v6, 99328, v6
    s_lshl_b32 s62, s100, 9
    s_add_u32 s62, s62, 88128
    v_lshl_add_u32 v7, v0, 3, s62
    s_mov_b32 s48, s4
    s_mov_b32 s49, s5
    s_mov_b32 s50, 5120
    s_mov_b32 s51, 0x20000
    buffer_load_dwordx4 v[8:11], v5, s[48:51], 0 offen
    s_mov_b32 s62, 20480
    s_mov_b32 s63, 30720
    s_branch L_poll_110
L_poll_110s:
    s_sleep 32
L_poll_110:
    buffer_load_dwordx4 v[12:15], v5, s[40:43], s62 offen sc1
    buffer_load_dwordx4 v[16:19], v5, s[40:43], s63 offen sc1
    s_sub_u32 s60, s60, 1
    s_cbranch_scc1 L_poll_110t
    s_waitcnt vmcnt(0)
    v_max3_u32 v38, v12, v13, v14
    v_max3_u32 v38, v38, v15, v16
    v_max3_u32 v38, v38, v17, v18
    v_max_u32 v38, v38, v19
    v_cmp_eq_u32 vcc, -1, v38
    s_cbranch_vccnz L_poll_110s
L_poll_110e:
    v_lshlrev_b32 v40, 16, v8
    v_and_b32 v41, 0xffff0000, v8
    v_lshlrev_b32 v42, 16, v9
    v_and_b32 v43, 0xffff0000, v9
    v_lshlrev_b32 v44, 16, v10
    v_and_b32 v45, 0xffff0000, v10
    v_lshlrev_b32 v46, 16, v11
    v_and_b32 v47, 0xffff0000, v11
    v_lshlrev_b32 v48, 16, v12
    v_and_b32 v49, 0xffff0000, v12
    v_lshlrev_b32 v50, 16, v13
    v_and_b32 v51, 0xffff0000, v13
    v_lshlrev_b32 v52, 16, v14
    v_and_b32 v53, 0xffff0000, v14
    v_lshlrev_b32 v54, 16, v15
    v_and_b32 v55, 0xffff0000, v15
    v_lshlrev_b32 v56, 16, v16
    v_and_b32 v57, 0xffff0000, v16
    v_lshlrev_b32 v58, 16, v17
    v_and_b32 v59, 0xffff0000, v17
    v_lshlrev_b32 v60, 16, v18
    v_and_b32 v61, 0xffff0000, v18
    v_lshlrev_b32 v62, 16, v19
    v_and_b32 v63, 0xffff0000, v19
    v_mov_b32 v64, 0
    v_mov_b32 v65, 0
    v_mov_b32 v66, 0
    v_mov_b32 v67, 0
    v_mov_b32 v68, 0
    v_mov_b32 v69, 0
    v_mov_b32 v70, 0
    v_mov_b32 v71, 0
    v_bfe_u32 v5, v0, 2, 2
    v_lshlrev_b32 v5, 8, v5
    v_lshrrev_b32 v8, 4, v0
    v_lshl_add_u32 v5, v8, 6, v5
    v_and_b32 v8, 3, v0
    v_lshl_add_u32 v5, v8, 4, v5
    s_lshl_b32 s56, s100, 10
    s_or_b32 s96, s59, 0
    s_cbranch_scc0 L_nofrag_111
    v_mov_b32 v104, 162060
L_lw_112:
    ds_read_b32 v105, v104
    s_waitcnt lgkmcnt(0)
    v_cmp_gt_u32 vcc, 4, v105
    s_cbranch_vccz L_lw_112e
    s_sleep 2
    s_sub_u32 s60, s60, 1
    s_cbranch_scc0 L_lw_112
    s_mov_b32 s60, 0
L_lw_112e:
    s_cmp_eq_u32 s59, 0
    s_cbranch_scc1 L_nofrag_111
    v_bfe_u32 v104, v0, 2, 1
    v_bfe_u32 v110, v0, 4, 1
    v_lshl_add_u32 v104, v110, 2, v104
    v_and_b32 v110, 8, v0
    v_add_u32 v104, v104, v110
    v_lshrrev_b32 v110, 5, v0
    v_lshl_add_u32 v104, v110, 4, v104
    v_bfe_u32 v111, v0, 0, 1
    v_mul_u32_u24 v111, 0xaaaa, v111
    v_add_u32 v111, 0x4444, v111
    v_mov_b32 v112, 0
    v_mov_b32 v113, 0
    v_mov_b32 v114, 0
    v_mov_b32 v115, 0
    v_mov_b32 v116, 0
    v_mov_b32 v117, 0
    v_mov_b32 v118, 0
    v_mov_b32 v119, 0
    v_lshlrev_b32 v104, 7, v104
    v_and_b32 v110, 3, v0
    v_lshl_add_u32 v104, v110, 3, v104
    v_lshrrev_b32 v109, 4, v0
    v_and_b32 v110, 1, v0
    s_lshr_b32 s63, s3, 1
    s_and_b32 s62, s3, 1
    s_lshl_b32 s96, s63, 14
    s_lshl_b32 s100, s62, 6
    s_add_u32 s100, s100, 81920
    s_add_u32 s96, s96, s100
    v_add_u32 v104, s96, v104
    ds_read_b64_tr_b16 v[72:73], v104 offset:0
    ds_read_b64_tr_b16 v[74:75], v104 offset:256
    ds_read_b64_tr_b16 v[76:77], v104 offset:4096
    ds_read_b64_tr_b16 v[78:79], v104 offset:4352
    ds_read_b64_tr_b16 v[80:81], v104 offset:32
    ds_read_b64_tr_b16 v[82:83], v104 offset:288
    ds_read_b64_tr_b16 v[84:85], v104 offset:4128
    ds_read_b64_tr_b16 v[86:87], v104 offset:4384
    ds_read_b64_tr_b16 v[88:89], v104 offset:8192
    ds_read_b64_tr_b16 v[90:91], v104 offset:8448
    ds_read_b64_tr_b16 v[92:93], v104 offset:12288
    ds_read_b64_tr_b16 v[94:95], v104 offset:12544
    ds_read_b64_tr_b16 v[96:97], v104 offset:8224
    ds_read_b64_tr_b16 v[98:99], v104 offset:8480
    ds_read_b64_tr_b16 v[100:101], v104 offset:12320
    ds_read_b64_tr_b16 v[102:103], v104 offset:12576
    v_bfe_u32 v105, v0, 1, 3
    v_lshlrev_b32 v105, 8, v105
    v_lshl_add_u32 v105, v109, 5, v105
    v_lshl_add_u32 v105, v110, 4, v105
    v_lshrrev_b32 v106, 3, v0
    v_lshlrev_b32 v106, 7, v106
    v_and_b32 v110, 7, v0
    v_lshl_add_u32 v107, v110, 3, v106
    v_add_u32 v107, s100, v107
    v_lshlrev_b32 v106, 8, v109
    v_and_b32 v110, 15, v0
    v_lshl_add_u32 v106, v110, 2, v106
    v_add_u32 v106, s96, v106
    v_lshlrev_b32 v108, 2, v0
    s_lshl_b32 s96, s62, 2
    s_add_u32 s96, s96, 162088
    v_mov_b32 v109, s96
    s_lshl_b32 s100, s63, 11
    s_lshl_b32 s96, s34, 13
    s_add_u32 s100, s100, s96
    s_add_u32 s100, s100, 106496
    s_mul_i32 s101, s34, 5120
    s_lshl_b32 s96, s35, 9
    s_add_u32 s101, s101, s96
    s_lshl_b32 s96, s62, 8
    s_add_u32 s101, s101, s96
    s_sub_u32 s101, s101, 11264
    s_and_b32 s96, s101, 0xffffe000
    s_add_u32 s101, s101, s96
    s_add_u32 s101, s101, 212992
    v_add_u32 v110, 8192, v108
L_nofrag_111:
    s_cmp_ge_u32 s35, 20
    s_cbranch_scc1 L_nofin_113
    s_lshl1_add_u32 s62, s35, s3
    s_sub_u32 s62, s62, 6
    s_lshl_b32 s57, s62, 7
    s_mul_i32 s63, s62, 0x199a
    s_lshr_b32 s63, s63, 16
    s_mul_i32 s63, s63, 1280
    s_sub_u32 s63, s57, s63
    v_lshrrev_b32 v72, 3, v0
    v_mul_u32_u24 v72, 5120, v72
    v_and_b32 v8, 7, v0
    v_lshl_add_u32 v72, v8, 4, v72
    s_add_u32 s62, s57, 327680
    v_add_u32 v72, s62, v72
    v_add_u32 v73, 40960, v72
    v_add_u32 v74, 81920, v72
    v_add_u32 v75, 122880, v72
    v_bfe_u32 v9, v0, 4, 1
    v_lshlrev_b32 v76, 4, v8
    v_lshl_add_u32 v76, v9, 3, v76
    s_lshl_b32 s62, s57, 1
    s_add_u32 s62, s62, 99328
    v_lshl_add_u32 v77, v76, 1, s62
    s_mov_b32 s48, s22
    s_mov_b32 s49, s23
    s_mov_b32 s50, 1280
    s_mov_b32 s51, 0x20000
    buffer_load_dwordx2 v[86:87], v76, s[48:51], s63 offen
    s_add_u32 s62, s57, 35840
    s_branch L_poll_114
L_poll_114s:
    s_sleep 32
L_poll_114:
    buffer_load_dwordx2 v[8:9], v76, s[40:43], s62 offen sc1
    s_sub_u32 s60, s60, 1
    s_cbranch_scc1 L_poll_114t
    s_waitcnt vmcnt(0)
    v_max_u32 v38, v8, v9
    v_cmp_eq_u32 vcc, -1, v38
    s_cbranch_vccnz L_poll_114s
L_poll_114e:
    v_lshlrev_b32 v78, 16, v86
    v_and_b32 v79, 0xffff0000, v86
    v_lshlrev_b32 v82, 16, v8
    v_and_b32 v83, 0xffff0000, v8
    v_lshlrev_b32 v80, 16, v87
    v_and_b32 v81, 0xffff0000, v87
    v_lshlrev_b32 v84, 16, v9
    v_and_b32 v85, 0xffff0000, v9
    v_bfe_u32 v8, v0, 1, 3
    v_and_b32 v9, 1, v0
    v_lshlrev_b32 v9, 4, v9
    v_mov_b32 v10, 0x3f80
    v_lshlrev_b32 v9, v9, v10
    v_cmp_eq_u32 vcc, 0, v8
    v_mov_b32 v100, 0
    s_nop 0
    v_cndmask_b32 v104, 0, v9, vcc
    v_cmp_eq_u32 vcc, 1, v8
    v_mov_b32 v101, 0
    s_nop 0
    v_cndmask_b32 v105, 0, v9, vcc
    v_cmp_eq_u32 vcc, 2, v8
    v_mov_b32 v102, 0
    s_nop 0
    v_cndmask_b32 v106, 0, v9, vcc
    v_cmp_eq_u32 vcc, 3, v8
    v_mov_b32 v103, 0
    s_nop 0
    v_cndmask_b32 v107, 0, v9, vcc
L_nofin_113:
    v_mov_b32 v12, 162076
L_lw_115:
    ds_read_b32 v13, v12
    s_waitcnt lgkmcnt(0)
    v_cmp_gt_u32 vcc, 4, v13
    s_cbranch_vccz L_lw_115e
    s_sleep 4
    s_sub_u32 s60, s60, 1
    s_cbranch_scc0 L_lw_115
    s_mov_b32 s60, 0
L_lw_115e:
    v_and_b32 v11, 31, v0
    v_lshlrev_b32 v11, 7, v11
    s_lshl_b32 s63, s34, 12
    s_add_u32 s63, s63, 73792
    buffer_load_dword v12, v39, s[40:43], s98 offen sc1
    s_branch L_poll_116
L_poll_116s:
    s_sleep 4
L_poll_116:
    buffer_load_dwordx2 v[8:9], v21, s[40:43], s99 offen sc1
    buffer_load_dword v10, v11, s[40:43], s63 offen sc1
    s_sub_u32 s60, s60, 1
    s_cbranch_scc1 L_poll_116t
    s_waitcnt vmcnt(0)
    v_max3_u32 v38, v8, v9, v10
    v_cmp_eq_u32 vcc, -1, v38
    s_cbranch_vccnz L_poll_116s
L_poll_116e:
    v_mov_b32 v37, v8
    s_nop 1
    v_max_f32_dpp v37, v37, v37 quad_perm:[1,0,3,2] row_mask:0xf bank_mask:0xf
    s_nop 1
    v_max_f32_dpp v37, v37, v37 quad_perm:[2,3,0,1] row_mask:0xf bank_mask:0xf
    s_nop 1
    v_max_f32_dpp v37, v37, v37 row_ror:4 row_mask:0xf bank_mask:0xf
    s_nop 1
    v_max_f32_dpp v37, v37, v37 row_ror:8 row_mask:0xf bank_mask:0xf
    v_sub_f32 v8, v8, v37
    v_exp_f32 v8, v8
    s_nop 0
    v_mul_f32 v9, v8, v9
    s_nop 1
    v_add_f32_dpp v9, v9, v9 quad_perm:[1,0,3,2] row_mask:0xf bank_mask:0xf
    s_nop 1
    v_add_f32_dpp v9, v9, v9 quad_perm:[2,3,0,1] row_mask:0xf bank_mask:0xf
    s_nop 1
    v_add_f32_dpp v9, v9, v9 row_ror:4 row_mask:0xf bank_mask:0xf
    s_nop 1
    v_add_f32_dpp v9, v9, v9 row_ror:8 row_mask:0xf bank_mask:0xf
    v_ashrrev_i32 v12, 8, v10
    s_nop 1
    v_add_u32_dpp v12, v12, v12 quad_perm:[1,0,3,2] row_mask:0xf bank_mask:0xf
    s_nop 1
    v_add_u32_dpp v12, v12, v12 quad_perm:[2,3,0,1] row_mask:0xf bank_mask:0xf
    s_nop 1
    v_add_u32_dpp v12, v12, v12 row_ror:4 row_mask:0xf bank_mask:0xf
    s_nop 1
    v_add_u32_dpp v12, v12, v12 row_ror:8 row_mask:0xf bank_mask:0xf
    v_mov_b32 v13, v12
    s_nop 1
    v_permlane16_swap_b32 v12, v13
    v_add_u32 v12, v12, v13
    v_mov_b32 v13, v12
    s_nop 1
    v_permlane32_swap_b32 v12, v13
    v_add_u32 v12, v12, v13
    v_ashrrev_i32 v12, 31, v12
    v_and_b32 v12, 8192, v12
    v_mov_b32 v13, 162084
    ds_write_b32 v13, v12
    v_and_b32 v10, 0xff, v10
    s_getreg_b32 s62, hwreg(HW_REG_XCC_ID, 0, 4)
    v_cmp_ne_u32 vcc, s62, v10
    s_nop 0
    s_cmp_eq_u64 vcc, 0
    s_cselect_b32 s61, 1, 0
    v_rcp_f32 v9, v9
    v_lshrrev_b32 v3, 1, v2
    v_add_u32 v3, 161984, v3
    v_mul_f32 v8, v8, v9
    v_mov_b32 v10, 162072
    v_mov_b32 v11, s61
    ds_write_b32 v3, v8
    ds_write_b32 v10, v11
    s_cmp_eq_u32 s61, 1
    s_cbranch_scc0 L_ycs
    buffer_store_dwordx4 v[24:27], v22, s[40:43], 0 offen offset:0
    buffer_store_dwordx4 v[24:27], v22, s[40:43], 0 offen offset:1024
    buffer_store_dwordx4 v[24:27], v22, s[40:43], 0 offen offset:2048
    buffer_store_dwordx4 v[24:27], v22, s[40:43], 0 offen offset:3072
    buffer_store_dwordx4 v[24:27], v23, s[40:43], 0 offen offset:0
L_ycd:
    s_branch L_poll_117
L_poll_117s:
    s_sleep 4
L_poll_117:
    buffer_load_dwordx4 v[32:35], v20, s[40:43], s97 offen sc1
    s_sub_u32 s60, s60, 1
    s_cbranch_scc1 L_poll_117t
    s_waitcnt vmcnt(0)
    v_max3_u32 v38, v32, v33, v34
    v_max_u32 v38, v38, v35
    v_cmp_eq_u32 vcc, -1, v38
    s_cbranch_vccnz L_poll_117s
L_poll_117e:
    s_branch L_pxj
L_px6:
    s_or_b32 s96, s59, s39
    s_cbranch_scc0 L_nofrag_118
    v_mov_b32 v104, 162060
L_lw_119:
    ds_read_b32 v105, v104
    s_waitcnt lgkmcnt(0)
    v_cmp_gt_u32 vcc, 4, v105
    s_cbranch_vccz L_lw_119e
    s_sleep 2
    s_sub_u32 s60, s60, 1
    s_cbranch_scc0 L_lw_119
    s_mov_b32 s60, 0
L_lw_119e:
    s_cmp_eq_u32 s59, 0
    s_cbranch_scc1 L_nofrag_118
    v_bfe_u32 v104, v0, 2, 1
    v_bfe_u32 v110, v0, 4, 1
    v_lshl_add_u32 v104, v110, 2, v104
    v_and_b32 v110, 8, v0
    v_add_u32 v104, v104, v110
    v_lshrrev_b32 v110, 5, v0
    v_lshl_add_u32 v104, v110, 4, v104
    v_bfe_u32 v111, v0, 0, 1
    v_mul_u32_u24 v111, 0xaaaa, v111
    v_add_u32 v111, 0x4444, v111
    v_mov_b32 v112, 0
    v_mov_b32 v113, 0
    v_mov_b32 v114, 0
    v_mov_b32 v115, 0
    v_mov_b32 v116, 0
    v_mov_b32 v117, 0
    v_mov_b32 v118, 0
    v_mov_b32 v119, 0
    v_lshlrev_b32 v104, 7, v104
    v_and_b32 v110, 3, v0
    v_lshl_add_u32 v104, v110, 3, v104
    v_lshrrev_b32 v109, 4, v0
    v_and_b32 v110, 1, v0
    s_lshr_b32 s63, s3, 1
    s_and_b32 s62, s3, 1
    s_lshl_b32 s96, s63, 14
    s_lshl_b32 s100, s62, 6
    s_add_u32 s100, s100, 81920
    s_add_u32 s96, s96, s100
    v_add_u32 v104, s96, v104
    ds_read_b64_tr_b16 v[72:73], v104 offset:0
    ds_read_b64_tr_b16 v[74:75], v104 offset:256
    ds_read_b64_tr_b16 v[76:77], v104 offset:4096
    ds_read_b64_tr_b16 v[78:79], v104 offset:4352
    ds_read_b64_tr_b16 v[80:81], v104 offset:32
    ds_read_b64_tr_b16 v[82:83], v104 offset:288
    ds_read_b64_tr_b16 v[84:85], v104 offset:4128
    ds_read_b64_tr_b16 v[86:87], v104 offset:4384
    ds_read_b64_tr_b16 v[88:89], v104 offset:8192
    ds_read_b64_tr_b16 v[90:91], v104 offset:8448
    ds_read_b64_tr_b16 v[92:93], v104 offset:12288
    ds_read_b64_tr_b16 v[94:95], v104 offset:12544
    ds_read_b64_tr_b16 v[96:97], v104 offset:8224
    ds_read_b64_tr_b16 v[98:99], v104 offset:8480
    ds_read_b64_tr_b16 v[100:101], v104 offset:12320
    ds_read_b64_tr_b16 v[102:103], v104 offset:12576
    v_bfe_u32 v105, v0, 1, 3
    v_lshlrev_b32 v105, 8, v105
    v_lshl_add_u32 v105, v109, 5, v105
    v_lshl_add_u32 v105, v110, 4, v105
    v_lshrrev_b32 v106, 3, v0
    v_lshlrev_b32 v106, 7, v106
    v_and_b32 v110, 7, v0
    v_lshl_add_u32 v107, v110, 3, v106
    v_add_u32 v107, s100, v107
    v_lshlrev_b32 v106, 8, v109
    v_and_b32 v110, 15, v0
    v_lshl_add_u32 v106, v110, 2, v106
    v_add_u32 v106, s96, v106
    v_lshlrev_b32 v108, 2, v0
    s_lshl_b32 s96, s62, 2
    s_add_u32 s96, s96, 162088
    v_mov_b32 v109, s96
    s_lshl_b32 s100, s63, 11
    s_lshl_b32 s96, s34, 13
    s_add_u32 s100, s100, s96
    s_add_u32 s100, s100, 106496
    s_mul_i32 s101, s34, 5120
    s_lshl_b32 s96, s35, 9
    s_add_u32 s101, s101, s96
    s_lshl_b32 s96, s62, 8
    s_add_u32 s101, s101, s96
    s_sub_u32 s101, s101, 11264
    s_and_b32 s96, s101, 0xffffe000
    s_add_u32 s101, s101, s96
    s_add_u32 s101, s101, 212992
    v_add_u32 v110, 8192, v108
L_nofrag_118:
    s_mov_b32 s62, 3
    s_lshl1_add_u32 s96, s35, s3
    s_and_b32 s63, s96, 7
    s_lshl_b32 s63, s63, 14
    s_lshl_b32 s96, s96, 7
    s_add_u32 s96, s96, s63
    s_add_u32 s96, s96, 475136
    s_add_u32 s98, s32, s96
    s_addc_u32 s99, s33, 0
    s_load_dword s4, s[98:99], 0 glc
    s_load_dword s5, s[98:99], 8192 glc
    s_mov_b32 s63, 0
    s_waitcnt lgkmcnt(0)
L_np:
    s_not_b32 s4, s4
    s_mov_b32 s6, s4
    s_mov_b32 s7, 0
    s_load_dword s4, s[98:99], 0 glc
L_npc0:
    s_add_u32 s7, s7, 1
    s_cmp_eq_u32 s4, s6
    s_cselect_b32 s8, s7, 1000
    s_cmp_lt_u32 s8, 60
    s_cbranch_scc1 L_npc0
    s_waitcnt lgkmcnt(0)
    s_sub_u32 s63, s63, s7
    s_not_b32 s5, s5
    s_mov_b32 s6, s5
    s_mov_b32 s7, 0
    s_load_dword s5, s[98:99], 8192 glc
L_npc1:
    s_add_u32 s7, s7, 1
    s_cmp_eq_u32 s5, s6
    s_cselect_b32 s8, s7, 1000
    s_cmp_lt_u32 s8, 60
    s_cbranch_scc1 L_npc1
    s_waitcnt lgkmcnt(0)
    s_add_u32 s63, s63, s7
    s_sub_u32 s62, s62, 1
    s_cmp_lg_u32 s62, 0
    s_cbranch_scc1 L_np
    v_mov_b32 v8, 162096
    v_mov_b32 v9, s63
    s_mov_b64 exec, 1
    ds_add_u32 v8, v9
    s_mov_b64 exec, -1
    v_mov_b32 v8, 162068
L_lw_120:
    ds_read_b32 v9, v8
    s_waitcnt lgkmcnt(0)
    v_cmp_gt_u32 vcc, 1, v9
    s_cbranch_vccz L_lw_120e
    s_sleep 32
    s_sub_u32 s60, s60, 1
    s_cbranch_scc0 L_lw_120
    s_mov_b32 s60, 0
L_lw_120e:
    s_cmp_ge_u32 s35, 20
    s_cbranch_scc1 L_nofin_121
    s_lshl1_add_u32 s62, s35, s3
    s_sub_u32 s62, s62, 6
    s_lshl_b32 s57, s62, 7
    s_mul_i32 s63, s62, 0x199a
    s_lshr_b32 s63, s63, 16
    s_mul_i32 s63, s63, 1280
    s_sub_u32 s63, s57, s63
    v_lshrrev_b32 v72, 3, v0
    v_mul_u32_u24 v72, 5120, v72
    v_and_b32 v8, 7, v0
    v_lshl_add_u32 v72, v8, 4, v72
    s_add_u32 s62, s57, 327680
    v_add_u32 v72, s62, v72
    v_add_u32 v73, 40960, v72
    v_add_u32 v74, 81920, v72
    v_add_u32 v75, 122880, v72
    v_bfe_u32 v9, v0, 4, 1
    v_lshlrev_b32 v76, 4, v8
    v_lshl_add_u32 v76, v9, 3, v76
    s_lshl_b32 s62, s57, 1
    s_add_u32 s62, s62, 99328
    v_lshl_add_u32 v77, v76, 1, s62
    s_mov_b32 s48, s22
    s_mov_b32 s49, s23
    s_mov_b32 s50, 1280
    s_mov_b32 s51, 0x20000
    buffer_load_dwordx2 v[86:87], v76, s[48:51], s63 offen
    s_add_u32 s62, s57, 35840
    s_branch L_poll_122
L_poll_122s:
    s_sleep 32
L_poll_122:
    buffer_load_dwordx2 v[8:9], v76, s[40:43], s62 offen sc1
    s_sub_u32 s60, s60, 1
    s_cbranch_scc1 L_poll_122t
    s_waitcnt vmcnt(0)
    v_max_u32 v38, v8, v9
    v_cmp_eq_u32 vcc, -1, v38
    s_cbranch_vccnz L_poll_122s
L_poll_122e:
    v_lshlrev_b32 v78, 16, v86
    v_and_b32 v79, 0xffff0000, v86
    v_lshlrev_b32 v82, 16, v8
    v_and_b32 v83, 0xffff0000, v8
    v_lshlrev_b32 v80, 16, v87
    v_and_b32 v81, 0xffff0000, v87
    v_lshlrev_b32 v84, 16, v9
    v_and_b32 v85, 0xffff0000, v9
    v_bfe_u32 v8, v0, 1, 3
    v_and_b32 v9, 1, v0
    v_lshlrev_b32 v9, 4, v9
    v_mov_b32 v10, 0x3f80
    v_lshlrev_b32 v9, v9, v10
    v_cmp_eq_u32 vcc, 0, v8
    v_mov_b32 v100, 0
    s_nop 0
    v_cndmask_b32 v104, 0, v9, vcc
    v_cmp_eq_u32 vcc, 1, v8
    v_mov_b32 v101, 0
    s_nop 0
    v_cndmask_b32 v105, 0, v9, vcc
    v_cmp_eq_u32 vcc, 2, v8
    v_mov_b32 v102, 0
    s_nop 0
    v_cndmask_b32 v106, 0, v9, vcc
    v_cmp_eq_u32 vcc, 3, v8
    v_mov_b32 v103, 0
    s_nop 0
    v_cndmask_b32 v107, 0, v9, vcc
L_nofin_121:
    v_mov_b32 v8, 162076
L_lw_123:
    ds_read_b32 v9, v8
    s_waitcnt lgkmcnt(0)
    v_cmp_gt_u32 vcc, 4, v9
    s_cbranch_vccz L_lw_123e
    s_sleep 16
    s_sub_u32 s60, s60, 1
    s_cbranch_scc0 L_lw_123
    s_mov_b32 s60, 0
L_lw_123e:
    s_branch L_poll_124
L_poll_124s:
    s_sleep 4
L_poll_124:
    buffer_load_dwordx4 v[32:35], v20, s[40:43], s97 offen sc1
    s_sub_u32 s60, s60, 1
    s_cbranch_scc1 L_poll_124t
    s_waitcnt vmcnt(0)
    v_max3_u32 v38, v32, v33, v34
    v_max_u32 v38, v38, v35
    v_cmp_eq_u32 vcc, -1, v38
    s_cbranch_vccnz L_poll_124s
L_poll_124e:
L_pxj:
    s_cmp_ge_u32 s35, 20
    s_cbranch_scc1 L_pxk
    s_mov_b64 exec, -1
L_pxk:
    v_mov_b32 v8, 162048
L_lw_125:
    ds_read_b32 v9, v8
    s_waitcnt lgkmcnt(0)
    v_cmp_gt_u32 vcc, 3, v9
    s_cbranch_vccz L_lw_125e
    s_sleep 2
    s_sub_u32 s60, s60, 1
    s_cbranch_scc0 L_lw_125
    s_mov_b32 s60, 0
L_lw_125e:
    v_lshrrev_b32 v9, 4, v0
    v_lshl_add_u32 v8, v9, 2, v2
    s_lshl_b32 s96, s3, 9
    s_add_u32 s96, s96, 157824
    v_lshl_add_u32 v8, v8, 2, s96
    v_lshlrev_b32 v9, 3, v0
    v_add_u32 v9, 157824, v9
    v_mov_b32 v10, 162048
    v_mov_b32 v11, 1
    s_lshl_b32 s96, s38, 5
    s_add_u32 s96, s96, 161984
    v_mov_b32 v3, s96
    s_sub_u32 s62, 8, s39
    s_lshl_b32 s98, s34, 5
    s_add_u32 s98, s98, s35
    s_lshl_b32 s98, s98, 8
    s_add_u32 s98, s98, 106496
    v_lshlrev_b32 v39, 2, v0
    s_branch L_t0
L_s_role:
    s_cmp_eq_u32 s3, 7
    s_cbranch_scc1 L_t2gate
    s_cmp_gt_u32 s3, 3
    s_cbranch_scc1 L_fin_prep
    s_mov_b32 s48, s18
    s_mov_b32 s49, s19
    s_mov_b32 s50, 3456
    s_mov_b32 s51, 0x20000
    v_lshrrev_b32 v3, 4, v0
    v_and_b32 v4, 15, v0
    v_lshlrev_b32 v4, 1, v4
    s_lshl_b32 s62, s35, 7
    s_lshl_b32 s63, s3, 5
    s_add_u32 s62, s62, s63
    buffer_load_ushort v82, v4, s[48:51], s62 offen
    v_mov_b32 v72, 162064
L_lw_126:
    ds_read_b32 v73, v72
    s_waitcnt lgkmcnt(0)
    v_cmp_gt_u32 vcc, 4, v73
    s_cbranch_vccz L_lw_126e
    s_sleep 2
    s_sub_u32 s60, s60, 1
    s_cbranch_scc0 L_lw_126
    s_mov_b32 s60, 0
L_lw_126e:
    v_bfe_u32 v72, v0, 2, 1
    v_bfe_u32 v73, v0, 4, 1
    v_lshl_add_u32 v72, v73, 2, v72
    v_and_b32 v73, 8, v0
    v_add_u32 v72, v72, v73
    v_lshrrev_b32 v73, 5, v0
    v_lshl_add_u32 v72, v73, 4, v72
    v_lshlrev_b32 v72, 7, v72
    v_and_b32 v73, 3, v0
    v_lshl_add_u32 v72, v73, 3, v72
    v_and_b32 v73, 8, v0
    v_lshl_add_u32 v72, v73, 3, v72
    v_xor_b32 v72, s63, v72
    v_xor_b32 v73, 32, v72
    v_add_u32 v74, 40960, v72
    v_add_u32 v75, 40960, v73
    v_bfe_u32 v1, v0, 2, 2
    v_bfe_u32 v2, v0, 1, 1
    v_and_b32 v6, 1, v0
    v_lshlrev_b32 v7, 5, v3
    v_lshl_add_u32 v7, v6, 4, v7
    v_lshl_add_u32 v5, v2, 2, v1
    v_mul_u32_u24 v5, 1296, v5
    v_add_u32 v5, v5, v7
    v_add_u32 v5, 147456, v5
    v_bfe_u32 v87, v0, 0, 1
    v_mul_u32_u24 v87, 0xaaaa, v87
    v_add_u32 v87, 0x4444, v87
    ds_read_b64_tr_b16 v[88:89], v72 offset:0
    ds_read_b64_tr_b16 v[90:91], v73 offset:256
    ds_read_b64_tr_b16 v[92:93], v72 offset:4096
    ds_read_b64_tr_b16 v[94:95], v73 offset:4352
    ds_read_b64_tr_b16 v[96:97], v72 offset:8192
    ds_read_b64_tr_b16 v[98:99], v73 offset:8448
    ds_read_b64_tr_b16 v[100:101], v72 offset:12288
    ds_read_b64_tr_b16 v[102:103], v73 offset:12544
    ds_read_b64_tr_b16 v[104:105], v72 offset:16384
    ds_read_b64_tr_b16 v[106:107], v73 offset:16640
    ds_read_b64_tr_b16 v[108:109], v72 offset:20480
    ds_read_b64_tr_b16 v[110:111], v73 offset:20736
    ds_read_b64_tr_b16 v[112:113], v72 offset:24576
    ds_read_b64_tr_b16 v[114:115], v73 offset:24832
    ds_read_b64_tr_b16 v[116:117], v72 offset:28672
    ds_read_b64_tr_b16 v[118:119], v73 offset:28928
    ds_read_b64_tr_b16 v[120:121], v72 offset:32768
    ds_read_b64_tr_b16 v[122:123], v73 offset:33024
    ds_read_b64_tr_b16 v[124:125], v72 offset:36864
    ds_read_b64_tr_b16 v[126:127], v73 offset:37120
    ds_read_b64_tr_b16 v[128:129], v74 offset:0
    ds_read_b64_tr_b16 v[130:131], v75 offset:256
    ds_read_b64_tr_b16 v[132:133], v74 offset:4096
    ds_read_b64_tr_b16 v[134:135], v75 offset:4352
    ds_read_b64_tr_b16 v[136:137], v74 offset:8192
    ds_read_b64_tr_b16 v[138:139], v75 offset:8448
    ds_read_b64_tr_b16 v[140:141], v74 offset:12288
    ds_read_b64_tr_b16 v[142:143], v75 offset:12544
    ds_read_b64_tr_b16 v[144:145], v74 offset:16384
    ds_read_b64_tr_b16 v[146:147], v75 offset:16640
    ds_read_b64_tr_b16 v[148:149], v74 offset:20480
    ds_read_b64_tr_b16 v[150:151], v75 offset:20736
    ds_read_b64_tr_b16 v[152:153], v74 offset:24576
    ds_read_b64_tr_b16 v[154:155], v75 offset:24832
    ds_read_b64_tr_b16 v[156:157], v74 offset:28672
    ds_read_b64_tr_b16 v[158:159], v75 offset:28928
    ds_read_b64_tr_b16 v[160:161], v74 offset:32768
    ds_read_b64_tr_b16 v[162:163], v75 offset:33024
    ds_read_b64_tr_b16 v[164:165], v74 offset:36864
    ds_read_b64_tr_b16 v[166:167], v75 offset:37120
    ds_read_b128 v[8:11], v5 offset:0
    ds_read_b128 v[12:15], v5 offset:128
    ds_read_b128 v[16:19], v5 offset:256
    ds_read_b128 v[20:23], v5 offset:384
    ds_read_b128 v[24:27], v5 offset:512
    ds_read_b128 v[28:31], v5 offset:640
    ds_read_b128 v[32:35], v5 offset:768
    ds_read_b128 v[36:39], v5 offset:896
    ds_read_b128 v[40:43], v5 offset:1024
    ds_read_b128 v[44:47], v5 offset:1152
    v_mov_b32 v48, 0
    v_mov_b32 v49, 0
    v_mov_b32 v50, 0
    v_mov_b32 v51, 0
    v_mov_b32 v52, 0
    v_mov_b32 v53, 0
    v_mov_b32 v54, 0
    v_mov_b32 v55, 0
    v_mov_b32 v56, 0
    v_mov_b32 v57, 0
    v_mov_b32 v58, 0
    v_mov_b32 v59, 0
    s_waitcnt lgkmcnt(9)
    v_smfmac_f32_16x16x64_bf16 v[48:51], v[8:11], v[88:95], v87
    s_waitcnt lgkmcnt(8)
    v_smfmac_f32_16x16x64_bf16 v[48:51], v[12:15], v[96:103], v87
    s_waitcnt lgkmcnt(7)
    v_smfmac_f32_16x16x64_bf16 v[48:51], v[16:19], v[104:111], v87
    s_waitcnt lgkmcnt(6)
    v_smfmac_f32_16x16x64_bf16 v[48:51], v[20:23], v[112:119], v87
    s_waitcnt lgkmcnt(5)
    v_smfmac_f32_16x16x64_bf16 v[48:51], v[24:27], v[120:127], v87
    s_waitcnt lgkmcnt(4)
    v_smfmac_f32_16x16x64_bf16 v[48:51], v[28:31], v[128:135], v87
    s_waitcnt lgkmcnt(3)
    v_smfmac_f32_16x16x64_bf16 v[48:51], v[32:35], v[136:143], v87
    s_waitcnt lgkmcnt(2)
    v_smfmac_f32_16x16x64_bf16 v[48:51], v[36:39], v[144:151], v87
    s_waitcnt lgkmcnt(1)
    v_smfmac_f32_16x16x64_bf16 v[48:51], v[40:43], v[152:159], v87
    s_waitcnt lgkmcnt(0)
    v_smfmac_f32_16x16x64_bf16 v[48:51], v[44:47], v[160:167], v87
    v_mul_u32_u24 v79, 1296, v1
    v_lshl_add_u32 v79, v2, 7, v79
    v_add_u32 v79, v79, v7
    v_add_u32 v79, 82944, v79
    v_mul_u32_u24 v80, 144, v3
    v_add3_u32 v80, v80, v4, s63
    v_add_u32 v80, 90688, v80
    v_lshlrev_b32 v81, 3, v0
    v_add_u32 v81, 88128, v81
    v_add_f32 v84, v48, v49
    v_add_f32 v85, v50, v51
    s_mov_b32 s62, 0xbacccccd
    s_mov_b32 s63, 0xbdd2d3e8
    v_mov_b32 v86, 0xc0135761
    s_waitcnt vmcnt(0)
    v_lshlrev_b32 v82, 16, v82
    v_add_f32 v85, v85, v82
    s_branch L_ffn1
L_fin_prep:
    s_cmp_lg_u32 s3, 6
    s_cbranch_scc1 L_end
    s_cmp_ge_u32 s35, 20
    s_cbranch_scc1 L_end
    s_barrier
L_fin:
    s_mov_b32 s52, s28
    s_mov_b32 s53, s29
    s_mov_b32 s54, 5120
    s_mov_b32 s55, 0x20000
    s_mov_b64 s[4:5], -1
    s_mov_b64 s[6:7], -1
    s_mov_b64 s[8:9], -1
    s_mov_b64 s[10:11], 0xffffff
    s_barrier
    ds_read_b128 v[108:111], v77
    s_barrier
L_yg:
    s_mov_b64 exec, s[4:5]
    buffer_load_dwordx4 v[88:91], v72, s[40:43], 0 offen sc1
    s_mov_b64 exec, s[6:7]
    buffer_load_dwordx4 v[92:95], v73, s[40:43], 0 offen sc1
    s_mov_b64 exec, s[8:9]
    buffer_load_dwordx4 v[96:99], v74, s[40:43], 0 offen sc1
    s_mov_b64 exec, s[10:11]
    buffer_load_dwordx4 v[100:103], v75, s[40:43], 0 offen sc1
    s_mov_b64 exec, -1
    s_sub_u32 s60, s60, 1
    s_cbranch_scc1 L_ygt
    s_waitcnt vmcnt(3)
    v_max3_u32 v3, v88, v89, v90
    v_max_u32 v3, v3, v91
    v_cmp_eq_u32 s[4:5], -1, v3
    s_waitcnt vmcnt(2)
    v_max3_u32 v3, v92, v93, v94
    v_max_u32 v3, v3, v95
    v_cmp_eq_u32 s[6:7], -1, v3
    s_waitcnt vmcnt(1)
    v_max3_u32 v3, v96, v97, v98
    v_max_u32 v3, v3, v99
    v_cmp_eq_u32 s[8:9], -1, v3
    s_waitcnt vmcnt(0)
    v_max3_u32 v3, v100, v101, v102
    v_max_u32 v3, v3, v103
    v_cmp_eq_u32 s[10:11], -1, v3
    s_or_b64 s[16:17], s[4:5], s[6:7]
    s_or_b64 s[16:17], s[16:17], s[8:9]
    s_or_b64 s[16:17], s[16:17], s[10:11]
    s_cbranch_scc1 L_yg
L_ygd:
    v_mfma_f32_16x16x32_bf16 v[112:115], v[104:107], v[88:91], 0
    v_mfma_f32_16x16x32_bf16 v[112:115], v[104:107], v[92:95], v[112:115]
    v_mfma_f32_16x16x32_bf16 v[112:115], v[104:107], v[96:99], v[112:115]
    v_mfma_f32_16x16x32_bf16 v[112:115], v[104:107], v[100:103], v[112:115]
    s_waitcnt lgkmcnt(0)
    v_pk_fma_f32 v[108:109], v[78:79], v[82:83], v[108:109]
    v_pk_fma_f32 v[110:111], v[80:81], v[84:85], v[110:111]
    s_nop 4
    v_add_f32_dpp v112, v112, v112 row_ror:8 row_mask:0xf bank_mask:0xf
    v_add_f32_dpp v113, v113, v113 row_ror:8 row_mask:0xf bank_mask:0xf
    v_add_f32_dpp v114, v114, v114 row_ror:8 row_mask:0xf bank_mask:0xf
    v_add_f32_dpp v115, v115, v115 row_ror:8 row_mask:0xf bank_mask:0xf
    v_pk_fma_f32 v[112:113], v[112:113], v[82:83], v[108:109]
    v_pk_fma_f32 v[114:115], v[114:115], v[84:85], v[110:111]
    v_cvt_pk_bf16_f32 v112, v112, v113
    v_cvt_pk_bf16_f32 v113, v114, v115
    s_mov_b64 exec, 0x00ff00ff
    buffer_store_dwordx2 v[112:113], v76, s[52:55], s57 offen
    s_endpgm
L_t2gate:
    v_mov_b32 v8, 162048
L_lw_127:
    ds_read_b32 v9, v8
    s_waitcnt lgkmcnt(0)
    v_cmp_gt_u32 vcc, 8, v9
    s_cbranch_vccz L_lw_127e
    s_sleep 2
    s_sub_u32 s60, s60, 1
    s_cbranch_scc0 L_lw_127
    s_mov_b32 s60, 0
L_lw_127e:
    ds_read_b32 v9, v8 offset:24
    ds_read_b32 v10, v8 offset:36
    v_add_u32 v5, 212992, v5
    s_waitcnt lgkmcnt(0)
    v_readfirstlane_b32 s61, v9
    v_add_u32 v5, v5, v10
    s_mov_b32 s58, 0x3f80
    s_mov_b32 s59, 0x3f800000
    s_mov_b32 s63, 0xff
L_prb:
    s_bcnt1_i32_b32 s62, s63
    s_mov_b32 s97, s63
    s_ff1_i32_b32 s12, s97
    s_bitset0_b32 s97, s12
    s_mul_i32 s4, s12, 5120
    s_add_u32 s4, s4, s56
    s_and_b32 s96, s4, 0xffffe000
    s_add_u32 s4, s4, s96
    s_cmp_eq_u32 s62, 1
    s_cbranch_scc1 L_pi1
    s_ff1_i32_b32 s13, s97
    s_bitset0_b32 s97, s13
    s_mul_i32 s5, s13, 5120
    s_add_u32 s5, s5, s56
    s_and_b32 s96, s5, 0xffffe000
    s_add_u32 s5, s5, s96
    s_cmp_eq_u32 s62, 2
    s_cbranch_scc1 L_pi2
    s_ff1_i32_b32 s14, s97
    s_bitset0_b32 s97, s14
    s_mul_i32 s6, s14, 5120
    s_add_u32 s6, s6, s56
    s_and_b32 s96, s6, 0xffffe000
    s_add_u32 s6, s6, s96
    s_cmp_eq_u32 s62, 3
    s_cbranch_scc1 L_pi3
    s_ff1_i32_b32 s15, s97
    s_bitset0_b32 s97, s15
    s_mul_i32 s7, s15, 5120
    s_add_u32 s7, s7, s56
    s_and_b32 s96, s7, 0xffffe000
    s_add_u32 s7, s7, s96
    s_cmp_eq_u32 s62, 4
    s_cbranch_scc1 L_pi4
    s_ff1_i32_b32 s16, s97
    s_bitset0_b32 s97, s16
    s_mul_i32 s8, s16, 5120
    s_add_u32 s8, s8, s56
    s_and_b32 s96, s8, 0xffffe000
    s_add_u32 s8, s8, s96
    s_cmp_eq_u32 s62, 5
    s_cbranch_scc1 L_pi5
    s_ff1_i32_b32 s17, s97
    s_bitset0_b32 s97, s17
    s_mul_i32 s9, s17, 5120
    s_add_u32 s9, s9, s56
    s_and_b32 s96, s9, 0xffffe000
    s_add_u32 s9, s9, s96
    s_cmp_eq_u32 s62, 6
    s_cbranch_scc1 L_pi6
    s_ff1_i32_b32 s18, s97
    s_bitset0_b32 s97, s18
    s_mul_i32 s10, s18, 5120
    s_add_u32 s10, s10, s56
    s_and_b32 s96, s10, 0xffffe000
    s_add_u32 s10, s10, s96
    s_cmp_eq_u32 s62, 7
    s_cbranch_scc1 L_pi7
    s_ff1_i32_b32 s19, s97
    s_bitset0_b32 s97, s19
    s_mul_i32 s11, s19, 5120
    s_add_u32 s11, s11, s56
    s_and_b32 s96, s11, 0xffffe000
    s_add_u32 s11, s11, s96
L_pi8:
    buffer_load_dwordx4 v[36:39], v5, s[40:43], s11 offen sc1
L_pi7:
    buffer_load_dwordx4 v[32:35], v5, s[40:43], s10 offen sc1
L_pi6:
    buffer_load_dwordx4 v[28:31], v5, s[40:43], s9 offen sc1
L_pi5:
    buffer_load_dwordx4 v[24:27], v5, s[40:43], s8 offen sc1
L_pi4:
    buffer_load_dwordx4 v[20:23], v5, s[40:43], s7 offen sc1
L_pi3:
    buffer_load_dwordx4 v[16:19], v5, s[40:43], s6 offen sc1
L_pi2:
    buffer_load_dwordx4 v[12:15], v5, s[40:43], s5 offen sc1
    buffer_load_dwordx4 v[8:11], v5, s[40:43], s4 offen sc1
    s_sub_u32 s60, s60, 1
    s_cbranch_scc1 L_pto
    s_waitcnt vmcnt(0)
    v_max3_u32 v3, v8, v9, v10
    v_max_u32 v3, v3, v11
    v_cmp_eq_u32 vcc, -1, v3
    s_cbranch_vccz L_pgot0
    v_max3_u32 v3, v12, v13, v14
    v_max_u32 v3, v3, v15
    v_cmp_eq_u32 vcc, -1, v3
    s_cbranch_vccz L_pgot1
    s_cmp_eq_u32 s62, 2
    s_cbranch_scc1 L_pi2
    v_max3_u32 v3, v16, v17, v18
    v_max_u32 v3, v3, v19
    v_cmp_eq_u32 vcc, -1, v3
    s_cbranch_vccz L_pgot2
    s_cmp_eq_u32 s62, 3
    s_cbranch_scc1 L_pi3
    v_max3_u32 v3, v20, v21, v22
    v_max_u32 v3, v3, v23
    v_cmp_eq_u32 vcc, -1, v3
    s_cbranch_vccz L_pgot3
    s_cmp_eq_u32 s62, 4
    s_cbranch_scc1 L_pi4
    v_max3_u32 v3, v24, v25, v26
    v_max_u32 v3, v3, v27
    v_cmp_eq_u32 vcc, -1, v3
    s_cbranch_vccz L_pgot4
    s_cmp_eq_u32 s62, 5
    s_cbranch_scc1 L_pi5
    v_max3_u32 v3, v28, v29, v30
    v_max_u32 v3, v3, v31
    v_cmp_eq_u32 vcc, -1, v3
    s_cbranch_vccz L_pgot5
    s_cmp_eq_u32 s62, 6
    s_cbranch_scc1 L_pi6
    v_max3_u32 v3, v32, v33, v34
    v_max_u32 v3, v3, v35
    v_cmp_eq_u32 vcc, -1, v3
    s_cbranch_vccz L_pgot6
    s_cmp_eq_u32 s62, 7
    s_cbranch_scc1 L_pi7
    v_max3_u32 v3, v36, v37, v38
    v_max_u32 v3, v3, v39
    v_cmp_eq_u32 vcc, -1, v3
    s_cbranch_vccz L_pgot7
    s_branch L_pi8
L_pgot0:
    v_dot2c_f32_bf16 v64, s58, v8
    v_dot2c_f32_bf16 v65, s59, v8
    v_dot2c_f32_bf16 v66, s58, v9
    v_dot2c_f32_bf16 v67, s59, v9
    v_dot2c_f32_bf16 v68, s58, v10
    v_dot2c_f32_bf16 v69, s59, v10
    v_dot2c_f32_bf16 v70, s58, v11
    v_dot2c_f32_bf16 v71, s59, v11
    s_bitset0_b32 s63, s12
    s_cmp_eq_u32 s63, 0
    s_cbranch_scc1 L_pgd
L_pn0:
    s_cmp_eq_u32 s62, 1
    s_cbranch_scc1 L_prb
    v_max3_u32 v3, v12, v13, v14
    v_max_u32 v3, v3, v15
    v_cmp_eq_u32 vcc, -1, v3
    s_cbranch_vccnz L_pn1
L_pgot1:
    v_dot2c_f32_bf16 v64, s58, v12
    v_dot2c_f32_bf16 v65, s59, v12
    v_dot2c_f32_bf16 v66, s58, v13
    v_dot2c_f32_bf16 v67, s59, v13
    v_dot2c_f32_bf16 v68, s58, v14
    v_dot2c_f32_bf16 v69, s59, v14
    v_dot2c_f32_bf16 v70, s58, v15
    v_dot2c_f32_bf16 v71, s59, v15
    s_bitset0_b32 s63, s13
    s_cmp_eq_u32 s63, 0
    s_cbranch_scc1 L_pgd
L_pn1:
    s_cmp_eq_u32 s62, 2
    s_cbranch_scc1 L_prb
    v_max3_u32 v3, v16, v17, v18
    v_max_u32 v3, v3, v19
    v_cmp_eq_u32 vcc, -1, v3
    s_cbranch_vccnz L_pn2
L_pgot2:
    v_dot2c_f32_bf16 v64, s58, v16
    v_dot2c_f32_bf16 v65, s59, v16
    v_dot2c_f32_bf16 v66, s58, v17
    v_dot2c_f32_bf16 v67, s59, v17
    v_dot2c_f32_bf16 v68, s58, v18
    v_dot2c_f32_bf16 v69, s59, v18
    v_dot2c_f32_bf16 v70, s58, v19
    v_dot2c_f32_bf16 v71, s59, v19
    s_bitset0_b32 s63, s14
    s_cmp_eq_u32 s63, 0
    s_cbranch_scc1 L_pgd
L_pn2:
    s_cmp_eq_u32 s62, 3
    s_cbranch_scc1 L_prb
    v_max3_u32 v3, v20, v21, v22
    v_max_u32 v3, v3, v23
    v_cmp_eq_u32 vcc, -1, v3
    s_cbranch_vccnz L_pn3
L_pgot3:
    v_dot2c_f32_bf16 v64, s58, v20
    v_dot2c_f32_bf16 v65, s59, v20
    v_dot2c_f32_bf16 v66, s58, v21
    v_dot2c_f32_bf16 v67, s59, v21
    v_dot2c_f32_bf16 v68, s58, v22
    v_dot2c_f32_bf16 v69, s59, v22
    v_dot2c_f32_bf16 v70, s58, v23
    v_dot2c_f32_bf16 v71, s59, v23
    s_bitset0_b32 s63, s15
    s_cmp_eq_u32 s63, 0
    s_cbranch_scc1 L_pgd
L_pn3:
    s_cmp_eq_u32 s62, 4
    s_cbranch_scc1 L_prb
    v_max3_u32 v3, v24, v25, v26
    v_max_u32 v3, v3, v27
    v_cmp_eq_u32 vcc, -1, v3
    s_cbranch_vccnz L_pn4
L_pgot4:
    v_dot2c_f32_bf16 v64, s58, v24
    v_dot2c_f32_bf16 v65, s59, v24
    v_dot2c_f32_bf16 v66, s58, v25
    v_dot2c_f32_bf16 v67, s59, v25
    v_dot2c_f32_bf16 v68, s58, v26
    v_dot2c_f32_bf16 v69, s59, v26
    v_dot2c_f32_bf16 v70, s58, v27
    v_dot2c_f32_bf16 v71, s59, v27
    s_bitset0_b32 s63, s16
    s_cmp_eq_u32 s63, 0
    s_cbranch_scc1 L_pgd
L_pn4:
    s_cmp_eq_u32 s62, 5
    s_cbranch_scc1 L_prb
    v_max3_u32 v3, v28, v29, v30
    v_max_u32 v3, v3, v31
    v_cmp_eq_u32 vcc, -1, v3
    s_cbranch_vccnz L_pn5
L_pgot5:
    v_dot2c_f32_bf16 v64, s58, v28
    v_dot2c_f32_bf16 v65, s59, v28
    v_dot2c_f32_bf16 v66, s58, v29
    v_dot2c_f32_bf16 v67, s59, v29
    v_dot2c_f32_bf16 v68, s58, v30
    v_dot2c_f32_bf16 v69, s59, v30
    v_dot2c_f32_bf16 v70, s58, v31
    v_dot2c_f32_bf16 v71, s59, v31
    s_bitset0_b32 s63, s17
    s_cmp_eq_u32 s63, 0
    s_cbranch_scc1 L_pgd
L_pn5:
    s_cmp_eq_u32 s62, 6
    s_cbranch_scc1 L_prb
    v_max3_u32 v3, v32, v33, v34
    v_max_u32 v3, v3, v35
    v_cmp_eq_u32 vcc, -1, v3
    s_cbranch_vccnz L_pn6
L_pgot6:
    v_dot2c_f32_bf16 v64, s58, v32
    v_dot2c_f32_bf16 v65, s59, v32
    v_dot2c_f32_bf16 v66, s58, v33
    v_dot2c_f32_bf16 v67, s59, v33
    v_dot2c_f32_bf16 v68, s58, v34
    v_dot2c_f32_bf16 v69, s59, v34
    v_dot2c_f32_bf16 v70, s58, v35
    v_dot2c_f32_bf16 v71, s59, v35
    s_bitset0_b32 s63, s18
    s_cmp_eq_u32 s63, 0
    s_cbranch_scc1 L_pgd
L_pn6:
    s_cmp_eq_u32 s62, 7
    s_cbranch_scc1 L_prb
    v_max3_u32 v3, v36, v37, v38
    v_max_u32 v3, v3, v39
    v_cmp_eq_u32 vcc, -1, v3
    s_cbranch_vccnz L_pn7
L_pgot7:
    v_dot2c_f32_bf16 v64, s58, v36
    v_dot2c_f32_bf16 v65, s59, v36
    v_dot2c_f32_bf16 v66, s58, v37
    v_dot2c_f32_bf16 v67, s59, v37
    v_dot2c_f32_bf16 v68, s58, v38
    v_dot2c_f32_bf16 v69, s59, v38
    v_dot2c_f32_bf16 v70, s58, v39
    v_dot2c_f32_bf16 v71, s59, v39
    s_bitset0_b32 s63, s19
    s_cmp_eq_u32 s63, 0
    s_cbranch_scc1 L_pgd
L_pn7:
    s_branch L_prb
L_pi1:
L_poll_128:
    buffer_load_dwordx4 v[8:11], v5, s[40:43], s4 offen sc1
    s_sub_u32 s60, s60, 1
    s_cbranch_scc1 L_poll_128t
    s_waitcnt vmcnt(0)
    v_max3_u32 v3, v8, v9, v10
    v_max_u32 v3, v3, v11
    v_cmp_eq_u32 vcc, -1, v3
    s_cbranch_vccnz L_poll_128
L_poll_128e:
    v_dot2c_f32_bf16 v64, s58, v8
    v_dot2c_f32_bf16 v65, s59, v8
    v_dot2c_f32_bf16 v66, s58, v9
    v_dot2c_f32_bf16 v67, s59, v9
    v_dot2c_f32_bf16 v68, s58, v10
    v_dot2c_f32_bf16 v69, s59, v10
    v_dot2c_f32_bf16 v70, s58, v11
    v_dot2c_f32_bf16 v71, s59, v11
L_pgd:
    v_pk_fma_f32 v[64:65], v[64:65], v[48:49], v[40:41]
    v_pk_fma_f32 v[66:67], v[66:67], v[50:51], v[42:43]
    v_pk_fma_f32 v[68:69], v[68:69], v[52:53], v[44:45]
    v_pk_fma_f32 v[70:71], v[70:71], v[54:55], v[46:47]
    v_pk_mul_f32 v[56:57], v[64:65], v[56:57]
    v_pk_mul_f32 v[58:59], v[66:67], v[58:59]
    v_pk_mul_f32 v[60:61], v[68:69], v[60:61]
    v_pk_mul_f32 v[62:63], v[70:71], v[62:63]
    v_cvt_pk_bf16_f32 v8, v56, v57
    v_cvt_pk_bf16_f32 v9, v58, v59
    v_cvt_pk_bf16_f32 v10, v60, v61
    v_cvt_pk_bf16_f32 v11, v62, v63
    ds_write_b128 v4, v[8:11]
    v_pk_add_f32 v[40:41], v[64:65], v[66:67]
    v_pk_add_f32 v[42:43], v[68:69], v[70:71]
    v_pk_mul_f32 v[44:45], v[64:65], v[64:65]
    v_pk_mul_f32 v[46:47], v[66:67], v[66:67]
    v_pk_add_f32 v[40:41], v[40:41], v[42:43]
    v_pk_fma_f32 v[44:45], v[68:69], v[68:69], v[44:45]
    v_pk_fma_f32 v[46:47], v[70:71], v[70:71], v[46:47]
    v_add_f32 v40, v40, v41
    v_pk_add_f32 v[44:45], v[44:45], v[46:47]
    v_add_f32 v41, v44, v45
    ds_write_b64 v7, v[40:41]
    s_waitcnt lgkmcnt(0)
    s_barrier
    v_mov_b32 v16, 0
    v_mov_b32 v17, 0
    v_mov_b32 v18, 0
    v_mov_b32 v19, 0
    v_mov_b32 v20, 0
    v_mov_b32 v21, 0
    v_mov_b32 v22, 0
    v_mov_b32 v23, 0
    v_mov_b32 v24, 0
    v_mov_b32 v25, 0
    v_mov_b32 v26, 0
    v_mov_b32 v27, 0
    v_mov_b32 v28, 0
    v_mov_b32 v29, 0
    v_mov_b32 v30, 0
    v_mov_b32 v31, 0
    v_mov_b32 v32, 0
    v_mov_b32 v33, 0
    v_mov_b32 v34, 0
    v_mov_b32 v35, 0
    ds_write_b128 v6, v[64:67]
    ds_write_b128 v6, v[68:71] offset:16
    s_waitcnt lgkmcnt(0)
    s_cmp_lg_u32 s3, 7
    s_cbranch_scc1 L_ffn2
    s_cmp_lt_u32 s35, 20
    s_cbranch_scc1 L_fin
    s_endpgm
L_ffn1:
    s_barrier
L_ffn1b:
    ds_read_b128 v[8:11], v79
    ds_read_b64 v[30:31], v81 offset:0
    ds_read_b64 v[32:33], v81 offset:512
    ds_read_b64 v[34:35], v81 offset:1024
    ds_read_b64 v[36:37], v81 offset:1536
    ds_read_b64 v[38:39], v81 offset:2048
    ds_read_b128 v[12:15], v79 offset:256
    ds_read_b128 v[16:19], v79 offset:512
    ds_read_b128 v[20:23], v79 offset:768
    ds_read_b128 v[24:27], v79 offset:1024
    s_waitcnt lgkmcnt(9)
    v_smfmac_f32_16x16x64_bf16 v[52:55], v[8:11], v[88:95], v87
    v_smfmac_f32_16x16x64_bf16 v[56:59], v[8:11], v[96:103], v87
    s_waitcnt lgkmcnt(3)
    v_smfmac_f32_16x16x64_bf16 v[52:55], v[12:15], v[104:111], v87
    v_pk_add_f32 v[30:31], v[30:31], v[32:33]
    v_pk_add_f32 v[34:35], v[34:35], v[36:37]
    v_smfmac_f32_16x16x64_bf16 v[56:59], v[12:15], v[112:119], v87
    v_pk_add_f32 v[30:31], v[30:31], v[38:39]
    v_pk_add_f32 v[30:31], v[30:31], v[34:35]
    s_nop 0
    s_waitcnt lgkmcnt(2)
    v_smfmac_f32_16x16x64_bf16 v[52:55], v[16:19], v[120:127], v87
    v_add_f32_dpp v30, v30, v30 quad_perm:[1,0,3,2] row_mask:0xf bank_mask:0xf
    v_add_f32_dpp v31, v31, v31 quad_perm:[1,0,3,2] row_mask:0xf bank_mask:0xf
    v_smfmac_f32_16x16x64_bf16 v[56:59], v[16:19], v[128:135], v87
    v_add_f32_dpp v30, v30, v30 quad_perm:[2,3,0,1] row_mask:0xf bank_mask:0xf
    v_add_f32_dpp v31, v31, v31 quad_perm:[2,3,0,1] row_mask:0xf bank_mask:0xf
    s_waitcnt lgkmcnt(1)
    v_smfmac_f32_16x16x64_bf16 v[52:55], v[20:23], v[136:143], v87
    v_add_f32_dpp v30, v30, v30 row_ror:4 row_mask:0xf bank_mask:0xf
    v_add_f32_dpp v31, v31, v31 row_ror:4 row_mask:0xf bank_mask:0xf
    v_smfmac_f32_16x16x64_bf16 v[56:59], v[20:23], v[144:151], v87
    v_add_f32_dpp v30, v30, v30 row_ror:8 row_mask:0xf bank_mask:0xf
    v_add_f32_dpp v31, v31, v31 row_ror:8 row_mask:0xf bank_mask:0xf
    s_waitcnt lgkmcnt(0)
    v_smfmac_f32_16x16x64_bf16 v[52:55], v[24:27], v[152:159], v87
    v_mul_f32 v48, s62, v30
    v_mul_f32 v49, s62, v31
    v_smfmac_f32_16x16x64_bf16 v[56:59], v[24:27], v[160:167], v87
    v_mul_f32 v7, v84, v48
    v_fma_f32 v49, -v48, v48, -v49
    v_max_f32 v49, 0, v49
    v_add_f32 v49, 0x3727c5ac, v49
    v_rsq_f32 v49, v49
    v_add_f32 v4, v52, v53
    v_add_f32 v4, v4, v7
    s_nop 0
    v_add_f32 v5, v58, v59
    v_add_f32 v4, v4, v5
    v_fma_f32 v4, v4, v49, v85
    v_mul_f32 v5, v4, v4
    v_fma_f32 v5, v5, s63, v86
    v_mul_f32 v5, v5, v4
    v_exp_f32 v5, v5
    s_nop 0
    v_add_f32 v5, 1.0, v5
    v_rcp_f32 v5, v5
    s_nop 0
    v_mul_f32 v4, v4, v5
    v_cvt_pk_bf16_f32 v4, v4, v4
    ds_write_b16 v80, v4
    s_waitcnt lgkmcnt(0)
    s_barrier
    s_endpgm
L_h_t1:
    s_sub_u32 s63, s56, 154
    s_cmp_lt_u32 s63, 16
    s_cbranch_scc0 L_h_noclr
    s_lshl2_add_u32 s62, s63, s3
    s_mul_i32 s62, s62, 4608
    v_mov_b32 v4, -1
    v_mov_b32 v5, -1
    v_mov_b32 v6, -1
    v_mov_b32 v7, -1
    v_lshlrev_b32 v8, 4, v0
    buffer_store_dwordx4 v[4:7], v8, s[40:43], s62 offen offset:0 sc1
    buffer_store_dwordx4 v[4:7], v8, s[40:43], s62 offen offset:1024 sc1
    buffer_store_dwordx4 v[4:7], v8, s[40:43], s62 offen offset:2048 sc1
    buffer_store_dwordx4 v[4:7], v8, s[40:43], s62 offen offset:3072 sc1
    s_add_u32 s62, s62, 4096
    s_bfm_b64 exec, 32, 0
    buffer_store_dwordx4 v[4:7], v8, s[40:43], s62 offen offset:0 sc1
    s_mov_b64 exec, 1
    v_mov_b32 v9, 162100
    v_mov_b32 v10, 1
    s_and_b32 s62, s63, 1
    s_mul_i32 s62, s62, 126
    s_lshl1_add_u32 s63, s63, s62
    s_waitcnt vmcnt(0)
    ds_add_rtn_u32 v10, v9, v10
    s_waitcnt lgkmcnt(0)
    v_readfirstlane_b32 s62, v10
    s_nop 0
    s_cmp_lg_u32 s62, 3
    s_cbranch_scc1 L_h_clrd
    buffer_store_dword v4, v36, s[44:47], s63 offen sc1
L_h_clrd:
    s_mov_b64 exec, -1
L_h_noclr:
    v_lshrrev_b32 v1, 3, v0
    v_mul_u32_u24 v1, 1280, v1
    v_and_b32 v2, 7, v0
    v_lshl_add_u32 v1, v2, 4, v1
    s_lshl2_add_u32 s63, s34, s3
    s_mul_i32 s63, s63, 163840
    s_lshl_b32 s62, s35, 7
    s_add_u32 s63, s63, s62
    s_sub_u32 s63, s63, 2816
    s_lshl_b32 s62, s3, 14
    s_add_u32 s62, s62, 81920
    s_mov_b32 m0, s62
    s_mov_b32 s48, s12
    s_mov_b32 s49, s13
    s_mov_b32 s50, 5242880
    s_mov_b32 s51, 0x20000
    s_add_u32 s100, s39, 1
    s_mov_b32 s62, 8
L_dma_5:
    buffer_load_dwordx4 v1, s[48:51], s63 offen nt lds
    s_add_u32 m0, m0, 1024
    s_add_u32 s63, s63, 10240
    s_cmp_eq_u32 s100, 0
    s_cbranch_scc1 L_dma_5n0
    s_waitcnt vmcnt(7)
    s_cmp_eq_u32 s100, 2
    s_cbranch_scc1 L_dma_5n0
    s_waitcnt vmcnt(5)
L_dma_5n0:
    buffer_load_dwordx4 v1, s[48:51], s63 offen nt lds
    s_add_u32 m0, m0, 1024
    s_add_u32 s63, s63, 10240
    s_cmp_eq_u32 s100, 0
    s_cbranch_scc1 L_dma_5n1
    s_waitcnt vmcnt(7)
    s_cmp_eq_u32 s100, 2
    s_cbranch_scc1 L_dma_5n1
    s_waitcnt vmcnt(5)
L_dma_5n1:
    s_sub_u32 s62, s62, 1
    s_cmp_lg_u32 s62, 0
    s_cbranch_scc1 L_dma_5
    s_cmp_eq_u32 s39, 1
    s_cbranch_scc1 L_h_role
    s_barrier
    s_waitcnt vmcnt(0)
    v_mov_b32 v4, 162060
    v_mov_b32 v5, 1
    s_mov_b64 exec, 1
    ds_add_u32 v4, v5
    s_mov_b64 exec, -1
    s_cmp_eq_u32 s3, 0
    s_cbranch_scc1 L_service
    s_endpgm
L_h_role:
    v_mov_b32 v72, 0
    v_mov_b32 v73, 0
    v_mov_b32 v74, 0
    v_mov_b32 v75, 0
    v_mov_b32 v76, 0
    v_lshrrev_b32 v3, 4, v0
    v_and_b32 v2, 3, v0
    v_bfe_u32 v1, v0, 2, 2
    v_mul_u32_u24 v160, 1280, v3
    v_and_b32 v4, 15, v0
    v_lshl_add_u32 v163, v4, 2, v160
    v_lshl_add_u32 v160, v4, 3, v160
    s_mul_i32 s57, s35, 5120
    s_mul_i32 s62, s3, 320
    s_add_u32 s57, s57, s62
    s_add_u32 s57, s57, 327680
    v_add_u32 v8, 0, v0
    v_mul_u32_u24 v10, 0xccd, v8
    v_lshrrev_b32 v10, 16, v10
    v_mul_u32_u24 v9, 20, v10
    v_sub_u32 v8, v8, v9
    v_mul_u32_u24 v10, 1280, v10
    v_lshl_add_u32 v10, v8, 4, v10
    v_add_u32 v8, 64, v0
    v_mul_u32_u24 v11, 0xccd, v8
    v_lshrrev_b32 v11, 16, v11
    v_mul_u32_u24 v9, 20, v11
    v_sub_u32 v8, v8, v9
    v_mul_u32_u24 v11, 1280, v11
    v_lshl_add_u32 v11, v8, 4, v11
    v_add_u32 v8, 128, v0
    v_mul_u32_u24 v12, 0xccd, v8
    v_lshrrev_b32 v12, 16, v12
    v_mul_u32_u24 v9, 20, v12
    v_sub_u32 v8, v8, v9
    v_mul_u32_u24 v12, 1280, v12
    v_lshl_add_u32 v12, v8, 4, v12
    v_add_u32 v8, 192, v0
    v_mul_u32_u24 v13, 0xccd, v8
    v_lshrrev_b32 v13, 16, v13
    v_mul_u32_u24 v9, 20, v13
    v_sub_u32 v8, v8, v9
    v_mul_u32_u24 v13, 1280, v13
    v_lshl_add_u32 v13, v8, 4, v13
    v_add_u32 v8, 256, v0
    v_mul_u32_u24 v14, 0xccd, v8
    v_lshrrev_b32 v14, 16, v14
    v_mul_u32_u24 v9, 20, v14
    v_sub_u32 v8, v8, v9
    v_mul_u32_u24 v14, 1280, v14
    v_lshl_add_u32 v14, v8, 4, v14
    s_mov_b32 s48, s20
    s_mov_b32 s49, s21
    s_mov_b32 s50, 2211840
    s_mov_b32 s51, 0x20000
    s_mul_i32 s63, s35, 81920
    s_mul_i32 s62, s3, 320
    s_add_u32 s63, s63, s62
    s_mov_b32 m0, s101
    s_mov_b32 s62, 4
L_w2dma:
    buffer_load_dwordx4 v10, s[48:51], s63 offen nt lds
    s_add_u32 m0, m0, 1024
    s_waitcnt vmcnt(7)
    s_cmp_ge_u32 s35, 22
    s_cbranch_scc1 L_w2n0
    s_waitcnt vmcnt(7)
L_w2n0:
    buffer_load_dwordx4 v11, s[48:51], s63 offen nt lds
    s_add_u32 m0, m0, 1024
    s_waitcnt vmcnt(7)
    s_cmp_ge_u32 s35, 22
    s_cbranch_scc1 L_w2n1
    s_waitcnt vmcnt(7)
L_w2n1:
    buffer_load_dwordx4 v12, s[48:51], s63 offen nt lds
    s_add_u32 m0, m0, 1024
    s_waitcnt vmcnt(7)
    s_cmp_ge_u32 s35, 22
    s_cbranch_scc1 L_w2n2
    s_waitcnt vmcnt(7)
L_w2n2:
    buffer_load_dwordx4 v13, s[48:51], s63 offen nt lds
    s_add_u32 m0, m0, 1024
    s_waitcnt vmcnt(7)
    s_cmp_ge_u32 s35, 22
    s_cbranch_scc1 L_w2n3
    s_waitcnt vmcnt(7)
L_w2n3:
    buffer_load_dwordx4 v14, s[48:51], s63 offen nt lds
    s_add_u32 m0, m0, 1024
    s_waitcnt vmcnt(7)
    s_cmp_ge_u32 s35, 22
    s_cbranch_scc1 L_w2n4
    s_waitcnt vmcnt(7)
L_w2n4:
    s_add_u32 s63, s63, 20480
    s_sub_u32 s62, s62, 1
    s_cmp_lg_u32 s62, 0
    s_cbranch_scc1 L_w2dma
    v_lshrrev_b32 v8, 5, v0
    v_lshlrev_b32 v8, 2, v8
    v_bfe_u32 v9, v0, 4, 1
    v_add_u32 v8, v8, v9
    v_mul_u32_u24 v8, 1280, v8
    v_add_u32 v8, s101, v8
    v_and_b32 v10, 15, v0
    v_lshl_add_u32 v9, v10, 2, v8
    v_lshl_add_u32 v8, v10, 3, v8
    s_mov_b32 s62, 0x05040100
    s_mov_b32 s63, 0x07060302
    s_waitcnt vmcnt(0)
    v_mov_b32 v4, 162060
    v_mov_b32 v5, 1
    s_mov_b64 exec, 1
    ds_add_u32 v4, v5
    s_mov_b64 exec, -1
    ds_read_b64 v[16:17], v8 offset:0
    ds_read_b64 v[18:19], v8 offset:320
    ds_read_b64 v[20:21], v8 offset:2560
    ds_read_b64 v[22:23], v8 offset:2880
    ds_read_b64 v[24:25], v8 offset:640
    ds_read_b64 v[26:27], v8 offset:960
    ds_read_b64 v[28:29], v8 offset:3200
    ds_read_b64 v[30:31], v8 offset:3520
    ds_read_b64 v[32:33], v8 offset:10240
    ds_read_b64 v[34:35], v8 offset:10560
    ds_read_b64 v[36:37], v8 offset:12800
    ds_read_b64 v[38:39], v8 offset:13120
    ds_read_b64 v[40:41], v8 offset:10880
    ds_read_b64 v[42:43], v8 offset:11200
    ds_read_b64 v[44:45], v8 offset:13440
    ds_read_b64 v[46:47], v8 offset:13760
    s_waitcnt lgkmcnt(0)
    v_perm_b32 v80, v18, v16, s62
    v_perm_b32 v88, v18, v16, s63
    v_perm_b32 v96, v19, v17, s62
    v_perm_b32 v104, v19, v17, s63
    v_perm_b32 v81, v22, v20, s62
    v_perm_b32 v89, v22, v20, s63
    v_perm_b32 v97, v23, v21, s62
    v_perm_b32 v105, v23, v21, s63
    v_perm_b32 v82, v26, v24, s62
    v_perm_b32 v90, v26, v24, s63
    v_perm_b32 v98, v27, v25, s62
    v_perm_b32 v106, v27, v25, s63
    v_perm_b32 v83, v30, v28, s62
    v_perm_b32 v91, v30, v28, s63
    v_perm_b32 v99, v31, v29, s62
    v_perm_b32 v107, v31, v29, s63
    v_perm_b32 v84, v34, v32, s62
    v_perm_b32 v92, v34, v32, s63
    v_perm_b32 v100, v35, v33, s62
    v_perm_b32 v108, v35, v33, s63
    v_perm_b32 v85, v38, v36, s62
    v_perm_b32 v93, v38, v36, s63
    v_perm_b32 v101, v39, v37, s62
    v_perm_b32 v109, v39, v37, s63
    v_perm_b32 v86, v42, v40, s62
    v_perm_b32 v94, v42, v40, s63
    v_perm_b32 v102, v43, v41, s62
    v_perm_b32 v110, v43, v41, s63
    v_perm_b32 v87, v46, v44, s62
    v_perm_b32 v95, v46, v44, s63
    v_perm_b32 v103, v47, v45, s62
    v_perm_b32 v111, v47, v45, s63
    ds_read_b64 v[16:17], v8 offset:128
    ds_read_b64 v[18:19], v8 offset:448
    ds_read_b64 v[20:21], v8 offset:2688
    ds_read_b64 v[22:23], v8 offset:3008
    ds_read_b64 v[24:25], v8 offset:768
    ds_read_b64 v[26:27], v8 offset:1088
    ds_read_b64 v[28:29], v8 offset:3328
    ds_read_b64 v[30:31], v8 offset:3648
    ds_read_b64 v[32:33], v8 offset:10368
    ds_read_b64 v[34:35], v8 offset:10688
    ds_read_b64 v[36:37], v8 offset:12928
    ds_read_b64 v[38:39], v8 offset:13248
    ds_read_b64 v[40:41], v8 offset:11008
    ds_read_b64 v[42:43], v8 offset:11328
    ds_read_b64 v[44:45], v8 offset:13568
    ds_read_b64 v[46:47], v8 offset:13888
    s_waitcnt lgkmcnt(0)
    v_perm_b32 v112, v18, v16, s62
    v_perm_b32 v120, v18, v16, s63
    v_perm_b32 v128, v19, v17, s62
    v_perm_b32 v136, v19, v17, s63
    v_perm_b32 v113, v22, v20, s62
    v_perm_b32 v121, v22, v20, s63
    v_perm_b32 v129, v23, v21, s62
    v_perm_b32 v137, v23, v21, s63
    v_perm_b32 v114, v26, v24, s62
    v_perm_b32 v122, v26, v24, s63
    v_perm_b32 v130, v27, v25, s62
    v_perm_b32 v138, v27, v25, s63
    v_perm_b32 v115, v30, v28, s62
    v_perm_b32 v123, v30, v28, s63
    v_perm_b32 v131, v31, v29, s62
    v_perm_b32 v139, v31, v29, s63
    v_perm_b32 v116, v34, v32, s62
    v_perm_b32 v124, v34, v32, s63
    v_perm_b32 v132, v35, v33, s62
    v_perm_b32 v140, v35, v33, s63
    v_perm_b32 v117, v38, v36, s62
    v_perm_b32 v125, v38, v36, s63
    v_perm_b32 v133, v39, v37, s62
    v_perm_b32 v141, v39, v37, s63
    v_perm_b32 v118, v42, v40, s62
    v_perm_b32 v126, v42, v40, s63
    v_perm_b32 v134, v43, v41, s62
    v_perm_b32 v142, v43, v41, s63
    v_perm_b32 v119, v46, v44, s62
    v_perm_b32 v127, v46, v44, s63
    v_perm_b32 v135, v47, v45, s62
    v_perm_b32 v143, v47, v45, s63
    ds_read_b32 v16, v9 offset:256
    ds_read_b32 v18, v9 offset:576
    ds_read_b32 v20, v9 offset:2816
    ds_read_b32 v22, v9 offset:3136
    ds_read_b32 v24, v9 offset:896
    ds_read_b32 v26, v9 offset:1216
    ds_read_b32 v28, v9 offset:3456
    ds_read_b32 v30, v9 offset:3776
    ds_read_b32 v32, v9 offset:10496
    ds_read_b32 v34, v9 offset:10816
    ds_read_b32 v36, v9 offset:13056
    ds_read_b32 v38, v9 offset:13376
    ds_read_b32 v40, v9 offset:11136
    ds_read_b32 v42, v9 offset:11456
    ds_read_b32 v44, v9 offset:13696
    ds_read_b32 v46, v9 offset:14016
    s_waitcnt lgkmcnt(0)
    v_perm_b32 v144, v18, v16, s62
    v_perm_b32 v152, v18, v16, s63
    v_perm_b32 v145, v22, v20, s62
    v_perm_b32 v153, v22, v20, s63
    v_perm_b32 v146, v26, v24, s62
    v_perm_b32 v154, v26, v24, s63
    v_perm_b32 v147, v30, v28, s62
    v_perm_b32 v155, v30, v28, s63
    v_perm_b32 v148, v34, v32, s62
    v_perm_b32 v156, v34, v32, s63
    v_perm_b32 v149, v38, v36, s62
    v_perm_b32 v157, v38, v36, s63
    v_perm_b32 v150, v42, v40, s62
    v_perm_b32 v158, v42, v40, s63
    v_perm_b32 v151, v46, v44, s62
    v_perm_b32 v159, v46, v44, s63
    s_mov_b32 s48, s16
    s_mov_b32 s49, s17
    s_mov_b32 s50, 2211840
    s_mov_b32 s51, 0x20000
    s_lshl_b32 s98, s35, 7
    s_mov_b32 s99, 3456
    v_lshrrev_b32 v9, 3, v0
    v_mul_lo_u32 v10, v9, s99
    v_and_b32 v9, 2, v9
    v_xor_b32 v9, v9, v0
    v_and_b32 v9, 7, v9
    v_lshl_add_u32 v10, v9, 4, v10
    v_add_u32 v10, s98, v10
    v_xor_b32 v11, 64, v10
    s_mul_i32 s63, s3, 552960
    s_mov_b32 m0, s101
    s_waitcnt lgkmcnt(0)
    s_cmp_ge_u32 s35, 22
    s_cselect_b32 s100, 2, 1
    s_mov_b32 s62, 10
L_dma_6:
    buffer_load_dwordx4 v10, s[48:51], s63 offen nt lds
    s_add_u32 m0, m0, 1024
    s_add_u32 s63, s63, 27648
    s_cmp_eq_u32 s100, 0
    s_cbranch_scc1 L_dma_6n0
    s_waitcnt vmcnt(7)
    s_cmp_eq_u32 s100, 2
    s_cbranch_scc1 L_dma_6n0
    s_waitcnt vmcnt(7)
L_dma_6n0:
    buffer_load_dwordx4 v11, s[48:51], s63 offen nt lds
    s_add_u32 m0, m0, 1024
    s_add_u32 s63, s63, 27648
    s_cmp_eq_u32 s100, 0
    s_cbranch_scc1 L_dma_6n1
    s_waitcnt vmcnt(7)
    s_cmp_eq_u32 s100, 2
    s_cbranch_scc1 L_dma_6n1
    s_waitcnt vmcnt(7)
L_dma_6n1:
    s_sub_u32 s62, s62, 1
    s_cmp_lg_u32 s62, 0
    s_cbranch_scc1 L_dma_6
    v_mov_b32 v8, 162068
L_lw_7:
    ds_read_b32 v9, v8
    s_waitcnt lgkmcnt(0)
    v_cmp_gt_u32 vcc, 1, v9
    s_cbranch_vccz L_lw_7e
    s_sleep 8
    s_sub_u32 s60, s60, 1
    s_cbranch_scc0 L_lw_7
    s_mov_b32 s60, 0
L_lw_7e:
    s_cmp_lg_u32 s3, 3
    s_cbranch_scc1 L_h_nomo
    v_and_b32 v4, 15, v0
    v_lshlrev_b32 v4, 4, v4
    v_mul_u32_u24 v5, 1280, v3
    v_add_u32 v5, v5, v4
    v_mul_u32_u24 v6, 1296, v3
    v_add_u32 v6, v6, v4
    v_add_u32 v6, 147456, v6
    s_mov_b32 s62, 30720
    s_mov_b32 s63, 25600
    s_branch L_poll_8
L_poll_8s:
    s_sleep 8
L_poll_8:
    buffer_load_dwordx4 v[40:43], v5, s[40:43], s62 offen offset:0 sc1
    buffer_load_dwordx4 v[44:47], v5, s[40:43], s62 offen offset:256 sc1
    buffer_load_dwordx4 v[48:51], v5, s[40:43], s62 offen offset:512 sc1
    buffer_load_dwordx4 v[52:55], v5, s[40:43], s62 offen offset:768 sc1
    buffer_load_dwordx4 v[56:59], v5, s[40:43], s62 offen offset:1024 sc1
    buffer_load_dwordx4 v[60:63], v5, s[40:43], s63 offen offset:0 sc1
    buffer_load_dwordx4 v[64:67], v5, s[40:43], s63 offen offset:256 sc1
    buffer_load_dwordx4 v[68:71], v5, s[40:43], s63 offen offset:512 sc1
    buffer_load_dwordx4 v[72:75], v5, s[40:43], s63 offen offset:768 sc1
    buffer_load_dwordx4 v[76:79], v5, s[40:43], s63 offen offset:1024 sc1
    s_sub_u32 s60, s60, 1
    s_cbranch_scc1 L_poll_8t
    s_waitcnt vmcnt(0)
    v_max3_u32 v7, v40, v41, v42
    v_max3_u32 v7, v7, v43, v44
    v_max3_u32 v7, v7, v45, v46
    v_max3_u32 v7, v7, v47, v48
    v_max3_u32 v7, v7, v49, v50
    v_max3_u32 v7, v7, v51, v52
    v_max3_u32 v7, v7, v53, v54
    v_max3_u32 v7, v7, v55, v56
    v_max3_u32 v7, v7, v57, v58
    v_max3_u32 v7, v7, v59, v60
    v_max3_u32 v7, v7, v61, v62
    v_max3_u32 v7, v7, v63, v64
    v_max3_u32 v7, v7, v65, v66
    v_max3_u32 v7, v7, v67, v68
    v_max3_u32 v7, v7, v69, v70
    v_max3_u32 v7, v7, v71, v72
    v_max3_u32 v7, v7, v73, v74
    v_max3_u32 v7, v7, v75, v76
    v_max3_u32 v7, v7, v77, v78
    v_max_u32 v7, v7, v79
    v_cmp_eq_u32 vcc, -1, v7
    s_cbranch_vccnz L_poll_8s
L_poll_8e:
    ds_write_b128 v6, v[40:43] offset:0
    ds_write_b128 v6, v[44:47] offset:256
    ds_write_b128 v6, v[48:51] offset:512
    ds_write_b128 v6, v[52:55] offset:768
    ds_write_b128 v6, v[56:59] offset:1024
    ds_write_b128 v6, v[60:63] offset:5184
    ds_write_b128 v6, v[64:67] offset:5440
    ds_write_b128 v6, v[68:71] offset:5696
    ds_write_b128 v6, v[72:75] offset:5952
    ds_write_b128 v6, v[76:79] offset:6208
L_h_nomo:
    v_mul_u32_u24 v4, 144, v1
    v_lshl_add_u32 v4, v3, 5, v4
    v_bfe_u32 v5, v0, 1, 1
    v_lshl_add_u32 v4, v5, 4, v4
    v_add_u32 v4, 90688, v4
    v_mov_b32 v5, 162112
    v_and_b32 v6, 1, v0
    v_cmp_eq_u32 vcc, 0, v6
    s_nop 1
    v_cndmask_b32 v161, v5, v4, vcc
    v_cndmask_b32 v162, v4, v5, vcc
    v_bfe_u32 v164, v0, 1, 1
    v_mul_u32_u24 v164, 0xaaaa, v164
    v_add_u32 v164, 0x4444, v164
    s_mov_b32 s100, s3
    s_lshl_b32 s63, s100, 8
    v_and_b32 v8, 15, v0
    v_lshl_add_u32 v8, v8, 4, s63
    v_lshrrev_b32 v9, 4, v0
    v_mul_u32_u24 v5, 1280, v9
    v_add_u32 v5, v5, v8
    v_mul_u32_u24 v4, 1296, v9
    v_add_u32 v4, v4, v8
    v_add_u32 v4, 82944, v4
    v_lshlrev_b32 v6, 1, v5
    v_add_u32 v6, 99328, v6
    s_lshl_b32 s62, s100, 9
    s_add_u32 s62, s62, 88128
    v_lshl_add_u32 v7, v0, 3, s62
    s_mov_b32 s48, s4
    s_mov_b32 s49, s5
    s_mov_b32 s50, 5120
    s_mov_b32 s51, 0x20000
    buffer_load_dwordx4 v[8:11], v5, s[48:51], 0 offen
    s_mov_b32 s62, 20480
    s_mov_b32 s63, 30720
    s_branch L_poll_9
L_poll_9s:
    s_sleep 8
L_poll_9:
    buffer_load_dwordx4 v[12:15], v5, s[40:43], s62 offen sc1
    buffer_load_dwordx4 v[16:19], v5, s[40:43], s63 offen sc1
    s_sub_u32 s60, s60, 1
    s_cbranch_scc1 L_poll_9t
    s_waitcnt vmcnt(0)
    v_max3_u32 v38, v12, v13, v14
    v_max3_u32 v38, v38, v15, v16
    v_max3_u32 v38, v38, v17, v18
    v_max_u32 v38, v38, v19
    v_cmp_eq_u32 vcc, -1, v38
    s_cbranch_vccnz L_poll_9s
L_poll_9e:
    v_lshlrev_b32 v40, 16, v8
    v_and_b32 v41, 0xffff0000, v8
    v_lshlrev_b32 v42, 16, v9
    v_and_b32 v43, 0xffff0000, v9
    v_lshlrev_b32 v44, 16, v10
    v_and_b32 v45, 0xffff0000, v10
    v_lshlrev_b32 v46, 16, v11
    v_and_b32 v47, 0xffff0000, v11
    v_lshlrev_b32 v48, 16, v12
    v_and_b32 v49, 0xffff0000, v12
    v_lshlrev_b32 v50, 16, v13
    v_and_b32 v51, 0xffff0000, v13
    v_lshlrev_b32 v52, 16, v14
    v_and_b32 v53, 0xffff0000, v14
    v_lshlrev_b32 v54, 16, v15
    v_and_b32 v55, 0xffff0000, v15
    v_lshlrev_b32 v56, 16, v16
    v_and_b32 v57, 0xffff0000, v16
    v_lshlrev_b32 v58, 16, v17
    v_and_b32 v59, 0xffff0000, v17
    v_lshlrev_b32 v60, 16, v18
    v_and_b32 v61, 0xffff0000, v18
    v_lshlrev_b32 v62, 16, v19
    v_and_b32 v63, 0xffff0000, v19
    v_mov_b32 v64, 0
    v_mov_b32 v65, 0
    v_mov_b32 v66, 0
    v_mov_b32 v67, 0
    v_mov_b32 v68, 0
    v_mov_b32 v69, 0
    v_mov_b32 v70, 0
    v_mov_b32 v71, 0
    v_bfe_u32 v5, v0, 2, 2
    v_lshlrev_b32 v5, 8, v5
    v_lshrrev_b32 v8, 4, v0
    v_lshl_add_u32 v5, v8, 6, v5
    v_and_b32 v8, 3, v0
    v_lshl_add_u32 v5, v8, 4, v5
    s_lshl_b32 s56, s100, 10
    s_waitcnt vmcnt(0) lgkmcnt(0)
    v_mov_b32 v8, 162064
    v_mov_b32 v9, 1
    s_mov_b64 exec, 1
    ds_add_u32 v8, v9
    s_mov_b64 exec, -1
    s_branch L_t2gate
L_ffn2:
    s_barrier
L_ffn2b:
    ds_read_b128 v[8:11], v161
    ds_read_b128 v[12:15], v162
    s_cmp_eq_u32 s61, 1
    s_cbranch_scc0 L_f2slow
    s_waitcnt lgkmcnt(1)
    v_smfmac_f32_16x16x64_bf16 v[16:19], v[8:11], v[80:87], v164
    v_smfmac_f32_16x16x64_bf16 v[20:23], v[8:11], v[96:103], v164
    s_waitcnt lgkmcnt(0)
    v_smfmac_f32_16x16x64_bf16 v[16:19], v[12:15], v[88:95], v164
    v_smfmac_f32_16x16x64_bf16 v[20:23], v[12:15], v[104:111], v164
    v_smfmac_f32_16x16x64_bf16 v[24:27], v[8:11], v[112:119], v164
    v_smfmac_f32_16x16x64_bf16 v[28:31], v[8:11], v[128:135], v164
    v_smfmac_f32_16x16x64_bf16 v[24:27], v[12:15], v[120:127], v164
    v_smfmac_f32_16x16x64_bf16 v[28:31], v[12:15], v[136:143], v164
    v_smfmac_f32_16x16x64_bf16 v[32:35], v[8:11], v[144:151], v164
    v_smfmac_f32_16x16x64_bf16 v[32:35], v[12:15], v[152:159], v164
    s_nop 0
    v_pk_add_f32 v[16:17], v[16:17], v[18:19]
    v_cvt_pk_bf16_f32 v40, v16, v17
    v_pk_add_f32 v[20:21], v[20:21], v[22:23]
    v_cvt_pk_bf16_f32 v41, v20, v21
    buffer_store_dwordx2 v[40:41], v160, s[40:43], s57 offen
    v_pk_add_f32 v[24:25], v[24:25], v[26:27]
    v_cvt_pk_bf16_f32 v42, v24, v25
    v_pk_add_f32 v[28:29], v[28:29], v[30:31]
    v_cvt_pk_bf16_f32 v43, v28, v29
    buffer_store_dwordx2 v[42:43], v160, s[40:43], s57 offen offset:128
    v_pk_add_f32 v[32:33], v[32:33], v[34:35]
    v_cvt_pk_bf16_f32 v44, v32, v33
    buffer_store_dword v44, v163, s[40:43], s57 offen offset:256
L_f2done:
    s_barrier
    s_endpgm
L_f2slow:
    s_waitcnt lgkmcnt(1)
    v_smfmac_f32_16x16x64_bf16 v[16:19], v[8:11], v[80:87], v164
    v_smfmac_f32_16x16x64_bf16 v[20:23], v[8:11], v[96:103], v164
    s_waitcnt lgkmcnt(0)
    v_smfmac_f32_16x16x64_bf16 v[16:19], v[12:15], v[88:95], v164
    v_smfmac_f32_16x16x64_bf16 v[20:23], v[12:15], v[104:111], v164
    v_smfmac_f32_16x16x64_bf16 v[24:27], v[8:11], v[112:119], v164
    v_smfmac_f32_16x16x64_bf16 v[28:31], v[8:11], v[128:135], v164
    v_smfmac_f32_16x16x64_bf16 v[24:27], v[12:15], v[120:127], v164
    v_smfmac_f32_16x16x64_bf16 v[28:31], v[12:15], v[136:143], v164
    v_smfmac_f32_16x16x64_bf16 v[32:35], v[8:11], v[144:151], v164
    v_smfmac_f32_16x16x64_bf16 v[32:35], v[12:15], v[152:159], v164
    s_nop 0
    v_pk_add_f32 v[16:17], v[16:17], v[18:19]
    v_cvt_pk_bf16_f32 v40, v16, v17
    v_pk_add_f32 v[20:21], v[20:21], v[22:23]
    v_cvt_pk_bf16_f32 v41, v20, v21
    buffer_store_dwordx2 v[40:41], v160, s[40:43], s57 offen sc1
    v_pk_add_f32 v[24:25], v[24:25], v[26:27]
    v_cvt_pk_bf16_f32 v42, v24, v25
    v_pk_add_f32 v[28:29], v[28:29], v[30:31]
    v_cvt_pk_bf16_f32 v43, v28, v29
    buffer_store_dwordx2 v[42:43], v160, s[40:43], s57 offen offset:128 sc1
    v_pk_add_f32 v[32:33], v[32:33], v[34:35]
    v_cvt_pk_bf16_f32 v44, v32, v33
    buffer_store_dword v44, v163, s[40:43], s57 offen offset:256 sc1
    s_branch L_f2done
L_poll_3t:
    s_mov_b32 s60, 0
    s_waitcnt vmcnt(0)
    s_branch L_poll_3e
L_poll_8t:
    s_mov_b32 s60, 0
    s_waitcnt vmcnt(0)
    s_branch L_poll_8e
L_poll_9t:
    s_mov_b32 s60, 0
    s_waitcnt vmcnt(0)
    s_branch L_poll_9e
L_poll_101t:
    s_mov_b32 s60, 0
    s_waitcnt vmcnt(0)
    s_branch L_poll_101e
L_pfast:
    buffer_store_dword v12, v108, s[40:43], s101 offen
    buffer_store_dword v12, v110, s[40:43], s101 offen
    s_branch L_pdone
L_poll_103t:
    s_mov_b32 s60, 0
    s_waitcnt vmcnt(0)
    s_branch L_poll_103e
L_poll_105t:
    s_mov_b32 s60, 0
    s_waitcnt vmcnt(0)
    s_branch L_poll_105e
L_poll_108t:
    s_mov_b32 s60, 0
    s_waitcnt vmcnt(0)
    s_branch L_poll_108e
L_poll_110t:
    s_mov_b32 s60, 0
    s_waitcnt vmcnt(0)
    s_branch L_poll_110e
L_poll_114t:
    s_mov_b32 s60, 0
    s_waitcnt vmcnt(0)
    s_branch L_poll_114e
L_poll_116t:
    s_mov_b32 s60, 0
    s_waitcnt vmcnt(0)
    s_branch L_poll_116e
L_ycs:
    buffer_store_dwordx4 v[24:27], v22, s[40:43], 0 offen offset:0 sc1
    buffer_store_dwordx4 v[24:27], v22, s[40:43], 0 offen offset:1024 sc1
    buffer_store_dwordx4 v[24:27], v22, s[40:43], 0 offen offset:2048 sc1
    buffer_store_dwordx4 v[24:27], v22, s[40:43], 0 offen offset:3072 sc1
    buffer_store_dwordx4 v[24:27], v23, s[40:43], 0 offen offset:0 sc1
    s_branch L_ycd
L_poll_117t:
    s_mov_b32 s60, 0
    s_waitcnt vmcnt(0)
    s_branch L_poll_117e
L_poll_122t:
    s_mov_b32 s60, 0
    s_waitcnt vmcnt(0)
    s_branch L_poll_122e
L_poll_124t:
    s_mov_b32 s60, 0
    s_waitcnt vmcnt(0)
    s_branch L_poll_124e
L_ygt:
    s_waitcnt vmcnt(0)
    s_branch L_ygd
L_pto:
    s_mov_b32 s60, 0
    s_waitcnt vmcnt(0)
    s_branch L_pgot0
L_poll_128t:
    s_mov_b32 s60, 0
    s_waitcnt vmcnt(0)
    s_branch L_poll_128e
L_end:
    s_endpgm
L_codeend:
.section .rodata,"a"
.p2align 6
.amdhsa_kernel adaLN_cond__sliding_block_cached__dense_activation_gelu__decode_kernel
  .amdhsa_next_free_vgpr 168
  .amdhsa_next_free_sgpr 102
  .amdhsa_accum_offset 168
  .amdhsa_group_segment_fixed_size 0
  .amdhsa_kernarg_size 120
  .amdhsa_user_sgpr_count 2
  .amdhsa_user_sgpr_kernarg_segment_ptr 1
  .amdhsa_system_sgpr_workgroup_id_x 1
.end_amdhsa_kernel
```

```asm
; @launch grid=(256,1,1) block=(768,1,1) lds=162176
.amdgcn_target "amdgcn-amd-amdhsa--gfx950"
.text
.globl adaLN_cond__sliding_block_cached__dense_activation_gelu__decode_kernel
.p2align 8
.type adaLN_cond__sliding_block_cached__dense_activation_gelu__decode_kernel,@function
adaLN_cond__sliding_block_cached__dense_activation_gelu__decode_kernel:
    s_load_dwordx16 s[4:19], s[0:1], 0
    s_load_dwordx8 s[20:27], s[0:1], 64
    s_load_dwordx4 s[28:31], s[0:1], 96
    s_load_dwordx2 s[32:33], s[0:1], 112
    s_cmp_ge_u32 s2, 256
    s_cbranch_scc1 L_end
    v_lshrrev_b32 v1, 6, v0
    v_mul_u32_u24 v2, 36, v0
    v_readfirstlane_b32 s3, v1
    v_and_b32 v0, 63, v0
    s_and_b32 s34, s2, 7
    s_lshr_b32 s35, s2, 3
    s_cmp_lg_u32 s35, 21
    s_cbranch_scc1 L_nopf
    s_getpc_b64 s[48:49]
L_pc:
    v_min_u32 v2, L_codeend-L_pc-4, v2
    v_mov_b32 v3, s49
    v_add_co_u32 v2, vcc, s48, v2
    s_nop 1
    v_addc_co_u32 v3, vcc, 0, v3, vcc
    global_load_dword v152, v[2:3], off
L_nopf:
    s_lshr_b32 s36, s35, 3
    s_lshl2_add_u32 s36, s34, s36
    s_bfe_u32 s37, s35, 0x20001
    s_and_b32 s38, s35, 1
    s_cmp_lt_u32 s35, 27
    s_cselect_b32 s39, 1, 0
    s_cmp_eq_u32 s34, 2
    s_cselect_b32 s39, s39, 0
    s_sub_u32 s62, s34, 3
    s_and_b32 s62, s62, 7
    s_mul_i32 s56, s35, 7
    s_add_u32 s56, s56, s62
    s_cmp_eq_u32 s62, 7
    s_cselect_b32 s56, 255, s56
    s_mov_b32 s60, 1000000
    s_mov_b32 s61, 0
    v_mov_b32 v36, 0
    s_cmp_lt_u32 s3, 4
    s_cbranch_scc1 L_helpers
    s_sub_u32 s3, s3, 4
    s_cmp_ge_u32 s35, 22
    s_cselect_b32 s59, 1, 0
    s_add_u32 s62, s3, s59
    s_cmp_ge_u32 s62, 6
    s_cselect_b32 s62, s39, 0
    s_cmp_eq_u32 s62, 1
    s_cbranch_scc1 L_proxy
    s_cmp_eq_u32 s59, 1
    s_cselect_b32 s100, 0, 81920
    s_lshl_b32 s62, s3, 13
    s_add_u32 s100, s100, s62
    s_and_b32 s62, s39, s59
    s_cselect_b32 s100, -1, s100
    s_mov_b32 s101, 0
L_stream:
    s_lshl_b32 s62, s37, 5
    s_add_u32 s62, s62, s36
    s_lshl_b32 s63, s62, 21
    s_lshl_b32 s96, s38, 18
    s_add_u32 s63, s63, s96
    s_add_u32 s63, s63, 1572864
    v_lshlrev_b32 v1, 4, v0
    s_lshl_b32 s96, s3, 12
    v_add_u32 v1, s96, v1
    s_mov_b32 s97, 0
    s_mov_b32 s50, 262144
    s_mov_b32 s51, 0x20000
    s_waitcnt lgkmcnt(0)
    s_add_u32 s48, s6, s63
    s_addc_u32 s49, s7, 0
    s_cmp_lt_u32 s56, 40
    s_cbranch_scc0 L_nob0
    s_barrier
L_nob0:
    buffer_load_dwordx4 v[40:43], v1, s[48:51], s97 offen offset:0 nt
    buffer_load_dwordx4 v[44:47], v1, s[48:51], s97 offen offset:1024 nt
    s_cmp_lt_u32 s56, 40
    s_cbranch_scc1 L_stream2
    s_barrier
    s_branch L_stream2
L_helpers:
    s_cmp_lg_u32 s3, 0
    s_cbranch_scc1 L_noinit
    v_lshlrev_b32 v1, 2, v0
    v_add_u32 v1, 161920, v1
    ds_write_b32 v1, v36
L_noinit:
    s_waitcnt lgkmcnt(0)
    s_mov_b32 s40, s32
    s_mov_b32 s41, s33
    s_mov_b32 s42, 589824
    s_mov_b32 s43, 0x20000
    s_mov_b32 s44, s30
    s_mov_b32 s45, s31
    s_mov_b32 s46, 256
    s_mov_b32 s47, 0x20000
    s_lshl2_add_u32 s62, s35, s3
    s_cmp_eq_u32 s62, 87
    s_cbranch_scc1 L_touch
L_notp:
    s_mul_i32 s101, s3, 20480
    s_mov_b32 s96, s56
    s_cmp_lt_u32 s56, 40
    s_cbranch_scc0 L_nothalf
    s_cmp_lt_u32 s3, 2
    s_cbranch_scc1 L_unit
    s_add_u32 s62, s56, 20
    s_cmp_eq_u32 s3, 2
    s_cbranch_scc1 L_job
    s_barrier
    s_branch L_service
L_nothalf:
    s_cmp_lt_u32 s56, 144
    s_cbranch_scc1 L_unit
    s_sub_u32 s62, s56, 144
    s_cmp_lt_u32 s62, 10
    s_cbranch_scc0 L_nojob
    s_cmp_lt_u32 s3, 2
    s_cbranch_scc0 L_nojob
    s_mul_i32 s63, s3, 10
    s_add_u32 s62, s62, s63
L_job:
    s_cmp_lt_u32 s62, 59
    s_cbranch_scc0 L_end
    s_mov_b32 s100, s101
    s_lshl_b32 s101, s62, 9
    s_add_u32 s101, s101, 172032
    s_cmp_lt_u32 s62, 27
    s_cselect_b32 s63, 0, 27
    s_cselect_b32 s3, 7, 6
    s_cmp_lt_u32 s62, 54
    s_cselect_b32 s63, s63, 32
    s_cselect_b32 s3, s3, 5
    s_sub_u32 s35, s62, s63
    s_mov_b32 s34, 2
    s_lshr_b32 s36, s35, 3
    s_add_u32 s36, s36, 8
    s_bfe_u32 s37, s35, 0x20001
    s_and_b32 s38, s35, 1
    s_mov_b32 s59, 0
    s_branch L_stream
L_nojob:
    s_barrier
    s_cmp_ge_u32 s35, 22
    s_cbranch_scc1 L_h_t1
    s_cmp_eq_u32 s39, 1
    s_cbranch_scc1 L_h_role
    s_cmp_lt_u32 s96, 144
    s_cbranch_scc1 L_unit
    s_cmp_eq_u32 s3, 3
    s_cbranch_scc1 L_service
    s_endpgm
L_unit:
    v_lshrrev_b32 v3, 4, v0
    v_and_b32 v4, 3, v0
    v_bfe_u32 v7, v0, 2, 2
    s_mov_b32 s14, s3
    s_mov_b32 s15, 3
    s_sub_u32 s62, s96, 40
    s_cmp_lt_u32 s62, 64
    s_cbranch_scc1 L_u_q
    s_mov_b32 s100, 1
    s_sub_u32 s96, s96, 84
    s_cmp_lt_u32 s56, 40
    s_cbranch_scc0 L_u_full
    s_mov_b32 s100, 0
    s_lshr_b32 s96, s56, 1
    s_and_b32 s62, s56, 1
    s_lshl1_add_u32 s14, s62, s14
    s_mov_b32 s15, 1
L_u_full:
    s_mov_b32 s97, 0
    s_mov_b32 s99, 7680
    s_mov_b32 s48, s26
    s_mov_b32 s49, s27
    s_mov_b32 s50, 4915200
    s_mov_b32 s51, 0x20000
    s_mov_b32 s52, s24
    s_mov_b32 s53, s25
    s_mov_b32 s54, 5120
    s_mov_b32 s55, 0x20000
    v_and_b32 v6, 15, v0
    v_lshlrev_b32 v6, 4, v6
    v_mul_u32_u24 v5, 1280, v3
    v_add_u32 v5, v5, v6
    s_mul_i32 s62, s14, 320
    buffer_load_dwordx4 v[8:11], v5, s[52:55], s62 offen
    s_mov_b32 exec_lo, 0x000f000f
    s_mov_b32 exec_hi, 0x000f000f
    buffer_load_dwordx4 v[12:15], v5, s[52:55], s62 offen offset:256
    s_mov_b64 exec, -1
    s_lshl_b32 s98, s96, 7
    s_mul_i32 s13, s96, 0x199a
    s_lshr_b32 s13, s13, 16
    s_cmp_lg_u32 s13, 1
    s_cbranch_scc1 L_u_go
    s_mov_b32 s52, s4
    s_mov_b32 s53, s5
    s_mov_b32 s54, 5120
    s_mov_b32 s55, 0x20000
    v_mul_u32_u24 v5, 1280, v4
    v_lshlrev_b32 v64, 5, v7
    v_lshl_add_u32 v64, v3, 3, v64
    v_add_u32 v64, v64, v5
    v_lshrrev_b32 v6, 2, v0
    v_lshl_add_u32 v6, v6, 4, v5
    s_sub_u32 s62, s98, 1280
    buffer_load_dwordx4 v[16:19], v6, s[52:55], 0 offen offset:0
    buffer_load_dwordx4 v[20:23], v6, s[52:55], 0 offen offset:256
    buffer_load_dwordx4 v[24:27], v6, s[52:55], 0 offen offset:512
    buffer_load_dwordx4 v[28:31], v6, s[52:55], 0 offen offset:768
    buffer_load_dwordx4 v[32:35], v6, s[52:55], 0 offen offset:1024
    buffer_load_dwordx2 v[66:67], v64, s[52:55], s62 offen
    s_branch L_u_go
L_u_q:
    s_mov_b32 s97, 1
    s_mov_b32 s99, 8192
    s_mov_b32 s100, 2
    s_lshl_b32 s98, s62, 7
    s_mov_b32 s48, s10
    s_mov_b32 s49, s11
    s_mov_b32 s50, 5242880
    s_mov_b32 s51, 0x20000
L_u_go:
    v_lshrrev_b32 v6, 3, v0
    v_mul_lo_u32 v1, v6, s99
    v_and_b32 v6, 2, v6
    v_xor_b32 v6, v6, v0
    v_and_b32 v6, 7, v6
    v_lshl_add_u32 v1, v6, 4, v1
    v_add_u32 v1, s98, v1
    v_xor_b32 v2, 64, v1
    s_mul_i32 s63, s99, s14
    s_mul_i32 s63, s63, 160
    s_lshl_b32 s59, s99, 3
    s_mov_b32 m0, s101
    s_mov_b32 s62, 10
L_dma_1:
    buffer_load_dwordx4 v1, s[48:51], s63 offen nt lds
    s_add_u32 m0, m0, 1024
    s_add_u32 s63, s63, s59
    s_cmp_eq_u32 s100, 0
    s_cbranch_scc1 L_dma_1n0
    s_waitcnt vmcnt(5)
    s_cmp_eq_u32 s100, 2
    s_cbranch_scc1 L_dma_1n0
    s_waitcnt vmcnt(5)
L_dma_1n0:
    buffer_load_dwordx4 v2, s[48:51], s63 offen nt lds
    s_add_u32 m0, m0, 1024
    s_add_u32 s63, s63, s59
    s_cmp_eq_u32 s100, 0
    s_cbranch_scc1 L_dma_1n1
    s_waitcnt vmcnt(5)
    s_cmp_eq_u32 s100, 2
    s_cbranch_scc1 L_dma_1n1
    s_waitcnt vmcnt(5)
L_dma_1n1:
    s_sub_u32 s62, s62, 1
    s_cmp_lg_u32 s62, 0
    s_cbranch_scc1 L_dma_1
    v_min_u32 v65, 15, v0
    v_and_b32 v6, 1, v65
    v_mul_u32_u24 v6, 126, v6
    v_lshl_add_u32 v65, v65, 1, v6
    v_mov_b32 v68, 0
    s_cmp_lt_u32 s56, 40
    s_cbranch_scc1 L_u_nofl
    buffer_load_dword v68, v65, s[44:47], 0 offen sc1
L_u_nofl:
    s_cmp_lt_u32 s56, 144
    s_cbranch_scc0 L_u_nob
    s_barrier
L_u_nob:
    v_lshrrev_b32 v60, 4, v0
    v_lshlrev_b32 v60, 10, v60
    v_bfe_u32 v6, v0, 2, 2
    v_lshl_add_u32 v60, v6, 7, v60
    v_and_b32 v6, 3, v0
    v_lshl_add_u32 v60, v6, 3, v60
    v_bfe_u32 v6, v0, 3, 2
    v_lshl_add_u32 v60, v6, 5, v60
    v_xor_b32 v61, 32, v60
    v_xor_b32 v62, 64, v60
    v_xor_b32 v63, 0x60, v60
    v_add_u32 v60, s101, v60
    v_add_u32 v61, s101, v61
    v_add_u32 v62, s101, v62
    v_add_u32 v63, s101, v63
    v_mov_b32 v56, 1.0
    v_mov_b32 v57, 1.0
    v_mov_b32 v58, 1.0
    v_mov_b32 v59, 1.0
    s_mov_b32 s58, 0
    v_lshl_add_u32 v69, v7, 2, v3
    v_lshl_add_u32 v69, v4, 4, v69
    v_and_b32 v64, 15, v0
    v_lshlrev_b32 v64, 3, v64
    s_cmp_eq_u32 s97, 1
    s_cbranch_scc1 L_u_q2
    v_mul_u32_u24 v6, 1280, v3
    v_add_u32 v64, v64, v6
    s_mul_i32 s63, s13, 3840
    s_add_u32 s57, s98, s63
    s_add_u32 s57, s57, 10240
    s_cmp_lt_u32 s56, 40
    s_cbranch_scc0 L_u_nat
    v_lshrrev_b32 v69, 1, v3
    v_lshlrev_b32 v69, 3, v69
    v_lshl_add_u32 v69, v7, 4, v69
    v_lshl_add_u32 v69, v4, 1, v69
    v_and_b32 v6, 1, v3
    v_add_u32 v69, v69, v6
    s_lshr_b32 s62, s56, 1
    s_lshl_b32 s57, s62, 11
    s_cmp_ge_u32 s62, 10
    s_cselect_b32 s62, -19968, 0
    s_add_u32 s57, s57, s62
    s_and_b32 s62, s56, 1
    s_lshl_b32 s62, s62, 8
    s_add_u32 s57, s57, s62
    v_lshrrev_b32 v64, 5, v0
    v_lshlrev_b32 v64, 10, v64
    v_and_b32 v6, 31, v0
    v_lshl_add_u32 v64, v6, 3, v64
L_u_nat:
    s_cmp_eq_u32 s13, 4
    s_cselect_b32 s58, 1.0, 0
    s_cmp_eq_u32 s13, 1
    s_cselect_b32 s58, 1.0, s58
    s_cselect_b32 s56, 1, 0
    s_cmp_eq_u32 s14, 0
    s_cselect_b32 s58, s58, 0
    s_waitcnt vmcnt(20)
    s_mov_b32 s62, 0xbfb8aa3b
    v_lshlrev_b32 v40, 16, v8
    v_and_b32 v41, 0xffff0000, v8
    v_lshlrev_b32 v42, 16, v9
    v_and_b32 v43, 0xffff0000, v9
    v_lshlrev_b32 v44, 16, v10
    v_and_b32 v45, 0xffff0000, v10
    v_lshlrev_b32 v46, 16, v11
    v_and_b32 v47, 0xffff0000, v11
    v_mul_f32 v48, s62, v40
    v_mul_f32 v49, s62, v41
    v_mul_f32 v50, s62, v42
    v_mul_f32 v51, s62, v43
    v_mul_f32 v52, s62, v44
    v_mul_f32 v53, s62, v45
    v_mul_f32 v54, s62, v46
    v_mul_f32 v55, s62, v47
    v_exp_f32 v48, v48
    v_exp_f32 v49, v49
    v_exp_f32 v50, v50
    v_exp_f32 v51, v51
    v_exp_f32 v52, v52
    v_exp_f32 v53, v53
    v_exp_f32 v54, v54
    v_exp_f32 v55, v55
    v_add_f32 v48, 1.0, v48
    v_add_f32 v49, 1.0, v49
    v_add_f32 v50, 1.0, v50
    v_add_f32 v51, 1.0, v51
    v_add_f32 v52, 1.0, v52
    v_add_f32 v53, 1.0, v53
    v_add_f32 v54, 1.0, v54
    v_add_f32 v55, 1.0, v55
    v_rcp_f32 v48, v48
    v_rcp_f32 v49, v49
    v_rcp_f32 v50, v50
    v_rcp_f32 v51, v51
    v_rcp_f32 v52, v52
    v_rcp_f32 v53, v53
    v_rcp_f32 v54, v54
    v_rcp_f32 v55, v55
    v_mul_f32 v40, v40, v48
    v_mul_f32 v41, v41, v49
    v_mul_f32 v42, v42, v50
    v_mul_f32 v43, v43, v51
    v_mul_f32 v44, v44, v52
    v_mul_f32 v45, v45, v53
    v_mul_f32 v46, v46, v54
    v_mul_f32 v47, v47, v55
    v_cvt_pk_bf16_f32 v8, v40, v41
    v_cvt_pk_bf16_f32 v9, v42, v43
    v_cvt_pk_bf16_f32 v10, v44, v45
    v_cvt_pk_bf16_f32 v11, v46, v47
    v_lshlrev_b32 v40, 16, v12
    v_and_b32 v41, 0xffff0000, v12
    v_lshlrev_b32 v42, 16, v13
    v_and_b32 v43, 0xffff0000, v13
    v_lshlrev_b32 v44, 16, v14
    v_and_b32 v45, 0xffff0000, v14
    v_lshlrev_b32 v46, 16, v15
    v_and_b32 v47, 0xffff0000, v15
    v_mul_f32 v48, s62, v40
    v_mul_f32 v49, s62, v41
    v_mul_f32 v50, s62, v42
    v_mul_f32 v51, s62, v43
    v_mul_f32 v52, s62, v44
    v_mul_f32 v53, s62, v45
    v_mul_f32 v54, s62, v46
    v_mul_f32 v55, s62, v47
    v_exp_f32 v48, v48
    v_exp_f32 v49, v49
    v_exp_f32 v50, v50
    v_exp_f32 v51, v51
    v_exp_f32 v52, v52
    v_exp_f32 v53, v53
    v_exp_f32 v54, v54
    v_exp_f32 v55, v55
    v_add_f32 v48, 1.0, v48
    v_add_f32 v49, 1.0, v49
    v_add_f32 v50, 1.0, v50
    v_add_f32 v51, 1.0, v51
    v_add_f32 v52, 1.0, v52
    v_add_f32 v53, 1.0, v53
    v_add_f32 v54, 1.0, v54
    v_add_f32 v55, 1.0, v55
    v_rcp_f32 v48, v48
    v_rcp_f32 v49, v49
    v_rcp_f32 v50, v50
    v_rcp_f32 v51, v51
    v_rcp_f32 v52, v52
    v_rcp_f32 v53, v53
    v_rcp_f32 v54, v54
    v_rcp_f32 v55, v55
    v_mul_f32 v40, v40, v48
    v_mul_f32 v41, v41, v49
    v_mul_f32 v42, v42, v50
    v_mul_f32 v43, v43, v51
    v_mul_f32 v44, v44, v52
    v_mul_f32 v45, v45, v53
    v_mul_f32 v46, v46, v54
    v_mul_f32 v47, v47, v55
    v_cvt_pk_bf16_f32 v12, v40, v41
    v_cvt_pk_bf16_f32 v13, v42, v43
    v_cvt_pk_bf16_f32 v14, v44, v45
    v_cvt_pk_bf16_f32 v15, v46, v47
    s_mul_i32 s62, s3, 1344
    s_add_u32 s62, s62, 151552
    v_mul_u32_u24 v5, 336, v3
    v_and_b32 v6, 15, v0
    v_lshl_add_u32 v5, v6, 4, v5
    v_add_u32 v5, s62, v5
    ds_write_b128 v5, v[8:11]
    s_mov_b32 exec_lo, 0x000f000f
    s_mov_b32 exec_hi, 0x000f000f
    ds_write_b128 v5, v[12:15] offset:256
    s_mov_b64 exec, -1
    v_mul_u32_u24 v5, 336, v4
    v_lshl_add_u32 v5, v3, 4, v5
    v_add_u32 v5, s62, v5
    s_mov_b32 s59, 0x3e800000
    s_cmp_eq_u32 s56, 0
    s_cbranch_scc1 L_u_nost
    v_mov_b32 v40, 0
    v_mov_b32 v41, 0
    s_mov_b32 s62, 0x3f803f80
    v_dot2c_f32_bf16 v40, s62, v16
    v_dot2c_f32_bf16 v41, v16, v16
    v_dot2c_f32_bf16 v40, s62, v17
    v_dot2c_f32_bf16 v41, v17, v17
    v_dot2c_f32_bf16 v40, s62, v18
    v_dot2c_f32_bf16 v41, v18, v18
    v_dot2c_f32_bf16 v40, s62, v19
    v_dot2c_f32_bf16 v41, v19, v19
    v_dot2c_f32_bf16 v40, s62, v20
    v_dot2c_f32_bf16 v41, v20, v20
    v_dot2c_f32_bf16 v40, s62, v21
    v_dot2c_f32_bf16 v41, v21, v21
    v_dot2c_f32_bf16 v40, s62, v22
    v_dot2c_f32_bf16 v41, v22, v22
    v_dot2c_f32_bf16 v40, s62, v23
    v_dot2c_f32_bf16 v41, v23, v23
    v_dot2c_f32_bf16 v40, s62, v24
    v_dot2c_f32_bf16 v41, v24, v24
    v_dot2c_f32_bf16 v40, s62, v25
    v_dot2c_f32_bf16 v41, v25, v25
    v_dot2c_f32_bf16 v40, s62, v26
    v_dot2c_f32_bf16 v41, v26, v26
    v_dot2c_f32_bf16 v40, s62, v27
    v_dot2c_f32_bf16 v41, v27, v27
    v_dot2c_f32_bf16 v40, s62, v28
    v_dot2c_f32_bf16 v41, v28, v28
    v_dot2c_f32_bf16 v40, s62, v29
    v_dot2c_f32_bf16 v41, v29, v29
    v_dot2c_f32_bf16 v40, s62, v30
    v_dot2c_f32_bf16 v41, v30, v30
    v_dot2c_f32_bf16 v40, s62, v31
    v_dot2c_f32_bf16 v41, v31, v31
    v_dot2c_f32_bf16 v40, s62, v32
    v_dot2c_f32_bf16 v41, v32, v32
    v_dot2c_f32_bf16 v40, s62, v33
    v_dot2c_f32_bf16 v41, v33, v33
    v_dot2c_f32_bf16 v40, s62, v34
    v_dot2c_f32_bf16 v41, v34, v34
    v_dot2c_f32_bf16 v40, s62, v35
    v_dot2c_f32_bf16 v41, v35, v35
    s_nop 1
    v_add_f32_dpp v40, v40, v40 row_ror:4 row_mask:0xf bank_mask:0xf
    v_add_f32_dpp v41, v41, v41 row_ror:4 row_mask:0xf bank_mask:0xf
    s_nop 0
    v_add_f32_dpp v40, v40, v40 row_ror:8 row_mask:0xf bank_mask:0xf
    v_add_f32_dpp v41, v41, v41 row_ror:8 row_mask:0xf bank_mask:0xf
    v_mov_b32 v42, v40
    v_mov_b32 v43, v41
    s_nop 0
    v_permlane16_swap_b32 v40, v42
    v_permlane16_swap_b32 v41, v43
    v_add_f32 v40, v40, v42
    v_add_f32 v41, v41, v43
    v_mov_b32 v42, v40
    v_mov_b32 v43, v41
    s_nop 0
    v_permlane32_swap_b32 v40, v42
    v_permlane32_swap_b32 v41, v43
    v_add_f32 v40, v40, v42
    v_add_f32 v41, v41, v43
    s_mov_b32 s62, 0x3acccccd
    v_mul_f32 v40, s62, v40
    v_mul_f32 v41, s62, v41
    v_fma_f32 v41, -v40, v40, v41
    v_max_f32 v41, 0, v41
    v_add_f32 v41, 0x3727c5ac, v41
    v_rsq_f32 v41, v41
    v_lshlrev_b32 v56, 16, v66
    v_and_b32 v57, 0xffff0000, v66
    v_lshlrev_b32 v58, 16, v67
    v_and_b32 v59, 0xffff0000, v67
    v_sub_f32 v56, v56, v40
    v_sub_f32 v57, v57, v40
    v_sub_f32 v58, v58, v40
    v_sub_f32 v59, v59, v40
    v_mul_f32 v56, v56, v41
    v_mul_f32 v57, v57, v41
    v_mul_f32 v58, v58, v41
    v_mul_f32 v59, v59, v41
L_u_nost:
    ds_read_b128 v[8:11], v5 offset:0
    ds_read_b128 v[12:15], v5 offset:64
    ds_read_b128 v[16:19], v5 offset:128
    ds_read_b128 v[20:23], v5 offset:192
    ds_read_b128 v[24:27], v5 offset:256
    s_branch L_u_frag
L_u_q2:
    v_lshl_add_u32 v64, v3, 13, v64
    s_add_u32 s57, s98, 40960
    v_lshlrev_b32 v5, 8, v7
    v_lshl_add_u32 v5, v3, 6, v5
    v_lshl_add_u32 v5, v4, 4, v5
    s_mul_i32 s63, s3, 5120
    s_add_u32 s63, s63, 0
    s_add_u32 s12, s63, 4096
    s_mov_b32 s59, 1.0
L_u_frag:
    s_waitcnt vmcnt(0)
    v_cmp_ne_u32 vcc, -1, v68
    s_cbranch_vccz L_u_yok
    s_cmp_eq_u32 s97, 1
    s_cbranch_scc1 L_u_ywait
    buffer_load_dword v68, v65, s[44:47], 0 offen sc1
    s_branch L_u_yok
L_u_ywait:
L_wy_2:
    buffer_load_dword v68, v65, s[44:47], 0 offen sc1
    s_waitcnt vmcnt(0)
    v_cmp_ne_u32 vcc, -1, v68
    s_cbranch_vccz L_wy_2e
    s_sleep 4
    s_sub_u32 s60, s60, 1
    s_cbranch_scc0 L_wy_2
    s_mov_b32 s60, 0
L_wy_2e:
L_u_yok:
    ds_read_b64_tr_b16 v[80:81], v60 offset:0
    ds_read_b64_tr_b16 v[82:83], v60 offset:512
    ds_read_b64_tr_b16 v[84:85], v61 offset:0
    ds_read_b64_tr_b16 v[86:87], v61 offset:512
    ds_read_b64_tr_b16 v[88:89], v62 offset:0
    ds_read_b64_tr_b16 v[90:91], v62 offset:512
    ds_read_b64_tr_b16 v[92:93], v63 offset:0
    ds_read_b64_tr_b16 v[94:95], v63 offset:512
    ds_read_b64_tr_b16 v[96:97], v60 offset:4096
    ds_read_b64_tr_b16 v[98:99], v60 offset:4608
    ds_read_b64_tr_b16 v[100:101], v61 offset:4096
    ds_read_b64_tr_b16 v[102:103], v61 offset:4608
    ds_read_b64_tr_b16 v[104:105], v62 offset:4096
    ds_read_b64_tr_b16 v[106:107], v62 offset:4608
    ds_read_b64_tr_b16 v[108:109], v63 offset:4096
    ds_read_b64_tr_b16 v[110:111], v63 offset:4608
    ds_read_b64_tr_b16 v[112:113], v60 offset:8192
    ds_read_b64_tr_b16 v[114:115], v60 offset:8704
    ds_read_b64_tr_b16 v[116:117], v61 offset:8192
    ds_read_b64_tr_b16 v[118:119], v61 offset:8704
    ds_read_b64_tr_b16 v[120:121], v62 offset:8192
    ds_read_b64_tr_b16 v[122:123], v62 offset:8704
    ds_read_b64_tr_b16 v[124:125], v63 offset:8192
    ds_read_b64_tr_b16 v[126:127], v63 offset:8704
    ds_read_b64_tr_b16 v[128:129], v60 offset:12288
    ds_read_b64_tr_b16 v[130:131], v60 offset:12800
    ds_read_b64_tr_b16 v[132:133], v61 offset:12288
    ds_read_b64_tr_b16 v[134:135], v61 offset:12800
    ds_read_b64_tr_b16 v[136:137], v62 offset:12288
    ds_read_b64_tr_b16 v[138:139], v62 offset:12800
    ds_read_b64_tr_b16 v[140:141], v63 offset:12288
    ds_read_b64_tr_b16 v[142:143], v63 offset:12800
    ds_read_b64_tr_b16 v[144:145], v60 offset:16384
    ds_read_b64_tr_b16 v[146:147], v60 offset:16896
    ds_read_b64_tr_b16 v[148:149], v61 offset:16384
    ds_read_b64_tr_b16 v[150:151], v61 offset:16896
    ds_read_b64_tr_b16 v[152:153], v62 offset:16384
    ds_read_b64_tr_b16 v[154:155], v62 offset:16896
    ds_read_b64_tr_b16 v[156:157], v63 offset:16384
    ds_read_b64_tr_b16 v[158:159], v63 offset:16896
    s_cmp_eq_u32 s97, 0
    s_cbranch_scc1 L_u_mm
    s_branch L_poll_3
L_poll_3s:
    s_sleep 8
L_poll_3:
    buffer_load_dwordx4 v[8:11], v5, s[40:43], s63 offen offset:0 sc1
    buffer_load_dwordx4 v[12:15], v5, s[40:43], s63 offen offset:1024 sc1
    buffer_load_dwordx4 v[16:19], v5, s[40:43], s63 offen offset:2048 sc1
    buffer_load_dwordx4 v[20:23], v5, s[40:43], s63 offen offset:3072 sc1
    buffer_load_dwordx4 v[24:27], v5, s[40:43], s12 offen offset:0 sc1
    s_sub_u32 s60, s60, 1
    s_cbranch_scc1 L_poll_3t
    s_waitcnt vmcnt(0)
    v_max3_u32 v37, v8, v9, v10
    v_max3_u32 v37, v37, v11, v12
    v_max3_u32 v37, v37, v13, v14
    v_max3_u32 v37, v37, v15, v16
    v_max3_u32 v37, v37, v17, v18
    v_max3_u32 v37, v37, v19, v20
    v_max3_u32 v37, v37, v21, v22
    v_max3_u32 v37, v37, v23, v24
    v_max3_u32 v37, v37, v25, v26
    v_max_u32 v37, v37, v27
    v_cmp_eq_u32 vcc, -1, v37
    s_cbranch_vccnz L_poll_3s
L_poll_3e:
L_u_got:
L_u_mm:
    s_waitcnt lgkmcnt(0)
    v_mfma_f32_16x16x32_bf16 v[40:43], v[80:83], v[8:11], 0
    v_mfma_f32_16x16x32_bf16 v[44:47], v[84:87], v[8:11], 0
    v_mfma_f32_16x16x32_bf16 v[48:51], v[88:91], v[8:11], 0
    v_mfma_f32_16x16x32_bf16 v[52:55], v[92:95], v[8:11], 0
    v_mfma_f32_16x16x32_bf16 v[40:43], v[96:99], v[12:15], v[40:43]
    v_mfma_f32_16x16x32_bf16 v[44:47], v[100:103], v[12:15], v[44:47]
    v_mfma_f32_16x16x32_bf16 v[48:51], v[104:107], v[12:15], v[48:51]
    v_mfma_f32_16x16x32_bf16 v[52:55], v[108:111], v[12:15], v[52:55]
    v_mfma_f32_16x16x32_bf16 v[40:43], v[112:115], v[16:19], v[40:43]
    v_mfma_f32_16x16x32_bf16 v[44:47], v[116:119], v[16:19], v[44:47]
    v_mfma_f32_16x16x32_bf16 v[48:51], v[120:123], v[16:19], v[48:51]
    v_mfma_f32_16x16x32_bf16 v[52:55], v[124:127], v[16:19], v[52:55]
    v_mfma_f32_16x16x32_bf16 v[40:43], v[128:131], v[20:23], v[40:43]
    v_mfma_f32_16x16x32_bf16 v[44:47], v[132:135], v[20:23], v[44:47]
    v_mfma_f32_16x16x32_bf16 v[48:51], v[136:139], v[20:23], v[48:51]
    v_mfma_f32_16x16x32_bf16 v[52:55], v[140:143], v[20:23], v[52:55]
    v_mfma_f32_16x16x32_bf16 v[40:43], v[144:147], v[24:27], v[40:43]
    v_mfma_f32_16x16x32_bf16 v[44:47], v[148:151], v[24:27], v[44:47]
    v_mfma_f32_16x16x32_bf16 v[48:51], v[152:155], v[24:27], v[48:51]
    v_mfma_f32_16x16x32_bf16 v[52:55], v[156:159], v[24:27], v[52:55]
    v_lshlrev_b32 v5, 4, v0
    v_add_u32 v5, 147456, v5
    s_lshl_b32 s62, s3, 10
    s_add_u32 s62, s62, 147456
    v_lshl_add_u32 v6, v69, 4, s62
    v_mov_b32 v24, s58
    v_mov_b32 v32, 162056
    v_mov_b32 v33, 1
    v_add_f32_dpp v40, v40, v40 row_ror:8 row_mask:0xf bank_mask:0xf
    v_add_f32_dpp v41, v41, v41 row_ror:8 row_mask:0xf bank_mask:0xf
    v_add_f32_dpp v42, v42, v42 row_ror:8 row_mask:0xf bank_mask:0xf
    v_add_f32_dpp v43, v43, v43 row_ror:8 row_mask:0xf bank_mask:0xf
    v_add_f32_dpp v44, v44, v44 row_ror:8 row_mask:0xf bank_mask:0xf
    v_add_f32_dpp v45, v45, v45 row_ror:8 row_mask:0xf bank_mask:0xf
    v_add_f32_dpp v46, v46, v46 row_ror:8 row_mask:0xf bank_mask:0xf
    v_add_f32_dpp v47, v47, v47 row_ror:8 row_mask:0xf bank_mask:0xf
    v_add_f32_dpp v48, v48, v48 row_ror:8 row_mask:0xf bank_mask:0xf
    v_add_f32_dpp v49, v49, v49 row_ror:8 row_mask:0xf bank_mask:0xf
    v_add_f32_dpp v50, v50, v50 row_ror:8 row_mask:0xf bank_mask:0xf
    v_add_f32_dpp v51, v51, v51 row_ror:8 row_mask:0xf bank_mask:0xf
    v_add_f32_dpp v52, v52, v52 row_ror:8 row_mask:0xf bank_mask:0xf
    v_add_f32_dpp v53, v53, v53 row_ror:8 row_mask:0xf bank_mask:0xf
    v_add_f32_dpp v54, v54, v54 row_ror:8 row_mask:0xf bank_mask:0xf
    v_add_f32_dpp v55, v55, v55 row_ror:8 row_mask:0xf bank_mask:0xf
    v_add_f32_dpp v28, v40, v40 row_ror:4 row_mask:0xf bank_mask:0x1
    v_add_f32_dpp v29, v41, v41 row_ror:4 row_mask:0xf bank_mask:0x1
    v_add_f32_dpp v30, v42, v42 row_ror:4 row_mask:0xf bank_mask:0x1
    v_add_f32_dpp v31, v43, v43 row_ror:4 row_mask:0xf bank_mask:0x1
    v_add_f32_dpp v28, v44, v44 row_ror:4 row_mask:0xf bank_mask:0x2
    v_add_f32_dpp v29, v45, v45 row_ror:4 row_mask:0xf bank_mask:0x2
    v_add_f32_dpp v30, v46, v46 row_ror:4 row_mask:0xf bank_mask:0x2
    v_add_f32_dpp v31, v47, v47 row_ror:4 row_mask:0xf bank_mask:0x2
    v_add_f32_dpp v28, v48, v48 row_ror:4 row_mask:0xf bank_mask:0x4
    v_add_f32_dpp v29, v49, v49 row_ror:4 row_mask:0xf bank_mask:0x4
    v_add_f32_dpp v30, v50, v50 row_ror:4 row_mask:0xf bank_mask:0x4
    v_add_f32_dpp v31, v51, v51 row_ror:4 row_mask:0xf bank_mask:0x4
    v_add_f32_dpp v28, v52, v52 row_ror:4 row_mask:0xf bank_mask:0x8
    v_add_f32_dpp v29, v53, v53 row_ror:4 row_mask:0xf bank_mask:0x8
    v_add_f32_dpp v30, v54, v54 row_ror:4 row_mask:0xf bank_mask:0x8
    v_add_f32_dpp v31, v55, v55 row_ror:4 row_mask:0xf bank_mask:0x8
    v_fma_f32 v28, v28, s59, v24
    v_fma_f32 v29, v29, s59, v24
    v_fma_f32 v30, v30, s59, v24
    v_fma_f32 v31, v31, s59, v24
    v_mul_f32 v28, v28, v56
    v_mul_f32 v29, v29, v57
    v_mul_f32 v30, v30, v58
    v_mul_f32 v31, v31, v59
    ds_write_b128 v6, v[28:31]
    s_mov_b64 exec, 1
    ds_add_rtn_u32 v34, v32, v33
    s_mov_b64 exec, -1
    ds_read_b128 v[8:11], v5
    ds_read_b128 v[12:15], v5 offset:1024
    ds_read_b128 v[16:19], v5 offset:2048
    ds_read_b128 v[20:23], v5 offset:3072
    s_waitcnt lgkmcnt(0)
    v_readfirstlane_b32 s62, v34
    s_nop 0
    s_cmp_eq_u32 s62, s15
    s_cbranch_scc1 L_u_last
    s_cmp_eq_u32 s62, 1
    s_cbranch_scc1 L_service
    s_endpgm
L_u_last:
    v_add_f32 v8, v8, v12
    v_add_f32 v9, v9, v13
    v_add_f32 v10, v10, v14
    v_add_f32 v11, v11, v15
    s_cmp_eq_u32 s15, 1
    s_cbranch_scc1 L_u_two
    v_add_f32 v16, v16, v20
    v_add_f32 v17, v17, v21
    v_add_f32 v18, v18, v22
    v_add_f32 v19, v19, v23
    v_add_f32 v8, v8, v16
    v_add_f32 v9, v9, v17
    v_add_f32 v10, v10, v18
    v_add_f32 v11, v11, v19
L_u_two:
    v_cvt_pk_bf16_f32 v8, v8, v9
    v_cvt_pk_bf16_f32 v9, v10, v11
    s_waitcnt vmcnt(0)
    v_cmp_ne_u32 vcc, -1, v68
    s_cbranch_vccz L_u_st
L_wy_4:
    buffer_load_dword v68, v65, s[44:47], 0 offen sc1
    s_waitcnt vmcnt(0)
    v_cmp_ne_u32 vcc, -1, v68
    s_cbranch_vccz L_wy_4e
    s_sleep 4
    s_sub_u32 s60, s60, 1
    s_cbranch_scc0 L_wy_4
    s_mov_b32 s60, 0
L_wy_4e:
L_u_st:
    buffer_store_dwordx2 v[8:9], v64, s[40:43], s57 offen sc1
    s_endpgm
L_touch:
    s_load_dword s0, s[32:33], 0
    s_load_dword s0, s[30:31], 0
    s_cmp_eq_u32 s39, 1
    s_cbranch_scc1 L_tpr
    s_mov_b32 s62, 16777216
    s_load_dword s0, s[8:9], s62
    s_mov_b32 s62, 83886080
    s_load_dword s0, s[8:9], s62
    s_mov_b32 s62, 150994944
    s_load_dword s0, s[8:9], s62
    s_mov_b32 s62, 218103808
    s_load_dword s0, s[8:9], s62
    s_branch L_tpv
L_tpr:
    s_load_dword s0, s[20:21], 0
    s_mov_b32 s62, 2211836
    s_load_dword s0, s[20:21], s62
    s_load_dword s0, s[16:17], 0
    s_mov_b32 s62, 2211836
    s_load_dword s0, s[16:17], s62
    s_load_dword s0, s[18:19], 0
    s_load_dword s0, s[22:23], 0
    s_load_dword s0, s[28:29], 0
    s_load_dword s0, s[4:5], 0
L_tpv:
    s_lshl_b32 s62, s34, 23
    s_load_dword s0, s[8:9], s62
    s_add_u32 s62, s62, 67108864
    s_load_dword s0, s[8:9], s62
    s_add_u32 s62, s62, 67108864
    s_load_dword s0, s[8:9], s62
    s_add_u32 s62, s62, 67108864
    s_load_dword s0, s[8:9], s62
    s_add_u32 s62, s62, 67108864
    s_branch L_notp
L_stream2:
    s_mov_b32 s12, s100
    s_mov_b32 s13, s101
    s_andn2_b32 s96, s59, s39
    s_cbranch_scc0 L_noua
    s_barrier
L_noua:
    s_mov_b32 s40, s32
    s_mov_b32 s41, s33
    s_mov_b32 s42, 589824
    s_mov_b32 s43, 0x20000
    s_mov_b32 s44, s30
    s_mov_b32 s45, s31
    s_mov_b32 s46, 256
    s_mov_b32 s47, 0x20000
    s_bitcmp1_b32 s3, 0
    s_mov_b32 s57, 0xffffffff
    s_mov_b32 s58, 0x0
    s_mov_b32 s14, 0xffffff
    s_mov_b32 s15, 0x0
L_pm_10:
    s_sub_u32 s96, s56, 104
    s_cmp_lt_u32 s96, 66
    s_cbranch_scc0 L_pm_11
    s_bitcmp1_b32 s3, 0
    s_mov_b32 s57, 0xff00000f
    s_mov_b32 s58, 0x0
    s_mov_b32 s14, 0xffffff
    s_mov_b32 s15, 0x0
L_pm_11:
    s_sub_u32 s96, s56, 144
    s_cmp_lt_u32 s96, 10
    s_cbranch_scc0 L_pm_12
    s_bitcmp1_b32 s3, 0
    s_mov_b32 s57, 0xffffffff
    s_mov_b32 s58, 0xfff
    s_mov_b32 s14, 0xffffff
    s_mov_b32 s15, 0x0
L_pm_12:
    s_cmp_lt_u32 s56, 104
    s_cbranch_scc0 L_pm_13
    s_bitcmp1_b32 s3, 0
    s_mov_b32 s57, 0xf
    s_mov_b32 s58, 0x0
    s_mov_b32 s14, 0xffffff
    s_mov_b32 s15, 0x0
L_pm_13:
    s_sub_u32 s96, s56, 43
    s_and_b32 s96, s96, 0xffffffc7
    s_cmp_eq_u32 s96, 0
    s_cbranch_scc0 L_pm_14
    s_bitcmp1_b32 s3, 0
    s_mov_b32 s57, 0x0
    s_mov_b32 s58, 0x0
    s_mov_b32 s14, 0x0
    s_mov_b32 s15, 0x0
L_pm_14:
    s_cmp_lt_u32 s56, 40
    s_cbranch_scc0 L_pm_15
    s_bitcmp1_b32 s3, 0
    s_mov_b32 s57, 0xffffffff
    s_mov_b32 s58, 0xf
    s_mov_b32 s14, 0xffffff
    s_mov_b32 s15, 0x0
L_pm_15:
    s_cmp_eq_u32 s39, 1
    s_cbranch_scc0 L_pm_16
    s_bitcmp1_b32 s3, 0
    s_mov_b32 s57, 0xff
    s_mov_b32 s58, 0xff
    s_mov_b32 s14, 0x0
    s_mov_b32 s15, 0x0
L_pm_16:
    s_cmp_lg_u32 s13, 0
    s_cbranch_scc0 L_pm_17
    s_bitcmp1_b32 s3, 0
    s_mov_b32 s57, 0xffffffff
    s_mov_b32 s58, 0x0
    s_mov_b32 s14, 0x0
    s_mov_b32 s15, 0x0
L_pm_17:
    s_and_b32 s96, s39, s59
    s_cbranch_scc0 L_pm_18
    s_bitcmp1_b32 s3, 0
    s_mov_b32 s57, 0x3ff
    s_mov_b32 s58, 0x3ff
    s_mov_b32 s14, 0x0
    s_mov_b32 s15, 0x0
L_pm_18:
    s_add_u32 s52, s8, s63
    s_addc_u32 s53, s9, 0
    s_mov_b32 s54, 262144
    s_mov_b32 s55, 0x20000
    v_and_b32 v2, 15, v0
    v_lshrrev_b32 v3, 1, v2
    v_and_b32 v37, 1, v2
    v_lshlrev_b32 v37, 4, v37
    v_mov_b32 v38, 0xffff
    v_lshlrev_b32 v37, v37, v38
    v_cmp_eq_u32 vcc, 0, v3
    v_mov_b32 v32, 0
    s_nop 0
    v_cndmask_b32 v20, 0, v37, vcc
    v_cmp_eq_u32 vcc, 1, v3
    v_mov_b32 v33, 0
    s_nop 0
    v_cndmask_b32 v21, 0, v37, vcc
    v_cmp_eq_u32 vcc, 2, v3
    v_mov_b32 v34, 0
    s_nop 0
    v_cndmask_b32 v22, 0, v37, vcc
    v_cmp_eq_u32 vcc, 3, v3
    v_mov_b32 v35, 0
    s_nop 0
    v_cndmask_b32 v23, 0, v37, vcc
    v_lshlrev_b32 v2, 4, v2
    s_lshl_b32 s98, s62, 8
    s_add_u32 s98, s98, 40960
    s_bitcmp0_b32 s57, 2
    s_cbranch_scc1 L_sf_19
    s_bitcmp0_b32 s58, 2
    s_cbranch_scc1 L_sf_19
    s_waitcnt vmcnt(1)
L_sf_19:
    buffer_load_dwordx4 v[48:51], v1, s[48:51], s97 offen offset:2048 nt
    s_bitcmp0_b32 s57, 3
    s_cbranch_scc1 L_sf_20
    s_waitcnt vmcnt(2)
    s_bitcmp0_b32 s58, 3
    s_cbranch_scc1 L_sf_20
    s_waitcnt vmcnt(1)
L_sf_20:
    buffer_load_dwordx4 v[52:55], v1, s[48:51], s97 offen offset:3072 nt
    s_add_u32 s97, s97, 32768
    v_add_u32 v1, 4096, v1
    v_and_b32 v1, 0x7fff, v1
    s_waitcnt vmcnt(3)
    s_bitcmp0_b32 s57, 4
    s_cbranch_scc1 L_sf_21
    s_waitcnt vmcnt(2)
    s_bitcmp0_b32 s58, 4
    s_cbranch_scc1 L_sf_21
    s_waitcnt vmcnt(1)
L_sf_21:
    buffer_load_dwordx4 v[56:59], v1, s[48:51], s97 offen offset:0 nt
    s_waitcnt vmcnt(3)
    s_bitcmp0_b32 s57, 5
    s_cbranch_scc1 L_sf_22
    s_waitcnt vmcnt(2)
    s_bitcmp0_b32 s58, 5
    s_cbranch_scc1 L_sf_22
    s_waitcnt vmcnt(1)
L_sf_22:
    buffer_load_dwordx4 v[60:63], v1, s[48:51], s97 offen offset:1024 nt
    s_waitcnt vmcnt(3)
    s_bitcmp0_b32 s57, 6
    s_cbranch_scc1 L_sf_23
    s_waitcnt vmcnt(2)
    s_bitcmp0_b32 s58, 6
    s_cbranch_scc1 L_sf_23
    s_waitcnt vmcnt(1)
L_sf_23:
    buffer_load_dwordx4 v[64:67], v1, s[48:51], s97 offen offset:2048 nt
    s_waitcnt vmcnt(3)
    s_bitcmp0_b32 s57, 7
    s_cbranch_scc1 L_sf_24
    s_waitcnt vmcnt(2)
    s_bitcmp0_b32 s58, 7
    s_cbranch_scc1 L_sf_24
    s_waitcnt vmcnt(1)
L_sf_24:
    buffer_load_dwordx4 v[68:71], v1, s[48:51], s97 offen offset:3072 nt
    s_add_u32 s97, s97, 32768
    v_add_u32 v1, 4096, v1
    v_and_b32 v1, 0x7fff, v1
    s_waitcnt vmcnt(3)
    s_bitcmp0_b32 s57, 8
    s_cbranch_scc1 L_sf_25
    s_waitcnt vmcnt(2)
    s_bitcmp0_b32 s58, 8
    s_cbranch_scc1 L_sf_25
    s_waitcnt vmcnt(1)
L_sf_25:
    buffer_load_dwordx4 v[72:75], v1, s[48:51], s97 offen offset:0 nt
    s_waitcnt vmcnt(3)
    s_bitcmp0_b32 s57, 9
    s_cbranch_scc1 L_sf_26
    s_waitcnt vmcnt(2)
    s_bitcmp0_b32 s58, 9
    s_cbranch_scc1 L_sf_26
    s_waitcnt vmcnt(1)
L_sf_26:
    buffer_load_dwordx4 v[76:79], v1, s[48:51], s97 offen offset:1024 nt
    s_waitcnt vmcnt(3)
    s_bitcmp0_b32 s57, 10
    s_cbranch_scc1 L_sf_27
    s_waitcnt vmcnt(2)
    s_bitcmp0_b32 s58, 10
    s_cbranch_scc1 L_sf_27
    s_waitcnt vmcnt(1)
L_sf_27:
    buffer_load_dwordx4 v[80:83], v1, s[48:51], s97 offen offset:2048 nt
    s_waitcnt vmcnt(3)
    s_bitcmp0_b32 s57, 11
    s_cbranch_scc1 L_sf_28
    s_waitcnt vmcnt(2)
    s_bitcmp0_b32 s58, 11
    s_cbranch_scc1 L_sf_28
    s_waitcnt vmcnt(1)
L_sf_28:
    buffer_load_dwordx4 v[84:87], v1, s[48:51], s97 offen offset:3072 nt
    s_add_u32 s97, s97, 32768
    v_add_u32 v1, 4096, v1
    v_and_b32 v1, 0x7fff, v1
    s_waitcnt vmcnt(3)
    s_bitcmp0_b32 s57, 12
    s_cbranch_scc1 L_sf_29
    s_waitcnt vmcnt(2)
    s_bitcmp0_b32 s58, 12
    s_cbranch_scc1 L_sf_29
    s_waitcnt vmcnt(1)
L_sf_29:
    buffer_load_dwordx4 v[88:91], v1, s[48:51], s97 offen offset:0 nt
    s_waitcnt vmcnt(3)
    s_bitcmp0_b32 s57, 13
    s_cbranch_scc1 L_sf_30
    s_waitcnt vmcnt(2)
    s_bitcmp0_b32 s58, 13
    s_cbranch_scc1 L_sf_30
    s_waitcnt vmcnt(1)
L_sf_30:
    buffer_load_dwordx4 v[92:95], v1, s[48:51], s97 offen offset:1024 nt
    s_waitcnt vmcnt(3)
    s_bitcmp0_b32 s57, 14
    s_cbranch_scc1 L_sf_31
    s_waitcnt vmcnt(2)
    s_bitcmp0_b32 s58, 14
    s_cbranch_scc1 L_sf_31
    s_waitcnt vmcnt(1)
L_sf_31:
    buffer_load_dwordx4 v[96:99], v1, s[48:51], s97 offen offset:2048 nt
    s_waitcnt vmcnt(3)
    s_bitcmp0_b32 s57, 15
    s_cbranch_scc1 L_sf_32
    s_waitcnt vmcnt(2)
    s_bitcmp0_b32 s58, 15
    s_cbranch_scc1 L_sf_32
    s_waitcnt vmcnt(1)
L_sf_32:
    buffer_load_dwordx4 v[100:103], v1, s[48:51], s97 offen offset:3072 nt
    s_add_u32 s97, s97, 32768
    v_add_u32 v1, 4096, v1
    v_and_b32 v1, 0x7fff, v1
    s_waitcnt vmcnt(3)
    s_bitcmp0_b32 s57, 16
    s_cbranch_scc1 L_sf_33
    s_waitcnt vmcnt(2)
    s_bitcmp0_b32 s58, 16
    s_cbranch_scc1 L_sf_33
    s_waitcnt vmcnt(1)
L_sf_33:
    buffer_load_dwordx4 v[104:107], v1, s[48:51], s97 offen offset:0 nt
    s_waitcnt vmcnt(3)
    s_bitcmp0_b32 s57, 17
    s_cbranch_scc1 L_sf_34
    s_waitcnt vmcnt(2)
    s_bitcmp0_b32 s58, 17
    s_cbranch_scc1 L_sf_34
    s_waitcnt vmcnt(1)
L_sf_34:
    buffer_load_dwordx4 v[108:111], v1, s[48:51], s97 offen offset:1024 nt
    s_waitcnt vmcnt(3)
    s_bitcmp0_b32 s57, 18
    s_cbranch_scc1 L_sf_35
    s_waitcnt vmcnt(2)
    s_bitcmp0_b32 s58, 18
    s_cbranch_scc1 L_sf_35
    s_waitcnt vmcnt(1)
L_sf_35:
    buffer_load_dwordx4 v[112:115], v1, s[48:51], s97 offen offset:2048 nt
    s_waitcnt vmcnt(3)
    s_bitcmp0_b32 s57, 19
    s_cbranch_scc1 L_sf_36
    s_waitcnt vmcnt(2)
    s_bitcmp0_b32 s58, 19
    s_cbranch_scc1 L_sf_36
    s_waitcnt vmcnt(1)
L_sf_36:
    buffer_load_dwordx4 v[116:119], v1, s[48:51], s97 offen offset:3072 nt
    s_add_u32 s97, s97, 32768
    v_add_u32 v1, 4096, v1
    v_and_b32 v1, 0x7fff, v1
    s_waitcnt vmcnt(3)
    s_bitcmp0_b32 s57, 20
    s_cbranch_scc1 L_sf_37
    s_waitcnt vmcnt(2)
    s_bitcmp0_b32 s58, 20
    s_cbranch_scc1 L_sf_37
    s_waitcnt vmcnt(1)
L_sf_37:
    buffer_load_dwordx4 v[120:123], v1, s[48:51], s97 offen offset:0 nt
    s_waitcnt vmcnt(3)
    s_bitcmp0_b32 s57, 21
    s_cbranch_scc1 L_sf_38
    s_waitcnt vmcnt(2)
    s_bitcmp0_b32 s58, 21
    s_cbranch_scc1 L_sf_38
    s_waitcnt vmcnt(1)
L_sf_38:
    buffer_load_dwordx4 v[124:127], v1, s[48:51], s97 offen offset:1024 nt
    s_cmp_eq_u32 s12, -1
    s_cbranch_scc1 L_k_nopf
    s_waitcnt vmcnt(3)
    s_bitcmp0_b32 s57, 22
    s_cbranch_scc1 L_sf_39
    s_waitcnt vmcnt(2)
    s_bitcmp0_b32 s58, 22
    s_cbranch_scc1 L_sf_39
    s_waitcnt vmcnt(1)
L_sf_39:
    buffer_load_dwordx4 v[128:131], v1, s[48:51], s97 offen offset:2048 nt
    s_waitcnt vmcnt(3)
    s_bitcmp0_b32 s57, 23
    s_cbranch_scc1 L_sf_40
    s_waitcnt vmcnt(2)
    s_bitcmp0_b32 s58, 23
    s_cbranch_scc1 L_sf_40
    s_waitcnt vmcnt(1)
L_sf_40:
    buffer_load_dwordx4 v[132:135], v1, s[48:51], s97 offen offset:3072 nt
    s_add_u32 s97, s97, 32768
    v_add_u32 v1, 4096, v1
    v_and_b32 v1, 0x7fff, v1
    s_waitcnt vmcnt(3)
    s_bitcmp0_b32 s57, 24
    s_cbranch_scc1 L_sf_41
    s_waitcnt vmcnt(2)
    s_bitcmp0_b32 s58, 24
    s_cbranch_scc1 L_sf_41
    s_waitcnt vmcnt(1)
L_sf_41:
    buffer_load_dwordx4 v[136:139], v1, s[48:51], s97 offen offset:0 nt
    s_waitcnt vmcnt(3)
    s_bitcmp0_b32 s57, 25
    s_cbranch_scc1 L_sf_42
    s_waitcnt vmcnt(2)
    s_bitcmp0_b32 s58, 25
    s_cbranch_scc1 L_sf_42
    s_waitcnt vmcnt(1)
L_sf_42:
    buffer_load_dwordx4 v[140:143], v1, s[48:51], s97 offen offset:1024 nt
    s_waitcnt vmcnt(3)
    s_bitcmp0_b32 s57, 26
    s_cbranch_scc1 L_sf_43
    s_waitcnt vmcnt(2)
    s_bitcmp0_b32 s58, 26
    s_cbranch_scc1 L_sf_43
    s_waitcnt vmcnt(1)
L_sf_43:
    buffer_load_dwordx4 v[144:147], v1, s[48:51], s97 offen offset:2048 nt
    s_waitcnt vmcnt(3)
    s_bitcmp0_b32 s57, 27
    s_cbranch_scc1 L_sf_44
    s_waitcnt vmcnt(2)
    s_bitcmp0_b32 s58, 27
    s_cbranch_scc1 L_sf_44
    s_waitcnt vmcnt(1)
L_sf_44:
    buffer_load_dwordx4 v[148:151], v1, s[48:51], s97 offen offset:3072 nt
    s_add_u32 s97, s97, 32768
    v_add_u32 v1, 4096, v1
    v_and_b32 v1, 0x7fff, v1
    s_waitcnt vmcnt(3)
    s_bitcmp0_b32 s57, 28
    s_cbranch_scc1 L_sf_45
    s_waitcnt vmcnt(2)
    s_bitcmp0_b32 s58, 28
    s_cbranch_scc1 L_sf_45
    s_waitcnt vmcnt(1)
L_sf_45:
    buffer_load_dwordx4 v[152:155], v1, s[48:51], s97 offen offset:0 nt
    s_waitcnt vmcnt(3)
    s_bitcmp0_b32 s57, 29
    s_cbranch_scc1 L_sf_46
    s_waitcnt vmcnt(2)
    s_bitcmp0_b32 s58, 29
    s_cbranch_scc1 L_sf_46
    s_waitcnt vmcnt(1)
L_sf_46:
    buffer_load_dwordx4 v[156:159], v1, s[48:51], s97 offen offset:1024 nt
    s_waitcnt vmcnt(3)
    s_bitcmp0_b32 s57, 30
    s_cbranch_scc1 L_sf_47
    s_waitcnt vmcnt(2)
    s_bitcmp0_b32 s58, 30
    s_cbranch_scc1 L_sf_47
    s_waitcnt vmcnt(1)
L_sf_47:
    buffer_load_dwordx4 v[160:163], v1, s[48:51], s97 offen offset:2048 nt
    v_min_u32 v39, 15, v0
    v_and_b32 v38, 1, v39
    v_mul_u32_u24 v38, 126, v38
    v_lshl_add_u32 v39, v39, 1, v38
    buffer_load_dword v37, v39, s[44:47], 0 offen sc1
    s_waitcnt vmcnt(4)
    s_bitcmp0_b32 s57, 31
    s_cbranch_scc1 L_sf_48
    s_waitcnt vmcnt(3)
    s_bitcmp0_b32 s58, 31
    s_cbranch_scc1 L_sf_48
    s_waitcnt vmcnt(2)
L_sf_48:
    buffer_load_dwordx4 v[164:167], v1, s[48:51], s97 offen offset:3072 nt
    s_mov_b32 s97, 0
    v_add_u32 v1, 4096, v1
    v_and_b32 v1, 0x7fff, v1
    s_waitcnt vmcnt(4)
    s_bitcmp0_b32 s14, 0
    s_cbranch_scc1 L_sf_49
    s_waitcnt vmcnt(3)
    s_bitcmp0_b32 s15, 0
    s_cbranch_scc1 L_sf_49
    s_waitcnt vmcnt(2)
L_sf_49:
    s_add_u32 m0, s12, 0
    s_nop 0
    buffer_load_dwordx4 v1, s[52:55], s97 offen offset:0 nt lds
    s_waitcnt vmcnt(4)
    s_bitcmp0_b32 s14, 1
    s_cbranch_scc1 L_sf_50
    s_waitcnt vmcnt(3)
    s_bitcmp0_b32 s15, 1
    s_cbranch_scc1 L_sf_50
    s_waitcnt vmcnt(1)
L_sf_50:
    buffer_load_dwordx4 v1, s[52:55], s97 offen offset:1024 nt lds
    s_waitcnt vmcnt(4)
    s_bitcmp0_b32 s14, 2
    s_cbranch_scc1 L_sf_51
    s_waitcnt vmcnt(2)
    s_bitcmp0_b32 s15, 2
    s_cbranch_scc1 L_sf_51
    s_waitcnt vmcnt(1)
L_sf_51:
    buffer_load_dwordx4 v1, s[52:55], s97 offen offset:2048 nt lds
    s_waitcnt vmcnt(3)
    s_bitcmp0_b32 s14, 3
    s_cbranch_scc1 L_sf_52
    s_waitcnt vmcnt(2)
    s_bitcmp0_b32 s15, 3
    s_cbranch_scc1 L_sf_52
    s_waitcnt vmcnt(1)
L_sf_52:
    buffer_load_dwordx4 v1, s[52:55], s97 offen offset:3072 nt lds
    s_add_u32 s97, s97, 32768
    v_add_u32 v1, 4096, v1
    v_and_b32 v1, 0x7fff, v1
    v_cmp_eq_u32 vcc, 0, v37
    s_nop 0
    s_or_b32 s96, vcc_lo, vcc_hi
    buffer_load_dwordx4 v[4:7], v2, s[40:43], s98 offen sc1
    s_waitcnt vmcnt(4)
    s_bitcmp0_b32 s14, 4
    s_cbranch_scc1 L_sf_53
    s_waitcnt vmcnt(3)
    s_bitcmp0_b32 s15, 4
    s_cbranch_scc1 L_sf_53
    s_waitcnt vmcnt(2)
L_sf_53:
    s_add_u32 m0, s12, 4096
    s_nop 0
    buffer_load_dwordx4 v1, s[52:55], s97 offen offset:0 nt lds
    s_waitcnt vmcnt(4)
    s_bitcmp0_b32 s14, 5
    s_cbranch_scc1 L_sf_54
    s_waitcnt vmcnt(3)
    s_bitcmp0_b32 s15, 5
    s_cbranch_scc1 L_sf_54
    s_waitcnt vmcnt(2)
L_sf_54:
    buffer_load_dwordx4 v1, s[52:55], s97 offen offset:1024 nt lds
    s_waitcnt vmcnt(4)
    s_bitcmp0_b32 s14, 6
    s_cbranch_scc1 L_sf_55
    s_waitcnt vmcnt(3)
    s_bitcmp0_b32 s15, 6
    s_cbranch_scc1 L_sf_55
    s_waitcnt vmcnt(1)
L_sf_55:
    buffer_load_dwordx4 v1, s[52:55], s97 offen offset:2048 nt lds
    s_waitcnt vmcnt(4)
    s_bitcmp0_b32 s14, 7
    s_cbranch_scc1 L_sf_56
    s_waitcnt vmcnt(2)
    s_bitcmp0_b32 s15, 7
    s_cbranch_scc1 L_sf_56
    s_waitcnt vmcnt(1)
L_sf_56:
    buffer_load_dwordx4 v1, s[52:55], s97 offen offset:3072 nt lds
    s_add_u32 s97, s97, 32768
    v_add_u32 v1, 4096, v1
    v_and_b32 v1, 0x7fff, v1
L_k_join:
    s_waitcnt vmcnt(4)
    v_max3_u32 v38, v4, v5, v6
    v_max_u32 v38, v38, v7
    v_cmp_eq_u32 vcc, -1, v38
    s_cmp_lg_u32 s96, 0
    s_cbranch_scc1 L_qslow
    s_cbranch_vccnz L_qslow2
L_qok:
    v_dot2_f32_bf16 v8, v72, v4, 0
    v_dot2_f32_bf16 v9, v76, v4, 0
    v_dot2_f32_bf16 v10, v80, v4, 0
    v_dot2_f32_bf16 v11, v84, v4, 0
    v_dot2_f32_bf16 v24, v88, v4, 0
    v_dot2_f32_bf16 v25, v92, v4, 0
    v_dot2_f32_bf16 v26, v96, v4, 0
    v_dot2_f32_bf16 v27, v100, v4, 0
    v_dot2_f32_bf16 v8, v73, v5, v8
    v_dot2_f32_bf16 v9, v77, v5, v9
    v_dot2_f32_bf16 v10, v81, v5, v10
    v_dot2_f32_bf16 v11, v85, v5, v11
    v_dot2_f32_bf16 v24, v89, v5, v24
    v_dot2_f32_bf16 v25, v93, v5, v25
    v_dot2_f32_bf16 v26, v97, v5, v26
    v_dot2_f32_bf16 v27, v101, v5, v27
    v_dot2_f32_bf16 v8, v74, v6, v8
    v_dot2_f32_bf16 v9, v78, v6, v9
    v_dot2_f32_bf16 v10, v82, v6, v10
    v_dot2_f32_bf16 v11, v86, v6, v11
    v_dot2_f32_bf16 v24, v90, v6, v24
    v_dot2_f32_bf16 v25, v94, v6, v25
    v_dot2_f32_bf16 v26, v98, v6, v26
    v_dot2_f32_bf16 v27, v102, v6, v27
    v_dot2_f32_bf16 v8, v75, v7, v8
    v_dot2_f32_bf16 v9, v79, v7, v9
    v_dot2_f32_bf16 v10, v83, v7, v10
    v_dot2_f32_bf16 v11, v87, v7, v11
    v_dot2_f32_bf16 v24, v91, v7, v24
    v_dot2_f32_bf16 v25, v95, v7, v25
    v_dot2_f32_bf16 v26, v99, v7, v26
    v_dot2_f32_bf16 v27, v103, v7, v27
    v_add_f32_dpp v8, v8, v8 row_ror:8 row_mask:0xf bank_mask:0x3
    v_add_f32_dpp v10, v10, v10 row_ror:8 row_mask:0xf bank_mask:0x3
    v_add_f32_dpp v24, v24, v24 row_ror:8 row_mask:0xf bank_mask:0x3
    v_add_f32_dpp v26, v26, v26 row_ror:8 row_mask:0xf bank_mask:0x3
    v_add_f32_dpp v8, v9, v9 row_ror:8 row_mask:0xf bank_mask:0xc
    v_add_f32_dpp v10, v11, v11 row_ror:8 row_mask:0xf bank_mask:0xc
    v_add_f32_dpp v24, v25, v25 row_ror:8 row_mask:0xf bank_mask:0xc
    v_add_f32_dpp v26, v27, v27 row_ror:8 row_mask:0xf bank_mask:0xc
    v_add_f32_dpp v14, v8, v8 row_half_mirror row_mask:0xf bank_mask:0x5
    v_add_f32_dpp v15, v24, v24 row_half_mirror row_mask:0xf bank_mask:0x5
    v_add_f32_dpp v14, v10, v10 row_half_mirror row_mask:0xf bank_mask:0xa
    v_add_f32_dpp v15, v26, v26 row_half_mirror row_mask:0xf bank_mask:0xa
    s_nop 0
    v_add_f32_dpp v14, v14, v14 quad_perm:[1,0,3,2] row_mask:0xf bank_mask:0xf
    v_add_f32_dpp v15, v15, v15 quad_perm:[1,0,3,2] row_mask:0xf bank_mask:0xf
    s_nop 0
    v_add_f32_dpp v14, v14, v14 quad_perm:[2,3,0,1] row_mask:0xf bank_mask:0xf
    v_add_f32_dpp v15, v15, v15 quad_perm:[2,3,0,1] row_mask:0xf bank_mask:0xf
    s_waitcnt vmcnt(3)
    s_bitcmp0_b32 s14, 8
    s_cbranch_scc1 L_sf_67
    s_waitcnt vmcnt(2)
    s_bitcmp0_b32 s15, 8
    s_cbranch_scc1 L_sf_67
    s_waitcnt vmcnt(1)
L_sf_67:
    buffer_load_dwordx4 v[72:75], v1, s[52:55], s97 offen offset:0 nt
    v_dot2_f32_bf16 v8, v40, v4, 0
    v_dot2_f32_bf16 v9, v44, v4, 0
    v_dot2_f32_bf16 v10, v48, v4, 0
    v_dot2_f32_bf16 v11, v52, v4, 0
    v_dot2_f32_bf16 v24, v56, v4, 0
    v_dot2_f32_bf16 v25, v60, v4, 0
    v_dot2_f32_bf16 v26, v64, v4, 0
    v_dot2_f32_bf16 v27, v68, v4, 0
    v_dot2_f32_bf16 v28, v104, v4, 0
    v_dot2_f32_bf16 v29, v108, v4, 0
    v_dot2_f32_bf16 v30, v112, v4, 0
    v_dot2_f32_bf16 v31, v116, v4, 0
    v_dot2_f32_bf16 v8, v41, v5, v8
    v_dot2_f32_bf16 v9, v45, v5, v9
    v_dot2_f32_bf16 v10, v49, v5, v10
    v_dot2_f32_bf16 v11, v53, v5, v11
    v_dot2_f32_bf16 v24, v57, v5, v24
    v_dot2_f32_bf16 v25, v61, v5, v25
    v_dot2_f32_bf16 v26, v65, v5, v26
    v_dot2_f32_bf16 v27, v69, v5, v27
    v_dot2_f32_bf16 v28, v105, v5, v28
    v_dot2_f32_bf16 v29, v109, v5, v29
    v_dot2_f32_bf16 v30, v113, v5, v30
    v_dot2_f32_bf16 v31, v117, v5, v31
    v_dot2_f32_bf16 v8, v42, v6, v8
    v_dot2_f32_bf16 v9, v46, v6, v9
    v_dot2_f32_bf16 v10, v50, v6, v10
    v_dot2_f32_bf16 v11, v54, v6, v11
    v_dot2_f32_bf16 v24, v58, v6, v24
    v_dot2_f32_bf16 v25, v62, v6, v25
    v_dot2_f32_bf16 v26, v66, v6, v26
    v_dot2_f32_bf16 v27, v70, v6, v27
    v_dot2_f32_bf16 v28, v106, v6, v28
    v_dot2_f32_bf16 v29, v110, v6, v29
    v_dot2_f32_bf16 v30, v114, v6, v30
    v_dot2_f32_bf16 v31, v118, v6, v31
    v_dot2_f32_bf16 v8, v43, v7, v8
    v_dot2_f32_bf16 v9, v47, v7, v9
    v_dot2_f32_bf16 v10, v51, v7, v10
    v_dot2_f32_bf16 v11, v55, v7, v11
    v_dot2_f32_bf16 v24, v59, v7, v24
    v_dot2_f32_bf16 v25, v63, v7, v25
    v_dot2_f32_bf16 v26, v67, v7, v26
    v_dot2_f32_bf16 v27, v71, v7, v27
    v_dot2_f32_bf16 v28, v107, v7, v28
    v_dot2_f32_bf16 v29, v111, v7, v29
    v_dot2_f32_bf16 v30, v115, v7, v30
    v_dot2_f32_bf16 v31, v119, v7, v31
    v_add_f32_dpp v8, v8, v8 row_ror:8 row_mask:0xf bank_mask:0x3
    v_add_f32_dpp v10, v10, v10 row_ror:8 row_mask:0xf bank_mask:0x3
    v_add_f32_dpp v24, v24, v24 row_ror:8 row_mask:0xf bank_mask:0x3
    v_add_f32_dpp v26, v26, v26 row_ror:8 row_mask:0xf bank_mask:0x3
    v_add_f32_dpp v28, v28, v28 row_ror:8 row_mask:0xf bank_mask:0x3
    v_add_f32_dpp v30, v30, v30 row_ror:8 row_mask:0xf bank_mask:0x3
    v_add_f32_dpp v8, v9, v9 row_ror:8 row_mask:0xf bank_mask:0xc
    v_add_f32_dpp v10, v11, v11 row_ror:8 row_mask:0xf bank_mask:0xc
    v_add_f32_dpp v24, v25, v25 row_ror:8 row_mask:0xf bank_mask:0xc
    v_add_f32_dpp v26, v27, v27 row_ror:8 row_mask:0xf bank_mask:0xc
    v_add_f32_dpp v28, v29, v29 row_ror:8 row_mask:0xf bank_mask:0xc
    v_add_f32_dpp v30, v31, v31 row_ror:8 row_mask:0xf bank_mask:0xc
    v_add_f32_dpp v12, v8, v8 row_half_mirror row_mask:0xf bank_mask:0x5
    v_add_f32_dpp v13, v24, v24 row_half_mirror row_mask:0xf bank_mask:0x5
    v_add_f32_dpp v16, v28, v28 row_half_mirror row_mask:0xf bank_mask:0x5
    v_add_f32_dpp v12, v10, v10 row_half_mirror row_mask:0xf bank_mask:0xa
    v_add_f32_dpp v13, v26, v26 row_half_mirror row_mask:0xf bank_mask:0xa
    v_add_f32_dpp v16, v30, v30 row_half_mirror row_mask:0xf bank_mask:0xa
    v_add_f32_dpp v12, v12, v12 quad_perm:[1,0,3,2] row_mask:0xf bank_mask:0xf
    v_add_f32_dpp v13, v13, v13 quad_perm:[1,0,3,2] row_mask:0xf bank_mask:0xf
    v_add_f32_dpp v16, v16, v16 quad_perm:[1,0,3,2] row_mask:0xf bank_mask:0xf
    v_add_f32_dpp v12, v12, v12 quad_perm:[2,3,0,1] row_mask:0xf bank_mask:0xf
    v_add_f32_dpp v13, v13, v13 quad_perm:[2,3,0,1] row_mask:0xf bank_mask:0xf
    v_add_f32_dpp v16, v16, v16 quad_perm:[2,3,0,1] row_mask:0xf bank_mask:0xf
    s_waitcnt vmcnt(3)
    s_bitcmp0_b32 s14, 9
    s_cbranch_scc1 L_sf_68
    s_waitcnt vmcnt(2)
    s_bitcmp0_b32 s15, 9
    s_cbranch_scc1 L_sf_68
    s_waitcnt vmcnt(1)
L_sf_68:
    buffer_load_dwordx4 v[76:79], v1, s[52:55], s97 offen offset:1024 nt
    v_dot2_f32_bf16 v8, v120, v4, 0
    v_dot2_f32_bf16 v9, v124, v4, 0
    v_dot2_f32_bf16 v10, v128, v4, 0
    v_dot2_f32_bf16 v11, v132, v4, 0
    v_dot2_f32_bf16 v24, v136, v4, 0
    v_dot2_f32_bf16 v25, v140, v4, 0
    v_dot2_f32_bf16 v26, v144, v4, 0
    v_dot2_f32_bf16 v27, v148, v4, 0
    v_dot2_f32_bf16 v8, v121, v5, v8
    v_dot2_f32_bf16 v9, v125, v5, v9
    v_dot2_f32_bf16 v10, v129, v5, v10
    v_dot2_f32_bf16 v11, v133, v5, v11
    v_dot2_f32_bf16 v24, v137, v5, v24
    v_dot2_f32_bf16 v25, v141, v5, v25
    v_dot2_f32_bf16 v26, v145, v5, v26
    v_dot2_f32_bf16 v27, v149, v5, v27
    v_dot2_f32_bf16 v8, v122, v6, v8
    v_dot2_f32_bf16 v9, v126, v6, v9
    v_dot2_f32_bf16 v10, v130, v6, v10
    v_dot2_f32_bf16 v11, v134, v6, v11
    v_dot2_f32_bf16 v24, v138, v6, v24
    v_dot2_f32_bf16 v25, v142, v6, v25
    v_dot2_f32_bf16 v26, v146, v6, v26
    v_dot2_f32_bf16 v27, v150, v6, v27
    v_dot2_f32_bf16 v8, v123, v7, v8
    v_dot2_f32_bf16 v9, v127, v7, v9
    v_dot2_f32_bf16 v10, v131, v7, v10
    v_dot2_f32_bf16 v11, v135, v7, v11
    v_dot2_f32_bf16 v24, v139, v7, v24
    v_dot2_f32_bf16 v25, v143, v7, v25
    v_dot2_f32_bf16 v26, v147, v7, v26
    v_dot2_f32_bf16 v27, v151, v7, v27
    v_add_f32_dpp v8, v8, v8 row_ror:8 row_mask:0xf bank_mask:0x3
    v_add_f32_dpp v10, v10, v10 row_ror:8 row_mask:0xf bank_mask:0x3
    v_add_f32_dpp v24, v24, v24 row_ror:8 row_mask:0xf bank_mask:0x3
    v_add_f32_dpp v26, v26, v26 row_ror:8 row_mask:0xf bank_mask:0x3
    v_add_f32_dpp v8, v9, v9 row_ror:8 row_mask:0xf bank_mask:0xc
    v_add_f32_dpp v10, v11, v11 row_ror:8 row_mask:0xf bank_mask:0xc
    v_add_f32_dpp v24, v25, v25 row_ror:8 row_mask:0xf bank_mask:0xc
    v_add_f32_dpp v26, v27, v27 row_ror:8 row_mask:0xf bank_mask:0xc
    v_add_f32_dpp v17, v8, v8 row_half_mirror row_mask:0xf bank_mask:0x5
    v_add_f32_dpp v18, v24, v24 row_half_mirror row_mask:0xf bank_mask:0x5
    v_add_f32_dpp v17, v10, v10 row_half_mirror row_mask:0xf bank_mask:0xa
    v_add_f32_dpp v18, v26, v26 row_half_mirror row_mask:0xf bank_mask:0xa
    s_nop 0
    v_add_f32_dpp v17, v17, v17 quad_perm:[1,0,3,2] row_mask:0xf bank_mask:0xf
    v_add_f32_dpp v18, v18, v18 quad_perm:[1,0,3,2] row_mask:0xf bank_mask:0xf
    s_nop 0
    v_add_f32_dpp v17, v17, v17 quad_perm:[2,3,0,1] row_mask:0xf bank_mask:0xf
    v_add_f32_dpp v18, v18, v18 quad_perm:[2,3,0,1] row_mask:0xf bank_mask:0xf
    s_waitcnt vmcnt(3)
    s_bitcmp0_b32 s14, 10
    s_cbranch_scc1 L_sf_69
    s_waitcnt vmcnt(2)
    s_bitcmp0_b32 s15, 10
    s_cbranch_scc1 L_sf_69
    s_waitcnt vmcnt(1)
L_sf_69:
    buffer_load_dwordx4 v[80:83], v1, s[52:55], s97 offen offset:2048 nt
    s_waitcnt vmcnt(3)
    s_bitcmp0_b32 s14, 11
    s_cbranch_scc1 L_sf_70
    s_waitcnt vmcnt(2)
    s_bitcmp0_b32 s15, 11
    s_cbranch_scc1 L_sf_70
    s_waitcnt vmcnt(1)
L_sf_70:
    buffer_load_dwordx4 v[84:87], v1, s[52:55], s97 offen offset:3072 nt
    s_add_u32 s97, s97, 32768
    v_add_u32 v1, 4096, v1
    v_and_b32 v1, 0x7fff, v1
    s_cmp_eq_u32 s12, -1
    s_cbranch_scc1 L_nopfrd
    v_lshl_add_u32 v38, v0, 4, s12
    ds_read_b128 v[40:43], v38 offset:0
    ds_read_b128 v[44:47], v38 offset:1024
    ds_read_b128 v[48:51], v38 offset:2048
    ds_read_b128 v[52:55], v38 offset:3072
    ds_read_b128 v[56:59], v38 offset:4096
    ds_read_b128 v[60:63], v38 offset:5120
    ds_read_b128 v[64:67], v38 offset:6144
    ds_read_b128 v[68:71], v38 offset:7168
L_nopfrd:
    v_dot2_f32_bf16 v8, v152, v4, 0
    v_dot2_f32_bf16 v9, v156, v4, 0
    v_dot2_f32_bf16 v10, v160, v4, 0
    v_dot2_f32_bf16 v11, v164, v4, 0
    v_dot2_f32_bf16 v8, v153, v5, v8
    v_dot2_f32_bf16 v9, v157, v5, v9
    v_dot2_f32_bf16 v10, v161, v5, v10
    v_dot2_f32_bf16 v11, v165, v5, v11
    v_dot2_f32_bf16 v8, v154, v6, v8
    v_dot2_f32_bf16 v9, v158, v6, v9
    v_dot2_f32_bf16 v10, v162, v6, v10
    v_dot2_f32_bf16 v11, v166, v6, v11
    v_dot2_f32_bf16 v8, v155, v7, v8
    v_dot2_f32_bf16 v9, v159, v7, v9
    v_dot2_f32_bf16 v10, v163, v7, v10
    v_dot2_f32_bf16 v11, v167, v7, v11
    v_add_f32_dpp v8, v8, v8 row_ror:8 row_mask:0xf bank_mask:0x3
    s_nop 0
    v_add_f32_dpp v10, v10, v10 row_ror:8 row_mask:0xf bank_mask:0x3
    v_add_f32_dpp v8, v9, v9 row_ror:8 row_mask:0xf bank_mask:0xc
    v_add_f32_dpp v10, v11, v11 row_ror:8 row_mask:0xf bank_mask:0xc
    s_nop 0
    v_add_f32_dpp v19, v8, v8 row_half_mirror row_mask:0xf bank_mask:0x5
    v_add_f32_dpp v19, v10, v10 row_half_mirror row_mask:0xf bank_mask:0xa
    s_nop 1
    v_add_f32_dpp v19, v19, v19 quad_perm:[1,0,3,2] row_mask:0xf bank_mask:0xf
    s_nop 1
    v_add_f32_dpp v19, v19, v19 quad_perm:[2,3,0,1] row_mask:0xf bank_mask:0xf
    v_max3_f32 v3, v12, v13, v14
    v_max3_f32 v8, v15, v16, v17
    v_max3_f32 v3, v3, v18, v19
    v_max_f32 v3, v3, v8
    s_nop 1
    v_max_f32_dpp v3, v3, v3 row_ror:4 row_mask:0xf bank_mask:0xf
    s_nop 1
    v_max_f32_dpp v3, v3, v3 row_ror:8 row_mask:0xf bank_mask:0xf
    v_mov_b32 v8, v3
    s_nop 1
    v_permlane16_swap_b32 v3, v8
    v_max_f32 v3, v3, v8
    v_mov_b32 v8, v3
    s_nop 1
    v_permlane32_swap_b32 v3, v8
    v_max_f32 v3, v3, v8
    s_mov_b32 s96, 0x3e0293ee
    v_mul_f32 v8, s96, v3
    v_fma_f32 v12, v12, s96, -v8
    v_fma_f32 v13, v13, s96, -v8
    v_fma_f32 v14, v14, s96, -v8
    v_fma_f32 v15, v15, s96, -v8
    v_fma_f32 v16, v16, s96, -v8
    v_fma_f32 v17, v17, s96, -v8
    v_fma_f32 v18, v18, s96, -v8
    v_fma_f32 v19, v19, s96, -v8
    v_exp_f32 v12, v12
    v_exp_f32 v13, v13
    v_exp_f32 v14, v14
    v_exp_f32 v15, v15
    v_exp_f32 v16, v16
    v_exp_f32 v17, v17
    v_exp_f32 v18, v18
    v_exp_f32 v19, v19
    v_add_f32 v9, v12, v13
    v_add_f32 v10, v14, v15
    v_add_f32 v11, v16, v17
    v_add_f32 v3, v18, v19
    v_add_f32 v9, v9, v10
    v_add_f32 v3, v3, v11
    v_add_f32 v9, v9, v3
    v_cvt_pk_bf16_f32 v12, v12, v12
    v_cvt_pk_bf16_f32 v13, v13, v13
    v_cvt_pk_bf16_f32 v14, v14, v14
    v_cvt_pk_bf16_f32 v15, v15, v15
    v_cvt_pk_bf16_f32 v16, v16, v16
    v_cvt_pk_bf16_f32 v17, v17, v17
    v_cvt_pk_bf16_f32 v18, v18, v18
    v_cvt_pk_bf16_f32 v19, v19, v19
    v_add_f32_dpp v9, v9, v9 row_ror:4 row_mask:0xf bank_mask:0xf
    s_nop 1
    v_add_f32_dpp v9, v9, v9 row_ror:8 row_mask:0xf bank_mask:0xf
    v_mov_b32 v10, v9
    s_nop 1
    v_permlane16_swap_b32 v9, v10
    v_add_f32 v9, v9, v10
    v_mov_b32 v10, v9
    s_nop 1
    v_permlane32_swap_b32 v9, v10
    v_add_f32 v9, v9, v10
    s_mov_b64 exec, 1
    s_cmp_lg_u32 s13, 0
    s_cbranch_scc1 L_mljob
    s_lshl_b32 s96, s3, 3
    s_add_u32 s96, s96, 161920
    v_mov_b32 v10, s96
    v_mov_b32 v11, 162068
    v_mov_b32 v3, 1
    ds_write_b64 v10, v[8:9]
    ds_add_u32 v11, v3
L_mldone:
    s_mov_b64 exec, -1
    v_lshrrev_b32 v2, 1, v2
    v_and_b32_dpp v24, v14, v20 row_newbcast:0 row_mask:0xf bank_mask:0xf
    v_and_b32_dpp v25, v14, v21 row_newbcast:0 row_mask:0xf bank_mask:0xf
    v_and_b32_dpp v26, v14, v22 row_newbcast:0 row_mask:0xf bank_mask:0xf
    v_and_b32_dpp v27, v14, v23 row_newbcast:0 row_mask:0xf bank_mask:0xf
    s_waitcnt vmcnt(3)
    s_bitcmp0_b32 s14, 12
    s_cbranch_scc1 L_sf_71
    s_waitcnt vmcnt(2)
    s_bitcmp0_b32 s15, 12
    s_cbranch_scc1 L_sf_71
    s_waitcnt vmcnt(1)
L_sf_71:
    buffer_load_dwordx4 v[88:91], v1, s[52:55], s97 offen offset:0 nt
    v_mfma_f32_16x16x32_bf16 v[32:35], v[24:27], v[72:75], v[32:35]
    s_cmp_eq_u32 s12, -1
    s_cbranch_scc1 L_nopfpv8
    s_waitcnt lgkmcnt(0)
    v_and_b32_dpp v24, v12, v20 row_newbcast:0 row_mask:0xf bank_mask:0xf
    v_and_b32_dpp v25, v12, v21 row_newbcast:0 row_mask:0xf bank_mask:0xf
    v_and_b32_dpp v26, v12, v22 row_newbcast:0 row_mask:0xf bank_mask:0xf
    v_and_b32_dpp v27, v12, v23 row_newbcast:0 row_mask:0xf bank_mask:0xf
    s_nop 1
    v_mfma_f32_16x16x32_bf16 v[32:35], v[24:27], v[40:43], v[32:35]
    v_and_b32_dpp v28, v12, v20 row_newbcast:8 row_mask:0xf bank_mask:0xf
    v_and_b32_dpp v29, v12, v21 row_newbcast:8 row_mask:0xf bank_mask:0xf
    v_and_b32_dpp v30, v12, v22 row_newbcast:8 row_mask:0xf bank_mask:0xf
    v_and_b32_dpp v31, v12, v23 row_newbcast:8 row_mask:0xf bank_mask:0xf
    s_nop 1
    v_mfma_f32_16x16x32_bf16 v[32:35], v[28:31], v[44:47], v[32:35]
    v_and_b32_dpp v24, v12, v20 row_newbcast:4 row_mask:0xf bank_mask:0xf
    v_and_b32_dpp v25, v12, v21 row_newbcast:4 row_mask:0xf bank_mask:0xf
    v_and_b32_dpp v26, v12, v22 row_newbcast:4 row_mask:0xf bank_mask:0xf
    v_and_b32_dpp v27, v12, v23 row_newbcast:4 row_mask:0xf bank_mask:0xf
    s_nop 1
    v_mfma_f32_16x16x32_bf16 v[32:35], v[24:27], v[48:51], v[32:35]
    v_and_b32_dpp v28, v12, v20 row_newbcast:12 row_mask:0xf bank_mask:0xf
    v_and_b32_dpp v29, v12, v21 row_newbcast:12 row_mask:0xf bank_mask:0xf
    v_and_b32_dpp v30, v12, v22 row_newbcast:12 row_mask:0xf bank_mask:0xf
    v_and_b32_dpp v31, v12, v23 row_newbcast:12 row_mask:0xf bank_mask:0xf
    s_nop 1
    v_mfma_f32_16x16x32_bf16 v[32:35], v[28:31], v[52:55], v[32:35]
L_nopfpv8:
    v_and_b32_dpp v28, v14, v20 row_newbcast:8 row_mask:0xf bank_mask:0xf
    v_and_b32_dpp v29, v14, v21 row_newbcast:8 row_mask:0xf bank_mask:0xf
    v_and_b32_dpp v30, v14, v22 row_newbcast:8 row_mask:0xf bank_mask:0xf
    v_and_b32_dpp v31, v14, v23 row_newbcast:8 row_mask:0xf bank_mask:0xf
    s_waitcnt vmcnt(3)
    s_bitcmp0_b32 s14, 13
    s_cbranch_scc1 L_sf_72
    s_waitcnt vmcnt(2)
    s_bitcmp0_b32 s15, 13
    s_cbranch_scc1 L_sf_72
    s_waitcnt vmcnt(1)
L_sf_72:
    buffer_load_dwordx4 v[92:95], v1, s[52:55], s97 offen offset:1024 nt
    v_mfma_f32_16x16x32_bf16 v[32:35], v[28:31], v[76:79], v[32:35]
    s_cmp_eq_u32 s12, -1
    s_cbranch_scc1 L_nopfpv9
    s_waitcnt lgkmcnt(0)
    v_and_b32_dpp v24, v13, v20 row_newbcast:0 row_mask:0xf bank_mask:0xf
    v_and_b32_dpp v25, v13, v21 row_newbcast:0 row_mask:0xf bank_mask:0xf
    v_and_b32_dpp v26, v13, v22 row_newbcast:0 row_mask:0xf bank_mask:0xf
    v_and_b32_dpp v27, v13, v23 row_newbcast:0 row_mask:0xf bank_mask:0xf
    s_nop 1
    v_mfma_f32_16x16x32_bf16 v[32:35], v[24:27], v[56:59], v[32:35]
    v_and_b32_dpp v28, v13, v20 row_newbcast:8 row_mask:0xf bank_mask:0xf
    v_and_b32_dpp v29, v13, v21 row_newbcast:8 row_mask:0xf bank_mask:0xf
    v_and_b32_dpp v30, v13, v22 row_newbcast:8 row_mask:0xf bank_mask:0xf
    v_and_b32_dpp v31, v13, v23 row_newbcast:8 row_mask:0xf bank_mask:0xf
    s_nop 1
    v_mfma_f32_16x16x32_bf16 v[32:35], v[28:31], v[60:63], v[32:35]
    v_and_b32_dpp v24, v13, v20 row_newbcast:4 row_mask:0xf bank_mask:0xf
    v_and_b32_dpp v25, v13, v21 row_newbcast:4 row_mask:0xf bank_mask:0xf
    v_and_b32_dpp v26, v13, v22 row_newbcast:4 row_mask:0xf bank_mask:0xf
    v_and_b32_dpp v27, v13, v23 row_newbcast:4 row_mask:0xf bank_mask:0xf
    s_nop 1
    v_mfma_f32_16x16x32_bf16 v[32:35], v[24:27], v[64:67], v[32:35]
    v_and_b32_dpp v28, v13, v20 row_newbcast:12 row_mask:0xf bank_mask:0xf
    v_and_b32_dpp v29, v13, v21 row_newbcast:12 row_mask:0xf bank_mask:0xf
    v_and_b32_dpp v30, v13, v22 row_newbcast:12 row_mask:0xf bank_mask:0xf
    v_and_b32_dpp v31, v13, v23 row_newbcast:12 row_mask:0xf bank_mask:0xf
    s_nop 1
    v_mfma_f32_16x16x32_bf16 v[32:35], v[28:31], v[68:71], v[32:35]
L_nopfpv9:
    v_and_b32_dpp v24, v14, v20 row_newbcast:4 row_mask:0xf bank_mask:0xf
    v_and_b32_dpp v25, v14, v21 row_newbcast:4 row_mask:0xf bank_mask:0xf
    v_and_b32_dpp v26, v14, v22 row_newbcast:4 row_mask:0xf bank_mask:0xf
    v_and_b32_dpp v27, v14, v23 row_newbcast:4 row_mask:0xf bank_mask:0xf
    s_waitcnt vmcnt(3)
    s_bitcmp0_b32 s14, 14
    s_cbranch_scc1 L_sf_73
    s_waitcnt vmcnt(2)
    s_bitcmp0_b32 s15, 14
    s_cbranch_scc1 L_sf_73
    s_waitcnt vmcnt(1)
L_sf_73:
    buffer_load_dwordx4 v[96:99], v1, s[52:55], s97 offen offset:2048 nt
    v_mfma_f32_16x16x32_bf16 v[32:35], v[24:27], v[80:83], v[32:35]
    v_and_b32_dpp v28, v14, v20 row_newbcast:12 row_mask:0xf bank_mask:0xf
    v_and_b32_dpp v29, v14, v21 row_newbcast:12 row_mask:0xf bank_mask:0xf
    v_and_b32_dpp v30, v14, v22 row_newbcast:12 row_mask:0xf bank_mask:0xf
    v_and_b32_dpp v31, v14, v23 row_newbcast:12 row_mask:0xf bank_mask:0xf
    s_waitcnt vmcnt(3)
    s_bitcmp0_b32 s14, 15
    s_cbranch_scc1 L_sf_74
    s_waitcnt vmcnt(2)
    s_bitcmp0_b32 s15, 15
    s_cbranch_scc1 L_sf_74
    s_waitcnt vmcnt(1)
L_sf_74:
    buffer_load_dwordx4 v[100:103], v1, s[52:55], s97 offen offset:3072 nt
    s_add_u32 s97, s97, 32768
    v_add_u32 v1, 4096, v1
    v_and_b32 v1, 0x7fff, v1
    v_mfma_f32_16x16x32_bf16 v[32:35], v[28:31], v[84:87], v[32:35]
    v_and_b32_dpp v24, v15, v20 row_newbcast:0 row_mask:0xf bank_mask:0xf
    v_and_b32_dpp v25, v15, v21 row_newbcast:0 row_mask:0xf bank_mask:0xf
    v_and_b32_dpp v26, v15, v22 row_newbcast:0 row_mask:0xf bank_mask:0xf
    v_and_b32_dpp v27, v15, v23 row_newbcast:0 row_mask:0xf bank_mask:0xf
    s_waitcnt vmcnt(3)
    s_bitcmp0_b32 s14, 16
    s_cbranch_scc1 L_sf_75
    s_waitcnt vmcnt(2)
    s_bitcmp0_b32 s15, 16
    s_cbranch_scc1 L_sf_75
    s_waitcnt vmcnt(1)
L_sf_75:
    buffer_load_dwordx4 v[104:107], v1, s[52:55], s97 offen offset:0 nt
    v_mfma_f32_16x16x32_bf16 v[32:35], v[24:27], v[88:91], v[32:35]
    v_and_b32_dpp v28, v15, v20 row_newbcast:8 row_mask:0xf bank_mask:0xf
    v_and_b32_dpp v29, v15, v21 row_newbcast:8 row_mask:0xf bank_mask:0xf
    v_and_b32_dpp v30, v15, v22 row_newbcast:8 row_mask:0xf bank_mask:0xf
    v_and_b32_dpp v31, v15, v23 row_newbcast:8 row_mask:0xf bank_mask:0xf
    s_waitcnt vmcnt(3)
    s_bitcmp0_b32 s14, 17
    s_cbranch_scc1 L_sf_76
    s_waitcnt vmcnt(2)
    s_bitcmp0_b32 s15, 17
    s_cbranch_scc1 L_sf_76
    s_waitcnt vmcnt(1)
L_sf_76:
    buffer_load_dwordx4 v[108:111], v1, s[52:55], s97 offen offset:1024 nt
    v_mfma_f32_16x16x32_bf16 v[32:35], v[28:31], v[92:95], v[32:35]
    v_and_b32_dpp v24, v15, v20 row_newbcast:4 row_mask:0xf bank_mask:0xf
    v_and_b32_dpp v25, v15, v21 row_newbcast:4 row_mask:0xf bank_mask:0xf
    v_and_b32_dpp v26, v15, v22 row_newbcast:4 row_mask:0xf bank_mask:0xf
    v_and_b32_dpp v27, v15, v23 row_newbcast:4 row_mask:0xf bank_mask:0xf
    s_waitcnt vmcnt(3)
    s_bitcmp0_b32 s14, 18
    s_cbranch_scc1 L_sf_77
    s_waitcnt vmcnt(2)
    s_bitcmp0_b32 s15, 18
    s_cbranch_scc1 L_sf_77
    s_waitcnt vmcnt(1)
L_sf_77:
    buffer_load_dwordx4 v[112:115], v1, s[52:55], s97 offen offset:2048 nt
    v_mfma_f32_16x16x32_bf16 v[32:35], v[24:27], v[96:99], v[32:35]
    v_and_b32_dpp v28, v15, v20 row_newbcast:12 row_mask:0xf bank_mask:0xf
    v_and_b32_dpp v29, v15, v21 row_newbcast:12 row_mask:0xf bank_mask:0xf
    v_and_b32_dpp v30, v15, v22 row_newbcast:12 row_mask:0xf bank_mask:0xf
    v_and_b32_dpp v31, v15, v23 row_newbcast:12 row_mask:0xf bank_mask:0xf
    s_waitcnt vmcnt(3)
    s_bitcmp0_b32 s14, 19
    s_cbranch_scc1 L_sf_78
    s_waitcnt vmcnt(2)
    s_bitcmp0_b32 s15, 19
    s_cbranch_scc1 L_sf_78
    s_waitcnt vmcnt(1)
L_sf_78:
    buffer_load_dwordx4 v[116:119], v1, s[52:55], s97 offen offset:3072 nt
    s_add_u32 s97, s97, 32768
    v_add_u32 v1, 4096, v1
    v_and_b32 v1, 0x7fff, v1
    v_mfma_f32_16x16x32_bf16 v[32:35], v[28:31], v[100:103], v[32:35]
    v_and_b32_dpp v24, v16, v20 row_newbcast:0 row_mask:0xf bank_mask:0xf
    v_and_b32_dpp v25, v16, v21 row_newbcast:0 row_mask:0xf bank_mask:0xf
    v_and_b32_dpp v26, v16, v22 row_newbcast:0 row_mask:0xf bank_mask:0xf
    v_and_b32_dpp v27, v16, v23 row_newbcast:0 row_mask:0xf bank_mask:0xf
    s_waitcnt vmcnt(3)
    s_bitcmp0_b32 s14, 20
    s_cbranch_scc1 L_sf_79
    s_waitcnt vmcnt(2)
    s_bitcmp0_b32 s15, 20
    s_cbranch_scc1 L_sf_79
    s_waitcnt vmcnt(1)
L_sf_79:
    buffer_load_dwordx4 v[120:123], v1, s[52:55], s97 offen offset:0 nt
    v_mfma_f32_16x16x32_bf16 v[32:35], v[24:27], v[104:107], v[32:35]
    v_and_b32_dpp v28, v16, v20 row_newbcast:8 row_mask:0xf bank_mask:0xf
    v_and_b32_dpp v29, v16, v21 row_newbcast:8 row_mask:0xf bank_mask:0xf
    v_and_b32_dpp v30, v16, v22 row_newbcast:8 row_mask:0xf bank_mask:0xf
    v_and_b32_dpp v31, v16, v23 row_newbcast:8 row_mask:0xf bank_mask:0xf
    s_waitcnt vmcnt(3)
    s_bitcmp0_b32 s14, 21
    s_cbranch_scc1 L_sf_80
    s_waitcnt vmcnt(2)
    s_bitcmp0_b32 s15, 21
    s_cbranch_scc1 L_sf_80
    s_waitcnt vmcnt(1)
L_sf_80:
    buffer_load_dwordx4 v[124:127], v1, s[52:55], s97 offen offset:1024 nt
    v_mfma_f32_16x16x32_bf16 v[32:35], v[28:31], v[108:111], v[32:35]
    v_and_b32_dpp v24, v16, v20 row_newbcast:4 row_mask:0xf bank_mask:0xf
    v_and_b32_dpp v25, v16, v21 row_newbcast:4 row_mask:0xf bank_mask:0xf
    v_and_b32_dpp v26, v16, v22 row_newbcast:4 row_mask:0xf bank_mask:0xf
    v_and_b32_dpp v27, v16, v23 row_newbcast:4 row_mask:0xf bank_mask:0xf
    s_waitcnt vmcnt(3)
    s_bitcmp0_b32 s14, 22
    s_cbranch_scc1 L_sf_81
    s_waitcnt vmcnt(2)
    s_bitcmp0_b32 s15, 22
    s_cbranch_scc1 L_sf_81
    s_waitcnt vmcnt(1)
L_sf_81:
    buffer_load_dwordx4 v[128:131], v1, s[52:55], s97 offen offset:2048 nt
    v_mfma_f32_16x16x32_bf16 v[32:35], v[24:27], v[112:115], v[32:35]
    v_and_b32_dpp v28, v16, v20 row_newbcast:12 row_mask:0xf bank_mask:0xf
    v_and_b32_dpp v29, v16, v21 row_newbcast:12 row_mask:0xf bank_mask:0xf
    v_and_b32_dpp v30, v16, v22 row_newbcast:12 row_mask:0xf bank_mask:0xf
    v_and_b32_dpp v31, v16, v23 row_newbcast:12 row_mask:0xf bank_mask:0xf
    s_waitcnt vmcnt(3)
    s_bitcmp0_b32 s14, 23
    s_cbranch_scc1 L_sf_82
    s_waitcnt vmcnt(2)
    s_bitcmp0_b32 s15, 23
    s_cbranch_scc1 L_sf_82
    s_waitcnt vmcnt(1)
L_sf_82:
    buffer_load_dwordx4 v[132:135], v1, s[52:55], s97 offen offset:3072 nt
    s_add_u32 s97, s97, 32768
    v_add_u32 v1, 4096, v1
    v_and_b32 v1, 0x7fff, v1
    v_mfma_f32_16x16x32_bf16 v[32:35], v[28:31], v[116:119], v[32:35]
    v_and_b32_dpp v24, v17, v20 row_newbcast:0 row_mask:0xf bank_mask:0xf
    v_and_b32_dpp v25, v17, v21 row_newbcast:0 row_mask:0xf bank_mask:0xf
    v_and_b32_dpp v26, v17, v22 row_newbcast:0 row_mask:0xf bank_mask:0xf
    v_and_b32_dpp v27, v17, v23 row_newbcast:0 row_mask:0xf bank_mask:0xf
    s_waitcnt vmcnt(3)
    s_bitcmp0_b32 s14, 24
    s_cbranch_scc1 L_sf_83
    s_waitcnt vmcnt(2)
    s_bitcmp0_b32 s15, 24
    s_cbranch_scc1 L_sf_83
    s_waitcnt vmcnt(1)
L_sf_83:
    buffer_load_dwordx4 v[136:139], v1, s[52:55], s97 offen offset:0 nt
    v_mfma_f32_16x16x32_bf16 v[32:35], v[24:27], v[120:123], v[32:35]
    s_or_b32 s96, s59, 0
    s_cbranch_scc0 L_nofrag_84
    v_mov_b32 v104, 162060
L_lw_85:
    ds_read_b32 v105, v104
    s_waitcnt lgkmcnt(0)
    v_cmp_gt_u32 vcc, 4, v105
    s_cbranch_vccz L_lw_85e
    s_sleep 2
    s_sub_u32 s60, s60, 1
    s_cbranch_scc0 L_lw_85
    s_mov_b32 s60, 0
L_lw_85e:
    s_cmp_eq_u32 s59, 0
    s_cbranch_scc1 L_nofrag_84
    v_bfe_u32 v104, v0, 2, 1
    v_bfe_u32 v110, v0, 4, 1
    v_lshl_add_u32 v104, v110, 2, v104
    v_and_b32 v110, 8, v0
    v_add_u32 v104, v104, v110
    v_lshrrev_b32 v110, 5, v0
    v_lshl_add_u32 v104, v110, 4, v104
    v_bfe_u32 v111, v0, 0, 1
    v_mul_u32_u24 v111, 0xaaaa, v111
    v_add_u32 v111, 0x4444, v111
    v_mov_b32 v112, 0
    v_mov_b32 v113, 0
    v_mov_b32 v114, 0
    v_mov_b32 v115, 0
    v_mov_b32 v116, 0
    v_mov_b32 v117, 0
    v_mov_b32 v118, 0
    v_mov_b32 v119, 0
    v_lshlrev_b32 v104, 7, v104
    v_and_b32 v110, 3, v0
    v_lshl_add_u32 v104, v110, 3, v104
    v_lshrrev_b32 v109, 4, v0
    v_and_b32 v110, 1, v0
    s_lshr_b32 s63, s3, 1
    s_and_b32 s62, s3, 1
    s_lshl_b32 s96, s63, 14
    s_lshl_b32 s100, s62, 6
    s_add_u32 s100, s100, 81920
    s_add_u32 s96, s96, s100
    v_add_u32 v104, s96, v104
    ds_read_b64_tr_b16 v[72:73], v104 offset:0
    ds_read_b64_tr_b16 v[74:75], v104 offset:256
    ds_read_b64_tr_b16 v[76:77], v104 offset:4096
    ds_read_b64_tr_b16 v[78:79], v104 offset:4352
    ds_read_b64_tr_b16 v[80:81], v104 offset:32
    ds_read_b64_tr_b16 v[82:83], v104 offset:288
    ds_read_b64_tr_b16 v[84:85], v104 offset:4128
    ds_read_b64_tr_b16 v[86:87], v104 offset:4384
    ds_read_b64_tr_b16 v[88:89], v104 offset:8192
    ds_read_b64_tr_b16 v[90:91], v104 offset:8448
    ds_read_b64_tr_b16 v[92:93], v104 offset:12288
    ds_read_b64_tr_b16 v[94:95], v104 offset:12544
    ds_read_b64_tr_b16 v[96:97], v104 offset:8224
    ds_read_b64_tr_b16 v[98:99], v104 offset:8480
    ds_read_b64_tr_b16 v[100:101], v104 offset:12320
    ds_read_b64_tr_b16 v[102:103], v104 offset:12576
    v_bfe_u32 v105, v0, 1, 3
    v_lshlrev_b32 v105, 8, v105
    v_lshl_add_u32 v105, v109, 5, v105
    v_lshl_add_u32 v105, v110, 4, v105
    v_lshrrev_b32 v106, 3, v0
    v_lshlrev_b32 v106, 7, v106
    v_and_b32 v110, 7, v0
    v_lshl_add_u32 v107, v110, 3, v106
    v_add_u32 v107, s100, v107
    v_lshlrev_b32 v106, 8, v109
    v_and_b32 v110, 15, v0
    v_lshl_add_u32 v106, v110, 2, v106
    v_add_u32 v106, s96, v106
    v_lshlrev_b32 v108, 2, v0
    s_lshl_b32 s96, s62, 2
    s_add_u32 s96, s96, 162088
    v_mov_b32 v109, s96
    s_lshl_b32 s100, s63, 11
    s_lshl_b32 s96, s34, 13
    s_add_u32 s100, s100, s96
    s_add_u32 s100, s100, 106496
    s_mul_i32 s101, s34, 5120
    s_lshl_b32 s96, s35, 9
    s_add_u32 s101, s101, s96
    s_lshl_b32 s96, s62, 8
    s_add_u32 s101, s101, s96
    s_sub_u32 s101, s101, 11264
    s_and_b32 s96, s101, 0xffffe000
    s_add_u32 s101, s101, s96
    s_add_u32 s101, s101, 212992
    v_add_u32 v110, 8192, v108
L_nofrag_84:
    v_and_b32_dpp v28, v17, v20 row_newbcast:8 row_mask:0xf bank_mask:0xf
    v_and_b32_dpp v29, v17, v21 row_newbcast:8 row_mask:0xf bank_mask:0xf
    v_and_b32_dpp v30, v17, v22 row_newbcast:8 row_mask:0xf bank_mask:0xf
    v_and_b32_dpp v31, v17, v23 row_newbcast:8 row_mask:0xf bank_mask:0xf
    s_waitcnt vmcnt(3)
    s_bitcmp0_b32 s14, 25
    s_cbranch_scc1 L_sf_86
    s_waitcnt vmcnt(2)
    s_bitcmp0_b32 s15, 25
    s_cbranch_scc1 L_sf_86
    s_waitcnt vmcnt(1)
L_sf_86:
    buffer_load_dwordx4 v[140:143], v1, s[52:55], s97 offen offset:1024 nt
    v_mfma_f32_16x16x32_bf16 v[32:35], v[28:31], v[124:127], v[32:35]
    v_and_b32_dpp v24, v17, v20 row_newbcast:4 row_mask:0xf bank_mask:0xf
    v_and_b32_dpp v25, v17, v21 row_newbcast:4 row_mask:0xf bank_mask:0xf
    v_and_b32_dpp v26, v17, v22 row_newbcast:4 row_mask:0xf bank_mask:0xf
    v_and_b32_dpp v27, v17, v23 row_newbcast:4 row_mask:0xf bank_mask:0xf
    s_waitcnt vmcnt(3)
    s_bitcmp0_b32 s14, 26
    s_cbranch_scc1 L_sf_87
    s_waitcnt vmcnt(2)
    s_bitcmp0_b32 s15, 26
    s_cbranch_scc1 L_sf_87
    s_waitcnt vmcnt(1)
L_sf_87:
    buffer_load_dwordx4 v[144:147], v1, s[52:55], s97 offen offset:2048 nt
    v_mfma_f32_16x16x32_bf16 v[32:35], v[24:27], v[128:131], v[32:35]
    v_and_b32_dpp v28, v17, v20 row_newbcast:12 row_mask:0xf bank_mask:0xf
    v_and_b32_dpp v29, v17, v21 row_newbcast:12 row_mask:0xf bank_mask:0xf
    v_and_b32_dpp v30, v17, v22 row_newbcast:12 row_mask:0xf bank_mask:0xf
    v_and_b32_dpp v31, v17, v23 row_newbcast:12 row_mask:0xf bank_mask:0xf
    s_waitcnt vmcnt(3)
    s_bitcmp0_b32 s14, 27
    s_cbranch_scc1 L_sf_88
    s_waitcnt vmcnt(2)
    s_bitcmp0_b32 s15, 27
    s_cbranch_scc1 L_sf_88
    s_waitcnt vmcnt(1)
L_sf_88:
    buffer_load_dwordx4 v[148:151], v1, s[52:55], s97 offen offset:3072 nt
    s_add_u32 s97, s97, 32768
    v_add_u32 v1, 4096, v1
    v_and_b32 v1, 0x7fff, v1
    v_mfma_f32_16x16x32_bf16 v[32:35], v[28:31], v[132:135], v[32:35]
    v_and_b32_dpp v24, v18, v20 row_newbcast:0 row_mask:0xf bank_mask:0xf
    v_and_b32_dpp v25, v18, v21 row_newbcast:0 row_mask:0xf bank_mask:0xf
    v_and_b32_dpp v26, v18, v22 row_newbcast:0 row_mask:0xf bank_mask:0xf
    v_and_b32_dpp v27, v18, v23 row_newbcast:0 row_mask:0xf bank_mask:0xf
    s_waitcnt vmcnt(3)
    s_bitcmp0_b32 s14, 28
    s_cbranch_scc1 L_sf_89
    s_waitcnt vmcnt(2)
    s_bitcmp0_b32 s15, 28
    s_cbranch_scc1 L_sf_89
    s_waitcnt vmcnt(1)
L_sf_89:
    buffer_load_dwordx4 v[152:155], v1, s[52:55], s97 offen offset:0 nt
    v_mfma_f32_16x16x32_bf16 v[32:35], v[24:27], v[136:139], v[32:35]
    v_mov_b32 v10, 162076
    v_mov_b32 v11, 1
    s_mov_b64 exec, 1
    ds_add_u32 v10, v11
    s_mov_b64 exec, -1
    v_and_b32_dpp v28, v18, v20 row_newbcast:8 row_mask:0xf bank_mask:0xf
    v_and_b32_dpp v29, v18, v21 row_newbcast:8 row_mask:0xf bank_mask:0xf
    v_and_b32_dpp v30, v18, v22 row_newbcast:8 row_mask:0xf bank_mask:0xf
    v_and_b32_dpp v31, v18, v23 row_newbcast:8 row_mask:0xf bank_mask:0xf
    s_waitcnt vmcnt(3)
    s_bitcmp0_b32 s14, 29
    s_cbranch_scc1 L_sf_90
    s_waitcnt vmcnt(2)
    s_bitcmp0_b32 s15, 29
    s_cbranch_scc1 L_sf_90
    s_waitcnt vmcnt(1)
L_sf_90:
    buffer_load_dwordx4 v[156:159], v1, s[52:55], s97 offen offset:1024 nt
    v_mfma_f32_16x16x32_bf16 v[32:35], v[28:31], v[140:143], v[32:35]
    v_and_b32_dpp v24, v18, v20 row_newbcast:4 row_mask:0xf bank_mask:0xf
    v_and_b32_dpp v25, v18, v21 row_newbcast:4 row_mask:0xf bank_mask:0xf
    v_and_b32_dpp v26, v18, v22 row_newbcast:4 row_mask:0xf bank_mask:0xf
    v_and_b32_dpp v27, v18, v23 row_newbcast:4 row_mask:0xf bank_mask:0xf
    s_waitcnt vmcnt(3)
    s_bitcmp0_b32 s14, 30
    s_cbranch_scc1 L_sf_91
    s_waitcnt vmcnt(2)
    s_bitcmp0_b32 s15, 30
    s_cbranch_scc1 L_sf_91
    s_waitcnt vmcnt(1)
L_sf_91:
    buffer_load_dwordx4 v[160:163], v1, s[52:55], s97 offen offset:2048 nt
    v_mfma_f32_16x16x32_bf16 v[32:35], v[24:27], v[144:147], v[32:35]
    v_lshrrev_b32 v9, 4, v0
    v_lshl_add_u32 v8, v9, 2, v2
    s_lshl_b32 s96, s3, 9
    s_add_u32 s96, s96, 157824
    v_lshl_add_u32 v8, v8, 2, s96
    v_lshlrev_b32 v9, 3, v0
    v_add_u32 v9, 157824, v9
    v_mov_b32 v10, 162048
    v_mov_b32 v11, 1
    s_lshl_b32 s96, s38, 5
    s_add_u32 s96, s96, 161984
    v_mov_b32 v3, s96
    s_sub_u32 s62, 8, s39
    s_lshl_b32 s98, s34, 5
    s_add_u32 s98, s98, s35
    s_lshl_b32 s98, s98, 8
    s_add_u32 s98, s98, 106496
    v_lshlrev_b32 v39, 2, v0
    v_and_b32_dpp v28, v18, v20 row_newbcast:12 row_mask:0xf bank_mask:0xf
    v_and_b32_dpp v29, v18, v21 row_newbcast:12 row_mask:0xf bank_mask:0xf
    v_and_b32_dpp v30, v18, v22 row_newbcast:12 row_mask:0xf bank_mask:0xf
    v_and_b32_dpp v31, v18, v23 row_newbcast:12 row_mask:0xf bank_mask:0xf
    s_waitcnt vmcnt(3)
    s_bitcmp0_b32 s14, 31
    s_cbranch_scc1 L_sf_92
    s_waitcnt vmcnt(2)
    s_bitcmp0_b32 s15, 31
    s_cbranch_scc1 L_sf_92
    s_waitcnt vmcnt(1)
L_sf_92:
    buffer_load_dwordx4 v[164:167], v1, s[52:55], s97 offen offset:3072 nt
    s_mov_b32 s97, 0
    v_add_u32 v1, 4096, v1
    v_and_b32 v1, 0x7fff, v1
    v_mfma_f32_16x16x32_bf16 v[32:35], v[28:31], v[148:151], v[32:35]
    s_cmp_eq_u32 s12, -1
    s_cbranch_scc1 L_v_nopf
    v_and_b32_dpp v24, v19, v20 row_newbcast:0 row_mask:0xf bank_mask:0xf
    v_and_b32_dpp v25, v19, v21 row_newbcast:0 row_mask:0xf bank_mask:0xf
    v_and_b32_dpp v26, v19, v22 row_newbcast:0 row_mask:0xf bank_mask:0xf
    v_and_b32_dpp v27, v19, v23 row_newbcast:0 row_mask:0xf bank_mask:0xf
    s_waitcnt vmcnt(3)
    s_nop 0
    v_mfma_f32_16x16x32_bf16 v[32:35], v[24:27], v[152:155], v[32:35]
    v_and_b32_dpp v28, v19, v20 row_newbcast:8 row_mask:0xf bank_mask:0xf
    v_and_b32_dpp v29, v19, v21 row_newbcast:8 row_mask:0xf bank_mask:0xf
    v_and_b32_dpp v30, v19, v22 row_newbcast:8 row_mask:0xf bank_mask:0xf
    v_and_b32_dpp v31, v19, v23 row_newbcast:8 row_mask:0xf bank_mask:0xf
    s_waitcnt vmcnt(2)
    s_nop 0
    v_mfma_f32_16x16x32_bf16 v[32:35], v[28:31], v[156:159], v[32:35]
    v_and_b32_dpp v24, v19, v20 row_newbcast:4 row_mask:0xf bank_mask:0xf
    v_and_b32_dpp v25, v19, v21 row_newbcast:4 row_mask:0xf bank_mask:0xf
    v_and_b32_dpp v26, v19, v22 row_newbcast:4 row_mask:0xf bank_mask:0xf
    v_and_b32_dpp v27, v19, v23 row_newbcast:4 row_mask:0xf bank_mask:0xf
    s_waitcnt vmcnt(1)
    s_nop 0
    v_mfma_f32_16x16x32_bf16 v[32:35], v[24:27], v[160:163], v[32:35]
    v_and_b32_dpp v28, v19, v20 row_newbcast:12 row_mask:0xf bank_mask:0xf
    v_and_b32_dpp v29, v19, v21 row_newbcast:12 row_mask:0xf bank_mask:0xf
    v_and_b32_dpp v30, v19, v22 row_newbcast:12 row_mask:0xf bank_mask:0xf
    v_and_b32_dpp v31, v19, v23 row_newbcast:12 row_mask:0xf bank_mask:0xf
    s_waitcnt vmcnt(0)
    s_nop 0
    v_mfma_f32_16x16x32_bf16 v[32:35], v[28:31], v[164:167], v[32:35]
L_v_join:
    s_cmp_lg_u32 s13, 0
    s_cbranch_scc1 L_jobend
L_t0:
    s_mov_b32 exec_hi, 0
    s_nop 4
    ds_write_b128 v8, v[32:35]
L_t0b:
    s_mov_b64 exec, 1
    ds_add_rtn_u32 v37, v10, v11
    s_mov_b64 exec, -1
    ds_read_b32 v38, v10 offset:24
    ds_read_b128 v[24:27], v3
    ds_read_b128 v[28:31], v3 offset:16
    ds_read_b64 v[144:145], v9 offset:0
    ds_read_b64 v[146:147], v9 offset:512
    ds_read_b64 v[148:149], v9 offset:1024
    ds_read_b64 v[150:151], v9 offset:1536
    ds_read_b64 v[152:153], v9 offset:2048
    ds_read_b64 v[154:155], v9 offset:2560
    ds_read_b64 v[156:157], v9 offset:3072
    ds_read_b64 v[158:159], v9 offset:3584
    s_waitcnt lgkmcnt(10)
    v_readfirstlane_b32 s96, v37
    v_readfirstlane_b32 s61, v38
    s_cmp_lg_u32 s96, s62
    s_cbranch_scc1 L_nopub
    s_waitcnt lgkmcnt(6)
    v_pk_mul_f32 v[144:145], v[144:145], v[24:25] op_sel:[0,0] op_sel_hi:[1,0]
    v_pk_mul_f32 v[146:147], v[146:147], v[24:25] op_sel:[0,1] op_sel_hi:[1,1]
    s_waitcnt lgkmcnt(4)
    v_pk_fma_f32 v[144:145], v[148:149], v[26:27], v[144:145] op_sel:[0,0,0] op_sel_hi:[1,0,1]
    v_pk_fma_f32 v[146:147], v[150:151], v[26:27], v[146:147] op_sel:[0,1,0] op_sel_hi:[1,1,1]
    s_waitcnt lgkmcnt(2)
    v_pk_fma_f32 v[144:145], v[152:153], v[28:29], v[144:145] op_sel:[0,0,0] op_sel_hi:[1,0,1]
    v_pk_fma_f32 v[146:147], v[154:155], v[28:29], v[146:147] op_sel:[0,1,0] op_sel_hi:[1,1,1]
    s_waitcnt lgkmcnt(0)
    v_pk_fma_f32 v[144:145], v[156:157], v[30:31], v[144:145] op_sel:[0,0,0] op_sel_hi:[1,0,1]
    v_pk_fma_f32 v[146:147], v[158:159], v[30:31], v[146:147] op_sel:[0,1,0] op_sel_hi:[1,1,1]
    s_cmp_eq_u32 s61, 1
    v_pk_add_f32 v[144:145], v[144:145], v[146:147]
    v_cvt_pk_bf16_f32 v32, v144, v145
    s_cbranch_scc0 L_oslow
    buffer_store_dword v32, v39, s[40:43], s98 offen
L_odone:
L_nopub:
    s_cmp_eq_u32 s59, 0
    s_cbranch_scc1 L_not1
L_poll_101:
    buffer_load_dwordx4 v[16:19], v105, s[40:43], s100 offen sc1
    buffer_load_dwordx4 v[20:23], v105, s[40:43], s100 offen offset:128 sc1
    s_sub_u32 s60, s60, 1
    s_cbranch_scc1 L_poll_101t
    s_waitcnt vmcnt(0)
    v_max3_u32 v38, v16, v17, v18
    v_max3_u32 v38, v38, v19, v20
    v_max3_u32 v38, v38, v21, v22
    v_max_u32 v38, v38, v23
    v_cmp_eq_u32 vcc, -1, v38
    s_cbranch_vccnz L_poll_101
L_poll_101e:
    v_smfmac_f32_16x16x64_bf16 v[112:115], v[16:19], v[72:79], v111
    v_smfmac_f32_16x16x64_bf16 v[116:119], v[16:19], v[80:87], v111
    v_smfmac_f32_16x16x64_bf16 v[112:115], v[20:23], v[88:95], v111
    v_smfmac_f32_16x16x64_bf16 v[116:119], v[20:23], v[96:103], v111
    s_nop 6
    v_pk_add_f32 v[112:113], v[112:113], v[114:115]
    v_pk_add_f32 v[116:117], v[116:117], v[118:119]
    v_add_f32 v12, v112, v113
    v_add_f32 v13, v116, v117
    ds_write2_b32 v106, v12, v13 offset0:0 offset1:32
    s_mov_b64 exec, 1
    ds_add_rtn_u32 v37, v109, v11
    s_mov_b64 exec, -1
    ds_read_b64 v[72:73], v107 offset:0
    ds_read_b64 v[74:75], v107 offset:16384
    ds_read_b64 v[76:77], v107 offset:32768
    ds_read_b64 v[78:79], v107 offset:49152
    s_cmp_eq_u32 s34, 2
    s_cselect_b32 s97, s61, 0
    s_waitcnt lgkmcnt(4)
    v_readfirstlane_b32 s96, v37
    s_waitcnt lgkmcnt(2)
    v_pk_add_f32 v[72:73], v[72:73], v[74:75]
    s_cmp_lg_u32 s96, 3
    s_cbranch_scc1 L_not1
    s_cmp_eq_u32 s97, 1
    s_waitcnt lgkmcnt(0)
    v_pk_add_f32 v[76:77], v[76:77], v[78:79]
    v_pk_add_f32 v[72:73], v[72:73], v[76:77]
    v_cvt_pk_bf16_f32 v12, v72, v73
    s_cbranch_scc1 L_pfast
    buffer_store_dword v12, v108, s[40:43], s101 offen sc1
    buffer_store_dword v12, v110, s[40:43], s101 offen sc1
L_pdone:
L_not1:
    s_waitcnt lgkmcnt(0)
    s_cmp_eq_u32 s39, 1
    s_cbranch_scc1 L_s_role
    s_cmp_eq_u32 s34, 2
    s_cselect_b32 s62, s59, 0
    s_cmp_eq_u32 s62, 1
    s_cbranch_scc1 L_refetch
L_norf:
    s_endpgm
L_k_nopf:
    s_waitcnt vmcnt(3)
    s_bitcmp0_b32 s57, 22
    s_cbranch_scc1 L_sf_57
    s_waitcnt vmcnt(2)
    s_bitcmp0_b32 s58, 22
    s_cbranch_scc1 L_sf_57
    s_waitcnt vmcnt(1)
L_sf_57:
    buffer_load_dwordx4 v[128:131], v1, s[48:51], s97 offen offset:2048 nt
    v_min_u32 v39, 15, v0
    v_and_b32 v38, 1, v39
    v_mul_u32_u24 v38, 126, v38
    v_lshl_add_u32 v39, v39, 1, v38
    buffer_load_dword v37, v39, s[44:47], 0 offen sc1
    s_waitcnt vmcnt(4)
    s_bitcmp0_b32 s57, 23
    s_cbranch_scc1 L_sf_58
    s_waitcnt vmcnt(3)
    s_bitcmp0_b32 s58, 23
    s_cbranch_scc1 L_sf_58
    s_waitcnt vmcnt(2)
L_sf_58:
    buffer_load_dwordx4 v[132:135], v1, s[48:51], s97 offen offset:3072 nt
    s_add_u32 s97, s97, 32768
    v_add_u32 v1, 4096, v1
    v_and_b32 v1, 0x7fff, v1
    s_waitcnt vmcnt(4)
    s_bitcmp0_b32 s57, 24
    s_cbranch_scc1 L_sf_59
    s_waitcnt vmcnt(3)
    s_bitcmp0_b32 s58, 24
    s_cbranch_scc1 L_sf_59
    s_waitcnt vmcnt(2)
L_sf_59:
    buffer_load_dwordx4 v[136:139], v1, s[48:51], s97 offen offset:0 nt
    s_waitcnt vmcnt(4)
    s_bitcmp0_b32 s57, 25
    s_cbranch_scc1 L_sf_60
    s_waitcnt vmcnt(3)
    s_bitcmp0_b32 s58, 25
    s_cbranch_scc1 L_sf_60
    s_waitcnt vmcnt(1)
L_sf_60:
    buffer_load_dwordx4 v[140:143], v1, s[48:51], s97 offen offset:1024 nt
    s_waitcnt vmcnt(4)
    s_bitcmp0_b32 s57, 26
    s_cbranch_scc1 L_sf_61
    s_waitcnt vmcnt(2)
    s_bitcmp0_b32 s58, 26
    s_cbranch_scc1 L_sf_61
    s_waitcnt vmcnt(1)
L_sf_61:
    buffer_load_dwordx4 v[144:147], v1, s[48:51], s97 offen offset:2048 nt
    s_waitcnt vmcnt(3)
    s_bitcmp0_b32 s57, 27
    s_cbranch_scc1 L_sf_62
    s_waitcnt vmcnt(2)
    s_bitcmp0_b32 s58, 27
    s_cbranch_scc1 L_sf_62
    s_waitcnt vmcnt(1)
L_sf_62:
    buffer_load_dwordx4 v[148:151], v1, s[48:51], s97 offen offset:3072 nt
    s_add_u32 s97, s97, 32768
    v_add_u32 v1, 4096, v1
    v_and_b32 v1, 0x7fff, v1
    v_cmp_eq_u32 vcc, 0, v37
    s_nop 0
    s_or_b32 s96, vcc_lo, vcc_hi
    buffer_load_dwordx4 v[4:7], v2, s[40:43], s98 offen sc1
    s_waitcnt vmcnt(4)
    s_bitcmp0_b32 s57, 28
    s_cbranch_scc1 L_sf_63
    s_waitcnt vmcnt(3)
    s_bitcmp0_b32 s58, 28
    s_cbranch_scc1 L_sf_63
    s_waitcnt vmcnt(2)
L_sf_63:
    buffer_load_dwordx4 v[152:155], v1, s[48:51], s97 offen offset:0 nt
    s_waitcnt vmcnt(4)
    s_bitcmp0_b32 s57, 29
    s_cbranch_scc1 L_sf_64
    s_waitcnt vmcnt(3)
    s_bitcmp0_b32 s58, 29
    s_cbranch_scc1 L_sf_64
    s_waitcnt vmcnt(2)
L_sf_64:
    buffer_load_dwordx4 v[156:159], v1, s[48:51], s97 offen offset:1024 nt
    s_waitcnt vmcnt(4)
    s_bitcmp0_b32 s57, 30
    s_cbranch_scc1 L_sf_65
    s_waitcnt vmcnt(3)
    s_bitcmp0_b32 s58, 30
    s_cbranch_scc1 L_sf_65
    s_waitcnt vmcnt(1)
L_sf_65:
    buffer_load_dwordx4 v[160:163], v1, s[48:51], s97 offen offset:2048 nt
    s_waitcnt vmcnt(4)
    s_bitcmp0_b32 s57, 31
    s_cbranch_scc1 L_sf_66
    s_waitcnt vmcnt(2)
    s_bitcmp0_b32 s58, 31
    s_cbranch_scc1 L_sf_66
    s_waitcnt vmcnt(1)
L_sf_66:
    buffer_load_dwordx4 v[164:167], v1, s[48:51], s97 offen offset:3072 nt
    s_mov_b32 s97, 0
    v_add_u32 v1, 4096, v1
    v_and_b32 v1, 0x7fff, v1
    v_add_u32 v1, 8192, v1
    v_and_b32 v1, 0x7fff, v1
    s_mov_b32 s97, 65536
    s_branch L_k_join
L_v_nopf:
    v_and_b32_dpp v24, v19, v20 row_newbcast:0 row_mask:0xf bank_mask:0xf
    v_and_b32_dpp v25, v19, v21 row_newbcast:0 row_mask:0xf bank_mask:0xf
    v_and_b32_dpp v26, v19, v22 row_newbcast:0 row_mask:0xf bank_mask:0xf
    v_and_b32_dpp v27, v19, v23 row_newbcast:0 row_mask:0xf bank_mask:0xf
    s_waitcnt vmcnt(3)
    s_bitcmp0_b32 s14, 0
    s_cbranch_scc1 L_sf_93
    s_waitcnt vmcnt(2)
    s_bitcmp0_b32 s15, 0
    s_cbranch_scc1 L_sf_93
    s_waitcnt vmcnt(1)
L_sf_93:
    buffer_load_dwordx4 v[40:43], v1, s[52:55], s97 offen offset:0 nt
    v_mfma_f32_16x16x32_bf16 v[32:35], v[24:27], v[152:155], v[32:35]
    v_and_b32_dpp v28, v19, v20 row_newbcast:8 row_mask:0xf bank_mask:0xf
    v_and_b32_dpp v29, v19, v21 row_newbcast:8 row_mask:0xf bank_mask:0xf
    v_and_b32_dpp v30, v19, v22 row_newbcast:8 row_mask:0xf bank_mask:0xf
    v_and_b32_dpp v31, v19, v23 row_newbcast:8 row_mask:0xf bank_mask:0xf
    s_waitcnt vmcnt(3)
    s_bitcmp0_b32 s14, 1
    s_cbranch_scc1 L_sf_94
    s_waitcnt vmcnt(2)
    s_bitcmp0_b32 s15, 1
    s_cbranch_scc1 L_sf_94
    s_waitcnt vmcnt(1)
L_sf_94:
    buffer_load_dwordx4 v[44:47], v1, s[52:55], s97 offen offset:1024 nt
    v_mfma_f32_16x16x32_bf16 v[32:35], v[28:31], v[156:159], v[32:35]
    v_and_b32_dpp v24, v19, v20 row_newbcast:4 row_mask:0xf bank_mask:0xf
    v_and_b32_dpp v25, v19, v21 row_newbcast:4 row_mask:0xf bank_mask:0xf
    v_and_b32_dpp v26, v19, v22 row_newbcast:4 row_mask:0xf bank_mask:0xf
    v_and_b32_dpp v27, v19, v23 row_newbcast:4 row_mask:0xf bank_mask:0xf
    s_waitcnt vmcnt(3)
    s_bitcmp0_b32 s14, 2
    s_cbranch_scc1 L_sf_95
    s_waitcnt vmcnt(2)
    s_bitcmp0_b32 s15, 2
    s_cbranch_scc1 L_sf_95
    s_waitcnt vmcnt(1)
L_sf_95:
    buffer_load_dwordx4 v[48:51], v1, s[52:55], s97 offen offset:2048 nt
    v_mfma_f32_16x16x32_bf16 v[32:35], v[24:27], v[160:163], v[32:35]
    v_and_b32_dpp v28, v19, v20 row_newbcast:12 row_mask:0xf bank_mask:0xf
    v_and_b32_dpp v29, v19, v21 row_newbcast:12 row_mask:0xf bank_mask:0xf
    v_and_b32_dpp v30, v19, v22 row_newbcast:12 row_mask:0xf bank_mask:0xf
    v_and_b32_dpp v31, v19, v23 row_newbcast:12 row_mask:0xf bank_mask:0xf
    s_waitcnt vmcnt(3)
    s_bitcmp0_b32 s14, 3
    s_cbranch_scc1 L_sf_96
    s_waitcnt vmcnt(2)
    s_bitcmp0_b32 s15, 3
    s_cbranch_scc1 L_sf_96
    s_waitcnt vmcnt(1)
L_sf_96:
    buffer_load_dwordx4 v[52:55], v1, s[52:55], s97 offen offset:3072 nt
    s_add_u32 s97, s97, 32768
    v_add_u32 v1, 4096, v1
    v_and_b32 v1, 0x7fff, v1
    v_mfma_f32_16x16x32_bf16 v[32:35], v[28:31], v[164:167], v[32:35]
    v_and_b32_dpp v24, v12, v20 row_newbcast:0 row_mask:0xf bank_mask:0xf
    v_and_b32_dpp v25, v12, v21 row_newbcast:0 row_mask:0xf bank_mask:0xf
    v_and_b32_dpp v26, v12, v22 row_newbcast:0 row_mask:0xf bank_mask:0xf
    v_and_b32_dpp v27, v12, v23 row_newbcast:0 row_mask:0xf bank_mask:0xf
    s_waitcnt vmcnt(3)
    s_bitcmp0_b32 s14, 4
    s_cbranch_scc1 L_sf_97
    s_waitcnt vmcnt(2)
    s_bitcmp0_b32 s15, 4
    s_cbranch_scc1 L_sf_97
    s_waitcnt vmcnt(1)
L_sf_97:
    buffer_load_dwordx4 v[56:59], v1, s[52:55], s97 offen offset:0 nt
    v_mfma_f32_16x16x32_bf16 v[32:35], v[24:27], v[40:43], v[32:35]
    v_and_b32_dpp v28, v12, v20 row_newbcast:8 row_mask:0xf bank_mask:0xf
    v_and_b32_dpp v29, v12, v21 row_newbcast:8 row_mask:0xf bank_mask:0xf
    v_and_b32_dpp v30, v12, v22 row_newbcast:8 row_mask:0xf bank_mask:0xf
    v_and_b32_dpp v31, v12, v23 row_newbcast:8 row_mask:0xf bank_mask:0xf
    s_waitcnt vmcnt(3)
    s_bitcmp0_b32 s14, 5
    s_cbranch_scc1 L_sf_98
    s_waitcnt vmcnt(2)
    s_bitcmp0_b32 s15, 5
    s_cbranch_scc1 L_sf_98
    s_waitcnt vmcnt(1)
L_sf_98:
    buffer_load_dwordx4 v[60:63], v1, s[52:55], s97 offen offset:1024 nt
    v_mfma_f32_16x16x32_bf16 v[32:35], v[28:31], v[44:47], v[32:35]
    v_and_b32_dpp v24, v12, v20 row_newbcast:4 row_mask:0xf bank_mask:0xf
    v_and_b32_dpp v25, v12, v21 row_newbcast:4 row_mask:0xf bank_mask:0xf
    v_and_b32_dpp v26, v12, v22 row_newbcast:4 row_mask:0xf bank_mask:0xf
    v_and_b32_dpp v27, v12, v23 row_newbcast:4 row_mask:0xf bank_mask:0xf
    s_waitcnt vmcnt(3)
    s_bitcmp0_b32 s14, 6
    s_cbranch_scc1 L_sf_99
    s_waitcnt vmcnt(2)
    s_bitcmp0_b32 s15, 6
    s_cbranch_scc1 L_sf_99
    s_waitcnt vmcnt(1)
L_sf_99:
    buffer_load_dwordx4 v[64:67], v1, s[52:55], s97 offen offset:2048 nt
    v_mfma_f32_16x16x32_bf16 v[32:35], v[24:27], v[48:51], v[32:35]
    v_and_b32_dpp v28, v12, v20 row_newbcast:12 row_mask:0xf bank_mask:0xf
    v_and_b32_dpp v29, v12, v21 row_newbcast:12 row_mask:0xf bank_mask:0xf
    v_and_b32_dpp v30, v12, v22 row_newbcast:12 row_mask:0xf bank_mask:0xf
    v_and_b32_dpp v31, v12, v23 row_newbcast:12 row_mask:0xf bank_mask:0xf
    s_waitcnt vmcnt(3)
    s_bitcmp0_b32 s14, 7
    s_cbranch_scc1 L_sf_100
    s_waitcnt vmcnt(2)
    s_bitcmp0_b32 s15, 7
    s_cbranch_scc1 L_sf_100
    s_waitcnt vmcnt(1)
L_sf_100:
    buffer_load_dwordx4 v[68:71], v1, s[52:55], s97 offen offset:3072 nt
    s_add_u32 s97, s97, 32768
    v_add_u32 v1, 4096, v1
    v_and_b32 v1, 0x7fff, v1
    v_mfma_f32_16x16x32_bf16 v[32:35], v[28:31], v[52:55], v[32:35]
    v_and_b32_dpp v24, v13, v20 row_newbcast:0 row_mask:0xf bank_mask:0xf
    v_and_b32_dpp v25, v13, v21 row_newbcast:0 row_mask:0xf bank_mask:0xf
    v_and_b32_dpp v26, v13, v22 row_newbcast:0 row_mask:0xf bank_mask:0xf
    v_and_b32_dpp v27, v13, v23 row_newbcast:0 row_mask:0xf bank_mask:0xf
    s_waitcnt vmcnt(3)
    s_nop 0
    v_mfma_f32_16x16x32_bf16 v[32:35], v[24:27], v[56:59], v[32:35]
    v_and_b32_dpp v28, v13, v20 row_newbcast:8 row_mask:0xf bank_mask:0xf
    v_and_b32_dpp v29, v13, v21 row_newbcast:8 row_mask:0xf bank_mask:0xf
    v_and_b32_dpp v30, v13, v22 row_newbcast:8 row_mask:0xf bank_mask:0xf
    v_and_b32_dpp v31, v13, v23 row_newbcast:8 row_mask:0xf bank_mask:0xf
    s_waitcnt vmcnt(2)
    s_nop 0
    v_mfma_f32_16x16x32_bf16 v[32:35], v[28:31], v[60:63], v[32:35]
    v_and_b32_dpp v24, v13, v20 row_newbcast:4 row_mask:0xf bank_mask:0xf
    v_and_b32_dpp v25, v13, v21 row_newbcast:4 row_mask:0xf bank_mask:0xf
    v_and_b32_dpp v26, v13, v22 row_newbcast:4 row_mask:0xf bank_mask:0xf
    v_and_b32_dpp v27, v13, v23 row_newbcast:4 row_mask:0xf bank_mask:0xf
    s_waitcnt vmcnt(1)
    s_nop 0
    v_mfma_f32_16x16x32_bf16 v[32:35], v[24:27], v[64:67], v[32:35]
    v_and_b32_dpp v28, v13, v20 row_newbcast:12 row_mask:0xf bank_mask:0xf
    v_and_b32_dpp v29, v13, v21 row_newbcast:12 row_mask:0xf bank_mask:0xf
    v_and_b32_dpp v30, v13, v22 row_newbcast:12 row_mask:0xf bank_mask:0xf
    v_and_b32_dpp v31, v13, v23 row_newbcast:12 row_mask:0xf bank_mask:0xf
    s_waitcnt vmcnt(0)
    s_nop 0
    v_mfma_f32_16x16x32_bf16 v[32:35], v[28:31], v[68:71], v[32:35]
    s_branch L_v_join
L_oslow:
    buffer_store_dword v32, v39, s[40:43], s98 offen sc1
    s_branch L_odone
L_refetch:
    s_lshr_b32 s62, s3, 2
    s_mul_i32 s62, s62, 5
    s_add_u32 s62, s62, s35
    s_sub_u32 s62, s62, 27
    s_cmp_ge_u32 s62, 7
    s_cbranch_scc1 L_norf
    s_add_u32 s62, s62, 3
    s_and_b32 s62, s62, 7
    s_mul_i32 s62, s62, 5120
    v_mov_b32 v8, 162048
L_lw_102:
    ds_read_b32 v9, v8
    s_waitcnt lgkmcnt(0)
    v_cmp_gt_u32 vcc, 9, v9
    s_cbranch_vccz L_lw_102e
    s_sleep 2
    s_sub_u32 s60, s60, 1
    s_cbranch_scc0 L_lw_102
    s_mov_b32 s60, 0
L_lw_102e:
    ds_read_b32 v9, v8 offset:36
    v_lshlrev_b32 v5, 4, v0
    v_add_u32 v5, 212992, v5
    s_add_u32 s4, s62, 0
    s_and_b32 s63, s4, 0xffffe000
    s_add_u32 s4, s4, s63
    s_add_u32 s5, s62, 1024
    s_and_b32 s63, s5, 0xffffe000
    s_add_u32 s5, s5, s63
    s_add_u32 s6, s62, 2048
    s_and_b32 s63, s6, 0xffffe000
    s_add_u32 s6, s6, s63
    s_add_u32 s7, s62, 3072
    s_and_b32 s63, s7, 0xffffe000
    s_add_u32 s7, s7, s63
    s_add_u32 s8, s62, 4096
    s_and_b32 s63, s8, 0xffffe000
    s_add_u32 s8, s8, s63
    s_waitcnt lgkmcnt(0)
    v_add_u32 v5, v5, v9
L_poll_103:
    buffer_load_dwordx4 v[12:15], v5, s[40:43], s4 offen sc1
    buffer_load_dwordx4 v[16:19], v5, s[40:43], s5 offen sc1
    buffer_load_dwordx4 v[20:23], v5, s[40:43], s6 offen sc1
    buffer_load_dwordx4 v[24:27], v5, s[40:43], s7 offen sc1
    buffer_load_dwordx4 v[28:31], v5, s[40:43], s8 offen sc1
    s_sub_u32 s60, s60, 1
    s_cbranch_scc1 L_poll_103t
    s_waitcnt vmcnt(0)
    v_max3_u32 v3, v12, v16, v20
    v_max3_u32 v3, v3, v24, v28
    v_cmp_eq_u32 vcc, -1, v3
    s_cbranch_vccnz L_poll_103
L_poll_103e:
    s_branch L_norf
L_qslow:
L_wy_104:
    buffer_load_dword v37, v39, s[44:47], 0 offen sc1
    s_waitcnt vmcnt(0)
    v_cmp_ne_u32 vcc, -1, v37
    s_cbranch_vccz L_wy_104e
    s_sleep 4
    s_sub_u32 s60, s60, 1
    s_cbranch_scc0 L_wy_104
    s_mov_b32 s60, 0
L_wy_104e:
L_qslow2:
    s_branch L_poll_105
L_poll_105s:
    s_sleep 2
L_poll_105:
    buffer_load_dwordx4 v[4:7], v2, s[40:43], s98 offen sc1
    s_sub_u32 s60, s60, 1
    s_cbranch_scc1 L_poll_105t
    s_waitcnt vmcnt(0)
    v_max3_u32 v38, v4, v5, v6
    v_max_u32 v38, v38, v7
    v_cmp_eq_u32 vcc, -1, v38
    s_cbranch_vccnz L_poll_105s
L_poll_105e:
    s_branch L_qok
L_mljob:
    s_lshl4_add_u32 s96, s35, s3
    s_lshl_b32 s96, s96, 3
    s_add_u32 s96, s96, 81920
    buffer_store_dwordx2 v[8:9], v36, s[40:43], s96 offen sc1
    s_branch L_mldone
L_service:
    v_mov_b32 v72, 0
    v_mov_b32 v73, 0
    v_mov_b32 v74, 0
    v_mov_b32 v75, 0
    v_mov_b32 v76, 0
    s_mov_b32 s59, 0
    v_mov_b32 v5, 0
    v_mov_b32 v105, 0
    v_mov_b32 v108, 0
    v_mov_b32 v110, 0
    v_mov_b32 v160, 0
    v_mov_b32 v163, 0
    v_mov_b32 v8, 162068
L_lw_106:
    ds_read_b32 v9, v8
    s_waitcnt lgkmcnt(0)
    v_cmp_gt_u32 vcc, 8, v9
    s_cbranch_vccz L_lw_106e
    s_sleep 8
    s_sub_u32 s60, s60, 1
    s_cbranch_scc0 L_lw_106
    s_mov_b32 s60, 0
L_lw_106e:
    v_and_b32 v2, 15, v0
    v_lshlrev_b32 v2, 3, v2
    v_add_u32 v3, 161920, v2
    ds_read_b64 v[8:9], v3
    v_mov_b32 v11, 162096
    ds_read_b32 v11, v11
    s_getreg_b32 s58, hwreg(HW_REG_XCC_ID, 0, 4)
    s_lshl_b32 s98, s34, 5
    s_add_u32 s98, s98, s35
    s_lshl_b32 s62, s98, 7
    s_add_u32 s62, s62, 73728
    s_and_b32 s99, s62, 0xffffff00
    s_lshl_b32 s98, s98, 8
    s_add_u32 s98, s98, 106496
    v_lshlrev_b32 v39, 2, v0
    v_and_b32 v21, 64, v2
    v_add_u32 v21, v21, v2
    v_cmp_eq_u32 vcc, 8, v0
    s_bfm_b64 exec, 8, 0
    s_bitset1_b32 exec_lo, 8
    s_waitcnt lgkmcnt(0)
    v_lshl_add_u32 v10, v11, 8, s58
    v_cndmask_b32 v8, v8, v10, vcc
    buffer_store_dwordx2 v[8:9], v2, s[40:43], s62 offen sc1
    s_mov_b64 exec, -1
    v_mov_b32 v12, 162076
L_lw_107:
    ds_read_b32 v13, v12
    s_waitcnt lgkmcnt(0)
    v_cmp_gt_u32 vcc, 4, v13
    s_cbranch_vccz L_lw_107e
    s_sleep 4
    s_sub_u32 s60, s60, 1
    s_cbranch_scc0 L_lw_107
    s_mov_b32 s60, 0
L_lw_107e:
    v_and_b32 v11, 31, v0
    v_lshlrev_b32 v11, 7, v11
    s_lshl_b32 s63, s34, 12
    s_add_u32 s63, s63, 73792
    buffer_load_dword v12, v39, s[40:43], s98 offen sc1
    s_branch L_poll_108
L_poll_108s:
    s_sleep 16
L_poll_108:
    buffer_load_dwordx2 v[8:9], v21, s[40:43], s99 offen sc1
    buffer_load_dword v10, v11, s[40:43], s63 offen sc1
    s_sub_u32 s60, s60, 1
    s_cbranch_scc1 L_poll_108t
    s_waitcnt vmcnt(0)
    v_max3_u32 v38, v8, v9, v10
    v_cmp_eq_u32 vcc, -1, v38
    s_cbranch_vccnz L_poll_108s
L_poll_108e:
    v_mov_b32 v37, v8
    s_nop 1
    v_max_f32_dpp v37, v37, v37 quad_perm:[1,0,3,2] row_mask:0xf bank_mask:0xf
    s_nop 1
    v_max_f32_dpp v37, v37, v37 quad_perm:[2,3,0,1] row_mask:0xf bank_mask:0xf
    s_nop 1
    v_max_f32_dpp v37, v37, v37 row_ror:4 row_mask:0xf bank_mask:0xf
    s_nop 1
    v_max_f32_dpp v37, v37, v37 row_ror:8 row_mask:0xf bank_mask:0xf
    v_sub_f32 v8, v8, v37
    v_exp_f32 v8, v8
    s_nop 0
    v_mul_f32 v9, v8, v9
    s_nop 1
    v_add_f32_dpp v9, v9, v9 quad_perm:[1,0,3,2] row_mask:0xf bank_mask:0xf
    s_nop 1
    v_add_f32_dpp v9, v9, v9 quad_perm:[2,3,0,1] row_mask:0xf bank_mask:0xf
    s_nop 1
    v_add_f32_dpp v9, v9, v9 row_ror:4 row_mask:0xf bank_mask:0xf
    s_nop 1
    v_add_f32_dpp v9, v9, v9 row_ror:8 row_mask:0xf bank_mask:0xf
    v_ashrrev_i32 v12, 8, v10
    s_nop 1
    v_add_u32_dpp v12, v12, v12 quad_perm:[1,0,3,2] row_mask:0xf bank_mask:0xf
    s_nop 1
    v_add_u32_dpp v12, v12, v12 quad_perm:[2,3,0,1] row_mask:0xf bank_mask:0xf
    s_nop 1
    v_add_u32_dpp v12, v12, v12 row_ror:4 row_mask:0xf bank_mask:0xf
    s_nop 1
    v_add_u32_dpp v12, v12, v12 row_ror:8 row_mask:0xf bank_mask:0xf
    v_mov_b32 v13, v12
    s_nop 1
    v_permlane16_swap_b32 v12, v13
    v_add_u32 v12, v12, v13
    v_mov_b32 v13, v12
    s_nop 1
    v_permlane32_swap_b32 v12, v13
    v_add_u32 v12, v12, v13
    v_ashrrev_i32 v12, 31, v12
    v_and_b32 v12, 8192, v12
    v_mov_b32 v13, 162084
    ds_write_b32 v13, v12
    v_and_b32 v10, 0xff, v10
    s_getreg_b32 s62, hwreg(HW_REG_XCC_ID, 0, 4)
    v_cmp_ne_u32 vcc, s62, v10
    s_nop 0
    s_cmp_eq_u64 vcc, 0
    s_cselect_b32 s61, 1, 0
    v_rcp_f32 v9, v9
    v_lshrrev_b32 v3, 1, v2
    v_add_u32 v3, 161984, v3
    v_mul_f32 v8, v8, v9
    v_mov_b32 v10, 162072
    v_mov_b32 v11, s61
    ds_write_b32 v3, v8
    ds_write_b32 v10, v11
    s_mov_b32 s3, 1
    v_lshrrev_b32 v9, 4, v0
    v_lshl_add_u32 v8, v9, 2, v2
    s_lshl_b32 s96, s3, 9
    s_add_u32 s96, s96, 157824
    v_lshl_add_u32 v8, v8, 2, s96
    v_lshlrev_b32 v9, 3, v0
    v_add_u32 v9, 157824, v9
    v_mov_b32 v10, 162048
    v_mov_b32 v11, 1
    s_lshl_b32 s96, s38, 5
    s_add_u32 s96, s96, 161984
    v_mov_b32 v3, s96
    s_sub_u32 s62, 8, s39
    s_lshl_b32 s98, s34, 5
    s_add_u32 s98, s98, s35
    s_lshl_b32 s98, s98, 8
    s_add_u32 s98, s98, 106496
    v_lshlrev_b32 v39, 2, v0
    s_branch L_t0b
L_jobend:
    v_lshlrev_b32 v9, 4, v0
    s_mov_b32 exec_hi, 0
    s_nop 3
    buffer_store_dwordx4 v[32:35], v9, s[40:43], s13 offen sc1
    s_endpgm
L_proxy:
    v_mov_b32 v72, 0
    v_mov_b32 v73, 0
    v_mov_b32 v74, 0
    v_mov_b32 v75, 0
    v_mov_b32 v76, 0
    v_mov_b32 v5, 0
    v_mov_b32 v105, 0
    v_mov_b32 v108, 0
    v_mov_b32 v110, 0
    v_mov_b32 v160, 0
    v_mov_b32 v163, 0
    s_barrier
    s_waitcnt lgkmcnt(0)
    s_mov_b32 s40, s32
    s_mov_b32 s41, s33
    s_mov_b32 s42, 589824
    s_mov_b32 s43, 0x20000
    s_mov_b32 s44, s30
    s_mov_b32 s45, s31
    s_mov_b32 s46, 256
    s_mov_b32 s47, 0x20000
    s_sub_u32 s97, 7, s3
    s_mul_i32 s97, s97, 27
    s_cmp_eq_u32 s3, 5
    s_cselect_b32 s97, 32, s97
    s_add_u32 s97, s97, s35
    s_lshl_b32 s97, s97, 9
    s_add_u32 s97, s97, 172032
    v_and_b32 v2, 15, v0
    v_lshlrev_b32 v2, 3, v2
    v_and_b32 v20, 31, v0
    v_lshlrev_b32 v20, 4, v20
    s_cmp_lg_u32 s3, 7
    s_cbranch_scc1 L_px6
    s_sub_u32 s96, 6, s59
    s_mul_i32 s62, s35, 5120
    s_add_u32 s62, s62, 327680
    v_lshl_add_u32 v22, v0, 4, s62
    v_add_u32 v23, 4096, v22
    v_mov_b32 v24, -1
    v_mov_b32 v25, -1
    v_mov_b32 v26, -1
    v_mov_b32 v27, -1
    v_mov_b32 v8, 162068
L_lw_109:
    ds_read_b32 v9, v8
    s_waitcnt lgkmcnt(0)
    v_cmp_gt_u32 vcc, s96, v9
    s_cbranch_vccz L_lw_109e
    s_sleep 8
    s_sub_u32 s60, s60, 1
    s_cbranch_scc0 L_lw_109
    s_mov_b32 s60, 0
L_lw_109e:
    v_and_b32 v2, 15, v0
    v_lshlrev_b32 v2, 3, v2
    v_add_u32 v3, 161920, v2
    ds_read_b64 v[8:9], v3
    v_mov_b32 v11, 162096
    ds_read_b32 v11, v11
    s_getreg_b32 s58, hwreg(HW_REG_XCC_ID, 0, 4)
    s_lshl_b32 s98, s34, 5
    s_add_u32 s98, s98, s35
    s_lshl_b32 s62, s98, 7
    s_add_u32 s62, s62, 73728
    s_and_b32 s99, s62, 0xffffff00
    s_lshl_b32 s98, s98, 8
    s_add_u32 s98, s98, 106496
    v_lshlrev_b32 v39, 2, v0
    v_and_b32 v21, 64, v2
    v_add_u32 v21, v21, v2
    v_cmp_eq_u32 vcc, 8, v0
    s_bfm_b64 exec, s96, 0
    s_bitset1_b32 exec_lo, 8
    s_waitcnt lgkmcnt(0)
    v_lshl_add_u32 v10, v11, 8, s58
    v_cndmask_b32 v8, v8, v10, vcc
    buffer_store_dwordx2 v[8:9], v2, s[40:43], s62 offen sc1
    s_mov_b64 exec, -1
    buffer_load_dwordx4 v[120:123], v22, s[40:43], 0 offen offset:0 sc1
    buffer_load_dwordx4 v[124:127], v22, s[40:43], 0 offen offset:1024 sc1
    buffer_load_dwordx4 v[128:131], v22, s[40:43], 0 offen offset:2048 sc1
    buffer_load_dwordx4 v[132:135], v22, s[40:43], 0 offen offset:3072 sc1
    buffer_load_dwordx4 v[136:139], v23, s[40:43], 0 offen offset:0 sc1
    s_mov_b32 s100, 4
    s_lshl_b32 s63, s100, 8
    v_and_b32 v8, 15, v0
    v_lshl_add_u32 v8, v8, 4, s63
    v_lshrrev_b32 v9, 4, v0
    v_mul_u32_u24 v5, 1280, v9
    v_add_u32 v5, v5, v8
    v_mul_u32_u24 v4, 1296, v9
    v_add_u32 v4, v4, v8
    v_add_u32 v4, 82944, v4
    v_lshlrev_b32 v6, 1, v5
    v_add_u32 v6, 99328, v6
    s_lshl_b32 s62, s100, 9
    s_add_u32 s62, s62, 88128
    v_lshl_add_u32 v7, v0, 3, s62
    s_mov_b32 s48, s4
    s_mov_b32 s49, s5
    s_mov_b32 s50, 5120
    s_mov_b32 s51, 0x20000
    buffer_load_dwordx4 v[8:11], v5, s[48:51], 0 offen
    s_mov_b32 s62, 20480
    s_mov_b32 s63, 30720
    s_branch L_poll_110
L_poll_110s:
    s_sleep 32
L_poll_110:
    buffer_load_dwordx4 v[12:15], v5, s[40:43], s62 offen sc1
    buffer_load_dwordx4 v[16:19], v5, s[40:43], s63 offen sc1
    s_sub_u32 s60, s60, 1
    s_cbranch_scc1 L_poll_110t
    s_waitcnt vmcnt(0)
    v_max3_u32 v38, v12, v13, v14
    v_max3_u32 v38, v38, v15, v16
    v_max3_u32 v38, v38, v17, v18
    v_max_u32 v38, v38, v19
    v_cmp_eq_u32 vcc, -1, v38
    s_cbranch_vccnz L_poll_110s
L_poll_110e:
    v_lshlrev_b32 v40, 16, v8
    v_and_b32 v41, 0xffff0000, v8
    v_lshlrev_b32 v42, 16, v9
    v_and_b32 v43, 0xffff0000, v9
    v_lshlrev_b32 v44, 16, v10
    v_and_b32 v45, 0xffff0000, v10
    v_lshlrev_b32 v46, 16, v11
    v_and_b32 v47, 0xffff0000, v11
    v_lshlrev_b32 v48, 16, v12
    v_and_b32 v49, 0xffff0000, v12
    v_lshlrev_b32 v50, 16, v13
    v_and_b32 v51, 0xffff0000, v13
    v_lshlrev_b32 v52, 16, v14
    v_and_b32 v53, 0xffff0000, v14
    v_lshlrev_b32 v54, 16, v15
    v_and_b32 v55, 0xffff0000, v15
    v_lshlrev_b32 v56, 16, v16
    v_and_b32 v57, 0xffff0000, v16
    v_lshlrev_b32 v58, 16, v17
    v_and_b32 v59, 0xffff0000, v17
    v_lshlrev_b32 v60, 16, v18
    v_and_b32 v61, 0xffff0000, v18
    v_lshlrev_b32 v62, 16, v19
    v_and_b32 v63, 0xffff0000, v19
    v_mov_b32 v64, 0
    v_mov_b32 v65, 0
    v_mov_b32 v66, 0
    v_mov_b32 v67, 0
    v_mov_b32 v68, 0
    v_mov_b32 v69, 0
    v_mov_b32 v70, 0
    v_mov_b32 v71, 0
    v_bfe_u32 v5, v0, 2, 2
    v_lshlrev_b32 v5, 8, v5
    v_lshrrev_b32 v8, 4, v0
    v_lshl_add_u32 v5, v8, 6, v5
    v_and_b32 v8, 3, v0
    v_lshl_add_u32 v5, v8, 4, v5
    s_lshl_b32 s56, s100, 10
    s_or_b32 s96, s59, 0
    s_cbranch_scc0 L_nofrag_111
    v_mov_b32 v104, 162060
L_lw_112:
    ds_read_b32 v105, v104
    s_waitcnt lgkmcnt(0)
    v_cmp_gt_u32 vcc, 4, v105
    s_cbranch_vccz L_lw_112e
    s_sleep 2
    s_sub_u32 s60, s60, 1
    s_cbranch_scc0 L_lw_112
    s_mov_b32 s60, 0
L_lw_112e:
    s_cmp_eq_u32 s59, 0
    s_cbranch_scc1 L_nofrag_111
    v_bfe_u32 v104, v0, 2, 1
    v_bfe_u32 v110, v0, 4, 1
    v_lshl_add_u32 v104, v110, 2, v104
    v_and_b32 v110, 8, v0
    v_add_u32 v104, v104, v110
    v_lshrrev_b32 v110, 5, v0
    v_lshl_add_u32 v104, v110, 4, v104
    v_bfe_u32 v111, v0, 0, 1
    v_mul_u32_u24 v111, 0xaaaa, v111
    v_add_u32 v111, 0x4444, v111
    v_mov_b32 v112, 0
    v_mov_b32 v113, 0
    v_mov_b32 v114, 0
    v_mov_b32 v115, 0
    v_mov_b32 v116, 0
    v_mov_b32 v117, 0
    v_mov_b32 v118, 0
    v_mov_b32 v119, 0
    v_lshlrev_b32 v104, 7, v104
    v_and_b32 v110, 3, v0
    v_lshl_add_u32 v104, v110, 3, v104
    v_lshrrev_b32 v109, 4, v0
    v_and_b32 v110, 1, v0
    s_lshr_b32 s63, s3, 1
    s_and_b32 s62, s3, 1
    s_lshl_b32 s96, s63, 14
    s_lshl_b32 s100, s62, 6
    s_add_u32 s100, s100, 81920
    s_add_u32 s96, s96, s100
    v_add_u32 v104, s96, v104
    ds_read_b64_tr_b16 v[72:73], v104 offset:0
    ds_read_b64_tr_b16 v[74:75], v104 offset:256
    ds_read_b64_tr_b16 v[76:77], v104 offset:4096
    ds_read_b64_tr_b16 v[78:79], v104 offset:4352
    ds_read_b64_tr_b16 v[80:81], v104 offset:32
    ds_read_b64_tr_b16 v[82:83], v104 offset:288
    ds_read_b64_tr_b16 v[84:85], v104 offset:4128
    ds_read_b64_tr_b16 v[86:87], v104 offset:4384
    ds_read_b64_tr_b16 v[88:89], v104 offset:8192
    ds_read_b64_tr_b16 v[90:91], v104 offset:8448
    ds_read_b64_tr_b16 v[92:93], v104 offset:12288
    ds_read_b64_tr_b16 v[94:95], v104 offset:12544
    ds_read_b64_tr_b16 v[96:97], v104 offset:8224
    ds_read_b64_tr_b16 v[98:99], v104 offset:8480
    ds_read_b64_tr_b16 v[100:101], v104 offset:12320
    ds_read_b64_tr_b16 v[102:103], v104 offset:12576
    v_bfe_u32 v105, v0, 1, 3
    v_lshlrev_b32 v105, 8, v105
    v_lshl_add_u32 v105, v109, 5, v105
    v_lshl_add_u32 v105, v110, 4, v105
    v_lshrrev_b32 v106, 3, v0
    v_lshlrev_b32 v106, 7, v106
    v_and_b32 v110, 7, v0
    v_lshl_add_u32 v107, v110, 3, v106
    v_add_u32 v107, s100, v107
    v_lshlrev_b32 v106, 8, v109
    v_and_b32 v110, 15, v0
    v_lshl_add_u32 v106, v110, 2, v106
    v_add_u32 v106, s96, v106
    v_lshlrev_b32 v108, 2, v0
    s_lshl_b32 s96, s62, 2
    s_add_u32 s96, s96, 162088
    v_mov_b32 v109, s96
    s_lshl_b32 s100, s63, 11
    s_lshl_b32 s96, s34, 13
    s_add_u32 s100, s100, s96
    s_add_u32 s100, s100, 106496
    s_mul_i32 s101, s34, 5120
    s_lshl_b32 s96, s35, 9
    s_add_u32 s101, s101, s96
    s_lshl_b32 s96, s62, 8
    s_add_u32 s101, s101, s96
    s_sub_u32 s101, s101, 11264
    s_and_b32 s96, s101, 0xffffe000
    s_add_u32 s101, s101, s96
    s_add_u32 s101, s101, 212992
    v_add_u32 v110, 8192, v108
L_nofrag_111:
    s_cmp_ge_u32 s35, 20
    s_cbranch_scc1 L_nofin_113
    s_lshl1_add_u32 s62, s35, s3
    s_sub_u32 s62, s62, 6
    s_lshl_b32 s57, s62, 7
    s_mul_i32 s63, s62, 0x199a
    s_lshr_b32 s63, s63, 16
    s_mul_i32 s63, s63, 1280
    s_sub_u32 s63, s57, s63
    v_lshrrev_b32 v72, 3, v0
    v_mul_u32_u24 v72, 5120, v72
    v_and_b32 v8, 7, v0
    v_lshl_add_u32 v72, v8, 4, v72
    s_add_u32 s62, s57, 327680
    v_add_u32 v72, s62, v72
    v_add_u32 v73, 40960, v72
    v_add_u32 v74, 81920, v72
    v_add_u32 v75, 122880, v72
    v_bfe_u32 v9, v0, 4, 1
    v_lshlrev_b32 v76, 4, v8
    v_lshl_add_u32 v76, v9, 3, v76
    s_lshl_b32 s62, s57, 1
    s_add_u32 s62, s62, 99328
    v_lshl_add_u32 v77, v76, 1, s62
    s_mov_b32 s48, s22
    s_mov_b32 s49, s23
    s_mov_b32 s50, 1280
    s_mov_b32 s51, 0x20000
    buffer_load_dwordx2 v[86:87], v76, s[48:51], s63 offen
    s_add_u32 s62, s57, 35840
    s_branch L_poll_114
L_poll_114s:
    s_sleep 32
L_poll_114:
    buffer_load_dwordx2 v[8:9], v76, s[40:43], s62 offen sc1
    s_sub_u32 s60, s60, 1
    s_cbranch_scc1 L_poll_114t
    s_waitcnt vmcnt(0)
    v_max_u32 v38, v8, v9
    v_cmp_eq_u32 vcc, -1, v38
    s_cbranch_vccnz L_poll_114s
L_poll_114e:
    v_lshlrev_b32 v78, 16, v86
    v_and_b32 v79, 0xffff0000, v86
    v_lshlrev_b32 v82, 16, v8
    v_and_b32 v83, 0xffff0000, v8
    v_lshlrev_b32 v80, 16, v87
    v_and_b32 v81, 0xffff0000, v87
    v_lshlrev_b32 v84, 16, v9
    v_and_b32 v85, 0xffff0000, v9
    v_bfe_u32 v8, v0, 1, 3
    v_and_b32 v9, 1, v0
    v_lshlrev_b32 v9, 4, v9
    v_mov_b32 v10, 0x3f80
    v_lshlrev_b32 v9, v9, v10
    v_cmp_eq_u32 vcc, 0, v8
    v_mov_b32 v100, 0
    s_nop 0
    v_cndmask_b32 v104, 0, v9, vcc
    v_cmp_eq_u32 vcc, 1, v8
    v_mov_b32 v101, 0
    s_nop 0
    v_cndmask_b32 v105, 0, v9, vcc
    v_cmp_eq_u32 vcc, 2, v8
    v_mov_b32 v102, 0
    s_nop 0
    v_cndmask_b32 v106, 0, v9, vcc
    v_cmp_eq_u32 vcc, 3, v8
    v_mov_b32 v103, 0
    s_nop 0
    v_cndmask_b32 v107, 0, v9, vcc
L_nofin_113:
    v_mov_b32 v12, 162076
L_lw_115:
    ds_read_b32 v13, v12
    s_waitcnt lgkmcnt(0)
    v_cmp_gt_u32 vcc, 4, v13
    s_cbranch_vccz L_lw_115e
    s_sleep 4
    s_sub_u32 s60, s60, 1
    s_cbranch_scc0 L_lw_115
    s_mov_b32 s60, 0
L_lw_115e:
    v_and_b32 v11, 31, v0
    v_lshlrev_b32 v11, 7, v11
    s_lshl_b32 s63, s34, 12
    s_add_u32 s63, s63, 73792
    buffer_load_dword v12, v39, s[40:43], s98 offen sc1
    s_branch L_poll_116
L_poll_116s:
    s_sleep 4
L_poll_116:
    buffer_load_dwordx2 v[8:9], v21, s[40:43], s99 offen sc1
    buffer_load_dword v10, v11, s[40:43], s63 offen sc1
    s_sub_u32 s60, s60, 1
    s_cbranch_scc1 L_poll_116t
    s_waitcnt vmcnt(0)
    v_max3_u32 v38, v8, v9, v10
    v_cmp_eq_u32 vcc, -1, v38
    s_cbranch_vccnz L_poll_116s
L_poll_116e:
    v_mov_b32 v37, v8
    s_nop 1
    v_max_f32_dpp v37, v37, v37 quad_perm:[1,0,3,2] row_mask:0xf bank_mask:0xf
    s_nop 1
    v_max_f32_dpp v37, v37, v37 quad_perm:[2,3,0,1] row_mask:0xf bank_mask:0xf
    s_nop 1
    v_max_f32_dpp v37, v37, v37 row_ror:4 row_mask:0xf bank_mask:0xf
    s_nop 1
    v_max_f32_dpp v37, v37, v37 row_ror:8 row_mask:0xf bank_mask:0xf
    v_sub_f32 v8, v8, v37
    v_exp_f32 v8, v8
    s_nop 0
    v_mul_f32 v9, v8, v9
    s_nop 1
    v_add_f32_dpp v9, v9, v9 quad_perm:[1,0,3,2] row_mask:0xf bank_mask:0xf
    s_nop 1
    v_add_f32_dpp v9, v9, v9 quad_perm:[2,3,0,1] row_mask:0xf bank_mask:0xf
    s_nop 1
    v_add_f32_dpp v9, v9, v9 row_ror:4 row_mask:0xf bank_mask:0xf
    s_nop 1
    v_add_f32_dpp v9, v9, v9 row_ror:8 row_mask:0xf bank_mask:0xf
    v_ashrrev_i32 v12, 8, v10
    s_nop 1
    v_add_u32_dpp v12, v12, v12 quad_perm:[1,0,3,2] row_mask:0xf bank_mask:0xf
    s_nop 1
    v_add_u32_dpp v12, v12, v12 quad_perm:[2,3,0,1] row_mask:0xf bank_mask:0xf
    s_nop 1
    v_add_u32_dpp v12, v12, v12 row_ror:4 row_mask:0xf bank_mask:0xf
    s_nop 1
    v_add_u32_dpp v12, v12, v12 row_ror:8 row_mask:0xf bank_mask:0xf
    v_mov_b32 v13, v12
    s_nop 1
    v_permlane16_swap_b32 v12, v13
    v_add_u32 v12, v12, v13
    v_mov_b32 v13, v12
    s_nop 1
    v_permlane32_swap_b32 v12, v13
    v_add_u32 v12, v12, v13
    v_ashrrev_i32 v12, 31, v12
    v_and_b32 v12, 8192, v12
    v_mov_b32 v13, 162084
    ds_write_b32 v13, v12
    v_and_b32 v10, 0xff, v10
    s_getreg_b32 s62, hwreg(HW_REG_XCC_ID, 0, 4)
    v_cmp_ne_u32 vcc, s62, v10
    s_nop 0
    s_cmp_eq_u64 vcc, 0
    s_cselect_b32 s61, 1, 0
    v_rcp_f32 v9, v9
    v_lshrrev_b32 v3, 1, v2
    v_add_u32 v3, 161984, v3
    v_mul_f32 v8, v8, v9
    v_mov_b32 v10, 162072
    v_mov_b32 v11, s61
    ds_write_b32 v3, v8
    ds_write_b32 v10, v11
    s_cmp_eq_u32 s61, 1
    s_cbranch_scc0 L_ycs
    buffer_store_dwordx4 v[24:27], v22, s[40:43], 0 offen offset:0
    buffer_store_dwordx4 v[24:27], v22, s[40:43], 0 offen offset:1024
    buffer_store_dwordx4 v[24:27], v22, s[40:43], 0 offen offset:2048
    buffer_store_dwordx4 v[24:27], v22, s[40:43], 0 offen offset:3072
    buffer_store_dwordx4 v[24:27], v23, s[40:43], 0 offen offset:0
L_ycd:
    s_branch L_poll_117
L_poll_117s:
    s_sleep 4
L_poll_117:
    buffer_load_dwordx4 v[32:35], v20, s[40:43], s97 offen sc1
    s_sub_u32 s60, s60, 1
    s_cbranch_scc1 L_poll_117t
    s_waitcnt vmcnt(0)
    v_max3_u32 v38, v32, v33, v34
    v_max_u32 v38, v38, v35
    v_cmp_eq_u32 vcc, -1, v38
    s_cbranch_vccnz L_poll_117s
L_poll_117e:
    s_branch L_pxj
L_px6:
    s_or_b32 s96, s59, s39
    s_cbranch_scc0 L_nofrag_118
    v_mov_b32 v104, 162060
L_lw_119:
    ds_read_b32 v105, v104
    s_waitcnt lgkmcnt(0)
    v_cmp_gt_u32 vcc, 4, v105
    s_cbranch_vccz L_lw_119e
    s_sleep 2
    s_sub_u32 s60, s60, 1
    s_cbranch_scc0 L_lw_119
    s_mov_b32 s60, 0
L_lw_119e:
    s_cmp_eq_u32 s59, 0
    s_cbranch_scc1 L_nofrag_118
    v_bfe_u32 v104, v0, 2, 1
    v_bfe_u32 v110, v0, 4, 1
    v_lshl_add_u32 v104, v110, 2, v104
    v_and_b32 v110, 8, v0
    v_add_u32 v104, v104, v110
    v_lshrrev_b32 v110, 5, v0
    v_lshl_add_u32 v104, v110, 4, v104
    v_bfe_u32 v111, v0, 0, 1
    v_mul_u32_u24 v111, 0xaaaa, v111
    v_add_u32 v111, 0x4444, v111
    v_mov_b32 v112, 0
    v_mov_b32 v113, 0
    v_mov_b32 v114, 0
    v_mov_b32 v115, 0
    v_mov_b32 v116, 0
    v_mov_b32 v117, 0
    v_mov_b32 v118, 0
    v_mov_b32 v119, 0
    v_lshlrev_b32 v104, 7, v104
    v_and_b32 v110, 3, v0
    v_lshl_add_u32 v104, v110, 3, v104
    v_lshrrev_b32 v109, 4, v0
    v_and_b32 v110, 1, v0
    s_lshr_b32 s63, s3, 1
    s_and_b32 s62, s3, 1
    s_lshl_b32 s96, s63, 14
    s_lshl_b32 s100, s62, 6
    s_add_u32 s100, s100, 81920
    s_add_u32 s96, s96, s100
    v_add_u32 v104, s96, v104
    ds_read_b64_tr_b16 v[72:73], v104 offset:0
    ds_read_b64_tr_b16 v[74:75], v104 offset:256
    ds_read_b64_tr_b16 v[76:77], v104 offset:4096
    ds_read_b64_tr_b16 v[78:79], v104 offset:4352
    ds_read_b64_tr_b16 v[80:81], v104 offset:32
    ds_read_b64_tr_b16 v[82:83], v104 offset:288
    ds_read_b64_tr_b16 v[84:85], v104 offset:4128
    ds_read_b64_tr_b16 v[86:87], v104 offset:4384
    ds_read_b64_tr_b16 v[88:89], v104 offset:8192
    ds_read_b64_tr_b16 v[90:91], v104 offset:8448
    ds_read_b64_tr_b16 v[92:93], v104 offset:12288
    ds_read_b64_tr_b16 v[94:95], v104 offset:12544
    ds_read_b64_tr_b16 v[96:97], v104 offset:8224
    ds_read_b64_tr_b16 v[98:99], v104 offset:8480
    ds_read_b64_tr_b16 v[100:101], v104 offset:12320
    ds_read_b64_tr_b16 v[102:103], v104 offset:12576
    v_bfe_u32 v105, v0, 1, 3
    v_lshlrev_b32 v105, 8, v105
    v_lshl_add_u32 v105, v109, 5, v105
    v_lshl_add_u32 v105, v110, 4, v105
    v_lshrrev_b32 v106, 3, v0
    v_lshlrev_b32 v106, 7, v106
    v_and_b32 v110, 7, v0
    v_lshl_add_u32 v107, v110, 3, v106
    v_add_u32 v107, s100, v107
    v_lshlrev_b32 v106, 8, v109
    v_and_b32 v110, 15, v0
    v_lshl_add_u32 v106, v110, 2, v106
    v_add_u32 v106, s96, v106
    v_lshlrev_b32 v108, 2, v0
    s_lshl_b32 s96, s62, 2
    s_add_u32 s96, s96, 162088
    v_mov_b32 v109, s96
    s_lshl_b32 s100, s63, 11
    s_lshl_b32 s96, s34, 13
    s_add_u32 s100, s100, s96
    s_add_u32 s100, s100, 106496
    s_mul_i32 s101, s34, 5120
    s_lshl_b32 s96, s35, 9
    s_add_u32 s101, s101, s96
    s_lshl_b32 s96, s62, 8
    s_add_u32 s101, s101, s96
    s_sub_u32 s101, s101, 11264
    s_and_b32 s96, s101, 0xffffe000
    s_add_u32 s101, s101, s96
    s_add_u32 s101, s101, 212992
    v_add_u32 v110, 8192, v108
L_nofrag_118:
    s_mov_b32 s62, 3
    s_lshl1_add_u32 s96, s35, s3
    s_and_b32 s63, s96, 7
    s_lshl_b32 s63, s63, 14
    s_lshl_b32 s96, s96, 7
    s_add_u32 s96, s96, s63
    s_add_u32 s96, s96, 475136
    s_add_u32 s98, s32, s96
    s_addc_u32 s99, s33, 0
    s_load_dword s4, s[98:99], 0 glc
    s_load_dword s5, s[98:99], 8192 glc
    s_mov_b32 s63, 0
    s_waitcnt lgkmcnt(0)
L_np:
    s_not_b32 s4, s4
    s_mov_b32 s6, s4
    s_mov_b32 s7, 0
    s_load_dword s4, s[98:99], 0 glc
L_npc0:
    s_add_u32 s7, s7, 1
    s_cmp_eq_u32 s4, s6
    s_cselect_b32 s8, s7, 1000
    s_cmp_lt_u32 s8, 60
    s_cbranch_scc1 L_npc0
    s_waitcnt lgkmcnt(0)
    s_sub_u32 s63, s63, s7
    s_not_b32 s5, s5
    s_mov_b32 s6, s5
    s_mov_b32 s7, 0
    s_load_dword s5, s[98:99], 8192 glc
L_npc1:
    s_add_u32 s7, s7, 1
    s_cmp_eq_u32 s5, s6
    s_cselect_b32 s8, s7, 1000
    s_cmp_lt_u32 s8, 60
    s_cbranch_scc1 L_npc1
    s_waitcnt lgkmcnt(0)
    s_add_u32 s63, s63, s7
    s_sub_u32 s62, s62, 1
    s_cmp_lg_u32 s62, 0
    s_cbranch_scc1 L_np
    v_mov_b32 v8, 162096
    v_mov_b32 v9, s63
    s_mov_b64 exec, 1
    ds_add_u32 v8, v9
    s_mov_b64 exec, -1
    v_mov_b32 v8, 162068
L_lw_120:
    ds_read_b32 v9, v8
    s_waitcnt lgkmcnt(0)
    v_cmp_gt_u32 vcc, 1, v9
    s_cbranch_vccz L_lw_120e
    s_sleep 32
    s_sub_u32 s60, s60, 1
    s_cbranch_scc0 L_lw_120
    s_mov_b32 s60, 0
L_lw_120e:
    s_cmp_ge_u32 s35, 20
    s_cbranch_scc1 L_nofin_121
    s_lshl1_add_u32 s62, s35, s3
    s_sub_u32 s62, s62, 6
    s_lshl_b32 s57, s62, 7
    s_mul_i32 s63, s62, 0x199a
    s_lshr_b32 s63, s63, 16
    s_mul_i32 s63, s63, 1280
    s_sub_u32 s63, s57, s63
    v_lshrrev_b32 v72, 3, v0
    v_mul_u32_u24 v72, 5120, v72
    v_and_b32 v8, 7, v0
    v_lshl_add_u32 v72, v8, 4, v72
    s_add_u32 s62, s57, 327680
    v_add_u32 v72, s62, v72
    v_add_u32 v73, 40960, v72
    v_add_u32 v74, 81920, v72
    v_add_u32 v75, 122880, v72
    v_bfe_u32 v9, v0, 4, 1
    v_lshlrev_b32 v76, 4, v8
    v_lshl_add_u32 v76, v9, 3, v76
    s_lshl_b32 s62, s57, 1
    s_add_u32 s62, s62, 99328
    v_lshl_add_u32 v77, v76, 1, s62
    s_mov_b32 s48, s22
    s_mov_b32 s49, s23
    s_mov_b32 s50, 1280
    s_mov_b32 s51, 0x20000
    buffer_load_dwordx2 v[86:87], v76, s[48:51], s63 offen
    s_add_u32 s62, s57, 35840
    s_branch L_poll_122
L_poll_122s:
    s_sleep 32
L_poll_122:
    buffer_load_dwordx2 v[8:9], v76, s[40:43], s62 offen sc1
    s_sub_u32 s60, s60, 1
    s_cbranch_scc1 L_poll_122t
    s_waitcnt vmcnt(0)
    v_max_u32 v38, v8, v9
    v_cmp_eq_u32 vcc, -1, v38
    s_cbranch_vccnz L_poll_122s
L_poll_122e:
    v_lshlrev_b32 v78, 16, v86
    v_and_b32 v79, 0xffff0000, v86
    v_lshlrev_b32 v82, 16, v8
    v_and_b32 v83, 0xffff0000, v8
    v_lshlrev_b32 v80, 16, v87
    v_and_b32 v81, 0xffff0000, v87
    v_lshlrev_b32 v84, 16, v9
    v_and_b32 v85, 0xffff0000, v9
    v_bfe_u32 v8, v0, 1, 3
    v_and_b32 v9, 1, v0
    v_lshlrev_b32 v9, 4, v9
    v_mov_b32 v10, 0x3f80
    v_lshlrev_b32 v9, v9, v10
    v_cmp_eq_u32 vcc, 0, v8
    v_mov_b32 v100, 0
    s_nop 0
    v_cndmask_b32 v104, 0, v9, vcc
    v_cmp_eq_u32 vcc, 1, v8
    v_mov_b32 v101, 0
    s_nop 0
    v_cndmask_b32 v105, 0, v9, vcc
    v_cmp_eq_u32 vcc, 2, v8
    v_mov_b32 v102, 0
    s_nop 0
    v_cndmask_b32 v106, 0, v9, vcc
    v_cmp_eq_u32 vcc, 3, v8
    v_mov_b32 v103, 0
    s_nop 0
    v_cndmask_b32 v107, 0, v9, vcc
L_nofin_121:
    v_mov_b32 v8, 162076
L_lw_123:
    ds_read_b32 v9, v8
    s_waitcnt lgkmcnt(0)
    v_cmp_gt_u32 vcc, 4, v9
    s_cbranch_vccz L_lw_123e
    s_sleep 16
    s_sub_u32 s60, s60, 1
    s_cbranch_scc0 L_lw_123
    s_mov_b32 s60, 0
L_lw_123e:
    s_branch L_poll_124
L_poll_124s:
    s_sleep 4
L_poll_124:
    buffer_load_dwordx4 v[32:35], v20, s[40:43], s97 offen sc1
    s_sub_u32 s60, s60, 1
    s_cbranch_scc1 L_poll_124t
    s_waitcnt vmcnt(0)
    v_max3_u32 v38, v32, v33, v34
    v_max_u32 v38, v38, v35
    v_cmp_eq_u32 vcc, -1, v38
    s_cbranch_vccnz L_poll_124s
L_poll_124e:
L_pxj:
    s_cmp_ge_u32 s35, 20
    s_cbranch_scc1 L_pxk
    s_mov_b64 exec, -1
L_pxk:
    v_mov_b32 v8, 162048
L_lw_125:
    ds_read_b32 v9, v8
    s_waitcnt lgkmcnt(0)
    v_cmp_gt_u32 vcc, 3, v9
    s_cbranch_vccz L_lw_125e
    s_sleep 2
    s_sub_u32 s60, s60, 1
    s_cbranch_scc0 L_lw_125
    s_mov_b32 s60, 0
L_lw_125e:
    v_lshrrev_b32 v9, 4, v0
    v_lshl_add_u32 v8, v9, 2, v2
    s_lshl_b32 s96, s3, 9
    s_add_u32 s96, s96, 157824
    v_lshl_add_u32 v8, v8, 2, s96
    v_lshlrev_b32 v9, 3, v0
    v_add_u32 v9, 157824, v9
    v_mov_b32 v10, 162048
    v_mov_b32 v11, 1
    s_lshl_b32 s96, s38, 5
    s_add_u32 s96, s96, 161984
    v_mov_b32 v3, s96
    s_sub_u32 s62, 8, s39
    s_lshl_b32 s98, s34, 5
    s_add_u32 s98, s98, s35
    s_lshl_b32 s98, s98, 8
    s_add_u32 s98, s98, 106496
    v_lshlrev_b32 v39, 2, v0
    s_branch L_t0
L_s_role:
    s_cmp_eq_u32 s3, 7
    s_cbranch_scc1 L_t2gate
    s_cmp_gt_u32 s3, 3
    s_cbranch_scc1 L_fin_prep
    s_mov_b32 s48, s18
    s_mov_b32 s49, s19
    s_mov_b32 s50, 3456
    s_mov_b32 s51, 0x20000
    v_lshrrev_b32 v3, 4, v0
    v_and_b32 v4, 15, v0
    v_lshlrev_b32 v4, 1, v4
    s_lshl_b32 s62, s35, 7
    s_lshl_b32 s63, s3, 5
    s_add_u32 s62, s62, s63
    buffer_load_ushort v82, v4, s[48:51], s62 offen
    v_mov_b32 v72, 162064
L_lw_126:
    ds_read_b32 v73, v72
    s_waitcnt lgkmcnt(0)
    v_cmp_gt_u32 vcc, 4, v73
    s_cbranch_vccz L_lw_126e
    s_sleep 2
    s_sub_u32 s60, s60, 1
    s_cbranch_scc0 L_lw_126
    s_mov_b32 s60, 0
L_lw_126e:
    v_bfe_u32 v72, v0, 2, 1
    v_bfe_u32 v73, v0, 4, 1
    v_lshl_add_u32 v72, v73, 2, v72
    v_and_b32 v73, 8, v0
    v_add_u32 v72, v72, v73
    v_lshrrev_b32 v73, 5, v0
    v_lshl_add_u32 v72, v73, 4, v72
    v_lshlrev_b32 v72, 7, v72
    v_and_b32 v73, 3, v0
    v_lshl_add_u32 v72, v73, 3, v72
    v_and_b32 v73, 8, v0
    v_lshl_add_u32 v72, v73, 3, v72
    v_xor_b32 v72, s63, v72
    v_xor_b32 v73, 32, v72
    v_add_u32 v74, 40960, v72
    v_add_u32 v75, 40960, v73
    v_bfe_u32 v1, v0, 2, 2
    v_bfe_u32 v2, v0, 1, 1
    v_and_b32 v6, 1, v0
    v_lshlrev_b32 v7, 5, v3
    v_lshl_add_u32 v7, v6, 4, v7
    v_lshl_add_u32 v5, v2, 2, v1
    v_mul_u32_u24 v5, 1296, v5
    v_add_u32 v5, v5, v7
    v_add_u32 v5, 147456, v5
    v_bfe_u32 v87, v0, 0, 1
    v_mul_u32_u24 v87, 0xaaaa, v87
    v_add_u32 v87, 0x4444, v87
    ds_read_b64_tr_b16 v[88:89], v72 offset:0
    ds_read_b64_tr_b16 v[90:91], v73 offset:256
    ds_read_b64_tr_b16 v[92:93], v72 offset:4096
    ds_read_b64_tr_b16 v[94:95], v73 offset:4352
    ds_read_b64_tr_b16 v[96:97], v72 offset:8192
    ds_read_b64_tr_b16 v[98:99], v73 offset:8448
    ds_read_b64_tr_b16 v[100:101], v72 offset:12288
    ds_read_b64_tr_b16 v[102:103], v73 offset:12544
    ds_read_b64_tr_b16 v[104:105], v72 offset:16384
    ds_read_b64_tr_b16 v[106:107], v73 offset:16640
    ds_read_b64_tr_b16 v[108:109], v72 offset:20480
    ds_read_b64_tr_b16 v[110:111], v73 offset:20736
    ds_read_b64_tr_b16 v[112:113], v72 offset:24576
    ds_read_b64_tr_b16 v[114:115], v73 offset:24832
    ds_read_b64_tr_b16 v[116:117], v72 offset:28672
    ds_read_b64_tr_b16 v[118:119], v73 offset:28928
    ds_read_b64_tr_b16 v[120:121], v72 offset:32768
    ds_read_b64_tr_b16 v[122:123], v73 offset:33024
    ds_read_b64_tr_b16 v[124:125], v72 offset:36864
    ds_read_b64_tr_b16 v[126:127], v73 offset:37120
    ds_read_b64_tr_b16 v[128:129], v74 offset:0
    ds_read_b64_tr_b16 v[130:131], v75 offset:256
    ds_read_b64_tr_b16 v[132:133], v74 offset:4096
    ds_read_b64_tr_b16 v[134:135], v75 offset:4352
    ds_read_b64_tr_b16 v[136:137], v74 offset:8192
    ds_read_b64_tr_b16 v[138:139], v75 offset:8448
    ds_read_b64_tr_b16 v[140:141], v74 offset:12288
    ds_read_b64_tr_b16 v[142:143], v75 offset:12544
    ds_read_b64_tr_b16 v[144:145], v74 offset:16384
    ds_read_b64_tr_b16 v[146:147], v75 offset:16640
    ds_read_b64_tr_b16 v[148:149], v74 offset:20480
    ds_read_b64_tr_b16 v[150:151], v75 offset:20736
    ds_read_b64_tr_b16 v[152:153], v74 offset:24576
    ds_read_b64_tr_b16 v[154:155], v75 offset:24832
    ds_read_b64_tr_b16 v[156:157], v74 offset:28672
    ds_read_b64_tr_b16 v[158:159], v75 offset:28928
    ds_read_b64_tr_b16 v[160:161], v74 offset:32768
    ds_read_b64_tr_b16 v[162:163], v75 offset:33024
    ds_read_b64_tr_b16 v[164:165], v74 offset:36864
    ds_read_b64_tr_b16 v[166:167], v75 offset:37120
    ds_read_b128 v[8:11], v5 offset:0
    ds_read_b128 v[12:15], v5 offset:128
    ds_read_b128 v[16:19], v5 offset:256
    ds_read_b128 v[20:23], v5 offset:384
    ds_read_b128 v[24:27], v5 offset:512
    ds_read_b128 v[28:31], v5 offset:640
    ds_read_b128 v[32:35], v5 offset:768
    ds_read_b128 v[36:39], v5 offset:896
    ds_read_b128 v[40:43], v5 offset:1024
    ds_read_b128 v[44:47], v5 offset:1152
    v_mov_b32 v48, 0
    v_mov_b32 v49, 0
    v_mov_b32 v50, 0
    v_mov_b32 v51, 0
    v_mov_b32 v52, 0
    v_mov_b32 v53, 0
    v_mov_b32 v54, 0
    v_mov_b32 v55, 0
    v_mov_b32 v56, 0
    v_mov_b32 v57, 0
    v_mov_b32 v58, 0
    v_mov_b32 v59, 0
    s_waitcnt lgkmcnt(9)
    v_smfmac_f32_16x16x64_bf16 v[48:51], v[8:11], v[88:95], v87
    s_waitcnt lgkmcnt(8)
    v_smfmac_f32_16x16x64_bf16 v[48:51], v[12:15], v[96:103], v87
    s_waitcnt lgkmcnt(7)
    v_smfmac_f32_16x16x64_bf16 v[48:51], v[16:19], v[104:111], v87
    s_waitcnt lgkmcnt(6)
    v_smfmac_f32_16x16x64_bf16 v[48:51], v[20:23], v[112:119], v87
    s_waitcnt lgkmcnt(5)
    v_smfmac_f32_16x16x64_bf16 v[48:51], v[24:27], v[120:127], v87
    s_waitcnt lgkmcnt(4)
    v_smfmac_f32_16x16x64_bf16 v[48:51], v[28:31], v[128:135], v87
    s_waitcnt lgkmcnt(3)
    v_smfmac_f32_16x16x64_bf16 v[48:51], v[32:35], v[136:143], v87
    s_waitcnt lgkmcnt(2)
    v_smfmac_f32_16x16x64_bf16 v[48:51], v[36:39], v[144:151], v87
    s_waitcnt lgkmcnt(1)
    v_smfmac_f32_16x16x64_bf16 v[48:51], v[40:43], v[152:159], v87
    s_waitcnt lgkmcnt(0)
    v_smfmac_f32_16x16x64_bf16 v[48:51], v[44:47], v[160:167], v87
    v_mul_u32_u24 v79, 1296, v1
    v_lshl_add_u32 v79, v2, 7, v79
    v_add_u32 v79, v79, v7
    v_add_u32 v79, 82944, v79
    v_mul_u32_u24 v80, 144, v3
    v_add3_u32 v80, v80, v4, s63
    v_add_u32 v80, 90688, v80
    v_lshlrev_b32 v81, 3, v0
    v_add_u32 v81, 88128, v81
    v_add_f32 v84, v48, v49
    v_add_f32 v85, v50, v51
    s_mov_b32 s62, 0xbacccccd
    s_mov_b32 s63, 0xbdd2d3e8
    v_mov_b32 v86, 0xc0135761
    s_waitcnt vmcnt(0)
    v_lshlrev_b32 v82, 16, v82
    v_add_f32 v85, v85, v82
    s_branch L_ffn1
L_fin_prep:
    s_cmp_lg_u32 s3, 6
    s_cbranch_scc1 L_end
    s_cmp_ge_u32 s35, 20
    s_cbranch_scc1 L_end
    s_barrier
L_fin:
    s_mov_b32 s52, s28
    s_mov_b32 s53, s29
    s_mov_b32 s54, 5120
    s_mov_b32 s55, 0x20000
    s_mov_b64 s[4:5], -1
    s_mov_b64 s[6:7], -1
    s_mov_b64 s[8:9], -1
    s_mov_b64 s[10:11], 0xffffff
    s_barrier
    ds_read_b128 v[108:111], v77
    s_barrier
L_yg:
    s_mov_b64 exec, s[4:5]
    buffer_load_dwordx4 v[88:91], v72, s[40:43], 0 offen sc1
    s_mov_b64 exec, s[6:7]
    buffer_load_dwordx4 v[92:95], v73, s[40:43], 0 offen sc1
    s_mov_b64 exec, s[8:9]
    buffer_load_dwordx4 v[96:99], v74, s[40:43], 0 offen sc1
    s_mov_b64 exec, s[10:11]
    buffer_load_dwordx4 v[100:103], v75, s[40:43], 0 offen sc1
    s_mov_b64 exec, -1
    s_sub_u32 s60, s60, 1
    s_cbranch_scc1 L_ygt
    s_waitcnt vmcnt(3)
    v_max3_u32 v3, v88, v89, v90
    v_max_u32 v3, v3, v91
    v_cmp_eq_u32 s[4:5], -1, v3
    s_waitcnt vmcnt(2)
    v_max3_u32 v3, v92, v93, v94
    v_max_u32 v3, v3, v95
    v_cmp_eq_u32 s[6:7], -1, v3
    s_waitcnt vmcnt(1)
    v_max3_u32 v3, v96, v97, v98
    v_max_u32 v3, v3, v99
    v_cmp_eq_u32 s[8:9], -1, v3
    s_waitcnt vmcnt(0)
    v_max3_u32 v3, v100, v101, v102
    v_max_u32 v3, v3, v103
    v_cmp_eq_u32 s[10:11], -1, v3
    s_or_b64 s[16:17], s[4:5], s[6:7]
    s_or_b64 s[16:17], s[16:17], s[8:9]
    s_or_b64 s[16:17], s[16:17], s[10:11]
    s_cbranch_scc1 L_yg
L_ygd:
    v_mfma_f32_16x16x32_bf16 v[112:115], v[104:107], v[88:91], 0
    v_mfma_f32_16x16x32_bf16 v[112:115], v[104:107], v[92:95], v[112:115]
    v_mfma_f32_16x16x32_bf16 v[112:115], v[104:107], v[96:99], v[112:115]
    v_mfma_f32_16x16x32_bf16 v[112:115], v[104:107], v[100:103], v[112:115]
    s_waitcnt lgkmcnt(0)
    v_pk_fma_f32 v[108:109], v[78:79], v[82:83], v[108:109]
    v_pk_fma_f32 v[110:111], v[80:81], v[84:85], v[110:111]
    s_nop 4
    v_add_f32_dpp v112, v112, v112 row_ror:8 row_mask:0xf bank_mask:0xf
    v_add_f32_dpp v113, v113, v113 row_ror:8 row_mask:0xf bank_mask:0xf
    v_add_f32_dpp v114, v114, v114 row_ror:8 row_mask:0xf bank_mask:0xf
    v_add_f32_dpp v115, v115, v115 row_ror:8 row_mask:0xf bank_mask:0xf
    v_pk_fma_f32 v[112:113], v[112:113], v[82:83], v[108:109]
    v_pk_fma_f32 v[114:115], v[114:115], v[84:85], v[110:111]
    v_cvt_pk_bf16_f32 v112, v112, v113
    v_cvt_pk_bf16_f32 v113, v114, v115
    s_mov_b64 exec, 0x00ff00ff
    buffer_store_dwordx2 v[112:113], v76, s[52:55], s57 offen
    s_endpgm
L_t2gate:
    v_mov_b32 v8, 162048
L_lw_127:
    ds_read_b32 v9, v8
    s_waitcnt lgkmcnt(0)
    v_cmp_gt_u32 vcc, 8, v9
    s_cbranch_vccz L_lw_127e
    s_sleep 2
    s_sub_u32 s60, s60, 1
    s_cbranch_scc0 L_lw_127
    s_mov_b32 s60, 0
L_lw_127e:
    ds_read_b32 v9, v8 offset:24
    ds_read_b32 v10, v8 offset:36
    v_add_u32 v5, 212992, v5
    s_waitcnt lgkmcnt(0)
    v_readfirstlane_b32 s61, v9
    v_add_u32 v5, v5, v10
    s_mov_b32 s58, 0x3f80
    s_mov_b32 s59, 0x3f800000
    s_mov_b32 s63, 0xff
L_prb:
    s_bcnt1_i32_b32 s62, s63
    s_mov_b32 s97, s63
    s_ff1_i32_b32 s12, s97
    s_bitset0_b32 s97, s12
    s_mul_i32 s4, s12, 5120
    s_add_u32 s4, s4, s56
    s_and_b32 s96, s4, 0xffffe000
    s_add_u32 s4, s4, s96
    s_cmp_eq_u32 s62, 1
    s_cbranch_scc1 L_pi1
    s_ff1_i32_b32 s13, s97
    s_bitset0_b32 s97, s13
    s_mul_i32 s5, s13, 5120
    s_add_u32 s5, s5, s56
    s_and_b32 s96, s5, 0xffffe000
    s_add_u32 s5, s5, s96
    s_cmp_eq_u32 s62, 2
    s_cbranch_scc1 L_pi2
    s_ff1_i32_b32 s14, s97
    s_bitset0_b32 s97, s14
    s_mul_i32 s6, s14, 5120
    s_add_u32 s6, s6, s56
    s_and_b32 s96, s6, 0xffffe000
    s_add_u32 s6, s6, s96
    s_cmp_eq_u32 s62, 3
    s_cbranch_scc1 L_pi3
    s_ff1_i32_b32 s15, s97
    s_bitset0_b32 s97, s15
    s_mul_i32 s7, s15, 5120
    s_add_u32 s7, s7, s56
    s_and_b32 s96, s7, 0xffffe000
    s_add_u32 s7, s7, s96
    s_cmp_eq_u32 s62, 4
    s_cbranch_scc1 L_pi4
    s_ff1_i32_b32 s16, s97
    s_bitset0_b32 s97, s16
    s_mul_i32 s8, s16, 5120
    s_add_u32 s8, s8, s56
    s_and_b32 s96, s8, 0xffffe000
    s_add_u32 s8, s8, s96
    s_cmp_eq_u32 s62, 5
    s_cbranch_scc1 L_pi5
    s_ff1_i32_b32 s17, s97
    s_bitset0_b32 s97, s17
    s_mul_i32 s9, s17, 5120
    s_add_u32 s9, s9, s56
    s_and_b32 s96, s9, 0xffffe000
    s_add_u32 s9, s9, s96
    s_cmp_eq_u32 s62, 6
    s_cbranch_scc1 L_pi6
    s_ff1_i32_b32 s18, s97
    s_bitset0_b32 s97, s18
    s_mul_i32 s10, s18, 5120
    s_add_u32 s10, s10, s56
    s_and_b32 s96, s10, 0xffffe000
    s_add_u32 s10, s10, s96
    s_cmp_eq_u32 s62, 7
    s_cbranch_scc1 L_pi7
    s_ff1_i32_b32 s19, s97
    s_bitset0_b32 s97, s19
    s_mul_i32 s11, s19, 5120
    s_add_u32 s11, s11, s56
    s_and_b32 s96, s11, 0xffffe000
    s_add_u32 s11, s11, s96
L_pi8:
    buffer_load_dwordx4 v[36:39], v5, s[40:43], s11 offen sc1
L_pi7:
    buffer_load_dwordx4 v[32:35], v5, s[40:43], s10 offen sc1
L_pi6:
    buffer_load_dwordx4 v[28:31], v5, s[40:43], s9 offen sc1
L_pi5:
    buffer_load_dwordx4 v[24:27], v5, s[40:43], s8 offen sc1
L_pi4:
    buffer_load_dwordx4 v[20:23], v5, s[40:43], s7 offen sc1
L_pi3:
    buffer_load_dwordx4 v[16:19], v5, s[40:43], s6 offen sc1
L_pi2:
    buffer_load_dwordx4 v[12:15], v5, s[40:43], s5 offen sc1
    buffer_load_dwordx4 v[8:11], v5, s[40:43], s4 offen sc1
    s_sub_u32 s60, s60, 1
    s_cbranch_scc1 L_pto
    s_waitcnt vmcnt(0)
    v_max3_u32 v3, v8, v9, v10
    v_max_u32 v3, v3, v11
    v_cmp_eq_u32 vcc, -1, v3
    s_cbranch_vccz L_pgot0
    v_max3_u32 v3, v12, v13, v14
    v_max_u32 v3, v3, v15
    v_cmp_eq_u32 vcc, -1, v3
    s_cbranch_vccz L_pgot1
    s_cmp_eq_u32 s62, 2
    s_cbranch_scc1 L_pi2
    v_max3_u32 v3, v16, v17, v18
    v_max_u32 v3, v3, v19
    v_cmp_eq_u32 vcc, -1, v3
    s_cbranch_vccz L_pgot2
    s_cmp_eq_u32 s62, 3
    s_cbranch_scc1 L_pi3
    v_max3_u32 v3, v20, v21, v22
    v_max_u32 v3, v3, v23
    v_cmp_eq_u32 vcc, -1, v3
    s_cbranch_vccz L_pgot3
    s_cmp_eq_u32 s62, 4
    s_cbranch_scc1 L_pi4
    v_max3_u32 v3, v24, v25, v26
    v_max_u32 v3, v3, v27
    v_cmp_eq_u32 vcc, -1, v3
    s_cbranch_vccz L_pgot4
    s_cmp_eq_u32 s62, 5
    s_cbranch_scc1 L_pi5
    v_max3_u32 v3, v28, v29, v30
    v_max_u32 v3, v3, v31
    v_cmp_eq_u32 vcc, -1, v3
    s_cbranch_vccz L_pgot5
    s_cmp_eq_u32 s62, 6
    s_cbranch_scc1 L_pi6
    v_max3_u32 v3, v32, v33, v34
    v_max_u32 v3, v3, v35
    v_cmp_eq_u32 vcc, -1, v3
    s_cbranch_vccz L_pgot6
    s_cmp_eq_u32 s62, 7
    s_cbranch_scc1 L_pi7
    v_max3_u32 v3, v36, v37, v38
    v_max_u32 v3, v3, v39
    v_cmp_eq_u32 vcc, -1, v3
    s_cbranch_vccz L_pgot7
    s_branch L_pi8
L_pgot0:
    v_dot2c_f32_bf16 v64, s58, v8
    v_dot2c_f32_bf16 v65, s59, v8
    v_dot2c_f32_bf16 v66, s58, v9
    v_dot2c_f32_bf16 v67, s59, v9
    v_dot2c_f32_bf16 v68, s58, v10
    v_dot2c_f32_bf16 v69, s59, v10
    v_dot2c_f32_bf16 v70, s58, v11
    v_dot2c_f32_bf16 v71, s59, v11
    s_bitset0_b32 s63, s12
    s_cmp_eq_u32 s63, 0
    s_cbranch_scc1 L_pgd
L_pn0:
    s_cmp_eq_u32 s62, 1
    s_cbranch_scc1 L_prb
    v_max3_u32 v3, v12, v13, v14
    v_max_u32 v3, v3, v15
    v_cmp_eq_u32 vcc, -1, v3
    s_cbranch_vccnz L_pn1
L_pgot1:
    v_dot2c_f32_bf16 v64, s58, v12
    v_dot2c_f32_bf16 v65, s59, v12
    v_dot2c_f32_bf16 v66, s58, v13
    v_dot2c_f32_bf16 v67, s59, v13
    v_dot2c_f32_bf16 v68, s58, v14
    v_dot2c_f32_bf16 v69, s59, v14
    v_dot2c_f32_bf16 v70, s58, v15
    v_dot2c_f32_bf16 v71, s59, v15
    s_bitset0_b32 s63, s13
    s_cmp_eq_u32 s63, 0
    s_cbranch_scc1 L_pgd
L_pn1:
    s_cmp_eq_u32 s62, 2
    s_cbranch_scc1 L_prb
    v_max3_u32 v3, v16, v17, v18
    v_max_u32 v3, v3, v19
    v_cmp_eq_u32 vcc, -1, v3
    s_cbranch_vccnz L_pn2
L_pgot2:
    v_dot2c_f32_bf16 v64, s58, v16
    v_dot2c_f32_bf16 v65, s59, v16
    v_dot2c_f32_bf16 v66, s58, v17
    v_dot2c_f32_bf16 v67, s59, v17
    v_dot2c_f32_bf16 v68, s58, v18
    v_dot2c_f32_bf16 v69, s59, v18
    v_dot2c_f32_bf16 v70, s58, v19
    v_dot2c_f32_bf16 v71, s59, v19
    s_bitset0_b32 s63, s14
    s_cmp_eq_u32 s63, 0
    s_cbranch_scc1 L_pgd
L_pn2:
    s_cmp_eq_u32 s62, 3
    s_cbranch_scc1 L_prb
    v_max3_u32 v3, v20, v21, v22
    v_max_u32 v3, v3, v23
    v_cmp_eq_u32 vcc, -1, v3
    s_cbranch_vccnz L_pn3
L_pgot3:
    v_dot2c_f32_bf16 v64, s58, v20
    v_dot2c_f32_bf16 v65, s59, v20
    v_dot2c_f32_bf16 v66, s58, v21
    v_dot2c_f32_bf16 v67, s59, v21
    v_dot2c_f32_bf16 v68, s58, v22
    v_dot2c_f32_bf16 v69, s59, v22
    v_dot2c_f32_bf16 v70, s58, v23
    v_dot2c_f32_bf16 v71, s59, v23
    s_bitset0_b32 s63, s15
    s_cmp_eq_u32 s63, 0
    s_cbranch_scc1 L_pgd
L_pn3:
    s_cmp_eq_u32 s62, 4
    s_cbranch_scc1 L_prb
    v_max3_u32 v3, v24, v25, v26
    v_max_u32 v3, v3, v27
    v_cmp_eq_u32 vcc, -1, v3
    s_cbranch_vccnz L_pn4
L_pgot4:
    v_dot2c_f32_bf16 v64, s58, v24
    v_dot2c_f32_bf16 v65, s59, v24
    v_dot2c_f32_bf16 v66, s58, v25
    v_dot2c_f32_bf16 v67, s59, v25
    v_dot2c_f32_bf16 v68, s58, v26
    v_dot2c_f32_bf16 v69, s59, v26
    v_dot2c_f32_bf16 v70, s58, v27
    v_dot2c_f32_bf16 v71, s59, v27
    s_bitset0_b32 s63, s16
    s_cmp_eq_u32 s63, 0
    s_cbranch_scc1 L_pgd
L_pn4:
    s_cmp_eq_u32 s62, 5
    s_cbranch_scc1 L_prb
    v_max3_u32 v3, v28, v29, v30
    v_max_u32 v3, v3, v31
    v_cmp_eq_u32 vcc, -1, v3
    s_cbranch_vccnz L_pn5
L_pgot5:
    v_dot2c_f32_bf16 v64, s58, v28
    v_dot2c_f32_bf16 v65, s59, v28
    v_dot2c_f32_bf16 v66, s58, v29
    v_dot2c_f32_bf16 v67, s59, v29
    v_dot2c_f32_bf16 v68, s58, v30
    v_dot2c_f32_bf16 v69, s59, v30
    v_dot2c_f32_bf16 v70, s58, v31
    v_dot2c_f32_bf16 v71, s59, v31
    s_bitset0_b32 s63, s17
    s_cmp_eq_u32 s63, 0
    s_cbranch_scc1 L_pgd
L_pn5:
    s_cmp_eq_u32 s62, 6
    s_cbranch_scc1 L_prb
    v_max3_u32 v3, v32, v33, v34
    v_max_u32 v3, v3, v35
    v_cmp_eq_u32 vcc, -1, v3
    s_cbranch_vccnz L_pn6
L_pgot6:
    v_dot2c_f32_bf16 v64, s58, v32
    v_dot2c_f32_bf16 v65, s59, v32
    v_dot2c_f32_bf16 v66, s58, v33
    v_dot2c_f32_bf16 v67, s59, v33
    v_dot2c_f32_bf16 v68, s58, v34
    v_dot2c_f32_bf16 v69, s59, v34
    v_dot2c_f32_bf16 v70, s58, v35
    v_dot2c_f32_bf16 v71, s59, v35
    s_bitset0_b32 s63, s18
    s_cmp_eq_u32 s63, 0
    s_cbranch_scc1 L_pgd
L_pn6:
    s_cmp_eq_u32 s62, 7
    s_cbranch_scc1 L_prb
    v_max3_u32 v3, v36, v37, v38
    v_max_u32 v3, v3, v39
    v_cmp_eq_u32 vcc, -1, v3
    s_cbranch_vccnz L_pn7
L_pgot7:
    v_dot2c_f32_bf16 v64, s58, v36
    v_dot2c_f32_bf16 v65, s59, v36
    v_dot2c_f32_bf16 v66, s58, v37
    v_dot2c_f32_bf16 v67, s59, v37
    v_dot2c_f32_bf16 v68, s58, v38
    v_dot2c_f32_bf16 v69, s59, v38
    v_dot2c_f32_bf16 v70, s58, v39
    v_dot2c_f32_bf16 v71, s59, v39
    s_bitset0_b32 s63, s19
    s_cmp_eq_u32 s63, 0
    s_cbranch_scc1 L_pgd
L_pn7:
    s_branch L_prb
L_pi1:
L_poll_128:
    buffer_load_dwordx4 v[8:11], v5, s[40:43], s4 offen sc1
    s_sub_u32 s60, s60, 1
    s_cbranch_scc1 L_poll_128t
    s_waitcnt vmcnt(0)
    v_max3_u32 v3, v8, v9, v10
    v_max_u32 v3, v3, v11
    v_cmp_eq_u32 vcc, -1, v3
    s_cbranch_vccnz L_poll_128
L_poll_128e:
    v_dot2c_f32_bf16 v64, s58, v8
    v_dot2c_f32_bf16 v65, s59, v8
    v_dot2c_f32_bf16 v66, s58, v9
    v_dot2c_f32_bf16 v67, s59, v9
    v_dot2c_f32_bf16 v68, s58, v10
    v_dot2c_f32_bf16 v69, s59, v10
    v_dot2c_f32_bf16 v70, s58, v11
    v_dot2c_f32_bf16 v71, s59, v11
L_pgd:
    v_pk_fma_f32 v[64:65], v[64:65], v[48:49], v[40:41]
    v_pk_fma_f32 v[66:67], v[66:67], v[50:51], v[42:43]
    v_pk_fma_f32 v[68:69], v[68:69], v[52:53], v[44:45]
    v_pk_fma_f32 v[70:71], v[70:71], v[54:55], v[46:47]
    v_pk_mul_f32 v[56:57], v[64:65], v[56:57]
    v_pk_mul_f32 v[58:59], v[66:67], v[58:59]
    v_pk_mul_f32 v[60:61], v[68:69], v[60:61]
    v_pk_mul_f32 v[62:63], v[70:71], v[62:63]
    v_cvt_pk_bf16_f32 v8, v56, v57
    v_cvt_pk_bf16_f32 v9, v58, v59
    v_cvt_pk_bf16_f32 v10, v60, v61
    v_cvt_pk_bf16_f32 v11, v62, v63
    ds_write_b128 v4, v[8:11]
    v_pk_add_f32 v[40:41], v[64:65], v[66:67]
    v_pk_add_f32 v[42:43], v[68:69], v[70:71]
    v_pk_mul_f32 v[44:45], v[64:65], v[64:65]
    v_pk_mul_f32 v[46:47], v[66:67], v[66:67]
    v_pk_add_f32 v[40:41], v[40:41], v[42:43]
    v_pk_fma_f32 v[44:45], v[68:69], v[68:69], v[44:45]
    v_pk_fma_f32 v[46:47], v[70:71], v[70:71], v[46:47]
    v_add_f32 v40, v40, v41
    v_pk_add_f32 v[44:45], v[44:45], v[46:47]
    v_add_f32 v41, v44, v45
    ds_write_b64 v7, v[40:41]
    s_waitcnt lgkmcnt(0)
    s_barrier
    v_mov_b32 v16, 0
    v_mov_b32 v17, 0
    v_mov_b32 v18, 0
    v_mov_b32 v19, 0
    v_mov_b32 v20, 0
    v_mov_b32 v21, 0
    v_mov_b32 v22, 0
    v_mov_b32 v23, 0
    v_mov_b32 v24, 0
    v_mov_b32 v25, 0
    v_mov_b32 v26, 0
    v_mov_b32 v27, 0
    v_mov_b32 v28, 0
    v_mov_b32 v29, 0
    v_mov_b32 v30, 0
    v_mov_b32 v31, 0
    v_mov_b32 v32, 0
    v_mov_b32 v33, 0
    v_mov_b32 v34, 0
    v_mov_b32 v35, 0
    ds_write_b128 v6, v[64:67]
    ds_write_b128 v6, v[68:71] offset:16
    s_waitcnt lgkmcnt(0)
    s_cmp_lg_u32 s3, 7
    s_cbranch_scc1 L_ffn2
    s_cmp_lt_u32 s35, 20
    s_cbranch_scc1 L_fin
    s_endpgm
L_ffn1:
    s_barrier
L_ffn1b:
    ds_read_b128 v[8:11], v79
    ds_read_b64 v[30:31], v81 offset:0
    ds_read_b64 v[32:33], v81 offset:512
    ds_read_b64 v[34:35], v81 offset:1024
    ds_read_b64 v[36:37], v81 offset:1536
    ds_read_b64 v[38:39], v81 offset:2048
    ds_read_b128 v[12:15], v79 offset:256
    ds_read_b128 v[16:19], v79 offset:512
    ds_read_b128 v[20:23], v79 offset:768
    ds_read_b128 v[24:27], v79 offset:1024
    s_waitcnt lgkmcnt(9)
    v_smfmac_f32_16x16x64_bf16 v[52:55], v[8:11], v[88:95], v87
    v_smfmac_f32_16x16x64_bf16 v[56:59], v[8:11], v[96:103], v87
    s_waitcnt lgkmcnt(3)
    v_smfmac_f32_16x16x64_bf16 v[52:55], v[12:15], v[104:111], v87
    v_pk_add_f32 v[30:31], v[30:31], v[32:33]
    v_pk_add_f32 v[34:35], v[34:35], v[36:37]
    v_smfmac_f32_16x16x64_bf16 v[56:59], v[12:15], v[112:119], v87
    v_pk_add_f32 v[30:31], v[30:31], v[38:39]
    v_pk_add_f32 v[30:31], v[30:31], v[34:35]
    s_nop 0
    s_waitcnt lgkmcnt(2)
    v_smfmac_f32_16x16x64_bf16 v[52:55], v[16:19], v[120:127], v87
    v_add_f32_dpp v30, v30, v30 quad_perm:[1,0,3,2] row_mask:0xf bank_mask:0xf
    v_add_f32_dpp v31, v31, v31 quad_perm:[1,0,3,2] row_mask:0xf bank_mask:0xf
    v_smfmac_f32_16x16x64_bf16 v[56:59], v[16:19], v[128:135], v87
    v_add_f32_dpp v30, v30, v30 quad_perm:[2,3,0,1] row_mask:0xf bank_mask:0xf
    v_add_f32_dpp v31, v31, v31 quad_perm:[2,3,0,1] row_mask:0xf bank_mask:0xf
    s_waitcnt lgkmcnt(1)
    v_smfmac_f32_16x16x64_bf16 v[52:55], v[20:23], v[136:143], v87
    v_add_f32_dpp v30, v30, v30 row_ror:4 row_mask:0xf bank_mask:0xf
    v_add_f32_dpp v31, v31, v31 row_ror:4 row_mask:0xf bank_mask:0xf
    v_smfmac_f32_16x16x64_bf16 v[56:59], v[20:23], v[144:151], v87
    v_add_f32_dpp v30, v30, v30 row_ror:8 row_mask:0xf bank_mask:0xf
    v_add_f32_dpp v31, v31, v31 row_ror:8 row_mask:0xf bank_mask:0xf
    s_waitcnt lgkmcnt(0)
    v_smfmac_f32_16x16x64_bf16 v[52:55], v[24:27], v[152:159], v87
    v_mul_f32 v48, s62, v30
    v_mul_f32 v49, s62, v31
    v_smfmac_f32_16x16x64_bf16 v[56:59], v[24:27], v[160:167], v87
    v_mul_f32 v7, v84, v48
    v_fma_f32 v49, -v48, v48, -v49
    v_max_f32 v49, 0, v49
    v_add_f32 v49, 0x3727c5ac, v49
    v_rsq_f32 v49, v49
    v_add_f32 v4, v52, v53
    v_add_f32 v4, v4, v7
    s_nop 0
    v_add_f32 v5, v58, v59
    v_add_f32 v4, v4, v5
    v_fma_f32 v4, v4, v49, v85
    v_mul_f32 v5, v4, v4
    v_fma_f32 v5, v5, s63, v86
    v_mul_f32 v5, v5, v4
    v_exp_f32 v5, v5
    s_nop 0
    v_add_f32 v5, 1.0, v5
    v_rcp_f32 v5, v5
    s_nop 0
    v_mul_f32 v4, v4, v5
    v_cvt_pk_bf16_f32 v4, v4, v4
    ds_write_b16 v80, v4
    s_waitcnt lgkmcnt(0)
    s_barrier
    s_endpgm
L_cut:
L_h_t1:
    s_sub_u32 s63, s56, 154
    s_cmp_lt_u32 s63, 16
    s_cbranch_scc0 L_h_noclr
    s_lshl2_add_u32 s62, s63, s3
    s_mul_i32 s62, s62, 4608
    v_mov_b32 v4, -1
    v_mov_b32 v5, -1
    v_mov_b32 v6, -1
    v_mov_b32 v7, -1
    v_lshlrev_b32 v8, 4, v0
    buffer_store_dwordx4 v[4:7], v8, s[40:43], s62 offen offset:0 sc1
    buffer_store_dwordx4 v[4:7], v8, s[40:43], s62 offen offset:1024 sc1
    buffer_store_dwordx4 v[4:7], v8, s[40:43], s62 offen offset:2048 sc1
    buffer_store_dwordx4 v[4:7], v8, s[40:43], s62 offen offset:3072 sc1
    s_add_u32 s62, s62, 4096
    s_bfm_b64 exec, 32, 0
    buffer_store_dwordx4 v[4:7], v8, s[40:43], s62 offen offset:0 sc1
    s_mov_b64 exec, 1
    v_mov_b32 v9, 162100
    v_mov_b32 v10, 1
    s_and_b32 s62, s63, 1
    s_mul_i32 s62, s62, 126
    s_lshl1_add_u32 s63, s63, s62
    s_waitcnt vmcnt(0)
    ds_add_rtn_u32 v10, v9, v10
    s_waitcnt lgkmcnt(0)
    v_readfirstlane_b32 s62, v10
    s_nop 0
    s_cmp_lg_u32 s62, 3
    s_cbranch_scc1 L_h_clrd
    buffer_store_dword v4, v36, s[44:47], s63 offen sc1
L_h_clrd:
    s_mov_b64 exec, -1
L_h_noclr:
    v_lshrrev_b32 v1, 3, v0
    v_mul_u32_u24 v1, 1280, v1
    v_and_b32 v2, 7, v0
    v_lshl_add_u32 v1, v2, 4, v1
    s_lshl2_add_u32 s63, s34, s3
    s_mul_i32 s63, s63, 163840
    s_lshl_b32 s62, s35, 7
    s_add_u32 s63, s63, s62
    s_sub_u32 s63, s63, 2816
    s_lshl_b32 s62, s3, 14
    s_add_u32 s62, s62, 81920
    s_mov_b32 m0, s62
    s_mov_b32 s48, s12
    s_mov_b32 s49, s13
    s_mov_b32 s50, 5242880
    s_mov_b32 s51, 0x20000
    s_add_u32 s100, s39, 1
    s_mov_b32 s62, 8
L_dma_5:
    buffer_load_dwordx4 v1, s[48:51], s63 offen nt lds
    s_add_u32 m0, m0, 1024
    s_add_u32 s63, s63, 10240
    s_cmp_eq_u32 s100, 0
    s_cbranch_scc1 L_dma_5n0
    s_waitcnt vmcnt(7)
    s_cmp_eq_u32 s100, 2
    s_cbranch_scc1 L_dma_5n0
    s_waitcnt vmcnt(5)
L_dma_5n0:
    buffer_load_dwordx4 v1, s[48:51], s63 offen nt lds
    s_add_u32 m0, m0, 1024
    s_add_u32 s63, s63, 10240
    s_cmp_eq_u32 s100, 0
    s_cbranch_scc1 L_dma_5n1
    s_waitcnt vmcnt(7)
    s_cmp_eq_u32 s100, 2
    s_cbranch_scc1 L_dma_5n1
    s_waitcnt vmcnt(5)
L_dma_5n1:
    s_sub_u32 s62, s62, 1
    s_cmp_lg_u32 s62, 0
    s_cbranch_scc1 L_dma_5
    s_cmp_eq_u32 s39, 1
    s_cbranch_scc1 L_h_role
    s_barrier
    s_waitcnt vmcnt(0)
    v_mov_b32 v4, 162060
    v_mov_b32 v5, 1
    s_mov_b64 exec, 1
    ds_add_u32 v4, v5
    s_mov_b64 exec, -1
    s_cmp_eq_u32 s3, 0
    s_cbranch_scc1 L_service
    s_endpgm
L_h_role:
    v_mov_b32 v72, 0
    v_mov_b32 v73, 0
    v_mov_b32 v74, 0
    v_mov_b32 v75, 0
    v_mov_b32 v76, 0
    v_lshrrev_b32 v3, 4, v0
    v_and_b32 v2, 3, v0
    v_bfe_u32 v1, v0, 2, 2
    v_mul_u32_u24 v160, 1280, v3
    v_and_b32 v4, 15, v0
    v_lshl_add_u32 v163, v4, 2, v160
    v_lshl_add_u32 v160, v4, 3, v160
    s_mul_i32 s57, s35, 5120
    s_mul_i32 s62, s3, 320
    s_add_u32 s57, s57, s62
    s_add_u32 s57, s57, 327680
    v_add_u32 v8, 0, v0
    v_mul_u32_u24 v10, 0xccd, v8
    v_lshrrev_b32 v10, 16, v10
    v_mul_u32_u24 v9, 20, v10
    v_sub_u32 v8, v8, v9
    v_mul_u32_u24 v10, 1280, v10
    v_lshl_add_u32 v10, v8, 4, v10
    v_add_u32 v8, 64, v0
    v_mul_u32_u24 v11, 0xccd, v8
    v_lshrrev_b32 v11, 16, v11
    v_mul_u32_u24 v9, 20, v11
    v_sub_u32 v8, v8, v9
    v_mul_u32_u24 v11, 1280, v11
    v_lshl_add_u32 v11, v8, 4, v11
    v_add_u32 v8, 128, v0
    v_mul_u32_u24 v12, 0xccd, v8
    v_lshrrev_b32 v12, 16, v12
    v_mul_u32_u24 v9, 20, v12
    v_sub_u32 v8, v8, v9
    v_mul_u32_u24 v12, 1280, v12
    v_lshl_add_u32 v12, v8, 4, v12
    v_add_u32 v8, 192, v0
    v_mul_u32_u24 v13, 0xccd, v8
    v_lshrrev_b32 v13, 16, v13
    v_mul_u32_u24 v9, 20, v13
    v_sub_u32 v8, v8, v9
    v_mul_u32_u24 v13, 1280, v13
    v_lshl_add_u32 v13, v8, 4, v13
    v_add_u32 v8, 256, v0
    v_mul_u32_u24 v14, 0xccd, v8
    v_lshrrev_b32 v14, 16, v14
    v_mul_u32_u24 v9, 20, v14
    v_sub_u32 v8, v8, v9
    v_mul_u32_u24 v14, 1280, v14
    v_lshl_add_u32 v14, v8, 4, v14
    s_mov_b32 s48, s20
    s_mov_b32 s49, s21
    s_mov_b32 s50, 2211840
    s_mov_b32 s51, 0x20000
    s_mul_i32 s63, s35, 81920
    s_mul_i32 s62, s3, 320
    s_add_u32 s63, s63, s62
    s_mov_b32 m0, s101
    s_mov_b32 s62, 4
L_w2dma:
    buffer_load_dwordx4 v10, s[48:51], s63 offen nt lds
    s_add_u32 m0, m0, 1024
    s_waitcnt vmcnt(7)
    s_cmp_ge_u32 s35, 22
    s_cbranch_scc1 L_w2n0
    s_waitcnt vmcnt(7)
L_w2n0:
    buffer_load_dwordx4 v11, s[48:51], s63 offen nt lds
    s_add_u32 m0, m0, 1024
    s_waitcnt vmcnt(7)
    s_cmp_ge_u32 s35, 22
    s_cbranch_scc1 L_w2n1
    s_waitcnt vmcnt(7)
L_w2n1:
    buffer_load_dwordx4 v12, s[48:51], s63 offen nt lds
    s_add_u32 m0, m0, 1024
    s_waitcnt vmcnt(7)
    s_cmp_ge_u32 s35, 22
    s_cbranch_scc1 L_w2n2
    s_waitcnt vmcnt(7)
L_w2n2:
    buffer_load_dwordx4 v13, s[48:51], s63 offen nt lds
    s_add_u32 m0, m0, 1024
    s_waitcnt vmcnt(7)
    s_cmp_ge_u32 s35, 22
    s_cbranch_scc1 L_w2n3
    s_waitcnt vmcnt(7)
L_w2n3:
    buffer_load_dwordx4 v14, s[48:51], s63 offen nt lds
    s_add_u32 m0, m0, 1024
    s_waitcnt vmcnt(7)
    s_cmp_ge_u32 s35, 22
    s_cbranch_scc1 L_w2n4
    s_waitcnt vmcnt(7)
L_w2n4:
    s_add_u32 s63, s63, 20480
    s_sub_u32 s62, s62, 1
    s_cmp_lg_u32 s62, 0
    s_cbranch_scc1 L_w2dma
    v_lshrrev_b32 v8, 5, v0
    v_lshlrev_b32 v8, 2, v8
    v_bfe_u32 v9, v0, 4, 1
    v_add_u32 v8, v8, v9
    v_mul_u32_u24 v8, 1280, v8
    v_add_u32 v8, s101, v8
    v_and_b32 v10, 15, v0
    v_lshl_add_u32 v9, v10, 2, v8
    v_lshl_add_u32 v8, v10, 3, v8
    s_mov_b32 s62, 0x05040100
    s_mov_b32 s63, 0x07060302
    s_waitcnt vmcnt(0)
    v_mov_b32 v4, 162060
    v_mov_b32 v5, 1
    s_mov_b64 exec, 1
    ds_add_u32 v4, v5
    s_mov_b64 exec, -1
    ds_read_b64 v[16:17], v8 offset:0
    ds_read_b64 v[18:19], v8 offset:320
    ds_read_b64 v[20:21], v8 offset:2560
    ds_read_b64 v[22:23], v8 offset:2880
    ds_read_b64 v[24:25], v8 offset:640
    ds_read_b64 v[26:27], v8 offset:960
    ds_read_b64 v[28:29], v8 offset:3200
    ds_read_b64 v[30:31], v8 offset:3520
    ds_read_b64 v[32:33], v8 offset:10240
    ds_read_b64 v[34:35], v8 offset:10560
    ds_read_b64 v[36:37], v8 offset:12800
    ds_read_b64 v[38:39], v8 offset:13120
    ds_read_b64 v[40:41], v8 offset:10880
    ds_read_b64 v[42:43], v8 offset:11200
    ds_read_b64 v[44:45], v8 offset:13440
    ds_read_b64 v[46:47], v8 offset:13760
    s_waitcnt lgkmcnt(0)
    v_perm_b32 v80, v18, v16, s62
    v_perm_b32 v88, v18, v16, s63
    v_perm_b32 v96, v19, v17, s62
    v_perm_b32 v104, v19, v17, s63
    v_perm_b32 v81, v22, v20, s62
    v_perm_b32 v89, v22, v20, s63
    v_perm_b32 v97, v23, v21, s62
    v_perm_b32 v105, v23, v21, s63
    v_perm_b32 v82, v26, v24, s62
    v_perm_b32 v90, v26, v24, s63
    v_perm_b32 v98, v27, v25, s62
    v_perm_b32 v106, v27, v25, s63
    v_perm_b32 v83, v30, v28, s62
    v_perm_b32 v91, v30, v28, s63
    v_perm_b32 v99, v31, v29, s62
    v_perm_b32 v107, v31, v29, s63
    v_perm_b32 v84, v34, v32, s62
    v_perm_b32 v92, v34, v32, s63
    v_perm_b32 v100, v35, v33, s62
    v_perm_b32 v108, v35, v33, s63
    v_perm_b32 v85, v38, v36, s62
    v_perm_b32 v93, v38, v36, s63
    v_perm_b32 v101, v39, v37, s62
    v_perm_b32 v109, v39, v37, s63
    v_perm_b32 v86, v42, v40, s62
    v_perm_b32 v94, v42, v40, s63
    v_perm_b32 v102, v43, v41, s62
    v_perm_b32 v110, v43, v41, s63
    v_perm_b32 v87, v46, v44, s62
    v_perm_b32 v95, v46, v44, s63
    v_perm_b32 v103, v47, v45, s62
    v_perm_b32 v111, v47, v45, s63
    ds_read_b64 v[16:17], v8 offset:128
    ds_read_b64 v[18:19], v8 offset:448
    ds_read_b64 v[20:21], v8 offset:2688
    ds_read_b64 v[22:23], v8 offset:3008
    ds_read_b64 v[24:25], v8 offset:768
    ds_read_b64 v[26:27], v8 offset:1088
    ds_read_b64 v[28:29], v8 offset:3328
    ds_read_b64 v[30:31], v8 offset:3648
    ds_read_b64 v[32:33], v8 offset:10368
    ds_read_b64 v[34:35], v8 offset:10688
    ds_read_b64 v[36:37], v8 offset:12928
    ds_read_b64 v[38:39], v8 offset:13248
    ds_read_b64 v[40:41], v8 offset:11008
    ds_read_b64 v[42:43], v8 offset:11328
    ds_read_b64 v[44:45], v8 offset:13568
    ds_read_b64 v[46:47], v8 offset:13888
    s_waitcnt lgkmcnt(0)
    v_perm_b32 v112, v18, v16, s62
    v_perm_b32 v120, v18, v16, s63
    v_perm_b32 v128, v19, v17, s62
    v_perm_b32 v136, v19, v17, s63
    v_perm_b32 v113, v22, v20, s62
    v_perm_b32 v121, v22, v20, s63
    v_perm_b32 v129, v23, v21, s62
    v_perm_b32 v137, v23, v21, s63
    v_perm_b32 v114, v26, v24, s62
    v_perm_b32 v122, v26, v24, s63
    v_perm_b32 v130, v27, v25, s62
    v_perm_b32 v138, v27, v25, s63
    v_perm_b32 v115, v30, v28, s62
    v_perm_b32 v123, v30, v28, s63
    v_perm_b32 v131, v31, v29, s62
    v_perm_b32 v139, v31, v29, s63
    v_perm_b32 v116, v34, v32, s62
    v_perm_b32 v124, v34, v32, s63
    v_perm_b32 v132, v35, v33, s62
    v_perm_b32 v140, v35, v33, s63
    v_perm_b32 v117, v38, v36, s62
    v_perm_b32 v125, v38, v36, s63
    v_perm_b32 v133, v39, v37, s62
    v_perm_b32 v141, v39, v37, s63
    v_perm_b32 v118, v42, v40, s62
    v_perm_b32 v126, v42, v40, s63
    v_perm_b32 v134, v43, v41, s62
    v_perm_b32 v142, v43, v41, s63
    v_perm_b32 v119, v46, v44, s62
    v_perm_b32 v127, v46, v44, s63
    v_perm_b32 v135, v47, v45, s62
    v_perm_b32 v143, v47, v45, s63
    ds_read_b32 v16, v9 offset:256
    ds_read_b32 v18, v9 offset:576
    ds_read_b32 v20, v9 offset:2816
    ds_read_b32 v22, v9 offset:3136
    ds_read_b32 v24, v9 offset:896
    ds_read_b32 v26, v9 offset:1216
    ds_read_b32 v28, v9 offset:3456
    ds_read_b32 v30, v9 offset:3776
    ds_read_b32 v32, v9 offset:10496
    ds_read_b32 v34, v9 offset:10816
    ds_read_b32 v36, v9 offset:13056
    ds_read_b32 v38, v9 offset:13376
    ds_read_b32 v40, v9 offset:11136
    ds_read_b32 v42, v9 offset:11456
    ds_read_b32 v44, v9 offset:13696
    ds_read_b32 v46, v9 offset:14016
    s_waitcnt lgkmcnt(0)
    v_perm_b32 v144, v18, v16, s62
    v_perm_b32 v152, v18, v16, s63
    v_perm_b32 v145, v22, v20, s62
    v_perm_b32 v153, v22, v20, s63
    v_perm_b32 v146, v26, v24, s62
    v_perm_b32 v154, v26, v24, s63
    v_perm_b32 v147, v30, v28, s62
    v_perm_b32 v155, v30, v28, s63
    v_perm_b32 v148, v34, v32, s62
    v_perm_b32 v156, v34, v32, s63
    v_perm_b32 v149, v38, v36, s62
    v_perm_b32 v157, v38, v36, s63
    v_perm_b32 v150, v42, v40, s62
    v_perm_b32 v158, v42, v40, s63
    v_perm_b32 v151, v46, v44, s62
    v_perm_b32 v159, v46, v44, s63
    s_mov_b32 s48, s16
    s_mov_b32 s49, s17
    s_mov_b32 s50, 2211840
    s_mov_b32 s51, 0x20000
    s_lshl_b32 s98, s35, 7
    s_mov_b32 s99, 3456
    v_lshrrev_b32 v9, 3, v0
    v_mul_lo_u32 v10, v9, s99
    v_and_b32 v9, 2, v9
    v_xor_b32 v9, v9, v0
    v_and_b32 v9, 7, v9
    v_lshl_add_u32 v10, v9, 4, v10
    v_add_u32 v10, s98, v10
    v_xor_b32 v11, 64, v10
    s_mul_i32 s63, s3, 552960
    s_mov_b32 m0, s101
    s_waitcnt lgkmcnt(0)
    s_cmp_ge_u32 s35, 22
    s_cselect_b32 s100, 2, 1
    s_mov_b32 s62, 10
L_dma_6:
    buffer_load_dwordx4 v10, s[48:51], s63 offen nt lds
    s_add_u32 m0, m0, 1024
    s_add_u32 s63, s63, 27648
    s_cmp_eq_u32 s100, 0
    s_cbranch_scc1 L_dma_6n0
    s_waitcnt vmcnt(7)
    s_cmp_eq_u32 s100, 2
    s_cbranch_scc1 L_dma_6n0
    s_waitcnt vmcnt(7)
L_dma_6n0:
    buffer_load_dwordx4 v11, s[48:51], s63 offen nt lds
    s_add_u32 m0, m0, 1024
    s_add_u32 s63, s63, 27648
    s_cmp_eq_u32 s100, 0
    s_cbranch_scc1 L_dma_6n1
    s_waitcnt vmcnt(7)
    s_cmp_eq_u32 s100, 2
    s_cbranch_scc1 L_dma_6n1
    s_waitcnt vmcnt(7)
L_dma_6n1:
    s_sub_u32 s62, s62, 1
    s_cmp_lg_u32 s62, 0
    s_cbranch_scc1 L_dma_6
    v_mov_b32 v8, 162068
L_lw_7:
    ds_read_b32 v9, v8
    s_waitcnt lgkmcnt(0)
    v_cmp_gt_u32 vcc, 1, v9
    s_cbranch_vccz L_lw_7e
    s_sleep 8
    s_sub_u32 s60, s60, 1
    s_cbranch_scc0 L_lw_7
    s_mov_b32 s60, 0
L_lw_7e:
    s_cmp_lg_u32 s3, 3
    s_cbranch_scc1 L_h_nomo
    v_and_b32 v4, 15, v0
    v_lshlrev_b32 v4, 4, v4
    v_mul_u32_u24 v5, 1280, v3
    v_add_u32 v5, v5, v4
    v_mul_u32_u24 v6, 1296, v3
    v_add_u32 v6, v6, v4
    v_add_u32 v6, 147456, v6
    s_mov_b32 s62, 30720
    s_mov_b32 s63, 25600
    s_branch L_poll_8
L_poll_8s:
    s_sleep 8
L_poll_8:
    buffer_load_dwordx4 v[40:43], v5, s[40:43], s62 offen offset:0 sc1
    buffer_load_dwordx4 v[44:47], v5, s[40:43], s62 offen offset:256 sc1
    buffer_load_dwordx4 v[48:51], v5, s[40:43], s62 offen offset:512 sc1
    buffer_load_dwordx4 v[52:55], v5, s[40:43], s62 offen offset:768 sc1
    buffer_load_dwordx4 v[56:59], v5, s[40:43], s62 offen offset:1024 sc1
    buffer_load_dwordx4 v[60:63], v5, s[40:43], s63 offen offset:0 sc1
    buffer_load_dwordx4 v[64:67], v5, s[40:43], s63 offen offset:256 sc1
    buffer_load_dwordx4 v[68:71], v5, s[40:43], s63 offen offset:512 sc1
    buffer_load_dwordx4 v[72:75], v5, s[40:43], s63 offen offset:768 sc1
    buffer_load_dwordx4 v[76:79], v5, s[40:43], s63 offen offset:1024 sc1
    s_sub_u32 s60, s60, 1
    s_cbranch_scc1 L_poll_8t
    s_waitcnt vmcnt(0)
    v_max3_u32 v7, v40, v41, v42
    v_max3_u32 v7, v7, v43, v44
    v_max3_u32 v7, v7, v45, v46
    v_max3_u32 v7, v7, v47, v48
    v_max3_u32 v7, v7, v49, v50
    v_max3_u32 v7, v7, v51, v52
    v_max3_u32 v7, v7, v53, v54
    v_max3_u32 v7, v7, v55, v56
    v_max3_u32 v7, v7, v57, v58
    v_max3_u32 v7, v7, v59, v60
    v_max3_u32 v7, v7, v61, v62
    v_max3_u32 v7, v7, v63, v64
    v_max3_u32 v7, v7, v65, v66
    v_max3_u32 v7, v7, v67, v68
    v_max3_u32 v7, v7, v69, v70
    v_max3_u32 v7, v7, v71, v72
    v_max3_u32 v7, v7, v73, v74
    v_max3_u32 v7, v7, v75, v76
    v_max3_u32 v7, v7, v77, v78
    v_max_u32 v7, v7, v79
    v_cmp_eq_u32 vcc, -1, v7
    s_cbranch_vccnz L_poll_8s
L_poll_8e:
    ds_write_b128 v6, v[40:43] offset:0
    ds_write_b128 v6, v[44:47] offset:256
    ds_write_b128 v6, v[48:51] offset:512
    ds_write_b128 v6, v[52:55] offset:768
    ds_write_b128 v6, v[56:59] offset:1024
    ds_write_b128 v6, v[60:63] offset:5184
    ds_write_b128 v6, v[64:67] offset:5440
    ds_write_b128 v6, v[68:71] offset:5696
    ds_write_b128 v6, v[72:75] offset:5952
    ds_write_b128 v6, v[76:79] offset:6208
L_h_nomo:
    v_mul_u32_u24 v4, 144, v1
    v_lshl_add_u32 v4, v3, 5, v4
    v_bfe_u32 v5, v0, 1, 1
    v_lshl_add_u32 v4, v5, 4, v4
    v_add_u32 v4, 90688, v4
    v_mov_b32 v5, 162112
    v_and_b32 v6, 1, v0
    v_cmp_eq_u32 vcc, 0, v6
    s_nop 1
    v_cndmask_b32 v161, v5, v4, vcc
    v_cndmask_b32 v162, v4, v5, vcc
    v_bfe_u32 v164, v0, 1, 1
    v_mul_u32_u24 v164, 0xaaaa, v164
    v_add_u32 v164, 0x4444, v164
    s_mov_b32 s100, s3
    s_lshl_b32 s63, s100, 8
    v_and_b32 v8, 15, v0
    v_lshl_add_u32 v8, v8, 4, s63
    v_lshrrev_b32 v9, 4, v0
    v_mul_u32_u24 v5, 1280, v9
    v_add_u32 v5, v5, v8
    v_mul_u32_u24 v4, 1296, v9
    v_add_u32 v4, v4, v8
    v_add_u32 v4, 82944, v4
    v_lshlrev_b32 v6, 1, v5
    v_add_u32 v6, 99328, v6
    s_lshl_b32 s62, s100, 9
    s_add_u32 s62, s62, 88128
    v_lshl_add_u32 v7, v0, 3, s62
    s_mov_b32 s48, s4
    s_mov_b32 s49, s5
    s_mov_b32 s50, 5120
    s_mov_b32 s51, 0x20000
    buffer_load_dwordx4 v[8:11], v5, s[48:51], 0 offen
    s_mov_b32 s62, 20480
    s_mov_b32 s63, 30720
    s_branch L_poll_9
L_poll_9s:
    s_sleep 8
L_poll_9:
    buffer_load_dwordx4 v[12:15], v5, s[40:43], s62 offen sc1
    buffer_load_dwordx4 v[16:19], v5, s[40:43], s63 offen sc1
    s_sub_u32 s60, s60, 1
    s_cbranch_scc1 L_poll_9t
    s_waitcnt vmcnt(0)
    v_max3_u32 v38, v12, v13, v14
    v_max3_u32 v38, v38, v15, v16
    v_max3_u32 v38, v38, v17, v18
    v_max_u32 v38, v38, v19
    v_cmp_eq_u32 vcc, -1, v38
    s_cbranch_vccnz L_poll_9s
L_poll_9e:
    v_lshlrev_b32 v40, 16, v8
    v_and_b32 v41, 0xffff0000, v8
    v_lshlrev_b32 v42, 16, v9
    v_and_b32 v43, 0xffff0000, v9
    v_lshlrev_b32 v44, 16, v10
    v_and_b32 v45, 0xffff0000, v10
    v_lshlrev_b32 v46, 16, v11
    v_and_b32 v47, 0xffff0000, v11
    v_lshlrev_b32 v48, 16, v12
    v_and_b32 v49, 0xffff0000, v12
    v_lshlrev_b32 v50, 16, v13
    v_and_b32 v51, 0xffff0000, v13
    v_lshlrev_b32 v52, 16, v14
    v_and_b32 v53, 0xffff0000, v14
    v_lshlrev_b32 v54, 16, v15
    v_and_b32 v55, 0xffff0000, v15
    v_lshlrev_b32 v56, 16, v16
    v_and_b32 v57, 0xffff0000, v16
    v_lshlrev_b32 v58, 16, v17
    v_and_b32 v59, 0xffff0000, v17
    v_lshlrev_b32 v60, 16, v18
    v_and_b32 v61, 0xffff0000, v18
    v_lshlrev_b32 v62, 16, v19
    v_and_b32 v63, 0xffff0000, v19
    v_mov_b32 v64, 0
    v_mov_b32 v65, 0
    v_mov_b32 v66, 0
    v_mov_b32 v67, 0
    v_mov_b32 v68, 0
    v_mov_b32 v69, 0
    v_mov_b32 v70, 0
    v_mov_b32 v71, 0
    v_bfe_u32 v5, v0, 2, 2
    v_lshlrev_b32 v5, 8, v5
    v_lshrrev_b32 v8, 4, v0
    v_lshl_add_u32 v5, v8, 6, v5
    v_and_b32 v8, 3, v0
    v_lshl_add_u32 v5, v8, 4, v5
    s_lshl_b32 s56, s100, 10
    s_waitcnt vmcnt(0) lgkmcnt(0)
    v_mov_b32 v8, 162064
    v_mov_b32 v9, 1
    s_mov_b64 exec, 1
    ds_add_u32 v8, v9
    s_mov_b64 exec, -1
    s_branch L_t2gate
L_ffn2:
    s_barrier
L_ffn2b:
    ds_read_b128 v[8:11], v161
    ds_read_b128 v[12:15], v162
    s_cmp_eq_u32 s61, 1
    s_cbranch_scc0 L_f2slow
    s_waitcnt lgkmcnt(1)
    v_smfmac_f32_16x16x64_bf16 v[16:19], v[8:11], v[80:87], v164
    v_smfmac_f32_16x16x64_bf16 v[20:23], v[8:11], v[96:103], v164
    s_waitcnt lgkmcnt(0)
    v_smfmac_f32_16x16x64_bf16 v[16:19], v[12:15], v[88:95], v164
    v_smfmac_f32_16x16x64_bf16 v[20:23], v[12:15], v[104:111], v164
    v_smfmac_f32_16x16x64_bf16 v[24:27], v[8:11], v[112:119], v164
    v_smfmac_f32_16x16x64_bf16 v[28:31], v[8:11], v[128:135], v164
    v_smfmac_f32_16x16x64_bf16 v[24:27], v[12:15], v[120:127], v164
    v_smfmac_f32_16x16x64_bf16 v[28:31], v[12:15], v[136:143], v164
    v_smfmac_f32_16x16x64_bf16 v[32:35], v[8:11], v[144:151], v164
    v_smfmac_f32_16x16x64_bf16 v[32:35], v[12:15], v[152:159], v164
    s_nop 0
    v_pk_add_f32 v[16:17], v[16:17], v[18:19]
    v_cvt_pk_bf16_f32 v40, v16, v17
    v_pk_add_f32 v[20:21], v[20:21], v[22:23]
    v_cvt_pk_bf16_f32 v41, v20, v21
    buffer_store_dwordx2 v[40:41], v160, s[40:43], s57 offen
    v_pk_add_f32 v[24:25], v[24:25], v[26:27]
    v_cvt_pk_bf16_f32 v42, v24, v25
    v_pk_add_f32 v[28:29], v[28:29], v[30:31]
    v_cvt_pk_bf16_f32 v43, v28, v29
    buffer_store_dwordx2 v[42:43], v160, s[40:43], s57 offen offset:128
    v_pk_add_f32 v[32:33], v[32:33], v[34:35]
    v_cvt_pk_bf16_f32 v44, v32, v33
    buffer_store_dword v44, v163, s[40:43], s57 offen offset:256
L_f2done:
    s_barrier
    s_endpgm
L_f2slow:
    s_waitcnt lgkmcnt(1)
    v_smfmac_f32_16x16x64_bf16 v[16:19], v[8:11], v[80:87], v164
    v_smfmac_f32_16x16x64_bf16 v[20:23], v[8:11], v[96:103], v164
    s_waitcnt lgkmcnt(0)
    v_smfmac_f32_16x16x64_bf16 v[16:19], v[12:15], v[88:95], v164
    v_smfmac_f32_16x16x64_bf16 v[20:23], v[12:15], v[104:111], v164
    v_smfmac_f32_16x16x64_bf16 v[24:27], v[8:11], v[112:119], v164
    v_smfmac_f32_16x16x64_bf16 v[28:31], v[8:11], v[128:135], v164
    v_smfmac_f32_16x16x64_bf16 v[24:27], v[12:15], v[120:127], v164
    v_smfmac_f32_16x16x64_bf16 v[28:31], v[12:15], v[136:143], v164
    v_smfmac_f32_16x16x64_bf16 v[32:35], v[8:11], v[144:151], v164
    v_smfmac_f32_16x16x64_bf16 v[32:35], v[12:15], v[152:159], v164
    s_nop 0
    v_pk_add_f32 v[16:17], v[16:17], v[18:19]
    v_cvt_pk_bf16_f32 v40, v16, v17
    v_pk_add_f32 v[20:21], v[20:21], v[22:23]
    v_cvt_pk_bf16_f32 v41, v20, v21
    buffer_store_dwordx2 v[40:41], v160, s[40:43], s57 offen sc1
    v_pk_add_f32 v[24:25], v[24:25], v[26:27]
    v_cvt_pk_bf16_f32 v42, v24, v25
    v_pk_add_f32 v[28:29], v[28:29], v[30:31]
    v_cvt_pk_bf16_f32 v43, v28, v29
    buffer_store_dwordx2 v[42:43], v160, s[40:43], s57 offen offset:128 sc1
    v_pk_add_f32 v[32:33], v[32:33], v[34:35]
    v_cvt_pk_bf16_f32 v44, v32, v33
    buffer_store_dword v44, v163, s[40:43], s57 offen offset:256 sc1
    s_branch L_f2done
L_poll_3t:
    s_mov_b32 s60, 0
    s_waitcnt vmcnt(0)
    s_branch L_poll_3e
L_poll_8t:
    s_mov_b32 s60, 0
    s_waitcnt vmcnt(0)
    s_branch L_poll_8e
L_poll_9t:
    s_mov_b32 s60, 0
    s_waitcnt vmcnt(0)
    s_branch L_poll_9e
L_poll_101t:
    s_mov_b32 s60, 0
    s_waitcnt vmcnt(0)
    s_branch L_poll_101e
L_pfast:
    buffer_store_dword v12, v108, s[40:43], s101 offen
    buffer_store_dword v12, v110, s[40:43], s101 offen
    s_branch L_pdone
L_poll_103t:
    s_mov_b32 s60, 0
    s_waitcnt vmcnt(0)
    s_branch L_poll_103e
L_poll_105t:
    s_mov_b32 s60, 0
    s_waitcnt vmcnt(0)
    s_branch L_poll_105e
L_poll_108t:
    s_mov_b32 s60, 0
    s_waitcnt vmcnt(0)
    s_branch L_poll_108e
L_poll_110t:
    s_mov_b32 s60, 0
    s_waitcnt vmcnt(0)
    s_branch L_poll_110e
L_poll_114t:
    s_mov_b32 s60, 0
    s_waitcnt vmcnt(0)
    s_branch L_poll_114e
L_poll_116t:
    s_mov_b32 s60, 0
    s_waitcnt vmcnt(0)
    s_branch L_poll_116e
L_ycs:
    buffer_store_dwordx4 v[24:27], v22, s[40:43], 0 offen offset:0 sc1
    buffer_store_dwordx4 v[24:27], v22, s[40:43], 0 offen offset:1024 sc1
    buffer_store_dwordx4 v[24:27], v22, s[40:43], 0 offen offset:2048 sc1
    buffer_store_dwordx4 v[24:27], v22, s[40:43], 0 offen offset:3072 sc1
    buffer_store_dwordx4 v[24:27], v23, s[40:43], 0 offen offset:0 sc1
    s_branch L_ycd
L_poll_117t:
    s_mov_b32 s60, 0
    s_waitcnt vmcnt(0)
    s_branch L_poll_117e
L_poll_122t:
    s_mov_b32 s60, 0
    s_waitcnt vmcnt(0)
    s_branch L_poll_122e
L_poll_124t:
    s_mov_b32 s60, 0
    s_waitcnt vmcnt(0)
    s_branch L_poll_124e
L_ygt:
    s_waitcnt vmcnt(0)
    s_branch L_ygd
L_pto:
    s_mov_b32 s60, 0
    s_waitcnt vmcnt(0)
    s_branch L_pgot0
L_poll_128t:
    s_mov_b32 s60, 0
    s_waitcnt vmcnt(0)
    s_branch L_poll_128e
L_end:
    s_endpgm
L_codeend:
.section .rodata,"a"
.p2align 6
.amdhsa_kernel adaLN_cond__sliding_block_cached__dense_activation_gelu__decode_kernel
  .amdhsa_next_free_vgpr 168
  .amdhsa_next_free_sgpr 102
  .amdhsa_accum_offset 168
  .amdhsa_group_segment_fixed_size 0
  .amdhsa_kernarg_size 120
  .amdhsa_user_sgpr_count 2
  .amdhsa_user_sgpr_kernarg_segment_ptr 1
  .amdhsa_system_sgpr_workgroup_id_x 1
.end_amdhsa_kernel
```

```asm
; @launch grid=(256,1,1) block=(768,1,1) lds=162176
.amdgcn_target "amdgcn-amd-amdhsa--gfx950"
.text
.globl adaLN_cond__sliding_block_cached__dense_activation_gelu__decode_kernel
.p2align 8
.type adaLN_cond__sliding_block_cached__dense_activation_gelu__decode_kernel,@function
adaLN_cond__sliding_block_cached__dense_activation_gelu__decode_kernel:
    s_load_dwordx16 s[4:19], s[0:1], 0
    s_load_dwordx8 s[20:27], s[0:1], 64
    s_load_dwordx4 s[28:31], s[0:1], 96
    s_load_dwordx2 s[32:33], s[0:1], 112
    s_cmp_ge_u32 s2, 256
    s_cbranch_scc1 L_end
    v_lshrrev_b32 v1, 6, v0
    v_mul_u32_u24 v2, 36, v0
    v_readfirstlane_b32 s3, v1
    v_and_b32 v0, 63, v0
    s_and_b32 s34, s2, 7
    s_lshr_b32 s35, s2, 3
    s_cmp_lg_u32 s35, 21
    s_cbranch_scc1 L_nopf
    s_getpc_b64 s[48:49]
L_pc:
    v_min_u32 v2, L_codeend-L_pc-4, v2
    v_mov_b32 v3, s49
    v_add_co_u32 v2, vcc, s48, v2
    s_nop 1
    v_addc_co_u32 v3, vcc, 0, v3, vcc
    global_load_dword v152, v[2:3], off
L_nopf:
    s_lshr_b32 s36, s35, 3
    s_lshl2_add_u32 s36, s34, s36
    s_bfe_u32 s37, s35, 0x20001
    s_and_b32 s38, s35, 1
    s_cmp_lt_u32 s35, 27
    s_cselect_b32 s39, 1, 0
    s_cmp_eq_u32 s34, 2
    s_cselect_b32 s39, s39, 0
    s_sub_u32 s62, s34, 3
    s_and_b32 s62, s62, 7
    s_mul_i32 s56, s35, 7
    s_add_u32 s56, s56, s62
    s_cmp_eq_u32 s62, 7
    s_cselect_b32 s56, 255, s56
    s_mov_b32 s60, 1000000
    s_mov_b32 s61, 0
    v_mov_b32 v36, 0
    s_cmp_lt_u32 s3, 4
    s_cbranch_scc1 L_helpers
    s_sub_u32 s3, s3, 4
    s_cmp_ge_u32 s35, 22
    s_cselect_b32 s59, 1, 0
    s_add_u32 s62, s3, s59
    s_cmp_ge_u32 s62, 6
    s_cselect_b32 s62, s39, 0
    s_cmp_eq_u32 s62, 1
    s_cbranch_scc1 L_proxy
    s_cmp_eq_u32 s59, 1
    s_cselect_b32 s100, 0, 81920
    s_lshl_b32 s62, s3, 13
    s_add_u32 s100, s100, s62
    s_and_b32 s62, s39, s59
    s_cselect_b32 s100, -1, s100
    s_mov_b32 s101, 0
L_stream:
    s_lshl_b32 s62, s37, 5
    s_add_u32 s62, s62, s36
    s_lshl_b32 s63, s62, 21
    s_lshl_b32 s96, s38, 18
    s_add_u32 s63, s63, s96
    s_add_u32 s63, s63, 1572864
    v_lshlrev_b32 v1, 4, v0
    s_lshl_b32 s96, s3, 12
    v_add_u32 v1, s96, v1
    s_mov_b32 s97, 0
    s_mov_b32 s50, 262144
    s_mov_b32 s51, 0x20000
    s_waitcnt lgkmcnt(0)
    s_add_u32 s48, s6, s63
    s_addc_u32 s49, s7, 0
    s_cmp_lt_u32 s56, 40
    s_cbranch_scc0 L_nob0
    s_barrier
L_nob0:
    buffer_load_dwordx4 v[40:43], v1, s[48:51], s97 offen offset:0 nt
    buffer_load_dwordx4 v[44:47], v1, s[48:51], s97 offen offset:1024 nt
    s_cmp_lt_u32 s56, 40
    s_cbranch_scc1 L_stream2
    s_barrier
    s_branch L_stream2
L_helpers:
    s_cmp_lg_u32 s3, 0
    s_cbranch_scc1 L_noinit
    v_lshlrev_b32 v1, 2, v0
    v_add_u32 v1, 161920, v1
    ds_write_b32 v1, v36
L_noinit:
    s_waitcnt lgkmcnt(0)
    s_mov_b32 s40, s32
    s_mov_b32 s41, s33
    s_mov_b32 s42, 589824
    s_mov_b32 s43, 0x20000
    s_mov_b32 s44, s30
    s_mov_b32 s45, s31
    s_mov_b32 s46, 256
    s_mov_b32 s47, 0x20000
    s_lshl2_add_u32 s62, s35, s3
    s_cmp_eq_u32 s62, 87
    s_cbranch_scc1 L_touch
L_notp:
    s_mul_i32 s101, s3, 20480
    s_mov_b32 s96, s56
    s_cmp_lt_u32 s56, 40
    s_cbranch_scc0 L_nothalf
    s_cmp_lt_u32 s3, 2
    s_cbranch_scc1 L_unit
    s_add_u32 s62, s56, 20
    s_cmp_eq_u32 s3, 2
    s_cbranch_scc1 L_job
    s_barrier
    s_branch L_service
L_nothalf:
    s_cmp_lt_u32 s56, 144
    s_cbranch_scc1 L_unit
    s_sub_u32 s62, s56, 144
    s_cmp_lt_u32 s62, 10
    s_cbranch_scc0 L_nojob
    s_cmp_lt_u32 s3, 2
    s_cbranch_scc0 L_nojob
    s_mul_i32 s63, s3, 10
    s_add_u32 s62, s62, s63
L_job:
    s_cmp_lt_u32 s62, 59
    s_cbranch_scc0 L_end
    s_mov_b32 s100, s101
    s_lshl_b32 s101, s62, 9
    s_add_u32 s101, s101, 172032
    s_cmp_lt_u32 s62, 27
    s_cselect_b32 s63, 0, 27
    s_cselect_b32 s3, 7, 6
    s_cmp_lt_u32 s62, 54
    s_cselect_b32 s63, s63, 32
    s_cselect_b32 s3, s3, 5
    s_sub_u32 s35, s62, s63
    s_mov_b32 s34, 2
    s_lshr_b32 s36, s35, 3
    s_add_u32 s36, s36, 8
    s_bfe_u32 s37, s35, 0x20001
    s_and_b32 s38, s35, 1
    s_mov_b32 s59, 0
    s_branch L_stream
L_nojob:
    s_barrier
    s_cmp_ge_u32 s35, 22
    s_cbranch_scc1 L_h_t1
    s_cmp_eq_u32 s39, 1
    s_cbranch_scc1 L_h_role
    s_cmp_lt_u32 s96, 144
    s_cbranch_scc1 L_unit
    s_cmp_eq_u32 s3, 3
    s_cbranch_scc1 L_service
    s_endpgm
L_unit:
    v_lshrrev_b32 v3, 4, v0
    v_and_b32 v4, 3, v0
    v_bfe_u32 v7, v0, 2, 2
    s_mov_b32 s14, s3
    s_mov_b32 s15, 3
    s_sub_u32 s62, s96, 40
    s_cmp_lt_u32 s62, 64
    s_cbranch_scc1 L_u_q
    s_mov_b32 s100, 1
    s_sub_u32 s96, s96, 84
    s_cmp_lt_u32 s56, 40
    s_cbranch_scc0 L_u_full
    s_mov_b32 s100, 0
    s_lshr_b32 s96, s56, 1
    s_and_b32 s62, s56, 1
    s_lshl1_add_u32 s14, s62, s14
    s_mov_b32 s15, 1
L_u_full:
    s_mov_b32 s97, 0
    s_mov_b32 s99, 7680
    s_mov_b32 s48, s26
    s_mov_b32 s49, s27
    s_mov_b32 s50, 4915200
    s_mov_b32 s51, 0x20000
    s_mov_b32 s52, s24
    s_mov_b32 s53, s25
    s_mov_b32 s54, 5120
    s_mov_b32 s55, 0x20000
    v_and_b32 v6, 15, v0
    v_lshlrev_b32 v6, 4, v6
    v_mul_u32_u24 v5, 1280, v3
    v_add_u32 v5, v5, v6
    s_mul_i32 s62, s14, 320
    buffer_load_dwordx4 v[8:11], v5, s[52:55], s62 offen
    s_mov_b32 exec_lo, 0x000f000f
    s_mov_b32 exec_hi, 0x000f000f
    buffer_load_dwordx4 v[12:15], v5, s[52:55], s62 offen offset:256
    s_mov_b64 exec, -1
    s_lshl_b32 s98, s96, 7
    s_mul_i32 s13, s96, 0x199a
    s_lshr_b32 s13, s13, 16
    s_cmp_lg_u32 s13, 1
    s_cbranch_scc1 L_u_go
    s_mov_b32 s52, s4
    s_mov_b32 s53, s5
    s_mov_b32 s54, 5120
    s_mov_b32 s55, 0x20000
    v_mul_u32_u24 v5, 1280, v4
    v_lshlrev_b32 v64, 5, v7
    v_lshl_add_u32 v64, v3, 3, v64
    v_add_u32 v64, v64, v5
    v_lshrrev_b32 v6, 2, v0
    v_lshl_add_u32 v6, v6, 4, v5
    s_sub_u32 s62, s98, 1280
    buffer_load_dwordx4 v[16:19], v6, s[52:55], 0 offen offset:0
    buffer_load_dwordx4 v[20:23], v6, s[52:55], 0 offen offset:256
    buffer_load_dwordx4 v[24:27], v6, s[52:55], 0 offen offset:512
    buffer_load_dwordx4 v[28:31], v6, s[52:55], 0 offen offset:768
    buffer_load_dwordx4 v[32:35], v6, s[52:55], 0 offen offset:1024
    buffer_load_dwordx2 v[66:67], v64, s[52:55], s62 offen
    s_branch L_u_go
L_u_q:
    s_mov_b32 s97, 1
    s_mov_b32 s99, 8192
    s_mov_b32 s100, 2
    s_lshl_b32 s98, s62, 7
    s_mov_b32 s48, s10
    s_mov_b32 s49, s11
    s_mov_b32 s50, 5242880
    s_mov_b32 s51, 0x20000
L_u_go:
    v_lshrrev_b32 v6, 3, v0
    v_mul_lo_u32 v1, v6, s99
    v_and_b32 v6, 2, v6
    v_xor_b32 v6, v6, v0
    v_and_b32 v6, 7, v6
    v_lshl_add_u32 v1, v6, 4, v1
    v_add_u32 v1, s98, v1
    v_xor_b32 v2, 64, v1
    s_mul_i32 s63, s99, s14
    s_mul_i32 s63, s63, 160
    s_lshl_b32 s59, s99, 3
    s_mov_b32 m0, s101
    s_mov_b32 s62, 10
L_dma_1:
    buffer_load_dwordx4 v1, s[48:51], s63 offen nt lds
    s_add_u32 m0, m0, 1024
    s_add_u32 s63, s63, s59
    s_cmp_eq_u32 s100, 0
    s_cbranch_scc1 L_dma_1n0
    s_waitcnt vmcnt(5)
    s_cmp_eq_u32 s100, 2
    s_cbranch_scc1 L_dma_1n0
    s_waitcnt vmcnt(5)
L_dma_1n0:
    buffer_load_dwordx4 v2, s[48:51], s63 offen nt lds
    s_add_u32 m0, m0, 1024
    s_add_u32 s63, s63, s59
    s_cmp_eq_u32 s100, 0
    s_cbranch_scc1 L_dma_1n1
    s_waitcnt vmcnt(5)
    s_cmp_eq_u32 s100, 2
    s_cbranch_scc1 L_dma_1n1
    s_waitcnt vmcnt(5)
L_dma_1n1:
    s_sub_u32 s62, s62, 1
    s_cmp_lg_u32 s62, 0
    s_cbranch_scc1 L_dma_1
    v_min_u32 v65, 15, v0
    v_and_b32 v6, 1, v65
    v_mul_u32_u24 v6, 126, v6
    v_lshl_add_u32 v65, v65, 1, v6
    v_mov_b32 v68, 0
    s_cmp_lt_u32 s56, 40
    s_cbranch_scc1 L_u_nofl
    buffer_load_dword v68, v65, s[44:47], 0 offen sc1
L_u_nofl:
    s_cmp_lt_u32 s56, 144
    s_cbranch_scc0 L_u_nob
    s_barrier
L_u_nob:
    v_lshrrev_b32 v60, 4, v0
    v_lshlrev_b32 v60, 10, v60
    v_bfe_u32 v6, v0, 2, 2
    v_lshl_add_u32 v60, v6, 7, v60
    v_and_b32 v6, 3, v0
    v_lshl_add_u32 v60, v6, 3, v60
    v_bfe_u32 v6, v0, 3, 2
    v_lshl_add_u32 v60, v6, 5, v60
    v_xor_b32 v61, 32, v60
    v_xor_b32 v62, 64, v60
    v_xor_b32 v63, 0x60, v60
    v_add_u32 v60, s101, v60
    v_add_u32 v61, s101, v61
    v_add_u32 v62, s101, v62
    v_add_u32 v63, s101, v63
    v_mov_b32 v56, 1.0
    v_mov_b32 v57, 1.0
    v_mov_b32 v58, 1.0
    v_mov_b32 v59, 1.0
    s_mov_b32 s58, 0
    v_lshl_add_u32 v69, v7, 2, v3
    v_lshl_add_u32 v69, v4, 4, v69
    v_and_b32 v64, 15, v0
    v_lshlrev_b32 v64, 3, v64
    s_cmp_eq_u32 s97, 1
    s_cbranch_scc1 L_u_q2
    v_mul_u32_u24 v6, 1280, v3
    v_add_u32 v64, v64, v6
    s_mul_i32 s63, s13, 3840
    s_add_u32 s57, s98, s63
    s_add_u32 s57, s57, 10240
    s_cmp_lt_u32 s56, 40
    s_cbranch_scc0 L_u_nat
    v_lshrrev_b32 v69, 1, v3
    v_lshlrev_b32 v69, 3, v69
    v_lshl_add_u32 v69, v7, 4, v69
    v_lshl_add_u32 v69, v4, 1, v69
    v_and_b32 v6, 1, v3
    v_add_u32 v69, v69, v6
    s_lshr_b32 s62, s56, 1
    s_lshl_b32 s57, s62, 11
    s_cmp_ge_u32 s62, 10
    s_cselect_b32 s62, -19968, 0
    s_add_u32 s57, s57, s62
    s_and_b32 s62, s56, 1
    s_lshl_b32 s62, s62, 8
    s_add_u32 s57, s57, s62
    v_lshrrev_b32 v64, 5, v0
    v_lshlrev_b32 v64, 10, v64
    v_and_b32 v6, 31, v0
    v_lshl_add_u32 v64, v6, 3, v64
L_u_nat:
    s_cmp_eq_u32 s13, 4
    s_cselect_b32 s58, 1.0, 0
    s_cmp_eq_u32 s13, 1
    s_cselect_b32 s58, 1.0, s58
    s_cselect_b32 s56, 1, 0
    s_cmp_eq_u32 s14, 0
    s_cselect_b32 s58, s58, 0
    s_waitcnt vmcnt(20)
    s_mov_b32 s62, 0xbfb8aa3b
    v_lshlrev_b32 v40, 16, v8
    v_and_b32 v41, 0xffff0000, v8
    v_lshlrev_b32 v42, 16, v9
    v_and_b32 v43, 0xffff0000, v9
    v_lshlrev_b32 v44, 16, v10
    v_and_b32 v45, 0xffff0000, v10
    v_lshlrev_b32 v46, 16, v11
    v_and_b32 v47, 0xffff0000, v11
    v_mul_f32 v48, s62, v40
    v_mul_f32 v49, s62, v41
    v_mul_f32 v50, s62, v42
    v_mul_f32 v51, s62, v43
    v_mul_f32 v52, s62, v44
    v_mul_f32 v53, s62, v45
    v_mul_f32 v54, s62, v46
    v_mul_f32 v55, s62, v47
    v_exp_f32 v48, v48
    v_exp_f32 v49, v49
    v_exp_f32 v50, v50
    v_exp_f32 v51, v51
    v_exp_f32 v52, v52
    v_exp_f32 v53, v53
    v_exp_f32 v54, v54
    v_exp_f32 v55, v55
    v_add_f32 v48, 1.0, v48
    v_add_f32 v49, 1.0, v49
    v_add_f32 v50, 1.0, v50
    v_add_f32 v51, 1.0, v51
    v_add_f32 v52, 1.0, v52
    v_add_f32 v53, 1.0, v53
    v_add_f32 v54, 1.0, v54
    v_add_f32 v55, 1.0, v55
    v_rcp_f32 v48, v48
    v_rcp_f32 v49, v49
    v_rcp_f32 v50, v50
    v_rcp_f32 v51, v51
    v_rcp_f32 v52, v52
    v_rcp_f32 v53, v53
    v_rcp_f32 v54, v54
    v_rcp_f32 v55, v55
    v_mul_f32 v40, v40, v48
    v_mul_f32 v41, v41, v49
    v_mul_f32 v42, v42, v50
    v_mul_f32 v43, v43, v51
    v_mul_f32 v44, v44, v52
    v_mul_f32 v45, v45, v53
    v_mul_f32 v46, v46, v54
    v_mul_f32 v47, v47, v55
    v_cvt_pk_bf16_f32 v8, v40, v41
    v_cvt_pk_bf16_f32 v9, v42, v43
    v_cvt_pk_bf16_f32 v10, v44, v45
    v_cvt_pk_bf16_f32 v11, v46, v47
    v_lshlrev_b32 v40, 16, v12
    v_and_b32 v41, 0xffff0000, v12
    v_lshlrev_b32 v42, 16, v13
    v_and_b32 v43, 0xffff0000, v13
    v_lshlrev_b32 v44, 16, v14
    v_and_b32 v45, 0xffff0000, v14
    v_lshlrev_b32 v46, 16, v15
    v_and_b32 v47, 0xffff0000, v15
    v_mul_f32 v48, s62, v40
    v_mul_f32 v49, s62, v41
    v_mul_f32 v50, s62, v42
    v_mul_f32 v51, s62, v43
    v_mul_f32 v52, s62, v44
    v_mul_f32 v53, s62, v45
    v_mul_f32 v54, s62, v46
    v_mul_f32 v55, s62, v47
    v_exp_f32 v48, v48
    v_exp_f32 v49, v49
    v_exp_f32 v50, v50
    v_exp_f32 v51, v51
    v_exp_f32 v52, v52
    v_exp_f32 v53, v53
    v_exp_f32 v54, v54
    v_exp_f32 v55, v55
    v_add_f32 v48, 1.0, v48
    v_add_f32 v49, 1.0, v49
    v_add_f32 v50, 1.0, v50
    v_add_f32 v51, 1.0, v51
    v_add_f32 v52, 1.0, v52
    v_add_f32 v53, 1.0, v53
    v_add_f32 v54, 1.0, v54
    v_add_f32 v55, 1.0, v55
    v_rcp_f32 v48, v48
    v_rcp_f32 v49, v49
    v_rcp_f32 v50, v50
    v_rcp_f32 v51, v51
    v_rcp_f32 v52, v52
    v_rcp_f32 v53, v53
    v_rcp_f32 v54, v54
    v_rcp_f32 v55, v55
    v_mul_f32 v40, v40, v48
    v_mul_f32 v41, v41, v49
    v_mul_f32 v42, v42, v50
    v_mul_f32 v43, v43, v51
    v_mul_f32 v44, v44, v52
    v_mul_f32 v45, v45, v53
    v_mul_f32 v46, v46, v54
    v_mul_f32 v47, v47, v55
    v_cvt_pk_bf16_f32 v12, v40, v41
    v_cvt_pk_bf16_f32 v13, v42, v43
    v_cvt_pk_bf16_f32 v14, v44, v45
    v_cvt_pk_bf16_f32 v15, v46, v47
    s_mul_i32 s62, s3, 1344
    s_add_u32 s62, s62, 151552
    v_mul_u32_u24 v5, 336, v3
    v_and_b32 v6, 15, v0
    v_lshl_add_u32 v5, v6, 4, v5
    v_add_u32 v5, s62, v5
    ds_write_b128 v5, v[8:11]
    s_mov_b32 exec_lo, 0x000f000f
    s_mov_b32 exec_hi, 0x000f000f
    ds_write_b128 v5, v[12:15] offset:256
    s_mov_b64 exec, -1
    v_mul_u32_u24 v5, 336, v4
    v_lshl_add_u32 v5, v3, 4, v5
    v_add_u32 v5, s62, v5
    s_mov_b32 s59, 0x3e800000
    s_cmp_eq_u32 s56, 0
    s_cbranch_scc1 L_u_nost
    v_mov_b32 v40, 0
    v_mov_b32 v41, 0
    s_mov_b32 s62, 0x3f803f80
    v_dot2c_f32_bf16 v40, s62, v16
    v_dot2c_f32_bf16 v41, v16, v16
    v_dot2c_f32_bf16 v40, s62, v17
    v_dot2c_f32_bf16 v41, v17, v17
    v_dot2c_f32_bf16 v40, s62, v18
    v_dot2c_f32_bf16 v41, v18, v18
    v_dot2c_f32_bf16 v40, s62, v19
    v_dot2c_f32_bf16 v41, v19, v19
    v_dot2c_f32_bf16 v40, s62, v20
    v_dot2c_f32_bf16 v41, v20, v20
    v_dot2c_f32_bf16 v40, s62, v21
    v_dot2c_f32_bf16 v41, v21, v21
    v_dot2c_f32_bf16 v40, s62, v22
    v_dot2c_f32_bf16 v41, v22, v22
    v_dot2c_f32_bf16 v40, s62, v23
    v_dot2c_f32_bf16 v41, v23, v23
    v_dot2c_f32_bf16 v40, s62, v24
    v_dot2c_f32_bf16 v41, v24, v24
    v_dot2c_f32_bf16 v40, s62, v25
    v_dot2c_f32_bf16 v41, v25, v25
    v_dot2c_f32_bf16 v40, s62, v26
    v_dot2c_f32_bf16 v41, v26, v26
    v_dot2c_f32_bf16 v40, s62, v27
    v_dot2c_f32_bf16 v41, v27, v27
    v_dot2c_f32_bf16 v40, s62, v28
    v_dot2c_f32_bf16 v41, v28, v28
    v_dot2c_f32_bf16 v40, s62, v29
    v_dot2c_f32_bf16 v41, v29, v29
    v_dot2c_f32_bf16 v40, s62, v30
    v_dot2c_f32_bf16 v41, v30, v30
    v_dot2c_f32_bf16 v40, s62, v31
    v_dot2c_f32_bf16 v41, v31, v31
    v_dot2c_f32_bf16 v40, s62, v32
    v_dot2c_f32_bf16 v41, v32, v32
    v_dot2c_f32_bf16 v40, s62, v33
    v_dot2c_f32_bf16 v41, v33, v33
    v_dot2c_f32_bf16 v40, s62, v34
    v_dot2c_f32_bf16 v41, v34, v34
    v_dot2c_f32_bf16 v40, s62, v35
    v_dot2c_f32_bf16 v41, v35, v35
    s_nop 1
    v_add_f32_dpp v40, v40, v40 row_ror:4 row_mask:0xf bank_mask:0xf
    v_add_f32_dpp v41, v41, v41 row_ror:4 row_mask:0xf bank_mask:0xf
    s_nop 0
    v_add_f32_dpp v40, v40, v40 row_ror:8 row_mask:0xf bank_mask:0xf
    v_add_f32_dpp v41, v41, v41 row_ror:8 row_mask:0xf bank_mask:0xf
    v_mov_b32 v42, v40
    v_mov_b32 v43, v41
    s_nop 0
    v_permlane16_swap_b32 v40, v42
    v_permlane16_swap_b32 v41, v43
    v_add_f32 v40, v40, v42
    v_add_f32 v41, v41, v43
    v_mov_b32 v42, v40
    v_mov_b32 v43, v41
    s_nop 0
    v_permlane32_swap_b32 v40, v42
    v_permlane32_swap_b32 v41, v43
    v_add_f32 v40, v40, v42
    v_add_f32 v41, v41, v43
    s_mov_b32 s62, 0x3acccccd
    v_mul_f32 v40, s62, v40
    v_mul_f32 v41, s62, v41
    v_fma_f32 v41, -v40, v40, v41
    v_max_f32 v41, 0, v41
    v_add_f32 v41, 0x3727c5ac, v41
    v_rsq_f32 v41, v41
    v_lshlrev_b32 v56, 16, v66
    v_and_b32 v57, 0xffff0000, v66
    v_lshlrev_b32 v58, 16, v67
    v_and_b32 v59, 0xffff0000, v67
    v_sub_f32 v56, v56, v40
    v_sub_f32 v57, v57, v40
    v_sub_f32 v58, v58, v40
    v_sub_f32 v59, v59, v40
    v_mul_f32 v56, v56, v41
    v_mul_f32 v57, v57, v41
    v_mul_f32 v58, v58, v41
    v_mul_f32 v59, v59, v41
L_u_nost:
    ds_read_b128 v[8:11], v5 offset:0
    ds_read_b128 v[12:15], v5 offset:64
    ds_read_b128 v[16:19], v5 offset:128
    ds_read_b128 v[20:23], v5 offset:192
    ds_read_b128 v[24:27], v5 offset:256
    s_branch L_u_frag
L_u_q2:
    v_lshl_add_u32 v64, v3, 13, v64
    s_add_u32 s57, s98, 40960
    v_lshlrev_b32 v5, 8, v7
    v_lshl_add_u32 v5, v3, 6, v5
    v_lshl_add_u32 v5, v4, 4, v5
    s_mul_i32 s63, s3, 5120
    s_add_u32 s63, s63, 0
    s_add_u32 s12, s63, 4096
    s_mov_b32 s59, 1.0
L_u_frag:
    s_waitcnt vmcnt(0)
    v_cmp_ne_u32 vcc, -1, v68
    s_cbranch_vccz L_u_yok
    s_cmp_eq_u32 s97, 1
    s_cbranch_scc1 L_u_ywait
    buffer_load_dword v68, v65, s[44:47], 0 offen sc1
    s_branch L_u_yok
L_u_ywait:
L_wy_2:
    buffer_load_dword v68, v65, s[44:47], 0 offen sc1
    s_waitcnt vmcnt(0)
    v_cmp_ne_u32 vcc, -1, v68
    s_cbranch_vccz L_wy_2e
    s_sleep 4
    s_sub_u32 s60, s60, 1
    s_cbranch_scc0 L_wy_2
    s_mov_b32 s60, 0
L_wy_2e:
L_u_yok:
    ds_read_b64_tr_b16 v[80:81], v60 offset:0
    ds_read_b64_tr_b16 v[82:83], v60 offset:512
    ds_read_b64_tr_b16 v[84:85], v61 offset:0
    ds_read_b64_tr_b16 v[86:87], v61 offset:512
    ds_read_b64_tr_b16 v[88:89], v62 offset:0
    ds_read_b64_tr_b16 v[90:91], v62 offset:512
    ds_read_b64_tr_b16 v[92:93], v63 offset:0
    ds_read_b64_tr_b16 v[94:95], v63 offset:512
    ds_read_b64_tr_b16 v[96:97], v60 offset:4096
    ds_read_b64_tr_b16 v[98:99], v60 offset:4608
    ds_read_b64_tr_b16 v[100:101], v61 offset:4096
    ds_read_b64_tr_b16 v[102:103], v61 offset:4608
    ds_read_b64_tr_b16 v[104:105], v62 offset:4096
    ds_read_b64_tr_b16 v[106:107], v62 offset:4608
    ds_read_b64_tr_b16 v[108:109], v63 offset:4096
    ds_read_b64_tr_b16 v[110:111], v63 offset:4608
    ds_read_b64_tr_b16 v[112:113], v60 offset:8192
    ds_read_b64_tr_b16 v[114:115], v60 offset:8704
    ds_read_b64_tr_b16 v[116:117], v61 offset:8192
    ds_read_b64_tr_b16 v[118:119], v61 offset:8704
    ds_read_b64_tr_b16 v[120:121], v62 offset:8192
    ds_read_b64_tr_b16 v[122:123], v62 offset:8704
    ds_read_b64_tr_b16 v[124:125], v63 offset:8192
    ds_read_b64_tr_b16 v[126:127], v63 offset:8704
    ds_read_b64_tr_b16 v[128:129], v60 offset:12288
    ds_read_b64_tr_b16 v[130:131], v60 offset:12800
    ds_read_b64_tr_b16 v[132:133], v61 offset:12288
    ds_read_b64_tr_b16 v[134:135], v61 offset:12800
    ds_read_b64_tr_b16 v[136:137], v62 offset:12288
    ds_read_b64_tr_b16 v[138:139], v62 offset:12800
    ds_read_b64_tr_b16 v[140:141], v63 offset:12288
    ds_read_b64_tr_b16 v[142:143], v63 offset:12800
    ds_read_b64_tr_b16 v[144:145], v60 offset:16384
    ds_read_b64_tr_b16 v[146:147], v60 offset:16896
    ds_read_b64_tr_b16 v[148:149], v61 offset:16384
    ds_read_b64_tr_b16 v[150:151], v61 offset:16896
    ds_read_b64_tr_b16 v[152:153], v62 offset:16384
    ds_read_b64_tr_b16 v[154:155], v62 offset:16896
    ds_read_b64_tr_b16 v[156:157], v63 offset:16384
    ds_read_b64_tr_b16 v[158:159], v63 offset:16896
    s_cmp_eq_u32 s97, 0
    s_cbranch_scc1 L_u_mm
    s_branch L_poll_3
L_poll_3s:
    s_sleep 8
L_poll_3:
    buffer_load_dwordx4 v[8:11], v5, s[40:43], s63 offen offset:0 sc1
    buffer_load_dwordx4 v[12:15], v5, s[40:43], s63 offen offset:1024 sc1
    buffer_load_dwordx4 v[16:19], v5, s[40:43], s63 offen offset:2048 sc1
    buffer_load_dwordx4 v[20:23], v5, s[40:43], s63 offen offset:3072 sc1
    buffer_load_dwordx4 v[24:27], v5, s[40:43], s12 offen offset:0 sc1
    s_sub_u32 s60, s60, 1
    s_cbranch_scc1 L_poll_3t
    s_waitcnt vmcnt(0)
    v_max3_u32 v37, v8, v9, v10
    v_max3_u32 v37, v37, v11, v12
    v_max3_u32 v37, v37, v13, v14
    v_max3_u32 v37, v37, v15, v16
    v_max3_u32 v37, v37, v17, v18
    v_max3_u32 v37, v37, v19, v20
    v_max3_u32 v37, v37, v21, v22
    v_max3_u32 v37, v37, v23, v24
    v_max3_u32 v37, v37, v25, v26
    v_max_u32 v37, v37, v27
    v_cmp_eq_u32 vcc, -1, v37
    s_cbranch_vccnz L_poll_3s
L_poll_3e:
L_u_got:
L_u_mm:
    s_waitcnt lgkmcnt(0)
    v_mfma_f32_16x16x32_bf16 v[40:43], v[80:83], v[8:11], 0
    v_mfma_f32_16x16x32_bf16 v[44:47], v[84:87], v[8:11], 0
    v_mfma_f32_16x16x32_bf16 v[48:51], v[88:91], v[8:11], 0
    v_mfma_f32_16x16x32_bf16 v[52:55], v[92:95], v[8:11], 0
    v_mfma_f32_16x16x32_bf16 v[40:43], v[96:99], v[12:15], v[40:43]
    v_mfma_f32_16x16x32_bf16 v[44:47], v[100:103], v[12:15], v[44:47]
    v_mfma_f32_16x16x32_bf16 v[48:51], v[104:107], v[12:15], v[48:51]
    v_mfma_f32_16x16x32_bf16 v[52:55], v[108:111], v[12:15], v[52:55]
    v_mfma_f32_16x16x32_bf16 v[40:43], v[112:115], v[16:19], v[40:43]
    v_mfma_f32_16x16x32_bf16 v[44:47], v[116:119], v[16:19], v[44:47]
    v_mfma_f32_16x16x32_bf16 v[48:51], v[120:123], v[16:19], v[48:51]
    v_mfma_f32_16x16x32_bf16 v[52:55], v[124:127], v[16:19], v[52:55]
    v_mfma_f32_16x16x32_bf16 v[40:43], v[128:131], v[20:23], v[40:43]
    v_mfma_f32_16x16x32_bf16 v[44:47], v[132:135], v[20:23], v[44:47]
    v_mfma_f32_16x16x32_bf16 v[48:51], v[136:139], v[20:23], v[48:51]
    v_mfma_f32_16x16x32_bf16 v[52:55], v[140:143], v[20:23], v[52:55]
    v_mfma_f32_16x16x32_bf16 v[40:43], v[144:147], v[24:27], v[40:43]
    v_mfma_f32_16x16x32_bf16 v[44:47], v[148:151], v[24:27], v[44:47]
    v_mfma_f32_16x16x32_bf16 v[48:51], v[152:155], v[24:27], v[48:51]
    v_mfma_f32_16x16x32_bf16 v[52:55], v[156:159], v[24:27], v[52:55]
    v_lshlrev_b32 v5, 4, v0
    v_add_u32 v5, 147456, v5
    s_lshl_b32 s62, s3, 10
    s_add_u32 s62, s62, 147456
    v_lshl_add_u32 v6, v69, 4, s62
    v_mov_b32 v24, s58
    v_mov_b32 v32, 162056
    v_mov_b32 v33, 1
    v_add_f32_dpp v40, v40, v40 row_ror:8 row_mask:0xf bank_mask:0xf
    v_add_f32_dpp v41, v41, v41 row_ror:8 row_mask:0xf bank_mask:0xf
    v_add_f32_dpp v42, v42, v42 row_ror:8 row_mask:0xf bank_mask:0xf
    v_add_f32_dpp v43, v43, v43 row_ror:8 row_mask:0xf bank_mask:0xf
    v_add_f32_dpp v44, v44, v44 row_ror:8 row_mask:0xf bank_mask:0xf
    v_add_f32_dpp v45, v45, v45 row_ror:8 row_mask:0xf bank_mask:0xf
    v_add_f32_dpp v46, v46, v46 row_ror:8 row_mask:0xf bank_mask:0xf
    v_add_f32_dpp v47, v47, v47 row_ror:8 row_mask:0xf bank_mask:0xf
    v_add_f32_dpp v48, v48, v48 row_ror:8 row_mask:0xf bank_mask:0xf
    v_add_f32_dpp v49, v49, v49 row_ror:8 row_mask:0xf bank_mask:0xf
    v_add_f32_dpp v50, v50, v50 row_ror:8 row_mask:0xf bank_mask:0xf
    v_add_f32_dpp v51, v51, v51 row_ror:8 row_mask:0xf bank_mask:0xf
    v_add_f32_dpp v52, v52, v52 row_ror:8 row_mask:0xf bank_mask:0xf
    v_add_f32_dpp v53, v53, v53 row_ror:8 row_mask:0xf bank_mask:0xf
    v_add_f32_dpp v54, v54, v54 row_ror:8 row_mask:0xf bank_mask:0xf
    v_add_f32_dpp v55, v55, v55 row_ror:8 row_mask:0xf bank_mask:0xf
    v_add_f32_dpp v28, v40, v40 row_ror:4 row_mask:0xf bank_mask:0x1
    v_add_f32_dpp v29, v41, v41 row_ror:4 row_mask:0xf bank_mask:0x1
    v_add_f32_dpp v30, v42, v42 row_ror:4 row_mask:0xf bank_mask:0x1
    v_add_f32_dpp v31, v43, v43 row_ror:4 row_mask:0xf bank_mask:0x1
    v_add_f32_dpp v28, v44, v44 row_ror:4 row_mask:0xf bank_mask:0x2
    v_add_f32_dpp v29, v45, v45 row_ror:4 row_mask:0xf bank_mask:0x2
    v_add_f32_dpp v30, v46, v46 row_ror:4 row_mask:0xf bank_mask:0x2
    v_add_f32_dpp v31, v47, v47 row_ror:4 row_mask:0xf bank_mask:0x2
    v_add_f32_dpp v28, v48, v48 row_ror:4 row_mask:0xf bank_mask:0x4
    v_add_f32_dpp v29, v49, v49 row_ror:4 row_mask:0xf bank_mask:0x4
    v_add_f32_dpp v30, v50, v50 row_ror:4 row_mask:0xf bank_mask:0x4
    v_add_f32_dpp v31, v51, v51 row_ror:4 row_mask:0xf bank_mask:0x4
    v_add_f32_dpp v28, v52, v52 row_ror:4 row_mask:0xf bank_mask:0x8
    v_add_f32_dpp v29, v53, v53 row_ror:4 row_mask:0xf bank_mask:0x8
    v_add_f32_dpp v30, v54, v54 row_ror:4 row_mask:0xf bank_mask:0x8
    v_add_f32_dpp v31, v55, v55 row_ror:4 row_mask:0xf bank_mask:0x8
    v_fma_f32 v28, v28, s59, v24
    v_fma_f32 v29, v29, s59, v24
    v_fma_f32 v30, v30, s59, v24
    v_fma_f32 v31, v31, s59, v24
    v_mul_f32 v28, v28, v56
    v_mul_f32 v29, v29, v57
    v_mul_f32 v30, v30, v58
    v_mul_f32 v31, v31, v59
    ds_write_b128 v6, v[28:31]
    s_mov_b64 exec, 1
    ds_add_rtn_u32 v34, v32, v33
    s_mov_b64 exec, -1
    ds_read_b128 v[8:11], v5
    ds_read_b128 v[12:15], v5 offset:1024
    ds_read_b128 v[16:19], v5 offset:2048
    ds_read_b128 v[20:23], v5 offset:3072
    s_waitcnt lgkmcnt(0)
    v_readfirstlane_b32 s62, v34
    s_nop 0
    s_cmp_eq_u32 s62, s15
    s_cbranch_scc1 L_u_last
    s_cmp_eq_u32 s62, 1
    s_cbranch_scc1 L_service
    s_endpgm
L_u_last:
    v_add_f32 v8, v8, v12
    v_add_f32 v9, v9, v13
    v_add_f32 v10, v10, v14
    v_add_f32 v11, v11, v15
    s_cmp_eq_u32 s15, 1
    s_cbranch_scc1 L_u_two
    v_add_f32 v16, v16, v20
    v_add_f32 v17, v17, v21
    v_add_f32 v18, v18, v22
    v_add_f32 v19, v19, v23
    v_add_f32 v8, v8, v16
    v_add_f32 v9, v9, v17
    v_add_f32 v10, v10, v18
    v_add_f32 v11, v11, v19
L_u_two:
    v_cvt_pk_bf16_f32 v8, v8, v9
    v_cvt_pk_bf16_f32 v9, v10, v11
    s_waitcnt vmcnt(0)
    v_cmp_ne_u32 vcc, -1, v68
    s_cbranch_vccz L_u_st
L_wy_4:
    buffer_load_dword v68, v65, s[44:47], 0 offen sc1
    s_waitcnt vmcnt(0)
    v_cmp_ne_u32 vcc, -1, v68
    s_cbranch_vccz L_wy_4e
    s_sleep 4
    s_sub_u32 s60, s60, 1
    s_cbranch_scc0 L_wy_4
    s_mov_b32 s60, 0
L_wy_4e:
L_u_st:
    buffer_store_dwordx2 v[8:9], v64, s[40:43], s57 offen sc1
    s_endpgm
L_touch:
    s_load_dword s0, s[32:33], 0
    s_load_dword s0, s[30:31], 0
    s_cmp_eq_u32 s39, 1
    s_cbranch_scc1 L_tpr
    s_mov_b32 s62, 16777216
    s_load_dword s0, s[8:9], s62
    s_mov_b32 s62, 83886080
    s_load_dword s0, s[8:9], s62
    s_mov_b32 s62, 150994944
    s_load_dword s0, s[8:9], s62
    s_mov_b32 s62, 218103808
    s_load_dword s0, s[8:9], s62
    s_branch L_tpv
L_tpr:
    s_load_dword s0, s[20:21], 0
    s_mov_b32 s62, 2211836
    s_load_dword s0, s[20:21], s62
    s_load_dword s0, s[16:17], 0
    s_mov_b32 s62, 2211836
    s_load_dword s0, s[16:17], s62
    s_load_dword s0, s[18:19], 0
    s_load_dword s0, s[22:23], 0
    s_load_dword s0, s[28:29], 0
    s_load_dword s0, s[4:5], 0
L_tpv:
    s_lshl_b32 s62, s34, 23
    s_load_dword s0, s[8:9], s62
    s_add_u32 s62, s62, 67108864
    s_load_dword s0, s[8:9], s62
    s_add_u32 s62, s62, 67108864
    s_load_dword s0, s[8:9], s62
    s_add_u32 s62, s62, 67108864
    s_load_dword s0, s[8:9], s62
    s_add_u32 s62, s62, 67108864
    s_branch L_notp
L_stream2:
    s_mov_b32 s12, s100
    s_mov_b32 s13, s101
    s_andn2_b32 s96, s59, s39
    s_cbranch_scc0 L_noua
    s_barrier
L_noua:
    s_mov_b32 s40, s32
    s_mov_b32 s41, s33
    s_mov_b32 s42, 589824
    s_mov_b32 s43, 0x20000
    s_mov_b32 s44, s30
    s_mov_b32 s45, s31
    s_mov_b32 s46, 256
    s_mov_b32 s47, 0x20000
    s_bitcmp1_b32 s3, 0
    s_mov_b32 s57, 0xffffffff
    s_mov_b32 s58, 0x0
    s_mov_b32 s14, 0xffffff
    s_mov_b32 s15, 0x0
L_pm_10:
    s_sub_u32 s96, s56, 104
    s_cmp_lt_u32 s96, 66
    s_cbranch_scc0 L_pm_11
    s_bitcmp1_b32 s3, 0
    s_mov_b32 s57, 0xff00000f
    s_mov_b32 s58, 0x0
    s_mov_b32 s14, 0xffffff
    s_mov_b32 s15, 0x0
L_pm_11:
    s_sub_u32 s96, s56, 144
    s_cmp_lt_u32 s96, 10
    s_cbranch_scc0 L_pm_12
    s_bitcmp1_b32 s3, 0
    s_mov_b32 s57, 0xffffffff
    s_mov_b32 s58, 0xfff
    s_mov_b32 s14, 0xffffff
    s_mov_b32 s15, 0x0
L_pm_12:
    s_cmp_lt_u32 s56, 104
    s_cbranch_scc0 L_pm_13
    s_bitcmp1_b32 s3, 0
    s_mov_b32 s57, 0xf
    s_mov_b32 s58, 0x0
    s_mov_b32 s14, 0xffffff
    s_mov_b32 s15, 0x0
L_pm_13:
    s_sub_u32 s96, s56, 43
    s_and_b32 s96, s96, 0xffffffc7
    s_cmp_eq_u32 s96, 0
    s_cbranch_scc0 L_pm_14
    s_bitcmp1_b32 s3, 0
    s_mov_b32 s57, 0x0
    s_mov_b32 s58, 0x0
    s_mov_b32 s14, 0x0
    s_mov_b32 s15, 0x0
L_pm_14:
    s_cmp_lt_u32 s56, 40
    s_cbranch_scc0 L_pm_15
    s_bitcmp1_b32 s3, 0
    s_mov_b32 s57, 0xffffffff
    s_mov_b32 s58, 0xf
    s_mov_b32 s14, 0xffffff
    s_mov_b32 s15, 0x0
L_pm_15:
    s_cmp_eq_u32 s56, 255
    s_cbranch_scc0 L_pm_16
    s_bitcmp1_b32 s3, 0
    s_mov_b32 s57, 0xffffffff
    s_mov_b32 s58, 0x0
    s_mov_b32 s14, 0x0
    s_mov_b32 s15, 0x0
L_pm_16:
    s_cmp_eq_u32 s39, 1
    s_cbranch_scc0 L_pm_17
    s_bitcmp1_b32 s3, 0
    s_mov_b32 s57, 0xff
    s_mov_b32 s58, 0xff
    s_mov_b32 s14, 0x0
    s_mov_b32 s15, 0x0
L_pm_17:
    s_cmp_lg_u32 s13, 0
    s_cbranch_scc0 L_pm_18
    s_bitcmp1_b32 s3, 0
    s_mov_b32 s57, 0xffffffff
    s_mov_b32 s58, 0x0
    s_mov_b32 s14, 0x0
    s_mov_b32 s15, 0x0
L_pm_18:
    s_and_b32 s96, s39, s59
    s_cbranch_scc0 L_pm_19
    s_bitcmp1_b32 s3, 0
    s_mov_b32 s57, 0x3ff
    s_mov_b32 s58, 0x3ff
    s_mov_b32 s14, 0x0
    s_mov_b32 s15, 0x0
L_pm_19:
    s_add_u32 s52, s8, s63
    s_addc_u32 s53, s9, 0
    s_mov_b32 s54, 262144
    s_mov_b32 s55, 0x20000
    v_and_b32 v2, 15, v0
    v_lshrrev_b32 v3, 1, v2
    v_and_b32 v37, 1, v2
    v_lshlrev_b32 v37, 4, v37
    v_mov_b32 v38, 0xffff
    v_lshlrev_b32 v37, v37, v38
    v_cmp_eq_u32 vcc, 0, v3
    v_mov_b32 v32, 0
    s_nop 0
    v_cndmask_b32 v20, 0, v37, vcc
    v_cmp_eq_u32 vcc, 1, v3
    v_mov_b32 v33, 0
    s_nop 0
    v_cndmask_b32 v21, 0, v37, vcc
    v_cmp_eq_u32 vcc, 2, v3
    v_mov_b32 v34, 0
    s_nop 0
    v_cndmask_b32 v22, 0, v37, vcc
    v_cmp_eq_u32 vcc, 3, v3
    v_mov_b32 v35, 0
    s_nop 0
    v_cndmask_b32 v23, 0, v37, vcc
    v_lshlrev_b32 v2, 4, v2
    s_lshl_b32 s98, s62, 8
    s_add_u32 s98, s98, 40960
    s_bitcmp0_b32 s57, 2
    s_cbranch_scc1 L_sf_20
    s_bitcmp0_b32 s58, 2
    s_cbranch_scc1 L_sf_20
    s_waitcnt vmcnt(1)
L_sf_20:
    buffer_load_dwordx4 v[48:51], v1, s[48:51], s97 offen offset:2048 nt
    s_bitcmp0_b32 s57, 3
    s_cbranch_scc1 L_sf_21
    s_waitcnt vmcnt(2)
    s_bitcmp0_b32 s58, 3
    s_cbranch_scc1 L_sf_21
    s_waitcnt vmcnt(1)
L_sf_21:
    buffer_load_dwordx4 v[52:55], v1, s[48:51], s97 offen offset:3072 nt
    s_add_u32 s97, s97, 32768
    v_add_u32 v1, 4096, v1
    v_and_b32 v1, 0x7fff, v1
    s_waitcnt vmcnt(3)
    s_bitcmp0_b32 s57, 4
    s_cbranch_scc1 L_sf_22
    s_waitcnt vmcnt(2)
    s_bitcmp0_b32 s58, 4
    s_cbranch_scc1 L_sf_22
    s_waitcnt vmcnt(1)
L_sf_22:
    buffer_load_dwordx4 v[56:59], v1, s[48:51], s97 offen offset:0 nt
    s_waitcnt vmcnt(3)
    s_bitcmp0_b32 s57, 5
    s_cbranch_scc1 L_sf_23
    s_waitcnt vmcnt(2)
    s_bitcmp0_b32 s58, 5
    s_cbranch_scc1 L_sf_23
    s_waitcnt vmcnt(1)
L_sf_23:
    buffer_load_dwordx4 v[60:63], v1, s[48:51], s97 offen offset:1024 nt
    s_waitcnt vmcnt(3)
    s_bitcmp0_b32 s57, 6
    s_cbranch_scc1 L_sf_24
    s_waitcnt vmcnt(2)
    s_bitcmp0_b32 s58, 6
    s_cbranch_scc1 L_sf_24
    s_waitcnt vmcnt(1)
L_sf_24:
    buffer_load_dwordx4 v[64:67], v1, s[48:51], s97 offen offset:2048 nt
    s_waitcnt vmcnt(3)
    s_bitcmp0_b32 s57, 7
    s_cbranch_scc1 L_sf_25
    s_waitcnt vmcnt(2)
    s_bitcmp0_b32 s58, 7
    s_cbranch_scc1 L_sf_25
    s_waitcnt vmcnt(1)
L_sf_25:
    buffer_load_dwordx4 v[68:71], v1, s[48:51], s97 offen offset:3072 nt
    s_add_u32 s97, s97, 32768
    v_add_u32 v1, 4096, v1
    v_and_b32 v1, 0x7fff, v1
    s_waitcnt vmcnt(3)
    s_bitcmp0_b32 s57, 8
    s_cbranch_scc1 L_sf_26
    s_waitcnt vmcnt(2)
    s_bitcmp0_b32 s58, 8
    s_cbranch_scc1 L_sf_26
    s_waitcnt vmcnt(1)
L_sf_26:
    buffer_load_dwordx4 v[72:75], v1, s[48:51], s97 offen offset:0 nt
    s_waitcnt vmcnt(3)
    s_bitcmp0_b32 s57, 9
    s_cbranch_scc1 L_sf_27
    s_waitcnt vmcnt(2)
    s_bitcmp0_b32 s58, 9
    s_cbranch_scc1 L_sf_27
    s_waitcnt vmcnt(1)
L_sf_27:
    buffer_load_dwordx4 v[76:79], v1, s[48:51], s97 offen offset:1024 nt
    s_waitcnt vmcnt(3)
    s_bitcmp0_b32 s57, 10
    s_cbranch_scc1 L_sf_28
    s_waitcnt vmcnt(2)
    s_bitcmp0_b32 s58, 10
    s_cbranch_scc1 L_sf_28
    s_waitcnt vmcnt(1)
L_sf_28:
    buffer_load_dwordx4 v[80:83], v1, s[48:51], s97 offen offset:2048 nt
    s_waitcnt vmcnt(3)
    s_bitcmp0_b32 s57, 11
    s_cbranch_scc1 L_sf_29
    s_waitcnt vmcnt(2)
    s_bitcmp0_b32 s58, 11
    s_cbranch_scc1 L_sf_29
    s_waitcnt vmcnt(1)
L_sf_29:
    buffer_load_dwordx4 v[84:87], v1, s[48:51], s97 offen offset:3072 nt
    s_add_u32 s97, s97, 32768
    v_add_u32 v1, 4096, v1
    v_and_b32 v1, 0x7fff, v1
    s_waitcnt vmcnt(3)
    s_bitcmp0_b32 s57, 12
    s_cbranch_scc1 L_sf_30
    s_waitcnt vmcnt(2)
    s_bitcmp0_b32 s58, 12
    s_cbranch_scc1 L_sf_30
    s_waitcnt vmcnt(1)
L_sf_30:
    buffer_load_dwordx4 v[88:91], v1, s[48:51], s97 offen offset:0 nt
    s_waitcnt vmcnt(3)
    s_bitcmp0_b32 s57, 13
    s_cbranch_scc1 L_sf_31
    s_waitcnt vmcnt(2)
    s_bitcmp0_b32 s58, 13
    s_cbranch_scc1 L_sf_31
    s_waitcnt vmcnt(1)
L_sf_31:
    buffer_load_dwordx4 v[92:95], v1, s[48:51], s97 offen offset:1024 nt
    s_waitcnt vmcnt(3)
    s_bitcmp0_b32 s57, 14
    s_cbranch_scc1 L_sf_32
    s_waitcnt vmcnt(2)
    s_bitcmp0_b32 s58, 14
    s_cbranch_scc1 L_sf_32
    s_waitcnt vmcnt(1)
L_sf_32:
    buffer_load_dwordx4 v[96:99], v1, s[48:51], s97 offen offset:2048 nt
    s_waitcnt vmcnt(3)
    s_bitcmp0_b32 s57, 15
    s_cbranch_scc1 L_sf_33
    s_waitcnt vmcnt(2)
    s_bitcmp0_b32 s58, 15
    s_cbranch_scc1 L_sf_33
    s_waitcnt vmcnt(1)
L_sf_33:
    buffer_load_dwordx4 v[100:103], v1, s[48:51], s97 offen offset:3072 nt
    s_add_u32 s97, s97, 32768
    v_add_u32 v1, 4096, v1
    v_and_b32 v1, 0x7fff, v1
    s_waitcnt vmcnt(3)
    s_bitcmp0_b32 s57, 16
    s_cbranch_scc1 L_sf_34
    s_waitcnt vmcnt(2)
    s_bitcmp0_b32 s58, 16
    s_cbranch_scc1 L_sf_34
    s_waitcnt vmcnt(1)
L_sf_34:
    buffer_load_dwordx4 v[104:107], v1, s[48:51], s97 offen offset:0 nt
    s_waitcnt vmcnt(3)
    s_bitcmp0_b32 s57, 17
    s_cbranch_scc1 L_sf_35
    s_waitcnt vmcnt(2)
    s_bitcmp0_b32 s58, 17
    s_cbranch_scc1 L_sf_35
    s_waitcnt vmcnt(1)
L_sf_35:
    buffer_load_dwordx4 v[108:111], v1, s[48:51], s97 offen offset:1024 nt
    s_waitcnt vmcnt(3)
    s_bitcmp0_b32 s57, 18
    s_cbranch_scc1 L_sf_36
    s_waitcnt vmcnt(2)
    s_bitcmp0_b32 s58, 18
    s_cbranch_scc1 L_sf_36
    s_waitcnt vmcnt(1)
L_sf_36:
    buffer_load_dwordx4 v[112:115], v1, s[48:51], s97 offen offset:2048 nt
    s_waitcnt vmcnt(3)
    s_bitcmp0_b32 s57, 19
    s_cbranch_scc1 L_sf_37
    s_waitcnt vmcnt(2)
    s_bitcmp0_b32 s58, 19
    s_cbranch_scc1 L_sf_37
    s_waitcnt vmcnt(1)
L_sf_37:
    buffer_load_dwordx4 v[116:119], v1, s[48:51], s97 offen offset:3072 nt
    s_add_u32 s97, s97, 32768
    v_add_u32 v1, 4096, v1
    v_and_b32 v1, 0x7fff, v1
    s_waitcnt vmcnt(3)
    s_bitcmp0_b32 s57, 20
    s_cbranch_scc1 L_sf_38
    s_waitcnt vmcnt(2)
    s_bitcmp0_b32 s58, 20
    s_cbranch_scc1 L_sf_38
    s_waitcnt vmcnt(1)
L_sf_38:
    buffer_load_dwordx4 v[120:123], v1, s[48:51], s97 offen offset:0 nt
    s_waitcnt vmcnt(3)
    s_bitcmp0_b32 s57, 21
    s_cbranch_scc1 L_sf_39
    s_waitcnt vmcnt(2)
    s_bitcmp0_b32 s58, 21
    s_cbranch_scc1 L_sf_39
    s_waitcnt vmcnt(1)
L_sf_39:
    buffer_load_dwordx4 v[124:127], v1, s[48:51], s97 offen offset:1024 nt
    s_cmp_eq_u32 s12, -1
    s_cbranch_scc1 L_k_nopf
    s_waitcnt vmcnt(3)
    s_bitcmp0_b32 s57, 22
    s_cbranch_scc1 L_sf_40
    s_waitcnt vmcnt(2)
    s_bitcmp0_b32 s58, 22
    s_cbranch_scc1 L_sf_40
    s_waitcnt vmcnt(1)
L_sf_40:
    buffer_load_dwordx4 v[128:131], v1, s[48:51], s97 offen offset:2048 nt
    s_waitcnt vmcnt(3)
    s_bitcmp0_b32 s57, 23
    s_cbranch_scc1 L_sf_41
    s_waitcnt vmcnt(2)
    s_bitcmp0_b32 s58, 23
    s_cbranch_scc1 L_sf_41
    s_waitcnt vmcnt(1)
L_sf_41:
    buffer_load_dwordx4 v[132:135], v1, s[48:51], s97 offen offset:3072 nt
    s_add_u32 s97, s97, 32768
    v_add_u32 v1, 4096, v1
    v_and_b32 v1, 0x7fff, v1
    s_waitcnt vmcnt(3)
    s_bitcmp0_b32 s57, 24
    s_cbranch_scc1 L_sf_42
    s_waitcnt vmcnt(2)
    s_bitcmp0_b32 s58, 24
    s_cbranch_scc1 L_sf_42
    s_waitcnt vmcnt(1)
L_sf_42:
    buffer_load_dwordx4 v[136:139], v1, s[48:51], s97 offen offset:0 nt
    s_waitcnt vmcnt(3)
    s_bitcmp0_b32 s57, 25
    s_cbranch_scc1 L_sf_43
    s_waitcnt vmcnt(2)
    s_bitcmp0_b32 s58, 25
    s_cbranch_scc1 L_sf_43
    s_waitcnt vmcnt(1)
L_sf_43:
    buffer_load_dwordx4 v[140:143], v1, s[48:51], s97 offen offset:1024 nt
    s_waitcnt vmcnt(3)
    s_bitcmp0_b32 s57, 26
    s_cbranch_scc1 L_sf_44
    s_waitcnt vmcnt(2)
    s_bitcmp0_b32 s58, 26
    s_cbranch_scc1 L_sf_44
    s_waitcnt vmcnt(1)
L_sf_44:
    buffer_load_dwordx4 v[144:147], v1, s[48:51], s97 offen offset:2048 nt
    s_waitcnt vmcnt(3)
    s_bitcmp0_b32 s57, 27
    s_cbranch_scc1 L_sf_45
    s_waitcnt vmcnt(2)
    s_bitcmp0_b32 s58, 27
    s_cbranch_scc1 L_sf_45
    s_waitcnt vmcnt(1)
L_sf_45:
    buffer_load_dwordx4 v[148:151], v1, s[48:51], s97 offen offset:3072 nt
    s_add_u32 s97, s97, 32768
    v_add_u32 v1, 4096, v1
    v_and_b32 v1, 0x7fff, v1
    s_waitcnt vmcnt(3)
    s_bitcmp0_b32 s57, 28
    s_cbranch_scc1 L_sf_46
    s_waitcnt vmcnt(2)
    s_bitcmp0_b32 s58, 28
    s_cbranch_scc1 L_sf_46
    s_waitcnt vmcnt(1)
L_sf_46:
    buffer_load_dwordx4 v[152:155], v1, s[48:51], s97 offen offset:0 nt
    s_waitcnt vmcnt(3)
    s_bitcmp0_b32 s57, 29
    s_cbranch_scc1 L_sf_47
    s_waitcnt vmcnt(2)
    s_bitcmp0_b32 s58, 29
    s_cbranch_scc1 L_sf_47
    s_waitcnt vmcnt(1)
L_sf_47:
    buffer_load_dwordx4 v[156:159], v1, s[48:51], s97 offen offset:1024 nt
    s_waitcnt vmcnt(3)
    s_bitcmp0_b32 s57, 30
    s_cbranch_scc1 L_sf_48
    s_waitcnt vmcnt(2)
    s_bitcmp0_b32 s58, 30
    s_cbranch_scc1 L_sf_48
    s_waitcnt vmcnt(1)
L_sf_48:
    buffer_load_dwordx4 v[160:163], v1, s[48:51], s97 offen offset:2048 nt
    v_min_u32 v39, 15, v0
    v_and_b32 v38, 1, v39
    v_mul_u32_u24 v38, 126, v38
    v_lshl_add_u32 v39, v39, 1, v38
    buffer_load_dword v37, v39, s[44:47], 0 offen sc1
    s_waitcnt vmcnt(4)
    s_bitcmp0_b32 s57, 31
    s_cbranch_scc1 L_sf_49
    s_waitcnt vmcnt(3)
    s_bitcmp0_b32 s58, 31
    s_cbranch_scc1 L_sf_49
    s_waitcnt vmcnt(2)
L_sf_49:
    buffer_load_dwordx4 v[164:167], v1, s[48:51], s97 offen offset:3072 nt
    s_mov_b32 s97, 0
    v_add_u32 v1, 4096, v1
    v_and_b32 v1, 0x7fff, v1
    s_waitcnt vmcnt(4)
    s_bitcmp0_b32 s14, 0
    s_cbranch_scc1 L_sf_50
    s_waitcnt vmcnt(3)
    s_bitcmp0_b32 s15, 0
    s_cbranch_scc1 L_sf_50
    s_waitcnt vmcnt(2)
L_sf_50:
    s_add_u32 m0, s12, 0
    s_nop 0
    buffer_load_dwordx4 v1, s[52:55], s97 offen offset:0 nt lds
    s_waitcnt vmcnt(4)
    s_bitcmp0_b32 s14, 1
    s_cbranch_scc1 L_sf_51
    s_waitcnt vmcnt(3)
    s_bitcmp0_b32 s15, 1
    s_cbranch_scc1 L_sf_51
    s_waitcnt vmcnt(1)
L_sf_51:
    buffer_load_dwordx4 v1, s[52:55], s97 offen offset:1024 nt lds
    s_waitcnt vmcnt(4)
    s_bitcmp0_b32 s14, 2
    s_cbranch_scc1 L_sf_52
    s_waitcnt vmcnt(2)
    s_bitcmp0_b32 s15, 2
    s_cbranch_scc1 L_sf_52
    s_waitcnt vmcnt(1)
L_sf_52:
    buffer_load_dwordx4 v1, s[52:55], s97 offen offset:2048 nt lds
    s_waitcnt vmcnt(3)
    s_bitcmp0_b32 s14, 3
    s_cbranch_scc1 L_sf_53
    s_waitcnt vmcnt(2)
    s_bitcmp0_b32 s15, 3
    s_cbranch_scc1 L_sf_53
    s_waitcnt vmcnt(1)
L_sf_53:
    buffer_load_dwordx4 v1, s[52:55], s97 offen offset:3072 nt lds
    s_add_u32 s97, s97, 32768
    v_add_u32 v1, 4096, v1
    v_and_b32 v1, 0x7fff, v1
    v_cmp_eq_u32 vcc, 0, v37
    s_nop 0
    s_or_b32 s96, vcc_lo, vcc_hi
    buffer_load_dwordx4 v[4:7], v2, s[40:43], s98 offen sc1
    s_waitcnt vmcnt(4)
    s_bitcmp0_b32 s14, 4
    s_cbranch_scc1 L_sf_54
    s_waitcnt vmcnt(3)
    s_bitcmp0_b32 s15, 4
    s_cbranch_scc1 L_sf_54
    s_waitcnt vmcnt(2)
L_sf_54:
    s_add_u32 m0, s12, 4096
    s_nop 0
    buffer_load_dwordx4 v1, s[52:55], s97 offen offset:0 nt lds
    s_waitcnt vmcnt(4)
    s_bitcmp0_b32 s14, 5
    s_cbranch_scc1 L_sf_55
    s_waitcnt vmcnt(3)
    s_bitcmp0_b32 s15, 5
    s_cbranch_scc1 L_sf_55
    s_waitcnt vmcnt(2)
L_sf_55:
    buffer_load_dwordx4 v1, s[52:55], s97 offen offset:1024 nt lds
    s_waitcnt vmcnt(4)
    s_bitcmp0_b32 s14, 6
    s_cbranch_scc1 L_sf_56
    s_waitcnt vmcnt(3)
    s_bitcmp0_b32 s15, 6
    s_cbranch_scc1 L_sf_56
    s_waitcnt vmcnt(1)
L_sf_56:
    buffer_load_dwordx4 v1, s[52:55], s97 offen offset:2048 nt lds
    s_waitcnt vmcnt(4)
    s_bitcmp0_b32 s14, 7
    s_cbranch_scc1 L_sf_57
    s_waitcnt vmcnt(2)
    s_bitcmp0_b32 s15, 7
    s_cbranch_scc1 L_sf_57
    s_waitcnt vmcnt(1)
L_sf_57:
    buffer_load_dwordx4 v1, s[52:55], s97 offen offset:3072 nt lds
    s_add_u32 s97, s97, 32768
    v_add_u32 v1, 4096, v1
    v_and_b32 v1, 0x7fff, v1
L_k_join:
    s_waitcnt vmcnt(4)
    v_max3_u32 v38, v4, v5, v6
    v_max_u32 v38, v38, v7
    v_cmp_eq_u32 vcc, -1, v38
    s_cmp_lg_u32 s96, 0
    s_cbranch_scc1 L_qslow
    s_cbranch_vccnz L_qslow2
L_qok:
    v_dot2_f32_bf16 v8, v72, v4, 0
    v_dot2_f32_bf16 v9, v76, v4, 0
    v_dot2_f32_bf16 v10, v80, v4, 0
    v_dot2_f32_bf16 v11, v84, v4, 0
    v_dot2_f32_bf16 v24, v88, v4, 0
    v_dot2_f32_bf16 v25, v92, v4, 0
    v_dot2_f32_bf16 v26, v96, v4, 0
    v_dot2_f32_bf16 v27, v100, v4, 0
    v_dot2_f32_bf16 v8, v73, v5, v8
    v_dot2_f32_bf16 v9, v77, v5, v9
    v_dot2_f32_bf16 v10, v81, v5, v10
    v_dot2_f32_bf16 v11, v85, v5, v11
    v_dot2_f32_bf16 v24, v89, v5, v24
    v_dot2_f32_bf16 v25, v93, v5, v25
    v_dot2_f32_bf16 v26, v97, v5, v26
    v_dot2_f32_bf16 v27, v101, v5, v27
    v_dot2_f32_bf16 v8, v74, v6, v8
    v_dot2_f32_bf16 v9, v78, v6, v9
    v_dot2_f32_bf16 v10, v82, v6, v10
    v_dot2_f32_bf16 v11, v86, v6, v11
    v_dot2_f32_bf16 v24, v90, v6, v24
    v_dot2_f32_bf16 v25, v94, v6, v25
    v_dot2_f32_bf16 v26, v98, v6, v26
    v_dot2_f32_bf16 v27, v102, v6, v27
    v_dot2_f32_bf16 v8, v75, v7, v8
    v_dot2_f32_bf16 v9, v79, v7, v9
    v_dot2_f32_bf16 v10, v83, v7, v10
    v_dot2_f32_bf16 v11, v87, v7, v11
    v_dot2_f32_bf16 v24, v91, v7, v24
    v_dot2_f32_bf16 v25, v95, v7, v25
    v_dot2_f32_bf16 v26, v99, v7, v26
    v_dot2_f32_bf16 v27, v103, v7, v27
    v_add_f32_dpp v8, v8, v8 row_ror:8 row_mask:0xf bank_mask:0x3
    v_add_f32_dpp v10, v10, v10 row_ror:8 row_mask:0xf bank_mask:0x3
    v_add_f32_dpp v24, v24, v24 row_ror:8 row_mask:0xf bank_mask:0x3
    v_add_f32_dpp v26, v26, v26 row_ror:8 row_mask:0xf bank_mask:0x3
    v_add_f32_dpp v8, v9, v9 row_ror:8 row_mask:0xf bank_mask:0xc
    v_add_f32_dpp v10, v11, v11 row_ror:8 row_mask:0xf bank_mask:0xc
    v_add_f32_dpp v24, v25, v25 row_ror:8 row_mask:0xf bank_mask:0xc
    v_add_f32_dpp v26, v27, v27 row_ror:8 row_mask:0xf bank_mask:0xc
    v_add_f32_dpp v14, v8, v8 row_half_mirror row_mask:0xf bank_mask:0x5
    v_add_f32_dpp v15, v24, v24 row_half_mirror row_mask:0xf bank_mask:0x5
    v_add_f32_dpp v14, v10, v10 row_half_mirror row_mask:0xf bank_mask:0xa
    v_add_f32_dpp v15, v26, v26 row_half_mirror row_mask:0xf bank_mask:0xa
    s_nop 0
    v_add_f32_dpp v14, v14, v14 quad_perm:[1,0,3,2] row_mask:0xf bank_mask:0xf
    v_add_f32_dpp v15, v15, v15 quad_perm:[1,0,3,2] row_mask:0xf bank_mask:0xf
    s_nop 0
    v_add_f32_dpp v14, v14, v14 quad_perm:[2,3,0,1] row_mask:0xf bank_mask:0xf
    v_add_f32_dpp v15, v15, v15 quad_perm:[2,3,0,1] row_mask:0xf bank_mask:0xf
    s_waitcnt vmcnt(3)
    s_bitcmp0_b32 s14, 8
    s_cbranch_scc1 L_sf_68
    s_waitcnt vmcnt(2)
    s_bitcmp0_b32 s15, 8
    s_cbranch_scc1 L_sf_68
    s_waitcnt vmcnt(1)
L_sf_68:
    buffer_load_dwordx4 v[72:75], v1, s[52:55], s97 offen offset:0 nt
    v_dot2_f32_bf16 v8, v40, v4, 0
    v_dot2_f32_bf16 v9, v44, v4, 0
    v_dot2_f32_bf16 v10, v48, v4, 0
    v_dot2_f32_bf16 v11, v52, v4, 0
    v_dot2_f32_bf16 v24, v56, v4, 0
    v_dot2_f32_bf16 v25, v60, v4, 0
    v_dot2_f32_bf16 v26, v64, v4, 0
    v_dot2_f32_bf16 v27, v68, v4, 0
    v_dot2_f32_bf16 v28, v104, v4, 0
    v_dot2_f32_bf16 v29, v108, v4, 0
    v_dot2_f32_bf16 v30, v112, v4, 0
    v_dot2_f32_bf16 v31, v116, v4, 0
    v_dot2_f32_bf16 v8, v41, v5, v8
    v_dot2_f32_bf16 v9, v45, v5, v9
    v_dot2_f32_bf16 v10, v49, v5, v10
    v_dot2_f32_bf16 v11, v53, v5, v11
    v_dot2_f32_bf16 v24, v57, v5, v24
    v_dot2_f32_bf16 v25, v61, v5, v25
    v_dot2_f32_bf16 v26, v65, v5, v26
    v_dot2_f32_bf16 v27, v69, v5, v27
    v_dot2_f32_bf16 v28, v105, v5, v28
    v_dot2_f32_bf16 v29, v109, v5, v29
    v_dot2_f32_bf16 v30, v113, v5, v30
    v_dot2_f32_bf16 v31, v117, v5, v31
    v_dot2_f32_bf16 v8, v42, v6, v8
    v_dot2_f32_bf16 v9, v46, v6, v9
    v_dot2_f32_bf16 v10, v50, v6, v10
    v_dot2_f32_bf16 v11, v54, v6, v11
    v_dot2_f32_bf16 v24, v58, v6, v24
    v_dot2_f32_bf16 v25, v62, v6, v25
    v_dot2_f32_bf16 v26, v66, v6, v26
    v_dot2_f32_bf16 v27, v70, v6, v27
    v_dot2_f32_bf16 v28, v106, v6, v28
    v_dot2_f32_bf16 v29, v110, v6, v29
    v_dot2_f32_bf16 v30, v114, v6, v30
    v_dot2_f32_bf16 v31, v118, v6, v31
    v_dot2_f32_bf16 v8, v43, v7, v8
    v_dot2_f32_bf16 v9, v47, v7, v9
    v_dot2_f32_bf16 v10, v51, v7, v10
    v_dot2_f32_bf16 v11, v55, v7, v11
    v_dot2_f32_bf16 v24, v59, v7, v24
    v_dot2_f32_bf16 v25, v63, v7, v25
    v_dot2_f32_bf16 v26, v67, v7, v26
    v_dot2_f32_bf16 v27, v71, v7, v27
    v_dot2_f32_bf16 v28, v107, v7, v28
    v_dot2_f32_bf16 v29, v111, v7, v29
    v_dot2_f32_bf16 v30, v115, v7, v30
    v_dot2_f32_bf16 v31, v119, v7, v31
    v_add_f32_dpp v8, v8, v8 row_ror:8 row_mask:0xf bank_mask:0x3
    v_add_f32_dpp v10, v10, v10 row_ror:8 row_mask:0xf bank_mask:0x3
    v_add_f32_dpp v24, v24, v24 row_ror:8 row_mask:0xf bank_mask:0x3
    v_add_f32_dpp v26, v26, v26 row_ror:8 row_mask:0xf bank_mask:0x3
    v_add_f32_dpp v28, v28, v28 row_ror:8 row_mask:0xf bank_mask:0x3
    v_add_f32_dpp v30, v30, v30 row_ror:8 row_mask:0xf bank_mask:0x3
    v_add_f32_dpp v8, v9, v9 row_ror:8 row_mask:0xf bank_mask:0xc
    v_add_f32_dpp v10, v11, v11 row_ror:8 row_mask:0xf bank_mask:0xc
    v_add_f32_dpp v24, v25, v25 row_ror:8 row_mask:0xf bank_mask:0xc
    v_add_f32_dpp v26, v27, v27 row_ror:8 row_mask:0xf bank_mask:0xc
    v_add_f32_dpp v28, v29, v29 row_ror:8 row_mask:0xf bank_mask:0xc
    v_add_f32_dpp v30, v31, v31 row_ror:8 row_mask:0xf bank_mask:0xc
    v_add_f32_dpp v12, v8, v8 row_half_mirror row_mask:0xf bank_mask:0x5
    v_add_f32_dpp v13, v24, v24 row_half_mirror row_mask:0xf bank_mask:0x5
    v_add_f32_dpp v16, v28, v28 row_half_mirror row_mask:0xf bank_mask:0x5
    v_add_f32_dpp v12, v10, v10 row_half_mirror row_mask:0xf bank_mask:0xa
    v_add_f32_dpp v13, v26, v26 row_half_mirror row_mask:0xf bank_mask:0xa
    v_add_f32_dpp v16, v30, v30 row_half_mirror row_mask:0xf bank_mask:0xa
    v_add_f32_dpp v12, v12, v12 quad_perm:[1,0,3,2] row_mask:0xf bank_mask:0xf
    v_add_f32_dpp v13, v13, v13 quad_perm:[1,0,3,2] row_mask:0xf bank_mask:0xf
    v_add_f32_dpp v16, v16, v16 quad_perm:[1,0,3,2] row_mask:0xf bank_mask:0xf
    v_add_f32_dpp v12, v12, v12 quad_perm:[2,3,0,1] row_mask:0xf bank_mask:0xf
    v_add_f32_dpp v13, v13, v13 quad_perm:[2,3,0,1] row_mask:0xf bank_mask:0xf
    v_add_f32_dpp v16, v16, v16 quad_perm:[2,3,0,1] row_mask:0xf bank_mask:0xf
    s_waitcnt vmcnt(3)
    s_bitcmp0_b32 s14, 9
    s_cbranch_scc1 L_sf_69
    s_waitcnt vmcnt(2)
    s_bitcmp0_b32 s15, 9
    s_cbranch_scc1 L_sf_69
    s_waitcnt vmcnt(1)
L_sf_69:
    buffer_load_dwordx4 v[76:79], v1, s[52:55], s97 offen offset:1024 nt
    v_dot2_f32_bf16 v8, v120, v4, 0
    v_dot2_f32_bf16 v9, v124, v4, 0
    v_dot2_f32_bf16 v10, v128, v4, 0
    v_dot2_f32_bf16 v11, v132, v4, 0
    v_dot2_f32_bf16 v24, v136, v4, 0
    v_dot2_f32_bf16 v25, v140, v4, 0
    v_dot2_f32_bf16 v26, v144, v4, 0
    v_dot2_f32_bf16 v27, v148, v4, 0
    v_dot2_f32_bf16 v8, v121, v5, v8
    v_dot2_f32_bf16 v9, v125, v5, v9
    v_dot2_f32_bf16 v10, v129, v5, v10
    v_dot2_f32_bf16 v11, v133, v5, v11
    v_dot2_f32_bf16 v24, v137, v5, v24
    v_dot2_f32_bf16 v25, v141, v5, v25
    v_dot2_f32_bf16 v26, v145, v5, v26
    v_dot2_f32_bf16 v27, v149, v5, v27
    v_dot2_f32_bf16 v8, v122, v6, v8
    v_dot2_f32_bf16 v9, v126, v6, v9
    v_dot2_f32_bf16 v10, v130, v6, v10
    v_dot2_f32_bf16 v11, v134, v6, v11
    v_dot2_f32_bf16 v24, v138, v6, v24
    v_dot2_f32_bf16 v25, v142, v6, v25
    v_dot2_f32_bf16 v26, v146, v6, v26
    v_dot2_f32_bf16 v27, v150, v6, v27
    v_dot2_f32_bf16 v8, v123, v7, v8
    v_dot2_f32_bf16 v9, v127, v7, v9
    v_dot2_f32_bf16 v10, v131, v7, v10
    v_dot2_f32_bf16 v11, v135, v7, v11
    v_dot2_f32_bf16 v24, v139, v7, v24
    v_dot2_f32_bf16 v25, v143, v7, v25
    v_dot2_f32_bf16 v26, v147, v7, v26
    v_dot2_f32_bf16 v27, v151, v7, v27
    v_add_f32_dpp v8, v8, v8 row_ror:8 row_mask:0xf bank_mask:0x3
    v_add_f32_dpp v10, v10, v10 row_ror:8 row_mask:0xf bank_mask:0x3
    v_add_f32_dpp v24, v24, v24 row_ror:8 row_mask:0xf bank_mask:0x3
    v_add_f32_dpp v26, v26, v26 row_ror:8 row_mask:0xf bank_mask:0x3
    v_add_f32_dpp v8, v9, v9 row_ror:8 row_mask:0xf bank_mask:0xc
    v_add_f32_dpp v10, v11, v11 row_ror:8 row_mask:0xf bank_mask:0xc
    v_add_f32_dpp v24, v25, v25 row_ror:8 row_mask:0xf bank_mask:0xc
    v_add_f32_dpp v26, v27, v27 row_ror:8 row_mask:0xf bank_mask:0xc
    v_add_f32_dpp v17, v8, v8 row_half_mirror row_mask:0xf bank_mask:0x5
    v_add_f32_dpp v18, v24, v24 row_half_mirror row_mask:0xf bank_mask:0x5
    v_add_f32_dpp v17, v10, v10 row_half_mirror row_mask:0xf bank_mask:0xa
    v_add_f32_dpp v18, v26, v26 row_half_mirror row_mask:0xf bank_mask:0xa
    s_nop 0
    v_add_f32_dpp v17, v17, v17 quad_perm:[1,0,3,2] row_mask:0xf bank_mask:0xf
    v_add_f32_dpp v18, v18, v18 quad_perm:[1,0,3,2] row_mask:0xf bank_mask:0xf
    s_nop 0
    v_add_f32_dpp v17, v17, v17 quad_perm:[2,3,0,1] row_mask:0xf bank_mask:0xf
    v_add_f32_dpp v18, v18, v18 quad_perm:[2,3,0,1] row_mask:0xf bank_mask:0xf
    s_waitcnt vmcnt(3)
    s_bitcmp0_b32 s14, 10
    s_cbranch_scc1 L_sf_70
    s_waitcnt vmcnt(2)
    s_bitcmp0_b32 s15, 10
    s_cbranch_scc1 L_sf_70
    s_waitcnt vmcnt(1)
L_sf_70:
    buffer_load_dwordx4 v[80:83], v1, s[52:55], s97 offen offset:2048 nt
    s_waitcnt vmcnt(3)
    s_bitcmp0_b32 s14, 11
    s_cbranch_scc1 L_sf_71
    s_waitcnt vmcnt(2)
    s_bitcmp0_b32 s15, 11
    s_cbranch_scc1 L_sf_71
    s_waitcnt vmcnt(1)
L_sf_71:
    buffer_load_dwordx4 v[84:87], v1, s[52:55], s97 offen offset:3072 nt
    s_add_u32 s97, s97, 32768
    v_add_u32 v1, 4096, v1
    v_and_b32 v1, 0x7fff, v1
    s_cmp_eq_u32 s12, -1
    s_cbranch_scc1 L_nopfrd
    v_lshl_add_u32 v38, v0, 4, s12
    ds_read_b128 v[40:43], v38 offset:0
    ds_read_b128 v[44:47], v38 offset:1024
    ds_read_b128 v[48:51], v38 offset:2048
    ds_read_b128 v[52:55], v38 offset:3072
    ds_read_b128 v[56:59], v38 offset:4096
    ds_read_b128 v[60:63], v38 offset:5120
    ds_read_b128 v[64:67], v38 offset:6144
    ds_read_b128 v[68:71], v38 offset:7168
L_nopfrd:
    v_dot2_f32_bf16 v8, v152, v4, 0
    v_dot2_f32_bf16 v9, v156, v4, 0
    v_dot2_f32_bf16 v10, v160, v4, 0
    v_dot2_f32_bf16 v11, v164, v4, 0
    v_dot2_f32_bf16 v8, v153, v5, v8
    v_dot2_f32_bf16 v9, v157, v5, v9
    v_dot2_f32_bf16 v10, v161, v5, v10
    v_dot2_f32_bf16 v11, v165, v5, v11
    v_dot2_f32_bf16 v8, v154, v6, v8
    v_dot2_f32_bf16 v9, v158, v6, v9
    v_dot2_f32_bf16 v10, v162, v6, v10
    v_dot2_f32_bf16 v11, v166, v6, v11
    v_dot2_f32_bf16 v8, v155, v7, v8
    v_dot2_f32_bf16 v9, v159, v7, v9
    v_dot2_f32_bf16 v10, v163, v7, v10
    v_dot2_f32_bf16 v11, v167, v7, v11
    v_add_f32_dpp v8, v8, v8 row_ror:8 row_mask:0xf bank_mask:0x3
    s_nop 0
    v_add_f32_dpp v10, v10, v10 row_ror:8 row_mask:0xf bank_mask:0x3
    v_add_f32_dpp v8, v9, v9 row_ror:8 row_mask:0xf bank_mask:0xc
    v_add_f32_dpp v10, v11, v11 row_ror:8 row_mask:0xf bank_mask:0xc
    s_nop 0
    v_add_f32_dpp v19, v8, v8 row_half_mirror row_mask:0xf bank_mask:0x5
    v_add_f32_dpp v19, v10, v10 row_half_mirror row_mask:0xf bank_mask:0xa
    s_nop 1
    v_add_f32_dpp v19, v19, v19 quad_perm:[1,0,3,2] row_mask:0xf bank_mask:0xf
    s_nop 1
    v_add_f32_dpp v19, v19, v19 quad_perm:[2,3,0,1] row_mask:0xf bank_mask:0xf
    v_max3_f32 v3, v12, v13, v14
    v_max3_f32 v8, v15, v16, v17
    v_max3_f32 v3, v3, v18, v19
    v_max_f32 v3, v3, v8
    s_nop 1
    v_max_f32_dpp v3, v3, v3 row_ror:4 row_mask:0xf bank_mask:0xf
    s_nop 1
    v_max_f32_dpp v3, v3, v3 row_ror:8 row_mask:0xf bank_mask:0xf
    v_mov_b32 v8, v3
    s_nop 1
    v_permlane16_swap_b32 v3, v8
    v_max_f32 v3, v3, v8
    v_mov_b32 v8, v3
    s_nop 1
    v_permlane32_swap_b32 v3, v8
    v_max_f32 v3, v3, v8
    s_mov_b32 s96, 0x3e0293ee
    v_mul_f32 v8, s96, v3
    v_fma_f32 v12, v12, s96, -v8
    v_fma_f32 v13, v13, s96, -v8
    v_fma_f32 v14, v14, s96, -v8
    v_fma_f32 v15, v15, s96, -v8
    v_fma_f32 v16, v16, s96, -v8
    v_fma_f32 v17, v17, s96, -v8
    v_fma_f32 v18, v18, s96, -v8
    v_fma_f32 v19, v19, s96, -v8
    v_exp_f32 v12, v12
    v_exp_f32 v13, v13
    v_exp_f32 v14, v14
    v_exp_f32 v15, v15
    v_exp_f32 v16, v16
    v_exp_f32 v17, v17
    v_exp_f32 v18, v18
    v_exp_f32 v19, v19
    v_add_f32 v9, v12, v13
    v_add_f32 v10, v14, v15
    v_add_f32 v11, v16, v17
    v_add_f32 v3, v18, v19
    v_add_f32 v9, v9, v10
    v_add_f32 v3, v3, v11
    v_add_f32 v9, v9, v3
    v_cvt_pk_bf16_f32 v12, v12, v12
    v_cvt_pk_bf16_f32 v13, v13, v13
    v_cvt_pk_bf16_f32 v14, v14, v14
    v_cvt_pk_bf16_f32 v15, v15, v15
    v_cvt_pk_bf16_f32 v16, v16, v16
    v_cvt_pk_bf16_f32 v17, v17, v17
    v_cvt_pk_bf16_f32 v18, v18, v18
    v_cvt_pk_bf16_f32 v19, v19, v19
    v_add_f32_dpp v9, v9, v9 row_ror:4 row_mask:0xf bank_mask:0xf
    s_nop 1
    v_add_f32_dpp v9, v9, v9 row_ror:8 row_mask:0xf bank_mask:0xf
    v_mov_b32 v10, v9
    s_nop 1
    v_permlane16_swap_b32 v9, v10
    v_add_f32 v9, v9, v10
    v_mov_b32 v10, v9
    s_nop 1
    v_permlane32_swap_b32 v9, v10
    v_add_f32 v9, v9, v10
    s_mov_b64 exec, 1
    s_cmp_lg_u32 s13, 0
    s_cbranch_scc1 L_mljob
    s_lshl_b32 s96, s3, 3
    s_add_u32 s96, s96, 161920
    v_mov_b32 v10, s96
    v_mov_b32 v11, 162068
    v_mov_b32 v3, 1
    ds_write_b64 v10, v[8:9]
    ds_add_u32 v11, v3
L_mldone:
    s_mov_b64 exec, -1
    v_lshrrev_b32 v2, 1, v2
    v_and_b32_dpp v24, v14, v20 row_newbcast:0 row_mask:0xf bank_mask:0xf
    v_and_b32_dpp v25, v14, v21 row_newbcast:0 row_mask:0xf bank_mask:0xf
    v_and_b32_dpp v26, v14, v22 row_newbcast:0 row_mask:0xf bank_mask:0xf
    v_and_b32_dpp v27, v14, v23 row_newbcast:0 row_mask:0xf bank_mask:0xf
    s_waitcnt vmcnt(3)
    s_bitcmp0_b32 s14, 12
    s_cbranch_scc1 L_sf_72
    s_waitcnt vmcnt(2)
    s_bitcmp0_b32 s15, 12
    s_cbranch_scc1 L_sf_72
    s_waitcnt vmcnt(1)
L_sf_72:
    buffer_load_dwordx4 v[88:91], v1, s[52:55], s97 offen offset:0 nt
    v_mfma_f32_16x16x32_bf16 v[32:35], v[24:27], v[72:75], v[32:35]
    s_cmp_eq_u32 s12, -1
    s_cbranch_scc1 L_nopfpv8
    s_waitcnt lgkmcnt(0)
    v_and_b32_dpp v24, v12, v20 row_newbcast:0 row_mask:0xf bank_mask:0xf
    v_and_b32_dpp v25, v12, v21 row_newbcast:0 row_mask:0xf bank_mask:0xf
    v_and_b32_dpp v26, v12, v22 row_newbcast:0 row_mask:0xf bank_mask:0xf
    v_and_b32_dpp v27, v12, v23 row_newbcast:0 row_mask:0xf bank_mask:0xf
    s_nop 1
    v_mfma_f32_16x16x32_bf16 v[32:35], v[24:27], v[40:43], v[32:35]
    v_and_b32_dpp v28, v12, v20 row_newbcast:8 row_mask:0xf bank_mask:0xf
    v_and_b32_dpp v29, v12, v21 row_newbcast:8 row_mask:0xf bank_mask:0xf
    v_and_b32_dpp v30, v12, v22 row_newbcast:8 row_mask:0xf bank_mask:0xf
    v_and_b32_dpp v31, v12, v23 row_newbcast:8 row_mask:0xf bank_mask:0xf
    s_nop 1
    v_mfma_f32_16x16x32_bf16 v[32:35], v[28:31], v[44:47], v[32:35]
    v_and_b32_dpp v24, v12, v20 row_newbcast:4 row_mask:0xf bank_mask:0xf
    v_and_b32_dpp v25, v12, v21 row_newbcast:4 row_mask:0xf bank_mask:0xf
    v_and_b32_dpp v26, v12, v22 row_newbcast:4 row_mask:0xf bank_mask:0xf
    v_and_b32_dpp v27, v12, v23 row_newbcast:4 row_mask:0xf bank_mask:0xf
    s_nop 1
    v_mfma_f32_16x16x32_bf16 v[32:35], v[24:27], v[48:51], v[32:35]
    v_and_b32_dpp v28, v12, v20 row_newbcast:12 row_mask:0xf bank_mask:0xf
    v_and_b32_dpp v29, v12, v21 row_newbcast:12 row_mask:0xf bank_mask:0xf
    v_and_b32_dpp v30, v12, v22 row_newbcast:12 row_mask:0xf bank_mask:0xf
    v_and_b32_dpp v31, v12, v23 row_newbcast:12 row_mask:0xf bank_mask:0xf
    s_nop 1
    v_mfma_f32_16x16x32_bf16 v[32:35], v[28:31], v[52:55], v[32:35]
L_nopfpv8:
    v_and_b32_dpp v28, v14, v20 row_newbcast:8 row_mask:0xf bank_mask:0xf
    v_and_b32_dpp v29, v14, v21 row_newbcast:8 row_mask:0xf bank_mask:0xf
    v_and_b32_dpp v30, v14, v22 row_newbcast:8 row_mask:0xf bank_mask:0xf
    v_and_b32_dpp v31, v14, v23 row_newbcast:8 row_mask:0xf bank_mask:0xf
    s_waitcnt vmcnt(3)
    s_bitcmp0_b32 s14, 13
    s_cbranch_scc1 L_sf_73
    s_waitcnt vmcnt(2)
    s_bitcmp0_b32 s15, 13
    s_cbranch_scc1 L_sf_73
    s_waitcnt vmcnt(1)
L_sf_73:
    buffer_load_dwordx4 v[92:95], v1, s[52:55], s97 offen offset:1024 nt
    v_mfma_f32_16x16x32_bf16 v[32:35], v[28:31], v[76:79], v[32:35]
    s_cmp_eq_u32 s12, -1
    s_cbranch_scc1 L_nopfpv9
    s_waitcnt lgkmcnt(0)
    v_and_b32_dpp v24, v13, v20 row_newbcast:0 row_mask:0xf bank_mask:0xf
    v_and_b32_dpp v25, v13, v21 row_newbcast:0 row_mask:0xf bank_mask:0xf
    v_and_b32_dpp v26, v13, v22 row_newbcast:0 row_mask:0xf bank_mask:0xf
    v_and_b32_dpp v27, v13, v23 row_newbcast:0 row_mask:0xf bank_mask:0xf
    s_nop 1
    v_mfma_f32_16x16x32_bf16 v[32:35], v[24:27], v[56:59], v[32:35]
    v_and_b32_dpp v28, v13, v20 row_newbcast:8 row_mask:0xf bank_mask:0xf
    v_and_b32_dpp v29, v13, v21 row_newbcast:8 row_mask:0xf bank_mask:0xf
    v_and_b32_dpp v30, v13, v22 row_newbcast:8 row_mask:0xf bank_mask:0xf
    v_and_b32_dpp v31, v13, v23 row_newbcast:8 row_mask:0xf bank_mask:0xf
    s_nop 1
    v_mfma_f32_16x16x32_bf16 v[32:35], v[28:31], v[60:63], v[32:35]
    v_and_b32_dpp v24, v13, v20 row_newbcast:4 row_mask:0xf bank_mask:0xf
    v_and_b32_dpp v25, v13, v21 row_newbcast:4 row_mask:0xf bank_mask:0xf
    v_and_b32_dpp v26, v13, v22 row_newbcast:4 row_mask:0xf bank_mask:0xf
    v_and_b32_dpp v27, v13, v23 row_newbcast:4 row_mask:0xf bank_mask:0xf
    s_nop 1
    v_mfma_f32_16x16x32_bf16 v[32:35], v[24:27], v[64:67], v[32:35]
    v_and_b32_dpp v28, v13, v20 row_newbcast:12 row_mask:0xf bank_mask:0xf
    v_and_b32_dpp v29, v13, v21 row_newbcast:12 row_mask:0xf bank_mask:0xf
    v_and_b32_dpp v30, v13, v22 row_newbcast:12 row_mask:0xf bank_mask:0xf
    v_and_b32_dpp v31, v13, v23 row_newbcast:12 row_mask:0xf bank_mask:0xf
    s_nop 1
    v_mfma_f32_16x16x32_bf16 v[32:35], v[28:31], v[68:71], v[32:35]
L_nopfpv9:
    v_and_b32_dpp v24, v14, v20 row_newbcast:4 row_mask:0xf bank_mask:0xf
    v_and_b32_dpp v25, v14, v21 row_newbcast:4 row_mask:0xf bank_mask:0xf
    v_and_b32_dpp v26, v14, v22 row_newbcast:4 row_mask:0xf bank_mask:0xf
    v_and_b32_dpp v27, v14, v23 row_newbcast:4 row_mask:0xf bank_mask:0xf
    s_waitcnt vmcnt(3)
    s_bitcmp0_b32 s14, 14
    s_cbranch_scc1 L_sf_74
    s_waitcnt vmcnt(2)
    s_bitcmp0_b32 s15, 14
    s_cbranch_scc1 L_sf_74
    s_waitcnt vmcnt(1)
L_sf_74:
    buffer_load_dwordx4 v[96:99], v1, s[52:55], s97 offen offset:2048 nt
    v_mfma_f32_16x16x32_bf16 v[32:35], v[24:27], v[80:83], v[32:35]
    v_and_b32_dpp v28, v14, v20 row_newbcast:12 row_mask:0xf bank_mask:0xf
    v_and_b32_dpp v29, v14, v21 row_newbcast:12 row_mask:0xf bank_mask:0xf
    v_and_b32_dpp v30, v14, v22 row_newbcast:12 row_mask:0xf bank_mask:0xf
    v_and_b32_dpp v31, v14, v23 row_newbcast:12 row_mask:0xf bank_mask:0xf
    s_waitcnt vmcnt(3)
    s_bitcmp0_b32 s14, 15
    s_cbranch_scc1 L_sf_75
    s_waitcnt vmcnt(2)
    s_bitcmp0_b32 s15, 15
    s_cbranch_scc1 L_sf_75
    s_waitcnt vmcnt(1)
L_sf_75:
    buffer_load_dwordx4 v[100:103], v1, s[52:55], s97 offen offset:3072 nt
    s_add_u32 s97, s97, 32768
    v_add_u32 v1, 4096, v1
    v_and_b32 v1, 0x7fff, v1
    v_mfma_f32_16x16x32_bf16 v[32:35], v[28:31], v[84:87], v[32:35]
    v_and_b32_dpp v24, v15, v20 row_newbcast:0 row_mask:0xf bank_mask:0xf
    v_and_b32_dpp v25, v15, v21 row_newbcast:0 row_mask:0xf bank_mask:0xf
    v_and_b32_dpp v26, v15, v22 row_newbcast:0 row_mask:0xf bank_mask:0xf
    v_and_b32_dpp v27, v15, v23 row_newbcast:0 row_mask:0xf bank_mask:0xf
    s_waitcnt vmcnt(3)
    s_bitcmp0_b32 s14, 16
    s_cbranch_scc1 L_sf_76
    s_waitcnt vmcnt(2)
    s_bitcmp0_b32 s15, 16
    s_cbranch_scc1 L_sf_76
    s_waitcnt vmcnt(1)
L_sf_76:
    buffer_load_dwordx4 v[104:107], v1, s[52:55], s97 offen offset:0 nt
    v_mfma_f32_16x16x32_bf16 v[32:35], v[24:27], v[88:91], v[32:35]
    v_and_b32_dpp v28, v15, v20 row_newbcast:8 row_mask:0xf bank_mask:0xf
    v_and_b32_dpp v29, v15, v21 row_newbcast:8 row_mask:0xf bank_mask:0xf
    v_and_b32_dpp v30, v15, v22 row_newbcast:8 row_mask:0xf bank_mask:0xf
    v_and_b32_dpp v31, v15, v23 row_newbcast:8 row_mask:0xf bank_mask:0xf
    s_waitcnt vmcnt(3)
    s_bitcmp0_b32 s14, 17
    s_cbranch_scc1 L_sf_77
    s_waitcnt vmcnt(2)
    s_bitcmp0_b32 s15, 17
    s_cbranch_scc1 L_sf_77
    s_waitcnt vmcnt(1)
L_sf_77:
    buffer_load_dwordx4 v[108:111], v1, s[52:55], s97 offen offset:1024 nt
    v_mfma_f32_16x16x32_bf16 v[32:35], v[28:31], v[92:95], v[32:35]
    v_and_b32_dpp v24, v15, v20 row_newbcast:4 row_mask:0xf bank_mask:0xf
    v_and_b32_dpp v25, v15, v21 row_newbcast:4 row_mask:0xf bank_mask:0xf
    v_and_b32_dpp v26, v15, v22 row_newbcast:4 row_mask:0xf bank_mask:0xf
    v_and_b32_dpp v27, v15, v23 row_newbcast:4 row_mask:0xf bank_mask:0xf
    s_waitcnt vmcnt(3)
    s_bitcmp0_b32 s14, 18
    s_cbranch_scc1 L_sf_78
    s_waitcnt vmcnt(2)
    s_bitcmp0_b32 s15, 18
    s_cbranch_scc1 L_sf_78
    s_waitcnt vmcnt(1)
L_sf_78:
    buffer_load_dwordx4 v[112:115], v1, s[52:55], s97 offen offset:2048 nt
    v_mfma_f32_16x16x32_bf16 v[32:35], v[24:27], v[96:99], v[32:35]
    v_and_b32_dpp v28, v15, v20 row_newbcast:12 row_mask:0xf bank_mask:0xf
    v_and_b32_dpp v29, v15, v21 row_newbcast:12 row_mask:0xf bank_mask:0xf
    v_and_b32_dpp v30, v15, v22 row_newbcast:12 row_mask:0xf bank_mask:0xf
    v_and_b32_dpp v31, v15, v23 row_newbcast:12 row_mask:0xf bank_mask:0xf
    s_waitcnt vmcnt(3)
    s_bitcmp0_b32 s14, 19
    s_cbranch_scc1 L_sf_79
    s_waitcnt vmcnt(2)
    s_bitcmp0_b32 s15, 19
    s_cbranch_scc1 L_sf_79
    s_waitcnt vmcnt(1)
L_sf_79:
    buffer_load_dwordx4 v[116:119], v1, s[52:55], s97 offen offset:3072 nt
    s_add_u32 s97, s97, 32768
    v_add_u32 v1, 4096, v1
    v_and_b32 v1, 0x7fff, v1
    v_mfma_f32_16x16x32_bf16 v[32:35], v[28:31], v[100:103], v[32:35]
    v_and_b32_dpp v24, v16, v20 row_newbcast:0 row_mask:0xf bank_mask:0xf
    v_and_b32_dpp v25, v16, v21 row_newbcast:0 row_mask:0xf bank_mask:0xf
    v_and_b32_dpp v26, v16, v22 row_newbcast:0 row_mask:0xf bank_mask:0xf
    v_and_b32_dpp v27, v16, v23 row_newbcast:0 row_mask:0xf bank_mask:0xf
    s_waitcnt vmcnt(3)
    s_bitcmp0_b32 s14, 20
    s_cbranch_scc1 L_sf_80
    s_waitcnt vmcnt(2)
    s_bitcmp0_b32 s15, 20
    s_cbranch_scc1 L_sf_80
    s_waitcnt vmcnt(1)
L_sf_80:
    buffer_load_dwordx4 v[120:123], v1, s[52:55], s97 offen offset:0 nt
    v_mfma_f32_16x16x32_bf16 v[32:35], v[24:27], v[104:107], v[32:35]
    v_and_b32_dpp v28, v16, v20 row_newbcast:8 row_mask:0xf bank_mask:0xf
    v_and_b32_dpp v29, v16, v21 row_newbcast:8 row_mask:0xf bank_mask:0xf
    v_and_b32_dpp v30, v16, v22 row_newbcast:8 row_mask:0xf bank_mask:0xf
    v_and_b32_dpp v31, v16, v23 row_newbcast:8 row_mask:0xf bank_mask:0xf
    s_waitcnt vmcnt(3)
    s_bitcmp0_b32 s14, 21
    s_cbranch_scc1 L_sf_81
    s_waitcnt vmcnt(2)
    s_bitcmp0_b32 s15, 21
    s_cbranch_scc1 L_sf_81
    s_waitcnt vmcnt(1)
L_sf_81:
    buffer_load_dwordx4 v[124:127], v1, s[52:55], s97 offen offset:1024 nt
    v_mfma_f32_16x16x32_bf16 v[32:35], v[28:31], v[108:111], v[32:35]
    v_and_b32_dpp v24, v16, v20 row_newbcast:4 row_mask:0xf bank_mask:0xf
    v_and_b32_dpp v25, v16, v21 row_newbcast:4 row_mask:0xf bank_mask:0xf
    v_and_b32_dpp v26, v16, v22 row_newbcast:4 row_mask:0xf bank_mask:0xf
    v_and_b32_dpp v27, v16, v23 row_newbcast:4 row_mask:0xf bank_mask:0xf
    s_waitcnt vmcnt(3)
    s_bitcmp0_b32 s14, 22
    s_cbranch_scc1 L_sf_82
    s_waitcnt vmcnt(2)
    s_bitcmp0_b32 s15, 22
    s_cbranch_scc1 L_sf_82
    s_waitcnt vmcnt(1)
L_sf_82:
    buffer_load_dwordx4 v[128:131], v1, s[52:55], s97 offen offset:2048 nt
    v_mfma_f32_16x16x32_bf16 v[32:35], v[24:27], v[112:115], v[32:35]
    v_and_b32_dpp v28, v16, v20 row_newbcast:12 row_mask:0xf bank_mask:0xf
    v_and_b32_dpp v29, v16, v21 row_newbcast:12 row_mask:0xf bank_mask:0xf
    v_and_b32_dpp v30, v16, v22 row_newbcast:12 row_mask:0xf bank_mask:0xf
    v_and_b32_dpp v31, v16, v23 row_newbcast:12 row_mask:0xf bank_mask:0xf
    s_waitcnt vmcnt(3)
    s_bitcmp0_b32 s14, 23
    s_cbranch_scc1 L_sf_83
    s_waitcnt vmcnt(2)
    s_bitcmp0_b32 s15, 23
    s_cbranch_scc1 L_sf_83
    s_waitcnt vmcnt(1)
L_sf_83:
    buffer_load_dwordx4 v[132:135], v1, s[52:55], s97 offen offset:3072 nt
    s_add_u32 s97, s97, 32768
    v_add_u32 v1, 4096, v1
    v_and_b32 v1, 0x7fff, v1
    v_mfma_f32_16x16x32_bf16 v[32:35], v[28:31], v[116:119], v[32:35]
    v_and_b32_dpp v24, v17, v20 row_newbcast:0 row_mask:0xf bank_mask:0xf
    v_and_b32_dpp v25, v17, v21 row_newbcast:0 row_mask:0xf bank_mask:0xf
    v_and_b32_dpp v26, v17, v22 row_newbcast:0 row_mask:0xf bank_mask:0xf
    v_and_b32_dpp v27, v17, v23 row_newbcast:0 row_mask:0xf bank_mask:0xf
    s_waitcnt vmcnt(3)
    s_bitcmp0_b32 s14, 24
    s_cbranch_scc1 L_sf_84
    s_waitcnt vmcnt(2)
    s_bitcmp0_b32 s15, 24
    s_cbranch_scc1 L_sf_84
    s_waitcnt vmcnt(1)
L_sf_84:
    buffer_load_dwordx4 v[136:139], v1, s[52:55], s97 offen offset:0 nt
    v_mfma_f32_16x16x32_bf16 v[32:35], v[24:27], v[120:123], v[32:35]
    s_or_b32 s96, s59, 0
    s_cbranch_scc0 L_nofrag_85
    v_mov_b32 v104, 162060
L_lw_86:
    ds_read_b32 v105, v104
    s_waitcnt lgkmcnt(0)
    v_cmp_gt_u32 vcc, 4, v105
    s_cbranch_vccz L_lw_86e
    s_sleep 2
    s_sub_u32 s60, s60, 1
    s_cbranch_scc0 L_lw_86
    s_mov_b32 s60, 0
L_lw_86e:
    s_cmp_eq_u32 s59, 0
    s_cbranch_scc1 L_nofrag_85
    v_bfe_u32 v104, v0, 2, 1
    v_bfe_u32 v110, v0, 4, 1
    v_lshl_add_u32 v104, v110, 2, v104
    v_and_b32 v110, 8, v0
    v_add_u32 v104, v104, v110
    v_lshrrev_b32 v110, 5, v0
    v_lshl_add_u32 v104, v110, 4, v104
    v_bfe_u32 v111, v0, 0, 1
    v_mul_u32_u24 v111, 0xaaaa, v111
    v_add_u32 v111, 0x4444, v111
    v_mov_b32 v112, 0
    v_mov_b32 v113, 0
    v_mov_b32 v114, 0
    v_mov_b32 v115, 0
    v_mov_b32 v116, 0
    v_mov_b32 v117, 0
    v_mov_b32 v118, 0
    v_mov_b32 v119, 0
    v_lshlrev_b32 v104, 7, v104
    v_and_b32 v110, 3, v0
    v_lshl_add_u32 v104, v110, 3, v104
    v_lshrrev_b32 v109, 4, v0
    v_and_b32 v110, 1, v0
    s_lshr_b32 s63, s3, 1
    s_and_b32 s62, s3, 1
    s_lshl_b32 s96, s63, 14
    s_lshl_b32 s100, s62, 6
    s_add_u32 s100, s100, 81920
    s_add_u32 s96, s96, s100
    v_add_u32 v104, s96, v104
    ds_read_b64_tr_b16 v[72:73], v104 offset:0
    ds_read_b64_tr_b16 v[74:75], v104 offset:256
    ds_read_b64_tr_b16 v[76:77], v104 offset:4096
    ds_read_b64_tr_b16 v[78:79], v104 offset:4352
    ds_read_b64_tr_b16 v[80:81], v104 offset:32
    ds_read_b64_tr_b16 v[82:83], v104 offset:288
    ds_read_b64_tr_b16 v[84:85], v104 offset:4128
    ds_read_b64_tr_b16 v[86:87], v104 offset:4384
    ds_read_b64_tr_b16 v[88:89], v104 offset:8192
    ds_read_b64_tr_b16 v[90:91], v104 offset:8448
    ds_read_b64_tr_b16 v[92:93], v104 offset:12288
    ds_read_b64_tr_b16 v[94:95], v104 offset:12544
    ds_read_b64_tr_b16 v[96:97], v104 offset:8224
    ds_read_b64_tr_b16 v[98:99], v104 offset:8480
    ds_read_b64_tr_b16 v[100:101], v104 offset:12320
    ds_read_b64_tr_b16 v[102:103], v104 offset:12576
    v_bfe_u32 v105, v0, 1, 3
    v_lshlrev_b32 v105, 8, v105
    v_lshl_add_u32 v105, v109, 5, v105
    v_lshl_add_u32 v105, v110, 4, v105
    v_lshrrev_b32 v106, 3, v0
    v_lshlrev_b32 v106, 7, v106
    v_and_b32 v110, 7, v0
    v_lshl_add_u32 v107, v110, 3, v106
    v_add_u32 v107, s100, v107
    v_lshlrev_b32 v106, 8, v109
    v_and_b32 v110, 15, v0
    v_lshl_add_u32 v106, v110, 2, v106
    v_add_u32 v106, s96, v106
    v_lshlrev_b32 v108, 2, v0
    s_lshl_b32 s96, s62, 2
    s_add_u32 s96, s96, 162088
    v_mov_b32 v109, s96
    s_lshl_b32 s100, s63, 11
    s_lshl_b32 s96, s34, 13
    s_add_u32 s100, s100, s96
    s_add_u32 s100, s100, 106496
    s_mul_i32 s101, s34, 5120
    s_lshl_b32 s96, s35, 9
    s_add_u32 s101, s101, s96
    s_lshl_b32 s96, s62, 8
    s_add_u32 s101, s101, s96
    s_sub_u32 s101, s101, 11264
    s_and_b32 s96, s101, 0xffffe000
    s_add_u32 s101, s101, s96
    s_add_u32 s101, s101, 212992
    v_add_u32 v110, 8192, v108
L_nofrag_85:
    v_and_b32_dpp v28, v17, v20 row_newbcast:8 row_mask:0xf bank_mask:0xf
    v_and_b32_dpp v29, v17, v21 row_newbcast:8 row_mask:0xf bank_mask:0xf
    v_and_b32_dpp v30, v17, v22 row_newbcast:8 row_mask:0xf bank_mask:0xf
    v_and_b32_dpp v31, v17, v23 row_newbcast:8 row_mask:0xf bank_mask:0xf
    s_waitcnt vmcnt(3)
    s_bitcmp0_b32 s14, 25
    s_cbranch_scc1 L_sf_87
    s_waitcnt vmcnt(2)
    s_bitcmp0_b32 s15, 25
    s_cbranch_scc1 L_sf_87
    s_waitcnt vmcnt(1)
L_sf_87:
    buffer_load_dwordx4 v[140:143], v1, s[52:55], s97 offen offset:1024 nt
    v_mfma_f32_16x16x32_bf16 v[32:35], v[28:31], v[124:127], v[32:35]
    v_and_b32_dpp v24, v17, v20 row_newbcast:4 row_mask:0xf bank_mask:0xf
    v_and_b32_dpp v25, v17, v21 row_newbcast:4 row_mask:0xf bank_mask:0xf
    v_and_b32_dpp v26, v17, v22 row_newbcast:4 row_mask:0xf bank_mask:0xf
    v_and_b32_dpp v27, v17, v23 row_newbcast:4 row_mask:0xf bank_mask:0xf
    s_waitcnt vmcnt(3)
    s_bitcmp0_b32 s14, 26
    s_cbranch_scc1 L_sf_88
    s_waitcnt vmcnt(2)
    s_bitcmp0_b32 s15, 26
    s_cbranch_scc1 L_sf_88
    s_waitcnt vmcnt(1)
L_sf_88:
    buffer_load_dwordx4 v[144:147], v1, s[52:55], s97 offen offset:2048 nt
    v_mfma_f32_16x16x32_bf16 v[32:35], v[24:27], v[128:131], v[32:35]
    v_and_b32_dpp v28, v17, v20 row_newbcast:12 row_mask:0xf bank_mask:0xf
    v_and_b32_dpp v29, v17, v21 row_newbcast:12 row_mask:0xf bank_mask:0xf
    v_and_b32_dpp v30, v17, v22 row_newbcast:12 row_mask:0xf bank_mask:0xf
    v_and_b32_dpp v31, v17, v23 row_newbcast:12 row_mask:0xf bank_mask:0xf
    s_waitcnt vmcnt(3)
    s_bitcmp0_b32 s14, 27
    s_cbranch_scc1 L_sf_89
    s_waitcnt vmcnt(2)
    s_bitcmp0_b32 s15, 27
    s_cbranch_scc1 L_sf_89
    s_waitcnt vmcnt(1)
L_sf_89:
    buffer_load_dwordx4 v[148:151], v1, s[52:55], s97 offen offset:3072 nt
    s_add_u32 s97, s97, 32768
    v_add_u32 v1, 4096, v1
    v_and_b32 v1, 0x7fff, v1
    v_mfma_f32_16x16x32_bf16 v[32:35], v[28:31], v[132:135], v[32:35]
    v_and_b32_dpp v24, v18, v20 row_newbcast:0 row_mask:0xf bank_mask:0xf
    v_and_b32_dpp v25, v18, v21 row_newbcast:0 row_mask:0xf bank_mask:0xf
    v_and_b32_dpp v26, v18, v22 row_newbcast:0 row_mask:0xf bank_mask:0xf
    v_and_b32_dpp v27, v18, v23 row_newbcast:0 row_mask:0xf bank_mask:0xf
    s_waitcnt vmcnt(3)
    s_bitcmp0_b32 s14, 28
    s_cbranch_scc1 L_sf_90
    s_waitcnt vmcnt(2)
    s_bitcmp0_b32 s15, 28
    s_cbranch_scc1 L_sf_90
    s_waitcnt vmcnt(1)
L_sf_90:
    buffer_load_dwordx4 v[152:155], v1, s[52:55], s97 offen offset:0 nt
    v_mfma_f32_16x16x32_bf16 v[32:35], v[24:27], v[136:139], v[32:35]
    v_mov_b32 v10, 162076
    v_mov_b32 v11, 1
    s_mov_b64 exec, 1
    ds_add_u32 v10, v11
    s_mov_b64 exec, -1
    v_and_b32_dpp v28, v18, v20 row_newbcast:8 row_mask:0xf bank_mask:0xf
    v_and_b32_dpp v29, v18, v21 row_newbcast:8 row_mask:0xf bank_mask:0xf
    v_and_b32_dpp v30, v18, v22 row_newbcast:8 row_mask:0xf bank_mask:0xf
    v_and_b32_dpp v31, v18, v23 row_newbcast:8 row_mask:0xf bank_mask:0xf
    s_waitcnt vmcnt(3)
    s_bitcmp0_b32 s14, 29
    s_cbranch_scc1 L_sf_91
    s_waitcnt vmcnt(2)
    s_bitcmp0_b32 s15, 29
    s_cbranch_scc1 L_sf_91
    s_waitcnt vmcnt(1)
L_sf_91:
    buffer_load_dwordx4 v[156:159], v1, s[52:55], s97 offen offset:1024 nt
    v_mfma_f32_16x16x32_bf16 v[32:35], v[28:31], v[140:143], v[32:35]
    v_and_b32_dpp v24, v18, v20 row_newbcast:4 row_mask:0xf bank_mask:0xf
    v_and_b32_dpp v25, v18, v21 row_newbcast:4 row_mask:0xf bank_mask:0xf
    v_and_b32_dpp v26, v18, v22 row_newbcast:4 row_mask:0xf bank_mask:0xf
    v_and_b32_dpp v27, v18, v23 row_newbcast:4 row_mask:0xf bank_mask:0xf
    s_waitcnt vmcnt(3)
    s_bitcmp0_b32 s14, 30
    s_cbranch_scc1 L_sf_92
    s_waitcnt vmcnt(2)
    s_bitcmp0_b32 s15, 30
    s_cbranch_scc1 L_sf_92
    s_waitcnt vmcnt(1)
L_sf_92:
    buffer_load_dwordx4 v[160:163], v1, s[52:55], s97 offen offset:2048 nt
    v_mfma_f32_16x16x32_bf16 v[32:35], v[24:27], v[144:147], v[32:35]
    v_lshrrev_b32 v9, 4, v0
    v_lshl_add_u32 v8, v9, 2, v2
    s_lshl_b32 s96, s3, 9
    s_add_u32 s96, s96, 157824
    v_lshl_add_u32 v8, v8, 2, s96
    v_lshlrev_b32 v9, 3, v0
    v_add_u32 v9, 157824, v9
    v_mov_b32 v10, 162048
    v_mov_b32 v11, 1
    s_lshl_b32 s96, s38, 5
    s_add_u32 s96, s96, 161984
    v_mov_b32 v3, s96
    s_sub_u32 s62, 8, s39
    s_lshl_b32 s98, s34, 5
    s_add_u32 s98, s98, s35
    s_lshl_b32 s98, s98, 8
    s_add_u32 s98, s98, 106496
    v_lshlrev_b32 v39, 2, v0
    v_and_b32_dpp v28, v18, v20 row_newbcast:12 row_mask:0xf bank_mask:0xf
    v_and_b32_dpp v29, v18, v21 row_newbcast:12 row_mask:0xf bank_mask:0xf
    v_and_b32_dpp v30, v18, v22 row_newbcast:12 row_mask:0xf bank_mask:0xf
    v_and_b32_dpp v31, v18, v23 row_newbcast:12 row_mask:0xf bank_mask:0xf
    s_waitcnt vmcnt(3)
    s_bitcmp0_b32 s14, 31
    s_cbranch_scc1 L_sf_93
    s_waitcnt vmcnt(2)
    s_bitcmp0_b32 s15, 31
    s_cbranch_scc1 L_sf_93
    s_waitcnt vmcnt(1)
L_sf_93:
    buffer_load_dwordx4 v[164:167], v1, s[52:55], s97 offen offset:3072 nt
    s_mov_b32 s97, 0
    v_add_u32 v1, 4096, v1
    v_and_b32 v1, 0x7fff, v1
    v_mfma_f32_16x16x32_bf16 v[32:35], v[28:31], v[148:151], v[32:35]
    s_cmp_eq_u32 s12, -1
    s_cbranch_scc1 L_v_nopf
    v_and_b32_dpp v24, v19, v20 row_newbcast:0 row_mask:0xf bank_mask:0xf
    v_and_b32_dpp v25, v19, v21 row_newbcast:0 row_mask:0xf bank_mask:0xf
    v_and_b32_dpp v26, v19, v22 row_newbcast:0 row_mask:0xf bank_mask:0xf
    v_and_b32_dpp v27, v19, v23 row_newbcast:0 row_mask:0xf bank_mask:0xf
    s_waitcnt vmcnt(3)
    s_nop 0
    v_mfma_f32_16x16x32_bf16 v[32:35], v[24:27], v[152:155], v[32:35]
    v_and_b32_dpp v28, v19, v20 row_newbcast:8 row_mask:0xf bank_mask:0xf
    v_and_b32_dpp v29, v19, v21 row_newbcast:8 row_mask:0xf bank_mask:0xf
    v_and_b32_dpp v30, v19, v22 row_newbcast:8 row_mask:0xf bank_mask:0xf
    v_and_b32_dpp v31, v19, v23 row_newbcast:8 row_mask:0xf bank_mask:0xf
    s_waitcnt vmcnt(2)
    s_nop 0
    v_mfma_f32_16x16x32_bf16 v[32:35], v[28:31], v[156:159], v[32:35]
    v_and_b32_dpp v24, v19, v20 row_newbcast:4 row_mask:0xf bank_mask:0xf
    v_and_b32_dpp v25, v19, v21 row_newbcast:4 row_mask:0xf bank_mask:0xf
    v_and_b32_dpp v26, v19, v22 row_newbcast:4 row_mask:0xf bank_mask:0xf
    v_and_b32_dpp v27, v19, v23 row_newbcast:4 row_mask:0xf bank_mask:0xf
    s_waitcnt vmcnt(1)
    s_nop 0
    v_mfma_f32_16x16x32_bf16 v[32:35], v[24:27], v[160:163], v[32:35]
    v_and_b32_dpp v28, v19, v20 row_newbcast:12 row_mask:0xf bank_mask:0xf
    v_and_b32_dpp v29, v19, v21 row_newbcast:12 row_mask:0xf bank_mask:0xf
    v_and_b32_dpp v30, v19, v22 row_newbcast:12 row_mask:0xf bank_mask:0xf
    v_and_b32_dpp v31, v19, v23 row_newbcast:12 row_mask:0xf bank_mask:0xf
    s_waitcnt vmcnt(0)
    s_nop 0
    v_mfma_f32_16x16x32_bf16 v[32:35], v[28:31], v[164:167], v[32:35]
L_v_join:
    s_cmp_lg_u32 s13, 0
    s_cbranch_scc1 L_jobend
L_t0:
    s_mov_b32 exec_hi, 0
    s_nop 4
    ds_write_b128 v8, v[32:35]
L_t0b:
    s_mov_b64 exec, 1
    ds_add_rtn_u32 v37, v10, v11
    s_mov_b64 exec, -1
    ds_read_b32 v38, v10 offset:24
    ds_read_b128 v[24:27], v3
    ds_read_b128 v[28:31], v3 offset:16
    ds_read_b64 v[144:145], v9 offset:0
    ds_read_b64 v[146:147], v9 offset:512
    ds_read_b64 v[148:149], v9 offset:1024
    ds_read_b64 v[150:151], v9 offset:1536
    ds_read_b64 v[152:153], v9 offset:2048
    ds_read_b64 v[154:155], v9 offset:2560
    ds_read_b64 v[156:157], v9 offset:3072
    ds_read_b64 v[158:159], v9 offset:3584
    s_waitcnt lgkmcnt(10)
    v_readfirstlane_b32 s96, v37
    v_readfirstlane_b32 s61, v38
    s_cmp_lg_u32 s96, s62
    s_cbranch_scc1 L_nopub
    s_waitcnt lgkmcnt(6)
    v_pk_mul_f32 v[144:145], v[144:145], v[24:25] op_sel:[0,0] op_sel_hi:[1,0]
    v_pk_mul_f32 v[146:147], v[146:147], v[24:25] op_sel:[0,1] op_sel_hi:[1,1]
    s_waitcnt lgkmcnt(4)
    v_pk_fma_f32 v[144:145], v[148:149], v[26:27], v[144:145] op_sel:[0,0,0] op_sel_hi:[1,0,1]
    v_pk_fma_f32 v[146:147], v[150:151], v[26:27], v[146:147] op_sel:[0,1,0] op_sel_hi:[1,1,1]
    s_waitcnt lgkmcnt(2)
    v_pk_fma_f32 v[144:145], v[152:153], v[28:29], v[144:145] op_sel:[0,0,0] op_sel_hi:[1,0,1]
    v_pk_fma_f32 v[146:147], v[154:155], v[28:29], v[146:147] op_sel:[0,1,0] op_sel_hi:[1,1,1]
    s_waitcnt lgkmcnt(0)
    v_pk_fma_f32 v[144:145], v[156:157], v[30:31], v[144:145] op_sel:[0,0,0] op_sel_hi:[1,0,1]
    v_pk_fma_f32 v[146:147], v[158:159], v[30:31], v[146:147] op_sel:[0,1,0] op_sel_hi:[1,1,1]
    s_cmp_eq_u32 s61, 1
    v_pk_add_f32 v[144:145], v[144:145], v[146:147]
    v_cvt_pk_bf16_f32 v32, v144, v145
    s_cbranch_scc0 L_oslow
    buffer_store_dword v32, v39, s[40:43], s98 offen
L_odone:
L_nopub:
    s_cmp_eq_u32 s59, 0
    s_cbranch_scc1 L_not1
L_poll_102:
    buffer_load_dwordx4 v[16:19], v105, s[40:43], s100 offen sc1
    buffer_load_dwordx4 v[20:23], v105, s[40:43], s100 offen offset:128 sc1
    s_sub_u32 s60, s60, 1
    s_cbranch_scc1 L_poll_102t
    s_waitcnt vmcnt(0)
    v_max3_u32 v38, v16, v17, v18
    v_max3_u32 v38, v38, v19, v20
    v_max3_u32 v38, v38, v21, v22
    v_max_u32 v38, v38, v23
    v_cmp_eq_u32 vcc, -1, v38
    s_cbranch_vccnz L_poll_102
L_poll_102e:
    v_smfmac_f32_16x16x64_bf16 v[112:115], v[16:19], v[72:79], v111
    v_smfmac_f32_16x16x64_bf16 v[116:119], v[16:19], v[80:87], v111
    v_smfmac_f32_16x16x64_bf16 v[112:115], v[20:23], v[88:95], v111
    v_smfmac_f32_16x16x64_bf16 v[116:119], v[20:23], v[96:103], v111
    s_nop 6
    v_pk_add_f32 v[112:113], v[112:113], v[114:115]
    v_pk_add_f32 v[116:117], v[116:117], v[118:119]
    v_add_f32 v12, v112, v113
    v_add_f32 v13, v116, v117
    ds_write2_b32 v106, v12, v13 offset0:0 offset1:32
    s_mov_b64 exec, 1
    ds_add_rtn_u32 v37, v109, v11
    s_mov_b64 exec, -1
    ds_read_b64 v[72:73], v107 offset:0
    ds_read_b64 v[74:75], v107 offset:16384
    ds_read_b64 v[76:77], v107 offset:32768
    ds_read_b64 v[78:79], v107 offset:49152
    s_cmp_eq_u32 s34, 2
    s_cselect_b32 s97, s61, 0
    s_waitcnt lgkmcnt(4)
    v_readfirstlane_b32 s96, v37
    s_waitcnt lgkmcnt(2)
    v_pk_add_f32 v[72:73], v[72:73], v[74:75]
    s_cmp_lg_u32 s96, 3
    s_cbranch_scc1 L_not1
    s_cmp_eq_u32 s97, 1
    s_waitcnt lgkmcnt(0)
    v_pk_add_f32 v[76:77], v[76:77], v[78:79]
    v_pk_add_f32 v[72:73], v[72:73], v[76:77]
    v_cvt_pk_bf16_f32 v12, v72, v73
    s_cbranch_scc1 L_pfast
    buffer_store_dword v12, v108, s[40:43], s101 offen sc1
    buffer_store_dword v12, v110, s[40:43], s101 offen sc1
L_pdone:
L_not1:
    s_waitcnt lgkmcnt(0)
    s_cmp_eq_u32 s39, 1
    s_cbranch_scc1 L_s_role
    s_cmp_eq_u32 s34, 2
    s_cselect_b32 s62, s59, 0
    s_cmp_eq_u32 s62, 1
    s_cbranch_scc1 L_refetch
L_norf:
    s_endpgm
L_k_nopf:
    s_waitcnt vmcnt(3)
    s_bitcmp0_b32 s57, 22
    s_cbranch_scc1 L_sf_58
    s_waitcnt vmcnt(2)
    s_bitcmp0_b32 s58, 22
    s_cbranch_scc1 L_sf_58
    s_waitcnt vmcnt(1)
L_sf_58:
    buffer_load_dwordx4 v[128:131], v1, s[48:51], s97 offen offset:2048 nt
    v_min_u32 v39, 15, v0
    v_and_b32 v38, 1, v39
    v_mul_u32_u24 v38, 126, v38
    v_lshl_add_u32 v39, v39, 1, v38
    buffer_load_dword v37, v39, s[44:47], 0 offen sc1
    s_waitcnt vmcnt(4)
    s_bitcmp0_b32 s57, 23
    s_cbranch_scc1 L_sf_59
    s_waitcnt vmcnt(3)
    s_bitcmp0_b32 s58, 23
    s_cbranch_scc1 L_sf_59
    s_waitcnt vmcnt(2)
L_sf_59:
    buffer_load_dwordx4 v[132:135], v1, s[48:51], s97 offen offset:3072 nt
    s_add_u32 s97, s97, 32768
    v_add_u32 v1, 4096, v1
    v_and_b32 v1, 0x7fff, v1
    s_waitcnt vmcnt(4)
    s_bitcmp0_b32 s57, 24
    s_cbranch_scc1 L_sf_60
    s_waitcnt vmcnt(3)
    s_bitcmp0_b32 s58, 24
    s_cbranch_scc1 L_sf_60
    s_waitcnt vmcnt(2)
L_sf_60:
    buffer_load_dwordx4 v[136:139], v1, s[48:51], s97 offen offset:0 nt
    s_waitcnt vmcnt(4)
    s_bitcmp0_b32 s57, 25
    s_cbranch_scc1 L_sf_61
    s_waitcnt vmcnt(3)
    s_bitcmp0_b32 s58, 25
    s_cbranch_scc1 L_sf_61
    s_waitcnt vmcnt(1)
L_sf_61:
    buffer_load_dwordx4 v[140:143], v1, s[48:51], s97 offen offset:1024 nt
    s_waitcnt vmcnt(4)
    s_bitcmp0_b32 s57, 26
    s_cbranch_scc1 L_sf_62
    s_waitcnt vmcnt(2)
    s_bitcmp0_b32 s58, 26
    s_cbranch_scc1 L_sf_62
    s_waitcnt vmcnt(1)
L_sf_62:
    buffer_load_dwordx4 v[144:147], v1, s[48:51], s97 offen offset:2048 nt
    s_waitcnt vmcnt(3)
    s_bitcmp0_b32 s57, 27
    s_cbranch_scc1 L_sf_63
    s_waitcnt vmcnt(2)
    s_bitcmp0_b32 s58, 27
    s_cbranch_scc1 L_sf_63
    s_waitcnt vmcnt(1)
L_sf_63:
    buffer_load_dwordx4 v[148:151], v1, s[48:51], s97 offen offset:3072 nt
    s_add_u32 s97, s97, 32768
    v_add_u32 v1, 4096, v1
    v_and_b32 v1, 0x7fff, v1
    v_cmp_eq_u32 vcc, 0, v37
    s_nop 0
    s_or_b32 s96, vcc_lo, vcc_hi
    buffer_load_dwordx4 v[4:7], v2, s[40:43], s98 offen sc1
    s_waitcnt vmcnt(4)
    s_bitcmp0_b32 s57, 28
    s_cbranch_scc1 L_sf_64
    s_waitcnt vmcnt(3)
    s_bitcmp0_b32 s58, 28
    s_cbranch_scc1 L_sf_64
    s_waitcnt vmcnt(2)
L_sf_64:
    buffer_load_dwordx4 v[152:155], v1, s[48:51], s97 offen offset:0 nt
    s_waitcnt vmcnt(4)
    s_bitcmp0_b32 s57, 29
    s_cbranch_scc1 L_sf_65
    s_waitcnt vmcnt(3)
    s_bitcmp0_b32 s58, 29
    s_cbranch_scc1 L_sf_65
    s_waitcnt vmcnt(2)
L_sf_65:
    buffer_load_dwordx4 v[156:159], v1, s[48:51], s97 offen offset:1024 nt
    s_waitcnt vmcnt(4)
    s_bitcmp0_b32 s57, 30
    s_cbranch_scc1 L_sf_66
    s_waitcnt vmcnt(3)
    s_bitcmp0_b32 s58, 30
    s_cbranch_scc1 L_sf_66
    s_waitcnt vmcnt(1)
L_sf_66:
    buffer_load_dwordx4 v[160:163], v1, s[48:51], s97 offen offset:2048 nt
    s_waitcnt vmcnt(4)
    s_bitcmp0_b32 s57, 31
    s_cbranch_scc1 L_sf_67
    s_waitcnt vmcnt(2)
    s_bitcmp0_b32 s58, 31
    s_cbranch_scc1 L_sf_67
    s_waitcnt vmcnt(1)
L_sf_67:
    buffer_load_dwordx4 v[164:167], v1, s[48:51], s97 offen offset:3072 nt
    s_mov_b32 s97, 0
    v_add_u32 v1, 4096, v1
    v_and_b32 v1, 0x7fff, v1
    v_add_u32 v1, 8192, v1
    v_and_b32 v1, 0x7fff, v1
    s_mov_b32 s97, 65536
    s_branch L_k_join
L_v_nopf:
    v_and_b32_dpp v24, v19, v20 row_newbcast:0 row_mask:0xf bank_mask:0xf
    v_and_b32_dpp v25, v19, v21 row_newbcast:0 row_mask:0xf bank_mask:0xf
    v_and_b32_dpp v26, v19, v22 row_newbcast:0 row_mask:0xf bank_mask:0xf
    v_and_b32_dpp v27, v19, v23 row_newbcast:0 row_mask:0xf bank_mask:0xf
    s_waitcnt vmcnt(3)
    s_bitcmp0_b32 s14, 0
    s_cbranch_scc1 L_sf_94
    s_waitcnt vmcnt(2)
    s_bitcmp0_b32 s15, 0
    s_cbranch_scc1 L_sf_94
    s_waitcnt vmcnt(1)
L_sf_94:
    buffer_load_dwordx4 v[40:43], v1, s[52:55], s97 offen offset:0 nt
    v_mfma_f32_16x16x32_bf16 v[32:35], v[24:27], v[152:155], v[32:35]
    v_and_b32_dpp v28, v19, v20 row_newbcast:8 row_mask:0xf bank_mask:0xf
    v_and_b32_dpp v29, v19, v21 row_newbcast:8 row_mask:0xf bank_mask:0xf
    v_and_b32_dpp v30, v19, v22 row_newbcast:8 row_mask:0xf bank_mask:0xf
    v_and_b32_dpp v31, v19, v23 row_newbcast:8 row_mask:0xf bank_mask:0xf
    s_waitcnt vmcnt(3)
    s_bitcmp0_b32 s14, 1
    s_cbranch_scc1 L_sf_95
    s_waitcnt vmcnt(2)
    s_bitcmp0_b32 s15, 1
    s_cbranch_scc1 L_sf_95
    s_waitcnt vmcnt(1)
L_sf_95:
    buffer_load_dwordx4 v[44:47], v1, s[52:55], s97 offen offset:1024 nt
    v_mfma_f32_16x16x32_bf16 v[32:35], v[28:31], v[156:159], v[32:35]
    v_and_b32_dpp v24, v19, v20 row_newbcast:4 row_mask:0xf bank_mask:0xf
    v_and_b32_dpp v25, v19, v21 row_newbcast:4 row_mask:0xf bank_mask:0xf
    v_and_b32_dpp v26, v19, v22 row_newbcast:4 row_mask:0xf bank_mask:0xf
    v_and_b32_dpp v27, v19, v23 row_newbcast:4 row_mask:0xf bank_mask:0xf
    s_waitcnt vmcnt(3)
    s_bitcmp0_b32 s14, 2
    s_cbranch_scc1 L_sf_96
    s_waitcnt vmcnt(2)
    s_bitcmp0_b32 s15, 2
    s_cbranch_scc1 L_sf_96
    s_waitcnt vmcnt(1)
L_sf_96:
    buffer_load_dwordx4 v[48:51], v1, s[52:55], s97 offen offset:2048 nt
    v_mfma_f32_16x16x32_bf16 v[32:35], v[24:27], v[160:163], v[32:35]
    v_and_b32_dpp v28, v19, v20 row_newbcast:12 row_mask:0xf bank_mask:0xf
    v_and_b32_dpp v29, v19, v21 row_newbcast:12 row_mask:0xf bank_mask:0xf
    v_and_b32_dpp v30, v19, v22 row_newbcast:12 row_mask:0xf bank_mask:0xf
    v_and_b32_dpp v31, v19, v23 row_newbcast:12 row_mask:0xf bank_mask:0xf
    s_waitcnt vmcnt(3)
    s_bitcmp0_b32 s14, 3
    s_cbranch_scc1 L_sf_97
    s_waitcnt vmcnt(2)
    s_bitcmp0_b32 s15, 3
    s_cbranch_scc1 L_sf_97
    s_waitcnt vmcnt(1)
L_sf_97:
    buffer_load_dwordx4 v[52:55], v1, s[52:55], s97 offen offset:3072 nt
    s_add_u32 s97, s97, 32768
    v_add_u32 v1, 4096, v1
    v_and_b32 v1, 0x7fff, v1
    v_mfma_f32_16x16x32_bf16 v[32:35], v[28:31], v[164:167], v[32:35]
    v_and_b32_dpp v24, v12, v20 row_newbcast:0 row_mask:0xf bank_mask:0xf
    v_and_b32_dpp v25, v12, v21 row_newbcast:0 row_mask:0xf bank_mask:0xf
    v_and_b32_dpp v26, v12, v22 row_newbcast:0 row_mask:0xf bank_mask:0xf
    v_and_b32_dpp v27, v12, v23 row_newbcast:0 row_mask:0xf bank_mask:0xf
    s_waitcnt vmcnt(3)
    s_bitcmp0_b32 s14, 4
    s_cbranch_scc1 L_sf_98
    s_waitcnt vmcnt(2)
    s_bitcmp0_b32 s15, 4
    s_cbranch_scc1 L_sf_98
    s_waitcnt vmcnt(1)
L_sf_98:
    buffer_load_dwordx4 v[56:59], v1, s[52:55], s97 offen offset:0 nt
    v_mfma_f32_16x16x32_bf16 v[32:35], v[24:27], v[40:43], v[32:35]
    v_and_b32_dpp v28, v12, v20 row_newbcast:8 row_mask:0xf bank_mask:0xf
    v_and_b32_dpp v29, v12, v21 row_newbcast:8 row_mask:0xf bank_mask:0xf
    v_and_b32_dpp v30, v12, v22 row_newbcast:8 row_mask:0xf bank_mask:0xf
    v_and_b32_dpp v31, v12, v23 row_newbcast:8 row_mask:0xf bank_mask:0xf
    s_waitcnt vmcnt(3)
    s_bitcmp0_b32 s14, 5
    s_cbranch_scc1 L_sf_99
    s_waitcnt vmcnt(2)
    s_bitcmp0_b32 s15, 5
    s_cbranch_scc1 L_sf_99
    s_waitcnt vmcnt(1)
L_sf_99:
    buffer_load_dwordx4 v[60:63], v1, s[52:55], s97 offen offset:1024 nt
    v_mfma_f32_16x16x32_bf16 v[32:35], v[28:31], v[44:47], v[32:35]
    v_and_b32_dpp v24, v12, v20 row_newbcast:4 row_mask:0xf bank_mask:0xf
    v_and_b32_dpp v25, v12, v21 row_newbcast:4 row_mask:0xf bank_mask:0xf
    v_and_b32_dpp v26, v12, v22 row_newbcast:4 row_mask:0xf bank_mask:0xf
    v_and_b32_dpp v27, v12, v23 row_newbcast:4 row_mask:0xf bank_mask:0xf
    s_waitcnt vmcnt(3)
    s_bitcmp0_b32 s14, 6
    s_cbranch_scc1 L_sf_100
    s_waitcnt vmcnt(2)
    s_bitcmp0_b32 s15, 6
    s_cbranch_scc1 L_sf_100
    s_waitcnt vmcnt(1)
L_sf_100:
    buffer_load_dwordx4 v[64:67], v1, s[52:55], s97 offen offset:2048 nt
    v_mfma_f32_16x16x32_bf16 v[32:35], v[24:27], v[48:51], v[32:35]
    v_and_b32_dpp v28, v12, v20 row_newbcast:12 row_mask:0xf bank_mask:0xf
    v_and_b32_dpp v29, v12, v21 row_newbcast:12 row_mask:0xf bank_mask:0xf
    v_and_b32_dpp v30, v12, v22 row_newbcast:12 row_mask:0xf bank_mask:0xf
    v_and_b32_dpp v31, v12, v23 row_newbcast:12 row_mask:0xf bank_mask:0xf
    s_waitcnt vmcnt(3)
    s_bitcmp0_b32 s14, 7
    s_cbranch_scc1 L_sf_101
    s_waitcnt vmcnt(2)
    s_bitcmp0_b32 s15, 7
    s_cbranch_scc1 L_sf_101
    s_waitcnt vmcnt(1)
L_sf_101:
    buffer_load_dwordx4 v[68:71], v1, s[52:55], s97 offen offset:3072 nt
    s_add_u32 s97, s97, 32768
    v_add_u32 v1, 4096, v1
    v_and_b32 v1, 0x7fff, v1
    v_mfma_f32_16x16x32_bf16 v[32:35], v[28:31], v[52:55], v[32:35]
    v_and_b32_dpp v24, v13, v20 row_newbcast:0 row_mask:0xf bank_mask:0xf
    v_and_b32_dpp v25, v13, v21 row_newbcast:0 row_mask:0xf bank_mask:0xf
    v_and_b32_dpp v26, v13, v22 row_newbcast:0 row_mask:0xf bank_mask:0xf
    v_and_b32_dpp v27, v13, v23 row_newbcast:0 row_mask:0xf bank_mask:0xf
    s_waitcnt vmcnt(3)
    s_nop 0
    v_mfma_f32_16x16x32_bf16 v[32:35], v[24:27], v[56:59], v[32:35]
    v_and_b32_dpp v28, v13, v20 row_newbcast:8 row_mask:0xf bank_mask:0xf
    v_and_b32_dpp v29, v13, v21 row_newbcast:8 row_mask:0xf bank_mask:0xf
    v_and_b32_dpp v30, v13, v22 row_newbcast:8 row_mask:0xf bank_mask:0xf
    v_and_b32_dpp v31, v13, v23 row_newbcast:8 row_mask:0xf bank_mask:0xf
    s_waitcnt vmcnt(2)
    s_nop 0
    v_mfma_f32_16x16x32_bf16 v[32:35], v[28:31], v[60:63], v[32:35]
    v_and_b32_dpp v24, v13, v20 row_newbcast:4 row_mask:0xf bank_mask:0xf
    v_and_b32_dpp v25, v13, v21 row_newbcast:4 row_mask:0xf bank_mask:0xf
    v_and_b32_dpp v26, v13, v22 row_newbcast:4 row_mask:0xf bank_mask:0xf
    v_and_b32_dpp v27, v13, v23 row_newbcast:4 row_mask:0xf bank_mask:0xf
    s_waitcnt vmcnt(1)
    s_nop 0
    v_mfma_f32_16x16x32_bf16 v[32:35], v[24:27], v[64:67], v[32:35]
    v_and_b32_dpp v28, v13, v20 row_newbcast:12 row_mask:0xf bank_mask:0xf
    v_and_b32_dpp v29, v13, v21 row_newbcast:12 row_mask:0xf bank_mask:0xf
    v_and_b32_dpp v30, v13, v22 row_newbcast:12 row_mask:0xf bank_mask:0xf
    v_and_b32_dpp v31, v13, v23 row_newbcast:12 row_mask:0xf bank_mask:0xf
    s_waitcnt vmcnt(0)
    s_nop 0
    v_mfma_f32_16x16x32_bf16 v[32:35], v[28:31], v[68:71], v[32:35]
    s_branch L_v_join
L_oslow:
    buffer_store_dword v32, v39, s[40:43], s98 offen sc1
    s_branch L_odone
L_refetch:
    s_lshr_b32 s62, s3, 2
    s_mul_i32 s62, s62, 5
    s_add_u32 s62, s62, s35
    s_sub_u32 s62, s62, 27
    s_cmp_ge_u32 s62, 7
    s_cbranch_scc1 L_norf
    s_add_u32 s62, s62, 3
    s_and_b32 s62, s62, 7
    s_mul_i32 s62, s62, 5120
    v_mov_b32 v8, 162048
L_lw_103:
    ds_read_b32 v9, v8
    s_waitcnt lgkmcnt(0)
    v_cmp_gt_u32 vcc, 9, v9
    s_cbranch_vccz L_lw_103e
    s_sleep 2
    s_sub_u32 s60, s60, 1
    s_cbranch_scc0 L_lw_103
    s_mov_b32 s60, 0
L_lw_103e:
    ds_read_b32 v9, v8 offset:36
    v_lshlrev_b32 v5, 4, v0
    v_add_u32 v5, 212992, v5
    s_add_u32 s4, s62, 0
    s_and_b32 s63, s4, 0xffffe000
    s_add_u32 s4, s4, s63
    s_add_u32 s5, s62, 1024
    s_and_b32 s63, s5, 0xffffe000
    s_add_u32 s5, s5, s63
    s_add_u32 s6, s62, 2048
    s_and_b32 s63, s6, 0xffffe000
    s_add_u32 s6, s6, s63
    s_add_u32 s7, s62, 3072
    s_and_b32 s63, s7, 0xffffe000
    s_add_u32 s7, s7, s63
    s_add_u32 s8, s62, 4096
    s_and_b32 s63, s8, 0xffffe000
    s_add_u32 s8, s8, s63
    s_waitcnt lgkmcnt(0)
    v_add_u32 v5, v5, v9
L_poll_104:
    buffer_load_dwordx4 v[12:15], v5, s[40:43], s4 offen sc1
    buffer_load_dwordx4 v[16:19], v5, s[40:43], s5 offen sc1
    buffer_load_dwordx4 v[20:23], v5, s[40:43], s6 offen sc1
    buffer_load_dwordx4 v[24:27], v5, s[40:43], s7 offen sc1
    buffer_load_dwordx4 v[28:31], v5, s[40:43], s8 offen sc1
    s_sub_u32 s60, s60, 1
    s_cbranch_scc1 L_poll_104t
    s_waitcnt vmcnt(0)
    v_max3_u32 v3, v12, v16, v20
    v_max3_u32 v3, v3, v24, v28
    v_cmp_eq_u32 vcc, -1, v3
    s_cbranch_vccnz L_poll_104
L_poll_104e:
    s_branch L_norf
L_qslow:
L_wy_105:
    buffer_load_dword v37, v39, s[44:47], 0 offen sc1
    s_waitcnt vmcnt(0)
    v_cmp_ne_u32 vcc, -1, v37
    s_cbranch_vccz L_wy_105e
    s_sleep 4
    s_sub_u32 s60, s60, 1
    s_cbranch_scc0 L_wy_105
    s_mov_b32 s60, 0
L_wy_105e:
L_qslow2:
    s_branch L_poll_106
L_poll_106s:
    s_sleep 2
L_poll_106:
    buffer_load_dwordx4 v[4:7], v2, s[40:43], s98 offen sc1
    s_sub_u32 s60, s60, 1
    s_cbranch_scc1 L_poll_106t
    s_waitcnt vmcnt(0)
    v_max3_u32 v38, v4, v5, v6
    v_max_u32 v38, v38, v7
    v_cmp_eq_u32 vcc, -1, v38
    s_cbranch_vccnz L_poll_106s
L_poll_106e:
    s_branch L_qok
L_mljob:
    s_lshl4_add_u32 s96, s35, s3
    s_lshl_b32 s96, s96, 3
    s_add_u32 s96, s96, 81920
    buffer_store_dwordx2 v[8:9], v36, s[40:43], s96 offen sc1
    s_branch L_mldone
L_service:
    v_mov_b32 v72, 0
    v_mov_b32 v73, 0
    v_mov_b32 v74, 0
    v_mov_b32 v75, 0
    v_mov_b32 v76, 0
    s_mov_b32 s59, 0
    v_mov_b32 v5, 0
    v_mov_b32 v105, 0
    v_mov_b32 v108, 0
    v_mov_b32 v110, 0
    v_mov_b32 v160, 0
    v_mov_b32 v163, 0
    v_mov_b32 v8, 162068
L_lw_107:
    ds_read_b32 v9, v8
    s_waitcnt lgkmcnt(0)
    v_cmp_gt_u32 vcc, 8, v9
    s_cbranch_vccz L_lw_107e
    s_sleep 8
    s_sub_u32 s60, s60, 1
    s_cbranch_scc0 L_lw_107
    s_mov_b32 s60, 0
L_lw_107e:
    v_and_b32 v2, 15, v0
    v_lshlrev_b32 v2, 3, v2
    v_add_u32 v3, 161920, v2
    ds_read_b64 v[8:9], v3
    v_mov_b32 v11, 162096
    ds_read_b32 v11, v11
    s_getreg_b32 s58, hwreg(HW_REG_XCC_ID, 0, 4)
    s_lshl_b32 s98, s34, 5
    s_add_u32 s98, s98, s35
    s_lshl_b32 s62, s98, 7
    s_add_u32 s62, s62, 73728
    s_and_b32 s99, s62, 0xffffff00
    s_lshl_b32 s98, s98, 8
    s_add_u32 s98, s98, 106496
    v_lshlrev_b32 v39, 2, v0
    v_and_b32 v21, 64, v2
    v_add_u32 v21, v21, v2
    v_cmp_eq_u32 vcc, 8, v0
    s_bfm_b64 exec, 8, 0
    s_bitset1_b32 exec_lo, 8
    s_waitcnt lgkmcnt(0)
    v_lshl_add_u32 v10, v11, 8, s58
    v_cndmask_b32 v8, v8, v10, vcc
    buffer_store_dwordx2 v[8:9], v2, s[40:43], s62 offen sc1
    s_mov_b64 exec, -1
    v_mov_b32 v12, 162076
L_lw_108:
    ds_read_b32 v13, v12
    s_waitcnt lgkmcnt(0)
    v_cmp_gt_u32 vcc, 4, v13
    s_cbranch_vccz L_lw_108e
    s_sleep 4
    s_sub_u32 s60, s60, 1
    s_cbranch_scc0 L_lw_108
    s_mov_b32 s60, 0
L_lw_108e:
    v_and_b32 v11, 31, v0
    v_lshlrev_b32 v11, 7, v11
    s_lshl_b32 s63, s34, 12
    s_add_u32 s63, s63, 73792
    buffer_load_dword v12, v39, s[40:43], s98 offen sc1
    s_branch L_poll_109
L_poll_109s:
    s_sleep 16
L_poll_109:
    buffer_load_dwordx2 v[8:9], v21, s[40:43], s99 offen sc1
    buffer_load_dword v10, v11, s[40:43], s63 offen sc1
    s_sub_u32 s60, s60, 1
    s_cbranch_scc1 L_poll_109t
    s_waitcnt vmcnt(0)
    v_max3_u32 v38, v8, v9, v10
    v_cmp_eq_u32 vcc, -1, v38
    s_cbranch_vccnz L_poll_109s
L_poll_109e:
    v_mov_b32 v37, v8
    s_nop 1
    v_max_f32_dpp v37, v37, v37 quad_perm:[1,0,3,2] row_mask:0xf bank_mask:0xf
    s_nop 1
    v_max_f32_dpp v37, v37, v37 quad_perm:[2,3,0,1] row_mask:0xf bank_mask:0xf
    s_nop 1
    v_max_f32_dpp v37, v37, v37 row_ror:4 row_mask:0xf bank_mask:0xf
    s_nop 1
    v_max_f32_dpp v37, v37, v37 row_ror:8 row_mask:0xf bank_mask:0xf
    v_sub_f32 v8, v8, v37
    v_exp_f32 v8, v8
    s_nop 0
    v_mul_f32 v9, v8, v9
    s_nop 1
    v_add_f32_dpp v9, v9, v9 quad_perm:[1,0,3,2] row_mask:0xf bank_mask:0xf
    s_nop 1
    v_add_f32_dpp v9, v9, v9 quad_perm:[2,3,0,1] row_mask:0xf bank_mask:0xf
    s_nop 1
    v_add_f32_dpp v9, v9, v9 row_ror:4 row_mask:0xf bank_mask:0xf
    s_nop 1
    v_add_f32_dpp v9, v9, v9 row_ror:8 row_mask:0xf bank_mask:0xf
    v_ashrrev_i32 v12, 8, v10
    s_nop 1
    v_add_u32_dpp v12, v12, v12 quad_perm:[1,0,3,2] row_mask:0xf bank_mask:0xf
    s_nop 1
    v_add_u32_dpp v12, v12, v12 quad_perm:[2,3,0,1] row_mask:0xf bank_mask:0xf
    s_nop 1
    v_add_u32_dpp v12, v12, v12 row_ror:4 row_mask:0xf bank_mask:0xf
    s_nop 1
    v_add_u32_dpp v12, v12, v12 row_ror:8 row_mask:0xf bank_mask:0xf
    v_mov_b32 v13, v12
    s_nop 1
    v_permlane16_swap_b32 v12, v13
    v_add_u32 v12, v12, v13
    v_mov_b32 v13, v12
    s_nop 1
    v_permlane32_swap_b32 v12, v13
    v_add_u32 v12, v12, v13
    v_ashrrev_i32 v12, 31, v12
    v_and_b32 v12, 8192, v12
    v_mov_b32 v13, 162084
    ds_write_b32 v13, v12
    v_and_b32 v10, 0xff, v10
    s_getreg_b32 s62, hwreg(HW_REG_XCC_ID, 0, 4)
    v_cmp_ne_u32 vcc, s62, v10
    s_nop 0
    s_cmp_eq_u64 vcc, 0
    s_cselect_b32 s61, 1, 0
    v_rcp_f32 v9, v9
    v_lshrrev_b32 v3, 1, v2
    v_add_u32 v3, 161984, v3
    v_mul_f32 v8, v8, v9
    v_mov_b32 v10, 162072
    v_mov_b32 v11, s61
    ds_write_b32 v3, v8
    ds_write_b32 v10, v11
    s_mov_b32 s3, 1
    v_lshrrev_b32 v9, 4, v0
    v_lshl_add_u32 v8, v9, 2, v2
    s_lshl_b32 s96, s3, 9
    s_add_u32 s96, s96, 157824
    v_lshl_add_u32 v8, v8, 2, s96
    v_lshlrev_b32 v9, 3, v0
    v_add_u32 v9, 157824, v9
    v_mov_b32 v10, 162048
    v_mov_b32 v11, 1
    s_lshl_b32 s96, s38, 5
    s_add_u32 s96, s96, 161984
    v_mov_b32 v3, s96
    s_sub_u32 s62, 8, s39
    s_lshl_b32 s98, s34, 5
    s_add_u32 s98, s98, s35
    s_lshl_b32 s98, s98, 8
    s_add_u32 s98, s98, 106496
    v_lshlrev_b32 v39, 2, v0
    s_branch L_t0b
L_jobend:
    v_lshlrev_b32 v9, 4, v0
    s_mov_b32 exec_hi, 0
    s_nop 3
    buffer_store_dwordx4 v[32:35], v9, s[40:43], s13 offen sc1
    s_endpgm
L_proxy:
    v_mov_b32 v72, 0
    v_mov_b32 v73, 0
    v_mov_b32 v74, 0
    v_mov_b32 v75, 0
    v_mov_b32 v76, 0
    v_mov_b32 v5, 0
    v_mov_b32 v105, 0
    v_mov_b32 v108, 0
    v_mov_b32 v110, 0
    v_mov_b32 v160, 0
    v_mov_b32 v163, 0
    s_barrier
    s_waitcnt lgkmcnt(0)
    s_mov_b32 s40, s32
    s_mov_b32 s41, s33
    s_mov_b32 s42, 589824
    s_mov_b32 s43, 0x20000
    s_mov_b32 s44, s30
    s_mov_b32 s45, s31
    s_mov_b32 s46, 256
    s_mov_b32 s47, 0x20000
    s_sub_u32 s97, 7, s3
    s_mul_i32 s97, s97, 27
    s_cmp_eq_u32 s3, 5
    s_cselect_b32 s97, 32, s97
    s_add_u32 s97, s97, s35
    s_lshl_b32 s97, s97, 9
    s_add_u32 s97, s97, 172032
    v_and_b32 v2, 15, v0
    v_lshlrev_b32 v2, 3, v2
    v_and_b32 v20, 31, v0
    v_lshlrev_b32 v20, 4, v20
    s_cmp_lg_u32 s3, 7
    s_cbranch_scc1 L_px6
    s_sub_u32 s96, 6, s59
    s_mul_i32 s62, s35, 5120
    s_add_u32 s62, s62, 327680
    v_lshl_add_u32 v22, v0, 4, s62
    v_add_u32 v23, 4096, v22
    v_mov_b32 v24, -1
    v_mov_b32 v25, -1
    v_mov_b32 v26, -1
    v_mov_b32 v27, -1
    v_mov_b32 v8, 162068
L_lw_110:
    ds_read_b32 v9, v8
    s_waitcnt lgkmcnt(0)
    v_cmp_gt_u32 vcc, s96, v9
    s_cbranch_vccz L_lw_110e
    s_sleep 8
    s_sub_u32 s60, s60, 1
    s_cbranch_scc0 L_lw_110
    s_mov_b32 s60, 0
L_lw_110e:
    v_and_b32 v2, 15, v0
    v_lshlrev_b32 v2, 3, v2
    v_add_u32 v3, 161920, v2
    ds_read_b64 v[8:9], v3
    v_mov_b32 v11, 162096
    ds_read_b32 v11, v11
    s_getreg_b32 s58, hwreg(HW_REG_XCC_ID, 0, 4)
    s_lshl_b32 s98, s34, 5
    s_add_u32 s98, s98, s35
    s_lshl_b32 s62, s98, 7
    s_add_u32 s62, s62, 73728
    s_and_b32 s99, s62, 0xffffff00
    s_lshl_b32 s98, s98, 8
    s_add_u32 s98, s98, 106496
    v_lshlrev_b32 v39, 2, v0
    v_and_b32 v21, 64, v2
    v_add_u32 v21, v21, v2
    v_cmp_eq_u32 vcc, 8, v0
    s_bfm_b64 exec, s96, 0
    s_bitset1_b32 exec_lo, 8
    s_waitcnt lgkmcnt(0)
    v_lshl_add_u32 v10, v11, 8, s58
    v_cndmask_b32 v8, v8, v10, vcc
    buffer_store_dwordx2 v[8:9], v2, s[40:43], s62 offen sc1
    s_mov_b64 exec, -1
    buffer_load_dwordx4 v[120:123], v22, s[40:43], 0 offen offset:0 sc1
    buffer_load_dwordx4 v[124:127], v22, s[40:43], 0 offen offset:1024 sc1
    buffer_load_dwordx4 v[128:131], v22, s[40:43], 0 offen offset:2048 sc1
    buffer_load_dwordx4 v[132:135], v22, s[40:43], 0 offen offset:3072 sc1
    buffer_load_dwordx4 v[136:139], v23, s[40:43], 0 offen offset:0 sc1
    s_mov_b32 s100, 4
    s_lshl_b32 s63, s100, 8
    v_and_b32 v8, 15, v0
    v_lshl_add_u32 v8, v8, 4, s63
    v_lshrrev_b32 v9, 4, v0
    v_mul_u32_u24 v5, 1280, v9
    v_add_u32 v5, v5, v8
    v_mul_u32_u24 v4, 1296, v9
    v_add_u32 v4, v4, v8
    v_add_u32 v4, 82944, v4
    v_lshlrev_b32 v6, 1, v5
    v_add_u32 v6, 99328, v6
    s_lshl_b32 s62, s100, 9
    s_add_u32 s62, s62, 88128
    v_lshl_add_u32 v7, v0, 3, s62
    s_mov_b32 s48, s4
    s_mov_b32 s49, s5
    s_mov_b32 s50, 5120
    s_mov_b32 s51, 0x20000
    buffer_load_dwordx4 v[8:11], v5, s[48:51], 0 offen
    s_mov_b32 s62, 20480
    s_mov_b32 s63, 30720
    s_branch L_poll_111
L_poll_111s:
    s_sleep 32
L_poll_111:
    buffer_load_dwordx4 v[12:15], v5, s[40:43], s62 offen sc1
    buffer_load_dwordx4 v[16:19], v5, s[40:43], s63 offen sc1
    s_sub_u32 s60, s60, 1
    s_cbranch_scc1 L_poll_111t
    s_waitcnt vmcnt(0)
    v_max3_u32 v38, v12, v13, v14
    v_max3_u32 v38, v38, v15, v16
    v_max3_u32 v38, v38, v17, v18
    v_max_u32 v38, v38, v19
    v_cmp_eq_u32 vcc, -1, v38
    s_cbranch_vccnz L_poll_111s
L_poll_111e:
    v_lshlrev_b32 v40, 16, v8
    v_and_b32 v41, 0xffff0000, v8
    v_lshlrev_b32 v42, 16, v9
    v_and_b32 v43, 0xffff0000, v9
    v_lshlrev_b32 v44, 16, v10
    v_and_b32 v45, 0xffff0000, v10
    v_lshlrev_b32 v46, 16, v11
    v_and_b32 v47, 0xffff0000, v11
    v_lshlrev_b32 v48, 16, v12
    v_and_b32 v49, 0xffff0000, v12
    v_lshlrev_b32 v50, 16, v13
    v_and_b32 v51, 0xffff0000, v13
    v_lshlrev_b32 v52, 16, v14
    v_and_b32 v53, 0xffff0000, v14
    v_lshlrev_b32 v54, 16, v15
    v_and_b32 v55, 0xffff0000, v15
    v_lshlrev_b32 v56, 16, v16
    v_and_b32 v57, 0xffff0000, v16
    v_lshlrev_b32 v58, 16, v17
    v_and_b32 v59, 0xffff0000, v17
    v_lshlrev_b32 v60, 16, v18
    v_and_b32 v61, 0xffff0000, v18
    v_lshlrev_b32 v62, 16, v19
    v_and_b32 v63, 0xffff0000, v19
    v_mov_b32 v64, 0
    v_mov_b32 v65, 0
    v_mov_b32 v66, 0
    v_mov_b32 v67, 0
    v_mov_b32 v68, 0
    v_mov_b32 v69, 0
    v_mov_b32 v70, 0
    v_mov_b32 v71, 0
    v_bfe_u32 v5, v0, 2, 2
    v_lshlrev_b32 v5, 8, v5
    v_lshrrev_b32 v8, 4, v0
    v_lshl_add_u32 v5, v8, 6, v5
    v_and_b32 v8, 3, v0
    v_lshl_add_u32 v5, v8, 4, v5
    s_lshl_b32 s56, s100, 10
    s_or_b32 s96, s59, 0
    s_cbranch_scc0 L_nofrag_112
    v_mov_b32 v104, 162060
L_lw_113:
    ds_read_b32 v105, v104
    s_waitcnt lgkmcnt(0)
    v_cmp_gt_u32 vcc, 4, v105
    s_cbranch_vccz L_lw_113e
    s_sleep 2
    s_sub_u32 s60, s60, 1
    s_cbranch_scc0 L_lw_113
    s_mov_b32 s60, 0
L_lw_113e:
    s_cmp_eq_u32 s59, 0
    s_cbranch_scc1 L_nofrag_112
    v_bfe_u32 v104, v0, 2, 1
    v_bfe_u32 v110, v0, 4, 1
    v_lshl_add_u32 v104, v110, 2, v104
    v_and_b32 v110, 8, v0
    v_add_u32 v104, v104, v110
    v_lshrrev_b32 v110, 5, v0
    v_lshl_add_u32 v104, v110, 4, v104
    v_bfe_u32 v111, v0, 0, 1
    v_mul_u32_u24 v111, 0xaaaa, v111
    v_add_u32 v111, 0x4444, v111
    v_mov_b32 v112, 0
    v_mov_b32 v113, 0
    v_mov_b32 v114, 0
    v_mov_b32 v115, 0
    v_mov_b32 v116, 0
    v_mov_b32 v117, 0
    v_mov_b32 v118, 0
    v_mov_b32 v119, 0
    v_lshlrev_b32 v104, 7, v104
    v_and_b32 v110, 3, v0
    v_lshl_add_u32 v104, v110, 3, v104
    v_lshrrev_b32 v109, 4, v0
    v_and_b32 v110, 1, v0
    s_lshr_b32 s63, s3, 1
    s_and_b32 s62, s3, 1
    s_lshl_b32 s96, s63, 14
    s_lshl_b32 s100, s62, 6
    s_add_u32 s100, s100, 81920
    s_add_u32 s96, s96, s100
    v_add_u32 v104, s96, v104
    ds_read_b64_tr_b16 v[72:73], v104 offset:0
    ds_read_b64_tr_b16 v[74:75], v104 offset:256
    ds_read_b64_tr_b16 v[76:77], v104 offset:4096
    ds_read_b64_tr_b16 v[78:79], v104 offset:4352
    ds_read_b64_tr_b16 v[80:81], v104 offset:32
    ds_read_b64_tr_b16 v[82:83], v104 offset:288
    ds_read_b64_tr_b16 v[84:85], v104 offset:4128
    ds_read_b64_tr_b16 v[86:87], v104 offset:4384
    ds_read_b64_tr_b16 v[88:89], v104 offset:8192
    ds_read_b64_tr_b16 v[90:91], v104 offset:8448
    ds_read_b64_tr_b16 v[92:93], v104 offset:12288
    ds_read_b64_tr_b16 v[94:95], v104 offset:12544
    ds_read_b64_tr_b16 v[96:97], v104 offset:8224
    ds_read_b64_tr_b16 v[98:99], v104 offset:8480
    ds_read_b64_tr_b16 v[100:101], v104 offset:12320
    ds_read_b64_tr_b16 v[102:103], v104 offset:12576
    v_bfe_u32 v105, v0, 1, 3
    v_lshlrev_b32 v105, 8, v105
    v_lshl_add_u32 v105, v109, 5, v105
    v_lshl_add_u32 v105, v110, 4, v105
    v_lshrrev_b32 v106, 3, v0
    v_lshlrev_b32 v106, 7, v106
    v_and_b32 v110, 7, v0
    v_lshl_add_u32 v107, v110, 3, v106
    v_add_u32 v107, s100, v107
    v_lshlrev_b32 v106, 8, v109
    v_and_b32 v110, 15, v0
    v_lshl_add_u32 v106, v110, 2, v106
    v_add_u32 v106, s96, v106
    v_lshlrev_b32 v108, 2, v0
    s_lshl_b32 s96, s62, 2
    s_add_u32 s96, s96, 162088
    v_mov_b32 v109, s96
    s_lshl_b32 s100, s63, 11
    s_lshl_b32 s96, s34, 13
    s_add_u32 s100, s100, s96
    s_add_u32 s100, s100, 106496
    s_mul_i32 s101, s34, 5120
    s_lshl_b32 s96, s35, 9
    s_add_u32 s101, s101, s96
    s_lshl_b32 s96, s62, 8
    s_add_u32 s101, s101, s96
    s_sub_u32 s101, s101, 11264
    s_and_b32 s96, s101, 0xffffe000
    s_add_u32 s101, s101, s96
    s_add_u32 s101, s101, 212992
    v_add_u32 v110, 8192, v108
L_nofrag_112:
    s_cmp_ge_u32 s35, 20
    s_cbranch_scc1 L_nofin_114
    s_lshl1_add_u32 s62, s35, s3
    s_sub_u32 s62, s62, 6
    s_lshl_b32 s57, s62, 7
    s_mul_i32 s63, s62, 0x199a
    s_lshr_b32 s63, s63, 16
    s_mul_i32 s63, s63, 1280
    s_sub_u32 s63, s57, s63
    v_lshrrev_b32 v72, 3, v0
    v_mul_u32_u24 v72, 5120, v72
    v_and_b32 v8, 7, v0
    v_lshl_add_u32 v72, v8, 4, v72
    s_add_u32 s62, s57, 327680
    v_add_u32 v72, s62, v72
    v_add_u32 v73, 40960, v72
    v_add_u32 v74, 81920, v72
    v_add_u32 v75, 122880, v72
    v_bfe_u32 v9, v0, 4, 1
    v_lshlrev_b32 v76, 4, v8
    v_lshl_add_u32 v76, v9, 3, v76
    s_lshl_b32 s62, s57, 1
    s_add_u32 s62, s62, 99328
    v_lshl_add_u32 v77, v76, 1, s62
    s_mov_b32 s48, s22
    s_mov_b32 s49, s23
    s_mov_b32 s50, 1280
    s_mov_b32 s51, 0x20000
    buffer_load_dwordx2 v[86:87], v76, s[48:51], s63 offen
    s_add_u32 s62, s57, 35840
    s_branch L_poll_115
L_poll_115s:
    s_sleep 32
L_poll_115:
    buffer_load_dwordx2 v[8:9], v76, s[40:43], s62 offen sc1
    s_sub_u32 s60, s60, 1
    s_cbranch_scc1 L_poll_115t
    s_waitcnt vmcnt(0)
    v_max_u32 v38, v8, v9
    v_cmp_eq_u32 vcc, -1, v38
    s_cbranch_vccnz L_poll_115s
L_poll_115e:
    v_lshlrev_b32 v78, 16, v86
    v_and_b32 v79, 0xffff0000, v86
    v_lshlrev_b32 v82, 16, v8
    v_and_b32 v83, 0xffff0000, v8
    v_lshlrev_b32 v80, 16, v87
    v_and_b32 v81, 0xffff0000, v87
    v_lshlrev_b32 v84, 16, v9
    v_and_b32 v85, 0xffff0000, v9
    v_bfe_u32 v8, v0, 1, 3
    v_and_b32 v9, 1, v0
    v_lshlrev_b32 v9, 4, v9
    v_mov_b32 v10, 0x3f80
    v_lshlrev_b32 v9, v9, v10
    v_cmp_eq_u32 vcc, 0, v8
    v_mov_b32 v100, 0
    s_nop 0
    v_cndmask_b32 v104, 0, v9, vcc
    v_cmp_eq_u32 vcc, 1, v8
    v_mov_b32 v101, 0
    s_nop 0
    v_cndmask_b32 v105, 0, v9, vcc
    v_cmp_eq_u32 vcc, 2, v8
    v_mov_b32 v102, 0
    s_nop 0
    v_cndmask_b32 v106, 0, v9, vcc
    v_cmp_eq_u32 vcc, 3, v8
    v_mov_b32 v103, 0
    s_nop 0
    v_cndmask_b32 v107, 0, v9, vcc
L_nofin_114:
    v_mov_b32 v12, 162076
L_lw_116:
    ds_read_b32 v13, v12
    s_waitcnt lgkmcnt(0)
    v_cmp_gt_u32 vcc, 4, v13
    s_cbranch_vccz L_lw_116e
    s_sleep 4
    s_sub_u32 s60, s60, 1
    s_cbranch_scc0 L_lw_116
    s_mov_b32 s60, 0
L_lw_116e:
    v_and_b32 v11, 31, v0
    v_lshlrev_b32 v11, 7, v11
    s_lshl_b32 s63, s34, 12
    s_add_u32 s63, s63, 73792
    buffer_load_dword v12, v39, s[40:43], s98 offen sc1
    s_branch L_poll_117
L_poll_117s:
    s_sleep 2
L_poll_117:
    buffer_load_dwordx2 v[8:9], v21, s[40:43], s99 offen sc1
    buffer_load_dword v10, v11, s[40:43], s63 offen sc1
    s_sub_u32 s60, s60, 1
    s_cbranch_scc1 L_poll_117t
    s_waitcnt vmcnt(0)
    v_max3_u32 v38, v8, v9, v10
    v_cmp_eq_u32 vcc, -1, v38
    s_cbranch_vccnz L_poll_117s
L_poll_117e:
    v_mov_b32 v37, v8
    s_nop 1
    v_max_f32_dpp v37, v37, v37 quad_perm:[1,0,3,2] row_mask:0xf bank_mask:0xf
    s_nop 1
    v_max_f32_dpp v37, v37, v37 quad_perm:[2,3,0,1] row_mask:0xf bank_mask:0xf
    s_nop 1
    v_max_f32_dpp v37, v37, v37 row_ror:4 row_mask:0xf bank_mask:0xf
    s_nop 1
    v_max_f32_dpp v37, v37, v37 row_ror:8 row_mask:0xf bank_mask:0xf
    v_sub_f32 v8, v8, v37
    v_exp_f32 v8, v8
    s_nop 0
    v_mul_f32 v9, v8, v9
    s_nop 1
    v_add_f32_dpp v9, v9, v9 quad_perm:[1,0,3,2] row_mask:0xf bank_mask:0xf
    s_nop 1
    v_add_f32_dpp v9, v9, v9 quad_perm:[2,3,0,1] row_mask:0xf bank_mask:0xf
    s_nop 1
    v_add_f32_dpp v9, v9, v9 row_ror:4 row_mask:0xf bank_mask:0xf
    s_nop 1
    v_add_f32_dpp v9, v9, v9 row_ror:8 row_mask:0xf bank_mask:0xf
    v_ashrrev_i32 v12, 8, v10
    s_nop 1
    v_add_u32_dpp v12, v12, v12 quad_perm:[1,0,3,2] row_mask:0xf bank_mask:0xf
    s_nop 1
    v_add_u32_dpp v12, v12, v12 quad_perm:[2,3,0,1] row_mask:0xf bank_mask:0xf
    s_nop 1
    v_add_u32_dpp v12, v12, v12 row_ror:4 row_mask:0xf bank_mask:0xf
    s_nop 1
    v_add_u32_dpp v12, v12, v12 row_ror:8 row_mask:0xf bank_mask:0xf
    v_mov_b32 v13, v12
    s_nop 1
    v_permlane16_swap_b32 v12, v13
    v_add_u32 v12, v12, v13
    v_mov_b32 v13, v12
    s_nop 1
    v_permlane32_swap_b32 v12, v13
    v_add_u32 v12, v12, v13
    v_ashrrev_i32 v12, 31, v12
    v_and_b32 v12, 8192, v12
    v_mov_b32 v13, 162084
    ds_write_b32 v13, v12
    v_and_b32 v10, 0xff, v10
    s_getreg_b32 s62, hwreg(HW_REG_XCC_ID, 0, 4)
    v_cmp_ne_u32 vcc, s62, v10
    s_nop 0
    s_cmp_eq_u64 vcc, 0
    s_cselect_b32 s61, 1, 0
    v_rcp_f32 v9, v9
    v_lshrrev_b32 v3, 1, v2
    v_add_u32 v3, 161984, v3
    v_mul_f32 v8, v8, v9
    v_mov_b32 v10, 162072
    v_mov_b32 v11, s61
    ds_write_b32 v3, v8
    ds_write_b32 v10, v11
    s_cmp_eq_u32 s61, 1
    s_cbranch_scc0 L_ycs
    buffer_store_dwordx4 v[24:27], v22, s[40:43], 0 offen offset:0
    buffer_store_dwordx4 v[24:27], v22, s[40:43], 0 offen offset:1024
    buffer_store_dwordx4 v[24:27], v22, s[40:43], 0 offen offset:2048
    buffer_store_dwordx4 v[24:27], v22, s[40:43], 0 offen offset:3072
    buffer_store_dwordx4 v[24:27], v23, s[40:43], 0 offen offset:0
L_ycd:
    s_branch L_poll_118
L_poll_118s:
    s_sleep 2
L_poll_118:
    buffer_load_dwordx4 v[32:35], v20, s[40:43], s97 offen sc1
    s_sub_u32 s60, s60, 1
    s_cbranch_scc1 L_poll_118t
    s_waitcnt vmcnt(0)
    v_max3_u32 v38, v32, v33, v34
    v_max_u32 v38, v38, v35
    v_cmp_eq_u32 vcc, -1, v38
    s_cbranch_vccnz L_poll_118s
L_poll_118e:
    s_branch L_pxj
L_px6:
    s_or_b32 s96, s59, s39
    s_cbranch_scc0 L_nofrag_119
    v_mov_b32 v104, 162060
L_lw_120:
    ds_read_b32 v105, v104
    s_waitcnt lgkmcnt(0)
    v_cmp_gt_u32 vcc, 4, v105
    s_cbranch_vccz L_lw_120e
    s_sleep 2
    s_sub_u32 s60, s60, 1
    s_cbranch_scc0 L_lw_120
    s_mov_b32 s60, 0
L_lw_120e:
    s_cmp_eq_u32 s59, 0
    s_cbranch_scc1 L_nofrag_119
    v_bfe_u32 v104, v0, 2, 1
    v_bfe_u32 v110, v0, 4, 1
    v_lshl_add_u32 v104, v110, 2, v104
    v_and_b32 v110, 8, v0
    v_add_u32 v104, v104, v110
    v_lshrrev_b32 v110, 5, v0
    v_lshl_add_u32 v104, v110, 4, v104
    v_bfe_u32 v111, v0, 0, 1
    v_mul_u32_u24 v111, 0xaaaa, v111
    v_add_u32 v111, 0x4444, v111
    v_mov_b32 v112, 0
    v_mov_b32 v113, 0
    v_mov_b32 v114, 0
    v_mov_b32 v115, 0
    v_mov_b32 v116, 0
    v_mov_b32 v117, 0
    v_mov_b32 v118, 0
    v_mov_b32 v119, 0
    v_lshlrev_b32 v104, 7, v104
    v_and_b32 v110, 3, v0
    v_lshl_add_u32 v104, v110, 3, v104
    v_lshrrev_b32 v109, 4, v0
    v_and_b32 v110, 1, v0
    s_lshr_b32 s63, s3, 1
    s_and_b32 s62, s3, 1
    s_lshl_b32 s96, s63, 14
    s_lshl_b32 s100, s62, 6
    s_add_u32 s100, s100, 81920
    s_add_u32 s96, s96, s100
    v_add_u32 v104, s96, v104
    ds_read_b64_tr_b16 v[72:73], v104 offset:0
    ds_read_b64_tr_b16 v[74:75], v104 offset:256
    ds_read_b64_tr_b16 v[76:77], v104 offset:4096
    ds_read_b64_tr_b16 v[78:79], v104 offset:4352
    ds_read_b64_tr_b16 v[80:81], v104 offset:32
    ds_read_b64_tr_b16 v[82:83], v104 offset:288
    ds_read_b64_tr_b16 v[84:85], v104 offset:4128
    ds_read_b64_tr_b16 v[86:87], v104 offset:4384
    ds_read_b64_tr_b16 v[88:89], v104 offset:8192
    ds_read_b64_tr_b16 v[90:91], v104 offset:8448
    ds_read_b64_tr_b16 v[92:93], v104 offset:12288
    ds_read_b64_tr_b16 v[94:95], v104 offset:12544
    ds_read_b64_tr_b16 v[96:97], v104 offset:8224
    ds_read_b64_tr_b16 v[98:99], v104 offset:8480
    ds_read_b64_tr_b16 v[100:101], v104 offset:12320
    ds_read_b64_tr_b16 v[102:103], v104 offset:12576
    v_bfe_u32 v105, v0, 1, 3
    v_lshlrev_b32 v105, 8, v105
    v_lshl_add_u32 v105, v109, 5, v105
    v_lshl_add_u32 v105, v110, 4, v105
    v_lshrrev_b32 v106, 3, v0
    v_lshlrev_b32 v106, 7, v106
    v_and_b32 v110, 7, v0
    v_lshl_add_u32 v107, v110, 3, v106
    v_add_u32 v107, s100, v107
    v_lshlrev_b32 v106, 8, v109
    v_and_b32 v110, 15, v0
    v_lshl_add_u32 v106, v110, 2, v106
    v_add_u32 v106, s96, v106
    v_lshlrev_b32 v108, 2, v0
    s_lshl_b32 s96, s62, 2
    s_add_u32 s96, s96, 162088
    v_mov_b32 v109, s96
    s_lshl_b32 s100, s63, 11
    s_lshl_b32 s96, s34, 13
    s_add_u32 s100, s100, s96
    s_add_u32 s100, s100, 106496
    s_mul_i32 s101, s34, 5120
    s_lshl_b32 s96, s35, 9
    s_add_u32 s101, s101, s96
    s_lshl_b32 s96, s62, 8
    s_add_u32 s101, s101, s96
    s_sub_u32 s101, s101, 11264
    s_and_b32 s96, s101, 0xffffe000
    s_add_u32 s101, s101, s96
    s_add_u32 s101, s101, 212992
    v_add_u32 v110, 8192, v108
L_nofrag_119:
    s_mov_b32 s62, 3
    s_lshl1_add_u32 s96, s35, s3
    s_and_b32 s63, s96, 7
    s_lshl_b32 s63, s63, 14
    s_lshl_b32 s96, s96, 7
    s_add_u32 s96, s96, s63
    s_add_u32 s96, s96, 475136
    s_add_u32 s98, s32, s96
    s_addc_u32 s99, s33, 0
    s_load_dword s4, s[98:99], 0 glc
    s_load_dword s5, s[98:99], 8192 glc
    s_mov_b32 s63, 0
    s_waitcnt lgkmcnt(0)
L_np:
    s_not_b32 s4, s4
    s_mov_b32 s6, s4
    s_mov_b32 s7, 0
    s_load_dword s4, s[98:99], 0 glc
L_npc0:
    s_add_u32 s7, s7, 1
    s_cmp_eq_u32 s4, s6
    s_cselect_b32 s8, s7, 1000
    s_cmp_lt_u32 s8, 60
    s_cbranch_scc1 L_npc0
    s_waitcnt lgkmcnt(0)
    s_sub_u32 s63, s63, s7
    s_not_b32 s5, s5
    s_mov_b32 s6, s5
    s_mov_b32 s7, 0
    s_load_dword s5, s[98:99], 8192 glc
L_npc1:
    s_add_u32 s7, s7, 1
    s_cmp_eq_u32 s5, s6
    s_cselect_b32 s8, s7, 1000
    s_cmp_lt_u32 s8, 60
    s_cbranch_scc1 L_npc1
    s_waitcnt lgkmcnt(0)
    s_add_u32 s63, s63, s7
    s_sub_u32 s62, s62, 1
    s_cmp_lg_u32 s62, 0
    s_cbranch_scc1 L_np
    v_mov_b32 v8, 162096
    v_mov_b32 v9, s63
    s_mov_b64 exec, 1
    ds_add_u32 v8, v9
    s_mov_b64 exec, -1
    v_mov_b32 v8, 162068
L_lw_121:
    ds_read_b32 v9, v8
    s_waitcnt lgkmcnt(0)
    v_cmp_gt_u32 vcc, 1, v9
    s_cbranch_vccz L_lw_121e
    s_sleep 32
    s_sub_u32 s60, s60, 1
    s_cbranch_scc0 L_lw_121
    s_mov_b32 s60, 0
L_lw_121e:
    s_cmp_ge_u32 s35, 20
    s_cbranch_scc1 L_nofin_122
    s_lshl1_add_u32 s62, s35, s3
    s_sub_u32 s62, s62, 6
    s_lshl_b32 s57, s62, 7
    s_mul_i32 s63, s62, 0x199a
    s_lshr_b32 s63, s63, 16
    s_mul_i32 s63, s63, 1280
    s_sub_u32 s63, s57, s63
    v_lshrrev_b32 v72, 3, v0
    v_mul_u32_u24 v72, 5120, v72
    v_and_b32 v8, 7, v0
    v_lshl_add_u32 v72, v8, 4, v72
    s_add_u32 s62, s57, 327680
    v_add_u32 v72, s62, v72
    v_add_u32 v73, 40960, v72
    v_add_u32 v74, 81920, v72
    v_add_u32 v75, 122880, v72
    v_bfe_u32 v9, v0, 4, 1
    v_lshlrev_b32 v76, 4, v8
    v_lshl_add_u32 v76, v9, 3, v76
    s_lshl_b32 s62, s57, 1
    s_add_u32 s62, s62, 99328
    v_lshl_add_u32 v77, v76, 1, s62
    s_mov_b32 s48, s22
    s_mov_b32 s49, s23
    s_mov_b32 s50, 1280
    s_mov_b32 s51, 0x20000
    buffer_load_dwordx2 v[86:87], v76, s[48:51], s63 offen
    s_add_u32 s62, s57, 35840
    s_branch L_poll_123
L_poll_123s:
    s_sleep 32
L_poll_123:
    buffer_load_dwordx2 v[8:9], v76, s[40:43], s62 offen sc1
    s_sub_u32 s60, s60, 1
    s_cbranch_scc1 L_poll_123t
    s_waitcnt vmcnt(0)
    v_max_u32 v38, v8, v9
    v_cmp_eq_u32 vcc, -1, v38
    s_cbranch_vccnz L_poll_123s
L_poll_123e:
    v_lshlrev_b32 v78, 16, v86
    v_and_b32 v79, 0xffff0000, v86
    v_lshlrev_b32 v82, 16, v8
    v_and_b32 v83, 0xffff0000, v8
    v_lshlrev_b32 v80, 16, v87
    v_and_b32 v81, 0xffff0000, v87
    v_lshlrev_b32 v84, 16, v9
    v_and_b32 v85, 0xffff0000, v9
    v_bfe_u32 v8, v0, 1, 3
    v_and_b32 v9, 1, v0
    v_lshlrev_b32 v9, 4, v9
    v_mov_b32 v10, 0x3f80
    v_lshlrev_b32 v9, v9, v10
    v_cmp_eq_u32 vcc, 0, v8
    v_mov_b32 v100, 0
    s_nop 0
    v_cndmask_b32 v104, 0, v9, vcc
    v_cmp_eq_u32 vcc, 1, v8
    v_mov_b32 v101, 0
    s_nop 0
    v_cndmask_b32 v105, 0, v9, vcc
    v_cmp_eq_u32 vcc, 2, v8
    v_mov_b32 v102, 0
    s_nop 0
    v_cndmask_b32 v106, 0, v9, vcc
    v_cmp_eq_u32 vcc, 3, v8
    v_mov_b32 v103, 0
    s_nop 0
    v_cndmask_b32 v107, 0, v9, vcc
L_nofin_122:
    v_mov_b32 v8, 162076
L_lw_124:
    ds_read_b32 v9, v8
    s_waitcnt lgkmcnt(0)
    v_cmp_gt_u32 vcc, 4, v9
    s_cbranch_vccz L_lw_124e
    s_sleep 16
    s_sub_u32 s60, s60, 1
    s_cbranch_scc0 L_lw_124
    s_mov_b32 s60, 0
L_lw_124e:
    s_branch L_poll_125
L_poll_125s:
    s_sleep 2
L_poll_125:
    buffer_load_dwordx4 v[32:35], v20, s[40:43], s97 offen sc1
    s_sub_u32 s60, s60, 1
    s_cbranch_scc1 L_poll_125t
    s_waitcnt vmcnt(0)
    v_max3_u32 v38, v32, v33, v34
    v_max_u32 v38, v38, v35
    v_cmp_eq_u32 vcc, -1, v38
    s_cbranch_vccnz L_poll_125s
L_poll_125e:
L_pxj:
    s_cmp_ge_u32 s35, 20
    s_cbranch_scc1 L_pxk
    s_mov_b64 exec, -1
L_pxk:
    v_mov_b32 v8, 162048
L_lw_126:
    ds_read_b32 v9, v8
    s_waitcnt lgkmcnt(0)
    v_cmp_gt_u32 vcc, 3, v9
    s_cbranch_vccz L_lw_126e
    s_sleep 2
    s_sub_u32 s60, s60, 1
    s_cbranch_scc0 L_lw_126
    s_mov_b32 s60, 0
L_lw_126e:
    v_lshrrev_b32 v9, 4, v0
    v_lshl_add_u32 v8, v9, 2, v2
    s_lshl_b32 s96, s3, 9
    s_add_u32 s96, s96, 157824
    v_lshl_add_u32 v8, v8, 2, s96
    v_lshlrev_b32 v9, 3, v0
    v_add_u32 v9, 157824, v9
    v_mov_b32 v10, 162048
    v_mov_b32 v11, 1
    s_lshl_b32 s96, s38, 5
    s_add_u32 s96, s96, 161984
    v_mov_b32 v3, s96
    s_sub_u32 s62, 8, s39
    s_lshl_b32 s98, s34, 5
    s_add_u32 s98, s98, s35
    s_lshl_b32 s98, s98, 8
    s_add_u32 s98, s98, 106496
    v_lshlrev_b32 v39, 2, v0
    s_branch L_t0
L_s_role:
    s_cmp_eq_u32 s3, 7
    s_cbranch_scc1 L_t2gate
    s_cmp_gt_u32 s3, 3
    s_cbranch_scc1 L_fin_prep
    s_mov_b32 s48, s18
    s_mov_b32 s49, s19
    s_mov_b32 s50, 3456
    s_mov_b32 s51, 0x20000
    v_lshrrev_b32 v3, 4, v0
    v_and_b32 v4, 15, v0
    v_lshlrev_b32 v4, 1, v4
    s_lshl_b32 s62, s35, 7
    s_lshl_b32 s63, s3, 5
    s_add_u32 s62, s62, s63
    buffer_load_ushort v82, v4, s[48:51], s62 offen
    v_mov_b32 v72, 162064
L_lw_127:
    ds_read_b32 v73, v72
    s_waitcnt lgkmcnt(0)
    v_cmp_gt_u32 vcc, 4, v73
    s_cbranch_vccz L_lw_127e
    s_sleep 2
    s_sub_u32 s60, s60, 1
    s_cbranch_scc0 L_lw_127
    s_mov_b32 s60, 0
L_lw_127e:
    v_bfe_u32 v72, v0, 2, 1
    v_bfe_u32 v73, v0, 4, 1
    v_lshl_add_u32 v72, v73, 2, v72
    v_and_b32 v73, 8, v0
    v_add_u32 v72, v72, v73
    v_lshrrev_b32 v73, 5, v0
    v_lshl_add_u32 v72, v73, 4, v72
    v_lshlrev_b32 v72, 7, v72
    v_and_b32 v73, 3, v0
    v_lshl_add_u32 v72, v73, 3, v72
    v_and_b32 v73, 8, v0
    v_lshl_add_u32 v72, v73, 3, v72
    v_xor_b32 v72, s63, v72
    v_xor_b32 v73, 32, v72
    v_add_u32 v74, 40960, v72
    v_add_u32 v75, 40960, v73
    v_bfe_u32 v1, v0, 2, 2
    v_bfe_u32 v2, v0, 1, 1
    v_and_b32 v6, 1, v0
    v_lshlrev_b32 v7, 5, v3
    v_lshl_add_u32 v7, v6, 4, v7
    v_lshl_add_u32 v5, v2, 2, v1
    v_mul_u32_u24 v5, 1296, v5
    v_add_u32 v5, v5, v7
    v_add_u32 v5, 147456, v5
    v_bfe_u32 v87, v0, 0, 1
    v_mul_u32_u24 v87, 0xaaaa, v87
    v_add_u32 v87, 0x4444, v87
    ds_read_b64_tr_b16 v[88:89], v72 offset:0
    ds_read_b64_tr_b16 v[90:91], v73 offset:256
    ds_read_b64_tr_b16 v[92:93], v72 offset:4096
    ds_read_b64_tr_b16 v[94:95], v73 offset:4352
    ds_read_b64_tr_b16 v[96:97], v72 offset:8192
    ds_read_b64_tr_b16 v[98:99], v73 offset:8448
    ds_read_b64_tr_b16 v[100:101], v72 offset:12288
    ds_read_b64_tr_b16 v[102:103], v73 offset:12544
    ds_read_b64_tr_b16 v[104:105], v72 offset:16384
    ds_read_b64_tr_b16 v[106:107], v73 offset:16640
    ds_read_b64_tr_b16 v[108:109], v72 offset:20480
    ds_read_b64_tr_b16 v[110:111], v73 offset:20736
    ds_read_b64_tr_b16 v[112:113], v72 offset:24576
    ds_read_b64_tr_b16 v[114:115], v73 offset:24832
    ds_read_b64_tr_b16 v[116:117], v72 offset:28672
    ds_read_b64_tr_b16 v[118:119], v73 offset:28928
    ds_read_b64_tr_b16 v[120:121], v72 offset:32768
    ds_read_b64_tr_b16 v[122:123], v73 offset:33024
    ds_read_b64_tr_b16 v[124:125], v72 offset:36864
    ds_read_b64_tr_b16 v[126:127], v73 offset:37120
    ds_read_b64_tr_b16 v[128:129], v74 offset:0
    ds_read_b64_tr_b16 v[130:131], v75 offset:256
    ds_read_b64_tr_b16 v[132:133], v74 offset:4096
    ds_read_b64_tr_b16 v[134:135], v75 offset:4352
    ds_read_b64_tr_b16 v[136:137], v74 offset:8192
    ds_read_b64_tr_b16 v[138:139], v75 offset:8448
    ds_read_b64_tr_b16 v[140:141], v74 offset:12288
    ds_read_b64_tr_b16 v[142:143], v75 offset:12544
    ds_read_b64_tr_b16 v[144:145], v74 offset:16384
    ds_read_b64_tr_b16 v[146:147], v75 offset:16640
    ds_read_b64_tr_b16 v[148:149], v74 offset:20480
    ds_read_b64_tr_b16 v[150:151], v75 offset:20736
    ds_read_b64_tr_b16 v[152:153], v74 offset:24576
    ds_read_b64_tr_b16 v[154:155], v75 offset:24832
    ds_read_b64_tr_b16 v[156:157], v74 offset:28672
    ds_read_b64_tr_b16 v[158:159], v75 offset:28928
    ds_read_b64_tr_b16 v[160:161], v74 offset:32768
    ds_read_b64_tr_b16 v[162:163], v75 offset:33024
    ds_read_b64_tr_b16 v[164:165], v74 offset:36864
    ds_read_b64_tr_b16 v[166:167], v75 offset:37120
    ds_read_b128 v[8:11], v5 offset:0
    ds_read_b128 v[12:15], v5 offset:128
    ds_read_b128 v[16:19], v5 offset:256
    ds_read_b128 v[20:23], v5 offset:384
    ds_read_b128 v[24:27], v5 offset:512
    ds_read_b128 v[28:31], v5 offset:640
    ds_read_b128 v[32:35], v5 offset:768
    ds_read_b128 v[36:39], v5 offset:896
    ds_read_b128 v[40:43], v5 offset:1024
    ds_read_b128 v[44:47], v5 offset:1152
    v_mov_b32 v48, 0
    v_mov_b32 v49, 0
    v_mov_b32 v50, 0
    v_mov_b32 v51, 0
    v_mov_b32 v52, 0
    v_mov_b32 v53, 0
    v_mov_b32 v54, 0
    v_mov_b32 v55, 0
    v_mov_b32 v56, 0
    v_mov_b32 v57, 0
    v_mov_b32 v58, 0
    v_mov_b32 v59, 0
    s_waitcnt lgkmcnt(9)
    v_smfmac_f32_16x16x64_bf16 v[48:51], v[8:11], v[88:95], v87
    s_waitcnt lgkmcnt(8)
    v_smfmac_f32_16x16x64_bf16 v[48:51], v[12:15], v[96:103], v87
    s_waitcnt lgkmcnt(7)
    v_smfmac_f32_16x16x64_bf16 v[48:51], v[16:19], v[104:111], v87
    s_waitcnt lgkmcnt(6)
    v_smfmac_f32_16x16x64_bf16 v[48:51], v[20:23], v[112:119], v87
    s_waitcnt lgkmcnt(5)
    v_smfmac_f32_16x16x64_bf16 v[48:51], v[24:27], v[120:127], v87
    s_waitcnt lgkmcnt(4)
    v_smfmac_f32_16x16x64_bf16 v[48:51], v[28:31], v[128:135], v87
    s_waitcnt lgkmcnt(3)
    v_smfmac_f32_16x16x64_bf16 v[48:51], v[32:35], v[136:143], v87
    s_waitcnt lgkmcnt(2)
    v_smfmac_f32_16x16x64_bf16 v[48:51], v[36:39], v[144:151], v87
    s_waitcnt lgkmcnt(1)
    v_smfmac_f32_16x16x64_bf16 v[48:51], v[40:43], v[152:159], v87
    s_waitcnt lgkmcnt(0)
    v_smfmac_f32_16x16x64_bf16 v[48:51], v[44:47], v[160:167], v87
    v_mul_u32_u24 v79, 1296, v1
    v_lshl_add_u32 v79, v2, 7, v79
    v_add_u32 v79, v79, v7
    v_add_u32 v79, 82944, v79
    v_mul_u32_u24 v80, 144, v3
    v_add3_u32 v80, v80, v4, s63
    v_add_u32 v80, 90688, v80
    v_lshlrev_b32 v81, 3, v0
    v_add_u32 v81, 88128, v81
    v_add_f32 v84, v48, v49
    v_add_f32 v85, v50, v51
    s_mov_b32 s62, 0xbacccccd
    s_mov_b32 s63, 0xbdd2d3e8
    v_mov_b32 v86, 0xc0135761
    s_waitcnt vmcnt(0)
    v_lshlrev_b32 v82, 16, v82
    v_add_f32 v85, v85, v82
    s_branch L_ffn1
L_fin_prep:
    s_cmp_lg_u32 s3, 6
    s_cbranch_scc1 L_end
    s_cmp_ge_u32 s35, 20
    s_cbranch_scc1 L_end
    s_barrier
L_fin:
    s_mov_b32 s52, s28
    s_mov_b32 s53, s29
    s_mov_b32 s54, 5120
    s_mov_b32 s55, 0x20000
    s_mov_b64 s[4:5], -1
    s_mov_b64 s[6:7], -1
    s_mov_b64 s[8:9], -1
    s_mov_b64 s[10:11], 0xffffff
    s_barrier
    ds_read_b128 v[108:111], v77
    s_waitcnt lgkmcnt(0)
    v_pk_fma_f32 v[108:109], v[78:79], v[82:83], v[108:109]
    v_pk_fma_f32 v[110:111], v[80:81], v[84:85], v[110:111]
    s_barrier
L_yg:
    s_mov_b64 exec, s[4:5]
    buffer_load_dwordx4 v[88:91], v72, s[40:43], 0 offen sc1
    s_mov_b64 exec, s[6:7]
    buffer_load_dwordx4 v[92:95], v73, s[40:43], 0 offen sc1
    s_mov_b64 exec, s[8:9]
    buffer_load_dwordx4 v[96:99], v74, s[40:43], 0 offen sc1
    s_mov_b64 exec, s[10:11]
    buffer_load_dwordx4 v[100:103], v75, s[40:43], 0 offen sc1
    s_mov_b64 exec, -1
    s_sub_u32 s60, s60, 1
    s_cbranch_scc1 L_ygt
    s_waitcnt vmcnt(3)
    v_max3_u32 v3, v88, v89, v90
    v_max_u32 v3, v3, v91
    v_cmp_eq_u32 s[4:5], -1, v3
    v_mfma_f32_16x16x32_bf16 v[112:115], v[104:107], v[88:91], 0
    s_waitcnt vmcnt(2)
    v_max3_u32 v3, v92, v93, v94
    v_max_u32 v3, v3, v95
    v_cmp_eq_u32 s[6:7], -1, v3
    v_mfma_f32_16x16x32_bf16 v[112:115], v[104:107], v[92:95], v[112:115]
    s_waitcnt vmcnt(1)
    v_max3_u32 v3, v96, v97, v98
    v_max_u32 v3, v3, v99
    v_cmp_eq_u32 s[8:9], -1, v3
    v_mfma_f32_16x16x32_bf16 v[112:115], v[104:107], v[96:99], v[112:115]
    s_waitcnt vmcnt(0)
    v_max3_u32 v3, v100, v101, v102
    v_max_u32 v3, v3, v103
    v_cmp_eq_u32 s[10:11], -1, v3
    v_mfma_f32_16x16x32_bf16 v[112:115], v[104:107], v[100:103], v[112:115]
    s_or_b64 s[16:17], s[4:5], s[6:7]
    s_or_b64 s[16:17], s[16:17], s[8:9]
    s_or_b64 s[16:17], s[16:17], s[10:11]
    s_cbranch_scc1 L_yg
L_ygd:
    s_nop 3
    v_add_f32_dpp v112, v112, v112 row_ror:8 row_mask:0xf bank_mask:0xf
    v_add_f32_dpp v113, v113, v113 row_ror:8 row_mask:0xf bank_mask:0xf
    v_add_f32_dpp v114, v114, v114 row_ror:8 row_mask:0xf bank_mask:0xf
    v_add_f32_dpp v115, v115, v115 row_ror:8 row_mask:0xf bank_mask:0xf
    v_pk_fma_f32 v[112:113], v[112:113], v[82:83], v[108:109]
    v_pk_fma_f32 v[114:115], v[114:115], v[84:85], v[110:111]
    v_cvt_pk_bf16_f32 v112, v112, v113
    v_cvt_pk_bf16_f32 v113, v114, v115
    s_mov_b64 exec, 0x00ff00ff
    buffer_store_dwordx2 v[112:113], v76, s[52:55], s57 offen
    s_endpgm
L_t2gate:
    v_mov_b32 v8, 162048
L_lw_128:
    ds_read_b32 v9, v8
    s_waitcnt lgkmcnt(0)
    v_cmp_gt_u32 vcc, 8, v9
    s_cbranch_vccz L_lw_128e
    s_sleep 2
    s_sub_u32 s60, s60, 1
    s_cbranch_scc0 L_lw_128
    s_mov_b32 s60, 0
L_lw_128e:
    ds_read_b32 v9, v8 offset:24
    ds_read_b32 v10, v8 offset:36
    v_add_u32 v5, 212992, v5
    s_waitcnt lgkmcnt(0)
    v_readfirstlane_b32 s61, v9
    v_add_u32 v5, v5, v10
    s_mov_b32 s58, 0x3f80
    s_mov_b32 s59, 0x3f800000
    s_mov_b32 s63, 0xff
L_prb:
    s_bcnt1_i32_b32 s62, s63
    s_mov_b32 s97, s63
    s_ff1_i32_b32 s12, s97
    s_bitset0_b32 s97, s12
    s_mul_i32 s4, s12, 5120
    s_add_u32 s4, s4, s56
    s_and_b32 s96, s4, 0xffffe000
    s_add_u32 s4, s4, s96
    s_cmp_eq_u32 s62, 1
    s_cbranch_scc1 L_pi1
    s_ff1_i32_b32 s13, s97
    s_bitset0_b32 s97, s13
    s_mul_i32 s5, s13, 5120
    s_add_u32 s5, s5, s56
    s_and_b32 s96, s5, 0xffffe000
    s_add_u32 s5, s5, s96
    s_cmp_eq_u32 s62, 2
    s_cbranch_scc1 L_pi2
    s_ff1_i32_b32 s14, s97
    s_bitset0_b32 s97, s14
    s_mul_i32 s6, s14, 5120
    s_add_u32 s6, s6, s56
    s_and_b32 s96, s6, 0xffffe000
    s_add_u32 s6, s6, s96
    s_cmp_eq_u32 s62, 3
    s_cbranch_scc1 L_pi3
    s_ff1_i32_b32 s15, s97
    s_bitset0_b32 s97, s15
    s_mul_i32 s7, s15, 5120
    s_add_u32 s7, s7, s56
    s_and_b32 s96, s7, 0xffffe000
    s_add_u32 s7, s7, s96
    s_cmp_eq_u32 s62, 4
    s_cbranch_scc1 L_pi4
    s_ff1_i32_b32 s16, s97
    s_bitset0_b32 s97, s16
    s_mul_i32 s8, s16, 5120
    s_add_u32 s8, s8, s56
    s_and_b32 s96, s8, 0xffffe000
    s_add_u32 s8, s8, s96
    s_cmp_eq_u32 s62, 5
    s_cbranch_scc1 L_pi5
    s_ff1_i32_b32 s17, s97
    s_bitset0_b32 s97, s17
    s_mul_i32 s9, s17, 5120
    s_add_u32 s9, s9, s56
    s_and_b32 s96, s9, 0xffffe000
    s_add_u32 s9, s9, s96
    s_cmp_eq_u32 s62, 6
    s_cbranch_scc1 L_pi6
    s_ff1_i32_b32 s18, s97
    s_bitset0_b32 s97, s18
    s_mul_i32 s10, s18, 5120
    s_add_u32 s10, s10, s56
    s_and_b32 s96, s10, 0xffffe000
    s_add_u32 s10, s10, s96
    s_cmp_eq_u32 s62, 7
    s_cbranch_scc1 L_pi7
    s_ff1_i32_b32 s19, s97
    s_bitset0_b32 s97, s19
    s_mul_i32 s11, s19, 5120
    s_add_u32 s11, s11, s56
    s_and_b32 s96, s11, 0xffffe000
    s_add_u32 s11, s11, s96
L_pi8:
    buffer_load_dwordx4 v[36:39], v5, s[40:43], s11 offen sc1
L_pi7:
    buffer_load_dwordx4 v[32:35], v5, s[40:43], s10 offen sc1
L_pi6:
    buffer_load_dwordx4 v[28:31], v5, s[40:43], s9 offen sc1
L_pi5:
    buffer_load_dwordx4 v[24:27], v5, s[40:43], s8 offen sc1
L_pi4:
    buffer_load_dwordx4 v[20:23], v5, s[40:43], s7 offen sc1
L_pi3:
    buffer_load_dwordx4 v[16:19], v5, s[40:43], s6 offen sc1
L_pi2:
    buffer_load_dwordx4 v[12:15], v5, s[40:43], s5 offen sc1
    buffer_load_dwordx4 v[8:11], v5, s[40:43], s4 offen sc1
    s_sub_u32 s60, s60, 1
    s_cbranch_scc1 L_pto
    s_waitcnt vmcnt(0)
    v_max3_u32 v3, v8, v9, v10
    v_max_u32 v3, v3, v11
    v_cmp_eq_u32 vcc, -1, v3
    s_cbranch_vccz L_pgot0
    v_max3_u32 v3, v12, v13, v14
    v_max_u32 v3, v3, v15
    v_cmp_eq_u32 vcc, -1, v3
    s_cbranch_vccz L_pgot1
    s_cmp_eq_u32 s62, 2
    s_cbranch_scc1 L_pi2
    v_max3_u32 v3, v16, v17, v18
    v_max_u32 v3, v3, v19
    v_cmp_eq_u32 vcc, -1, v3
    s_cbranch_vccz L_pgot2
    s_cmp_eq_u32 s62, 3
    s_cbranch_scc1 L_pi3
    v_max3_u32 v3, v20, v21, v22
    v_max_u32 v3, v3, v23
    v_cmp_eq_u32 vcc, -1, v3
    s_cbranch_vccz L_pgot3
    s_cmp_eq_u32 s62, 4
    s_cbranch_scc1 L_pi4
    v_max3_u32 v3, v24, v25, v26
    v_max_u32 v3, v3, v27
    v_cmp_eq_u32 vcc, -1, v3
    s_cbranch_vccz L_pgot4
    s_cmp_eq_u32 s62, 5
    s_cbranch_scc1 L_pi5
    v_max3_u32 v3, v28, v29, v30
    v_max_u32 v3, v3, v31
    v_cmp_eq_u32 vcc, -1, v3
    s_cbranch_vccz L_pgot5
    s_cmp_eq_u32 s62, 6
    s_cbranch_scc1 L_pi6
    v_max3_u32 v3, v32, v33, v34
    v_max_u32 v3, v3, v35
    v_cmp_eq_u32 vcc, -1, v3
    s_cbranch_vccz L_pgot6
    s_cmp_eq_u32 s62, 7
    s_cbranch_scc1 L_pi7
    v_max3_u32 v3, v36, v37, v38
    v_max_u32 v3, v3, v39
    v_cmp_eq_u32 vcc, -1, v3
    s_cbranch_vccz L_pgot7
    s_branch L_pi8
L_pgot0:
    v_dot2c_f32_bf16 v64, s58, v8
    v_dot2c_f32_bf16 v65, s59, v8
    v_dot2c_f32_bf16 v66, s58, v9
    v_dot2c_f32_bf16 v67, s59, v9
    v_dot2c_f32_bf16 v68, s58, v10
    v_dot2c_f32_bf16 v69, s59, v10
    v_dot2c_f32_bf16 v70, s58, v11
    v_dot2c_f32_bf16 v71, s59, v11
    s_bitset0_b32 s63, s12
    s_cmp_eq_u32 s63, 0
    s_cbranch_scc1 L_pgd
L_pn0:
    s_cmp_eq_u32 s62, 1
    s_cbranch_scc1 L_prb
    v_max3_u32 v3, v12, v13, v14
    v_max_u32 v3, v3, v15
    v_cmp_eq_u32 vcc, -1, v3
    s_cbranch_vccnz L_pn1
L_pgot1:
    v_dot2c_f32_bf16 v64, s58, v12
    v_dot2c_f32_bf16 v65, s59, v12
    v_dot2c_f32_bf16 v66, s58, v13
    v_dot2c_f32_bf16 v67, s59, v13
    v_dot2c_f32_bf16 v68, s58, v14
    v_dot2c_f32_bf16 v69, s59, v14
    v_dot2c_f32_bf16 v70, s58, v15
    v_dot2c_f32_bf16 v71, s59, v15
    s_bitset0_b32 s63, s13
    s_cmp_eq_u32 s63, 0
    s_cbranch_scc1 L_pgd
L_pn1:
    s_cmp_eq_u32 s62, 2
    s_cbranch_scc1 L_prb
    v_max3_u32 v3, v16, v17, v18
    v_max_u32 v3, v3, v19
    v_cmp_eq_u32 vcc, -1, v3
    s_cbranch_vccnz L_pn2
L_pgot2:
    v_dot2c_f32_bf16 v64, s58, v16
    v_dot2c_f32_bf16 v65, s59, v16
    v_dot2c_f32_bf16 v66, s58, v17
    v_dot2c_f32_bf16 v67, s59, v17
    v_dot2c_f32_bf16 v68, s58, v18
    v_dot2c_f32_bf16 v69, s59, v18
    v_dot2c_f32_bf16 v70, s58, v19
    v_dot2c_f32_bf16 v71, s59, v19
    s_bitset0_b32 s63, s14
    s_cmp_eq_u32 s63, 0
    s_cbranch_scc1 L_pgd
L_pn2:
    s_cmp_eq_u32 s62, 3
    s_cbranch_scc1 L_prb
    v_max3_u32 v3, v20, v21, v22
    v_max_u32 v3, v3, v23
    v_cmp_eq_u32 vcc, -1, v3
    s_cbranch_vccnz L_pn3
L_pgot3:
    v_dot2c_f32_bf16 v64, s58, v20
    v_dot2c_f32_bf16 v65, s59, v20
    v_dot2c_f32_bf16 v66, s58, v21
    v_dot2c_f32_bf16 v67, s59, v21
    v_dot2c_f32_bf16 v68, s58, v22
    v_dot2c_f32_bf16 v69, s59, v22
    v_dot2c_f32_bf16 v70, s58, v23
    v_dot2c_f32_bf16 v71, s59, v23
    s_bitset0_b32 s63, s15
    s_cmp_eq_u32 s63, 0
    s_cbranch_scc1 L_pgd
L_pn3:
    s_cmp_eq_u32 s62, 4
    s_cbranch_scc1 L_prb
    v_max3_u32 v3, v24, v25, v26
    v_max_u32 v3, v3, v27
    v_cmp_eq_u32 vcc, -1, v3
    s_cbranch_vccnz L_pn4
L_pgot4:
    v_dot2c_f32_bf16 v64, s58, v24
    v_dot2c_f32_bf16 v65, s59, v24
    v_dot2c_f32_bf16 v66, s58, v25
    v_dot2c_f32_bf16 v67, s59, v25
    v_dot2c_f32_bf16 v68, s58, v26
    v_dot2c_f32_bf16 v69, s59, v26
    v_dot2c_f32_bf16 v70, s58, v27
    v_dot2c_f32_bf16 v71, s59, v27
    s_bitset0_b32 s63, s16
    s_cmp_eq_u32 s63, 0
    s_cbranch_scc1 L_pgd
L_pn4:
    s_cmp_eq_u32 s62, 5
    s_cbranch_scc1 L_prb
    v_max3_u32 v3, v28, v29, v30
    v_max_u32 v3, v3, v31
    v_cmp_eq_u32 vcc, -1, v3
    s_cbranch_vccnz L_pn5
L_pgot5:
    v_dot2c_f32_bf16 v64, s58, v28
    v_dot2c_f32_bf16 v65, s59, v28
    v_dot2c_f32_bf16 v66, s58, v29
    v_dot2c_f32_bf16 v67, s59, v29
    v_dot2c_f32_bf16 v68, s58, v30
    v_dot2c_f32_bf16 v69, s59, v30
    v_dot2c_f32_bf16 v70, s58, v31
    v_dot2c_f32_bf16 v71, s59, v31
    s_bitset0_b32 s63, s17
    s_cmp_eq_u32 s63, 0
    s_cbranch_scc1 L_pgd
L_pn5:
    s_cmp_eq_u32 s62, 6
    s_cbranch_scc1 L_prb
    v_max3_u32 v3, v32, v33, v34
    v_max_u32 v3, v3, v35
    v_cmp_eq_u32 vcc, -1, v3
    s_cbranch_vccnz L_pn6
L_pgot6:
    v_dot2c_f32_bf16 v64, s58, v32
    v_dot2c_f32_bf16 v65, s59, v32
    v_dot2c_f32_bf16 v66, s58, v33
    v_dot2c_f32_bf16 v67, s59, v33
    v_dot2c_f32_bf16 v68, s58, v34
    v_dot2c_f32_bf16 v69, s59, v34
    v_dot2c_f32_bf16 v70, s58, v35
    v_dot2c_f32_bf16 v71, s59, v35
    s_bitset0_b32 s63, s18
    s_cmp_eq_u32 s63, 0
    s_cbranch_scc1 L_pgd
L_pn6:
    s_cmp_eq_u32 s62, 7
    s_cbranch_scc1 L_prb
    v_max3_u32 v3, v36, v37, v38
    v_max_u32 v3, v3, v39
    v_cmp_eq_u32 vcc, -1, v3
    s_cbranch_vccnz L_pn7
L_pgot7:
    v_dot2c_f32_bf16 v64, s58, v36
    v_dot2c_f32_bf16 v65, s59, v36
    v_dot2c_f32_bf16 v66, s58, v37
    v_dot2c_f32_bf16 v67, s59, v37
    v_dot2c_f32_bf16 v68, s58, v38
    v_dot2c_f32_bf16 v69, s59, v38
    v_dot2c_f32_bf16 v70, s58, v39
    v_dot2c_f32_bf16 v71, s59, v39
    s_bitset0_b32 s63, s19
    s_cmp_eq_u32 s63, 0
    s_cbranch_scc1 L_pgd
L_pn7:
    s_branch L_prb
L_pi1:
L_poll_129:
    buffer_load_dwordx4 v[8:11], v5, s[40:43], s4 offen sc1
    s_sub_u32 s60, s60, 1
    s_cbranch_scc1 L_poll_129t
    s_waitcnt vmcnt(0)
    v_max3_u32 v3, v8, v9, v10
    v_max_u32 v3, v3, v11
    v_cmp_eq_u32 vcc, -1, v3
    s_cbranch_vccnz L_poll_129
L_poll_129e:
    v_dot2c_f32_bf16 v64, s58, v8
    v_dot2c_f32_bf16 v65, s59, v8
    v_dot2c_f32_bf16 v66, s58, v9
    v_dot2c_f32_bf16 v67, s59, v9
    v_dot2c_f32_bf16 v68, s58, v10
    v_dot2c_f32_bf16 v69, s59, v10
    v_dot2c_f32_bf16 v70, s58, v11
    v_dot2c_f32_bf16 v71, s59, v11
L_pgd:
    v_pk_fma_f32 v[64:65], v[64:65], v[48:49], v[40:41]
    v_pk_fma_f32 v[66:67], v[66:67], v[50:51], v[42:43]
    v_pk_fma_f32 v[68:69], v[68:69], v[52:53], v[44:45]
    v_pk_fma_f32 v[70:71], v[70:71], v[54:55], v[46:47]
    v_pk_mul_f32 v[56:57], v[64:65], v[56:57]
    v_pk_mul_f32 v[58:59], v[66:67], v[58:59]
    v_pk_mul_f32 v[60:61], v[68:69], v[60:61]
    v_pk_mul_f32 v[62:63], v[70:71], v[62:63]
    v_cvt_pk_bf16_f32 v8, v56, v57
    v_cvt_pk_bf16_f32 v9, v58, v59
    v_cvt_pk_bf16_f32 v10, v60, v61
    v_cvt_pk_bf16_f32 v11, v62, v63
    ds_write_b128 v4, v[8:11]
    v_pk_add_f32 v[40:41], v[64:65], v[66:67]
    v_pk_add_f32 v[42:43], v[68:69], v[70:71]
    v_pk_mul_f32 v[44:45], v[64:65], v[64:65]
    v_pk_mul_f32 v[46:47], v[66:67], v[66:67]
    v_pk_add_f32 v[40:41], v[40:41], v[42:43]
    v_pk_fma_f32 v[44:45], v[68:69], v[68:69], v[44:45]
    v_pk_fma_f32 v[46:47], v[70:71], v[70:71], v[46:47]
    v_add_f32 v40, v40, v41
    v_pk_add_f32 v[44:45], v[44:45], v[46:47]
    v_add_f32 v41, v44, v45
    ds_write_b64 v7, v[40:41]
    s_waitcnt lgkmcnt(0)
    s_barrier
    v_mov_b32 v16, 0
    v_mov_b32 v17, 0
    v_mov_b32 v18, 0
    v_mov_b32 v19, 0
    v_mov_b32 v20, 0
    v_mov_b32 v21, 0
    v_mov_b32 v22, 0
    v_mov_b32 v23, 0
    v_mov_b32 v24, 0
    v_mov_b32 v25, 0
    v_mov_b32 v26, 0
    v_mov_b32 v27, 0
    v_mov_b32 v28, 0
    v_mov_b32 v29, 0
    v_mov_b32 v30, 0
    v_mov_b32 v31, 0
    v_mov_b32 v32, 0
    v_mov_b32 v33, 0
    v_mov_b32 v34, 0
    v_mov_b32 v35, 0
    ds_write_b128 v6, v[64:67]
    ds_write_b128 v6, v[68:71] offset:16
    s_waitcnt lgkmcnt(0)
    s_cmp_lg_u32 s3, 7
    s_cbranch_scc1 L_ffn2
    s_cmp_lt_u32 s35, 20
    s_cbranch_scc1 L_fin
    s_endpgm
L_ffn1:
    s_barrier
L_ffn1b:
    ds_read_b128 v[8:11], v79
    ds_read_b64 v[30:31], v81 offset:0
    ds_read_b64 v[32:33], v81 offset:512
    ds_read_b64 v[34:35], v81 offset:1024
    ds_read_b64 v[36:37], v81 offset:1536
    ds_read_b64 v[38:39], v81 offset:2048
    ds_read_b128 v[12:15], v79 offset:256
    ds_read_b128 v[16:19], v79 offset:512
    ds_read_b128 v[20:23], v79 offset:768
    ds_read_b128 v[24:27], v79 offset:1024
    s_waitcnt lgkmcnt(9)
    v_smfmac_f32_16x16x64_bf16 v[52:55], v[8:11], v[88:95], v87
    v_smfmac_f32_16x16x64_bf16 v[56:59], v[8:11], v[96:103], v87
    s_waitcnt lgkmcnt(3)
    v_smfmac_f32_16x16x64_bf16 v[52:55], v[12:15], v[104:111], v87
    v_pk_add_f32 v[30:31], v[30:31], v[32:33]
    v_pk_add_f32 v[34:35], v[34:35], v[36:37]
    v_smfmac_f32_16x16x64_bf16 v[56:59], v[12:15], v[112:119], v87
    v_pk_add_f32 v[30:31], v[30:31], v[38:39]
    v_pk_add_f32 v[30:31], v[30:31], v[34:35]
    s_waitcnt lgkmcnt(2)
    v_smfmac_f32_16x16x64_bf16 v[52:55], v[16:19], v[120:127], v87
    v_add_f32_dpp v30, v30, v30 quad_perm:[1,0,3,2] row_mask:0xf bank_mask:0xf
    v_add_f32_dpp v31, v31, v31 quad_perm:[1,0,3,2] row_mask:0xf bank_mask:0xf
    v_smfmac_f32_16x16x64_bf16 v[56:59], v[16:19], v[128:135], v87
    v_add_f32_dpp v30, v30, v30 quad_perm:[2,3,0,1] row_mask:0xf bank_mask:0xf
    v_add_f32_dpp v31, v31, v31 quad_perm:[2,3,0,1] row_mask:0xf bank_mask:0xf
    s_waitcnt lgkmcnt(1)
    v_smfmac_f32_16x16x64_bf16 v[52:55], v[20:23], v[136:143], v87
    v_add_f32_dpp v30, v30, v30 row_ror:4 row_mask:0xf bank_mask:0xf
    v_add_f32_dpp v31, v31, v31 row_ror:4 row_mask:0xf bank_mask:0xf
    v_smfmac_f32_16x16x64_bf16 v[56:59], v[20:23], v[144:151], v87
    v_add_f32_dpp v30, v30, v30 row_ror:8 row_mask:0xf bank_mask:0xf
    v_add_f32_dpp v31, v31, v31 row_ror:8 row_mask:0xf bank_mask:0xf
    s_waitcnt lgkmcnt(0)
    v_smfmac_f32_16x16x64_bf16 v[52:55], v[24:27], v[152:159], v87
    v_mul_f32 v48, s62, v30
    v_mul_f32 v49, s62, v31
    v_smfmac_f32_16x16x64_bf16 v[56:59], v[24:27], v[160:167], v87
    v_mul_f32 v7, v84, v48
    v_fma_f32 v49, -v48, v48, -v49
    v_max_f32 v49, 0, v49
    v_add_f32 v49, 0x3727c5ac, v49
    v_rsq_f32 v49, v49
    v_add_f32 v4, v52, v53
    v_add_f32 v4, v4, v7
    s_nop 0
    v_add_f32 v5, v58, v59
    v_add_f32 v4, v4, v5
    v_fma_f32 v4, v4, v49, v85
    v_mul_f32 v5, v4, v4
    v_fma_f32 v5, v5, s63, v86
    v_mul_f32 v5, v5, v4
    v_exp_f32 v5, v5
    s_nop 0
    v_add_f32 v5, 1.0, v5
    v_rcp_f32 v5, v5
    s_nop 0
    v_mul_f32 v4, v4, v5
    v_cvt_pk_bf16_f32 v4, v4, v4
    ds_write_b16 v80, v4
    s_waitcnt lgkmcnt(0)
    s_barrier
    s_endpgm
L_cut:
L_h_t1:
    s_sub_u32 s63, s56, 154
    s_cmp_lt_u32 s63, 16
    s_cbranch_scc0 L_h_noclr
    s_lshl2_add_u32 s62, s63, s3
    s_mul_i32 s62, s62, 4608
    v_mov_b32 v4, -1
    v_mov_b32 v5, -1
    v_mov_b32 v6, -1
    v_mov_b32 v7, -1
    v_lshlrev_b32 v8, 4, v0
    buffer_store_dwordx4 v[4:7], v8, s[40:43], s62 offen offset:0 sc1
    buffer_store_dwordx4 v[4:7], v8, s[40:43], s62 offen offset:1024 sc1
    buffer_store_dwordx4 v[4:7], v8, s[40:43], s62 offen offset:2048 sc1
    buffer_store_dwordx4 v[4:7], v8, s[40:43], s62 offen offset:3072 sc1
    s_add_u32 s62, s62, 4096
    s_bfm_b64 exec, 32, 0
    buffer_store_dwordx4 v[4:7], v8, s[40:43], s62 offen offset:0 sc1
    s_mov_b64 exec, 1
    v_mov_b32 v9, 162100
    v_mov_b32 v10, 1
    s_and_b32 s62, s63, 1
    s_mul_i32 s62, s62, 126
    s_lshl1_add_u32 s63, s63, s62
    s_waitcnt vmcnt(0)
    ds_add_rtn_u32 v10, v9, v10
    s_waitcnt lgkmcnt(0)
    v_readfirstlane_b32 s62, v10
    s_nop 0
    s_cmp_lg_u32 s62, 3
    s_cbranch_scc1 L_h_clrd
    buffer_store_dword v4, v36, s[44:47], s63 offen sc1
L_h_clrd:
    s_mov_b64 exec, -1
L_h_noclr:
    v_lshrrev_b32 v1, 3, v0
    v_mul_u32_u24 v1, 1280, v1
    v_and_b32 v2, 7, v0
    v_lshl_add_u32 v1, v2, 4, v1
    s_lshl2_add_u32 s63, s34, s3
    s_mul_i32 s63, s63, 163840
    s_lshl_b32 s62, s35, 7
    s_add_u32 s63, s63, s62
    s_sub_u32 s63, s63, 2816
    s_lshl_b32 s62, s3, 14
    s_add_u32 s62, s62, 81920
    s_mov_b32 m0, s62
    s_mov_b32 s48, s12
    s_mov_b32 s49, s13
    s_mov_b32 s50, 5242880
    s_mov_b32 s51, 0x20000
    s_add_u32 s100, s39, 1
    s_mov_b32 s62, 8
L_dma_5:
    buffer_load_dwordx4 v1, s[48:51], s63 offen nt lds
    s_add_u32 m0, m0, 1024
    s_add_u32 s63, s63, 10240
    s_cmp_eq_u32 s100, 0
    s_cbranch_scc1 L_dma_5n0
    s_waitcnt vmcnt(7)
    s_cmp_eq_u32 s100, 2
    s_cbranch_scc1 L_dma_5n0
    s_waitcnt vmcnt(5)
L_dma_5n0:
    buffer_load_dwordx4 v1, s[48:51], s63 offen nt lds
    s_add_u32 m0, m0, 1024
    s_add_u32 s63, s63, 10240
    s_cmp_eq_u32 s100, 0
    s_cbranch_scc1 L_dma_5n1
    s_waitcnt vmcnt(7)
    s_cmp_eq_u32 s100, 2
    s_cbranch_scc1 L_dma_5n1
    s_waitcnt vmcnt(5)
L_dma_5n1:
    s_sub_u32 s62, s62, 1
    s_cmp_lg_u32 s62, 0
    s_cbranch_scc1 L_dma_5
    s_cmp_eq_u32 s39, 1
    s_cbranch_scc1 L_h_role
    s_barrier
    s_waitcnt vmcnt(0)
    v_mov_b32 v4, 162060
    v_mov_b32 v5, 1
    s_mov_b64 exec, 1
    ds_add_u32 v4, v5
    s_mov_b64 exec, -1
    s_cmp_eq_u32 s3, 0
    s_cbranch_scc1 L_service
    s_endpgm
L_h_role:
    v_mov_b32 v72, 0
    v_mov_b32 v73, 0
    v_mov_b32 v74, 0
    v_mov_b32 v75, 0
    v_mov_b32 v76, 0
    v_lshrrev_b32 v3, 4, v0
    v_and_b32 v2, 3, v0
    v_bfe_u32 v1, v0, 2, 2
    v_mul_u32_u24 v160, 1280, v3
    v_and_b32 v4, 15, v0
    v_lshl_add_u32 v163, v4, 2, v160
    v_lshl_add_u32 v160, v4, 3, v160
    s_mul_i32 s57, s35, 5120
    s_mul_i32 s62, s3, 320
    s_add_u32 s57, s57, s62
    s_add_u32 s57, s57, 327680
    v_add_u32 v8, 0, v0
    v_mul_u32_u24 v10, 0xccd, v8
    v_lshrrev_b32 v10, 16, v10
    v_mul_u32_u24 v9, 20, v10
    v_sub_u32 v8, v8, v9
    v_mul_u32_u24 v10, 1280, v10
    v_lshl_add_u32 v10, v8, 4, v10
    v_add_u32 v8, 64, v0
    v_mul_u32_u24 v11, 0xccd, v8
    v_lshrrev_b32 v11, 16, v11
    v_mul_u32_u24 v9, 20, v11
    v_sub_u32 v8, v8, v9
    v_mul_u32_u24 v11, 1280, v11
    v_lshl_add_u32 v11, v8, 4, v11
    v_add_u32 v8, 128, v0
    v_mul_u32_u24 v12, 0xccd, v8
    v_lshrrev_b32 v12, 16, v12
    v_mul_u32_u24 v9, 20, v12
    v_sub_u32 v8, v8, v9
    v_mul_u32_u24 v12, 1280, v12
    v_lshl_add_u32 v12, v8, 4, v12
    v_add_u32 v8, 192, v0
    v_mul_u32_u24 v13, 0xccd, v8
    v_lshrrev_b32 v13, 16, v13
    v_mul_u32_u24 v9, 20, v13
    v_sub_u32 v8, v8, v9
    v_mul_u32_u24 v13, 1280, v13
    v_lshl_add_u32 v13, v8, 4, v13
    v_add_u32 v8, 256, v0
    v_mul_u32_u24 v14, 0xccd, v8
    v_lshrrev_b32 v14, 16, v14
    v_mul_u32_u24 v9, 20, v14
    v_sub_u32 v8, v8, v9
    v_mul_u32_u24 v14, 1280, v14
    v_lshl_add_u32 v14, v8, 4, v14
    s_mov_b32 s48, s20
    s_mov_b32 s49, s21
    s_mov_b32 s50, 2211840
    s_mov_b32 s51, 0x20000
    s_mul_i32 s63, s35, 81920
    s_mul_i32 s62, s3, 320
    s_add_u32 s63, s63, s62
    s_mov_b32 m0, s101
    s_mov_b32 s62, 4
L_w2dma:
    buffer_load_dwordx4 v10, s[48:51], s63 offen nt lds
    s_add_u32 m0, m0, 1024
    s_waitcnt vmcnt(7)
    s_cmp_ge_u32 s35, 22
    s_cbranch_scc1 L_w2n0
    s_waitcnt vmcnt(7)
L_w2n0:
    buffer_load_dwordx4 v11, s[48:51], s63 offen nt lds
    s_add_u32 m0, m0, 1024
    s_waitcnt vmcnt(7)
    s_cmp_ge_u32 s35, 22
    s_cbranch_scc1 L_w2n1
    s_waitcnt vmcnt(7)
L_w2n1:
    buffer_load_dwordx4 v12, s[48:51], s63 offen nt lds
    s_add_u32 m0, m0, 1024
    s_waitcnt vmcnt(7)
    s_cmp_ge_u32 s35, 22
    s_cbranch_scc1 L_w2n2
    s_waitcnt vmcnt(7)
L_w2n2:
    buffer_load_dwordx4 v13, s[48:51], s63 offen nt lds
    s_add_u32 m0, m0, 1024
    s_waitcnt vmcnt(7)
    s_cmp_ge_u32 s35, 22
    s_cbranch_scc1 L_w2n3
    s_waitcnt vmcnt(7)
L_w2n3:
    buffer_load_dwordx4 v14, s[48:51], s63 offen nt lds
    s_add_u32 m0, m0, 1024
    s_waitcnt vmcnt(7)
    s_cmp_ge_u32 s35, 22
    s_cbranch_scc1 L_w2n4
    s_waitcnt vmcnt(7)
L_w2n4:
    s_add_u32 s63, s63, 20480
    s_sub_u32 s62, s62, 1
    s_cmp_lg_u32 s62, 0
    s_cbranch_scc1 L_w2dma
    v_lshrrev_b32 v8, 5, v0
    v_lshlrev_b32 v8, 2, v8
    v_bfe_u32 v9, v0, 4, 1
    v_add_u32 v8, v8, v9
    v_mul_u32_u24 v8, 1280, v8
    v_add_u32 v8, s101, v8
    v_and_b32 v10, 15, v0
    v_lshl_add_u32 v9, v10, 2, v8
    v_lshl_add_u32 v8, v10, 3, v8
    s_mov_b32 s62, 0x05040100
    s_mov_b32 s63, 0x07060302
    s_waitcnt vmcnt(0)
    v_mov_b32 v4, 162060
    v_mov_b32 v5, 1
    s_mov_b64 exec, 1
    ds_add_u32 v4, v5
    s_mov_b64 exec, -1
    ds_read_b64 v[16:17], v8 offset:0
    ds_read_b64 v[18:19], v8 offset:320
    ds_read_b64 v[20:21], v8 offset:2560
    ds_read_b64 v[22:23], v8 offset:2880
    ds_read_b64 v[24:25], v8 offset:640
    ds_read_b64 v[26:27], v8 offset:960
    ds_read_b64 v[28:29], v8 offset:3200
    ds_read_b64 v[30:31], v8 offset:3520
    ds_read_b64 v[32:33], v8 offset:10240
    ds_read_b64 v[34:35], v8 offset:10560
    ds_read_b64 v[36:37], v8 offset:12800
    ds_read_b64 v[38:39], v8 offset:13120
    ds_read_b64 v[40:41], v8 offset:10880
    ds_read_b64 v[42:43], v8 offset:11200
    ds_read_b64 v[44:45], v8 offset:13440
    ds_read_b64 v[46:47], v8 offset:13760
    s_waitcnt lgkmcnt(0)
    v_perm_b32 v80, v18, v16, s62
    v_perm_b32 v88, v18, v16, s63
    v_perm_b32 v96, v19, v17, s62
    v_perm_b32 v104, v19, v17, s63
    v_perm_b32 v81, v22, v20, s62
    v_perm_b32 v89, v22, v20, s63
    v_perm_b32 v97, v23, v21, s62
    v_perm_b32 v105, v23, v21, s63
    v_perm_b32 v82, v26, v24, s62
    v_perm_b32 v90, v26, v24, s63
    v_perm_b32 v98, v27, v25, s62
    v_perm_b32 v106, v27, v25, s63
    v_perm_b32 v83, v30, v28, s62
    v_perm_b32 v91, v30, v28, s63
    v_perm_b32 v99, v31, v29, s62
    v_perm_b32 v107, v31, v29, s63
    v_perm_b32 v84, v34, v32, s62
    v_perm_b32 v92, v34, v32, s63
    v_perm_b32 v100, v35, v33, s62
    v_perm_b32 v108, v35, v33, s63
    v_perm_b32 v85, v38, v36, s62
    v_perm_b32 v93, v38, v36, s63
    v_perm_b32 v101, v39, v37, s62
    v_perm_b32 v109, v39, v37, s63
    v_perm_b32 v86, v42, v40, s62
    v_perm_b32 v94, v42, v40, s63
    v_perm_b32 v102, v43, v41, s62
    v_perm_b32 v110, v43, v41, s63
    v_perm_b32 v87, v46, v44, s62
    v_perm_b32 v95, v46, v44, s63
    v_perm_b32 v103, v47, v45, s62
    v_perm_b32 v111, v47, v45, s63
    ds_read_b64 v[16:17], v8 offset:128
    ds_read_b64 v[18:19], v8 offset:448
    ds_read_b64 v[20:21], v8 offset:2688
    ds_read_b64 v[22:23], v8 offset:3008
    ds_read_b64 v[24:25], v8 offset:768
    ds_read_b64 v[26:27], v8 offset:1088
    ds_read_b64 v[28:29], v8 offset:3328
    ds_read_b64 v[30:31], v8 offset:3648
    ds_read_b64 v[32:33], v8 offset:10368
    ds_read_b64 v[34:35], v8 offset:10688
    ds_read_b64 v[36:37], v8 offset:12928
    ds_read_b64 v[38:39], v8 offset:13248
    ds_read_b64 v[40:41], v8 offset:11008
    ds_read_b64 v[42:43], v8 offset:11328
    ds_read_b64 v[44:45], v8 offset:13568
    ds_read_b64 v[46:47], v8 offset:13888
    s_waitcnt lgkmcnt(0)
    v_perm_b32 v112, v18, v16, s62
    v_perm_b32 v120, v18, v16, s63
    v_perm_b32 v128, v19, v17, s62
    v_perm_b32 v136, v19, v17, s63
    v_perm_b32 v113, v22, v20, s62
    v_perm_b32 v121, v22, v20, s63
    v_perm_b32 v129, v23, v21, s62
    v_perm_b32 v137, v23, v21, s63
    v_perm_b32 v114, v26, v24, s62
    v_perm_b32 v122, v26, v24, s63
    v_perm_b32 v130, v27, v25, s62
    v_perm_b32 v138, v27, v25, s63
    v_perm_b32 v115, v30, v28, s62
    v_perm_b32 v123, v30, v28, s63
    v_perm_b32 v131, v31, v29, s62
    v_perm_b32 v139, v31, v29, s63
    v_perm_b32 v116, v34, v32, s62
    v_perm_b32 v124, v34, v32, s63
    v_perm_b32 v132, v35, v33, s62
    v_perm_b32 v140, v35, v33, s63
    v_perm_b32 v117, v38, v36, s62
    v_perm_b32 v125, v38, v36, s63
    v_perm_b32 v133, v39, v37, s62
    v_perm_b32 v141, v39, v37, s63
    v_perm_b32 v118, v42, v40, s62
    v_perm_b32 v126, v42, v40, s63
    v_perm_b32 v134, v43, v41, s62
    v_perm_b32 v142, v43, v41, s63
    v_perm_b32 v119, v46, v44, s62
    v_perm_b32 v127, v46, v44, s63
    v_perm_b32 v135, v47, v45, s62
    v_perm_b32 v143, v47, v45, s63
    ds_read_b32 v16, v9 offset:256
    ds_read_b32 v18, v9 offset:576
    ds_read_b32 v20, v9 offset:2816
    ds_read_b32 v22, v9 offset:3136
    ds_read_b32 v24, v9 offset:896
    ds_read_b32 v26, v9 offset:1216
    ds_read_b32 v28, v9 offset:3456
    ds_read_b32 v30, v9 offset:3776
    ds_read_b32 v32, v9 offset:10496
    ds_read_b32 v34, v9 offset:10816
    ds_read_b32 v36, v9 offset:13056
    ds_read_b32 v38, v9 offset:13376
    ds_read_b32 v40, v9 offset:11136
    ds_read_b32 v42, v9 offset:11456
    ds_read_b32 v44, v9 offset:13696
    ds_read_b32 v46, v9 offset:14016
    s_waitcnt lgkmcnt(0)
    v_perm_b32 v144, v18, v16, s62
    v_perm_b32 v152, v18, v16, s63
    v_perm_b32 v145, v22, v20, s62
    v_perm_b32 v153, v22, v20, s63
    v_perm_b32 v146, v26, v24, s62
    v_perm_b32 v154, v26, v24, s63
    v_perm_b32 v147, v30, v28, s62
    v_perm_b32 v155, v30, v28, s63
    v_perm_b32 v148, v34, v32, s62
    v_perm_b32 v156, v34, v32, s63
    v_perm_b32 v149, v38, v36, s62
    v_perm_b32 v157, v38, v36, s63
    v_perm_b32 v150, v42, v40, s62
    v_perm_b32 v158, v42, v40, s63
    v_perm_b32 v151, v46, v44, s62
    v_perm_b32 v159, v46, v44, s63
    s_mov_b32 s48, s16
    s_mov_b32 s49, s17
    s_mov_b32 s50, 2211840
    s_mov_b32 s51, 0x20000
    s_lshl_b32 s98, s35, 7
    s_mov_b32 s99, 3456
    v_lshrrev_b32 v9, 3, v0
    v_mul_lo_u32 v10, v9, s99
    v_and_b32 v9, 2, v9
    v_xor_b32 v9, v9, v0
    v_and_b32 v9, 7, v9
    v_lshl_add_u32 v10, v9, 4, v10
    v_add_u32 v10, s98, v10
    v_xor_b32 v11, 64, v10
    s_mul_i32 s63, s3, 552960
    s_mov_b32 m0, s101
    s_waitcnt lgkmcnt(0)
    s_cmp_ge_u32 s35, 22
    s_cselect_b32 s100, 2, 1
    s_mov_b32 s62, 10
L_dma_6:
    buffer_load_dwordx4 v10, s[48:51], s63 offen nt lds
    s_add_u32 m0, m0, 1024
    s_add_u32 s63, s63, 27648
    s_cmp_eq_u32 s100, 0
    s_cbranch_scc1 L_dma_6n0
    s_waitcnt vmcnt(7)
    s_cmp_eq_u32 s100, 2
    s_cbranch_scc1 L_dma_6n0
    s_waitcnt vmcnt(7)
L_dma_6n0:
    buffer_load_dwordx4 v11, s[48:51], s63 offen nt lds
    s_add_u32 m0, m0, 1024
    s_add_u32 s63, s63, 27648
    s_cmp_eq_u32 s100, 0
    s_cbranch_scc1 L_dma_6n1
    s_waitcnt vmcnt(7)
    s_cmp_eq_u32 s100, 2
    s_cbranch_scc1 L_dma_6n1
    s_waitcnt vmcnt(7)
L_dma_6n1:
    s_sub_u32 s62, s62, 1
    s_cmp_lg_u32 s62, 0
    s_cbranch_scc1 L_dma_6
    v_mov_b32 v8, 162068
L_lw_7:
    ds_read_b32 v9, v8
    s_waitcnt lgkmcnt(0)
    v_cmp_gt_u32 vcc, 1, v9
    s_cbranch_vccz L_lw_7e
    s_sleep 8
    s_sub_u32 s60, s60, 1
    s_cbranch_scc0 L_lw_7
    s_mov_b32 s60, 0
L_lw_7e:
    s_cmp_lg_u32 s3, 3
    s_cbranch_scc1 L_h_nomo
    v_and_b32 v4, 15, v0
    v_lshlrev_b32 v4, 4, v4
    v_mul_u32_u24 v5, 1280, v3
    v_add_u32 v5, v5, v4
    v_mul_u32_u24 v6, 1296, v3
    v_add_u32 v6, v6, v4
    v_add_u32 v6, 147456, v6
    s_mov_b32 s62, 30720
    s_mov_b32 s63, 25600
    s_branch L_poll_8
L_poll_8s:
    s_sleep 8
L_poll_8:
    buffer_load_dwordx4 v[40:43], v5, s[40:43], s62 offen offset:0 sc1
    buffer_load_dwordx4 v[44:47], v5, s[40:43], s62 offen offset:256 sc1
    buffer_load_dwordx4 v[48:51], v5, s[40:43], s62 offen offset:512 sc1
    buffer_load_dwordx4 v[52:55], v5, s[40:43], s62 offen offset:768 sc1
    buffer_load_dwordx4 v[56:59], v5, s[40:43], s62 offen offset:1024 sc1
    buffer_load_dwordx4 v[60:63], v5, s[40:43], s63 offen offset:0 sc1
    buffer_load_dwordx4 v[64:67], v5, s[40:43], s63 offen offset:256 sc1
    buffer_load_dwordx4 v[68:71], v5, s[40:43], s63 offen offset:512 sc1
    buffer_load_dwordx4 v[72:75], v5, s[40:43], s63 offen offset:768 sc1
    buffer_load_dwordx4 v[76:79], v5, s[40:43], s63 offen offset:1024 sc1
    s_sub_u32 s60, s60, 1
    s_cbranch_scc1 L_poll_8t
    s_waitcnt vmcnt(0)
    v_max3_u32 v7, v40, v41, v42
    v_max3_u32 v7, v7, v43, v44
    v_max3_u32 v7, v7, v45, v46
    v_max3_u32 v7, v7, v47, v48
    v_max3_u32 v7, v7, v49, v50
    v_max3_u32 v7, v7, v51, v52
    v_max3_u32 v7, v7, v53, v54
    v_max3_u32 v7, v7, v55, v56
    v_max3_u32 v7, v7, v57, v58
    v_max3_u32 v7, v7, v59, v60
    v_max3_u32 v7, v7, v61, v62
    v_max3_u32 v7, v7, v63, v64
    v_max3_u32 v7, v7, v65, v66
    v_max3_u32 v7, v7, v67, v68
    v_max3_u32 v7, v7, v69, v70
    v_max3_u32 v7, v7, v71, v72
    v_max3_u32 v7, v7, v73, v74
    v_max3_u32 v7, v7, v75, v76
    v_max3_u32 v7, v7, v77, v78
    v_max_u32 v7, v7, v79
    v_cmp_eq_u32 vcc, -1, v7
    s_cbranch_vccnz L_poll_8s
L_poll_8e:
    ds_write_b128 v6, v[40:43] offset:0
    ds_write_b128 v6, v[44:47] offset:256
    ds_write_b128 v6, v[48:51] offset:512
    ds_write_b128 v6, v[52:55] offset:768
    ds_write_b128 v6, v[56:59] offset:1024
    ds_write_b128 v6, v[60:63] offset:5184
    ds_write_b128 v6, v[64:67] offset:5440
    ds_write_b128 v6, v[68:71] offset:5696
    ds_write_b128 v6, v[72:75] offset:5952
    ds_write_b128 v6, v[76:79] offset:6208
L_h_nomo:
    v_mul_u32_u24 v4, 144, v1
    v_lshl_add_u32 v4, v3, 5, v4
    v_bfe_u32 v5, v0, 1, 1
    v_lshl_add_u32 v4, v5, 4, v4
    v_add_u32 v4, 90688, v4
    v_mov_b32 v5, 162112
    v_and_b32 v6, 1, v0
    v_cmp_eq_u32 vcc, 0, v6
    s_nop 1
    v_cndmask_b32 v161, v5, v4, vcc
    v_cndmask_b32 v162, v4, v5, vcc
    v_bfe_u32 v164, v0, 1, 1
    v_mul_u32_u24 v164, 0xaaaa, v164
    v_add_u32 v164, 0x4444, v164
    s_mov_b32 s100, s3
    s_lshl_b32 s63, s100, 8
    v_and_b32 v8, 15, v0
    v_lshl_add_u32 v8, v8, 4, s63
    v_lshrrev_b32 v9, 4, v0
    v_mul_u32_u24 v5, 1280, v9
    v_add_u32 v5, v5, v8
    v_mul_u32_u24 v4, 1296, v9
    v_add_u32 v4, v4, v8
    v_add_u32 v4, 82944, v4
    v_lshlrev_b32 v6, 1, v5
    v_add_u32 v6, 99328, v6
    s_lshl_b32 s62, s100, 9
    s_add_u32 s62, s62, 88128
    v_lshl_add_u32 v7, v0, 3, s62
    s_mov_b32 s48, s4
    s_mov_b32 s49, s5
    s_mov_b32 s50, 5120
    s_mov_b32 s51, 0x20000
    buffer_load_dwordx4 v[8:11], v5, s[48:51], 0 offen
    s_mov_b32 s62, 20480
    s_mov_b32 s63, 30720
    s_branch L_poll_9
L_poll_9s:
    s_sleep 8
L_poll_9:
    buffer_load_dwordx4 v[12:15], v5, s[40:43], s62 offen sc1
    buffer_load_dwordx4 v[16:19], v5, s[40:43], s63 offen sc1
    s_sub_u32 s60, s60, 1
    s_cbranch_scc1 L_poll_9t
    s_waitcnt vmcnt(0)
    v_max3_u32 v38, v12, v13, v14
    v_max3_u32 v38, v38, v15, v16
    v_max3_u32 v38, v38, v17, v18
    v_max_u32 v38, v38, v19
    v_cmp_eq_u32 vcc, -1, v38
    s_cbranch_vccnz L_poll_9s
L_poll_9e:
    v_lshlrev_b32 v40, 16, v8
    v_and_b32 v41, 0xffff0000, v8
    v_lshlrev_b32 v42, 16, v9
    v_and_b32 v43, 0xffff0000, v9
    v_lshlrev_b32 v44, 16, v10
    v_and_b32 v45, 0xffff0000, v10
    v_lshlrev_b32 v46, 16, v11
    v_and_b32 v47, 0xffff0000, v11
    v_lshlrev_b32 v48, 16, v12
    v_and_b32 v49, 0xffff0000, v12
    v_lshlrev_b32 v50, 16, v13
    v_and_b32 v51, 0xffff0000, v13
    v_lshlrev_b32 v52, 16, v14
    v_and_b32 v53, 0xffff0000, v14
    v_lshlrev_b32 v54, 16, v15
    v_and_b32 v55, 0xffff0000, v15
    v_lshlrev_b32 v56, 16, v16
    v_and_b32 v57, 0xffff0000, v16
    v_lshlrev_b32 v58, 16, v17
    v_and_b32 v59, 0xffff0000, v17
    v_lshlrev_b32 v60, 16, v18
    v_and_b32 v61, 0xffff0000, v18
    v_lshlrev_b32 v62, 16, v19
    v_and_b32 v63, 0xffff0000, v19
    v_mov_b32 v64, 0
    v_mov_b32 v65, 0
    v_mov_b32 v66, 0
    v_mov_b32 v67, 0
    v_mov_b32 v68, 0
    v_mov_b32 v69, 0
    v_mov_b32 v70, 0
    v_mov_b32 v71, 0
    v_bfe_u32 v5, v0, 2, 2
    v_lshlrev_b32 v5, 8, v5
    v_lshrrev_b32 v8, 4, v0
    v_lshl_add_u32 v5, v8, 6, v5
    v_and_b32 v8, 3, v0
    v_lshl_add_u32 v5, v8, 4, v5
    s_lshl_b32 s56, s100, 10
    s_waitcnt vmcnt(0) lgkmcnt(0)
    v_mov_b32 v8, 162064
    v_mov_b32 v9, 1
    s_mov_b64 exec, 1
    ds_add_u32 v8, v9
    s_mov_b64 exec, -1
    s_branch L_t2gate
L_ffn2:
    s_barrier
L_ffn2b:
    ds_read_b128 v[8:11], v161
    ds_read_b128 v[12:15], v162
    s_cmp_eq_u32 s61, 1
    s_cbranch_scc0 L_f2slow
    s_waitcnt lgkmcnt(1)
    v_smfmac_f32_16x16x64_bf16 v[16:19], v[8:11], v[80:87], v164
    v_smfmac_f32_16x16x64_bf16 v[20:23], v[8:11], v[96:103], v164
    s_waitcnt lgkmcnt(0)
    v_smfmac_f32_16x16x64_bf16 v[16:19], v[12:15], v[88:95], v164
    v_smfmac_f32_16x16x64_bf16 v[20:23], v[12:15], v[104:111], v164
    v_smfmac_f32_16x16x64_bf16 v[24:27], v[8:11], v[112:119], v164
    v_smfmac_f32_16x16x64_bf16 v[28:31], v[8:11], v[128:135], v164
    v_smfmac_f32_16x16x64_bf16 v[24:27], v[12:15], v[120:127], v164
    v_smfmac_f32_16x16x64_bf16 v[28:31], v[12:15], v[136:143], v164
    v_smfmac_f32_16x16x64_bf16 v[32:35], v[8:11], v[144:151], v164
    v_smfmac_f32_16x16x64_bf16 v[32:35], v[12:15], v[152:159], v164
    s_nop 0
    v_pk_add_f32 v[16:17], v[16:17], v[18:19]
    v_cvt_pk_bf16_f32 v40, v16, v17
    v_pk_add_f32 v[20:21], v[20:21], v[22:23]
    v_cvt_pk_bf16_f32 v41, v20, v21
    buffer_store_dwordx2 v[40:41], v160, s[40:43], s57 offen
    v_pk_add_f32 v[24:25], v[24:25], v[26:27]
    v_cvt_pk_bf16_f32 v42, v24, v25
    v_pk_add_f32 v[28:29], v[28:29], v[30:31]
    v_cvt_pk_bf16_f32 v43, v28, v29
    buffer_store_dwordx2 v[42:43], v160, s[40:43], s57 offen offset:128
    v_pk_add_f32 v[32:33], v[32:33], v[34:35]
    v_cvt_pk_bf16_f32 v44, v32, v33
    buffer_store_dword v44, v163, s[40:43], s57 offen offset:256
L_f2done:
    s_barrier
    s_endpgm
L_f2slow:
    s_waitcnt lgkmcnt(1)
    v_smfmac_f32_16x16x64_bf16 v[16:19], v[8:11], v[80:87], v164
    v_smfmac_f32_16x16x64_bf16 v[20:23], v[8:11], v[96:103], v164
    s_waitcnt lgkmcnt(0)
    v_smfmac_f32_16x16x64_bf16 v[16:19], v[12:15], v[88:95], v164
    v_smfmac_f32_16x16x64_bf16 v[20:23], v[12:15], v[104:111], v164
    v_smfmac_f32_16x16x64_bf16 v[24:27], v[8:11], v[112:119], v164
    v_smfmac_f32_16x16x64_bf16 v[28:31], v[8:11], v[128:135], v164
    v_smfmac_f32_16x16x64_bf16 v[24:27], v[12:15], v[120:127], v164
    v_smfmac_f32_16x16x64_bf16 v[28:31], v[12:15], v[136:143], v164
    v_smfmac_f32_16x16x64_bf16 v[32:35], v[8:11], v[144:151], v164
    v_smfmac_f32_16x16x64_bf16 v[32:35], v[12:15], v[152:159], v164
    s_nop 0
    v_pk_add_f32 v[16:17], v[16:17], v[18:19]
    v_cvt_pk_bf16_f32 v40, v16, v17
    v_pk_add_f32 v[20:21], v[20:21], v[22:23]
    v_cvt_pk_bf16_f32 v41, v20, v21
    buffer_store_dwordx2 v[40:41], v160, s[40:43], s57 offen sc1
    v_pk_add_f32 v[24:25], v[24:25], v[26:27]
    v_cvt_pk_bf16_f32 v42, v24, v25
    v_pk_add_f32 v[28:29], v[28:29], v[30:31]
    v_cvt_pk_bf16_f32 v43, v28, v29
    buffer_store_dwordx2 v[42:43], v160, s[40:43], s57 offen offset:128 sc1
    v_pk_add_f32 v[32:33], v[32:33], v[34:35]
    v_cvt_pk_bf16_f32 v44, v32, v33
    buffer_store_dword v44, v163, s[40:43], s57 offen offset:256 sc1
    s_branch L_f2done
L_poll_3t:
    s_mov_b32 s60, 0
    s_waitcnt vmcnt(0)
    s_branch L_poll_3e
L_poll_8t:
    s_mov_b32 s60, 0
    s_waitcnt vmcnt(0)
    s_branch L_poll_8e
L_poll_9t:
    s_mov_b32 s60, 0
    s_waitcnt vmcnt(0)
    s_branch L_poll_9e
L_poll_102t:
    s_mov_b32 s60, 0
    s_waitcnt vmcnt(0)
    s_branch L_poll_102e
L_pfast:
    buffer_store_dword v12, v108, s[40:43], s101 offen
    buffer_store_dword v12, v110, s[40:43], s101 offen
    s_branch L_pdone
L_poll_104t:
    s_mov_b32 s60, 0
    s_waitcnt vmcnt(0)
    s_branch L_poll_104e
L_poll_106t:
    s_mov_b32 s60, 0
    s_waitcnt vmcnt(0)
    s_branch L_poll_106e
L_poll_109t:
    s_mov_b32 s60, 0
    s_waitcnt vmcnt(0)
    s_branch L_poll_109e
L_poll_111t:
    s_mov_b32 s60, 0
    s_waitcnt vmcnt(0)
    s_branch L_poll_111e
L_poll_115t:
    s_mov_b32 s60, 0
    s_waitcnt vmcnt(0)
    s_branch L_poll_115e
L_poll_117t:
    s_mov_b32 s60, 0
    s_waitcnt vmcnt(0)
    s_branch L_poll_117e
L_ycs:
    buffer_store_dwordx4 v[24:27], v22, s[40:43], 0 offen offset:0 sc1
    buffer_store_dwordx4 v[24:27], v22, s[40:43], 0 offen offset:1024 sc1
    buffer_store_dwordx4 v[24:27], v22, s[40:43], 0 offen offset:2048 sc1
    buffer_store_dwordx4 v[24:27], v22, s[40:43], 0 offen offset:3072 sc1
    buffer_store_dwordx4 v[24:27], v23, s[40:43], 0 offen offset:0 sc1
    s_branch L_ycd
L_poll_118t:
    s_mov_b32 s60, 0
    s_waitcnt vmcnt(0)
    s_branch L_poll_118e
L_poll_123t:
    s_mov_b32 s60, 0
    s_waitcnt vmcnt(0)
    s_branch L_poll_123e
L_poll_125t:
    s_mov_b32 s60, 0
    s_waitcnt vmcnt(0)
    s_branch L_poll_125e
L_ygt:
    s_waitcnt vmcnt(0)
    v_mfma_f32_16x16x32_bf16 v[112:115], v[104:107], v[88:91], 0
    v_mfma_f32_16x16x32_bf16 v[112:115], v[104:107], v[92:95], v[112:115]
    v_mfma_f32_16x16x32_bf16 v[112:115], v[104:107], v[96:99], v[112:115]
    v_mfma_f32_16x16x32_bf16 v[112:115], v[104:107], v[100:103], v[112:115]
    s_nop 7
    s_branch L_ygd
L_pto:
    s_mov_b32 s60, 0
    s_waitcnt vmcnt(0)
    s_branch L_pgot0
L_poll_129t:
    s_mov_b32 s60, 0
    s_waitcnt vmcnt(0)
    s_branch L_poll_129e
L_end:
    s_endpgm
L_codeend:
.section .rodata,"a"
.p2align 6
.amdhsa_kernel adaLN_cond__sliding_block_cached__dense_activation_gelu__decode_kernel
  .amdhsa_next_free_vgpr 168
  .amdhsa_next_free_sgpr 102
  .amdhsa_accum_offset 168
  .amdhsa_group_segment_fixed_size 0
  .amdhsa_kernarg_size 120
  .amdhsa_user_sgpr_count 2
  .amdhsa_user_sgpr_kernarg_segment_ptr 1
  .amdhsa_system_sgpr_workgroup_id_x 1
.end_amdhsa_kernel
```

```asm
; @launch grid=(256,1,1) block=(768,1,1) lds=162176
.amdgcn_target "amdgcn-amd-amdhsa--gfx950"
.text
.globl adaLN_cond__sliding_block_cached__dense_activation_gelu__decode_kernel
.p2align 8
.type adaLN_cond__sliding_block_cached__dense_activation_gelu__decode_kernel,@function
adaLN_cond__sliding_block_cached__dense_activation_gelu__decode_kernel:
    s_load_dwordx16 s[4:19], s[0:1], 0
    s_load_dwordx8 s[20:27], s[0:1], 64
    s_load_dwordx4 s[28:31], s[0:1], 96
    s_load_dwordx2 s[32:33], s[0:1], 112
    s_cmp_ge_u32 s2, 256
    s_cbranch_scc1 L_end
    v_lshrrev_b32 v1, 6, v0
    v_mul_u32_u24 v2, 36, v0
    v_readfirstlane_b32 s3, v1
    v_and_b32 v0, 63, v0
    s_and_b32 s34, s2, 7
    s_lshr_b32 s35, s2, 3
    s_cmp_lg_u32 s35, 21
    s_cbranch_scc1 L_nopf
    s_getpc_b64 s[48:49]
L_pc:
    v_min_u32 v2, L_codeend-L_pc-4, v2
    v_mov_b32 v3, s49
    v_add_co_u32 v2, vcc, s48, v2
    s_nop 1
    v_addc_co_u32 v3, vcc, 0, v3, vcc
    global_load_dword v152, v[2:3], off
L_nopf:
    s_lshr_b32 s36, s35, 3
    s_lshl2_add_u32 s36, s34, s36
    s_bfe_u32 s37, s35, 0x20001
    s_and_b32 s38, s35, 1
    s_cmp_lt_u32 s35, 27
    s_cselect_b32 s39, 1, 0
    s_cmp_eq_u32 s34, 2
    s_cselect_b32 s39, s39, 0
    s_sub_u32 s62, s34, 3
    s_and_b32 s62, s62, 7
    s_mul_i32 s56, s35, 7
    s_add_u32 s56, s56, s62
    s_cmp_eq_u32 s62, 7
    s_cselect_b32 s56, 255, s56
    s_mov_b32 s60, 1000000
    s_mov_b32 s61, 0
    v_mov_b32 v36, 0
    s_cmp_lt_u32 s3, 4
    s_cbranch_scc1 L_helpers
    s_sub_u32 s3, s3, 4
    s_cmp_ge_u32 s35, 22
    s_cselect_b32 s59, 1, 0
    s_add_u32 s62, s3, s59
    s_cmp_ge_u32 s62, 6
    s_cselect_b32 s62, s39, 0
    s_cmp_eq_u32 s62, 1
    s_cbranch_scc1 L_proxy
    s_cmp_eq_u32 s59, 1
    s_cselect_b32 s100, 0, 81920
    s_lshl_b32 s62, s3, 13
    s_add_u32 s100, s100, s62
    s_and_b32 s62, s39, s59
    s_cselect_b32 s100, -1, s100
    s_mov_b32 s101, 0
L_stream:
    s_lshl_b32 s62, s37, 5
    s_add_u32 s62, s62, s36
    s_lshl_b32 s63, s62, 21
    s_lshl_b32 s96, s38, 18
    s_add_u32 s63, s63, s96
    s_add_u32 s63, s63, 1572864
    v_lshlrev_b32 v1, 4, v0
    s_lshl_b32 s96, s3, 12
    v_add_u32 v1, s96, v1
    s_mov_b32 s97, 0
    s_mov_b32 s50, 262144
    s_mov_b32 s51, 0x20000
    s_waitcnt lgkmcnt(0)
    s_add_u32 s48, s6, s63
    s_addc_u32 s49, s7, 0
    s_cmp_lt_u32 s56, 40
    s_cbranch_scc0 L_nob0
    s_barrier
L_nob0:
    buffer_load_dwordx4 v[40:43], v1, s[48:51], s97 offen offset:0 nt
    buffer_load_dwordx4 v[44:47], v1, s[48:51], s97 offen offset:1024 nt
    s_cmp_lt_u32 s56, 40
    s_cbranch_scc1 L_stream2
    s_barrier
    s_branch L_stream2
L_helpers:
    s_cmp_lg_u32 s3, 0
    s_cbranch_scc1 L_noinit
    v_lshlrev_b32 v1, 2, v0
    v_add_u32 v1, 161920, v1
    ds_write_b32 v1, v36
L_noinit:
    s_waitcnt lgkmcnt(0)
    s_mov_b32 s40, s32
    s_mov_b32 s41, s33
    s_mov_b32 s42, 589824
    s_mov_b32 s43, 0x20000
    s_mov_b32 s44, s30
    s_mov_b32 s45, s31
    s_mov_b32 s46, 256
    s_mov_b32 s47, 0x20000
    s_lshl2_add_u32 s62, s35, s3
    s_cmp_eq_u32 s62, 87
    s_cbranch_scc1 L_touch
L_notp:
    s_mul_i32 s101, s3, 20480
    s_mov_b32 s96, s56
    s_cmp_lt_u32 s56, 40
    s_cbranch_scc0 L_nothalf
    s_cmp_lt_u32 s3, 2
    s_cbranch_scc1 L_unit
    s_add_u32 s62, s56, 20
    s_cmp_eq_u32 s3, 2
    s_cbranch_scc1 L_job
    s_barrier
    s_branch L_service
L_nothalf:
    s_cmp_lt_u32 s56, 144
    s_cbranch_scc1 L_unit
    s_sub_u32 s62, s56, 144
    s_cmp_lt_u32 s62, 10
    s_cbranch_scc0 L_nojob
    s_cmp_lt_u32 s3, 2
    s_cbranch_scc0 L_nojob
    s_mul_i32 s63, s3, 10
    s_add_u32 s62, s62, s63
L_job:
    s_cmp_lt_u32 s62, 59
    s_cbranch_scc0 L_end
    s_mov_b32 s100, s101
    s_lshl_b32 s101, s62, 9
    s_add_u32 s101, s101, 172032
    s_cmp_lt_u32 s62, 27
    s_cselect_b32 s63, 0, 27
    s_cselect_b32 s3, 7, 6
    s_cmp_lt_u32 s62, 54
    s_cselect_b32 s63, s63, 32
    s_cselect_b32 s3, s3, 5
    s_sub_u32 s35, s62, s63
    s_mov_b32 s34, 2
    s_lshr_b32 s36, s35, 3
    s_add_u32 s36, s36, 8
    s_bfe_u32 s37, s35, 0x20001
    s_and_b32 s38, s35, 1
    s_mov_b32 s59, 0
    s_branch L_stream
L_nojob:
    s_barrier
    s_cmp_ge_u32 s35, 22
    s_cbranch_scc1 L_h_t1
    s_cmp_eq_u32 s39, 1
    s_cbranch_scc1 L_h_role
    s_cmp_lt_u32 s96, 144
    s_cbranch_scc1 L_unit
    s_cmp_eq_u32 s3, 3
    s_cbranch_scc1 L_service
    s_endpgm
L_unit:
    v_lshrrev_b32 v3, 4, v0
    v_and_b32 v4, 3, v0
    v_bfe_u32 v7, v0, 2, 2
    s_mov_b32 s14, s3
    s_mov_b32 s15, 3
    s_sub_u32 s62, s96, 40
    s_cmp_lt_u32 s62, 64
    s_cbranch_scc1 L_u_q
    s_mov_b32 s100, 1
    s_sub_u32 s96, s96, 84
    s_cmp_lt_u32 s56, 40
    s_cbranch_scc0 L_u_full
    s_mov_b32 s100, 0
    s_lshr_b32 s96, s56, 1
    s_and_b32 s62, s56, 1
    s_lshl1_add_u32 s14, s62, s14
    s_mov_b32 s15, 1
L_u_full:
    s_mov_b32 s97, 0
    s_mov_b32 s99, 7680
    s_mov_b32 s48, s26
    s_mov_b32 s49, s27
    s_mov_b32 s50, 4915200
    s_mov_b32 s51, 0x20000
    s_mov_b32 s52, s24
    s_mov_b32 s53, s25
    s_mov_b32 s54, 5120
    s_mov_b32 s55, 0x20000
    v_and_b32 v6, 15, v0
    v_lshlrev_b32 v6, 4, v6
    v_mul_u32_u24 v5, 1280, v3
    v_add_u32 v5, v5, v6
    s_mul_i32 s62, s14, 320
    buffer_load_dwordx4 v[8:11], v5, s[52:55], s62 offen
    s_mov_b32 exec_lo, 0x000f000f
    s_mov_b32 exec_hi, 0x000f000f
    buffer_load_dwordx4 v[12:15], v5, s[52:55], s62 offen offset:256
    s_mov_b64 exec, -1
    s_lshl_b32 s98, s96, 7
    s_mul_i32 s13, s96, 0x199a
    s_lshr_b32 s13, s13, 16
    s_cmp_lg_u32 s13, 1
    s_cbranch_scc1 L_u_go
    s_mov_b32 s52, s4
    s_mov_b32 s53, s5
    s_mov_b32 s54, 5120
    s_mov_b32 s55, 0x20000
    v_mul_u32_u24 v5, 1280, v4
    v_lshlrev_b32 v64, 5, v7
    v_lshl_add_u32 v64, v3, 3, v64
    v_add_u32 v64, v64, v5
    v_lshrrev_b32 v6, 2, v0
    v_lshl_add_u32 v6, v6, 4, v5
    s_sub_u32 s62, s98, 1280
    buffer_load_dwordx4 v[16:19], v6, s[52:55], 0 offen offset:0
    buffer_load_dwordx4 v[20:23], v6, s[52:55], 0 offen offset:256
    buffer_load_dwordx4 v[24:27], v6, s[52:55], 0 offen offset:512
    buffer_load_dwordx4 v[28:31], v6, s[52:55], 0 offen offset:768
    buffer_load_dwordx4 v[32:35], v6, s[52:55], 0 offen offset:1024
    buffer_load_dwordx2 v[66:67], v64, s[52:55], s62 offen
    s_branch L_u_go
L_u_q:
    s_mov_b32 s97, 1
    s_mov_b32 s99, 8192
    s_mov_b32 s100, 2
    s_lshl_b32 s98, s62, 7
    s_mov_b32 s48, s10
    s_mov_b32 s49, s11
    s_mov_b32 s50, 5242880
    s_mov_b32 s51, 0x20000
L_u_go:
    v_lshrrev_b32 v6, 3, v0
    v_mul_lo_u32 v1, v6, s99
    v_and_b32 v6, 2, v6
    v_xor_b32 v6, v6, v0
    v_and_b32 v6, 7, v6
    v_lshl_add_u32 v1, v6, 4, v1
    v_add_u32 v1, s98, v1
    v_xor_b32 v2, 64, v1
    s_mul_i32 s63, s99, s14
    s_mul_i32 s63, s63, 160
    s_lshl_b32 s59, s99, 3
    s_mov_b32 m0, s101
    s_mov_b32 s62, 10
L_dma_1:
    buffer_load_dwordx4 v1, s[48:51], s63 offen nt lds
    s_add_u32 m0, m0, 1024
    s_add_u32 s63, s63, s59
    s_cmp_eq_u32 s100, 0
    s_cbranch_scc1 L_dma_1n0
    s_waitcnt vmcnt(5)
    s_cmp_eq_u32 s100, 2
    s_cbranch_scc1 L_dma_1n0
    s_waitcnt vmcnt(5)
L_dma_1n0:
    buffer_load_dwordx4 v2, s[48:51], s63 offen nt lds
    s_add_u32 m0, m0, 1024
    s_add_u32 s63, s63, s59
    s_cmp_eq_u32 s100, 0
    s_cbranch_scc1 L_dma_1n1
    s_waitcnt vmcnt(5)
    s_cmp_eq_u32 s100, 2
    s_cbranch_scc1 L_dma_1n1
    s_waitcnt vmcnt(5)
L_dma_1n1:
    s_sub_u32 s62, s62, 1
    s_cmp_lg_u32 s62, 0
    s_cbranch_scc1 L_dma_1
    v_min_u32 v65, 15, v0
    v_and_b32 v6, 1, v65
    v_mul_u32_u24 v6, 126, v6
    v_lshl_add_u32 v65, v65, 1, v6
    v_mov_b32 v68, 0
    s_cmp_lt_u32 s56, 40
    s_cbranch_scc1 L_u_nofl
    buffer_load_dword v68, v65, s[44:47], 0 offen sc1
L_u_nofl:
    s_cmp_lt_u32 s56, 144
    s_cbranch_scc0 L_u_nob
    s_barrier
L_u_nob:
    v_lshrrev_b32 v60, 4, v0
    v_lshlrev_b32 v60, 10, v60
    v_bfe_u32 v6, v0, 2, 2
    v_lshl_add_u32 v60, v6, 7, v60
    v_and_b32 v6, 3, v0
    v_lshl_add_u32 v60, v6, 3, v60
    v_bfe_u32 v6, v0, 3, 2
    v_lshl_add_u32 v60, v6, 5, v60
    v_xor_b32 v61, 32, v60
    v_xor_b32 v62, 64, v60
    v_xor_b32 v63, 0x60, v60
    v_add_u32 v60, s101, v60
    v_add_u32 v61, s101, v61
    v_add_u32 v62, s101, v62
    v_add_u32 v63, s101, v63
    v_mov_b32 v56, 1.0
    v_mov_b32 v57, 1.0
    v_mov_b32 v58, 1.0
    v_mov_b32 v59, 1.0
    s_mov_b32 s58, 0
    v_lshl_add_u32 v69, v7, 2, v3
    v_lshl_add_u32 v69, v4, 4, v69
    v_and_b32 v64, 15, v0
    v_lshlrev_b32 v64, 3, v64
    s_cmp_eq_u32 s97, 1
    s_cbranch_scc1 L_u_q2
    v_mul_u32_u24 v6, 1280, v3
    v_add_u32 v64, v64, v6
    s_mul_i32 s63, s13, 3840
    s_add_u32 s57, s98, s63
    s_add_u32 s57, s57, 10240
    s_cmp_lt_u32 s56, 40
    s_cbranch_scc0 L_u_nat
    v_lshrrev_b32 v69, 1, v3
    v_lshlrev_b32 v69, 3, v69
    v_lshl_add_u32 v69, v7, 4, v69
    v_lshl_add_u32 v69, v4, 1, v69
    v_and_b32 v6, 1, v3
    v_add_u32 v69, v69, v6
    s_lshr_b32 s62, s56, 1
    s_lshl_b32 s57, s62, 11
    s_cmp_ge_u32 s62, 10
    s_cselect_b32 s62, -19968, 0
    s_add_u32 s57, s57, s62
    s_and_b32 s62, s56, 1
    s_lshl_b32 s62, s62, 8
    s_add_u32 s57, s57, s62
    v_lshrrev_b32 v64, 5, v0
    v_lshlrev_b32 v64, 10, v64
    v_and_b32 v6, 31, v0
    v_lshl_add_u32 v64, v6, 3, v64
L_u_nat:
    s_cmp_eq_u32 s13, 4
    s_cselect_b32 s58, 1.0, 0
    s_cmp_eq_u32 s13, 1
    s_cselect_b32 s58, 1.0, s58
    s_cselect_b32 s56, 1, 0
    s_cmp_eq_u32 s14, 0
    s_cselect_b32 s58, s58, 0
    s_waitcnt vmcnt(20)
    s_mov_b32 s62, 0xbfb8aa3b
    v_lshlrev_b32 v40, 16, v8
    v_and_b32 v41, 0xffff0000, v8
    v_lshlrev_b32 v42, 16, v9
    v_and_b32 v43, 0xffff0000, v9
    v_lshlrev_b32 v44, 16, v10
    v_and_b32 v45, 0xffff0000, v10
    v_lshlrev_b32 v46, 16, v11
    v_and_b32 v47, 0xffff0000, v11
    v_mul_f32 v48, s62, v40
    v_mul_f32 v49, s62, v41
    v_mul_f32 v50, s62, v42
    v_mul_f32 v51, s62, v43
    v_mul_f32 v52, s62, v44
    v_mul_f32 v53, s62, v45
    v_mul_f32 v54, s62, v46
    v_mul_f32 v55, s62, v47
    v_exp_f32 v48, v48
    v_exp_f32 v49, v49
    v_exp_f32 v50, v50
    v_exp_f32 v51, v51
    v_exp_f32 v52, v52
    v_exp_f32 v53, v53
    v_exp_f32 v54, v54
    v_exp_f32 v55, v55
    v_add_f32 v48, 1.0, v48
    v_add_f32 v49, 1.0, v49
    v_add_f32 v50, 1.0, v50
    v_add_f32 v51, 1.0, v51
    v_add_f32 v52, 1.0, v52
    v_add_f32 v53, 1.0, v53
    v_add_f32 v54, 1.0, v54
    v_add_f32 v55, 1.0, v55
    v_rcp_f32 v48, v48
    v_rcp_f32 v49, v49
    v_rcp_f32 v50, v50
    v_rcp_f32 v51, v51
    v_rcp_f32 v52, v52
    v_rcp_f32 v53, v53
    v_rcp_f32 v54, v54
    v_rcp_f32 v55, v55
    v_mul_f32 v40, v40, v48
    v_mul_f32 v41, v41, v49
    v_mul_f32 v42, v42, v50
    v_mul_f32 v43, v43, v51
    v_mul_f32 v44, v44, v52
    v_mul_f32 v45, v45, v53
    v_mul_f32 v46, v46, v54
    v_mul_f32 v47, v47, v55
    v_cvt_pk_bf16_f32 v8, v40, v41
    v_cvt_pk_bf16_f32 v9, v42, v43
    v_cvt_pk_bf16_f32 v10, v44, v45
    v_cvt_pk_bf16_f32 v11, v46, v47
    v_lshlrev_b32 v40, 16, v12
    v_and_b32 v41, 0xffff0000, v12
    v_lshlrev_b32 v42, 16, v13
    v_and_b32 v43, 0xffff0000, v13
    v_lshlrev_b32 v44, 16, v14
    v_and_b32 v45, 0xffff0000, v14
    v_lshlrev_b32 v46, 16, v15
    v_and_b32 v47, 0xffff0000, v15
    v_mul_f32 v48, s62, v40
    v_mul_f32 v49, s62, v41
    v_mul_f32 v50, s62, v42
    v_mul_f32 v51, s62, v43
    v_mul_f32 v52, s62, v44
    v_mul_f32 v53, s62, v45
    v_mul_f32 v54, s62, v46
    v_mul_f32 v55, s62, v47
    v_exp_f32 v48, v48
    v_exp_f32 v49, v49
    v_exp_f32 v50, v50
    v_exp_f32 v51, v51
    v_exp_f32 v52, v52
    v_exp_f32 v53, v53
    v_exp_f32 v54, v54
    v_exp_f32 v55, v55
    v_add_f32 v48, 1.0, v48
    v_add_f32 v49, 1.0, v49
    v_add_f32 v50, 1.0, v50
    v_add_f32 v51, 1.0, v51
    v_add_f32 v52, 1.0, v52
    v_add_f32 v53, 1.0, v53
    v_add_f32 v54, 1.0, v54
    v_add_f32 v55, 1.0, v55
    v_rcp_f32 v48, v48
    v_rcp_f32 v49, v49
    v_rcp_f32 v50, v50
    v_rcp_f32 v51, v51
    v_rcp_f32 v52, v52
    v_rcp_f32 v53, v53
    v_rcp_f32 v54, v54
    v_rcp_f32 v55, v55
    v_mul_f32 v40, v40, v48
    v_mul_f32 v41, v41, v49
    v_mul_f32 v42, v42, v50
    v_mul_f32 v43, v43, v51
    v_mul_f32 v44, v44, v52
    v_mul_f32 v45, v45, v53
    v_mul_f32 v46, v46, v54
    v_mul_f32 v47, v47, v55
    v_cvt_pk_bf16_f32 v12, v40, v41
    v_cvt_pk_bf16_f32 v13, v42, v43
    v_cvt_pk_bf16_f32 v14, v44, v45
    v_cvt_pk_bf16_f32 v15, v46, v47
    s_mul_i32 s62, s3, 1344
    s_add_u32 s62, s62, 151552
    v_mul_u32_u24 v5, 336, v3
    v_and_b32 v6, 15, v0
    v_lshl_add_u32 v5, v6, 4, v5
    v_add_u32 v5, s62, v5
    ds_write_b128 v5, v[8:11]
    s_mov_b32 exec_lo, 0x000f000f
    s_mov_b32 exec_hi, 0x000f000f
    ds_write_b128 v5, v[12:15] offset:256
    s_mov_b64 exec, -1
    v_mul_u32_u24 v5, 336, v4
    v_lshl_add_u32 v5, v3, 4, v5
    v_add_u32 v5, s62, v5
    s_mov_b32 s59, 0x3e800000
    s_cmp_eq_u32 s56, 0
    s_cbranch_scc1 L_u_nost
    v_mov_b32 v40, 0
    v_mov_b32 v41, 0
    s_mov_b32 s62, 0x3f803f80
    v_dot2c_f32_bf16 v40, s62, v16
    v_dot2c_f32_bf16 v41, v16, v16
    v_dot2c_f32_bf16 v40, s62, v17
    v_dot2c_f32_bf16 v41, v17, v17
    v_dot2c_f32_bf16 v40, s62, v18
    v_dot2c_f32_bf16 v41, v18, v18
    v_dot2c_f32_bf16 v40, s62, v19
    v_dot2c_f32_bf16 v41, v19, v19
    v_dot2c_f32_bf16 v40, s62, v20
    v_dot2c_f32_bf16 v41, v20, v20
    v_dot2c_f32_bf16 v40, s62, v21
    v_dot2c_f32_bf16 v41, v21, v21
    v_dot2c_f32_bf16 v40, s62, v22
    v_dot2c_f32_bf16 v41, v22, v22
    v_dot2c_f32_bf16 v40, s62, v23
    v_dot2c_f32_bf16 v41, v23, v23
    v_dot2c_f32_bf16 v40, s62, v24
    v_dot2c_f32_bf16 v41, v24, v24
    v_dot2c_f32_bf16 v40, s62, v25
    v_dot2c_f32_bf16 v41, v25, v25
    v_dot2c_f32_bf16 v40, s62, v26
    v_dot2c_f32_bf16 v41, v26, v26
    v_dot2c_f32_bf16 v40, s62, v27
    v_dot2c_f32_bf16 v41, v27, v27
    v_dot2c_f32_bf16 v40, s62, v28
    v_dot2c_f32_bf16 v41, v28, v28
    v_dot2c_f32_bf16 v40, s62, v29
    v_dot2c_f32_bf16 v41, v29, v29
    v_dot2c_f32_bf16 v40, s62, v30
    v_dot2c_f32_bf16 v41, v30, v30
    v_dot2c_f32_bf16 v40, s62, v31
    v_dot2c_f32_bf16 v41, v31, v31
    v_dot2c_f32_bf16 v40, s62, v32
    v_dot2c_f32_bf16 v41, v32, v32
    v_dot2c_f32_bf16 v40, s62, v33
    v_dot2c_f32_bf16 v41, v33, v33
    v_dot2c_f32_bf16 v40, s62, v34
    v_dot2c_f32_bf16 v41, v34, v34
    v_dot2c_f32_bf16 v40, s62, v35
    v_dot2c_f32_bf16 v41, v35, v35
    s_nop 1
    v_add_f32_dpp v40, v40, v40 row_ror:4 row_mask:0xf bank_mask:0xf
    v_add_f32_dpp v41, v41, v41 row_ror:4 row_mask:0xf bank_mask:0xf
    s_nop 0
    v_add_f32_dpp v40, v40, v40 row_ror:8 row_mask:0xf bank_mask:0xf
    v_add_f32_dpp v41, v41, v41 row_ror:8 row_mask:0xf bank_mask:0xf
    v_mov_b32 v42, v40
    v_mov_b32 v43, v41
    s_nop 0
    v_permlane16_swap_b32 v40, v42
    v_permlane16_swap_b32 v41, v43
    v_add_f32 v40, v40, v42
    v_add_f32 v41, v41, v43
    v_mov_b32 v42, v40
    v_mov_b32 v43, v41
    s_nop 0
    v_permlane32_swap_b32 v40, v42
    v_permlane32_swap_b32 v41, v43
    v_add_f32 v40, v40, v42
    v_add_f32 v41, v41, v43
    s_mov_b32 s62, 0x3acccccd
    v_mul_f32 v40, s62, v40
    v_mul_f32 v41, s62, v41
    v_fma_f32 v41, -v40, v40, v41
    v_max_f32 v41, 0, v41
    v_add_f32 v41, 0x3727c5ac, v41
    v_rsq_f32 v41, v41
    v_lshlrev_b32 v56, 16, v66
    v_and_b32 v57, 0xffff0000, v66
    v_lshlrev_b32 v58, 16, v67
    v_and_b32 v59, 0xffff0000, v67
    v_sub_f32 v56, v56, v40
    v_sub_f32 v57, v57, v40
    v_sub_f32 v58, v58, v40
    v_sub_f32 v59, v59, v40
    v_mul_f32 v56, v56, v41
    v_mul_f32 v57, v57, v41
    v_mul_f32 v58, v58, v41
    v_mul_f32 v59, v59, v41
L_u_nost:
    ds_read_b128 v[8:11], v5 offset:0
    ds_read_b128 v[12:15], v5 offset:64
    ds_read_b128 v[16:19], v5 offset:128
    ds_read_b128 v[20:23], v5 offset:192
    ds_read_b128 v[24:27], v5 offset:256
    s_branch L_u_frag
L_u_q2:
    v_lshl_add_u32 v64, v3, 13, v64
    s_add_u32 s57, s98, 40960
    v_lshlrev_b32 v5, 8, v7
    v_lshl_add_u32 v5, v3, 6, v5
    v_lshl_add_u32 v5, v4, 4, v5
    s_mul_i32 s63, s3, 5120
    s_add_u32 s63, s63, 0
    s_add_u32 s12, s63, 4096
    s_mov_b32 s59, 1.0
L_u_frag:
    s_waitcnt vmcnt(0)
    v_cmp_ne_u32 vcc, -1, v68
    s_cbranch_vccz L_u_yok
    s_cmp_eq_u32 s97, 1
    s_cbranch_scc1 L_u_ywait
    buffer_load_dword v68, v65, s[44:47], 0 offen sc1
    s_branch L_u_yok
L_u_ywait:
L_wy_2:
    buffer_load_dword v68, v65, s[44:47], 0 offen sc1
    s_waitcnt vmcnt(0)
    v_cmp_ne_u32 vcc, -1, v68
    s_cbranch_vccz L_wy_2e
    s_sleep 4
    s_sub_u32 s60, s60, 1
    s_cbranch_scc0 L_wy_2
    s_mov_b32 s60, 0
L_wy_2e:
L_u_yok:
    ds_read_b64_tr_b16 v[80:81], v60 offset:0
    ds_read_b64_tr_b16 v[82:83], v60 offset:512
    ds_read_b64_tr_b16 v[84:85], v61 offset:0
    ds_read_b64_tr_b16 v[86:87], v61 offset:512
    ds_read_b64_tr_b16 v[88:89], v62 offset:0
    ds_read_b64_tr_b16 v[90:91], v62 offset:512
    ds_read_b64_tr_b16 v[92:93], v63 offset:0
    ds_read_b64_tr_b16 v[94:95], v63 offset:512
    ds_read_b64_tr_b16 v[96:97], v60 offset:4096
    ds_read_b64_tr_b16 v[98:99], v60 offset:4608
    ds_read_b64_tr_b16 v[100:101], v61 offset:4096
    ds_read_b64_tr_b16 v[102:103], v61 offset:4608
    ds_read_b64_tr_b16 v[104:105], v62 offset:4096
    ds_read_b64_tr_b16 v[106:107], v62 offset:4608
    ds_read_b64_tr_b16 v[108:109], v63 offset:4096
    ds_read_b64_tr_b16 v[110:111], v63 offset:4608
    ds_read_b64_tr_b16 v[112:113], v60 offset:8192
    ds_read_b64_tr_b16 v[114:115], v60 offset:8704
    ds_read_b64_tr_b16 v[116:117], v61 offset:8192
    ds_read_b64_tr_b16 v[118:119], v61 offset:8704
    ds_read_b64_tr_b16 v[120:121], v62 offset:8192
    ds_read_b64_tr_b16 v[122:123], v62 offset:8704
    ds_read_b64_tr_b16 v[124:125], v63 offset:8192
    ds_read_b64_tr_b16 v[126:127], v63 offset:8704
    ds_read_b64_tr_b16 v[128:129], v60 offset:12288
    ds_read_b64_tr_b16 v[130:131], v60 offset:12800
    ds_read_b64_tr_b16 v[132:133], v61 offset:12288
    ds_read_b64_tr_b16 v[134:135], v61 offset:12800
    ds_read_b64_tr_b16 v[136:137], v62 offset:12288
    ds_read_b64_tr_b16 v[138:139], v62 offset:12800
    ds_read_b64_tr_b16 v[140:141], v63 offset:12288
    ds_read_b64_tr_b16 v[142:143], v63 offset:12800
    ds_read_b64_tr_b16 v[144:145], v60 offset:16384
    ds_read_b64_tr_b16 v[146:147], v60 offset:16896
    ds_read_b64_tr_b16 v[148:149], v61 offset:16384
    ds_read_b64_tr_b16 v[150:151], v61 offset:16896
    ds_read_b64_tr_b16 v[152:153], v62 offset:16384
    ds_read_b64_tr_b16 v[154:155], v62 offset:16896
    ds_read_b64_tr_b16 v[156:157], v63 offset:16384
    ds_read_b64_tr_b16 v[158:159], v63 offset:16896
    s_cmp_eq_u32 s97, 0
    s_cbranch_scc1 L_u_mm
    s_branch L_poll_3
L_poll_3s:
    s_sleep 8
L_poll_3:
    buffer_load_dwordx4 v[8:11], v5, s[40:43], s63 offen offset:0 sc1
    buffer_load_dwordx4 v[12:15], v5, s[40:43], s63 offen offset:1024 sc1
    buffer_load_dwordx4 v[16:19], v5, s[40:43], s63 offen offset:2048 sc1
    buffer_load_dwordx4 v[20:23], v5, s[40:43], s63 offen offset:3072 sc1
    buffer_load_dwordx4 v[24:27], v5, s[40:43], s12 offen offset:0 sc1
    s_sub_u32 s60, s60, 1
    s_cbranch_scc1 L_poll_3t
    s_waitcnt vmcnt(0)
    v_max3_u32 v37, v8, v9, v10
    v_max3_u32 v37, v37, v11, v12
    v_max3_u32 v37, v37, v13, v14
    v_max3_u32 v37, v37, v15, v16
    v_max3_u32 v37, v37, v17, v18
    v_max3_u32 v37, v37, v19, v20
    v_max3_u32 v37, v37, v21, v22
    v_max3_u32 v37, v37, v23, v24
    v_max3_u32 v37, v37, v25, v26
    v_max_u32 v37, v37, v27
    v_cmp_eq_u32 vcc, -1, v37
    s_cbranch_vccnz L_poll_3s
L_poll_3e:
L_u_got:
L_u_mm:
    s_waitcnt lgkmcnt(0)
    v_mfma_f32_16x16x32_bf16 v[40:43], v[80:83], v[8:11], 0
    v_mfma_f32_16x16x32_bf16 v[44:47], v[84:87], v[8:11], 0
    v_mfma_f32_16x16x32_bf16 v[48:51], v[88:91], v[8:11], 0
    v_mfma_f32_16x16x32_bf16 v[52:55], v[92:95], v[8:11], 0
    v_mfma_f32_16x16x32_bf16 v[40:43], v[96:99], v[12:15], v[40:43]
    v_mfma_f32_16x16x32_bf16 v[44:47], v[100:103], v[12:15], v[44:47]
    v_mfma_f32_16x16x32_bf16 v[48:51], v[104:107], v[12:15], v[48:51]
    v_mfma_f32_16x16x32_bf16 v[52:55], v[108:111], v[12:15], v[52:55]
    v_mfma_f32_16x16x32_bf16 v[40:43], v[112:115], v[16:19], v[40:43]
    v_mfma_f32_16x16x32_bf16 v[44:47], v[116:119], v[16:19], v[44:47]
    v_mfma_f32_16x16x32_bf16 v[48:51], v[120:123], v[16:19], v[48:51]
    v_mfma_f32_16x16x32_bf16 v[52:55], v[124:127], v[16:19], v[52:55]
    v_mfma_f32_16x16x32_bf16 v[40:43], v[128:131], v[20:23], v[40:43]
    v_mfma_f32_16x16x32_bf16 v[44:47], v[132:135], v[20:23], v[44:47]
    v_mfma_f32_16x16x32_bf16 v[48:51], v[136:139], v[20:23], v[48:51]
    v_mfma_f32_16x16x32_bf16 v[52:55], v[140:143], v[20:23], v[52:55]
    v_mfma_f32_16x16x32_bf16 v[40:43], v[144:147], v[24:27], v[40:43]
    v_mfma_f32_16x16x32_bf16 v[44:47], v[148:151], v[24:27], v[44:47]
    v_mfma_f32_16x16x32_bf16 v[48:51], v[152:155], v[24:27], v[48:51]
    v_mfma_f32_16x16x32_bf16 v[52:55], v[156:159], v[24:27], v[52:55]
    v_lshlrev_b32 v5, 4, v0
    v_add_u32 v5, 147456, v5
    s_lshl_b32 s62, s3, 10
    s_add_u32 s62, s62, 147456
    v_lshl_add_u32 v6, v69, 4, s62
    v_mov_b32 v24, s58
    v_mov_b32 v32, 162056
    v_mov_b32 v33, 1
    v_add_f32_dpp v40, v40, v40 row_ror:8 row_mask:0xf bank_mask:0xf
    v_add_f32_dpp v41, v41, v41 row_ror:8 row_mask:0xf bank_mask:0xf
    v_add_f32_dpp v42, v42, v42 row_ror:8 row_mask:0xf bank_mask:0xf
    v_add_f32_dpp v43, v43, v43 row_ror:8 row_mask:0xf bank_mask:0xf
    v_add_f32_dpp v44, v44, v44 row_ror:8 row_mask:0xf bank_mask:0xf
    v_add_f32_dpp v45, v45, v45 row_ror:8 row_mask:0xf bank_mask:0xf
    v_add_f32_dpp v46, v46, v46 row_ror:8 row_mask:0xf bank_mask:0xf
    v_add_f32_dpp v47, v47, v47 row_ror:8 row_mask:0xf bank_mask:0xf
    v_add_f32_dpp v48, v48, v48 row_ror:8 row_mask:0xf bank_mask:0xf
    v_add_f32_dpp v49, v49, v49 row_ror:8 row_mask:0xf bank_mask:0xf
    v_add_f32_dpp v50, v50, v50 row_ror:8 row_mask:0xf bank_mask:0xf
    v_add_f32_dpp v51, v51, v51 row_ror:8 row_mask:0xf bank_mask:0xf
    v_add_f32_dpp v52, v52, v52 row_ror:8 row_mask:0xf bank_mask:0xf
    v_add_f32_dpp v53, v53, v53 row_ror:8 row_mask:0xf bank_mask:0xf
    v_add_f32_dpp v54, v54, v54 row_ror:8 row_mask:0xf bank_mask:0xf
    v_add_f32_dpp v55, v55, v55 row_ror:8 row_mask:0xf bank_mask:0xf
    v_add_f32_dpp v28, v40, v40 row_ror:4 row_mask:0xf bank_mask:0x1
    v_add_f32_dpp v29, v41, v41 row_ror:4 row_mask:0xf bank_mask:0x1
    v_add_f32_dpp v30, v42, v42 row_ror:4 row_mask:0xf bank_mask:0x1
    v_add_f32_dpp v31, v43, v43 row_ror:4 row_mask:0xf bank_mask:0x1
    v_add_f32_dpp v28, v44, v44 row_ror:4 row_mask:0xf bank_mask:0x2
    v_add_f32_dpp v29, v45, v45 row_ror:4 row_mask:0xf bank_mask:0x2
    v_add_f32_dpp v30, v46, v46 row_ror:4 row_mask:0xf bank_mask:0x2
    v_add_f32_dpp v31, v47, v47 row_ror:4 row_mask:0xf bank_mask:0x2
    v_add_f32_dpp v28, v48, v48 row_ror:4 row_mask:0xf bank_mask:0x4
    v_add_f32_dpp v29, v49, v49 row_ror:4 row_mask:0xf bank_mask:0x4
    v_add_f32_dpp v30, v50, v50 row_ror:4 row_mask:0xf bank_mask:0x4
    v_add_f32_dpp v31, v51, v51 row_ror:4 row_mask:0xf bank_mask:0x4
    v_add_f32_dpp v28, v52, v52 row_ror:4 row_mask:0xf bank_mask:0x8
    v_add_f32_dpp v29, v53, v53 row_ror:4 row_mask:0xf bank_mask:0x8
    v_add_f32_dpp v30, v54, v54 row_ror:4 row_mask:0xf bank_mask:0x8
    v_add_f32_dpp v31, v55, v55 row_ror:4 row_mask:0xf bank_mask:0x8
    v_fma_f32 v28, v28, s59, v24
    v_fma_f32 v29, v29, s59, v24
    v_fma_f32 v30, v30, s59, v24
    v_fma_f32 v31, v31, s59, v24
    v_mul_f32 v28, v28, v56
    v_mul_f32 v29, v29, v57
    v_mul_f32 v30, v30, v58
    v_mul_f32 v31, v31, v59
    ds_write_b128 v6, v[28:31]
    s_mov_b64 exec, 1
    ds_add_rtn_u32 v34, v32, v33
    s_mov_b64 exec, -1
    ds_read_b128 v[8:11], v5
    ds_read_b128 v[12:15], v5 offset:1024
    ds_read_b128 v[16:19], v5 offset:2048
    ds_read_b128 v[20:23], v5 offset:3072
    s_waitcnt lgkmcnt(0)
    v_readfirstlane_b32 s62, v34
    s_nop 0
    s_cmp_eq_u32 s62, s15
    s_cbranch_scc1 L_u_last
    s_cmp_eq_u32 s62, 1
    s_cbranch_scc1 L_service
    s_endpgm
L_u_last:
    v_add_f32 v8, v8, v12
    v_add_f32 v9, v9, v13
    v_add_f32 v10, v10, v14
    v_add_f32 v11, v11, v15
    s_cmp_eq_u32 s15, 1
    s_cbranch_scc1 L_u_two
    v_add_f32 v16, v16, v20
    v_add_f32 v17, v17, v21
    v_add_f32 v18, v18, v22
    v_add_f32 v19, v19, v23
    v_add_f32 v8, v8, v16
    v_add_f32 v9, v9, v17
    v_add_f32 v10, v10, v18
    v_add_f32 v11, v11, v19
L_u_two:
    v_cvt_pk_bf16_f32 v8, v8, v9
    v_cvt_pk_bf16_f32 v9, v10, v11
    s_waitcnt vmcnt(0)
    v_cmp_ne_u32 vcc, -1, v68
    s_cbranch_vccz L_u_st
L_wy_4:
    buffer_load_dword v68, v65, s[44:47], 0 offen sc1
    s_waitcnt vmcnt(0)
    v_cmp_ne_u32 vcc, -1, v68
    s_cbranch_vccz L_wy_4e
    s_sleep 4
    s_sub_u32 s60, s60, 1
    s_cbranch_scc0 L_wy_4
    s_mov_b32 s60, 0
L_wy_4e:
L_u_st:
    buffer_store_dwordx2 v[8:9], v64, s[40:43], s57 offen sc1
    s_endpgm
L_touch:
    s_load_dword s0, s[32:33], 0
    s_load_dword s0, s[30:31], 0
    s_cmp_eq_u32 s39, 1
    s_cbranch_scc1 L_tpr
    s_mov_b32 s62, 16777216
    s_load_dword s0, s[8:9], s62
    s_mov_b32 s62, 83886080
    s_load_dword s0, s[8:9], s62
    s_mov_b32 s62, 150994944
    s_load_dword s0, s[8:9], s62
    s_mov_b32 s62, 218103808
    s_load_dword s0, s[8:9], s62
    s_branch L_tpv
L_tpr:
    s_load_dword s0, s[20:21], 0
    s_mov_b32 s62, 2211836
    s_load_dword s0, s[20:21], s62
    s_load_dword s0, s[16:17], 0
    s_mov_b32 s62, 2211836
    s_load_dword s0, s[16:17], s62
    s_load_dword s0, s[18:19], 0
    s_load_dword s0, s[22:23], 0
    s_load_dword s0, s[28:29], 0
    s_load_dword s0, s[4:5], 0
L_tpv:
    s_lshl_b32 s62, s34, 23
    s_load_dword s0, s[8:9], s62
    s_add_u32 s62, s62, 67108864
    s_load_dword s0, s[8:9], s62
    s_add_u32 s62, s62, 67108864
    s_load_dword s0, s[8:9], s62
    s_add_u32 s62, s62, 67108864
    s_load_dword s0, s[8:9], s62
    s_add_u32 s62, s62, 67108864
    s_branch L_notp
L_stream2:
    s_mov_b32 s12, s100
    s_mov_b32 s13, s101
    s_andn2_b32 s96, s59, s39
    s_cbranch_scc0 L_noua
    s_barrier
L_noua:
    s_mov_b32 s40, s32
    s_mov_b32 s41, s33
    s_mov_b32 s42, 589824
    s_mov_b32 s43, 0x20000
    s_mov_b32 s44, s30
    s_mov_b32 s45, s31
    s_mov_b32 s46, 256
    s_mov_b32 s47, 0x20000
    s_bitcmp1_b32 s3, 0
    s_mov_b32 s57, 0xffffffff
    s_mov_b32 s58, 0x0
    s_mov_b32 s14, 0xffffff
    s_mov_b32 s15, 0x0
L_pm_10:
    s_sub_u32 s96, s56, 104
    s_cmp_lt_u32 s96, 66
    s_cbranch_scc0 L_pm_11
    s_bitcmp1_b32 s3, 0
    s_mov_b32 s57, 0xff00000f
    s_mov_b32 s58, 0x0
    s_mov_b32 s14, 0xffffff
    s_mov_b32 s15, 0x0
L_pm_11:
    s_sub_u32 s96, s56, 144
    s_cmp_lt_u32 s96, 10
    s_cbranch_scc0 L_pm_12
    s_bitcmp1_b32 s3, 0
    s_mov_b32 s57, 0xffffffff
    s_mov_b32 s58, 0xfff
    s_mov_b32 s14, 0xffffff
    s_mov_b32 s15, 0x0
L_pm_12:
    s_cmp_lt_u32 s56, 104
    s_cbranch_scc0 L_pm_13
    s_bitcmp1_b32 s3, 0
    s_mov_b32 s57, 0xf
    s_mov_b32 s58, 0x0
    s_mov_b32 s14, 0xffffff
    s_mov_b32 s15, 0x0
L_pm_13:
    s_sub_u32 s96, s56, 43
    s_and_b32 s96, s96, 0xffffffc7
    s_cmp_eq_u32 s96, 0
    s_cbranch_scc0 L_pm_14
    s_bitcmp1_b32 s3, 0
    s_mov_b32 s57, 0x0
    s_mov_b32 s58, 0x0
    s_mov_b32 s14, 0x0
    s_mov_b32 s15, 0x0
L_pm_14:
    s_cmp_lt_u32 s56, 40
    s_cbranch_scc0 L_pm_15
    s_bitcmp1_b32 s3, 0
    s_mov_b32 s57, 0xffffffff
    s_mov_b32 s58, 0xf
    s_mov_b32 s14, 0xffffff
    s_mov_b32 s15, 0x0
L_pm_15:
    s_cmp_eq_u32 s56, 255
    s_cbranch_scc0 L_pm_16
    s_bitcmp1_b32 s3, 0
    s_mov_b32 s57, 0xffffffff
    s_mov_b32 s58, 0x0
    s_mov_b32 s14, 0x0
    s_mov_b32 s15, 0x0
L_pm_16:
    s_cmp_eq_u32 s39, 1
    s_cbranch_scc0 L_pm_17
    s_bitcmp1_b32 s3, 0
    s_mov_b32 s57, 0xff
    s_mov_b32 s58, 0xff
    s_mov_b32 s14, 0x0
    s_mov_b32 s15, 0x0
L_pm_17:
    s_cmp_lg_u32 s13, 0
    s_cbranch_scc0 L_pm_18
    s_bitcmp1_b32 s3, 0
    s_mov_b32 s57, 0xffffffff
    s_mov_b32 s58, 0x0
    s_mov_b32 s14, 0x0
    s_mov_b32 s15, 0x0
L_pm_18:
    s_and_b32 s96, s39, s59
    s_cbranch_scc0 L_pm_19
    s_bitcmp1_b32 s3, 0
    s_mov_b32 s57, 0x3ff
    s_mov_b32 s58, 0x3ff
    s_mov_b32 s14, 0x0
    s_mov_b32 s15, 0x0
L_pm_19:
    s_add_u32 s52, s8, s63
    s_addc_u32 s53, s9, 0
    s_mov_b32 s54, 262144
    s_mov_b32 s55, 0x20000
    v_and_b32 v2, 15, v0
    v_lshrrev_b32 v3, 1, v2
    v_and_b32 v37, 1, v2
    v_lshlrev_b32 v37, 4, v37
    v_mov_b32 v38, 0xffff
    v_lshlrev_b32 v37, v37, v38
    v_cmp_eq_u32 vcc, 0, v3
    v_mov_b32 v32, 0
    s_nop 0
    v_cndmask_b32 v20, 0, v37, vcc
    v_cmp_eq_u32 vcc, 1, v3
    v_mov_b32 v33, 0
    s_nop 0
    v_cndmask_b32 v21, 0, v37, vcc
    v_cmp_eq_u32 vcc, 2, v3
    v_mov_b32 v34, 0
    s_nop 0
    v_cndmask_b32 v22, 0, v37, vcc
    v_cmp_eq_u32 vcc, 3, v3
    v_mov_b32 v35, 0
    s_nop 0
    v_cndmask_b32 v23, 0, v37, vcc
    v_lshlrev_b32 v2, 4, v2
    s_lshl_b32 s98, s62, 8
    s_add_u32 s98, s98, 40960
    s_bitcmp0_b32 s57, 2
    s_cbranch_scc1 L_sf_20
    s_bitcmp0_b32 s58, 2
    s_cbranch_scc1 L_sf_20
    s_waitcnt vmcnt(1)
L_sf_20:
    buffer_load_dwordx4 v[48:51], v1, s[48:51], s97 offen offset:2048 nt
    s_bitcmp0_b32 s57, 3
    s_cbranch_scc1 L_sf_21
    s_waitcnt vmcnt(2)
    s_bitcmp0_b32 s58, 3
    s_cbranch_scc1 L_sf_21
    s_waitcnt vmcnt(1)
L_sf_21:
    buffer_load_dwordx4 v[52:55], v1, s[48:51], s97 offen offset:3072 nt
    s_add_u32 s97, s97, 32768
    v_add_u32 v1, 4096, v1
    v_and_b32 v1, 0x7fff, v1
    s_waitcnt vmcnt(3)
    s_bitcmp0_b32 s57, 4
    s_cbranch_scc1 L_sf_22
    s_waitcnt vmcnt(2)
    s_bitcmp0_b32 s58, 4
    s_cbranch_scc1 L_sf_22
    s_waitcnt vmcnt(1)
L_sf_22:
    buffer_load_dwordx4 v[56:59], v1, s[48:51], s97 offen offset:0 nt
    s_waitcnt vmcnt(3)
    s_bitcmp0_b32 s57, 5
    s_cbranch_scc1 L_sf_23
    s_waitcnt vmcnt(2)
    s_bitcmp0_b32 s58, 5
    s_cbranch_scc1 L_sf_23
    s_waitcnt vmcnt(1)
L_sf_23:
    buffer_load_dwordx4 v[60:63], v1, s[48:51], s97 offen offset:1024 nt
    s_waitcnt vmcnt(3)
    s_bitcmp0_b32 s57, 6
    s_cbranch_scc1 L_sf_24
    s_waitcnt vmcnt(2)
    s_bitcmp0_b32 s58, 6
    s_cbranch_scc1 L_sf_24
    s_waitcnt vmcnt(1)
L_sf_24:
    buffer_load_dwordx4 v[64:67], v1, s[48:51], s97 offen offset:2048 nt
    s_waitcnt vmcnt(3)
    s_bitcmp0_b32 s57, 7
    s_cbranch_scc1 L_sf_25
    s_waitcnt vmcnt(2)
    s_bitcmp0_b32 s58, 7
    s_cbranch_scc1 L_sf_25
    s_waitcnt vmcnt(1)
L_sf_25:
    buffer_load_dwordx4 v[68:71], v1, s[48:51], s97 offen offset:3072 nt
    s_add_u32 s97, s97, 32768
    v_add_u32 v1, 4096, v1
    v_and_b32 v1, 0x7fff, v1
    s_waitcnt vmcnt(3)
    s_bitcmp0_b32 s57, 8
    s_cbranch_scc1 L_sf_26
    s_waitcnt vmcnt(2)
    s_bitcmp0_b32 s58, 8
    s_cbranch_scc1 L_sf_26
    s_waitcnt vmcnt(1)
L_sf_26:
    buffer_load_dwordx4 v[72:75], v1, s[48:51], s97 offen offset:0 nt
    s_waitcnt vmcnt(3)
    s_bitcmp0_b32 s57, 9
    s_cbranch_scc1 L_sf_27
    s_waitcnt vmcnt(2)
    s_bitcmp0_b32 s58, 9
    s_cbranch_scc1 L_sf_27
    s_waitcnt vmcnt(1)
L_sf_27:
    buffer_load_dwordx4 v[76:79], v1, s[48:51], s97 offen offset:1024 nt
    s_waitcnt vmcnt(3)
    s_bitcmp0_b32 s57, 10
    s_cbranch_scc1 L_sf_28
    s_waitcnt vmcnt(2)
    s_bitcmp0_b32 s58, 10
    s_cbranch_scc1 L_sf_28
    s_waitcnt vmcnt(1)
L_sf_28:
    buffer_load_dwordx4 v[80:83], v1, s[48:51], s97 offen offset:2048 nt
    s_waitcnt vmcnt(3)
    s_bitcmp0_b32 s57, 11
    s_cbranch_scc1 L_sf_29
    s_waitcnt vmcnt(2)
    s_bitcmp0_b32 s58, 11
    s_cbranch_scc1 L_sf_29
    s_waitcnt vmcnt(1)
L_sf_29:
    buffer_load_dwordx4 v[84:87], v1, s[48:51], s97 offen offset:3072 nt
    s_add_u32 s97, s97, 32768
    v_add_u32 v1, 4096, v1
    v_and_b32 v1, 0x7fff, v1
    s_waitcnt vmcnt(3)
    s_bitcmp0_b32 s57, 12
    s_cbranch_scc1 L_sf_30
    s_waitcnt vmcnt(2)
    s_bitcmp0_b32 s58, 12
    s_cbranch_scc1 L_sf_30
    s_waitcnt vmcnt(1)
L_sf_30:
    buffer_load_dwordx4 v[88:91], v1, s[48:51], s97 offen offset:0 nt
    s_waitcnt vmcnt(3)
    s_bitcmp0_b32 s57, 13
    s_cbranch_scc1 L_sf_31
    s_waitcnt vmcnt(2)
    s_bitcmp0_b32 s58, 13
    s_cbranch_scc1 L_sf_31
    s_waitcnt vmcnt(1)
L_sf_31:
    buffer_load_dwordx4 v[92:95], v1, s[48:51], s97 offen offset:1024 nt
    s_waitcnt vmcnt(3)
    s_bitcmp0_b32 s57, 14
    s_cbranch_scc1 L_sf_32
    s_waitcnt vmcnt(2)
    s_bitcmp0_b32 s58, 14
    s_cbranch_scc1 L_sf_32
    s_waitcnt vmcnt(1)
L_sf_32:
    buffer_load_dwordx4 v[96:99], v1, s[48:51], s97 offen offset:2048 nt
    s_waitcnt vmcnt(3)
    s_bitcmp0_b32 s57, 15
    s_cbranch_scc1 L_sf_33
    s_waitcnt vmcnt(2)
    s_bitcmp0_b32 s58, 15
    s_cbranch_scc1 L_sf_33
    s_waitcnt vmcnt(1)
L_sf_33:
    buffer_load_dwordx4 v[100:103], v1, s[48:51], s97 offen offset:3072 nt
    s_add_u32 s97, s97, 32768
    v_add_u32 v1, 4096, v1
    v_and_b32 v1, 0x7fff, v1
    s_waitcnt vmcnt(3)
    s_bitcmp0_b32 s57, 16
    s_cbranch_scc1 L_sf_34
    s_waitcnt vmcnt(2)
    s_bitcmp0_b32 s58, 16
    s_cbranch_scc1 L_sf_34
    s_waitcnt vmcnt(1)
L_sf_34:
    buffer_load_dwordx4 v[104:107], v1, s[48:51], s97 offen offset:0 nt
    s_waitcnt vmcnt(3)
    s_bitcmp0_b32 s57, 17
    s_cbranch_scc1 L_sf_35
    s_waitcnt vmcnt(2)
    s_bitcmp0_b32 s58, 17
    s_cbranch_scc1 L_sf_35
    s_waitcnt vmcnt(1)
L_sf_35:
    buffer_load_dwordx4 v[108:111], v1, s[48:51], s97 offen offset:1024 nt
    s_waitcnt vmcnt(3)
    s_bitcmp0_b32 s57, 18
    s_cbranch_scc1 L_sf_36
    s_waitcnt vmcnt(2)
    s_bitcmp0_b32 s58, 18
    s_cbranch_scc1 L_sf_36
    s_waitcnt vmcnt(1)
L_sf_36:
    buffer_load_dwordx4 v[112:115], v1, s[48:51], s97 offen offset:2048 nt
    s_waitcnt vmcnt(3)
    s_bitcmp0_b32 s57, 19
    s_cbranch_scc1 L_sf_37
    s_waitcnt vmcnt(2)
    s_bitcmp0_b32 s58, 19
    s_cbranch_scc1 L_sf_37
    s_waitcnt vmcnt(1)
L_sf_37:
    buffer_load_dwordx4 v[116:119], v1, s[48:51], s97 offen offset:3072 nt
    s_add_u32 s97, s97, 32768
    v_add_u32 v1, 4096, v1
    v_and_b32 v1, 0x7fff, v1
    s_waitcnt vmcnt(3)
    s_bitcmp0_b32 s57, 20
    s_cbranch_scc1 L_sf_38
    s_waitcnt vmcnt(2)
    s_bitcmp0_b32 s58, 20
    s_cbranch_scc1 L_sf_38
    s_waitcnt vmcnt(1)
L_sf_38:
    buffer_load_dwordx4 v[120:123], v1, s[48:51], s97 offen offset:0 nt
    s_waitcnt vmcnt(3)
    s_bitcmp0_b32 s57, 21
    s_cbranch_scc1 L_sf_39
    s_waitcnt vmcnt(2)
    s_bitcmp0_b32 s58, 21
    s_cbranch_scc1 L_sf_39
    s_waitcnt vmcnt(1)
L_sf_39:
    buffer_load_dwordx4 v[124:127], v1, s[48:51], s97 offen offset:1024 nt
    s_cmp_eq_u32 s12, -1
    s_cbranch_scc1 L_k_nopf
    s_waitcnt vmcnt(3)
    s_bitcmp0_b32 s57, 22
    s_cbranch_scc1 L_sf_40
    s_waitcnt vmcnt(2)
    s_bitcmp0_b32 s58, 22
    s_cbranch_scc1 L_sf_40
    s_waitcnt vmcnt(1)
L_sf_40:
    buffer_load_dwordx4 v[128:131], v1, s[48:51], s97 offen offset:2048 nt
    s_waitcnt vmcnt(3)
    s_bitcmp0_b32 s57, 23
    s_cbranch_scc1 L_sf_41
    s_waitcnt vmcnt(2)
    s_bitcmp0_b32 s58, 23
    s_cbranch_scc1 L_sf_41
    s_waitcnt vmcnt(1)
L_sf_41:
    buffer_load_dwordx4 v[132:135], v1, s[48:51], s97 offen offset:3072 nt
    s_add_u32 s97, s97, 32768
    v_add_u32 v1, 4096, v1
    v_and_b32 v1, 0x7fff, v1
    s_waitcnt vmcnt(3)
    s_bitcmp0_b32 s57, 24
    s_cbranch_scc1 L_sf_42
    s_waitcnt vmcnt(2)
    s_bitcmp0_b32 s58, 24
    s_cbranch_scc1 L_sf_42
    s_waitcnt vmcnt(1)
L_sf_42:
    buffer_load_dwordx4 v[136:139], v1, s[48:51], s97 offen offset:0 nt
    s_waitcnt vmcnt(3)
    s_bitcmp0_b32 s57, 25
    s_cbranch_scc1 L_sf_43
    s_waitcnt vmcnt(2)
    s_bitcmp0_b32 s58, 25
    s_cbranch_scc1 L_sf_43
    s_waitcnt vmcnt(1)
L_sf_43:
    buffer_load_dwordx4 v[140:143], v1, s[48:51], s97 offen offset:1024 nt
    s_waitcnt vmcnt(3)
    s_bitcmp0_b32 s57, 26
    s_cbranch_scc1 L_sf_44
    s_waitcnt vmcnt(2)
    s_bitcmp0_b32 s58, 26
    s_cbranch_scc1 L_sf_44
    s_waitcnt vmcnt(1)
L_sf_44:
    buffer_load_dwordx4 v[144:147], v1, s[48:51], s97 offen offset:2048 nt
    s_waitcnt vmcnt(3)
    s_bitcmp0_b32 s57, 27
    s_cbranch_scc1 L_sf_45
    s_waitcnt vmcnt(2)
    s_bitcmp0_b32 s58, 27
    s_cbranch_scc1 L_sf_45
    s_waitcnt vmcnt(1)
L_sf_45:
    buffer_load_dwordx4 v[148:151], v1, s[48:51], s97 offen offset:3072 nt
    s_add_u32 s97, s97, 32768
    v_add_u32 v1, 4096, v1
    v_and_b32 v1, 0x7fff, v1
    s_waitcnt vmcnt(3)
    s_bitcmp0_b32 s57, 28
    s_cbranch_scc1 L_sf_46
    s_waitcnt vmcnt(2)
    s_bitcmp0_b32 s58, 28
    s_cbranch_scc1 L_sf_46
    s_waitcnt vmcnt(1)
L_sf_46:
    buffer_load_dwordx4 v[152:155], v1, s[48:51], s97 offen offset:0 nt
    s_waitcnt vmcnt(3)
    s_bitcmp0_b32 s57, 29
    s_cbranch_scc1 L_sf_47
    s_waitcnt vmcnt(2)
    s_bitcmp0_b32 s58, 29
    s_cbranch_scc1 L_sf_47
    s_waitcnt vmcnt(1)
L_sf_47:
    buffer_load_dwordx4 v[156:159], v1, s[48:51], s97 offen offset:1024 nt
    s_waitcnt vmcnt(3)
    s_bitcmp0_b32 s57, 30
    s_cbranch_scc1 L_sf_48
    s_waitcnt vmcnt(2)
    s_bitcmp0_b32 s58, 30
    s_cbranch_scc1 L_sf_48
    s_waitcnt vmcnt(1)
L_sf_48:
    buffer_load_dwordx4 v[160:163], v1, s[48:51], s97 offen offset:2048 nt
    v_min_u32 v39, 15, v0
    v_and_b32 v38, 1, v39
    v_mul_u32_u24 v38, 126, v38
    v_lshl_add_u32 v39, v39, 1, v38
    buffer_load_dword v37, v39, s[44:47], 0 offen sc1
    s_waitcnt vmcnt(4)
    s_bitcmp0_b32 s57, 31
    s_cbranch_scc1 L_sf_49
    s_waitcnt vmcnt(3)
    s_bitcmp0_b32 s58, 31
    s_cbranch_scc1 L_sf_49
    s_waitcnt vmcnt(2)
L_sf_49:
    buffer_load_dwordx4 v[164:167], v1, s[48:51], s97 offen offset:3072 nt
    s_mov_b32 s97, 0
    v_add_u32 v1, 4096, v1
    v_and_b32 v1, 0x7fff, v1
    s_waitcnt vmcnt(4)
    s_bitcmp0_b32 s14, 0
    s_cbranch_scc1 L_sf_50
    s_waitcnt vmcnt(3)
    s_bitcmp0_b32 s15, 0
    s_cbranch_scc1 L_sf_50
    s_waitcnt vmcnt(2)
L_sf_50:
    s_add_u32 m0, s12, 0
    s_nop 0
    buffer_load_dwordx4 v1, s[52:55], s97 offen offset:0 nt lds
    s_waitcnt vmcnt(4)
    s_bitcmp0_b32 s14, 1
    s_cbranch_scc1 L_sf_51
    s_waitcnt vmcnt(3)
    s_bitcmp0_b32 s15, 1
    s_cbranch_scc1 L_sf_51
    s_waitcnt vmcnt(1)
L_sf_51:
    buffer_load_dwordx4 v1, s[52:55], s97 offen offset:1024 nt lds
    s_waitcnt vmcnt(4)
    s_bitcmp0_b32 s14, 2
    s_cbranch_scc1 L_sf_52
    s_waitcnt vmcnt(2)
    s_bitcmp0_b32 s15, 2
    s_cbranch_scc1 L_sf_52
    s_waitcnt vmcnt(1)
L_sf_52:
    buffer_load_dwordx4 v1, s[52:55], s97 offen offset:2048 nt lds
    s_waitcnt vmcnt(3)
    s_bitcmp0_b32 s14, 3
    s_cbranch_scc1 L_sf_53
    s_waitcnt vmcnt(2)
    s_bitcmp0_b32 s15, 3
    s_cbranch_scc1 L_sf_53
    s_waitcnt vmcnt(1)
L_sf_53:
    buffer_load_dwordx4 v1, s[52:55], s97 offen offset:3072 nt lds
    s_add_u32 s97, s97, 32768
    v_add_u32 v1, 4096, v1
    v_and_b32 v1, 0x7fff, v1
    v_cmp_eq_u32 vcc, 0, v37
    s_nop 0
    s_or_b32 s96, vcc_lo, vcc_hi
    buffer_load_dwordx4 v[4:7], v2, s[40:43], s98 offen sc1
    s_waitcnt vmcnt(4)
    s_bitcmp0_b32 s14, 4
    s_cbranch_scc1 L_sf_54
    s_waitcnt vmcnt(3)
    s_bitcmp0_b32 s15, 4
    s_cbranch_scc1 L_sf_54
    s_waitcnt vmcnt(2)
L_sf_54:
    s_add_u32 m0, s12, 4096
    s_nop 0
    buffer_load_dwordx4 v1, s[52:55], s97 offen offset:0 nt lds
    s_waitcnt vmcnt(4)
    s_bitcmp0_b32 s14, 5
    s_cbranch_scc1 L_sf_55
    s_waitcnt vmcnt(3)
    s_bitcmp0_b32 s15, 5
    s_cbranch_scc1 L_sf_55
    s_waitcnt vmcnt(2)
L_sf_55:
    buffer_load_dwordx4 v1, s[52:55], s97 offen offset:1024 nt lds
    s_waitcnt vmcnt(4)
    s_bitcmp0_b32 s14, 6
    s_cbranch_scc1 L_sf_56
    s_waitcnt vmcnt(3)
    s_bitcmp0_b32 s15, 6
    s_cbranch_scc1 L_sf_56
    s_waitcnt vmcnt(1)
L_sf_56:
    buffer_load_dwordx4 v1, s[52:55], s97 offen offset:2048 nt lds
    s_waitcnt vmcnt(4)
    s_bitcmp0_b32 s14, 7
    s_cbranch_scc1 L_sf_57
    s_waitcnt vmcnt(2)
    s_bitcmp0_b32 s15, 7
    s_cbranch_scc1 L_sf_57
    s_waitcnt vmcnt(1)
L_sf_57:
    buffer_load_dwordx4 v1, s[52:55], s97 offen offset:3072 nt lds
    s_add_u32 s97, s97, 32768
    v_add_u32 v1, 4096, v1
    v_and_b32 v1, 0x7fff, v1
L_k_join:
    s_waitcnt vmcnt(4)
    v_max3_u32 v38, v4, v5, v6
    v_max_u32 v38, v38, v7
    v_cmp_eq_u32 vcc, -1, v38
    s_cmp_lg_u32 s96, 0
    s_cbranch_scc1 L_qslow
    s_cbranch_vccnz L_qslow2
L_qok:
    v_dot2_f32_bf16 v8, v72, v4, 0
    v_dot2_f32_bf16 v9, v76, v4, 0
    v_dot2_f32_bf16 v10, v80, v4, 0
    v_dot2_f32_bf16 v11, v84, v4, 0
    v_dot2_f32_bf16 v24, v88, v4, 0
    v_dot2_f32_bf16 v25, v92, v4, 0
    v_dot2_f32_bf16 v26, v96, v4, 0
    v_dot2_f32_bf16 v27, v100, v4, 0
    v_dot2_f32_bf16 v8, v73, v5, v8
    v_dot2_f32_bf16 v9, v77, v5, v9
    v_dot2_f32_bf16 v10, v81, v5, v10
    v_dot2_f32_bf16 v11, v85, v5, v11
    v_dot2_f32_bf16 v24, v89, v5, v24
    v_dot2_f32_bf16 v25, v93, v5, v25
    v_dot2_f32_bf16 v26, v97, v5, v26
    v_dot2_f32_bf16 v27, v101, v5, v27
    v_dot2_f32_bf16 v8, v74, v6, v8
    v_dot2_f32_bf16 v9, v78, v6, v9
    v_dot2_f32_bf16 v10, v82, v6, v10
    v_dot2_f32_bf16 v11, v86, v6, v11
    v_dot2_f32_bf16 v24, v90, v6, v24
    v_dot2_f32_bf16 v25, v94, v6, v25
    v_dot2_f32_bf16 v26, v98, v6, v26
    v_dot2_f32_bf16 v27, v102, v6, v27
    v_dot2_f32_bf16 v8, v75, v7, v8
    v_dot2_f32_bf16 v9, v79, v7, v9
    v_dot2_f32_bf16 v10, v83, v7, v10
    v_dot2_f32_bf16 v11, v87, v7, v11
    v_dot2_f32_bf16 v24, v91, v7, v24
    v_dot2_f32_bf16 v25, v95, v7, v25
    v_dot2_f32_bf16 v26, v99, v7, v26
    v_dot2_f32_bf16 v27, v103, v7, v27
    v_add_f32_dpp v8, v8, v8 row_ror:8 row_mask:0xf bank_mask:0x3
    v_add_f32_dpp v10, v10, v10 row_ror:8 row_mask:0xf bank_mask:0x3
    v_add_f32_dpp v24, v24, v24 row_ror:8 row_mask:0xf bank_mask:0x3
    v_add_f32_dpp v26, v26, v26 row_ror:8 row_mask:0xf bank_mask:0x3
    v_add_f32_dpp v8, v9, v9 row_ror:8 row_mask:0xf bank_mask:0xc
    v_add_f32_dpp v10, v11, v11 row_ror:8 row_mask:0xf bank_mask:0xc
    v_add_f32_dpp v24, v25, v25 row_ror:8 row_mask:0xf bank_mask:0xc
    v_add_f32_dpp v26, v27, v27 row_ror:8 row_mask:0xf bank_mask:0xc
    v_add_f32_dpp v14, v8, v8 row_half_mirror row_mask:0xf bank_mask:0x5
    v_add_f32_dpp v15, v24, v24 row_half_mirror row_mask:0xf bank_mask:0x5
    v_add_f32_dpp v14, v10, v10 row_half_mirror row_mask:0xf bank_mask:0xa
    v_add_f32_dpp v15, v26, v26 row_half_mirror row_mask:0xf bank_mask:0xa
    s_nop 0
    v_add_f32_dpp v14, v14, v14 quad_perm:[1,0,3,2] row_mask:0xf bank_mask:0xf
    v_add_f32_dpp v15, v15, v15 quad_perm:[1,0,3,2] row_mask:0xf bank_mask:0xf
    s_nop 0
    v_add_f32_dpp v14, v14, v14 quad_perm:[2,3,0,1] row_mask:0xf bank_mask:0xf
    v_add_f32_dpp v15, v15, v15 quad_perm:[2,3,0,1] row_mask:0xf bank_mask:0xf
    s_waitcnt vmcnt(3)
    s_bitcmp0_b32 s14, 8
    s_cbranch_scc1 L_sf_68
    s_waitcnt vmcnt(2)
    s_bitcmp0_b32 s15, 8
    s_cbranch_scc1 L_sf_68
    s_waitcnt vmcnt(1)
L_sf_68:
    buffer_load_dwordx4 v[72:75], v1, s[52:55], s97 offen offset:0 nt
    v_dot2_f32_bf16 v8, v40, v4, 0
    v_dot2_f32_bf16 v9, v44, v4, 0
    v_dot2_f32_bf16 v10, v48, v4, 0
    v_dot2_f32_bf16 v11, v52, v4, 0
    v_dot2_f32_bf16 v24, v56, v4, 0
    v_dot2_f32_bf16 v25, v60, v4, 0
    v_dot2_f32_bf16 v26, v64, v4, 0
    v_dot2_f32_bf16 v27, v68, v4, 0
    v_dot2_f32_bf16 v28, v104, v4, 0
    v_dot2_f32_bf16 v29, v108, v4, 0
    v_dot2_f32_bf16 v30, v112, v4, 0
    v_dot2_f32_bf16 v31, v116, v4, 0
    v_dot2_f32_bf16 v8, v41, v5, v8
    v_dot2_f32_bf16 v9, v45, v5, v9
    v_dot2_f32_bf16 v10, v49, v5, v10
    v_dot2_f32_bf16 v11, v53, v5, v11
    v_dot2_f32_bf16 v24, v57, v5, v24
    v_dot2_f32_bf16 v25, v61, v5, v25
    v_dot2_f32_bf16 v26, v65, v5, v26
    v_dot2_f32_bf16 v27, v69, v5, v27
    v_dot2_f32_bf16 v28, v105, v5, v28
    v_dot2_f32_bf16 v29, v109, v5, v29
    v_dot2_f32_bf16 v30, v113, v5, v30
    v_dot2_f32_bf16 v31, v117, v5, v31
    v_dot2_f32_bf16 v8, v42, v6, v8
    v_dot2_f32_bf16 v9, v46, v6, v9
    v_dot2_f32_bf16 v10, v50, v6, v10
    v_dot2_f32_bf16 v11, v54, v6, v11
    v_dot2_f32_bf16 v24, v58, v6, v24
    v_dot2_f32_bf16 v25, v62, v6, v25
    v_dot2_f32_bf16 v26, v66, v6, v26
    v_dot2_f32_bf16 v27, v70, v6, v27
    v_dot2_f32_bf16 v28, v106, v6, v28
    v_dot2_f32_bf16 v29, v110, v6, v29
    v_dot2_f32_bf16 v30, v114, v6, v30
    v_dot2_f32_bf16 v31, v118, v6, v31
    v_dot2_f32_bf16 v8, v43, v7, v8
    v_dot2_f32_bf16 v9, v47, v7, v9
    v_dot2_f32_bf16 v10, v51, v7, v10
    v_dot2_f32_bf16 v11, v55, v7, v11
    v_dot2_f32_bf16 v24, v59, v7, v24
    v_dot2_f32_bf16 v25, v63, v7, v25
    v_dot2_f32_bf16 v26, v67, v7, v26
    v_dot2_f32_bf16 v27, v71, v7, v27
    v_dot2_f32_bf16 v28, v107, v7, v28
    v_dot2_f32_bf16 v29, v111, v7, v29
    v_dot2_f32_bf16 v30, v115, v7, v30
    v_dot2_f32_bf16 v31, v119, v7, v31
    v_add_f32_dpp v8, v8, v8 row_ror:8 row_mask:0xf bank_mask:0x3
    v_add_f32_dpp v10, v10, v10 row_ror:8 row_mask:0xf bank_mask:0x3
    v_add_f32_dpp v24, v24, v24 row_ror:8 row_mask:0xf bank_mask:0x3
    v_add_f32_dpp v26, v26, v26 row_ror:8 row_mask:0xf bank_mask:0x3
    v_add_f32_dpp v28, v28, v28 row_ror:8 row_mask:0xf bank_mask:0x3
    v_add_f32_dpp v30, v30, v30 row_ror:8 row_mask:0xf bank_mask:0x3
    v_add_f32_dpp v8, v9, v9 row_ror:8 row_mask:0xf bank_mask:0xc
    v_add_f32_dpp v10, v11, v11 row_ror:8 row_mask:0xf bank_mask:0xc
    v_add_f32_dpp v24, v25, v25 row_ror:8 row_mask:0xf bank_mask:0xc
    v_add_f32_dpp v26, v27, v27 row_ror:8 row_mask:0xf bank_mask:0xc
    v_add_f32_dpp v28, v29, v29 row_ror:8 row_mask:0xf bank_mask:0xc
    v_add_f32_dpp v30, v31, v31 row_ror:8 row_mask:0xf bank_mask:0xc
    v_add_f32_dpp v12, v8, v8 row_half_mirror row_mask:0xf bank_mask:0x5
    v_add_f32_dpp v13, v24, v24 row_half_mirror row_mask:0xf bank_mask:0x5
    v_add_f32_dpp v16, v28, v28 row_half_mirror row_mask:0xf bank_mask:0x5
    v_add_f32_dpp v12, v10, v10 row_half_mirror row_mask:0xf bank_mask:0xa
    v_add_f32_dpp v13, v26, v26 row_half_mirror row_mask:0xf bank_mask:0xa
    v_add_f32_dpp v16, v30, v30 row_half_mirror row_mask:0xf bank_mask:0xa
    v_add_f32_dpp v12, v12, v12 quad_perm:[1,0,3,2] row_mask:0xf bank_mask:0xf
    v_add_f32_dpp v13, v13, v13 quad_perm:[1,0,3,2] row_mask:0xf bank_mask:0xf
    v_add_f32_dpp v16, v16, v16 quad_perm:[1,0,3,2] row_mask:0xf bank_mask:0xf
    v_add_f32_dpp v12, v12, v12 quad_perm:[2,3,0,1] row_mask:0xf bank_mask:0xf
    v_add_f32_dpp v13, v13, v13 quad_perm:[2,3,0,1] row_mask:0xf bank_mask:0xf
    v_add_f32_dpp v16, v16, v16 quad_perm:[2,3,0,1] row_mask:0xf bank_mask:0xf
    s_waitcnt vmcnt(3)
    s_bitcmp0_b32 s14, 9
    s_cbranch_scc1 L_sf_69
    s_waitcnt vmcnt(2)
    s_bitcmp0_b32 s15, 9
    s_cbranch_scc1 L_sf_69
    s_waitcnt vmcnt(1)
L_sf_69:
    buffer_load_dwordx4 v[76:79], v1, s[52:55], s97 offen offset:1024 nt
    v_dot2_f32_bf16 v8, v120, v4, 0
    v_dot2_f32_bf16 v9, v124, v4, 0
    v_dot2_f32_bf16 v10, v128, v4, 0
    v_dot2_f32_bf16 v11, v132, v4, 0
    v_dot2_f32_bf16 v24, v136, v4, 0
    v_dot2_f32_bf16 v25, v140, v4, 0
    v_dot2_f32_bf16 v26, v144, v4, 0
    v_dot2_f32_bf16 v27, v148, v4, 0
    v_dot2_f32_bf16 v8, v121, v5, v8
    v_dot2_f32_bf16 v9, v125, v5, v9
    v_dot2_f32_bf16 v10, v129, v5, v10
    v_dot2_f32_bf16 v11, v133, v5, v11
    v_dot2_f32_bf16 v24, v137, v5, v24
    v_dot2_f32_bf16 v25, v141, v5, v25
    v_dot2_f32_bf16 v26, v145, v5, v26
    v_dot2_f32_bf16 v27, v149, v5, v27
    v_dot2_f32_bf16 v8, v122, v6, v8
    v_dot2_f32_bf16 v9, v126, v6, v9
    v_dot2_f32_bf16 v10, v130, v6, v10
    v_dot2_f32_bf16 v11, v134, v6, v11
    v_dot2_f32_bf16 v24, v138, v6, v24
    v_dot2_f32_bf16 v25, v142, v6, v25
    v_dot2_f32_bf16 v26, v146, v6, v26
    v_dot2_f32_bf16 v27, v150, v6, v27
    v_dot2_f32_bf16 v8, v123, v7, v8
    v_dot2_f32_bf16 v9, v127, v7, v9
    v_dot2_f32_bf16 v10, v131, v7, v10
    v_dot2_f32_bf16 v11, v135, v7, v11
    v_dot2_f32_bf16 v24, v139, v7, v24
    v_dot2_f32_bf16 v25, v143, v7, v25
    v_dot2_f32_bf16 v26, v147, v7, v26
    v_dot2_f32_bf16 v27, v151, v7, v27
    v_add_f32_dpp v8, v8, v8 row_ror:8 row_mask:0xf bank_mask:0x3
    v_add_f32_dpp v10, v10, v10 row_ror:8 row_mask:0xf bank_mask:0x3
    v_add_f32_dpp v24, v24, v24 row_ror:8 row_mask:0xf bank_mask:0x3
    v_add_f32_dpp v26, v26, v26 row_ror:8 row_mask:0xf bank_mask:0x3
    v_add_f32_dpp v8, v9, v9 row_ror:8 row_mask:0xf bank_mask:0xc
    v_add_f32_dpp v10, v11, v11 row_ror:8 row_mask:0xf bank_mask:0xc
    v_add_f32_dpp v24, v25, v25 row_ror:8 row_mask:0xf bank_mask:0xc
    v_add_f32_dpp v26, v27, v27 row_ror:8 row_mask:0xf bank_mask:0xc
    v_add_f32_dpp v17, v8, v8 row_half_mirror row_mask:0xf bank_mask:0x5
    v_add_f32_dpp v18, v24, v24 row_half_mirror row_mask:0xf bank_mask:0x5
    v_add_f32_dpp v17, v10, v10 row_half_mirror row_mask:0xf bank_mask:0xa
    v_add_f32_dpp v18, v26, v26 row_half_mirror row_mask:0xf bank_mask:0xa
    s_nop 0
    v_add_f32_dpp v17, v17, v17 quad_perm:[1,0,3,2] row_mask:0xf bank_mask:0xf
    v_add_f32_dpp v18, v18, v18 quad_perm:[1,0,3,2] row_mask:0xf bank_mask:0xf
    s_nop 0
    v_add_f32_dpp v17, v17, v17 quad_perm:[2,3,0,1] row_mask:0xf bank_mask:0xf
    v_add_f32_dpp v18, v18, v18 quad_perm:[2,3,0,1] row_mask:0xf bank_mask:0xf
    s_waitcnt vmcnt(3)
    s_bitcmp0_b32 s14, 10
    s_cbranch_scc1 L_sf_70
    s_waitcnt vmcnt(2)
    s_bitcmp0_b32 s15, 10
    s_cbranch_scc1 L_sf_70
    s_waitcnt vmcnt(1)
L_sf_70:
    buffer_load_dwordx4 v[80:83], v1, s[52:55], s97 offen offset:2048 nt
    s_waitcnt vmcnt(3)
    s_bitcmp0_b32 s14, 11
    s_cbranch_scc1 L_sf_71
    s_waitcnt vmcnt(2)
    s_bitcmp0_b32 s15, 11
    s_cbranch_scc1 L_sf_71
    s_waitcnt vmcnt(1)
L_sf_71:
    buffer_load_dwordx4 v[84:87], v1, s[52:55], s97 offen offset:3072 nt
    s_add_u32 s97, s97, 32768
    v_add_u32 v1, 4096, v1
    v_and_b32 v1, 0x7fff, v1
    s_cmp_eq_u32 s12, -1
    s_cbranch_scc1 L_nopfrd
    v_lshl_add_u32 v38, v0, 4, s12
    ds_read_b128 v[40:43], v38 offset:0
    ds_read_b128 v[44:47], v38 offset:1024
    ds_read_b128 v[48:51], v38 offset:2048
    ds_read_b128 v[52:55], v38 offset:3072
    ds_read_b128 v[56:59], v38 offset:4096
    ds_read_b128 v[60:63], v38 offset:5120
    ds_read_b128 v[64:67], v38 offset:6144
    ds_read_b128 v[68:71], v38 offset:7168
L_nopfrd:
    v_dot2_f32_bf16 v8, v152, v4, 0
    v_dot2_f32_bf16 v9, v156, v4, 0
    v_dot2_f32_bf16 v10, v160, v4, 0
    v_dot2_f32_bf16 v11, v164, v4, 0
    v_dot2_f32_bf16 v8, v153, v5, v8
    v_dot2_f32_bf16 v9, v157, v5, v9
    v_dot2_f32_bf16 v10, v161, v5, v10
    v_dot2_f32_bf16 v11, v165, v5, v11
    v_dot2_f32_bf16 v8, v154, v6, v8
    v_dot2_f32_bf16 v9, v158, v6, v9
    v_dot2_f32_bf16 v10, v162, v6, v10
    v_dot2_f32_bf16 v11, v166, v6, v11
    v_dot2_f32_bf16 v8, v155, v7, v8
    v_dot2_f32_bf16 v9, v159, v7, v9
    v_dot2_f32_bf16 v10, v163, v7, v10
    v_dot2_f32_bf16 v11, v167, v7, v11
    v_add_f32_dpp v8, v8, v8 row_ror:8 row_mask:0xf bank_mask:0x3
    s_nop 0
    v_add_f32_dpp v10, v10, v10 row_ror:8 row_mask:0xf bank_mask:0x3
    v_add_f32_dpp v8, v9, v9 row_ror:8 row_mask:0xf bank_mask:0xc
    v_add_f32_dpp v10, v11, v11 row_ror:8 row_mask:0xf bank_mask:0xc
    s_nop 0
    v_add_f32_dpp v19, v8, v8 row_half_mirror row_mask:0xf bank_mask:0x5
    v_add_f32_dpp v19, v10, v10 row_half_mirror row_mask:0xf bank_mask:0xa
    s_nop 1
    v_add_f32_dpp v19, v19, v19 quad_perm:[1,0,3,2] row_mask:0xf bank_mask:0xf
    s_nop 1
    v_add_f32_dpp v19, v19, v19 quad_perm:[2,3,0,1] row_mask:0xf bank_mask:0xf
    v_max3_f32 v3, v12, v13, v14
    v_max3_f32 v8, v15, v16, v17
    v_max3_f32 v3, v3, v18, v19
    v_max_f32 v3, v3, v8
    s_nop 1
    v_max_f32_dpp v3, v3, v3 row_ror:4 row_mask:0xf bank_mask:0xf
    s_nop 1
    v_max_f32_dpp v3, v3, v3 row_ror:8 row_mask:0xf bank_mask:0xf
    v_mov_b32 v8, v3
    s_nop 1
    v_permlane16_swap_b32 v3, v8
    v_max_f32 v3, v3, v8
    v_mov_b32 v8, v3
    s_nop 1
    v_permlane32_swap_b32 v3, v8
    v_max_f32 v3, v3, v8
    s_mov_b32 s96, 0x3e0293ee
    v_mul_f32 v8, s96, v3
    v_fma_f32 v12, v12, s96, -v8
    v_fma_f32 v13, v13, s96, -v8
    v_fma_f32 v14, v14, s96, -v8
    v_fma_f32 v15, v15, s96, -v8
    v_fma_f32 v16, v16, s96, -v8
    v_fma_f32 v17, v17, s96, -v8
    v_fma_f32 v18, v18, s96, -v8
    v_fma_f32 v19, v19, s96, -v8
    v_exp_f32 v12, v12
    v_exp_f32 v13, v13
    v_exp_f32 v14, v14
    v_exp_f32 v15, v15
    v_exp_f32 v16, v16
    v_exp_f32 v17, v17
    v_exp_f32 v18, v18
    v_exp_f32 v19, v19
    v_add_f32 v9, v12, v13
    v_add_f32 v10, v14, v15
    v_add_f32 v11, v16, v17
    v_add_f32 v3, v18, v19
    v_add_f32 v9, v9, v10
    v_add_f32 v3, v3, v11
    v_add_f32 v9, v9, v3
    v_cvt_pk_bf16_f32 v12, v12, v12
    v_cvt_pk_bf16_f32 v13, v13, v13
    v_cvt_pk_bf16_f32 v14, v14, v14
    v_cvt_pk_bf16_f32 v15, v15, v15
    v_cvt_pk_bf16_f32 v16, v16, v16
    v_cvt_pk_bf16_f32 v17, v17, v17
    v_cvt_pk_bf16_f32 v18, v18, v18
    v_cvt_pk_bf16_f32 v19, v19, v19
    v_add_f32_dpp v9, v9, v9 row_ror:4 row_mask:0xf bank_mask:0xf
    s_nop 1
    v_add_f32_dpp v9, v9, v9 row_ror:8 row_mask:0xf bank_mask:0xf
    v_mov_b32 v10, v9
    s_nop 1
    v_permlane16_swap_b32 v9, v10
    v_add_f32 v9, v9, v10
    v_mov_b32 v10, v9
    s_nop 1
    v_permlane32_swap_b32 v9, v10
    v_add_f32 v9, v9, v10
    s_mov_b64 exec, 1
    s_cmp_lg_u32 s13, 0
    s_cbranch_scc1 L_mljob
    s_lshl_b32 s96, s3, 3
    s_add_u32 s96, s96, 161920
    v_mov_b32 v10, s96
    v_mov_b32 v11, 162068
    v_mov_b32 v3, 1
    ds_write_b64 v10, v[8:9]
    ds_add_u32 v11, v3
L_mldone:
    s_mov_b64 exec, -1
    v_lshrrev_b32 v2, 1, v2
    v_and_b32_dpp v24, v14, v20 row_newbcast:0 row_mask:0xf bank_mask:0xf
    v_and_b32_dpp v25, v14, v21 row_newbcast:0 row_mask:0xf bank_mask:0xf
    v_and_b32_dpp v26, v14, v22 row_newbcast:0 row_mask:0xf bank_mask:0xf
    v_and_b32_dpp v27, v14, v23 row_newbcast:0 row_mask:0xf bank_mask:0xf
    s_waitcnt vmcnt(3)
    s_bitcmp0_b32 s14, 12
    s_cbranch_scc1 L_sf_72
    s_waitcnt vmcnt(2)
    s_bitcmp0_b32 s15, 12
    s_cbranch_scc1 L_sf_72
    s_waitcnt vmcnt(1)
L_sf_72:
    buffer_load_dwordx4 v[88:91], v1, s[52:55], s97 offen offset:0 nt
    v_mfma_f32_16x16x32_bf16 v[32:35], v[24:27], v[72:75], v[32:35]
    s_cmp_eq_u32 s12, -1
    s_cbranch_scc1 L_nopfpv8
    s_waitcnt lgkmcnt(0)
    v_and_b32_dpp v24, v12, v20 row_newbcast:0 row_mask:0xf bank_mask:0xf
    v_and_b32_dpp v25, v12, v21 row_newbcast:0 row_mask:0xf bank_mask:0xf
    v_and_b32_dpp v26, v12, v22 row_newbcast:0 row_mask:0xf bank_mask:0xf
    v_and_b32_dpp v27, v12, v23 row_newbcast:0 row_mask:0xf bank_mask:0xf
    s_nop 1
    v_mfma_f32_16x16x32_bf16 v[32:35], v[24:27], v[40:43], v[32:35]
    v_and_b32_dpp v28, v12, v20 row_newbcast:8 row_mask:0xf bank_mask:0xf
    v_and_b32_dpp v29, v12, v21 row_newbcast:8 row_mask:0xf bank_mask:0xf
    v_and_b32_dpp v30, v12, v22 row_newbcast:8 row_mask:0xf bank_mask:0xf
    v_and_b32_dpp v31, v12, v23 row_newbcast:8 row_mask:0xf bank_mask:0xf
    s_nop 1
    v_mfma_f32_16x16x32_bf16 v[32:35], v[28:31], v[44:47], v[32:35]
    v_and_b32_dpp v24, v12, v20 row_newbcast:4 row_mask:0xf bank_mask:0xf
    v_and_b32_dpp v25, v12, v21 row_newbcast:4 row_mask:0xf bank_mask:0xf
    v_and_b32_dpp v26, v12, v22 row_newbcast:4 row_mask:0xf bank_mask:0xf
    v_and_b32_dpp v27, v12, v23 row_newbcast:4 row_mask:0xf bank_mask:0xf
    s_nop 1
    v_mfma_f32_16x16x32_bf16 v[32:35], v[24:27], v[48:51], v[32:35]
    v_and_b32_dpp v28, v12, v20 row_newbcast:12 row_mask:0xf bank_mask:0xf
    v_and_b32_dpp v29, v12, v21 row_newbcast:12 row_mask:0xf bank_mask:0xf
    v_and_b32_dpp v30, v12, v22 row_newbcast:12 row_mask:0xf bank_mask:0xf
    v_and_b32_dpp v31, v12, v23 row_newbcast:12 row_mask:0xf bank_mask:0xf
    s_nop 1
    v_mfma_f32_16x16x32_bf16 v[32:35], v[28:31], v[52:55], v[32:35]
L_nopfpv8:
    v_and_b32_dpp v28, v14, v20 row_newbcast:8 row_mask:0xf bank_mask:0xf
    v_and_b32_dpp v29, v14, v21 row_newbcast:8 row_mask:0xf bank_mask:0xf
    v_and_b32_dpp v30, v14, v22 row_newbcast:8 row_mask:0xf bank_mask:0xf
    v_and_b32_dpp v31, v14, v23 row_newbcast:8 row_mask:0xf bank_mask:0xf
    s_waitcnt vmcnt(3)
    s_bitcmp0_b32 s14, 13
    s_cbranch_scc1 L_sf_73
    s_waitcnt vmcnt(2)
    s_bitcmp0_b32 s15, 13
    s_cbranch_scc1 L_sf_73
    s_waitcnt vmcnt(1)
L_sf_73:
    buffer_load_dwordx4 v[92:95], v1, s[52:55], s97 offen offset:1024 nt
    v_mfma_f32_16x16x32_bf16 v[32:35], v[28:31], v[76:79], v[32:35]
    s_cmp_eq_u32 s12, -1
    s_cbranch_scc1 L_nopfpv9
    s_waitcnt lgkmcnt(0)
    v_and_b32_dpp v24, v13, v20 row_newbcast:0 row_mask:0xf bank_mask:0xf
    v_and_b32_dpp v25, v13, v21 row_newbcast:0 row_mask:0xf bank_mask:0xf
    v_and_b32_dpp v26, v13, v22 row_newbcast:0 row_mask:0xf bank_mask:0xf
    v_and_b32_dpp v27, v13, v23 row_newbcast:0 row_mask:0xf bank_mask:0xf
    s_nop 1
    v_mfma_f32_16x16x32_bf16 v[32:35], v[24:27], v[56:59], v[32:35]
    v_and_b32_dpp v28, v13, v20 row_newbcast:8 row_mask:0xf bank_mask:0xf
    v_and_b32_dpp v29, v13, v21 row_newbcast:8 row_mask:0xf bank_mask:0xf
    v_and_b32_dpp v30, v13, v22 row_newbcast:8 row_mask:0xf bank_mask:0xf
    v_and_b32_dpp v31, v13, v23 row_newbcast:8 row_mask:0xf bank_mask:0xf
    s_nop 1
    v_mfma_f32_16x16x32_bf16 v[32:35], v[28:31], v[60:63], v[32:35]
    v_and_b32_dpp v24, v13, v20 row_newbcast:4 row_mask:0xf bank_mask:0xf
    v_and_b32_dpp v25, v13, v21 row_newbcast:4 row_mask:0xf bank_mask:0xf
    v_and_b32_dpp v26, v13, v22 row_newbcast:4 row_mask:0xf bank_mask:0xf
    v_and_b32_dpp v27, v13, v23 row_newbcast:4 row_mask:0xf bank_mask:0xf
    s_nop 1
    v_mfma_f32_16x16x32_bf16 v[32:35], v[24:27], v[64:67], v[32:35]
    v_and_b32_dpp v28, v13, v20 row_newbcast:12 row_mask:0xf bank_mask:0xf
    v_and_b32_dpp v29, v13, v21 row_newbcast:12 row_mask:0xf bank_mask:0xf
    v_and_b32_dpp v30, v13, v22 row_newbcast:12 row_mask:0xf bank_mask:0xf
    v_and_b32_dpp v31, v13, v23 row_newbcast:12 row_mask:0xf bank_mask:0xf
    s_nop 1
    v_mfma_f32_16x16x32_bf16 v[32:35], v[28:31], v[68:71], v[32:35]
L_nopfpv9:
    v_and_b32_dpp v24, v14, v20 row_newbcast:4 row_mask:0xf bank_mask:0xf
    v_and_b32_dpp v25, v14, v21 row_newbcast:4 row_mask:0xf bank_mask:0xf
    v_and_b32_dpp v26, v14, v22 row_newbcast:4 row_mask:0xf bank_mask:0xf
    v_and_b32_dpp v27, v14, v23 row_newbcast:4 row_mask:0xf bank_mask:0xf
    s_waitcnt vmcnt(3)
    s_bitcmp0_b32 s14, 14
    s_cbranch_scc1 L_sf_74
    s_waitcnt vmcnt(2)
    s_bitcmp0_b32 s15, 14
    s_cbranch_scc1 L_sf_74
    s_waitcnt vmcnt(1)
L_sf_74:
    buffer_load_dwordx4 v[96:99], v1, s[52:55], s97 offen offset:2048 nt
    v_mfma_f32_16x16x32_bf16 v[32:35], v[24:27], v[80:83], v[32:35]
    v_and_b32_dpp v28, v14, v20 row_newbcast:12 row_mask:0xf bank_mask:0xf
    v_and_b32_dpp v29, v14, v21 row_newbcast:12 row_mask:0xf bank_mask:0xf
    v_and_b32_dpp v30, v14, v22 row_newbcast:12 row_mask:0xf bank_mask:0xf
    v_and_b32_dpp v31, v14, v23 row_newbcast:12 row_mask:0xf bank_mask:0xf
    s_waitcnt vmcnt(3)
    s_bitcmp0_b32 s14, 15
    s_cbranch_scc1 L_sf_75
    s_waitcnt vmcnt(2)
    s_bitcmp0_b32 s15, 15
    s_cbranch_scc1 L_sf_75
    s_waitcnt vmcnt(1)
L_sf_75:
    buffer_load_dwordx4 v[100:103], v1, s[52:55], s97 offen offset:3072 nt
    s_add_u32 s97, s97, 32768
    v_add_u32 v1, 4096, v1
    v_and_b32 v1, 0x7fff, v1
    v_mfma_f32_16x16x32_bf16 v[32:35], v[28:31], v[84:87], v[32:35]
    v_and_b32_dpp v24, v15, v20 row_newbcast:0 row_mask:0xf bank_mask:0xf
    v_and_b32_dpp v25, v15, v21 row_newbcast:0 row_mask:0xf bank_mask:0xf
    v_and_b32_dpp v26, v15, v22 row_newbcast:0 row_mask:0xf bank_mask:0xf
    v_and_b32_dpp v27, v15, v23 row_newbcast:0 row_mask:0xf bank_mask:0xf
    s_waitcnt vmcnt(3)
    s_bitcmp0_b32 s14, 16
    s_cbranch_scc1 L_sf_76
    s_waitcnt vmcnt(2)
    s_bitcmp0_b32 s15, 16
    s_cbranch_scc1 L_sf_76
    s_waitcnt vmcnt(1)
L_sf_76:
    buffer_load_dwordx4 v[104:107], v1, s[52:55], s97 offen offset:0 nt
    v_mfma_f32_16x16x32_bf16 v[32:35], v[24:27], v[88:91], v[32:35]
    v_and_b32_dpp v28, v15, v20 row_newbcast:8 row_mask:0xf bank_mask:0xf
    v_and_b32_dpp v29, v15, v21 row_newbcast:8 row_mask:0xf bank_mask:0xf
    v_and_b32_dpp v30, v15, v22 row_newbcast:8 row_mask:0xf bank_mask:0xf
    v_and_b32_dpp v31, v15, v23 row_newbcast:8 row_mask:0xf bank_mask:0xf
    s_waitcnt vmcnt(3)
    s_bitcmp0_b32 s14, 17
    s_cbranch_scc1 L_sf_77
    s_waitcnt vmcnt(2)
    s_bitcmp0_b32 s15, 17
    s_cbranch_scc1 L_sf_77
    s_waitcnt vmcnt(1)
L_sf_77:
    buffer_load_dwordx4 v[108:111], v1, s[52:55], s97 offen offset:1024 nt
    v_mfma_f32_16x16x32_bf16 v[32:35], v[28:31], v[92:95], v[32:35]
    v_and_b32_dpp v24, v15, v20 row_newbcast:4 row_mask:0xf bank_mask:0xf
    v_and_b32_dpp v25, v15, v21 row_newbcast:4 row_mask:0xf bank_mask:0xf
    v_and_b32_dpp v26, v15, v22 row_newbcast:4 row_mask:0xf bank_mask:0xf
    v_and_b32_dpp v27, v15, v23 row_newbcast:4 row_mask:0xf bank_mask:0xf
    s_waitcnt vmcnt(3)
    s_bitcmp0_b32 s14, 18
    s_cbranch_scc1 L_sf_78
    s_waitcnt vmcnt(2)
    s_bitcmp0_b32 s15, 18
    s_cbranch_scc1 L_sf_78
    s_waitcnt vmcnt(1)
L_sf_78:
    buffer_load_dwordx4 v[112:115], v1, s[52:55], s97 offen offset:2048 nt
    v_mfma_f32_16x16x32_bf16 v[32:35], v[24:27], v[96:99], v[32:35]
    v_and_b32_dpp v28, v15, v20 row_newbcast:12 row_mask:0xf bank_mask:0xf
    v_and_b32_dpp v29, v15, v21 row_newbcast:12 row_mask:0xf bank_mask:0xf
    v_and_b32_dpp v30, v15, v22 row_newbcast:12 row_mask:0xf bank_mask:0xf
    v_and_b32_dpp v31, v15, v23 row_newbcast:12 row_mask:0xf bank_mask:0xf
    s_waitcnt vmcnt(3)
    s_bitcmp0_b32 s14, 19
    s_cbranch_scc1 L_sf_79
    s_waitcnt vmcnt(2)
    s_bitcmp0_b32 s15, 19
    s_cbranch_scc1 L_sf_79
    s_waitcnt vmcnt(1)
L_sf_79:
    buffer_load_dwordx4 v[116:119], v1, s[52:55], s97 offen offset:3072 nt
    s_add_u32 s97, s97, 32768
    v_add_u32 v1, 4096, v1
    v_and_b32 v1, 0x7fff, v1
    v_mfma_f32_16x16x32_bf16 v[32:35], v[28:31], v[100:103], v[32:35]
    v_and_b32_dpp v24, v16, v20 row_newbcast:0 row_mask:0xf bank_mask:0xf
    v_and_b32_dpp v25, v16, v21 row_newbcast:0 row_mask:0xf bank_mask:0xf
    v_and_b32_dpp v26, v16, v22 row_newbcast:0 row_mask:0xf bank_mask:0xf
    v_and_b32_dpp v27, v16, v23 row_newbcast:0 row_mask:0xf bank_mask:0xf
    s_waitcnt vmcnt(3)
    s_bitcmp0_b32 s14, 20
    s_cbranch_scc1 L_sf_80
    s_waitcnt vmcnt(2)
    s_bitcmp0_b32 s15, 20
    s_cbranch_scc1 L_sf_80
    s_waitcnt vmcnt(1)
L_sf_80:
    buffer_load_dwordx4 v[120:123], v1, s[52:55], s97 offen offset:0 nt
    v_mfma_f32_16x16x32_bf16 v[32:35], v[24:27], v[104:107], v[32:35]
    v_and_b32_dpp v28, v16, v20 row_newbcast:8 row_mask:0xf bank_mask:0xf
    v_and_b32_dpp v29, v16, v21 row_newbcast:8 row_mask:0xf bank_mask:0xf
    v_and_b32_dpp v30, v16, v22 row_newbcast:8 row_mask:0xf bank_mask:0xf
    v_and_b32_dpp v31, v16, v23 row_newbcast:8 row_mask:0xf bank_mask:0xf
    s_waitcnt vmcnt(3)
    s_bitcmp0_b32 s14, 21
    s_cbranch_scc1 L_sf_81
    s_waitcnt vmcnt(2)
    s_bitcmp0_b32 s15, 21
    s_cbranch_scc1 L_sf_81
    s_waitcnt vmcnt(1)
L_sf_81:
    buffer_load_dwordx4 v[124:127], v1, s[52:55], s97 offen offset:1024 nt
    v_mfma_f32_16x16x32_bf16 v[32:35], v[28:31], v[108:111], v[32:35]
    v_and_b32_dpp v24, v16, v20 row_newbcast:4 row_mask:0xf bank_mask:0xf
    v_and_b32_dpp v25, v16, v21 row_newbcast:4 row_mask:0xf bank_mask:0xf
    v_and_b32_dpp v26, v16, v22 row_newbcast:4 row_mask:0xf bank_mask:0xf
    v_and_b32_dpp v27, v16, v23 row_newbcast:4 row_mask:0xf bank_mask:0xf
    s_waitcnt vmcnt(3)
    s_bitcmp0_b32 s14, 22
    s_cbranch_scc1 L_sf_82
    s_waitcnt vmcnt(2)
    s_bitcmp0_b32 s15, 22
    s_cbranch_scc1 L_sf_82
    s_waitcnt vmcnt(1)
L_sf_82:
    buffer_load_dwordx4 v[128:131], v1, s[52:55], s97 offen offset:2048 nt
    v_mfma_f32_16x16x32_bf16 v[32:35], v[24:27], v[112:115], v[32:35]
    v_and_b32_dpp v28, v16, v20 row_newbcast:12 row_mask:0xf bank_mask:0xf
    v_and_b32_dpp v29, v16, v21 row_newbcast:12 row_mask:0xf bank_mask:0xf
    v_and_b32_dpp v30, v16, v22 row_newbcast:12 row_mask:0xf bank_mask:0xf
    v_and_b32_dpp v31, v16, v23 row_newbcast:12 row_mask:0xf bank_mask:0xf
    s_waitcnt vmcnt(3)
    s_bitcmp0_b32 s14, 23
    s_cbranch_scc1 L_sf_83
    s_waitcnt vmcnt(2)
    s_bitcmp0_b32 s15, 23
    s_cbranch_scc1 L_sf_83
    s_waitcnt vmcnt(1)
L_sf_83:
    buffer_load_dwordx4 v[132:135], v1, s[52:55], s97 offen offset:3072 nt
    s_add_u32 s97, s97, 32768
    v_add_u32 v1, 4096, v1
    v_and_b32 v1, 0x7fff, v1
    v_mfma_f32_16x16x32_bf16 v[32:35], v[28:31], v[116:119], v[32:35]
    v_and_b32_dpp v24, v17, v20 row_newbcast:0 row_mask:0xf bank_mask:0xf
    v_and_b32_dpp v25, v17, v21 row_newbcast:0 row_mask:0xf bank_mask:0xf
    v_and_b32_dpp v26, v17, v22 row_newbcast:0 row_mask:0xf bank_mask:0xf
    v_and_b32_dpp v27, v17, v23 row_newbcast:0 row_mask:0xf bank_mask:0xf
    s_waitcnt vmcnt(3)
    s_bitcmp0_b32 s14, 24
    s_cbranch_scc1 L_sf_84
    s_waitcnt vmcnt(2)
    s_bitcmp0_b32 s15, 24
    s_cbranch_scc1 L_sf_84
    s_waitcnt vmcnt(1)
L_sf_84:
    buffer_load_dwordx4 v[136:139], v1, s[52:55], s97 offen offset:0 nt
    v_mfma_f32_16x16x32_bf16 v[32:35], v[24:27], v[120:123], v[32:35]
    s_or_b32 s96, s59, 0
    s_cbranch_scc0 L_nofrag_85
    v_mov_b32 v104, 162060
L_lw_86:
    ds_read_b32 v105, v104
    s_waitcnt lgkmcnt(0)
    v_cmp_gt_u32 vcc, 4, v105
    s_cbranch_vccz L_lw_86e
    s_sleep 2
    s_sub_u32 s60, s60, 1
    s_cbranch_scc0 L_lw_86
    s_mov_b32 s60, 0
L_lw_86e:
    s_cmp_eq_u32 s59, 0
    s_cbranch_scc1 L_nofrag_85
    v_bfe_u32 v104, v0, 2, 1
    v_bfe_u32 v110, v0, 4, 1
    v_lshl_add_u32 v104, v110, 2, v104
    v_and_b32 v110, 8, v0
    v_add_u32 v104, v104, v110
    v_lshrrev_b32 v110, 5, v0
    v_lshl_add_u32 v104, v110, 4, v104
    v_bfe_u32 v111, v0, 0, 1
    v_mul_u32_u24 v111, 0xaaaa, v111
    v_add_u32 v111, 0x4444, v111
    v_mov_b32 v112, 0
    v_mov_b32 v113, 0
    v_mov_b32 v114, 0
    v_mov_b32 v115, 0
    v_mov_b32 v116, 0
    v_mov_b32 v117, 0
    v_mov_b32 v118, 0
    v_mov_b32 v119, 0
    v_lshlrev_b32 v104, 7, v104
    v_and_b32 v110, 3, v0
    v_lshl_add_u32 v104, v110, 3, v104
    v_lshrrev_b32 v109, 4, v0
    v_and_b32 v110, 1, v0
    s_lshr_b32 s63, s3, 1
    s_and_b32 s62, s3, 1
    s_lshl_b32 s96, s63, 14
    s_lshl_b32 s100, s62, 6
    s_add_u32 s100, s100, 81920
    s_add_u32 s96, s96, s100
    v_add_u32 v104, s96, v104
    ds_read_b64_tr_b16 v[72:73], v104 offset:0
    ds_read_b64_tr_b16 v[74:75], v104 offset:256
    ds_read_b64_tr_b16 v[76:77], v104 offset:4096
    ds_read_b64_tr_b16 v[78:79], v104 offset:4352
    ds_read_b64_tr_b16 v[80:81], v104 offset:32
    ds_read_b64_tr_b16 v[82:83], v104 offset:288
    ds_read_b64_tr_b16 v[84:85], v104 offset:4128
    ds_read_b64_tr_b16 v[86:87], v104 offset:4384
    ds_read_b64_tr_b16 v[88:89], v104 offset:8192
    ds_read_b64_tr_b16 v[90:91], v104 offset:8448
    ds_read_b64_tr_b16 v[92:93], v104 offset:12288
    ds_read_b64_tr_b16 v[94:95], v104 offset:12544
    ds_read_b64_tr_b16 v[96:97], v104 offset:8224
    ds_read_b64_tr_b16 v[98:99], v104 offset:8480
    ds_read_b64_tr_b16 v[100:101], v104 offset:12320
    ds_read_b64_tr_b16 v[102:103], v104 offset:12576
    v_bfe_u32 v105, v0, 1, 3
    v_lshlrev_b32 v105, 8, v105
    v_lshl_add_u32 v105, v109, 5, v105
    v_lshl_add_u32 v105, v110, 4, v105
    v_lshrrev_b32 v106, 3, v0
    v_lshlrev_b32 v106, 7, v106
    v_and_b32 v110, 7, v0
    v_lshl_add_u32 v107, v110, 3, v106
    v_add_u32 v107, s100, v107
    v_lshlrev_b32 v106, 8, v109
    v_and_b32 v110, 15, v0
    v_lshl_add_u32 v106, v110, 2, v106
    v_add_u32 v106, s96, v106
    v_lshlrev_b32 v108, 2, v0
    s_lshl_b32 s96, s62, 2
    s_add_u32 s96, s96, 162088
    v_mov_b32 v109, s96
    s_lshl_b32 s100, s63, 11
    s_lshl_b32 s96, s34, 13
    s_add_u32 s100, s100, s96
    s_add_u32 s100, s100, 106496
    s_mul_i32 s101, s34, 5120
    s_lshl_b32 s96, s35, 9
    s_add_u32 s101, s101, s96
    s_lshl_b32 s96, s62, 8
    s_add_u32 s101, s101, s96
    s_sub_u32 s101, s101, 11264
    s_and_b32 s96, s101, 0xffffe000
    s_add_u32 s101, s101, s96
    s_add_u32 s101, s101, 212992
    v_add_u32 v110, 8192, v108
L_nofrag_85:
    v_and_b32_dpp v28, v17, v20 row_newbcast:8 row_mask:0xf bank_mask:0xf
    v_and_b32_dpp v29, v17, v21 row_newbcast:8 row_mask:0xf bank_mask:0xf
    v_and_b32_dpp v30, v17, v22 row_newbcast:8 row_mask:0xf bank_mask:0xf
    v_and_b32_dpp v31, v17, v23 row_newbcast:8 row_mask:0xf bank_mask:0xf
    s_waitcnt vmcnt(3)
    s_bitcmp0_b32 s14, 25
    s_cbranch_scc1 L_sf_87
    s_waitcnt vmcnt(2)
    s_bitcmp0_b32 s15, 25
    s_cbranch_scc1 L_sf_87
    s_waitcnt vmcnt(1)
L_sf_87:
    buffer_load_dwordx4 v[140:143], v1, s[52:55], s97 offen offset:1024 nt
    v_mfma_f32_16x16x32_bf16 v[32:35], v[28:31], v[124:127], v[32:35]
    v_and_b32_dpp v24, v17, v20 row_newbcast:4 row_mask:0xf bank_mask:0xf
    v_and_b32_dpp v25, v17, v21 row_newbcast:4 row_mask:0xf bank_mask:0xf
    v_and_b32_dpp v26, v17, v22 row_newbcast:4 row_mask:0xf bank_mask:0xf
    v_and_b32_dpp v27, v17, v23 row_newbcast:4 row_mask:0xf bank_mask:0xf
    s_waitcnt vmcnt(3)
    s_bitcmp0_b32 s14, 26
    s_cbranch_scc1 L_sf_88
    s_waitcnt vmcnt(2)
    s_bitcmp0_b32 s15, 26
    s_cbranch_scc1 L_sf_88
    s_waitcnt vmcnt(1)
L_sf_88:
    buffer_load_dwordx4 v[144:147], v1, s[52:55], s97 offen offset:2048 nt
    v_mfma_f32_16x16x32_bf16 v[32:35], v[24:27], v[128:131], v[32:35]
    v_and_b32_dpp v28, v17, v20 row_newbcast:12 row_mask:0xf bank_mask:0xf
    v_and_b32_dpp v29, v17, v21 row_newbcast:12 row_mask:0xf bank_mask:0xf
    v_and_b32_dpp v30, v17, v22 row_newbcast:12 row_mask:0xf bank_mask:0xf
    v_and_b32_dpp v31, v17, v23 row_newbcast:12 row_mask:0xf bank_mask:0xf
    s_waitcnt vmcnt(3)
    s_bitcmp0_b32 s14, 27
    s_cbranch_scc1 L_sf_89
    s_waitcnt vmcnt(2)
    s_bitcmp0_b32 s15, 27
    s_cbranch_scc1 L_sf_89
    s_waitcnt vmcnt(1)
L_sf_89:
    buffer_load_dwordx4 v[148:151], v1, s[52:55], s97 offen offset:3072 nt
    s_add_u32 s97, s97, 32768
    v_add_u32 v1, 4096, v1
    v_and_b32 v1, 0x7fff, v1
    v_mfma_f32_16x16x32_bf16 v[32:35], v[28:31], v[132:135], v[32:35]
    v_and_b32_dpp v24, v18, v20 row_newbcast:0 row_mask:0xf bank_mask:0xf
    v_and_b32_dpp v25, v18, v21 row_newbcast:0 row_mask:0xf bank_mask:0xf
    v_and_b32_dpp v26, v18, v22 row_newbcast:0 row_mask:0xf bank_mask:0xf
    v_and_b32_dpp v27, v18, v23 row_newbcast:0 row_mask:0xf bank_mask:0xf
    s_waitcnt vmcnt(3)
    s_bitcmp0_b32 s14, 28
    s_cbranch_scc1 L_sf_90
    s_waitcnt vmcnt(2)
    s_bitcmp0_b32 s15, 28
    s_cbranch_scc1 L_sf_90
    s_waitcnt vmcnt(1)
L_sf_90:
    buffer_load_dwordx4 v[152:155], v1, s[52:55], s97 offen offset:0 nt
    v_mfma_f32_16x16x32_bf16 v[32:35], v[24:27], v[136:139], v[32:35]
    v_mov_b32 v10, 162076
    v_mov_b32 v11, 1
    s_mov_b64 exec, 1
    ds_add_u32 v10, v11
    s_mov_b64 exec, -1
    v_and_b32_dpp v28, v18, v20 row_newbcast:8 row_mask:0xf bank_mask:0xf
    v_and_b32_dpp v29, v18, v21 row_newbcast:8 row_mask:0xf bank_mask:0xf
    v_and_b32_dpp v30, v18, v22 row_newbcast:8 row_mask:0xf bank_mask:0xf
    v_and_b32_dpp v31, v18, v23 row_newbcast:8 row_mask:0xf bank_mask:0xf
    s_waitcnt vmcnt(3)
    s_bitcmp0_b32 s14, 29
    s_cbranch_scc1 L_sf_91
    s_waitcnt vmcnt(2)
    s_bitcmp0_b32 s15, 29
    s_cbranch_scc1 L_sf_91
    s_waitcnt vmcnt(1)
L_sf_91:
    buffer_load_dwordx4 v[156:159], v1, s[52:55], s97 offen offset:1024 nt
    v_mfma_f32_16x16x32_bf16 v[32:35], v[28:31], v[140:143], v[32:35]
    v_and_b32_dpp v24, v18, v20 row_newbcast:4 row_mask:0xf bank_mask:0xf
    v_and_b32_dpp v25, v18, v21 row_newbcast:4 row_mask:0xf bank_mask:0xf
    v_and_b32_dpp v26, v18, v22 row_newbcast:4 row_mask:0xf bank_mask:0xf
    v_and_b32_dpp v27, v18, v23 row_newbcast:4 row_mask:0xf bank_mask:0xf
    s_waitcnt vmcnt(3)
    s_bitcmp0_b32 s14, 30
    s_cbranch_scc1 L_sf_92
    s_waitcnt vmcnt(2)
    s_bitcmp0_b32 s15, 30
    s_cbranch_scc1 L_sf_92
    s_waitcnt vmcnt(1)
L_sf_92:
    buffer_load_dwordx4 v[160:163], v1, s[52:55], s97 offen offset:2048 nt
    v_mfma_f32_16x16x32_bf16 v[32:35], v[24:27], v[144:147], v[32:35]
    v_lshrrev_b32 v9, 4, v0
    v_lshl_add_u32 v8, v9, 2, v2
    s_lshl_b32 s96, s3, 9
    s_add_u32 s96, s96, 157824
    v_lshl_add_u32 v8, v8, 2, s96
    v_lshlrev_b32 v9, 3, v0
    v_add_u32 v9, 157824, v9
    v_mov_b32 v10, 162048
    v_mov_b32 v11, 1
    s_lshl_b32 s96, s38, 5
    s_add_u32 s96, s96, 161984
    v_mov_b32 v3, s96
    s_sub_u32 s62, 8, s39
    s_lshl_b32 s98, s34, 5
    s_add_u32 s98, s98, s35
    s_lshl_b32 s98, s98, 8
    s_add_u32 s98, s98, 106496
    v_lshlrev_b32 v39, 2, v0
    v_and_b32_dpp v28, v18, v20 row_newbcast:12 row_mask:0xf bank_mask:0xf
    v_and_b32_dpp v29, v18, v21 row_newbcast:12 row_mask:0xf bank_mask:0xf
    v_and_b32_dpp v30, v18, v22 row_newbcast:12 row_mask:0xf bank_mask:0xf
    v_and_b32_dpp v31, v18, v23 row_newbcast:12 row_mask:0xf bank_mask:0xf
    s_waitcnt vmcnt(3)
    s_bitcmp0_b32 s14, 31
    s_cbranch_scc1 L_sf_93
    s_waitcnt vmcnt(2)
    s_bitcmp0_b32 s15, 31
    s_cbranch_scc1 L_sf_93
    s_waitcnt vmcnt(1)
L_sf_93:
    buffer_load_dwordx4 v[164:167], v1, s[52:55], s97 offen offset:3072 nt
    s_mov_b32 s97, 0
    v_add_u32 v1, 4096, v1
    v_and_b32 v1, 0x7fff, v1
    v_mfma_f32_16x16x32_bf16 v[32:35], v[28:31], v[148:151], v[32:35]
    s_cmp_eq_u32 s12, -1
    s_cbranch_scc1 L_v_nopf
    v_and_b32_dpp v40, v19, v20 row_newbcast:0 row_mask:0xf bank_mask:0xf
    v_and_b32_dpp v41, v19, v21 row_newbcast:0 row_mask:0xf bank_mask:0xf
    v_and_b32_dpp v42, v19, v22 row_newbcast:0 row_mask:0xf bank_mask:0xf
    v_and_b32_dpp v43, v19, v23 row_newbcast:0 row_mask:0xf bank_mask:0xf
    v_and_b32_dpp v44, v19, v20 row_newbcast:8 row_mask:0xf bank_mask:0xf
    v_and_b32_dpp v45, v19, v21 row_newbcast:8 row_mask:0xf bank_mask:0xf
    v_and_b32_dpp v46, v19, v22 row_newbcast:8 row_mask:0xf bank_mask:0xf
    v_and_b32_dpp v47, v19, v23 row_newbcast:8 row_mask:0xf bank_mask:0xf
    v_and_b32_dpp v48, v19, v20 row_newbcast:4 row_mask:0xf bank_mask:0xf
    v_and_b32_dpp v49, v19, v21 row_newbcast:4 row_mask:0xf bank_mask:0xf
    v_and_b32_dpp v50, v19, v22 row_newbcast:4 row_mask:0xf bank_mask:0xf
    v_and_b32_dpp v51, v19, v23 row_newbcast:4 row_mask:0xf bank_mask:0xf
    v_and_b32_dpp v52, v19, v20 row_newbcast:12 row_mask:0xf bank_mask:0xf
    v_and_b32_dpp v53, v19, v21 row_newbcast:12 row_mask:0xf bank_mask:0xf
    v_and_b32_dpp v54, v19, v22 row_newbcast:12 row_mask:0xf bank_mask:0xf
    v_and_b32_dpp v55, v19, v23 row_newbcast:12 row_mask:0xf bank_mask:0xf
    s_waitcnt vmcnt(3)
    v_mfma_f32_16x16x32_bf16 v[32:35], v[40:43], v[152:155], v[32:35]
    s_waitcnt vmcnt(2)
    v_mfma_f32_16x16x32_bf16 v[32:35], v[44:47], v[156:159], v[32:35]
    s_waitcnt vmcnt(1)
    v_mfma_f32_16x16x32_bf16 v[32:35], v[48:51], v[160:163], v[32:35]
    s_waitcnt vmcnt(0)
    v_mfma_f32_16x16x32_bf16 v[32:35], v[52:55], v[164:167], v[32:35]
L_v_join:
    s_cmp_lg_u32 s13, 0
    s_cbranch_scc1 L_jobend
L_t0:
    s_mov_b32 exec_hi, 0
    s_nop 4
    ds_write_b128 v8, v[32:35]
L_t0b:
    s_mov_b64 exec, 1
    ds_add_rtn_u32 v37, v10, v11
    s_mov_b64 exec, -1
    ds_read_b32 v38, v10 offset:24
    ds_read_b128 v[24:27], v3
    ds_read_b128 v[28:31], v3 offset:16
    ds_read_b64 v[144:145], v9 offset:0
    ds_read_b64 v[146:147], v9 offset:512
    ds_read_b64 v[148:149], v9 offset:1024
    ds_read_b64 v[150:151], v9 offset:1536
    ds_read_b64 v[152:153], v9 offset:2048
    ds_read_b64 v[154:155], v9 offset:2560
    ds_read_b64 v[156:157], v9 offset:3072
    ds_read_b64 v[158:159], v9 offset:3584
    s_waitcnt lgkmcnt(10)
    v_readfirstlane_b32 s96, v37
    v_readfirstlane_b32 s61, v38
    s_cmp_lg_u32 s96, s62
    s_cbranch_scc1 L_nopub
    s_waitcnt lgkmcnt(6)
    v_pk_mul_f32 v[144:145], v[144:145], v[24:25] op_sel:[0,0] op_sel_hi:[1,0]
    v_pk_mul_f32 v[146:147], v[146:147], v[24:25] op_sel:[0,1] op_sel_hi:[1,1]
    s_waitcnt lgkmcnt(4)
    v_pk_fma_f32 v[144:145], v[148:149], v[26:27], v[144:145] op_sel:[0,0,0] op_sel_hi:[1,0,1]
    v_pk_fma_f32 v[146:147], v[150:151], v[26:27], v[146:147] op_sel:[0,1,0] op_sel_hi:[1,1,1]
    s_waitcnt lgkmcnt(2)
    v_pk_fma_f32 v[144:145], v[152:153], v[28:29], v[144:145] op_sel:[0,0,0] op_sel_hi:[1,0,1]
    v_pk_fma_f32 v[146:147], v[154:155], v[28:29], v[146:147] op_sel:[0,1,0] op_sel_hi:[1,1,1]
    s_waitcnt lgkmcnt(0)
    v_pk_fma_f32 v[144:145], v[156:157], v[30:31], v[144:145] op_sel:[0,0,0] op_sel_hi:[1,0,1]
    v_pk_fma_f32 v[146:147], v[158:159], v[30:31], v[146:147] op_sel:[0,1,0] op_sel_hi:[1,1,1]
    s_cmp_eq_u32 s61, 1
    v_pk_add_f32 v[144:145], v[144:145], v[146:147]
    v_cvt_pk_bf16_f32 v32, v144, v145
    s_cbranch_scc0 L_oslow
    buffer_store_dword v32, v39, s[40:43], s98 offen
L_odone:
L_nopub:
    s_cmp_eq_u32 s59, 0
    s_cbranch_scc1 L_not1
L_poll_102:
    buffer_load_dwordx4 v[16:19], v105, s[40:43], s100 offen sc1
    buffer_load_dwordx4 v[20:23], v105, s[40:43], s100 offen offset:128 sc1
    s_sub_u32 s60, s60, 1
    s_cbranch_scc1 L_poll_102t
    s_waitcnt vmcnt(0)
    v_max3_u32 v38, v16, v17, v18
    v_max3_u32 v38, v38, v19, v20
    v_max3_u32 v38, v38, v21, v22
    v_max_u32 v38, v38, v23
    v_cmp_eq_u32 vcc, -1, v38
    s_cbranch_vccnz L_poll_102
L_poll_102e:
    v_smfmac_f32_16x16x64_bf16 v[112:115], v[16:19], v[72:79], v111
    v_smfmac_f32_16x16x64_bf16 v[116:119], v[16:19], v[80:87], v111
    v_smfmac_f32_16x16x64_bf16 v[112:115], v[20:23], v[88:95], v111
    v_smfmac_f32_16x16x64_bf16 v[116:119], v[20:23], v[96:103], v111
    s_nop 6
    v_pk_add_f32 v[112:113], v[112:113], v[114:115]
    v_pk_add_f32 v[116:117], v[116:117], v[118:119]
    v_add_f32 v12, v112, v113
    v_add_f32 v13, v116, v117
    ds_write2_b32 v106, v12, v13 offset0:0 offset1:32
    s_mov_b64 exec, 1
    ds_add_rtn_u32 v37, v109, v11
    s_mov_b64 exec, -1
    ds_read_b64 v[72:73], v107 offset:0
    ds_read_b64 v[74:75], v107 offset:16384
    ds_read_b64 v[76:77], v107 offset:32768
    ds_read_b64 v[78:79], v107 offset:49152
    s_cmp_eq_u32 s34, 2
    s_cselect_b32 s97, s61, 0
    s_waitcnt lgkmcnt(4)
    v_readfirstlane_b32 s96, v37
    s_waitcnt lgkmcnt(2)
    v_pk_add_f32 v[72:73], v[72:73], v[74:75]
    s_cmp_lg_u32 s96, 3
    s_cbranch_scc1 L_not1
    s_cmp_eq_u32 s97, 1
    s_waitcnt lgkmcnt(0)
    v_pk_add_f32 v[76:77], v[76:77], v[78:79]
    v_pk_add_f32 v[72:73], v[72:73], v[76:77]
    v_cvt_pk_bf16_f32 v12, v72, v73
    s_cbranch_scc1 L_pfast
    buffer_store_dword v12, v108, s[40:43], s101 offen sc1
    buffer_store_dword v12, v110, s[40:43], s101 offen sc1
L_pdone:
L_not1:
    s_waitcnt lgkmcnt(0)
    s_cmp_eq_u32 s39, 1
    s_cbranch_scc1 L_s_role
    s_cmp_eq_u32 s34, 2
    s_cselect_b32 s62, s59, 0
    s_cmp_eq_u32 s62, 1
    s_cbranch_scc1 L_refetch
L_norf:
    s_endpgm
L_k_nopf:
    s_waitcnt vmcnt(3)
    s_bitcmp0_b32 s57, 22
    s_cbranch_scc1 L_sf_58
    s_waitcnt vmcnt(2)
    s_bitcmp0_b32 s58, 22
    s_cbranch_scc1 L_sf_58
    s_waitcnt vmcnt(1)
L_sf_58:
    buffer_load_dwordx4 v[128:131], v1, s[48:51], s97 offen offset:2048 nt
    v_min_u32 v39, 15, v0
    v_and_b32 v38, 1, v39
    v_mul_u32_u24 v38, 126, v38
    v_lshl_add_u32 v39, v39, 1, v38
    buffer_load_dword v37, v39, s[44:47], 0 offen sc1
    s_waitcnt vmcnt(4)
    s_bitcmp0_b32 s57, 23
    s_cbranch_scc1 L_sf_59
    s_waitcnt vmcnt(3)
    s_bitcmp0_b32 s58, 23
    s_cbranch_scc1 L_sf_59
    s_waitcnt vmcnt(2)
L_sf_59:
    buffer_load_dwordx4 v[132:135], v1, s[48:51], s97 offen offset:3072 nt
    s_add_u32 s97, s97, 32768
    v_add_u32 v1, 4096, v1
    v_and_b32 v1, 0x7fff, v1
    s_waitcnt vmcnt(4)
    s_bitcmp0_b32 s57, 24
    s_cbranch_scc1 L_sf_60
    s_waitcnt vmcnt(3)
    s_bitcmp0_b32 s58, 24
    s_cbranch_scc1 L_sf_60
    s_waitcnt vmcnt(2)
L_sf_60:
    buffer_load_dwordx4 v[136:139], v1, s[48:51], s97 offen offset:0 nt
    s_waitcnt vmcnt(4)
    s_bitcmp0_b32 s57, 25
    s_cbranch_scc1 L_sf_61
    s_waitcnt vmcnt(3)
    s_bitcmp0_b32 s58, 25
    s_cbranch_scc1 L_sf_61
    s_waitcnt vmcnt(1)
L_sf_61:
    buffer_load_dwordx4 v[140:143], v1, s[48:51], s97 offen offset:1024 nt
    s_waitcnt vmcnt(4)
    s_bitcmp0_b32 s57, 26
    s_cbranch_scc1 L_sf_62
    s_waitcnt vmcnt(2)
    s_bitcmp0_b32 s58, 26
    s_cbranch_scc1 L_sf_62
    s_waitcnt vmcnt(1)
L_sf_62:
    buffer_load_dwordx4 v[144:147], v1, s[48:51], s97 offen offset:2048 nt
    s_waitcnt vmcnt(3)
    s_bitcmp0_b32 s57, 27
    s_cbranch_scc1 L_sf_63
    s_waitcnt vmcnt(2)
    s_bitcmp0_b32 s58, 27
    s_cbranch_scc1 L_sf_63
    s_waitcnt vmcnt(1)
L_sf_63:
    buffer_load_dwordx4 v[148:151], v1, s[48:51], s97 offen offset:3072 nt
    s_add_u32 s97, s97, 32768
    v_add_u32 v1, 4096, v1
    v_and_b32 v1, 0x7fff, v1
    v_cmp_eq_u32 vcc, 0, v37
    s_nop 0
    s_or_b32 s96, vcc_lo, vcc_hi
    buffer_load_dwordx4 v[4:7], v2, s[40:43], s98 offen sc1
    s_waitcnt vmcnt(4)
    s_bitcmp0_b32 s57, 28
    s_cbranch_scc1 L_sf_64
    s_waitcnt vmcnt(3)
    s_bitcmp0_b32 s58, 28
    s_cbranch_scc1 L_sf_64
    s_waitcnt vmcnt(2)
L_sf_64:
    buffer_load_dwordx4 v[152:155], v1, s[48:51], s97 offen offset:0 nt
    s_waitcnt vmcnt(4)
    s_bitcmp0_b32 s57, 29
    s_cbranch_scc1 L_sf_65
    s_waitcnt vmcnt(3)
    s_bitcmp0_b32 s58, 29
    s_cbranch_scc1 L_sf_65
    s_waitcnt vmcnt(2)
L_sf_65:
    buffer_load_dwordx4 v[156:159], v1, s[48:51], s97 offen offset:1024 nt
    s_waitcnt vmcnt(4)
    s_bitcmp0_b32 s57, 30
    s_cbranch_scc1 L_sf_66
    s_waitcnt vmcnt(3)
    s_bitcmp0_b32 s58, 30
    s_cbranch_scc1 L_sf_66
    s_waitcnt vmcnt(1)
L_sf_66:
    buffer_load_dwordx4 v[160:163], v1, s[48:51], s97 offen offset:2048 nt
    s_waitcnt vmcnt(4)
    s_bitcmp0_b32 s57, 31
    s_cbranch_scc1 L_sf_67
    s_waitcnt vmcnt(2)
    s_bitcmp0_b32 s58, 31
    s_cbranch_scc1 L_sf_67
    s_waitcnt vmcnt(1)
L_sf_67:
    buffer_load_dwordx4 v[164:167], v1, s[48:51], s97 offen offset:3072 nt
    s_mov_b32 s97, 0
    v_add_u32 v1, 4096, v1
    v_and_b32 v1, 0x7fff, v1
    v_add_u32 v1, 8192, v1
    v_and_b32 v1, 0x7fff, v1
    s_mov_b32 s97, 65536
    s_branch L_k_join
L_v_nopf:
    v_and_b32_dpp v24, v19, v20 row_newbcast:0 row_mask:0xf bank_mask:0xf
    v_and_b32_dpp v25, v19, v21 row_newbcast:0 row_mask:0xf bank_mask:0xf
    v_and_b32_dpp v26, v19, v22 row_newbcast:0 row_mask:0xf bank_mask:0xf
    v_and_b32_dpp v27, v19, v23 row_newbcast:0 row_mask:0xf bank_mask:0xf
    s_waitcnt vmcnt(3)
    s_bitcmp0_b32 s14, 0
    s_cbranch_scc1 L_sf_94
    s_waitcnt vmcnt(2)
    s_bitcmp0_b32 s15, 0
    s_cbranch_scc1 L_sf_94
    s_waitcnt vmcnt(1)
L_sf_94:
    buffer_load_dwordx4 v[40:43], v1, s[52:55], s97 offen offset:0 nt
    v_mfma_f32_16x16x32_bf16 v[32:35], v[24:27], v[152:155], v[32:35]
    v_and_b32_dpp v28, v19, v20 row_newbcast:8 row_mask:0xf bank_mask:0xf
    v_and_b32_dpp v29, v19, v21 row_newbcast:8 row_mask:0xf bank_mask:0xf
    v_and_b32_dpp v30, v19, v22 row_newbcast:8 row_mask:0xf bank_mask:0xf
    v_and_b32_dpp v31, v19, v23 row_newbcast:8 row_mask:0xf bank_mask:0xf
    s_waitcnt vmcnt(3)
    s_bitcmp0_b32 s14, 1
    s_cbranch_scc1 L_sf_95
    s_waitcnt vmcnt(2)
    s_bitcmp0_b32 s15, 1
    s_cbranch_scc1 L_sf_95
    s_waitcnt vmcnt(1)
L_sf_95:
    buffer_load_dwordx4 v[44:47], v1, s[52:55], s97 offen offset:1024 nt
    v_mfma_f32_16x16x32_bf16 v[32:35], v[28:31], v[156:159], v[32:35]
    v_and_b32_dpp v24, v19, v20 row_newbcast:4 row_mask:0xf bank_mask:0xf
    v_and_b32_dpp v25, v19, v21 row_newbcast:4 row_mask:0xf bank_mask:0xf
    v_and_b32_dpp v26, v19, v22 row_newbcast:4 row_mask:0xf bank_mask:0xf
    v_and_b32_dpp v27, v19, v23 row_newbcast:4 row_mask:0xf bank_mask:0xf
    s_waitcnt vmcnt(3)
    s_bitcmp0_b32 s14, 2
    s_cbranch_scc1 L_sf_96
    s_waitcnt vmcnt(2)
    s_bitcmp0_b32 s15, 2
    s_cbranch_scc1 L_sf_96
    s_waitcnt vmcnt(1)
L_sf_96:
    buffer_load_dwordx4 v[48:51], v1, s[52:55], s97 offen offset:2048 nt
    v_mfma_f32_16x16x32_bf16 v[32:35], v[24:27], v[160:163], v[32:35]
    v_and_b32_dpp v28, v19, v20 row_newbcast:12 row_mask:0xf bank_mask:0xf
    v_and_b32_dpp v29, v19, v21 row_newbcast:12 row_mask:0xf bank_mask:0xf
    v_and_b32_dpp v30, v19, v22 row_newbcast:12 row_mask:0xf bank_mask:0xf
    v_and_b32_dpp v31, v19, v23 row_newbcast:12 row_mask:0xf bank_mask:0xf
    s_waitcnt vmcnt(3)
    s_bitcmp0_b32 s14, 3
    s_cbranch_scc1 L_sf_97
    s_waitcnt vmcnt(2)
    s_bitcmp0_b32 s15, 3
    s_cbranch_scc1 L_sf_97
    s_waitcnt vmcnt(1)
L_sf_97:
    buffer_load_dwordx4 v[52:55], v1, s[52:55], s97 offen offset:3072 nt
    s_add_u32 s97, s97, 32768
    v_add_u32 v1, 4096, v1
    v_and_b32 v1, 0x7fff, v1
    v_mfma_f32_16x16x32_bf16 v[32:35], v[28:31], v[164:167], v[32:35]
    v_and_b32_dpp v24, v12, v20 row_newbcast:0 row_mask:0xf bank_mask:0xf
    v_and_b32_dpp v25, v12, v21 row_newbcast:0 row_mask:0xf bank_mask:0xf
    v_and_b32_dpp v26, v12, v22 row_newbcast:0 row_mask:0xf bank_mask:0xf
    v_and_b32_dpp v27, v12, v23 row_newbcast:0 row_mask:0xf bank_mask:0xf
    s_waitcnt vmcnt(3)
    s_bitcmp0_b32 s14, 4
    s_cbranch_scc1 L_sf_98
    s_waitcnt vmcnt(2)
    s_bitcmp0_b32 s15, 4
    s_cbranch_scc1 L_sf_98
    s_waitcnt vmcnt(1)
L_sf_98:
    buffer_load_dwordx4 v[56:59], v1, s[52:55], s97 offen offset:0 nt
    v_mfma_f32_16x16x32_bf16 v[32:35], v[24:27], v[40:43], v[32:35]
    v_and_b32_dpp v28, v12, v20 row_newbcast:8 row_mask:0xf bank_mask:0xf
    v_and_b32_dpp v29, v12, v21 row_newbcast:8 row_mask:0xf bank_mask:0xf
    v_and_b32_dpp v30, v12, v22 row_newbcast:8 row_mask:0xf bank_mask:0xf
    v_and_b32_dpp v31, v12, v23 row_newbcast:8 row_mask:0xf bank_mask:0xf
    s_waitcnt vmcnt(3)
    s_bitcmp0_b32 s14, 5
    s_cbranch_scc1 L_sf_99
    s_waitcnt vmcnt(2)
    s_bitcmp0_b32 s15, 5
    s_cbranch_scc1 L_sf_99
    s_waitcnt vmcnt(1)
L_sf_99:
    buffer_load_dwordx4 v[60:63], v1, s[52:55], s97 offen offset:1024 nt
    v_mfma_f32_16x16x32_bf16 v[32:35], v[28:31], v[44:47], v[32:35]
    v_and_b32_dpp v24, v12, v20 row_newbcast:4 row_mask:0xf bank_mask:0xf
    v_and_b32_dpp v25, v12, v21 row_newbcast:4 row_mask:0xf bank_mask:0xf
    v_and_b32_dpp v26, v12, v22 row_newbcast:4 row_mask:0xf bank_mask:0xf
    v_and_b32_dpp v27, v12, v23 row_newbcast:4 row_mask:0xf bank_mask:0xf
    s_waitcnt vmcnt(3)
    s_bitcmp0_b32 s14, 6
    s_cbranch_scc1 L_sf_100
    s_waitcnt vmcnt(2)
    s_bitcmp0_b32 s15, 6
    s_cbranch_scc1 L_sf_100
    s_waitcnt vmcnt(1)
L_sf_100:
    buffer_load_dwordx4 v[64:67], v1, s[52:55], s97 offen offset:2048 nt
    v_mfma_f32_16x16x32_bf16 v[32:35], v[24:27], v[48:51], v[32:35]
    v_and_b32_dpp v28, v12, v20 row_newbcast:12 row_mask:0xf bank_mask:0xf
    v_and_b32_dpp v29, v12, v21 row_newbcast:12 row_mask:0xf bank_mask:0xf
    v_and_b32_dpp v30, v12, v22 row_newbcast:12 row_mask:0xf bank_mask:0xf
    v_and_b32_dpp v31, v12, v23 row_newbcast:12 row_mask:0xf bank_mask:0xf
    s_waitcnt vmcnt(3)
    s_bitcmp0_b32 s14, 7
    s_cbranch_scc1 L_sf_101
    s_waitcnt vmcnt(2)
    s_bitcmp0_b32 s15, 7
    s_cbranch_scc1 L_sf_101
    s_waitcnt vmcnt(1)
L_sf_101:
    buffer_load_dwordx4 v[68:71], v1, s[52:55], s97 offen offset:3072 nt
    s_add_u32 s97, s97, 32768
    v_add_u32 v1, 4096, v1
    v_and_b32 v1, 0x7fff, v1
    v_mfma_f32_16x16x32_bf16 v[32:35], v[28:31], v[52:55], v[32:35]
    v_and_b32_dpp v24, v13, v20 row_newbcast:0 row_mask:0xf bank_mask:0xf
    v_and_b32_dpp v25, v13, v21 row_newbcast:0 row_mask:0xf bank_mask:0xf
    v_and_b32_dpp v26, v13, v22 row_newbcast:0 row_mask:0xf bank_mask:0xf
    v_and_b32_dpp v27, v13, v23 row_newbcast:0 row_mask:0xf bank_mask:0xf
    s_waitcnt vmcnt(3)
    s_nop 0
    v_mfma_f32_16x16x32_bf16 v[32:35], v[24:27], v[56:59], v[32:35]
    v_and_b32_dpp v28, v13, v20 row_newbcast:8 row_mask:0xf bank_mask:0xf
    v_and_b32_dpp v29, v13, v21 row_newbcast:8 row_mask:0xf bank_mask:0xf
    v_and_b32_dpp v30, v13, v22 row_newbcast:8 row_mask:0xf bank_mask:0xf
    v_and_b32_dpp v31, v13, v23 row_newbcast:8 row_mask:0xf bank_mask:0xf
    s_waitcnt vmcnt(2)
    s_nop 0
    v_mfma_f32_16x16x32_bf16 v[32:35], v[28:31], v[60:63], v[32:35]
    v_and_b32_dpp v24, v13, v20 row_newbcast:4 row_mask:0xf bank_mask:0xf
    v_and_b32_dpp v25, v13, v21 row_newbcast:4 row_mask:0xf bank_mask:0xf
    v_and_b32_dpp v26, v13, v22 row_newbcast:4 row_mask:0xf bank_mask:0xf
    v_and_b32_dpp v27, v13, v23 row_newbcast:4 row_mask:0xf bank_mask:0xf
    s_waitcnt vmcnt(1)
    s_nop 0
    v_mfma_f32_16x16x32_bf16 v[32:35], v[24:27], v[64:67], v[32:35]
    v_and_b32_dpp v28, v13, v20 row_newbcast:12 row_mask:0xf bank_mask:0xf
    v_and_b32_dpp v29, v13, v21 row_newbcast:12 row_mask:0xf bank_mask:0xf
    v_and_b32_dpp v30, v13, v22 row_newbcast:12 row_mask:0xf bank_mask:0xf
    v_and_b32_dpp v31, v13, v23 row_newbcast:12 row_mask:0xf bank_mask:0xf
    s_waitcnt vmcnt(0)
    s_nop 0
    v_mfma_f32_16x16x32_bf16 v[32:35], v[28:31], v[68:71], v[32:35]
    s_branch L_v_join
L_oslow:
    buffer_store_dword v32, v39, s[40:43], s98 offen sc1
    s_branch L_odone
L_refetch:
    s_lshr_b32 s62, s3, 2
    s_mul_i32 s62, s62, 5
    s_add_u32 s62, s62, s35
    s_sub_u32 s62, s62, 27
    s_cmp_ge_u32 s62, 7
    s_cbranch_scc1 L_norf
    s_add_u32 s62, s62, 3
    s_and_b32 s62, s62, 7
    s_mul_i32 s62, s62, 5120
    v_mov_b32 v8, 162048
L_lw_103:
    ds_read_b32 v9, v8
    s_waitcnt lgkmcnt(0)
    v_cmp_gt_u32 vcc, 9, v9
    s_cbranch_vccz L_lw_103e
    s_sleep 2
    s_sub_u32 s60, s60, 1
    s_cbranch_scc0 L_lw_103
    s_mov_b32 s60, 0
L_lw_103e:
    ds_read_b32 v9, v8 offset:36
    v_lshlrev_b32 v5, 4, v0
    v_add_u32 v5, 212992, v5
    s_add_u32 s4, s62, 0
    s_and_b32 s63, s4, 0xffffe000
    s_add_u32 s4, s4, s63
    s_add_u32 s5, s62, 1024
    s_and_b32 s63, s5, 0xffffe000
    s_add_u32 s5, s5, s63
    s_add_u32 s6, s62, 2048
    s_and_b32 s63, s6, 0xffffe000
    s_add_u32 s6, s6, s63
    s_add_u32 s7, s62, 3072
    s_and_b32 s63, s7, 0xffffe000
    s_add_u32 s7, s7, s63
    s_add_u32 s8, s62, 4096
    s_and_b32 s63, s8, 0xffffe000
    s_add_u32 s8, s8, s63
    s_waitcnt lgkmcnt(0)
    v_add_u32 v5, v5, v9
L_poll_104:
    buffer_load_dwordx4 v[12:15], v5, s[40:43], s4 offen sc1
    buffer_load_dwordx4 v[16:19], v5, s[40:43], s5 offen sc1
    buffer_load_dwordx4 v[20:23], v5, s[40:43], s6 offen sc1
    buffer_load_dwordx4 v[24:27], v5, s[40:43], s7 offen sc1
    buffer_load_dwordx4 v[28:31], v5, s[40:43], s8 offen sc1
    s_sub_u32 s60, s60, 1
    s_cbranch_scc1 L_poll_104t
    s_waitcnt vmcnt(0)
    v_max3_u32 v3, v12, v16, v20
    v_max3_u32 v3, v3, v24, v28
    v_cmp_eq_u32 vcc, -1, v3
    s_cbranch_vccnz L_poll_104
L_poll_104e:
    s_branch L_norf
L_qslow:
L_wy_105:
    buffer_load_dword v37, v39, s[44:47], 0 offen sc1
    s_waitcnt vmcnt(0)
    v_cmp_ne_u32 vcc, -1, v37
    s_cbranch_vccz L_wy_105e
    s_sleep 4
    s_sub_u32 s60, s60, 1
    s_cbranch_scc0 L_wy_105
    s_mov_b32 s60, 0
L_wy_105e:
L_qslow2:
    s_branch L_poll_106
L_poll_106s:
    s_sleep 2
L_poll_106:
    buffer_load_dwordx4 v[4:7], v2, s[40:43], s98 offen sc1
    s_sub_u32 s60, s60, 1
    s_cbranch_scc1 L_poll_106t
    s_waitcnt vmcnt(0)
    v_max3_u32 v38, v4, v5, v6
    v_max_u32 v38, v38, v7
    v_cmp_eq_u32 vcc, -1, v38
    s_cbranch_vccnz L_poll_106s
L_poll_106e:
    s_branch L_qok
L_mljob:
    s_lshl4_add_u32 s96, s35, s3
    s_lshl_b32 s96, s96, 3
    s_add_u32 s96, s96, 81920
    buffer_store_dwordx2 v[8:9], v36, s[40:43], s96 offen sc1
    s_branch L_mldone
L_service:
    v_mov_b32 v72, 0
    v_mov_b32 v73, 0
    v_mov_b32 v74, 0
    v_mov_b32 v75, 0
    v_mov_b32 v76, 0
    s_mov_b32 s59, 0
    v_mov_b32 v5, 0
    v_mov_b32 v105, 0
    v_mov_b32 v108, 0
    v_mov_b32 v110, 0
    v_mov_b32 v160, 0
    v_mov_b32 v163, 0
    v_mov_b32 v8, 162068
L_lw_107:
    ds_read_b32 v9, v8
    s_waitcnt lgkmcnt(0)
    v_cmp_gt_u32 vcc, 8, v9
    s_cbranch_vccz L_lw_107e
    s_sleep 8
    s_sub_u32 s60, s60, 1
    s_cbranch_scc0 L_lw_107
    s_mov_b32 s60, 0
L_lw_107e:
    v_and_b32 v2, 15, v0
    v_lshlrev_b32 v2, 3, v2
    v_add_u32 v3, 161920, v2
    ds_read_b64 v[8:9], v3
    v_mov_b32 v11, 162096
    ds_read_b32 v11, v11
    s_getreg_b32 s58, hwreg(HW_REG_XCC_ID, 0, 4)
    s_lshl_b32 s98, s34, 5
    s_add_u32 s98, s98, s35
    s_lshl_b32 s62, s98, 7
    s_add_u32 s62, s62, 73728
    s_and_b32 s99, s62, 0xffffff00
    s_lshl_b32 s98, s98, 8
    s_add_u32 s98, s98, 106496
    v_lshlrev_b32 v39, 2, v0
    v_and_b32 v21, 64, v2
    v_add_u32 v21, v21, v2
    v_cmp_eq_u32 vcc, 8, v0
    s_bfm_b64 exec, 8, 0
    s_bitset1_b32 exec_lo, 8
    s_waitcnt lgkmcnt(0)
    v_lshl_add_u32 v10, v11, 8, s58
    v_cndmask_b32 v8, v8, v10, vcc
    buffer_store_dwordx2 v[8:9], v2, s[40:43], s62 offen sc1
    s_mov_b64 exec, -1
    v_mov_b32 v12, 162076
L_lw_108:
    ds_read_b32 v13, v12
    s_waitcnt lgkmcnt(0)
    v_cmp_gt_u32 vcc, 4, v13
    s_cbranch_vccz L_lw_108e
    s_sleep 4
    s_sub_u32 s60, s60, 1
    s_cbranch_scc0 L_lw_108
    s_mov_b32 s60, 0
L_lw_108e:
    v_and_b32 v11, 31, v0
    v_lshlrev_b32 v11, 7, v11
    s_lshl_b32 s63, s34, 12
    s_add_u32 s63, s63, 73792
    buffer_load_dword v12, v39, s[40:43], s98 offen sc1
    s_branch L_poll_109
L_poll_109s:
    s_sleep 16
L_poll_109:
    buffer_load_dwordx2 v[8:9], v21, s[40:43], s99 offen sc1
    buffer_load_dword v10, v11, s[40:43], s63 offen sc1
    s_sub_u32 s60, s60, 1
    s_cbranch_scc1 L_poll_109t
    s_waitcnt vmcnt(0)
    v_max3_u32 v38, v8, v9, v10
    v_cmp_eq_u32 vcc, -1, v38
    s_cbranch_vccnz L_poll_109s
L_poll_109e:
    v_mov_b32 v37, v8
    s_nop 1
    v_max_f32_dpp v37, v37, v37 quad_perm:[1,0,3,2] row_mask:0xf bank_mask:0xf
    s_nop 1
    v_max_f32_dpp v37, v37, v37 quad_perm:[2,3,0,1] row_mask:0xf bank_mask:0xf
    s_nop 1
    v_max_f32_dpp v37, v37, v37 row_ror:4 row_mask:0xf bank_mask:0xf
    s_nop 1
    v_max_f32_dpp v37, v37, v37 row_ror:8 row_mask:0xf bank_mask:0xf
    v_sub_f32 v8, v8, v37
    v_exp_f32 v8, v8
    s_nop 0
    v_mul_f32 v9, v8, v9
    s_nop 1
    v_add_f32_dpp v9, v9, v9 quad_perm:[1,0,3,2] row_mask:0xf bank_mask:0xf
    s_nop 1
    v_add_f32_dpp v9, v9, v9 quad_perm:[2,3,0,1] row_mask:0xf bank_mask:0xf
    s_nop 1
    v_add_f32_dpp v9, v9, v9 row_ror:4 row_mask:0xf bank_mask:0xf
    s_nop 1
    v_add_f32_dpp v9, v9, v9 row_ror:8 row_mask:0xf bank_mask:0xf
    v_ashrrev_i32 v12, 8, v10
    s_nop 1
    v_add_u32_dpp v12, v12, v12 quad_perm:[1,0,3,2] row_mask:0xf bank_mask:0xf
    s_nop 1
    v_add_u32_dpp v12, v12, v12 quad_perm:[2,3,0,1] row_mask:0xf bank_mask:0xf
    s_nop 1
    v_add_u32_dpp v12, v12, v12 row_ror:4 row_mask:0xf bank_mask:0xf
    s_nop 1
    v_add_u32_dpp v12, v12, v12 row_ror:8 row_mask:0xf bank_mask:0xf
    v_mov_b32 v13, v12
    s_nop 1
    v_permlane16_swap_b32 v12, v13
    v_add_u32 v12, v12, v13
    v_mov_b32 v13, v12
    s_nop 1
    v_permlane32_swap_b32 v12, v13
    v_add_u32 v12, v12, v13
    v_ashrrev_i32 v12, 31, v12
    v_and_b32 v12, 8192, v12
    v_mov_b32 v13, 162084
    ds_write_b32 v13, v12
    v_and_b32 v10, 0xff, v10
    s_getreg_b32 s62, hwreg(HW_REG_XCC_ID, 0, 4)
    v_cmp_ne_u32 vcc, s62, v10
    s_nop 0
    s_cmp_eq_u64 vcc, 0
    s_cselect_b32 s61, 1, 0
    v_rcp_f32 v9, v9
    v_lshrrev_b32 v3, 1, v2
    v_add_u32 v3, 161984, v3
    v_mul_f32 v8, v8, v9
    v_mov_b32 v10, 162072
    v_mov_b32 v11, s61
    ds_write_b32 v3, v8
    ds_write_b32 v10, v11
    s_mov_b32 s3, 1
    v_lshrrev_b32 v9, 4, v0
    v_lshl_add_u32 v8, v9, 2, v2
    s_lshl_b32 s96, s3, 9
    s_add_u32 s96, s96, 157824
    v_lshl_add_u32 v8, v8, 2, s96
    v_lshlrev_b32 v9, 3, v0
    v_add_u32 v9, 157824, v9
    v_mov_b32 v10, 162048
    v_mov_b32 v11, 1
    s_lshl_b32 s96, s38, 5
    s_add_u32 s96, s96, 161984
    v_mov_b32 v3, s96
    s_sub_u32 s62, 8, s39
    s_lshl_b32 s98, s34, 5
    s_add_u32 s98, s98, s35
    s_lshl_b32 s98, s98, 8
    s_add_u32 s98, s98, 106496
    v_lshlrev_b32 v39, 2, v0
    s_branch L_t0b
L_jobend:
    v_lshlrev_b32 v9, 4, v0
    s_mov_b32 exec_hi, 0
    s_nop 3
    buffer_store_dwordx4 v[32:35], v9, s[40:43], s13 offen sc1
    s_endpgm
L_proxy:
    v_mov_b32 v72, 0
    v_mov_b32 v73, 0
    v_mov_b32 v74, 0
    v_mov_b32 v75, 0
    v_mov_b32 v76, 0
    v_mov_b32 v5, 0
    v_mov_b32 v105, 0
    v_mov_b32 v108, 0
    v_mov_b32 v110, 0
    v_mov_b32 v160, 0
    v_mov_b32 v163, 0
    s_barrier
    s_waitcnt lgkmcnt(0)
    s_mov_b32 s40, s32
    s_mov_b32 s41, s33
    s_mov_b32 s42, 589824
    s_mov_b32 s43, 0x20000
    s_mov_b32 s44, s30
    s_mov_b32 s45, s31
    s_mov_b32 s46, 256
    s_mov_b32 s47, 0x20000
    s_sub_u32 s97, 7, s3
    s_mul_i32 s97, s97, 27
    s_cmp_eq_u32 s3, 5
    s_cselect_b32 s97, 32, s97
    s_add_u32 s97, s97, s35
    s_lshl_b32 s97, s97, 9
    s_add_u32 s97, s97, 172032
    v_and_b32 v2, 15, v0
    v_lshlrev_b32 v2, 3, v2
    v_and_b32 v20, 31, v0
    v_lshlrev_b32 v20, 4, v20
    s_cmp_lg_u32 s3, 7
    s_cbranch_scc1 L_px6
    s_sub_u32 s96, 6, s59
    s_mul_i32 s62, s35, 5120
    s_add_u32 s62, s62, 327680
    v_lshl_add_u32 v22, v0, 4, s62
    v_add_u32 v23, 4096, v22
    v_mov_b32 v24, -1
    v_mov_b32 v25, -1
    v_mov_b32 v26, -1
    v_mov_b32 v27, -1
    v_mov_b32 v8, 162068
L_lw_110:
    ds_read_b32 v9, v8
    s_waitcnt lgkmcnt(0)
    v_cmp_gt_u32 vcc, s96, v9
    s_cbranch_vccz L_lw_110e
    s_sleep 8
    s_sub_u32 s60, s60, 1
    s_cbranch_scc0 L_lw_110
    s_mov_b32 s60, 0
L_lw_110e:
    v_and_b32 v2, 15, v0
    v_lshlrev_b32 v2, 3, v2
    v_add_u32 v3, 161920, v2
    ds_read_b64 v[8:9], v3
    v_mov_b32 v11, 162096
    ds_read_b32 v11, v11
    s_getreg_b32 s58, hwreg(HW_REG_XCC_ID, 0, 4)
    s_lshl_b32 s98, s34, 5
    s_add_u32 s98, s98, s35
    s_lshl_b32 s62, s98, 7
    s_add_u32 s62, s62, 73728
    s_and_b32 s99, s62, 0xffffff00
    s_lshl_b32 s98, s98, 8
    s_add_u32 s98, s98, 106496
    v_lshlrev_b32 v39, 2, v0
    v_and_b32 v21, 64, v2
    v_add_u32 v21, v21, v2
    v_cmp_eq_u32 vcc, 8, v0
    s_bfm_b64 exec, s96, 0
    s_bitset1_b32 exec_lo, 8
    s_waitcnt lgkmcnt(0)
    v_lshl_add_u32 v10, v11, 8, s58
    v_cndmask_b32 v8, v8, v10, vcc
    buffer_store_dwordx2 v[8:9], v2, s[40:43], s62 offen sc1
    s_mov_b64 exec, -1
    buffer_load_dwordx4 v[120:123], v22, s[40:43], 0 offen offset:0 sc1
    buffer_load_dwordx4 v[124:127], v22, s[40:43], 0 offen offset:1024 sc1
    buffer_load_dwordx4 v[128:131], v22, s[40:43], 0 offen offset:2048 sc1
    buffer_load_dwordx4 v[132:135], v22, s[40:43], 0 offen offset:3072 sc1
    buffer_load_dwordx4 v[136:139], v23, s[40:43], 0 offen offset:0 sc1
    s_mov_b32 s100, 4
    s_lshl_b32 s63, s100, 8
    v_and_b32 v8, 15, v0
    v_lshl_add_u32 v8, v8, 4, s63
    v_lshrrev_b32 v9, 4, v0
    v_mul_u32_u24 v5, 1280, v9
    v_add_u32 v5, v5, v8
    v_mul_u32_u24 v4, 1296, v9
    v_add_u32 v4, v4, v8
    v_add_u32 v4, 82944, v4
    v_lshlrev_b32 v6, 1, v5
    v_add_u32 v6, 99328, v6
    s_lshl_b32 s62, s100, 9
    s_add_u32 s62, s62, 88128
    v_lshl_add_u32 v7, v0, 3, s62
    s_mov_b32 s48, s4
    s_mov_b32 s49, s5
    s_mov_b32 s50, 5120
    s_mov_b32 s51, 0x20000
    buffer_load_dwordx4 v[8:11], v5, s[48:51], 0 offen
    s_mov_b32 s62, 20480
    s_mov_b32 s63, 30720
    s_branch L_poll_111
L_poll_111s:
    s_sleep 32
L_poll_111:
    buffer_load_dwordx4 v[12:15], v5, s[40:43], s62 offen sc1
    buffer_load_dwordx4 v[16:19], v5, s[40:43], s63 offen sc1
    s_sub_u32 s60, s60, 1
    s_cbranch_scc1 L_poll_111t
    s_waitcnt vmcnt(0)
    v_max3_u32 v38, v12, v13, v14
    v_max3_u32 v38, v38, v15, v16
    v_max3_u32 v38, v38, v17, v18
    v_max_u32 v38, v38, v19
    v_cmp_eq_u32 vcc, -1, v38
    s_cbranch_vccnz L_poll_111s
L_poll_111e:
    v_lshlrev_b32 v40, 16, v8
    v_and_b32 v41, 0xffff0000, v8
    v_lshlrev_b32 v42, 16, v9
    v_and_b32 v43, 0xffff0000, v9
    v_lshlrev_b32 v44, 16, v10
    v_and_b32 v45, 0xffff0000, v10
    v_lshlrev_b32 v46, 16, v11
    v_and_b32 v47, 0xffff0000, v11
    v_lshlrev_b32 v48, 16, v12
    v_and_b32 v49, 0xffff0000, v12
    v_lshlrev_b32 v50, 16, v13
    v_and_b32 v51, 0xffff0000, v13
    v_lshlrev_b32 v52, 16, v14
    v_and_b32 v53, 0xffff0000, v14
    v_lshlrev_b32 v54, 16, v15
    v_and_b32 v55, 0xffff0000, v15
    v_lshlrev_b32 v56, 16, v16
    v_and_b32 v57, 0xffff0000, v16
    v_lshlrev_b32 v58, 16, v17
    v_and_b32 v59, 0xffff0000, v17
    v_lshlrev_b32 v60, 16, v18
    v_and_b32 v61, 0xffff0000, v18
    v_lshlrev_b32 v62, 16, v19
    v_and_b32 v63, 0xffff0000, v19
    v_mov_b32 v64, 0
    v_mov_b32 v65, 0
    v_mov_b32 v66, 0
    v_mov_b32 v67, 0
    v_mov_b32 v68, 0
    v_mov_b32 v69, 0
    v_mov_b32 v70, 0
    v_mov_b32 v71, 0
    v_bfe_u32 v5, v0, 2, 2
    v_lshlrev_b32 v5, 8, v5
    v_lshrrev_b32 v8, 4, v0
    v_lshl_add_u32 v5, v8, 6, v5
    v_and_b32 v8, 3, v0
    v_lshl_add_u32 v5, v8, 4, v5
    s_lshl_b32 s56, s100, 10
    s_or_b32 s96, s59, 0
    s_cbranch_scc0 L_nofrag_112
    v_mov_b32 v104, 162060
L_lw_113:
    ds_read_b32 v105, v104
    s_waitcnt lgkmcnt(0)
    v_cmp_gt_u32 vcc, 4, v105
    s_cbranch_vccz L_lw_113e
    s_sleep 2
    s_sub_u32 s60, s60, 1
    s_cbranch_scc0 L_lw_113
    s_mov_b32 s60, 0
L_lw_113e:
    s_cmp_eq_u32 s59, 0
    s_cbranch_scc1 L_nofrag_112
    v_bfe_u32 v104, v0, 2, 1
    v_bfe_u32 v110, v0, 4, 1
    v_lshl_add_u32 v104, v110, 2, v104
    v_and_b32 v110, 8, v0
    v_add_u32 v104, v104, v110
    v_lshrrev_b32 v110, 5, v0
    v_lshl_add_u32 v104, v110, 4, v104
    v_bfe_u32 v111, v0, 0, 1
    v_mul_u32_u24 v111, 0xaaaa, v111
    v_add_u32 v111, 0x4444, v111
    v_mov_b32 v112, 0
    v_mov_b32 v113, 0
    v_mov_b32 v114, 0
    v_mov_b32 v115, 0
    v_mov_b32 v116, 0
    v_mov_b32 v117, 0
    v_mov_b32 v118, 0
    v_mov_b32 v119, 0
    v_lshlrev_b32 v104, 7, v104
    v_and_b32 v110, 3, v0
    v_lshl_add_u32 v104, v110, 3, v104
    v_lshrrev_b32 v109, 4, v0
    v_and_b32 v110, 1, v0
    s_lshr_b32 s63, s3, 1
    s_and_b32 s62, s3, 1
    s_lshl_b32 s96, s63, 14
    s_lshl_b32 s100, s62, 6
    s_add_u32 s100, s100, 81920
    s_add_u32 s96, s96, s100
    v_add_u32 v104, s96, v104
    ds_read_b64_tr_b16 v[72:73], v104 offset:0
    ds_read_b64_tr_b16 v[74:75], v104 offset:256
    ds_read_b64_tr_b16 v[76:77], v104 offset:4096
    ds_read_b64_tr_b16 v[78:79], v104 offset:4352
    ds_read_b64_tr_b16 v[80:81], v104 offset:32
    ds_read_b64_tr_b16 v[82:83], v104 offset:288
    ds_read_b64_tr_b16 v[84:85], v104 offset:4128
    ds_read_b64_tr_b16 v[86:87], v104 offset:4384
    ds_read_b64_tr_b16 v[88:89], v104 offset:8192
    ds_read_b64_tr_b16 v[90:91], v104 offset:8448
    ds_read_b64_tr_b16 v[92:93], v104 offset:12288
    ds_read_b64_tr_b16 v[94:95], v104 offset:12544
    ds_read_b64_tr_b16 v[96:97], v104 offset:8224
    ds_read_b64_tr_b16 v[98:99], v104 offset:8480
    ds_read_b64_tr_b16 v[100:101], v104 offset:12320
    ds_read_b64_tr_b16 v[102:103], v104 offset:12576
    v_bfe_u32 v105, v0, 1, 3
    v_lshlrev_b32 v105, 8, v105
    v_lshl_add_u32 v105, v109, 5, v105
    v_lshl_add_u32 v105, v110, 4, v105
    v_lshrrev_b32 v106, 3, v0
    v_lshlrev_b32 v106, 7, v106
    v_and_b32 v110, 7, v0
    v_lshl_add_u32 v107, v110, 3, v106
    v_add_u32 v107, s100, v107
    v_lshlrev_b32 v106, 8, v109
    v_and_b32 v110, 15, v0
    v_lshl_add_u32 v106, v110, 2, v106
    v_add_u32 v106, s96, v106
    v_lshlrev_b32 v108, 2, v0
    s_lshl_b32 s96, s62, 2
    s_add_u32 s96, s96, 162088
    v_mov_b32 v109, s96
    s_lshl_b32 s100, s63, 11
    s_lshl_b32 s96, s34, 13
    s_add_u32 s100, s100, s96
    s_add_u32 s100, s100, 106496
    s_mul_i32 s101, s34, 5120
    s_lshl_b32 s96, s35, 9
    s_add_u32 s101, s101, s96
    s_lshl_b32 s96, s62, 8
    s_add_u32 s101, s101, s96
    s_sub_u32 s101, s101, 11264
    s_and_b32 s96, s101, 0xffffe000
    s_add_u32 s101, s101, s96
    s_add_u32 s101, s101, 212992
    v_add_u32 v110, 8192, v108
L_nofrag_112:
    s_cmp_ge_u32 s35, 20
    s_cbranch_scc1 L_nofin_114
    s_lshl1_add_u32 s62, s35, s3
    s_sub_u32 s62, s62, 6
    s_lshl_b32 s57, s62, 7
    s_mul_i32 s63, s62, 0x199a
    s_lshr_b32 s63, s63, 16
    s_mul_i32 s63, s63, 1280
    s_sub_u32 s63, s57, s63
    v_lshrrev_b32 v72, 3, v0
    v_mul_u32_u24 v72, 5120, v72
    v_and_b32 v8, 7, v0
    v_lshl_add_u32 v72, v8, 4, v72
    s_add_u32 s62, s57, 327680
    v_add_u32 v72, s62, v72
    v_add_u32 v73, 40960, v72
    v_add_u32 v74, 81920, v72
    v_add_u32 v75, 122880, v72
    v_bfe_u32 v9, v0, 4, 1
    v_lshlrev_b32 v76, 4, v8
    v_lshl_add_u32 v76, v9, 3, v76
    s_lshl_b32 s62, s57, 1
    s_add_u32 s62, s62, 99328
    v_lshl_add_u32 v77, v76, 1, s62
    s_mov_b32 s48, s22
    s_mov_b32 s49, s23
    s_mov_b32 s50, 1280
    s_mov_b32 s51, 0x20000
    buffer_load_dwordx2 v[86:87], v76, s[48:51], s63 offen
    s_add_u32 s62, s57, 35840
    s_branch L_poll_115
L_poll_115s:
    s_sleep 32
L_poll_115:
    buffer_load_dwordx2 v[8:9], v76, s[40:43], s62 offen sc1
    s_sub_u32 s60, s60, 1
    s_cbranch_scc1 L_poll_115t
    s_waitcnt vmcnt(0)
    v_max_u32 v38, v8, v9
    v_cmp_eq_u32 vcc, -1, v38
    s_cbranch_vccnz L_poll_115s
L_poll_115e:
    v_lshlrev_b32 v78, 16, v86
    v_and_b32 v79, 0xffff0000, v86
    v_lshlrev_b32 v82, 16, v8
    v_and_b32 v83, 0xffff0000, v8
    v_lshlrev_b32 v80, 16, v87
    v_and_b32 v81, 0xffff0000, v87
    v_lshlrev_b32 v84, 16, v9
    v_and_b32 v85, 0xffff0000, v9
    v_bfe_u32 v8, v0, 1, 3
    v_and_b32 v9, 1, v0
    v_lshlrev_b32 v9, 4, v9
    v_mov_b32 v10, 0x3f80
    v_lshlrev_b32 v9, v9, v10
    v_cmp_eq_u32 vcc, 0, v8
    v_mov_b32 v100, 0
    s_nop 0
    v_cndmask_b32 v104, 0, v9, vcc
    v_cmp_eq_u32 vcc, 1, v8
    v_mov_b32 v101, 0
    s_nop 0
    v_cndmask_b32 v105, 0, v9, vcc
    v_cmp_eq_u32 vcc, 2, v8
    v_mov_b32 v102, 0
    s_nop 0
    v_cndmask_b32 v106, 0, v9, vcc
    v_cmp_eq_u32 vcc, 3, v8
    v_mov_b32 v103, 0
    s_nop 0
    v_cndmask_b32 v107, 0, v9, vcc
L_nofin_114:
    v_mov_b32 v12, 162076
L_lw_116:
    ds_read_b32 v13, v12
    s_waitcnt lgkmcnt(0)
    v_cmp_gt_u32 vcc, 4, v13
    s_cbranch_vccz L_lw_116e
    s_sleep 4
    s_sub_u32 s60, s60, 1
    s_cbranch_scc0 L_lw_116
    s_mov_b32 s60, 0
L_lw_116e:
    v_and_b32 v11, 31, v0
    v_lshlrev_b32 v11, 7, v11
    s_lshl_b32 s63, s34, 12
    s_add_u32 s63, s63, 73792
    buffer_load_dword v12, v39, s[40:43], s98 offen sc1
    s_branch L_poll_117
L_poll_117s:
    s_sleep 2
L_poll_117:
    buffer_load_dwordx2 v[8:9], v21, s[40:43], s99 offen sc1
    buffer_load_dword v10, v11, s[40:43], s63 offen sc1
    s_sub_u32 s60, s60, 1
    s_cbranch_scc1 L_poll_117t
    s_waitcnt vmcnt(0)
    v_max3_u32 v38, v8, v9, v10
    v_cmp_eq_u32 vcc, -1, v38
    s_cbranch_vccnz L_poll_117s
L_poll_117e:
    v_mov_b32 v37, v8
    s_nop 1
    v_max_f32_dpp v37, v37, v37 quad_perm:[1,0,3,2] row_mask:0xf bank_mask:0xf
    s_nop 1
    v_max_f32_dpp v37, v37, v37 quad_perm:[2,3,0,1] row_mask:0xf bank_mask:0xf
    s_nop 1
    v_max_f32_dpp v37, v37, v37 row_ror:4 row_mask:0xf bank_mask:0xf
    s_nop 1
    v_max_f32_dpp v37, v37, v37 row_ror:8 row_mask:0xf bank_mask:0xf
    v_sub_f32 v8, v8, v37
    v_exp_f32 v8, v8
    s_nop 0
    v_mul_f32 v9, v8, v9
    s_nop 1
    v_add_f32_dpp v9, v9, v9 quad_perm:[1,0,3,2] row_mask:0xf bank_mask:0xf
    s_nop 1
    v_add_f32_dpp v9, v9, v9 quad_perm:[2,3,0,1] row_mask:0xf bank_mask:0xf
    s_nop 1
    v_add_f32_dpp v9, v9, v9 row_ror:4 row_mask:0xf bank_mask:0xf
    s_nop 1
    v_add_f32_dpp v9, v9, v9 row_ror:8 row_mask:0xf bank_mask:0xf
    v_ashrrev_i32 v12, 8, v10
    s_nop 1
    v_add_u32_dpp v12, v12, v12 quad_perm:[1,0,3,2] row_mask:0xf bank_mask:0xf
    s_nop 1
    v_add_u32_dpp v12, v12, v12 quad_perm:[2,3,0,1] row_mask:0xf bank_mask:0xf
    s_nop 1
    v_add_u32_dpp v12, v12, v12 row_ror:4 row_mask:0xf bank_mask:0xf
    s_nop 1
    v_add_u32_dpp v12, v12, v12 row_ror:8 row_mask:0xf bank_mask:0xf
    v_mov_b32 v13, v12
    s_nop 1
    v_permlane16_swap_b32 v12, v13
    v_add_u32 v12, v12, v13
    v_mov_b32 v13, v12
    s_nop 1
    v_permlane32_swap_b32 v12, v13
    v_add_u32 v12, v12, v13
    v_ashrrev_i32 v12, 31, v12
    v_and_b32 v12, 8192, v12
    v_mov_b32 v13, 162084
    ds_write_b32 v13, v12
    v_and_b32 v10, 0xff, v10
    s_getreg_b32 s62, hwreg(HW_REG_XCC_ID, 0, 4)
    v_cmp_ne_u32 vcc, s62, v10
    s_nop 0
    s_cmp_eq_u64 vcc, 0
    s_cselect_b32 s61, 1, 0
    v_rcp_f32 v9, v9
    v_lshrrev_b32 v3, 1, v2
    v_add_u32 v3, 161984, v3
    v_mul_f32 v8, v8, v9
    v_mov_b32 v10, 162072
    v_mov_b32 v11, s61
    ds_write_b32 v3, v8
    ds_write_b32 v10, v11
    s_cmp_eq_u32 s61, 1
    s_cbranch_scc0 L_ycs
    buffer_store_dwordx4 v[24:27], v22, s[40:43], 0 offen offset:0
    buffer_store_dwordx4 v[24:27], v22, s[40:43], 0 offen offset:1024
    buffer_store_dwordx4 v[24:27], v22, s[40:43], 0 offen offset:2048
    buffer_store_dwordx4 v[24:27], v22, s[40:43], 0 offen offset:3072
    buffer_store_dwordx4 v[24:27], v23, s[40:43], 0 offen offset:0
L_ycd:
    s_branch L_poll_118
L_poll_118s:
    s_sleep 2
L_poll_118:
    buffer_load_dwordx4 v[32:35], v20, s[40:43], s97 offen sc1
    s_sub_u32 s60, s60, 1
    s_cbranch_scc1 L_poll_118t
    s_waitcnt vmcnt(0)
    v_max3_u32 v38, v32, v33, v34
    v_max_u32 v38, v38, v35
    v_cmp_eq_u32 vcc, -1, v38
    s_cbranch_vccnz L_poll_118s
L_poll_118e:
    s_branch L_pxj
L_px6:
    s_or_b32 s96, s59, s39
    s_cbranch_scc0 L_nofrag_119
    v_mov_b32 v104, 162060
L_lw_120:
    ds_read_b32 v105, v104
    s_waitcnt lgkmcnt(0)
    v_cmp_gt_u32 vcc, 4, v105
    s_cbranch_vccz L_lw_120e
    s_sleep 2
    s_sub_u32 s60, s60, 1
    s_cbranch_scc0 L_lw_120
    s_mov_b32 s60, 0
L_lw_120e:
    s_cmp_eq_u32 s59, 0
    s_cbranch_scc1 L_nofrag_119
    v_bfe_u32 v104, v0, 2, 1
    v_bfe_u32 v110, v0, 4, 1
    v_lshl_add_u32 v104, v110, 2, v104
    v_and_b32 v110, 8, v0
    v_add_u32 v104, v104, v110
    v_lshrrev_b32 v110, 5, v0
    v_lshl_add_u32 v104, v110, 4, v104
    v_bfe_u32 v111, v0, 0, 1
    v_mul_u32_u24 v111, 0xaaaa, v111
    v_add_u32 v111, 0x4444, v111
    v_mov_b32 v112, 0
    v_mov_b32 v113, 0
    v_mov_b32 v114, 0
    v_mov_b32 v115, 0
    v_mov_b32 v116, 0
    v_mov_b32 v117, 0
    v_mov_b32 v118, 0
    v_mov_b32 v119, 0
    v_lshlrev_b32 v104, 7, v104
    v_and_b32 v110, 3, v0
    v_lshl_add_u32 v104, v110, 3, v104
    v_lshrrev_b32 v109, 4, v0
    v_and_b32 v110, 1, v0
    s_lshr_b32 s63, s3, 1
    s_and_b32 s62, s3, 1
    s_lshl_b32 s96, s63, 14
    s_lshl_b32 s100, s62, 6
    s_add_u32 s100, s100, 81920
    s_add_u32 s96, s96, s100
    v_add_u32 v104, s96, v104
    ds_read_b64_tr_b16 v[72:73], v104 offset:0
    ds_read_b64_tr_b16 v[74:75], v104 offset:256
    ds_read_b64_tr_b16 v[76:77], v104 offset:4096
    ds_read_b64_tr_b16 v[78:79], v104 offset:4352
    ds_read_b64_tr_b16 v[80:81], v104 offset:32
    ds_read_b64_tr_b16 v[82:83], v104 offset:288
    ds_read_b64_tr_b16 v[84:85], v104 offset:4128
    ds_read_b64_tr_b16 v[86:87], v104 offset:4384
    ds_read_b64_tr_b16 v[88:89], v104 offset:8192
    ds_read_b64_tr_b16 v[90:91], v104 offset:8448
    ds_read_b64_tr_b16 v[92:93], v104 offset:12288
    ds_read_b64_tr_b16 v[94:95], v104 offset:12544
    ds_read_b64_tr_b16 v[96:97], v104 offset:8224
    ds_read_b64_tr_b16 v[98:99], v104 offset:8480
    ds_read_b64_tr_b16 v[100:101], v104 offset:12320
    ds_read_b64_tr_b16 v[102:103], v104 offset:12576
    v_bfe_u32 v105, v0, 1, 3
    v_lshlrev_b32 v105, 8, v105
    v_lshl_add_u32 v105, v109, 5, v105
    v_lshl_add_u32 v105, v110, 4, v105
    v_lshrrev_b32 v106, 3, v0
    v_lshlrev_b32 v106, 7, v106
    v_and_b32 v110, 7, v0
    v_lshl_add_u32 v107, v110, 3, v106
    v_add_u32 v107, s100, v107
    v_lshlrev_b32 v106, 8, v109
    v_and_b32 v110, 15, v0
    v_lshl_add_u32 v106, v110, 2, v106
    v_add_u32 v106, s96, v106
    v_lshlrev_b32 v108, 2, v0
    s_lshl_b32 s96, s62, 2
    s_add_u32 s96, s96, 162088
    v_mov_b32 v109, s96
    s_lshl_b32 s100, s63, 11
    s_lshl_b32 s96, s34, 13
    s_add_u32 s100, s100, s96
    s_add_u32 s100, s100, 106496
    s_mul_i32 s101, s34, 5120
    s_lshl_b32 s96, s35, 9
    s_add_u32 s101, s101, s96
    s_lshl_b32 s96, s62, 8
    s_add_u32 s101, s101, s96
    s_sub_u32 s101, s101, 11264
    s_and_b32 s96, s101, 0xffffe000
    s_add_u32 s101, s101, s96
    s_add_u32 s101, s101, 212992
    v_add_u32 v110, 8192, v108
L_nofrag_119:
    s_mov_b32 s62, 3
    s_lshl1_add_u32 s96, s35, s3
    s_and_b32 s63, s96, 7
    s_lshl_b32 s63, s63, 14
    s_lshl_b32 s96, s96, 7
    s_add_u32 s96, s96, s63
    s_add_u32 s96, s96, 475136
    s_add_u32 s98, s32, s96
    s_addc_u32 s99, s33, 0
    s_load_dword s4, s[98:99], 0 glc
    s_load_dword s5, s[98:99], 8192 glc
    s_mov_b32 s63, 0
    s_waitcnt lgkmcnt(0)
L_np:
    s_not_b32 s4, s4
    s_mov_b32 s6, s4
    s_mov_b32 s7, 0
    s_load_dword s4, s[98:99], 0 glc
L_npc0:
    s_add_u32 s7, s7, 1
    s_cmp_eq_u32 s4, s6
    s_cselect_b32 s8, s7, 1000
    s_cmp_lt_u32 s8, 60
    s_cbranch_scc1 L_npc0
    s_waitcnt lgkmcnt(0)
    s_sub_u32 s63, s63, s7
    s_not_b32 s5, s5
    s_mov_b32 s6, s5
    s_mov_b32 s7, 0
    s_load_dword s5, s[98:99], 8192 glc
L_npc1:
    s_add_u32 s7, s7, 1
    s_cmp_eq_u32 s5, s6
    s_cselect_b32 s8, s7, 1000
    s_cmp_lt_u32 s8, 60
    s_cbranch_scc1 L_npc1
    s_waitcnt lgkmcnt(0)
    s_add_u32 s63, s63, s7
    s_sub_u32 s62, s62, 1
    s_cmp_lg_u32 s62, 0
    s_cbranch_scc1 L_np
    v_mov_b32 v8, 162096
    v_mov_b32 v9, s63
    s_mov_b64 exec, 1
    ds_add_u32 v8, v9
    s_mov_b64 exec, -1
    v_mov_b32 v8, 162068
L_lw_121:
    ds_read_b32 v9, v8
    s_waitcnt lgkmcnt(0)
    v_cmp_gt_u32 vcc, 1, v9
    s_cbranch_vccz L_lw_121e
    s_sleep 32
    s_sub_u32 s60, s60, 1
    s_cbranch_scc0 L_lw_121
    s_mov_b32 s60, 0
L_lw_121e:
    s_cmp_ge_u32 s35, 20
    s_cbranch_scc1 L_nofin_122
    s_lshl1_add_u32 s62, s35, s3
    s_sub_u32 s62, s62, 6
    s_lshl_b32 s57, s62, 7
    s_mul_i32 s63, s62, 0x199a
    s_lshr_b32 s63, s63, 16
    s_mul_i32 s63, s63, 1280
    s_sub_u32 s63, s57, s63
    v_lshrrev_b32 v72, 3, v0
    v_mul_u32_u24 v72, 5120, v72
    v_and_b32 v8, 7, v0
    v_lshl_add_u32 v72, v8, 4, v72
    s_add_u32 s62, s57, 327680
    v_add_u32 v72, s62, v72
    v_add_u32 v73, 40960, v72
    v_add_u32 v74, 81920, v72
    v_add_u32 v75, 122880, v72
    v_bfe_u32 v9, v0, 4, 1
    v_lshlrev_b32 v76, 4, v8
    v_lshl_add_u32 v76, v9, 3, v76
    s_lshl_b32 s62, s57, 1
    s_add_u32 s62, s62, 99328
    v_lshl_add_u32 v77, v76, 1, s62
    s_mov_b32 s48, s22
    s_mov_b32 s49, s23
    s_mov_b32 s50, 1280
    s_mov_b32 s51, 0x20000
    buffer_load_dwordx2 v[86:87], v76, s[48:51], s63 offen
    s_add_u32 s62, s57, 35840
    s_branch L_poll_123
L_poll_123s:
    s_sleep 32
L_poll_123:
    buffer_load_dwordx2 v[8:9], v76, s[40:43], s62 offen sc1
    s_sub_u32 s60, s60, 1
    s_cbranch_scc1 L_poll_123t
    s_waitcnt vmcnt(0)
    v_max_u32 v38, v8, v9
    v_cmp_eq_u32 vcc, -1, v38
    s_cbranch_vccnz L_poll_123s
L_poll_123e:
    v_lshlrev_b32 v78, 16, v86
    v_and_b32 v79, 0xffff0000, v86
    v_lshlrev_b32 v82, 16, v8
    v_and_b32 v83, 0xffff0000, v8
    v_lshlrev_b32 v80, 16, v87
    v_and_b32 v81, 0xffff0000, v87
    v_lshlrev_b32 v84, 16, v9
    v_and_b32 v85, 0xffff0000, v9
    v_bfe_u32 v8, v0, 1, 3
    v_and_b32 v9, 1, v0
    v_lshlrev_b32 v9, 4, v9
    v_mov_b32 v10, 0x3f80
    v_lshlrev_b32 v9, v9, v10
    v_cmp_eq_u32 vcc, 0, v8
    v_mov_b32 v100, 0
    s_nop 0
    v_cndmask_b32 v104, 0, v9, vcc
    v_cmp_eq_u32 vcc, 1, v8
    v_mov_b32 v101, 0
    s_nop 0
    v_cndmask_b32 v105, 0, v9, vcc
    v_cmp_eq_u32 vcc, 2, v8
    v_mov_b32 v102, 0
    s_nop 0
    v_cndmask_b32 v106, 0, v9, vcc
    v_cmp_eq_u32 vcc, 3, v8
    v_mov_b32 v103, 0
    s_nop 0
    v_cndmask_b32 v107, 0, v9, vcc
L_nofin_122:
    v_mov_b32 v8, 162076
L_lw_124:
    ds_read_b32 v9, v8
    s_waitcnt lgkmcnt(0)
    v_cmp_gt_u32 vcc, 4, v9
    s_cbranch_vccz L_lw_124e
    s_sleep 16
    s_sub_u32 s60, s60, 1
    s_cbranch_scc0 L_lw_124
    s_mov_b32 s60, 0
L_lw_124e:
    s_branch L_poll_125
L_poll_125s:
    s_sleep 2
L_poll_125:
    buffer_load_dwordx4 v[32:35], v20, s[40:43], s97 offen sc1
    s_sub_u32 s60, s60, 1
    s_cbranch_scc1 L_poll_125t
    s_waitcnt vmcnt(0)
    v_max3_u32 v38, v32, v33, v34
    v_max_u32 v38, v38, v35
    v_cmp_eq_u32 vcc, -1, v38
    s_cbranch_vccnz L_poll_125s
L_poll_125e:
L_pxj:
    s_cmp_ge_u32 s35, 20
    s_cbranch_scc1 L_pxk
    s_mov_b64 exec, -1
L_pxk:
    v_mov_b32 v8, 162048
L_lw_126:
    ds_read_b32 v9, v8
    s_waitcnt lgkmcnt(0)
    v_cmp_gt_u32 vcc, 3, v9
    s_cbranch_vccz L_lw_126e
    s_sleep 2
    s_sub_u32 s60, s60, 1
    s_cbranch_scc0 L_lw_126
    s_mov_b32 s60, 0
L_lw_126e:
    v_lshrrev_b32 v9, 4, v0
    v_lshl_add_u32 v8, v9, 2, v2
    s_lshl_b32 s96, s3, 9
    s_add_u32 s96, s96, 157824
    v_lshl_add_u32 v8, v8, 2, s96
    v_lshlrev_b32 v9, 3, v0
    v_add_u32 v9, 157824, v9
    v_mov_b32 v10, 162048
    v_mov_b32 v11, 1
    s_lshl_b32 s96, s38, 5
    s_add_u32 s96, s96, 161984
    v_mov_b32 v3, s96
    s_sub_u32 s62, 8, s39
    s_lshl_b32 s98, s34, 5
    s_add_u32 s98, s98, s35
    s_lshl_b32 s98, s98, 8
    s_add_u32 s98, s98, 106496
    v_lshlrev_b32 v39, 2, v0
    s_branch L_t0
L_s_role:
    s_cmp_eq_u32 s3, 7
    s_cbranch_scc1 L_t2gate
    s_cmp_gt_u32 s3, 3
    s_cbranch_scc1 L_fin_prep
    s_mov_b32 s48, s18
    s_mov_b32 s49, s19
    s_mov_b32 s50, 3456
    s_mov_b32 s51, 0x20000
    v_lshrrev_b32 v3, 4, v0
    v_and_b32 v4, 15, v0
    v_lshlrev_b32 v4, 1, v4
    s_lshl_b32 s62, s35, 7
    s_lshl_b32 s63, s3, 5
    s_add_u32 s62, s62, s63
    buffer_load_ushort v82, v4, s[48:51], s62 offen
    v_mov_b32 v72, 162064
L_lw_127:
    ds_read_b32 v73, v72
    s_waitcnt lgkmcnt(0)
    v_cmp_gt_u32 vcc, 4, v73
    s_cbranch_vccz L_lw_127e
    s_sleep 2
    s_sub_u32 s60, s60, 1
    s_cbranch_scc0 L_lw_127
    s_mov_b32 s60, 0
L_lw_127e:
    v_bfe_u32 v72, v0, 2, 1
    v_bfe_u32 v73, v0, 4, 1
    v_lshl_add_u32 v72, v73, 2, v72
    v_and_b32 v73, 8, v0
    v_add_u32 v72, v72, v73
    v_lshrrev_b32 v73, 5, v0
    v_lshl_add_u32 v72, v73, 4, v72
    v_lshlrev_b32 v72, 7, v72
    v_and_b32 v73, 3, v0
    v_lshl_add_u32 v72, v73, 3, v72
    v_and_b32 v73, 8, v0
    v_lshl_add_u32 v72, v73, 3, v72
    v_xor_b32 v72, s63, v72
    v_xor_b32 v73, 32, v72
    v_add_u32 v74, 40960, v72
    v_add_u32 v75, 40960, v73
    v_bfe_u32 v1, v0, 2, 2
    v_bfe_u32 v2, v0, 1, 1
    v_and_b32 v6, 1, v0
    v_lshlrev_b32 v7, 5, v3
    v_lshl_add_u32 v7, v6, 4, v7
    v_lshl_add_u32 v5, v2, 2, v1
    v_mul_u32_u24 v5, 1296, v5
    v_add_u32 v5, v5, v7
    v_add_u32 v5, 147456, v5
    v_bfe_u32 v87, v0, 0, 1
    v_mul_u32_u24 v87, 0xaaaa, v87
    v_add_u32 v87, 0x4444, v87
    ds_read_b64_tr_b16 v[88:89], v72 offset:0
    ds_read_b64_tr_b16 v[90:91], v73 offset:256
    ds_read_b64_tr_b16 v[92:93], v72 offset:4096
    ds_read_b64_tr_b16 v[94:95], v73 offset:4352
    ds_read_b64_tr_b16 v[96:97], v72 offset:8192
    ds_read_b64_tr_b16 v[98:99], v73 offset:8448
    ds_read_b64_tr_b16 v[100:101], v72 offset:12288
    ds_read_b64_tr_b16 v[102:103], v73 offset:12544
    ds_read_b64_tr_b16 v[104:105], v72 offset:16384
    ds_read_b64_tr_b16 v[106:107], v73 offset:16640
    ds_read_b64_tr_b16 v[108:109], v72 offset:20480
    ds_read_b64_tr_b16 v[110:111], v73 offset:20736
    ds_read_b64_tr_b16 v[112:113], v72 offset:24576
    ds_read_b64_tr_b16 v[114:115], v73 offset:24832
    ds_read_b64_tr_b16 v[116:117], v72 offset:28672
    ds_read_b64_tr_b16 v[118:119], v73 offset:28928
    ds_read_b64_tr_b16 v[120:121], v72 offset:32768
    ds_read_b64_tr_b16 v[122:123], v73 offset:33024
    ds_read_b64_tr_b16 v[124:125], v72 offset:36864
    ds_read_b64_tr_b16 v[126:127], v73 offset:37120
    ds_read_b64_tr_b16 v[128:129], v74 offset:0
    ds_read_b64_tr_b16 v[130:131], v75 offset:256
    ds_read_b64_tr_b16 v[132:133], v74 offset:4096
    ds_read_b64_tr_b16 v[134:135], v75 offset:4352
    ds_read_b64_tr_b16 v[136:137], v74 offset:8192
    ds_read_b64_tr_b16 v[138:139], v75 offset:8448
    ds_read_b64_tr_b16 v[140:141], v74 offset:12288
    ds_read_b64_tr_b16 v[142:143], v75 offset:12544
    ds_read_b64_tr_b16 v[144:145], v74 offset:16384
    ds_read_b64_tr_b16 v[146:147], v75 offset:16640
    ds_read_b64_tr_b16 v[148:149], v74 offset:20480
    ds_read_b64_tr_b16 v[150:151], v75 offset:20736
    ds_read_b64_tr_b16 v[152:153], v74 offset:24576
    ds_read_b64_tr_b16 v[154:155], v75 offset:24832
    ds_read_b64_tr_b16 v[156:157], v74 offset:28672
    ds_read_b64_tr_b16 v[158:159], v75 offset:28928
    ds_read_b64_tr_b16 v[160:161], v74 offset:32768
    ds_read_b64_tr_b16 v[162:163], v75 offset:33024
    ds_read_b64_tr_b16 v[164:165], v74 offset:36864
    ds_read_b64_tr_b16 v[166:167], v75 offset:37120
    ds_read_b128 v[8:11], v5 offset:0
    ds_read_b128 v[12:15], v5 offset:128
    ds_read_b128 v[16:19], v5 offset:256
    ds_read_b128 v[20:23], v5 offset:384
    ds_read_b128 v[24:27], v5 offset:512
    ds_read_b128 v[28:31], v5 offset:640
    ds_read_b128 v[32:35], v5 offset:768
    ds_read_b128 v[36:39], v5 offset:896
    ds_read_b128 v[40:43], v5 offset:1024
    ds_read_b128 v[44:47], v5 offset:1152
    v_mov_b32 v48, 0
    v_mov_b32 v49, 0
    v_mov_b32 v50, 0
    v_mov_b32 v51, 0
    v_mov_b32 v52, 0
    v_mov_b32 v53, 0
    v_mov_b32 v54, 0
    v_mov_b32 v55, 0
    v_mov_b32 v56, 0
    v_mov_b32 v57, 0
    v_mov_b32 v58, 0
    v_mov_b32 v59, 0
    s_waitcnt lgkmcnt(9)
    v_smfmac_f32_16x16x64_bf16 v[48:51], v[8:11], v[88:95], v87
    s_waitcnt lgkmcnt(8)
    v_smfmac_f32_16x16x64_bf16 v[48:51], v[12:15], v[96:103], v87
    s_waitcnt lgkmcnt(7)
    v_smfmac_f32_16x16x64_bf16 v[48:51], v[16:19], v[104:111], v87
    s_waitcnt lgkmcnt(6)
    v_smfmac_f32_16x16x64_bf16 v[48:51], v[20:23], v[112:119], v87
    s_waitcnt lgkmcnt(5)
    v_smfmac_f32_16x16x64_bf16 v[48:51], v[24:27], v[120:127], v87
    s_waitcnt lgkmcnt(4)
    v_smfmac_f32_16x16x64_bf16 v[48:51], v[28:31], v[128:135], v87
    s_waitcnt lgkmcnt(3)
    v_smfmac_f32_16x16x64_bf16 v[48:51], v[32:35], v[136:143], v87
    s_waitcnt lgkmcnt(2)
    v_smfmac_f32_16x16x64_bf16 v[48:51], v[36:39], v[144:151], v87
    s_waitcnt lgkmcnt(1)
    v_smfmac_f32_16x16x64_bf16 v[48:51], v[40:43], v[152:159], v87
    s_waitcnt lgkmcnt(0)
    v_smfmac_f32_16x16x64_bf16 v[48:51], v[44:47], v[160:167], v87
    v_mul_u32_u24 v79, 1296, v1
    v_lshl_add_u32 v79, v2, 7, v79
    v_add_u32 v79, v79, v7
    v_add_u32 v79, 82944, v79
    v_mul_u32_u24 v80, 144, v3
    v_add3_u32 v80, v80, v4, s63
    v_add_u32 v80, 90688, v80
    v_lshlrev_b32 v81, 3, v0
    v_add_u32 v81, 88128, v81
    v_add_f32 v84, v48, v49
    v_add_f32 v85, v50, v51
    s_mov_b32 s62, 0xbacccccd
    s_mov_b32 s63, 0xbdd2d3e8
    v_mov_b32 v86, 0xc0135761
    s_waitcnt vmcnt(0)
    v_lshlrev_b32 v82, 16, v82
    v_add_f32 v85, v85, v82
    s_branch L_ffn1
L_fin_prep:
    s_cmp_lg_u32 s3, 6
    s_cbranch_scc1 L_end
    s_cmp_ge_u32 s35, 20
    s_cbranch_scc1 L_end
    s_barrier
L_fin:
    s_mov_b32 s52, s28
    s_mov_b32 s53, s29
    s_mov_b32 s54, 5120
    s_mov_b32 s55, 0x20000
    s_mov_b64 s[4:5], -1
    s_mov_b64 s[6:7], -1
    s_mov_b64 s[8:9], -1
    s_mov_b64 s[10:11], 0xffffff
    s_barrier
    ds_read_b128 v[108:111], v77
    s_waitcnt lgkmcnt(0)
    v_pk_fma_f32 v[108:109], v[78:79], v[82:83], v[108:109]
    v_pk_fma_f32 v[110:111], v[80:81], v[84:85], v[110:111]
    s_barrier
L_yg:
    s_mov_b64 exec, s[4:5]
    buffer_load_dwordx4 v[88:91], v72, s[40:43], 0 offen sc1
    s_mov_b64 exec, s[6:7]
    buffer_load_dwordx4 v[92:95], v73, s[40:43], 0 offen sc1
    s_mov_b64 exec, s[8:9]
    buffer_load_dwordx4 v[96:99], v74, s[40:43], 0 offen sc1
    s_mov_b64 exec, s[10:11]
    buffer_load_dwordx4 v[100:103], v75, s[40:43], 0 offen sc1
    s_mov_b64 exec, -1
    s_sub_u32 s60, s60, 1
    s_cbranch_scc1 L_ygt
    s_waitcnt vmcnt(3)
    v_max3_u32 v3, v88, v89, v90
    v_max_u32 v3, v3, v91
    v_cmp_eq_u32 s[4:5], -1, v3
    v_mfma_f32_16x16x32_bf16 v[112:115], v[104:107], v[88:91], 0
    s_waitcnt vmcnt(2)
    v_max3_u32 v3, v92, v93, v94
    v_max_u32 v3, v3, v95
    v_cmp_eq_u32 s[6:7], -1, v3
    v_mfma_f32_16x16x32_bf16 v[112:115], v[104:107], v[92:95], v[112:115]
    s_waitcnt vmcnt(1)
    v_max3_u32 v3, v96, v97, v98
    v_max_u32 v3, v3, v99
    v_cmp_eq_u32 s[8:9], -1, v3
    v_mfma_f32_16x16x32_bf16 v[112:115], v[104:107], v[96:99], v[112:115]
    s_waitcnt vmcnt(0)
    v_max3_u32 v3, v100, v101, v102
    v_max_u32 v3, v3, v103
    v_cmp_eq_u32 s[10:11], -1, v3
    v_mfma_f32_16x16x32_bf16 v[112:115], v[104:107], v[100:103], v[112:115]
    s_or_b64 s[16:17], s[4:5], s[6:7]
    s_or_b64 s[16:17], s[16:17], s[8:9]
    s_or_b64 s[16:17], s[16:17], s[10:11]
    s_cbranch_scc1 L_yg
L_ygd:
    s_nop 3
    v_add_f32_dpp v112, v112, v112 row_ror:8 row_mask:0xf bank_mask:0xf
    v_add_f32_dpp v113, v113, v113 row_ror:8 row_mask:0xf bank_mask:0xf
    v_add_f32_dpp v114, v114, v114 row_ror:8 row_mask:0xf bank_mask:0xf
    v_add_f32_dpp v115, v115, v115 row_ror:8 row_mask:0xf bank_mask:0xf
    v_pk_fma_f32 v[112:113], v[112:113], v[82:83], v[108:109]
    v_pk_fma_f32 v[114:115], v[114:115], v[84:85], v[110:111]
    v_cvt_pk_bf16_f32 v112, v112, v113
    v_cvt_pk_bf16_f32 v113, v114, v115
    s_mov_b64 exec, 0x00ff00ff
    buffer_store_dwordx2 v[112:113], v76, s[52:55], s57 offen
    s_endpgm
L_t2gate:
    v_mov_b32 v8, 162048
L_lw_128:
    ds_read_b32 v9, v8
    s_waitcnt lgkmcnt(0)
    v_cmp_gt_u32 vcc, 8, v9
    s_cbranch_vccz L_lw_128e
    s_sleep 2
    s_sub_u32 s60, s60, 1
    s_cbranch_scc0 L_lw_128
    s_mov_b32 s60, 0
L_lw_128e:
    ds_read_b32 v9, v8 offset:24
    ds_read_b32 v10, v8 offset:36
    v_add_u32 v5, 212992, v5
    s_waitcnt lgkmcnt(0)
    v_readfirstlane_b32 s61, v9
    v_add_u32 v5, v5, v10
    s_mov_b32 s58, 0x3f80
    s_mov_b32 s59, 0x3f800000
    s_mov_b32 s63, 0xff
L_prb:
    s_bcnt1_i32_b32 s62, s63
    s_mov_b32 s97, s63
    s_ff1_i32_b32 s12, s97
    s_bitset0_b32 s97, s12
    s_mul_i32 s4, s12, 5120
    s_add_u32 s4, s4, s56
    s_and_b32 s96, s4, 0xffffe000
    s_add_u32 s4, s4, s96
    s_cmp_eq_u32 s62, 1
    s_cbranch_scc1 L_pi1
    s_ff1_i32_b32 s13, s97
    s_bitset0_b32 s97, s13
    s_mul_i32 s5, s13, 5120
    s_add_u32 s5, s5, s56
    s_and_b32 s96, s5, 0xffffe000
    s_add_u32 s5, s5, s96
    s_cmp_eq_u32 s62, 2
    s_cbranch_scc1 L_pi2
    s_ff1_i32_b32 s14, s97
    s_bitset0_b32 s97, s14
    s_mul_i32 s6, s14, 5120
    s_add_u32 s6, s6, s56
    s_and_b32 s96, s6, 0xffffe000
    s_add_u32 s6, s6, s96
    s_cmp_eq_u32 s62, 3
    s_cbranch_scc1 L_pi3
    s_ff1_i32_b32 s15, s97
    s_bitset0_b32 s97, s15
    s_mul_i32 s7, s15, 5120
    s_add_u32 s7, s7, s56
    s_and_b32 s96, s7, 0xffffe000
    s_add_u32 s7, s7, s96
    s_cmp_eq_u32 s62, 4
    s_cbranch_scc1 L_pi4
    s_ff1_i32_b32 s16, s97
    s_bitset0_b32 s97, s16
    s_mul_i32 s8, s16, 5120
    s_add_u32 s8, s8, s56
    s_and_b32 s96, s8, 0xffffe000
    s_add_u32 s8, s8, s96
    s_cmp_eq_u32 s62, 5
    s_cbranch_scc1 L_pi5
    s_ff1_i32_b32 s17, s97
    s_bitset0_b32 s97, s17
    s_mul_i32 s9, s17, 5120
    s_add_u32 s9, s9, s56
    s_and_b32 s96, s9, 0xffffe000
    s_add_u32 s9, s9, s96
    s_cmp_eq_u32 s62, 6
    s_cbranch_scc1 L_pi6
    s_ff1_i32_b32 s18, s97
    s_bitset0_b32 s97, s18
    s_mul_i32 s10, s18, 5120
    s_add_u32 s10, s10, s56
    s_and_b32 s96, s10, 0xffffe000
    s_add_u32 s10, s10, s96
    s_cmp_eq_u32 s62, 7
    s_cbranch_scc1 L_pi7
    s_ff1_i32_b32 s19, s97
    s_bitset0_b32 s97, s19
    s_mul_i32 s11, s19, 5120
    s_add_u32 s11, s11, s56
    s_and_b32 s96, s11, 0xffffe000
    s_add_u32 s11, s11, s96
L_pi8:
    buffer_load_dwordx4 v[36:39], v5, s[40:43], s11 offen sc1
L_pi7:
    buffer_load_dwordx4 v[32:35], v5, s[40:43], s10 offen sc1
L_pi6:
    buffer_load_dwordx4 v[28:31], v5, s[40:43], s9 offen sc1
L_pi5:
    buffer_load_dwordx4 v[24:27], v5, s[40:43], s8 offen sc1
L_pi4:
    buffer_load_dwordx4 v[20:23], v5, s[40:43], s7 offen sc1
L_pi3:
    buffer_load_dwordx4 v[16:19], v5, s[40:43], s6 offen sc1
L_pi2:
    buffer_load_dwordx4 v[12:15], v5, s[40:43], s5 offen sc1
    buffer_load_dwordx4 v[8:11], v5, s[40:43], s4 offen sc1
    s_sub_u32 s60, s60, 1
    s_cbranch_scc1 L_pto
    s_waitcnt vmcnt(0)
    v_max3_u32 v3, v8, v9, v10
    v_max_u32 v3, v3, v11
    v_cmp_eq_u32 vcc, -1, v3
    s_cbranch_vccz L_pgot0
    v_max3_u32 v3, v12, v13, v14
    v_max_u32 v3, v3, v15
    v_cmp_eq_u32 vcc, -1, v3
    s_cbranch_vccz L_pgot1
    s_cmp_eq_u32 s62, 2
    s_cbranch_scc1 L_pi2
    v_max3_u32 v3, v16, v17, v18
    v_max_u32 v3, v3, v19
    v_cmp_eq_u32 vcc, -1, v3
    s_cbranch_vccz L_pgot2
    s_cmp_eq_u32 s62, 3
    s_cbranch_scc1 L_pi3
    v_max3_u32 v3, v20, v21, v22
    v_max_u32 v3, v3, v23
    v_cmp_eq_u32 vcc, -1, v3
    s_cbranch_vccz L_pgot3
    s_cmp_eq_u32 s62, 4
    s_cbranch_scc1 L_pi4
    v_max3_u32 v3, v24, v25, v26
    v_max_u32 v3, v3, v27
    v_cmp_eq_u32 vcc, -1, v3
    s_cbranch_vccz L_pgot4
    s_cmp_eq_u32 s62, 5
    s_cbranch_scc1 L_pi5
    v_max3_u32 v3, v28, v29, v30
    v_max_u32 v3, v3, v31
    v_cmp_eq_u32 vcc, -1, v3
    s_cbranch_vccz L_pgot5
    s_cmp_eq_u32 s62, 6
    s_cbranch_scc1 L_pi6
    v_max3_u32 v3, v32, v33, v34
    v_max_u32 v3, v3, v35
    v_cmp_eq_u32 vcc, -1, v3
    s_cbranch_vccz L_pgot6
    s_cmp_eq_u32 s62, 7
    s_cbranch_scc1 L_pi7
    v_max3_u32 v3, v36, v37, v38
    v_max_u32 v3, v3, v39
    v_cmp_eq_u32 vcc, -1, v3
    s_cbranch_vccz L_pgot7
    s_branch L_pi8
L_pgot0:
    v_dot2c_f32_bf16 v64, s58, v8
    v_dot2c_f32_bf16 v65, s59, v8
    v_dot2c_f32_bf16 v66, s58, v9
    v_dot2c_f32_bf16 v67, s59, v9
    v_dot2c_f32_bf16 v68, s58, v10
    v_dot2c_f32_bf16 v69, s59, v10
    v_dot2c_f32_bf16 v70, s58, v11
    v_dot2c_f32_bf16 v71, s59, v11
    s_bitset0_b32 s63, s12
    s_cmp_eq_u32 s63, 0
    s_cbranch_scc1 L_pgd
L_pn0:
    s_cmp_eq_u32 s62, 1
    s_cbranch_scc1 L_prb
    v_max3_u32 v3, v12, v13, v14
    v_max_u32 v3, v3, v15
    v_cmp_eq_u32 vcc, -1, v3
    s_cbranch_vccnz L_pn1
L_pgot1:
    v_dot2c_f32_bf16 v64, s58, v12
    v_dot2c_f32_bf16 v65, s59, v12
    v_dot2c_f32_bf16 v66, s58, v13
    v_dot2c_f32_bf16 v67, s59, v13
    v_dot2c_f32_bf16 v68, s58, v14
    v_dot2c_f32_bf16 v69, s59, v14
    v_dot2c_f32_bf16 v70, s58, v15
    v_dot2c_f32_bf16 v71, s59, v15
    s_bitset0_b32 s63, s13
    s_cmp_eq_u32 s63, 0
    s_cbranch_scc1 L_pgd
L_pn1:
    s_cmp_eq_u32 s62, 2
    s_cbranch_scc1 L_prb
    v_max3_u32 v3, v16, v17, v18
    v_max_u32 v3, v3, v19
    v_cmp_eq_u32 vcc, -1, v3
    s_cbranch_vccnz L_pn2
L_pgot2:
    v_dot2c_f32_bf16 v64, s58, v16
    v_dot2c_f32_bf16 v65, s59, v16
    v_dot2c_f32_bf16 v66, s58, v17
    v_dot2c_f32_bf16 v67, s59, v17
    v_dot2c_f32_bf16 v68, s58, v18
    v_dot2c_f32_bf16 v69, s59, v18
    v_dot2c_f32_bf16 v70, s58, v19
    v_dot2c_f32_bf16 v71, s59, v19
    s_bitset0_b32 s63, s14
    s_cmp_eq_u32 s63, 0
    s_cbranch_scc1 L_pgd
L_pn2:
    s_cmp_eq_u32 s62, 3
    s_cbranch_scc1 L_prb
    v_max3_u32 v3, v20, v21, v22
    v_max_u32 v3, v3, v23
    v_cmp_eq_u32 vcc, -1, v3
    s_cbranch_vccnz L_pn3
L_pgot3:
    v_dot2c_f32_bf16 v64, s58, v20
    v_dot2c_f32_bf16 v65, s59, v20
    v_dot2c_f32_bf16 v66, s58, v21
    v_dot2c_f32_bf16 v67, s59, v21
    v_dot2c_f32_bf16 v68, s58, v22
    v_dot2c_f32_bf16 v69, s59, v22
    v_dot2c_f32_bf16 v70, s58, v23
    v_dot2c_f32_bf16 v71, s59, v23
    s_bitset0_b32 s63, s15
    s_cmp_eq_u32 s63, 0
    s_cbranch_scc1 L_pgd
L_pn3:
    s_cmp_eq_u32 s62, 4
    s_cbranch_scc1 L_prb
    v_max3_u32 v3, v24, v25, v26
    v_max_u32 v3, v3, v27
    v_cmp_eq_u32 vcc, -1, v3
    s_cbranch_vccnz L_pn4
L_pgot4:
    v_dot2c_f32_bf16 v64, s58, v24
    v_dot2c_f32_bf16 v65, s59, v24
    v_dot2c_f32_bf16 v66, s58, v25
    v_dot2c_f32_bf16 v67, s59, v25
    v_dot2c_f32_bf16 v68, s58, v26
    v_dot2c_f32_bf16 v69, s59, v26
    v_dot2c_f32_bf16 v70, s58, v27
    v_dot2c_f32_bf16 v71, s59, v27
    s_bitset0_b32 s63, s16
    s_cmp_eq_u32 s63, 0
    s_cbranch_scc1 L_pgd
L_pn4:
    s_cmp_eq_u32 s62, 5
    s_cbranch_scc1 L_prb
    v_max3_u32 v3, v28, v29, v30
    v_max_u32 v3, v3, v31
    v_cmp_eq_u32 vcc, -1, v3
    s_cbranch_vccnz L_pn5
L_pgot5:
    v_dot2c_f32_bf16 v64, s58, v28
    v_dot2c_f32_bf16 v65, s59, v28
    v_dot2c_f32_bf16 v66, s58, v29
    v_dot2c_f32_bf16 v67, s59, v29
    v_dot2c_f32_bf16 v68, s58, v30
    v_dot2c_f32_bf16 v69, s59, v30
    v_dot2c_f32_bf16 v70, s58, v31
    v_dot2c_f32_bf16 v71, s59, v31
    s_bitset0_b32 s63, s17
    s_cmp_eq_u32 s63, 0
    s_cbranch_scc1 L_pgd
L_pn5:
    s_cmp_eq_u32 s62, 6
    s_cbranch_scc1 L_prb
    v_max3_u32 v3, v32, v33, v34
    v_max_u32 v3, v3, v35
    v_cmp_eq_u32 vcc, -1, v3
    s_cbranch_vccnz L_pn6
L_pgot6:
    v_dot2c_f32_bf16 v64, s58, v32
    v_dot2c_f32_bf16 v65, s59, v32
    v_dot2c_f32_bf16 v66, s58, v33
    v_dot2c_f32_bf16 v67, s59, v33
    v_dot2c_f32_bf16 v68, s58, v34
    v_dot2c_f32_bf16 v69, s59, v34
    v_dot2c_f32_bf16 v70, s58, v35
    v_dot2c_f32_bf16 v71, s59, v35
    s_bitset0_b32 s63, s18
    s_cmp_eq_u32 s63, 0
    s_cbranch_scc1 L_pgd
L_pn6:
    s_cmp_eq_u32 s62, 7
    s_cbranch_scc1 L_prb
    v_max3_u32 v3, v36, v37, v38
    v_max_u32 v3, v3, v39
    v_cmp_eq_u32 vcc, -1, v3
    s_cbranch_vccnz L_pn7
L_pgot7:
    v_dot2c_f32_bf16 v64, s58, v36
    v_dot2c_f32_bf16 v65, s59, v36
    v_dot2c_f32_bf16 v66, s58, v37
    v_dot2c_f32_bf16 v67, s59, v37
    v_dot2c_f32_bf16 v68, s58, v38
    v_dot2c_f32_bf16 v69, s59, v38
    v_dot2c_f32_bf16 v70, s58, v39
    v_dot2c_f32_bf16 v71, s59, v39
    s_bitset0_b32 s63, s19
    s_cmp_eq_u32 s63, 0
    s_cbranch_scc1 L_pgd
L_pn7:
    s_branch L_prb
L_pi1:
L_poll_129:
    buffer_load_dwordx4 v[8:11], v5, s[40:43], s4 offen sc1
    s_sub_u32 s60, s60, 1
    s_cbranch_scc1 L_poll_129t
    s_waitcnt vmcnt(0)
    v_max3_u32 v3, v8, v9, v10
    v_max_u32 v3, v3, v11
    v_cmp_eq_u32 vcc, -1, v3
    s_cbranch_vccnz L_poll_129
L_poll_129e:
    v_dot2c_f32_bf16 v64, s58, v8
    v_dot2c_f32_bf16 v65, s59, v8
    v_dot2c_f32_bf16 v66, s58, v9
    v_dot2c_f32_bf16 v67, s59, v9
    v_dot2c_f32_bf16 v68, s58, v10
    v_dot2c_f32_bf16 v69, s59, v10
    v_dot2c_f32_bf16 v70, s58, v11
    v_dot2c_f32_bf16 v71, s59, v11
L_pgd:
    v_pk_fma_f32 v[64:65], v[64:65], v[48:49], v[40:41]
    v_pk_fma_f32 v[66:67], v[66:67], v[50:51], v[42:43]
    v_pk_fma_f32 v[68:69], v[68:69], v[52:53], v[44:45]
    v_pk_fma_f32 v[70:71], v[70:71], v[54:55], v[46:47]
    v_pk_mul_f32 v[56:57], v[64:65], v[56:57]
    v_pk_mul_f32 v[58:59], v[66:67], v[58:59]
    v_pk_mul_f32 v[60:61], v[68:69], v[60:61]
    v_pk_mul_f32 v[62:63], v[70:71], v[62:63]
    v_cvt_pk_bf16_f32 v8, v56, v57
    v_cvt_pk_bf16_f32 v9, v58, v59
    v_cvt_pk_bf16_f32 v10, v60, v61
    v_cvt_pk_bf16_f32 v11, v62, v63
    ds_write_b128 v4, v[8:11]
    v_pk_add_f32 v[40:41], v[64:65], v[66:67]
    v_pk_add_f32 v[42:43], v[68:69], v[70:71]
    v_pk_mul_f32 v[44:45], v[64:65], v[64:65]
    v_pk_mul_f32 v[46:47], v[66:67], v[66:67]
    v_pk_add_f32 v[40:41], v[40:41], v[42:43]
    v_pk_fma_f32 v[44:45], v[68:69], v[68:69], v[44:45]
    v_pk_fma_f32 v[46:47], v[70:71], v[70:71], v[46:47]
    v_add_f32 v40, v40, v41
    v_pk_add_f32 v[44:45], v[44:45], v[46:47]
    v_add_f32 v41, v44, v45
    ds_write_b64 v7, v[40:41]
    s_waitcnt lgkmcnt(0)
    s_barrier
    v_mov_b32 v16, 0
    v_mov_b32 v17, 0
    v_mov_b32 v18, 0
    v_mov_b32 v19, 0
    v_mov_b32 v20, 0
    v_mov_b32 v21, 0
    v_mov_b32 v22, 0
    v_mov_b32 v23, 0
    v_mov_b32 v24, 0
    v_mov_b32 v25, 0
    v_mov_b32 v26, 0
    v_mov_b32 v27, 0
    v_mov_b32 v28, 0
    v_mov_b32 v29, 0
    v_mov_b32 v30, 0
    v_mov_b32 v31, 0
    v_mov_b32 v32, 0
    v_mov_b32 v33, 0
    v_mov_b32 v34, 0
    v_mov_b32 v35, 0
    ds_write_b128 v6, v[64:67]
    ds_write_b128 v6, v[68:71] offset:16
    s_waitcnt lgkmcnt(0)
    s_cmp_lg_u32 s3, 7
    s_cbranch_scc1 L_ffn2
    s_cmp_lt_u32 s35, 20
    s_cbranch_scc1 L_fin
    s_endpgm
L_ffn1:
    s_barrier
L_ffn1b:
    ds_read_b128 v[8:11], v79
    ds_read_b64 v[30:31], v81 offset:0
    ds_read_b64 v[32:33], v81 offset:512
    ds_read_b64 v[34:35], v81 offset:1024
    ds_read_b64 v[36:37], v81 offset:1536
    ds_read_b64 v[38:39], v81 offset:2048
    ds_read_b128 v[12:15], v79 offset:256
    ds_read_b128 v[16:19], v79 offset:512
    ds_read_b128 v[20:23], v79 offset:768
    ds_read_b128 v[24:27], v79 offset:1024
    s_waitcnt lgkmcnt(9)
    v_smfmac_f32_16x16x64_bf16 v[52:55], v[8:11], v[88:95], v87
    v_smfmac_f32_16x16x64_bf16 v[56:59], v[8:11], v[96:103], v87
    s_waitcnt lgkmcnt(3)
    v_smfmac_f32_16x16x64_bf16 v[52:55], v[12:15], v[104:111], v87
    v_pk_add_f32 v[30:31], v[30:31], v[32:33]
    v_pk_add_f32 v[34:35], v[34:35], v[36:37]
    v_smfmac_f32_16x16x64_bf16 v[56:59], v[12:15], v[112:119], v87
    v_pk_add_f32 v[30:31], v[30:31], v[38:39]
    v_pk_add_f32 v[30:31], v[30:31], v[34:35]
    s_waitcnt lgkmcnt(2)
    v_smfmac_f32_16x16x64_bf16 v[52:55], v[16:19], v[120:127], v87
    v_add_f32_dpp v30, v30, v30 quad_perm:[1,0,3,2] row_mask:0xf bank_mask:0xf
    v_add_f32_dpp v31, v31, v31 quad_perm:[1,0,3,2] row_mask:0xf bank_mask:0xf
    v_smfmac_f32_16x16x64_bf16 v[56:59], v[16:19], v[128:135], v87
    v_add_f32_dpp v30, v30, v30 quad_perm:[2,3,0,1] row_mask:0xf bank_mask:0xf
    v_add_f32_dpp v31, v31, v31 quad_perm:[2,3,0,1] row_mask:0xf bank_mask:0xf
    s_waitcnt lgkmcnt(1)
    v_smfmac_f32_16x16x64_bf16 v[52:55], v[20:23], v[136:143], v87
    v_add_f32_dpp v30, v30, v30 row_ror:4 row_mask:0xf bank_mask:0xf
    v_add_f32_dpp v31, v31, v31 row_ror:4 row_mask:0xf bank_mask:0xf
    v_smfmac_f32_16x16x64_bf16 v[56:59], v[20:23], v[144:151], v87
    v_add_f32_dpp v30, v30, v30 row_ror:8 row_mask:0xf bank_mask:0xf
    v_add_f32_dpp v31, v31, v31 row_ror:8 row_mask:0xf bank_mask:0xf
    s_waitcnt lgkmcnt(0)
    v_smfmac_f32_16x16x64_bf16 v[52:55], v[24:27], v[152:159], v87
    v_mul_f32 v48, s62, v30
    v_mul_f32 v49, s62, v31
    v_smfmac_f32_16x16x64_bf16 v[56:59], v[24:27], v[160:167], v87
    v_mul_f32 v7, v84, v48
    v_fma_f32 v49, -v48, v48, -v49
    v_max_f32 v49, 0, v49
    v_add_f32 v49, 0x3727c5ac, v49
    v_rsq_f32 v49, v49
    v_add_f32 v4, v52, v53
    v_add_f32 v4, v4, v7
    s_nop 0
    v_add_f32 v5, v58, v59
    v_add_f32 v4, v4, v5
    v_fma_f32 v4, v4, v49, v85
    v_mul_f32 v5, v4, v4
    v_fma_f32 v5, v5, s63, v86
    v_mul_f32 v5, v5, v4
    v_exp_f32 v5, v5
    s_nop 0
    v_add_f32 v5, 1.0, v5
    v_rcp_f32 v5, v5
    s_nop 0
    v_mul_f32 v4, v4, v5
    v_cvt_pk_bf16_f32 v4, v4, v4
    ds_write_b16 v80, v4
    s_waitcnt lgkmcnt(0)
    s_barrier
    s_endpgm
L_cut:
L_h_t1:
    s_sub_u32 s63, s56, 154
    s_cmp_lt_u32 s63, 16
    s_cbranch_scc0 L_h_noclr
    s_lshl2_add_u32 s62, s63, s3
    s_mul_i32 s62, s62, 4608
    v_mov_b32 v4, -1
    v_mov_b32 v5, -1
    v_mov_b32 v6, -1
    v_mov_b32 v7, -1
    v_lshlrev_b32 v8, 4, v0
    buffer_store_dwordx4 v[4:7], v8, s[40:43], s62 offen offset:0 sc1
    buffer_store_dwordx4 v[4:7], v8, s[40:43], s62 offen offset:1024 sc1
    buffer_store_dwordx4 v[4:7], v8, s[40:43], s62 offen offset:2048 sc1
    buffer_store_dwordx4 v[4:7], v8, s[40:43], s62 offen offset:3072 sc1
    s_add_u32 s62, s62, 4096
    s_bfm_b64 exec, 32, 0
    buffer_store_dwordx4 v[4:7], v8, s[40:43], s62 offen offset:0 sc1
    s_mov_b64 exec, 1
    v_mov_b32 v9, 162100
    v_mov_b32 v10, 1
    s_and_b32 s62, s63, 1
    s_mul_i32 s62, s62, 126
    s_lshl1_add_u32 s63, s63, s62
    s_waitcnt vmcnt(0)
    ds_add_rtn_u32 v10, v9, v10
    s_waitcnt lgkmcnt(0)
    v_readfirstlane_b32 s62, v10
    s_nop 0
    s_cmp_lg_u32 s62, 3
    s_cbranch_scc1 L_h_clrd
    buffer_store_dword v4, v36, s[44:47], s63 offen sc1
L_h_clrd:
    s_mov_b64 exec, -1
L_h_noclr:
    v_lshrrev_b32 v1, 3, v0
    v_mul_u32_u24 v1, 1280, v1
    v_and_b32 v2, 7, v0
    v_lshl_add_u32 v1, v2, 4, v1
    s_lshl2_add_u32 s63, s34, s3
    s_mul_i32 s63, s63, 163840
    s_lshl_b32 s62, s35, 7
    s_add_u32 s63, s63, s62
    s_sub_u32 s63, s63, 2816
    s_lshl_b32 s62, s3, 14
    s_add_u32 s62, s62, 81920
    s_mov_b32 m0, s62
    s_mov_b32 s48, s12
    s_mov_b32 s49, s13
    s_mov_b32 s50, 5242880
    s_mov_b32 s51, 0x20000
    s_add_u32 s100, s39, 1
    s_mov_b32 s62, 8
L_dma_5:
    buffer_load_dwordx4 v1, s[48:51], s63 offen nt lds
    s_add_u32 m0, m0, 1024
    s_add_u32 s63, s63, 10240
    s_cmp_eq_u32 s100, 0
    s_cbranch_scc1 L_dma_5n0
    s_waitcnt vmcnt(7)
    s_cmp_eq_u32 s100, 2
    s_cbranch_scc1 L_dma_5n0
    s_waitcnt vmcnt(5)
L_dma_5n0:
    buffer_load_dwordx4 v1, s[48:51], s63 offen nt lds
    s_add_u32 m0, m0, 1024
    s_add_u32 s63, s63, 10240
    s_cmp_eq_u32 s100, 0
    s_cbranch_scc1 L_dma_5n1
    s_waitcnt vmcnt(7)
    s_cmp_eq_u32 s100, 2
    s_cbranch_scc1 L_dma_5n1
    s_waitcnt vmcnt(5)
L_dma_5n1:
    s_sub_u32 s62, s62, 1
    s_cmp_lg_u32 s62, 0
    s_cbranch_scc1 L_dma_5
    s_cmp_eq_u32 s39, 1
    s_cbranch_scc1 L_h_role
    s_barrier
    s_waitcnt vmcnt(0)
    v_mov_b32 v4, 162060
    v_mov_b32 v5, 1
    s_mov_b64 exec, 1
    ds_add_u32 v4, v5
    s_mov_b64 exec, -1
    s_cmp_eq_u32 s3, 0
    s_cbranch_scc1 L_service
    s_endpgm
L_h_role:
    v_mov_b32 v72, 0
    v_mov_b32 v73, 0
    v_mov_b32 v74, 0
    v_mov_b32 v75, 0
    v_mov_b32 v76, 0
    v_lshrrev_b32 v3, 4, v0
    v_and_b32 v2, 3, v0
    v_bfe_u32 v1, v0, 2, 2
    v_mul_u32_u24 v160, 1280, v3
    v_and_b32 v4, 15, v0
    v_lshl_add_u32 v163, v4, 2, v160
    v_lshl_add_u32 v160, v4, 3, v160
    s_mul_i32 s57, s35, 5120
    s_mul_i32 s62, s3, 320
    s_add_u32 s57, s57, s62
    s_add_u32 s57, s57, 327680
    v_add_u32 v8, 0, v0
    v_mul_u32_u24 v10, 0xccd, v8
    v_lshrrev_b32 v10, 16, v10
    v_mul_u32_u24 v9, 20, v10
    v_sub_u32 v8, v8, v9
    v_mul_u32_u24 v10, 1280, v10
    v_lshl_add_u32 v10, v8, 4, v10
    v_add_u32 v8, 64, v0
    v_mul_u32_u24 v11, 0xccd, v8
    v_lshrrev_b32 v11, 16, v11
    v_mul_u32_u24 v9, 20, v11
    v_sub_u32 v8, v8, v9
    v_mul_u32_u24 v11, 1280, v11
    v_lshl_add_u32 v11, v8, 4, v11
    v_add_u32 v8, 128, v0
    v_mul_u32_u24 v12, 0xccd, v8
    v_lshrrev_b32 v12, 16, v12
    v_mul_u32_u24 v9, 20, v12
    v_sub_u32 v8, v8, v9
    v_mul_u32_u24 v12, 1280, v12
    v_lshl_add_u32 v12, v8, 4, v12
    v_add_u32 v8, 192, v0
    v_mul_u32_u24 v13, 0xccd, v8
    v_lshrrev_b32 v13, 16, v13
    v_mul_u32_u24 v9, 20, v13
    v_sub_u32 v8, v8, v9
    v_mul_u32_u24 v13, 1280, v13
    v_lshl_add_u32 v13, v8, 4, v13
    v_add_u32 v8, 256, v0
    v_mul_u32_u24 v14, 0xccd, v8
    v_lshrrev_b32 v14, 16, v14
    v_mul_u32_u24 v9, 20, v14
    v_sub_u32 v8, v8, v9
    v_mul_u32_u24 v14, 1280, v14
    v_lshl_add_u32 v14, v8, 4, v14
    s_mov_b32 s48, s20
    s_mov_b32 s49, s21
    s_mov_b32 s50, 2211840
    s_mov_b32 s51, 0x20000
    s_mul_i32 s63, s35, 81920
    s_mul_i32 s62, s3, 320
    s_add_u32 s63, s63, s62
    s_mov_b32 m0, s101
    s_mov_b32 s62, 4
L_w2dma:
    buffer_load_dwordx4 v10, s[48:51], s63 offen nt lds
    s_add_u32 m0, m0, 1024
    s_waitcnt vmcnt(7)
    s_cmp_ge_u32 s35, 22
    s_cbranch_scc1 L_w2n0
    s_waitcnt vmcnt(7)
L_w2n0:
    buffer_load_dwordx4 v11, s[48:51], s63 offen nt lds
    s_add_u32 m0, m0, 1024
    s_waitcnt vmcnt(7)
    s_cmp_ge_u32 s35, 22
    s_cbranch_scc1 L_w2n1
    s_waitcnt vmcnt(7)
L_w2n1:
    buffer_load_dwordx4 v12, s[48:51], s63 offen nt lds
    s_add_u32 m0, m0, 1024
    s_waitcnt vmcnt(7)
    s_cmp_ge_u32 s35, 22
    s_cbranch_scc1 L_w2n2
    s_waitcnt vmcnt(7)
L_w2n2:
    buffer_load_dwordx4 v13, s[48:51], s63 offen nt lds
    s_add_u32 m0, m0, 1024
    s_waitcnt vmcnt(7)
    s_cmp_ge_u32 s35, 22
    s_cbranch_scc1 L_w2n3
    s_waitcnt vmcnt(7)
L_w2n3:
    buffer_load_dwordx4 v14, s[48:51], s63 offen nt lds
    s_add_u32 m0, m0, 1024
    s_waitcnt vmcnt(7)
    s_cmp_ge_u32 s35, 22
    s_cbranch_scc1 L_w2n4
    s_waitcnt vmcnt(7)
L_w2n4:
    s_add_u32 s63, s63, 20480
    s_sub_u32 s62, s62, 1
    s_cmp_lg_u32 s62, 0
    s_cbranch_scc1 L_w2dma
    v_lshrrev_b32 v8, 5, v0
    v_lshlrev_b32 v8, 2, v8
    v_bfe_u32 v9, v0, 4, 1
    v_add_u32 v8, v8, v9
    v_mul_u32_u24 v8, 1280, v8
    v_add_u32 v8, s101, v8
    v_and_b32 v10, 15, v0
    v_lshl_add_u32 v9, v10, 2, v8
    v_lshl_add_u32 v8, v10, 3, v8
    s_mov_b32 s62, 0x05040100
    s_mov_b32 s63, 0x07060302
    s_waitcnt vmcnt(0)
    v_mov_b32 v4, 162060
    v_mov_b32 v5, 1
    s_mov_b64 exec, 1
    ds_add_u32 v4, v5
    s_mov_b64 exec, -1
    ds_read_b64 v[16:17], v8 offset:0
    ds_read_b64 v[18:19], v8 offset:320
    ds_read_b64 v[20:21], v8 offset:2560
    ds_read_b64 v[22:23], v8 offset:2880
    ds_read_b64 v[24:25], v8 offset:640
    ds_read_b64 v[26:27], v8 offset:960
    ds_read_b64 v[28:29], v8 offset:3200
    ds_read_b64 v[30:31], v8 offset:3520
    ds_read_b64 v[32:33], v8 offset:10240
    ds_read_b64 v[34:35], v8 offset:10560
    ds_read_b64 v[36:37], v8 offset:12800
    ds_read_b64 v[38:39], v8 offset:13120
    ds_read_b64 v[40:41], v8 offset:10880
    ds_read_b64 v[42:43], v8 offset:11200
    ds_read_b64 v[44:45], v8 offset:13440
    ds_read_b64 v[46:47], v8 offset:13760
    s_waitcnt lgkmcnt(0)
    v_perm_b32 v80, v18, v16, s62
    v_perm_b32 v88, v18, v16, s63
    v_perm_b32 v96, v19, v17, s62
    v_perm_b32 v104, v19, v17, s63
    v_perm_b32 v81, v22, v20, s62
    v_perm_b32 v89, v22, v20, s63
    v_perm_b32 v97, v23, v21, s62
    v_perm_b32 v105, v23, v21, s63
    v_perm_b32 v82, v26, v24, s62
    v_perm_b32 v90, v26, v24, s63
    v_perm_b32 v98, v27, v25, s62
    v_perm_b32 v106, v27, v25, s63
    v_perm_b32 v83, v30, v28, s62
    v_perm_b32 v91, v30, v28, s63
    v_perm_b32 v99, v31, v29, s62
    v_perm_b32 v107, v31, v29, s63
    v_perm_b32 v84, v34, v32, s62
    v_perm_b32 v92, v34, v32, s63
    v_perm_b32 v100, v35, v33, s62
    v_perm_b32 v108, v35, v33, s63
    v_perm_b32 v85, v38, v36, s62
    v_perm_b32 v93, v38, v36, s63
    v_perm_b32 v101, v39, v37, s62
    v_perm_b32 v109, v39, v37, s63
    v_perm_b32 v86, v42, v40, s62
    v_perm_b32 v94, v42, v40, s63
    v_perm_b32 v102, v43, v41, s62
    v_perm_b32 v110, v43, v41, s63
    v_perm_b32 v87, v46, v44, s62
    v_perm_b32 v95, v46, v44, s63
    v_perm_b32 v103, v47, v45, s62
    v_perm_b32 v111, v47, v45, s63
    ds_read_b64 v[16:17], v8 offset:128
    ds_read_b64 v[18:19], v8 offset:448
    ds_read_b64 v[20:21], v8 offset:2688
    ds_read_b64 v[22:23], v8 offset:3008
    ds_read_b64 v[24:25], v8 offset:768
    ds_read_b64 v[26:27], v8 offset:1088
    ds_read_b64 v[28:29], v8 offset:3328
    ds_read_b64 v[30:31], v8 offset:3648
    ds_read_b64 v[32:33], v8 offset:10368
    ds_read_b64 v[34:35], v8 offset:10688
    ds_read_b64 v[36:37], v8 offset:12928
    ds_read_b64 v[38:39], v8 offset:13248
    ds_read_b64 v[40:41], v8 offset:11008
    ds_read_b64 v[42:43], v8 offset:11328
    ds_read_b64 v[44:45], v8 offset:13568
    ds_read_b64 v[46:47], v8 offset:13888
    s_waitcnt lgkmcnt(0)
    v_perm_b32 v112, v18, v16, s62
    v_perm_b32 v120, v18, v16, s63
    v_perm_b32 v128, v19, v17, s62
    v_perm_b32 v136, v19, v17, s63
    v_perm_b32 v113, v22, v20, s62
    v_perm_b32 v121, v22, v20, s63
    v_perm_b32 v129, v23, v21, s62
    v_perm_b32 v137, v23, v21, s63
    v_perm_b32 v114, v26, v24, s62
    v_perm_b32 v122, v26, v24, s63
    v_perm_b32 v130, v27, v25, s62
    v_perm_b32 v138, v27, v25, s63
    v_perm_b32 v115, v30, v28, s62
    v_perm_b32 v123, v30, v28, s63
    v_perm_b32 v131, v31, v29, s62
    v_perm_b32 v139, v31, v29, s63
    v_perm_b32 v116, v34, v32, s62
    v_perm_b32 v124, v34, v32, s63
    v_perm_b32 v132, v35, v33, s62
    v_perm_b32 v140, v35, v33, s63
    v_perm_b32 v117, v38, v36, s62
    v_perm_b32 v125, v38, v36, s63
    v_perm_b32 v133, v39, v37, s62
    v_perm_b32 v141, v39, v37, s63
    v_perm_b32 v118, v42, v40, s62
    v_perm_b32 v126, v42, v40, s63
    v_perm_b32 v134, v43, v41, s62
    v_perm_b32 v142, v43, v41, s63
    v_perm_b32 v119, v46, v44, s62
    v_perm_b32 v127, v46, v44, s63
    v_perm_b32 v135, v47, v45, s62
    v_perm_b32 v143, v47, v45, s63
    ds_read_b32 v16, v9 offset:256
    ds_read_b32 v18, v9 offset:576
    ds_read_b32 v20, v9 offset:2816
    ds_read_b32 v22, v9 offset:3136
    ds_read_b32 v24, v9 offset:896
    ds_read_b32 v26, v9 offset:1216
    ds_read_b32 v28, v9 offset:3456
    ds_read_b32 v30, v9 offset:3776
    ds_read_b32 v32, v9 offset:10496
    ds_read_b32 v34, v9 offset:10816
    ds_read_b32 v36, v9 offset:13056
    ds_read_b32 v38, v9 offset:13376
    ds_read_b32 v40, v9 offset:11136
    ds_read_b32 v42, v9 offset:11456
    ds_read_b32 v44, v9 offset:13696
    ds_read_b32 v46, v9 offset:14016
    s_waitcnt lgkmcnt(0)
    v_perm_b32 v144, v18, v16, s62
    v_perm_b32 v152, v18, v16, s63
    v_perm_b32 v145, v22, v20, s62
    v_perm_b32 v153, v22, v20, s63
    v_perm_b32 v146, v26, v24, s62
    v_perm_b32 v154, v26, v24, s63
    v_perm_b32 v147, v30, v28, s62
    v_perm_b32 v155, v30, v28, s63
    v_perm_b32 v148, v34, v32, s62
    v_perm_b32 v156, v34, v32, s63
    v_perm_b32 v149, v38, v36, s62
    v_perm_b32 v157, v38, v36, s63
    v_perm_b32 v150, v42, v40, s62
    v_perm_b32 v158, v42, v40, s63
    v_perm_b32 v151, v46, v44, s62
    v_perm_b32 v159, v46, v44, s63
    s_mov_b32 s48, s16
    s_mov_b32 s49, s17
    s_mov_b32 s50, 2211840
    s_mov_b32 s51, 0x20000
    s_lshl_b32 s98, s35, 7
    s_mov_b32 s99, 3456
    v_lshrrev_b32 v9, 3, v0
    v_mul_lo_u32 v10, v9, s99
    v_and_b32 v9, 2, v9
    v_xor_b32 v9, v9, v0
    v_and_b32 v9, 7, v9
    v_lshl_add_u32 v10, v9, 4, v10
    v_add_u32 v10, s98, v10
    v_xor_b32 v11, 64, v10
    s_mul_i32 s63, s3, 552960
    s_mov_b32 m0, s101
    s_waitcnt lgkmcnt(0)
    s_cmp_ge_u32 s35, 22
    s_cselect_b32 s100, 2, 1
    s_mov_b32 s62, 10
L_dma_6:
    buffer_load_dwordx4 v10, s[48:51], s63 offen nt lds
    s_add_u32 m0, m0, 1024
    s_add_u32 s63, s63, 27648
    s_cmp_eq_u32 s100, 0
    s_cbranch_scc1 L_dma_6n0
    s_waitcnt vmcnt(7)
    s_cmp_eq_u32 s100, 2
    s_cbranch_scc1 L_dma_6n0
    s_waitcnt vmcnt(7)
L_dma_6n0:
    buffer_load_dwordx4 v11, s[48:51], s63 offen nt lds
    s_add_u32 m0, m0, 1024
    s_add_u32 s63, s63, 27648
    s_cmp_eq_u32 s100, 0
    s_cbranch_scc1 L_dma_6n1
    s_waitcnt vmcnt(7)
    s_cmp_eq_u32 s100, 2
    s_cbranch_scc1 L_dma_6n1
    s_waitcnt vmcnt(7)
L_dma_6n1:
    s_sub_u32 s62, s62, 1
    s_cmp_lg_u32 s62, 0
    s_cbranch_scc1 L_dma_6
    v_mov_b32 v8, 162068
L_lw_7:
    ds_read_b32 v9, v8
    s_waitcnt lgkmcnt(0)
    v_cmp_gt_u32 vcc, 1, v9
    s_cbranch_vccz L_lw_7e
    s_sleep 8
    s_sub_u32 s60, s60, 1
    s_cbranch_scc0 L_lw_7
    s_mov_b32 s60, 0
L_lw_7e:
    s_cmp_lg_u32 s3, 3
    s_cbranch_scc1 L_h_nomo
    v_and_b32 v4, 15, v0
    v_lshlrev_b32 v4, 4, v4
    v_mul_u32_u24 v5, 1280, v3
    v_add_u32 v5, v5, v4
    v_mul_u32_u24 v6, 1296, v3
    v_add_u32 v6, v6, v4
    v_add_u32 v6, 147456, v6
    s_mov_b32 s62, 30720
    s_mov_b32 s63, 25600
    s_branch L_poll_8
L_poll_8s:
    s_sleep 8
L_poll_8:
    buffer_load_dwordx4 v[40:43], v5, s[40:43], s62 offen offset:0 sc1
    buffer_load_dwordx4 v[44:47], v5, s[40:43], s62 offen offset:256 sc1
    buffer_load_dwordx4 v[48:51], v5, s[40:43], s62 offen offset:512 sc1
    buffer_load_dwordx4 v[52:55], v5, s[40:43], s62 offen offset:768 sc1
    buffer_load_dwordx4 v[56:59], v5, s[40:43], s62 offen offset:1024 sc1
    buffer_load_dwordx4 v[60:63], v5, s[40:43], s63 offen offset:0 sc1
    buffer_load_dwordx4 v[64:67], v5, s[40:43], s63 offen offset:256 sc1
    buffer_load_dwordx4 v[68:71], v5, s[40:43], s63 offen offset:512 sc1
    buffer_load_dwordx4 v[72:75], v5, s[40:43], s63 offen offset:768 sc1
    buffer_load_dwordx4 v[76:79], v5, s[40:43], s63 offen offset:1024 sc1
    s_sub_u32 s60, s60, 1
    s_cbranch_scc1 L_poll_8t
    s_waitcnt vmcnt(0)
    v_max3_u32 v7, v40, v41, v42
    v_max3_u32 v7, v7, v43, v44
    v_max3_u32 v7, v7, v45, v46
    v_max3_u32 v7, v7, v47, v48
    v_max3_u32 v7, v7, v49, v50
    v_max3_u32 v7, v7, v51, v52
    v_max3_u32 v7, v7, v53, v54
    v_max3_u32 v7, v7, v55, v56
    v_max3_u32 v7, v7, v57, v58
    v_max3_u32 v7, v7, v59, v60
    v_max3_u32 v7, v7, v61, v62
    v_max3_u32 v7, v7, v63, v64
    v_max3_u32 v7, v7, v65, v66
    v_max3_u32 v7, v7, v67, v68
    v_max3_u32 v7, v7, v69, v70
    v_max3_u32 v7, v7, v71, v72
    v_max3_u32 v7, v7, v73, v74
    v_max3_u32 v7, v7, v75, v76
    v_max3_u32 v7, v7, v77, v78
    v_max_u32 v7, v7, v79
    v_cmp_eq_u32 vcc, -1, v7
    s_cbranch_vccnz L_poll_8s
L_poll_8e:
    ds_write_b128 v6, v[40:43] offset:0
    ds_write_b128 v6, v[44:47] offset:256
    ds_write_b128 v6, v[48:51] offset:512
    ds_write_b128 v6, v[52:55] offset:768
    ds_write_b128 v6, v[56:59] offset:1024
    ds_write_b128 v6, v[60:63] offset:5184
    ds_write_b128 v6, v[64:67] offset:5440
    ds_write_b128 v6, v[68:71] offset:5696
    ds_write_b128 v6, v[72:75] offset:5952
    ds_write_b128 v6, v[76:79] offset:6208
L_h_nomo:
    v_mul_u32_u24 v4, 144, v1
    v_lshl_add_u32 v4, v3, 5, v4
    v_bfe_u32 v5, v0, 1, 1
    v_lshl_add_u32 v4, v5, 4, v4
    v_add_u32 v4, 90688, v4
    v_mov_b32 v5, 162112
    v_and_b32 v6, 1, v0
    v_cmp_eq_u32 vcc, 0, v6
    s_nop 1
    v_cndmask_b32 v161, v5, v4, vcc
    v_cndmask_b32 v162, v4, v5, vcc
    v_bfe_u32 v164, v0, 1, 1
    v_mul_u32_u24 v164, 0xaaaa, v164
    v_add_u32 v164, 0x4444, v164
    s_mov_b32 s100, s3
    s_lshl_b32 s63, s100, 8
    v_and_b32 v8, 15, v0
    v_lshl_add_u32 v8, v8, 4, s63
    v_lshrrev_b32 v9, 4, v0
    v_mul_u32_u24 v5, 1280, v9
    v_add_u32 v5, v5, v8
    v_mul_u32_u24 v4, 1296, v9
    v_add_u32 v4, v4, v8
    v_add_u32 v4, 82944, v4
    v_lshlrev_b32 v6, 1, v5
    v_add_u32 v6, 99328, v6
    s_lshl_b32 s62, s100, 9
    s_add_u32 s62, s62, 88128
    v_lshl_add_u32 v7, v0, 3, s62
    s_mov_b32 s48, s4
    s_mov_b32 s49, s5
    s_mov_b32 s50, 5120
    s_mov_b32 s51, 0x20000
    buffer_load_dwordx4 v[8:11], v5, s[48:51], 0 offen
    s_mov_b32 s62, 20480
    s_mov_b32 s63, 30720
    s_branch L_poll_9
L_poll_9s:
    s_sleep 8
L_poll_9:
    buffer_load_dwordx4 v[12:15], v5, s[40:43], s62 offen sc1
    buffer_load_dwordx4 v[16:19], v5, s[40:43], s63 offen sc1
    s_sub_u32 s60, s60, 1
    s_cbranch_scc1 L_poll_9t
    s_waitcnt vmcnt(0)
    v_max3_u32 v38, v12, v13, v14
    v_max3_u32 v38, v38, v15, v16
    v_max3_u32 v38, v38, v17, v18
    v_max_u32 v38, v38, v19
    v_cmp_eq_u32 vcc, -1, v38
    s_cbranch_vccnz L_poll_9s
L_poll_9e:
    v_lshlrev_b32 v40, 16, v8
    v_and_b32 v41, 0xffff0000, v8
    v_lshlrev_b32 v42, 16, v9
    v_and_b32 v43, 0xffff0000, v9
    v_lshlrev_b32 v44, 16, v10
    v_and_b32 v45, 0xffff0000, v10
    v_lshlrev_b32 v46, 16, v11
    v_and_b32 v47, 0xffff0000, v11
    v_lshlrev_b32 v48, 16, v12
    v_and_b32 v49, 0xffff0000, v12
    v_lshlrev_b32 v50, 16, v13
    v_and_b32 v51, 0xffff0000, v13
    v_lshlrev_b32 v52, 16, v14
    v_and_b32 v53, 0xffff0000, v14
    v_lshlrev_b32 v54, 16, v15
    v_and_b32 v55, 0xffff0000, v15
    v_lshlrev_b32 v56, 16, v16
    v_and_b32 v57, 0xffff0000, v16
    v_lshlrev_b32 v58, 16, v17
    v_and_b32 v59, 0xffff0000, v17
    v_lshlrev_b32 v60, 16, v18
    v_and_b32 v61, 0xffff0000, v18
    v_lshlrev_b32 v62, 16, v19
    v_and_b32 v63, 0xffff0000, v19
    v_mov_b32 v64, 0
    v_mov_b32 v65, 0
    v_mov_b32 v66, 0
    v_mov_b32 v67, 0
    v_mov_b32 v68, 0
    v_mov_b32 v69, 0
    v_mov_b32 v70, 0
    v_mov_b32 v71, 0
    v_bfe_u32 v5, v0, 2, 2
    v_lshlrev_b32 v5, 8, v5
    v_lshrrev_b32 v8, 4, v0
    v_lshl_add_u32 v5, v8, 6, v5
    v_and_b32 v8, 3, v0
    v_lshl_add_u32 v5, v8, 4, v5
    s_lshl_b32 s56, s100, 10
    s_waitcnt vmcnt(0) lgkmcnt(0)
    v_mov_b32 v8, 162064
    v_mov_b32 v9, 1
    s_mov_b64 exec, 1
    ds_add_u32 v8, v9
    s_mov_b64 exec, -1
    s_branch L_t2gate
L_ffn2:
    s_barrier
L_ffn2b:
    ds_read_b128 v[8:11], v161
    ds_read_b128 v[12:15], v162
    s_cmp_eq_u32 s61, 1
    s_cbranch_scc0 L_f2slow
    s_waitcnt lgkmcnt(1)
    v_smfmac_f32_16x16x64_bf16 v[16:19], v[8:11], v[80:87], v164
    v_smfmac_f32_16x16x64_bf16 v[20:23], v[8:11], v[96:103], v164
    s_waitcnt lgkmcnt(0)
    v_smfmac_f32_16x16x64_bf16 v[16:19], v[12:15], v[88:95], v164
    v_smfmac_f32_16x16x64_bf16 v[20:23], v[12:15], v[104:111], v164
    v_smfmac_f32_16x16x64_bf16 v[24:27], v[8:11], v[112:119], v164
    v_smfmac_f32_16x16x64_bf16 v[28:31], v[8:11], v[128:135], v164
    v_smfmac_f32_16x16x64_bf16 v[24:27], v[12:15], v[120:127], v164
    v_smfmac_f32_16x16x64_bf16 v[28:31], v[12:15], v[136:143], v164
    v_smfmac_f32_16x16x64_bf16 v[32:35], v[8:11], v[144:151], v164
    v_smfmac_f32_16x16x64_bf16 v[32:35], v[12:15], v[152:159], v164
    s_nop 0
    v_pk_add_f32 v[16:17], v[16:17], v[18:19]
    v_cvt_pk_bf16_f32 v40, v16, v17
    v_pk_add_f32 v[20:21], v[20:21], v[22:23]
    v_cvt_pk_bf16_f32 v41, v20, v21
    buffer_store_dwordx2 v[40:41], v160, s[40:43], s57 offen
    v_pk_add_f32 v[24:25], v[24:25], v[26:27]
    v_cvt_pk_bf16_f32 v42, v24, v25
    v_pk_add_f32 v[28:29], v[28:29], v[30:31]
    v_cvt_pk_bf16_f32 v43, v28, v29
    buffer_store_dwordx2 v[42:43], v160, s[40:43], s57 offen offset:128
    v_pk_add_f32 v[32:33], v[32:33], v[34:35]
    v_cvt_pk_bf16_f32 v44, v32, v33
    buffer_store_dword v44, v163, s[40:43], s57 offen offset:256
L_f2done:
    s_barrier
    s_endpgm
L_f2slow:
    s_waitcnt lgkmcnt(1)
    v_smfmac_f32_16x16x64_bf16 v[16:19], v[8:11], v[80:87], v164
    v_smfmac_f32_16x16x64_bf16 v[20:23], v[8:11], v[96:103], v164
    s_waitcnt lgkmcnt(0)
    v_smfmac_f32_16x16x64_bf16 v[16:19], v[12:15], v[88:95], v164
    v_smfmac_f32_16x16x64_bf16 v[20:23], v[12:15], v[104:111], v164
    v_smfmac_f32_16x16x64_bf16 v[24:27], v[8:11], v[112:119], v164
    v_smfmac_f32_16x16x64_bf16 v[28:31], v[8:11], v[128:135], v164
    v_smfmac_f32_16x16x64_bf16 v[24:27], v[12:15], v[120:127], v164
    v_smfmac_f32_16x16x64_bf16 v[28:31], v[12:15], v[136:143], v164
    v_smfmac_f32_16x16x64_bf16 v[32:35], v[8:11], v[144:151], v164
    v_smfmac_f32_16x16x64_bf16 v[32:35], v[12:15], v[152:159], v164
    s_nop 0
    v_pk_add_f32 v[16:17], v[16:17], v[18:19]
    v_cvt_pk_bf16_f32 v40, v16, v17
    v_pk_add_f32 v[20:21], v[20:21], v[22:23]
    v_cvt_pk_bf16_f32 v41, v20, v21
    buffer_store_dwordx2 v[40:41], v160, s[40:43], s57 offen sc1
    v_pk_add_f32 v[24:25], v[24:25], v[26:27]
    v_cvt_pk_bf16_f32 v42, v24, v25
    v_pk_add_f32 v[28:29], v[28:29], v[30:31]
    v_cvt_pk_bf16_f32 v43, v28, v29
    buffer_store_dwordx2 v[42:43], v160, s[40:43], s57 offen offset:128 sc1
    v_pk_add_f32 v[32:33], v[32:33], v[34:35]
    v_cvt_pk_bf16_f32 v44, v32, v33
    buffer_store_dword v44, v163, s[40:43], s57 offen offset:256 sc1
    s_branch L_f2done
L_poll_3t:
    s_mov_b32 s60, 0
    s_waitcnt vmcnt(0)
    s_branch L_poll_3e
L_poll_8t:
    s_mov_b32 s60, 0
    s_waitcnt vmcnt(0)
    s_branch L_poll_8e
L_poll_9t:
    s_mov_b32 s60, 0
    s_waitcnt vmcnt(0)
    s_branch L_poll_9e
L_poll_102t:
    s_mov_b32 s60, 0
    s_waitcnt vmcnt(0)
    s_branch L_poll_102e
L_pfast:
    buffer_store_dword v12, v108, s[40:43], s101 offen
    buffer_store_dword v12, v110, s[40:43], s101 offen
    s_branch L_pdone
L_poll_104t:
    s_mov_b32 s60, 0
    s_waitcnt vmcnt(0)
    s_branch L_poll_104e
L_poll_106t:
    s_mov_b32 s60, 0
    s_waitcnt vmcnt(0)
    s_branch L_poll_106e
L_poll_109t:
    s_mov_b32 s60, 0
    s_waitcnt vmcnt(0)
    s_branch L_poll_109e
L_poll_111t:
    s_mov_b32 s60, 0
    s_waitcnt vmcnt(0)
    s_branch L_poll_111e
L_poll_115t:
    s_mov_b32 s60, 0
    s_waitcnt vmcnt(0)
    s_branch L_poll_115e
L_poll_117t:
    s_mov_b32 s60, 0
    s_waitcnt vmcnt(0)
    s_branch L_poll_117e
L_ycs:
    buffer_store_dwordx4 v[24:27], v22, s[40:43], 0 offen offset:0 sc1
    buffer_store_dwordx4 v[24:27], v22, s[40:43], 0 offen offset:1024 sc1
    buffer_store_dwordx4 v[24:27], v22, s[40:43], 0 offen offset:2048 sc1
    buffer_store_dwordx4 v[24:27], v22, s[40:43], 0 offen offset:3072 sc1
    buffer_store_dwordx4 v[24:27], v23, s[40:43], 0 offen offset:0 sc1
    s_branch L_ycd
L_poll_118t:
    s_mov_b32 s60, 0
    s_waitcnt vmcnt(0)
    s_branch L_poll_118e
L_poll_123t:
    s_mov_b32 s60, 0
    s_waitcnt vmcnt(0)
    s_branch L_poll_123e
L_poll_125t:
    s_mov_b32 s60, 0
    s_waitcnt vmcnt(0)
    s_branch L_poll_125e
L_ygt:
    s_waitcnt vmcnt(0)
    v_mfma_f32_16x16x32_bf16 v[112:115], v[104:107], v[88:91], 0
    v_mfma_f32_16x16x32_bf16 v[112:115], v[104:107], v[92:95], v[112:115]
    v_mfma_f32_16x16x32_bf16 v[112:115], v[104:107], v[96:99], v[112:115]
    v_mfma_f32_16x16x32_bf16 v[112:115], v[104:107], v[100:103], v[112:115]
    s_nop 7
    s_branch L_ygd
L_pto:
    s_mov_b32 s60, 0
    s_waitcnt vmcnt(0)
    s_branch L_pgot0
L_poll_129t:
    s_mov_b32 s60, 0
    s_waitcnt vmcnt(0)
    s_branch L_poll_129e
L_end:
    s_endpgm
L_codeend:
.section .rodata,"a"
.p2align 6
.amdhsa_kernel adaLN_cond__sliding_block_cached__dense_activation_gelu__decode_kernel
  .amdhsa_next_free_vgpr 168
  .amdhsa_next_free_sgpr 102
  .amdhsa_accum_offset 168
  .amdhsa_group_segment_fixed_size 0
  .amdhsa_kernarg_size 120
  .amdhsa_user_sgpr_count 2
  .amdhsa_user_sgpr_kernarg_segment_ptr 1
  .amdhsa_system_sgpr_workgroup_id_x 1
.end_amdhsa_kernel
```

```asm
; @launch grid=(256,1,1) block=(768,1,1) lds=162176
.amdgcn_target "amdgcn-amd-amdhsa--gfx950"
.text
.globl adaLN_cond__sliding_block_cached__dense_activation_gelu__decode_kernel
.p2align 8
.type adaLN_cond__sliding_block_cached__dense_activation_gelu__decode_kernel,@function
adaLN_cond__sliding_block_cached__dense_activation_gelu__decode_kernel:
    s_load_dwordx16 s[4:19], s[0:1], 0
    s_load_dwordx8 s[20:27], s[0:1], 64
    s_load_dwordx4 s[28:31], s[0:1], 96
    s_load_dwordx2 s[32:33], s[0:1], 112
    s_cmp_ge_u32 s2, 256
    s_cbranch_scc1 L_end
    v_lshrrev_b32 v1, 6, v0
    v_mul_u32_u24 v2, 36, v0
    v_readfirstlane_b32 s3, v1
    v_and_b32 v0, 63, v0
    s_and_b32 s34, s2, 7
    s_lshr_b32 s35, s2, 3
    s_cmp_lg_u32 s35, 21
    s_cbranch_scc1 L_nopf
    s_getpc_b64 s[48:49]
L_pc:
    v_min_u32 v2, L_codeend-L_pc-4, v2
    v_mov_b32 v3, s49
    v_add_co_u32 v2, vcc, s48, v2
    s_nop 1
    v_addc_co_u32 v3, vcc, 0, v3, vcc
    global_load_dword v152, v[2:3], off
L_nopf:
    s_lshr_b32 s36, s35, 3
    s_lshl2_add_u32 s36, s34, s36
    s_bfe_u32 s37, s35, 0x20001
    s_and_b32 s38, s35, 1
    s_cmp_lt_u32 s35, 27
    s_cselect_b32 s39, 1, 0
    s_cmp_eq_u32 s34, 2
    s_cselect_b32 s39, s39, 0
    s_sub_u32 s62, s34, 3
    s_and_b32 s62, s62, 7
    s_mul_i32 s56, s35, 7
    s_add_u32 s56, s56, s62
    s_cmp_eq_u32 s62, 7
    s_cselect_b32 s56, 255, s56
    s_mov_b32 s60, 1000000
    s_mov_b32 s61, 0
    v_mov_b32 v36, 0
    s_cmp_lt_u32 s3, 4
    s_cbranch_scc1 L_helpers
    s_sub_u32 s3, s3, 4
    s_cmp_ge_u32 s35, 22
    s_cselect_b32 s59, 1, 0
    s_add_u32 s62, s3, s59
    s_cmp_ge_u32 s62, 6
    s_cselect_b32 s62, s39, 0
    s_cmp_eq_u32 s62, 1
    s_cbranch_scc1 L_proxy
    s_cmp_eq_u32 s59, 1
    s_cselect_b32 s100, 0, 81920
    s_lshl_b32 s62, s3, 13
    s_add_u32 s100, s100, s62
    s_and_b32 s62, s39, s59
    s_cselect_b32 s100, -1, s100
    s_mov_b32 s101, 0
L_stream:
    s_lshl_b32 s62, s37, 5
    s_add_u32 s62, s62, s36
    s_lshl_b32 s63, s62, 21
    s_lshl_b32 s96, s38, 18
    s_add_u32 s63, s63, s96
    s_add_u32 s63, s63, 1572864
    v_lshlrev_b32 v1, 4, v0
    s_lshl_b32 s96, s3, 12
    v_add_u32 v1, s96, v1
    s_mov_b32 s97, 0
    s_mov_b32 s50, 262144
    s_mov_b32 s51, 0x20000
    s_waitcnt lgkmcnt(0)
    s_add_u32 s48, s6, s63
    s_addc_u32 s49, s7, 0
    s_cmp_lt_u32 s56, 40
    s_cbranch_scc0 L_nob0
    s_barrier
L_nob0:
    buffer_load_dwordx4 v[40:43], v1, s[48:51], s97 offen offset:0 nt
    buffer_load_dwordx4 v[44:47], v1, s[48:51], s97 offen offset:1024 nt
    s_cmp_lt_u32 s56, 40
    s_cbranch_scc1 L_stream2
    s_barrier
    s_branch L_stream2
L_helpers:
    s_cmp_lg_u32 s3, 0
    s_cbranch_scc1 L_noinit
    v_lshlrev_b32 v1, 2, v0
    v_add_u32 v1, 161920, v1
    ds_write_b32 v1, v36
L_noinit:
    s_waitcnt lgkmcnt(0)
    s_mov_b32 s40, s32
    s_mov_b32 s41, s33
    s_mov_b32 s42, 589824
    s_mov_b32 s43, 0x20000
    s_mov_b32 s44, s30
    s_mov_b32 s45, s31
    s_mov_b32 s46, 256
    s_mov_b32 s47, 0x20000
    s_lshl2_add_u32 s62, s35, s3
    s_cmp_eq_u32 s62, 87
    s_cbranch_scc1 L_touch
L_notp:
    s_mul_i32 s101, s3, 20480
    s_mov_b32 s96, s56
    s_cmp_lt_u32 s56, 40
    s_cbranch_scc0 L_nothalf
    s_cmp_lt_u32 s3, 2
    s_cbranch_scc1 L_unit
    s_add_u32 s62, s56, 20
    s_cmp_eq_u32 s3, 2
    s_cbranch_scc1 L_job
    s_barrier
    s_branch L_service
L_nothalf:
    s_cmp_lt_u32 s56, 144
    s_cbranch_scc1 L_unit
    s_sub_u32 s62, s56, 144
    s_cmp_lt_u32 s62, 10
    s_cbranch_scc0 L_nojob
    s_cmp_lt_u32 s3, 2
    s_cbranch_scc0 L_nojob
    s_mul_i32 s63, s3, 10
    s_add_u32 s62, s62, s63
L_job:
    s_cmp_lt_u32 s62, 59
    s_cbranch_scc0 L_end
    s_mov_b32 s100, s101
    s_lshl_b32 s101, s62, 9
    s_add_u32 s101, s101, 172032
    s_cmp_lt_u32 s62, 27
    s_cselect_b32 s63, 0, 27
    s_cselect_b32 s3, 7, 6
    s_cmp_lt_u32 s62, 54
    s_cselect_b32 s63, s63, 32
    s_cselect_b32 s3, s3, 5
    s_sub_u32 s35, s62, s63
    s_mov_b32 s34, 2
    s_lshr_b32 s36, s35, 3
    s_add_u32 s36, s36, 8
    s_bfe_u32 s37, s35, 0x20001
    s_and_b32 s38, s35, 1
    s_mov_b32 s59, 0
    s_branch L_stream
L_nojob:
    s_barrier
    s_cmp_ge_u32 s35, 22
    s_cbranch_scc1 L_h_t1
    s_cmp_eq_u32 s39, 1
    s_cbranch_scc1 L_h_role
    s_cmp_lt_u32 s96, 144
    s_cbranch_scc1 L_unit
    s_cmp_eq_u32 s3, 3
    s_cbranch_scc1 L_service
    s_endpgm
L_unit:
    v_lshrrev_b32 v3, 4, v0
    v_and_b32 v4, 3, v0
    v_bfe_u32 v7, v0, 2, 2
    s_mov_b32 s14, s3
    s_mov_b32 s15, 3
    s_sub_u32 s62, s96, 40
    s_cmp_lt_u32 s62, 64
    s_cbranch_scc1 L_u_q
    s_mov_b32 s100, 1
    s_sub_u32 s96, s96, 84
    s_cmp_lt_u32 s56, 40
    s_cbranch_scc0 L_u_full
    s_mov_b32 s100, 0
    s_lshr_b32 s96, s56, 1
    s_and_b32 s62, s56, 1
    s_lshl1_add_u32 s14, s62, s14
    s_mov_b32 s15, 1
L_u_full:
    s_mov_b32 s97, 0
    s_mov_b32 s99, 7680
    s_mov_b32 s48, s26
    s_mov_b32 s49, s27
    s_mov_b32 s50, 4915200
    s_mov_b32 s51, 0x20000
    s_mov_b32 s52, s24
    s_mov_b32 s53, s25
    s_mov_b32 s54, 5120
    s_mov_b32 s55, 0x20000
    v_and_b32 v6, 15, v0
    v_lshlrev_b32 v6, 4, v6
    v_mul_u32_u24 v5, 1280, v3
    v_add_u32 v5, v5, v6
    s_mul_i32 s62, s14, 320
    buffer_load_dwordx4 v[8:11], v5, s[52:55], s62 offen
    s_mov_b32 exec_lo, 0x000f000f
    s_mov_b32 exec_hi, 0x000f000f
    buffer_load_dwordx4 v[12:15], v5, s[52:55], s62 offen offset:256
    s_mov_b64 exec, -1
    s_lshl_b32 s98, s96, 7
    s_mul_i32 s13, s96, 0x199a
    s_lshr_b32 s13, s13, 16
    s_cmp_lg_u32 s13, 1
    s_cbranch_scc1 L_u_go
    s_mov_b32 s52, s4
    s_mov_b32 s53, s5
    s_mov_b32 s54, 5120
    s_mov_b32 s55, 0x20000
    v_mul_u32_u24 v5, 1280, v4
    v_lshlrev_b32 v64, 5, v7
    v_lshl_add_u32 v64, v3, 3, v64
    v_add_u32 v64, v64, v5
    v_lshrrev_b32 v6, 2, v0
    v_lshl_add_u32 v6, v6, 4, v5
    s_sub_u32 s62, s98, 1280
    buffer_load_dwordx4 v[16:19], v6, s[52:55], 0 offen offset:0
    buffer_load_dwordx4 v[20:23], v6, s[52:55], 0 offen offset:256
    buffer_load_dwordx4 v[24:27], v6, s[52:55], 0 offen offset:512
    buffer_load_dwordx4 v[28:31], v6, s[52:55], 0 offen offset:768
    buffer_load_dwordx4 v[32:35], v6, s[52:55], 0 offen offset:1024
    buffer_load_dwordx2 v[66:67], v64, s[52:55], s62 offen
    s_branch L_u_go
L_u_q:
    s_mov_b32 s97, 1
    s_mov_b32 s99, 8192
    s_mov_b32 s100, 2
    s_lshl_b32 s98, s62, 7
    s_mov_b32 s48, s10
    s_mov_b32 s49, s11
    s_mov_b32 s50, 5242880
    s_mov_b32 s51, 0x20000
L_u_go:
    v_lshrrev_b32 v6, 3, v0
    v_mul_lo_u32 v1, v6, s99
    v_and_b32 v6, 2, v6
    v_xor_b32 v6, v6, v0
    v_and_b32 v6, 7, v6
    v_lshl_add_u32 v1, v6, 4, v1
    v_add_u32 v1, s98, v1
    v_xor_b32 v2, 64, v1
    s_mul_i32 s63, s99, s14
    s_mul_i32 s63, s63, 160
    s_lshl_b32 s59, s99, 3
    s_mov_b32 m0, s101
    s_mov_b32 s62, 10
L_dma_1:
    buffer_load_dwordx4 v1, s[48:51], s63 offen nt lds
    s_add_u32 m0, m0, 1024
    s_add_u32 s63, s63, s59
    s_cmp_eq_u32 s100, 0
    s_cbranch_scc1 L_dma_1n0
    s_waitcnt vmcnt(5)
    s_cmp_eq_u32 s100, 2
    s_cbranch_scc1 L_dma_1n0
    s_waitcnt vmcnt(5)
L_dma_1n0:
    buffer_load_dwordx4 v2, s[48:51], s63 offen nt lds
    s_add_u32 m0, m0, 1024
    s_add_u32 s63, s63, s59
    s_cmp_eq_u32 s100, 0
    s_cbranch_scc1 L_dma_1n1
    s_waitcnt vmcnt(5)
    s_cmp_eq_u32 s100, 2
    s_cbranch_scc1 L_dma_1n1
    s_waitcnt vmcnt(5)
L_dma_1n1:
    s_sub_u32 s62, s62, 1
    s_cmp_lg_u32 s62, 0
    s_cbranch_scc1 L_dma_1
    v_min_u32 v65, 15, v0
    v_and_b32 v6, 1, v65
    v_mul_u32_u24 v6, 126, v6
    v_lshl_add_u32 v65, v65, 1, v6
    v_mov_b32 v68, 0
    s_cmp_lt_u32 s56, 40
    s_cbranch_scc1 L_u_nofl
    buffer_load_dword v68, v65, s[44:47], 0 offen sc1
L_u_nofl:
    s_cmp_lt_u32 s56, 144
    s_cbranch_scc0 L_u_nob
    s_barrier
L_u_nob:
    v_lshrrev_b32 v60, 4, v0
    v_lshlrev_b32 v60, 10, v60
    v_bfe_u32 v6, v0, 2, 2
    v_lshl_add_u32 v60, v6, 7, v60
    v_and_b32 v6, 3, v0
    v_lshl_add_u32 v60, v6, 3, v60
    v_bfe_u32 v6, v0, 3, 2
    v_lshl_add_u32 v60, v6, 5, v60
    v_xor_b32 v61, 32, v60
    v_xor_b32 v62, 64, v60
    v_xor_b32 v63, 0x60, v60
    v_add_u32 v60, s101, v60
    v_add_u32 v61, s101, v61
    v_add_u32 v62, s101, v62
    v_add_u32 v63, s101, v63
    v_mov_b32 v56, 1.0
    v_mov_b32 v57, 1.0
    v_mov_b32 v58, 1.0
    v_mov_b32 v59, 1.0
    s_mov_b32 s58, 0
    v_lshl_add_u32 v69, v7, 2, v3
    v_lshl_add_u32 v69, v4, 4, v69
    v_and_b32 v64, 15, v0
    v_lshlrev_b32 v64, 3, v64
    s_cmp_eq_u32 s97, 1
    s_cbranch_scc1 L_u_q2
    v_mul_u32_u24 v6, 1280, v3
    v_add_u32 v64, v64, v6
    s_mul_i32 s63, s13, 3840
    s_add_u32 s57, s98, s63
    s_add_u32 s57, s57, 10240
    s_cmp_lt_u32 s56, 40
    s_cbranch_scc0 L_u_nat
    v_lshrrev_b32 v69, 1, v3
    v_lshlrev_b32 v69, 3, v69
    v_lshl_add_u32 v69, v7, 4, v69
    v_lshl_add_u32 v69, v4, 1, v69
    v_and_b32 v6, 1, v3
    v_add_u32 v69, v69, v6
    s_lshr_b32 s62, s56, 1
    s_lshl_b32 s57, s62, 11
    s_cmp_ge_u32 s62, 10
    s_cselect_b32 s62, -19968, 0
    s_add_u32 s57, s57, s62
    s_and_b32 s62, s56, 1
    s_lshl_b32 s62, s62, 8
    s_add_u32 s57, s57, s62
    v_lshrrev_b32 v64, 5, v0
    v_lshlrev_b32 v64, 10, v64
    v_and_b32 v6, 31, v0
    v_lshl_add_u32 v64, v6, 3, v64
L_u_nat:
    s_cmp_eq_u32 s13, 4
    s_cselect_b32 s58, 1.0, 0
    s_cmp_eq_u32 s13, 1
    s_cselect_b32 s58, 1.0, s58
    s_cselect_b32 s56, 1, 0
    s_cmp_eq_u32 s14, 0
    s_cselect_b32 s58, s58, 0
    s_waitcnt vmcnt(20)
    s_mov_b32 s62, 0xbfb8aa3b
    v_lshlrev_b32 v40, 16, v8
    v_and_b32 v41, 0xffff0000, v8
    v_lshlrev_b32 v42, 16, v9
    v_and_b32 v43, 0xffff0000, v9
    v_lshlrev_b32 v44, 16, v10
    v_and_b32 v45, 0xffff0000, v10
    v_lshlrev_b32 v46, 16, v11
    v_and_b32 v47, 0xffff0000, v11
    v_mul_f32 v48, s62, v40
    v_mul_f32 v49, s62, v41
    v_mul_f32 v50, s62, v42
    v_mul_f32 v51, s62, v43
    v_mul_f32 v52, s62, v44
    v_mul_f32 v53, s62, v45
    v_mul_f32 v54, s62, v46
    v_mul_f32 v55, s62, v47
    v_exp_f32 v48, v48
    v_exp_f32 v49, v49
    v_exp_f32 v50, v50
    v_exp_f32 v51, v51
    v_exp_f32 v52, v52
    v_exp_f32 v53, v53
    v_exp_f32 v54, v54
    v_exp_f32 v55, v55
    v_add_f32 v48, 1.0, v48
    v_add_f32 v49, 1.0, v49
    v_add_f32 v50, 1.0, v50
    v_add_f32 v51, 1.0, v51
    v_add_f32 v52, 1.0, v52
    v_add_f32 v53, 1.0, v53
    v_add_f32 v54, 1.0, v54
    v_add_f32 v55, 1.0, v55
    v_rcp_f32 v48, v48
    v_rcp_f32 v49, v49
    v_rcp_f32 v50, v50
    v_rcp_f32 v51, v51
    v_rcp_f32 v52, v52
    v_rcp_f32 v53, v53
    v_rcp_f32 v54, v54
    v_rcp_f32 v55, v55
    v_mul_f32 v40, v40, v48
    v_mul_f32 v41, v41, v49
    v_mul_f32 v42, v42, v50
    v_mul_f32 v43, v43, v51
    v_mul_f32 v44, v44, v52
    v_mul_f32 v45, v45, v53
    v_mul_f32 v46, v46, v54
    v_mul_f32 v47, v47, v55
    v_cvt_pk_bf16_f32 v8, v40, v41
    v_cvt_pk_bf16_f32 v9, v42, v43
    v_cvt_pk_bf16_f32 v10, v44, v45
    v_cvt_pk_bf16_f32 v11, v46, v47
    v_lshlrev_b32 v40, 16, v12
    v_and_b32 v41, 0xffff0000, v12
    v_lshlrev_b32 v42, 16, v13
    v_and_b32 v43, 0xffff0000, v13
    v_lshlrev_b32 v44, 16, v14
    v_and_b32 v45, 0xffff0000, v14
    v_lshlrev_b32 v46, 16, v15
    v_and_b32 v47, 0xffff0000, v15
    v_mul_f32 v48, s62, v40
    v_mul_f32 v49, s62, v41
    v_mul_f32 v50, s62, v42
    v_mul_f32 v51, s62, v43
    v_mul_f32 v52, s62, v44
    v_mul_f32 v53, s62, v45
    v_mul_f32 v54, s62, v46
    v_mul_f32 v55, s62, v47
    v_exp_f32 v48, v48
    v_exp_f32 v49, v49
    v_exp_f32 v50, v50
    v_exp_f32 v51, v51
    v_exp_f32 v52, v52
    v_exp_f32 v53, v53
    v_exp_f32 v54, v54
    v_exp_f32 v55, v55
    v_add_f32 v48, 1.0, v48
    v_add_f32 v49, 1.0, v49
    v_add_f32 v50, 1.0, v50
    v_add_f32 v51, 1.0, v51
    v_add_f32 v52, 1.0, v52
    v_add_f32 v53, 1.0, v53
    v_add_f32 v54, 1.0, v54
    v_add_f32 v55, 1.0, v55
    v_rcp_f32 v48, v48
    v_rcp_f32 v49, v49
    v_rcp_f32 v50, v50
    v_rcp_f32 v51, v51
    v_rcp_f32 v52, v52
    v_rcp_f32 v53, v53
    v_rcp_f32 v54, v54
    v_rcp_f32 v55, v55
    v_mul_f32 v40, v40, v48
    v_mul_f32 v41, v41, v49
    v_mul_f32 v42, v42, v50
    v_mul_f32 v43, v43, v51
    v_mul_f32 v44, v44, v52
    v_mul_f32 v45, v45, v53
    v_mul_f32 v46, v46, v54
    v_mul_f32 v47, v47, v55
    v_cvt_pk_bf16_f32 v12, v40, v41
    v_cvt_pk_bf16_f32 v13, v42, v43
    v_cvt_pk_bf16_f32 v14, v44, v45
    v_cvt_pk_bf16_f32 v15, v46, v47
    s_mul_i32 s62, s3, 1344
    s_add_u32 s62, s62, 151552
    v_mul_u32_u24 v5, 336, v3
    v_and_b32 v6, 15, v0
    v_lshl_add_u32 v5, v6, 4, v5
    v_add_u32 v5, s62, v5
    ds_write_b128 v5, v[8:11]
    s_mov_b32 exec_lo, 0x000f000f
    s_mov_b32 exec_hi, 0x000f000f
    ds_write_b128 v5, v[12:15] offset:256
    s_mov_b64 exec, -1
    v_mul_u32_u24 v5, 336, v4
    v_lshl_add_u32 v5, v3, 4, v5
    v_add_u32 v5, s62, v5
    s_mov_b32 s59, 0x3e800000
    s_cmp_eq_u32 s56, 0
    s_cbranch_scc1 L_u_nost
    v_mov_b32 v40, 0
    v_mov_b32 v41, 0
    s_mov_b32 s62, 0x3f803f80
    v_dot2c_f32_bf16 v40, s62, v16
    v_dot2c_f32_bf16 v41, v16, v16
    v_dot2c_f32_bf16 v40, s62, v17
    v_dot2c_f32_bf16 v41, v17, v17
    v_dot2c_f32_bf16 v40, s62, v18
    v_dot2c_f32_bf16 v41, v18, v18
    v_dot2c_f32_bf16 v40, s62, v19
    v_dot2c_f32_bf16 v41, v19, v19
    v_dot2c_f32_bf16 v40, s62, v20
    v_dot2c_f32_bf16 v41, v20, v20
    v_dot2c_f32_bf16 v40, s62, v21
    v_dot2c_f32_bf16 v41, v21, v21
    v_dot2c_f32_bf16 v40, s62, v22
    v_dot2c_f32_bf16 v41, v22, v22
    v_dot2c_f32_bf16 v40, s62, v23
    v_dot2c_f32_bf16 v41, v23, v23
    v_dot2c_f32_bf16 v40, s62, v24
    v_dot2c_f32_bf16 v41, v24, v24
    v_dot2c_f32_bf16 v40, s62, v25
    v_dot2c_f32_bf16 v41, v25, v25
    v_dot2c_f32_bf16 v40, s62, v26
    v_dot2c_f32_bf16 v41, v26, v26
    v_dot2c_f32_bf16 v40, s62, v27
    v_dot2c_f32_bf16 v41, v27, v27
    v_dot2c_f32_bf16 v40, s62, v28
    v_dot2c_f32_bf16 v41, v28, v28
    v_dot2c_f32_bf16 v40, s62, v29
    v_dot2c_f32_bf16 v41, v29, v29
    v_dot2c_f32_bf16 v40, s62, v30
    v_dot2c_f32_bf16 v41, v30, v30
    v_dot2c_f32_bf16 v40, s62, v31
    v_dot2c_f32_bf16 v41, v31, v31
    v_dot2c_f32_bf16 v40, s62, v32
    v_dot2c_f32_bf16 v41, v32, v32
    v_dot2c_f32_bf16 v40, s62, v33
    v_dot2c_f32_bf16 v41, v33, v33
    v_dot2c_f32_bf16 v40, s62, v34
    v_dot2c_f32_bf16 v41, v34, v34
    v_dot2c_f32_bf16 v40, s62, v35
    v_dot2c_f32_bf16 v41, v35, v35
    s_nop 1
    v_add_f32_dpp v40, v40, v40 row_ror:4 row_mask:0xf bank_mask:0xf
    v_add_f32_dpp v41, v41, v41 row_ror:4 row_mask:0xf bank_mask:0xf
    s_nop 0
    v_add_f32_dpp v40, v40, v40 row_ror:8 row_mask:0xf bank_mask:0xf
    v_add_f32_dpp v41, v41, v41 row_ror:8 row_mask:0xf bank_mask:0xf
    v_mov_b32 v42, v40
    v_mov_b32 v43, v41
    s_nop 0
    v_permlane16_swap_b32 v40, v42
    v_permlane16_swap_b32 v41, v43
    v_add_f32 v40, v40, v42
    v_add_f32 v41, v41, v43
    v_mov_b32 v42, v40
    v_mov_b32 v43, v41
    s_nop 0
    v_permlane32_swap_b32 v40, v42
    v_permlane32_swap_b32 v41, v43
    v_add_f32 v40, v40, v42
    v_add_f32 v41, v41, v43
    s_mov_b32 s62, 0x3acccccd
    v_mul_f32 v40, s62, v40
    v_mul_f32 v41, s62, v41
    v_fma_f32 v41, -v40, v40, v41
    v_max_f32 v41, 0, v41
    v_add_f32 v41, 0x3727c5ac, v41
    v_rsq_f32 v41, v41
    v_lshlrev_b32 v56, 16, v66
    v_and_b32 v57, 0xffff0000, v66
    v_lshlrev_b32 v58, 16, v67
    v_and_b32 v59, 0xffff0000, v67
    v_sub_f32 v56, v56, v40
    v_sub_f32 v57, v57, v40
    v_sub_f32 v58, v58, v40
    v_sub_f32 v59, v59, v40
    v_mul_f32 v56, v56, v41
    v_mul_f32 v57, v57, v41
    v_mul_f32 v58, v58, v41
    v_mul_f32 v59, v59, v41
L_u_nost:
    ds_read_b128 v[8:11], v5 offset:0
    ds_read_b128 v[12:15], v5 offset:64
    ds_read_b128 v[16:19], v5 offset:128
    ds_read_b128 v[20:23], v5 offset:192
    ds_read_b128 v[24:27], v5 offset:256
    s_branch L_u_frag
L_u_q2:
    v_lshl_add_u32 v64, v3, 13, v64
    s_add_u32 s57, s98, 40960
    v_lshlrev_b32 v5, 8, v7
    v_lshl_add_u32 v5, v3, 6, v5
    v_lshl_add_u32 v5, v4, 4, v5
    s_mul_i32 s63, s3, 5120
    s_add_u32 s63, s63, 0
    s_add_u32 s12, s63, 4096
    s_mov_b32 s59, 1.0
L_u_frag:
    s_waitcnt vmcnt(0)
    v_cmp_ne_u32 vcc, -1, v68
    s_cbranch_vccz L_u_yok
    s_cmp_eq_u32 s97, 1
    s_cbranch_scc1 L_u_ywait
    buffer_load_dword v68, v65, s[44:47], 0 offen sc1
    s_branch L_u_yok
L_u_ywait:
L_wy_2:
    buffer_load_dword v68, v65, s[44:47], 0 offen sc1
    s_waitcnt vmcnt(0)
    v_cmp_ne_u32 vcc, -1, v68
    s_cbranch_vccz L_wy_2e
    s_sleep 4
    s_sub_u32 s60, s60, 1
    s_cbranch_scc0 L_wy_2
    s_mov_b32 s60, 0
L_wy_2e:
L_u_yok:
    ds_read_b64_tr_b16 v[80:81], v60 offset:0
    ds_read_b64_tr_b16 v[82:83], v60 offset:512
    ds_read_b64_tr_b16 v[84:85], v61 offset:0
    ds_read_b64_tr_b16 v[86:87], v61 offset:512
    ds_read_b64_tr_b16 v[88:89], v62 offset:0
    ds_read_b64_tr_b16 v[90:91], v62 offset:512
    ds_read_b64_tr_b16 v[92:93], v63 offset:0
    ds_read_b64_tr_b16 v[94:95], v63 offset:512
    ds_read_b64_tr_b16 v[96:97], v60 offset:4096
    ds_read_b64_tr_b16 v[98:99], v60 offset:4608
    ds_read_b64_tr_b16 v[100:101], v61 offset:4096
    ds_read_b64_tr_b16 v[102:103], v61 offset:4608
    ds_read_b64_tr_b16 v[104:105], v62 offset:4096
    ds_read_b64_tr_b16 v[106:107], v62 offset:4608
    ds_read_b64_tr_b16 v[108:109], v63 offset:4096
    ds_read_b64_tr_b16 v[110:111], v63 offset:4608
    ds_read_b64_tr_b16 v[112:113], v60 offset:8192
    ds_read_b64_tr_b16 v[114:115], v60 offset:8704
    ds_read_b64_tr_b16 v[116:117], v61 offset:8192
    ds_read_b64_tr_b16 v[118:119], v61 offset:8704
    ds_read_b64_tr_b16 v[120:121], v62 offset:8192
    ds_read_b64_tr_b16 v[122:123], v62 offset:8704
    ds_read_b64_tr_b16 v[124:125], v63 offset:8192
    ds_read_b64_tr_b16 v[126:127], v63 offset:8704
    ds_read_b64_tr_b16 v[128:129], v60 offset:12288
    ds_read_b64_tr_b16 v[130:131], v60 offset:12800
    ds_read_b64_tr_b16 v[132:133], v61 offset:12288
    ds_read_b64_tr_b16 v[134:135], v61 offset:12800
    ds_read_b64_tr_b16 v[136:137], v62 offset:12288
    ds_read_b64_tr_b16 v[138:139], v62 offset:12800
    ds_read_b64_tr_b16 v[140:141], v63 offset:12288
    ds_read_b64_tr_b16 v[142:143], v63 offset:12800
    ds_read_b64_tr_b16 v[144:145], v60 offset:16384
    ds_read_b64_tr_b16 v[146:147], v60 offset:16896
    ds_read_b64_tr_b16 v[148:149], v61 offset:16384
    ds_read_b64_tr_b16 v[150:151], v61 offset:16896
    ds_read_b64_tr_b16 v[152:153], v62 offset:16384
    ds_read_b64_tr_b16 v[154:155], v62 offset:16896
    ds_read_b64_tr_b16 v[156:157], v63 offset:16384
    ds_read_b64_tr_b16 v[158:159], v63 offset:16896
    s_cmp_eq_u32 s97, 0
    s_cbranch_scc1 L_u_mm
    s_branch L_poll_3
L_poll_3s:
    s_sleep 8
L_poll_3:
    buffer_load_dwordx4 v[8:11], v5, s[40:43], s63 offen offset:0 sc1
    buffer_load_dwordx4 v[12:15], v5, s[40:43], s63 offen offset:1024 sc1
    buffer_load_dwordx4 v[16:19], v5, s[40:43], s63 offen offset:2048 sc1
    buffer_load_dwordx4 v[20:23], v5, s[40:43], s63 offen offset:3072 sc1
    buffer_load_dwordx4 v[24:27], v5, s[40:43], s12 offen offset:0 sc1
    s_sub_u32 s60, s60, 1
    s_cbranch_scc1 L_poll_3t
    s_waitcnt vmcnt(0)
    v_max3_u32 v37, v8, v9, v10
    v_max3_u32 v37, v37, v11, v12
    v_max3_u32 v37, v37, v13, v14
    v_max3_u32 v37, v37, v15, v16
    v_max3_u32 v37, v37, v17, v18
    v_max3_u32 v37, v37, v19, v20
    v_max3_u32 v37, v37, v21, v22
    v_max3_u32 v37, v37, v23, v24
    v_max3_u32 v37, v37, v25, v26
    v_max_u32 v37, v37, v27
    v_cmp_eq_u32 vcc, -1, v37
    s_cbranch_vccnz L_poll_3s
L_poll_3e:
L_u_got:
L_u_mm:
    s_waitcnt lgkmcnt(0)
    v_mfma_f32_16x16x32_bf16 v[40:43], v[80:83], v[8:11], 0
    v_mfma_f32_16x16x32_bf16 v[44:47], v[84:87], v[8:11], 0
    v_mfma_f32_16x16x32_bf16 v[48:51], v[88:91], v[8:11], 0
    v_mfma_f32_16x16x32_bf16 v[52:55], v[92:95], v[8:11], 0
    v_mfma_f32_16x16x32_bf16 v[40:43], v[96:99], v[12:15], v[40:43]
    v_mfma_f32_16x16x32_bf16 v[44:47], v[100:103], v[12:15], v[44:47]
    v_mfma_f32_16x16x32_bf16 v[48:51], v[104:107], v[12:15], v[48:51]
    v_mfma_f32_16x16x32_bf16 v[52:55], v[108:111], v[12:15], v[52:55]
    v_mfma_f32_16x16x32_bf16 v[40:43], v[112:115], v[16:19], v[40:43]
    v_mfma_f32_16x16x32_bf16 v[44:47], v[116:119], v[16:19], v[44:47]
    v_mfma_f32_16x16x32_bf16 v[48:51], v[120:123], v[16:19], v[48:51]
    v_mfma_f32_16x16x32_bf16 v[52:55], v[124:127], v[16:19], v[52:55]
    v_mfma_f32_16x16x32_bf16 v[40:43], v[128:131], v[20:23], v[40:43]
    v_mfma_f32_16x16x32_bf16 v[44:47], v[132:135], v[20:23], v[44:47]
    v_mfma_f32_16x16x32_bf16 v[48:51], v[136:139], v[20:23], v[48:51]
    v_mfma_f32_16x16x32_bf16 v[52:55], v[140:143], v[20:23], v[52:55]
    v_mfma_f32_16x16x32_bf16 v[40:43], v[144:147], v[24:27], v[40:43]
    v_mfma_f32_16x16x32_bf16 v[44:47], v[148:151], v[24:27], v[44:47]
    v_mfma_f32_16x16x32_bf16 v[48:51], v[152:155], v[24:27], v[48:51]
    v_mfma_f32_16x16x32_bf16 v[52:55], v[156:159], v[24:27], v[52:55]
    v_lshlrev_b32 v5, 4, v0
    v_add_u32 v5, 147456, v5
    s_lshl_b32 s62, s3, 10
    s_add_u32 s62, s62, 147456
    v_lshl_add_u32 v6, v69, 4, s62
    v_mov_b32 v24, s58
    v_mov_b32 v32, 162056
    v_mov_b32 v33, 1
    v_add_f32_dpp v40, v40, v40 row_ror:8 row_mask:0xf bank_mask:0xf
    v_add_f32_dpp v41, v41, v41 row_ror:8 row_mask:0xf bank_mask:0xf
    v_add_f32_dpp v42, v42, v42 row_ror:8 row_mask:0xf bank_mask:0xf
    v_add_f32_dpp v43, v43, v43 row_ror:8 row_mask:0xf bank_mask:0xf
    v_add_f32_dpp v44, v44, v44 row_ror:8 row_mask:0xf bank_mask:0xf
    v_add_f32_dpp v45, v45, v45 row_ror:8 row_mask:0xf bank_mask:0xf
    v_add_f32_dpp v46, v46, v46 row_ror:8 row_mask:0xf bank_mask:0xf
    v_add_f32_dpp v47, v47, v47 row_ror:8 row_mask:0xf bank_mask:0xf
    v_add_f32_dpp v48, v48, v48 row_ror:8 row_mask:0xf bank_mask:0xf
    v_add_f32_dpp v49, v49, v49 row_ror:8 row_mask:0xf bank_mask:0xf
    v_add_f32_dpp v50, v50, v50 row_ror:8 row_mask:0xf bank_mask:0xf
    v_add_f32_dpp v51, v51, v51 row_ror:8 row_mask:0xf bank_mask:0xf
    v_add_f32_dpp v52, v52, v52 row_ror:8 row_mask:0xf bank_mask:0xf
    v_add_f32_dpp v53, v53, v53 row_ror:8 row_mask:0xf bank_mask:0xf
    v_add_f32_dpp v54, v54, v54 row_ror:8 row_mask:0xf bank_mask:0xf
    v_add_f32_dpp v55, v55, v55 row_ror:8 row_mask:0xf bank_mask:0xf
    v_add_f32_dpp v28, v40, v40 row_ror:4 row_mask:0xf bank_mask:0x1
    v_add_f32_dpp v29, v41, v41 row_ror:4 row_mask:0xf bank_mask:0x1
    v_add_f32_dpp v30, v42, v42 row_ror:4 row_mask:0xf bank_mask:0x1
    v_add_f32_dpp v31, v43, v43 row_ror:4 row_mask:0xf bank_mask:0x1
    v_add_f32_dpp v28, v44, v44 row_ror:4 row_mask:0xf bank_mask:0x2
    v_add_f32_dpp v29, v45, v45 row_ror:4 row_mask:0xf bank_mask:0x2
    v_add_f32_dpp v30, v46, v46 row_ror:4 row_mask:0xf bank_mask:0x2
    v_add_f32_dpp v31, v47, v47 row_ror:4 row_mask:0xf bank_mask:0x2
    v_add_f32_dpp v28, v48, v48 row_ror:4 row_mask:0xf bank_mask:0x4
    v_add_f32_dpp v29, v49, v49 row_ror:4 row_mask:0xf bank_mask:0x4
    v_add_f32_dpp v30, v50, v50 row_ror:4 row_mask:0xf bank_mask:0x4
    v_add_f32_dpp v31, v51, v51 row_ror:4 row_mask:0xf bank_mask:0x4
    v_add_f32_dpp v28, v52, v52 row_ror:4 row_mask:0xf bank_mask:0x8
    v_add_f32_dpp v29, v53, v53 row_ror:4 row_mask:0xf bank_mask:0x8
    v_add_f32_dpp v30, v54, v54 row_ror:4 row_mask:0xf bank_mask:0x8
    v_add_f32_dpp v31, v55, v55 row_ror:4 row_mask:0xf bank_mask:0x8
    v_fma_f32 v28, v28, s59, v24
    v_fma_f32 v29, v29, s59, v24
    v_fma_f32 v30, v30, s59, v24
    v_fma_f32 v31, v31, s59, v24
    v_mul_f32 v28, v28, v56
    v_mul_f32 v29, v29, v57
    v_mul_f32 v30, v30, v58
    v_mul_f32 v31, v31, v59
    ds_write_b128 v6, v[28:31]
    s_mov_b64 exec, 1
    ds_add_rtn_u32 v34, v32, v33
    s_mov_b64 exec, -1
    ds_read_b128 v[8:11], v5
    ds_read_b128 v[12:15], v5 offset:1024
    ds_read_b128 v[16:19], v5 offset:2048
    ds_read_b128 v[20:23], v5 offset:3072
    s_waitcnt lgkmcnt(0)
    v_readfirstlane_b32 s62, v34
    s_nop 0
    s_cmp_eq_u32 s62, s15
    s_cbranch_scc1 L_u_last
    s_cmp_eq_u32 s62, 1
    s_cbranch_scc1 L_service
    s_endpgm
L_u_last:
    v_add_f32 v8, v8, v12
    v_add_f32 v9, v9, v13
    v_add_f32 v10, v10, v14
    v_add_f32 v11, v11, v15
    s_cmp_eq_u32 s15, 1
    s_cbranch_scc1 L_u_two
    v_add_f32 v16, v16, v20
    v_add_f32 v17, v17, v21
    v_add_f32 v18, v18, v22
    v_add_f32 v19, v19, v23
    v_add_f32 v8, v8, v16
    v_add_f32 v9, v9, v17
    v_add_f32 v10, v10, v18
    v_add_f32 v11, v11, v19
L_u_two:
    v_cvt_pk_bf16_f32 v8, v8, v9
    v_cvt_pk_bf16_f32 v9, v10, v11
    s_waitcnt vmcnt(0)
    v_cmp_ne_u32 vcc, -1, v68
    s_cbranch_vccz L_u_st
L_wy_4:
    buffer_load_dword v68, v65, s[44:47], 0 offen sc1
    s_waitcnt vmcnt(0)
    v_cmp_ne_u32 vcc, -1, v68
    s_cbranch_vccz L_wy_4e
    s_sleep 4
    s_sub_u32 s60, s60, 1
    s_cbranch_scc0 L_wy_4
    s_mov_b32 s60, 0
L_wy_4e:
L_u_st:
    buffer_store_dwordx2 v[8:9], v64, s[40:43], s57 offen sc1
    s_endpgm
L_touch:
    s_load_dword s0, s[32:33], 0
    s_load_dword s0, s[30:31], 0
    s_cmp_eq_u32 s39, 1
    s_cbranch_scc1 L_tpr
    s_mov_b32 s62, 16777216
    s_load_dword s0, s[8:9], s62
    s_mov_b32 s62, 83886080
    s_load_dword s0, s[8:9], s62
    s_mov_b32 s62, 150994944
    s_load_dword s0, s[8:9], s62
    s_mov_b32 s62, 218103808
    s_load_dword s0, s[8:9], s62
    s_branch L_tpv
L_tpr:
    s_load_dword s0, s[20:21], 0
    s_mov_b32 s62, 2211836
    s_load_dword s0, s[20:21], s62
    s_load_dword s0, s[16:17], 0
    s_mov_b32 s62, 2211836
    s_load_dword s0, s[16:17], s62
    s_load_dword s0, s[18:19], 0
    s_load_dword s0, s[22:23], 0
    s_load_dword s0, s[28:29], 0
    s_load_dword s0, s[4:5], 0
L_tpv:
    s_lshl_b32 s62, s34, 23
    s_load_dword s0, s[8:9], s62
    s_add_u32 s62, s62, 67108864
    s_load_dword s0, s[8:9], s62
    s_add_u32 s62, s62, 67108864
    s_load_dword s0, s[8:9], s62
    s_add_u32 s62, s62, 67108864
    s_load_dword s0, s[8:9], s62
    s_add_u32 s62, s62, 67108864
    s_branch L_notp
L_stream2:
    s_mov_b32 s12, s100
    s_mov_b32 s13, s101
    s_or_b32 s96, s59, s39
    s_cbranch_scc0 L_noua
    s_barrier
L_noua:
    s_mov_b32 s40, s32
    s_mov_b32 s41, s33
    s_mov_b32 s42, 589824
    s_mov_b32 s43, 0x20000
    s_mov_b32 s44, s30
    s_mov_b32 s45, s31
    s_mov_b32 s46, 256
    s_mov_b32 s47, 0x20000
    s_bitcmp1_b32 s3, 0
    s_mov_b32 s57, 0xffffffff
    s_mov_b32 s58, 0x0
    s_mov_b32 s14, 0xffffff
    s_mov_b32 s15, 0x0
L_pm_10:
    s_sub_u32 s96, s56, 104
    s_cmp_lt_u32 s96, 66
    s_cbranch_scc0 L_pm_11
    s_bitcmp1_b32 s3, 0
    s_mov_b32 s57, 0xff00000f
    s_mov_b32 s58, 0x0
    s_mov_b32 s14, 0xffffff
    s_mov_b32 s15, 0x0
L_pm_11:
    s_sub_u32 s96, s56, 144
    s_cmp_lt_u32 s96, 10
    s_cbranch_scc0 L_pm_12
    s_bitcmp1_b32 s3, 0
    s_mov_b32 s57, 0xffffffff
    s_mov_b32 s58, 0xfff
    s_mov_b32 s14, 0xffffff
    s_mov_b32 s15, 0x0
L_pm_12:
    s_cmp_lt_u32 s56, 104
    s_cbranch_scc0 L_pm_13
    s_bitcmp1_b32 s3, 0
    s_mov_b32 s57, 0xf
    s_mov_b32 s58, 0x0
    s_mov_b32 s14, 0xffffff
    s_mov_b32 s15, 0x0
L_pm_13:
    s_sub_u32 s96, s56, 43
    s_and_b32 s96, s96, 0xffffffc7
    s_cmp_eq_u32 s96, 0
    s_cbranch_scc0 L_pm_14
    s_bitcmp1_b32 s3, 0
    s_mov_b32 s57, 0x0
    s_mov_b32 s58, 0x0
    s_mov_b32 s14, 0x0
    s_mov_b32 s15, 0x0
L_pm_14:
    s_cmp_lt_u32 s56, 40
    s_cbranch_scc0 L_pm_15
    s_bitcmp1_b32 s3, 0
    s_mov_b32 s57, 0xffffffff
    s_mov_b32 s58, 0xf
    s_mov_b32 s14, 0xffffff
    s_mov_b32 s15, 0x0
L_pm_15:
    s_cmp_eq_u32 s56, 255
    s_cbranch_scc0 L_pm_16
    s_bitcmp1_b32 s3, 0
    s_mov_b32 s57, 0xffffffff
    s_mov_b32 s58, 0x0
    s_mov_b32 s14, 0x0
    s_mov_b32 s15, 0x0
L_pm_16:
    s_cmp_eq_u32 s39, 1
    s_cbranch_scc0 L_pm_17
    s_bitcmp1_b32 s3, 0
    s_mov_b32 s57, 0x0
    s_mov_b32 s58, 0x0
    s_mov_b32 s14, 0x0
    s_mov_b32 s15, 0x0
L_pm_17:
    s_cmp_lg_u32 s13, 0
    s_cbranch_scc0 L_pm_18
    s_bitcmp1_b32 s3, 0
    s_mov_b32 s57, 0xffffffff
    s_mov_b32 s58, 0x0
    s_mov_b32 s14, 0x0
    s_mov_b32 s15, 0x0
L_pm_18:
    s_and_b32 s96, s39, s59
    s_cbranch_scc0 L_pm_19
    s_bitcmp1_b32 s3, 0
    s_mov_b32 s57, 0x0
    s_mov_b32 s58, 0x0
    s_mov_b32 s14, 0x0
    s_mov_b32 s15, 0x0
L_pm_19:
    s_add_u32 s52, s8, s63
    s_addc_u32 s53, s9, 0
    s_mov_b32 s54, 262144
    s_mov_b32 s55, 0x20000
    v_and_b32 v2, 15, v0
    v_lshrrev_b32 v3, 1, v2
    v_and_b32 v37, 1, v2
    v_lshlrev_b32 v37, 4, v37
    v_mov_b32 v38, 0xffff
    v_lshlrev_b32 v37, v37, v38
    v_cmp_eq_u32 vcc, 0, v3
    v_mov_b32 v32, 0
    s_nop 0
    v_cndmask_b32 v20, 0, v37, vcc
    v_cmp_eq_u32 vcc, 1, v3
    v_mov_b32 v33, 0
    s_nop 0
    v_cndmask_b32 v21, 0, v37, vcc
    v_cmp_eq_u32 vcc, 2, v3
    v_mov_b32 v34, 0
    s_nop 0
    v_cndmask_b32 v22, 0, v37, vcc
    v_cmp_eq_u32 vcc, 3, v3
    v_mov_b32 v35, 0
    s_nop 0
    v_cndmask_b32 v23, 0, v37, vcc
    v_lshlrev_b32 v2, 4, v2
    s_lshl_b32 s98, s62, 8
    s_add_u32 s98, s98, 40960
    s_bitcmp0_b32 s57, 2
    s_cbranch_scc1 L_sf_20
    s_bitcmp0_b32 s58, 2
    s_cbranch_scc1 L_sf_20
    s_waitcnt vmcnt(1)
L_sf_20:
    buffer_load_dwordx4 v[48:51], v1, s[48:51], s97 offen offset:2048 nt
    s_bitcmp0_b32 s57, 3
    s_cbranch_scc1 L_sf_21
    s_waitcnt vmcnt(2)
    s_bitcmp0_b32 s58, 3
    s_cbranch_scc1 L_sf_21
    s_waitcnt vmcnt(1)
L_sf_21:
    buffer_load_dwordx4 v[52:55], v1, s[48:51], s97 offen offset:3072 nt
    s_add_u32 s97, s97, 32768
    v_add_u32 v1, 4096, v1
    v_and_b32 v1, 0x7fff, v1
    s_waitcnt vmcnt(3)
    s_bitcmp0_b32 s57, 4
    s_cbranch_scc1 L_sf_22
    s_waitcnt vmcnt(2)
    s_bitcmp0_b32 s58, 4
    s_cbranch_scc1 L_sf_22
    s_waitcnt vmcnt(1)
L_sf_22:
    buffer_load_dwordx4 v[56:59], v1, s[48:51], s97 offen offset:0 nt
    s_waitcnt vmcnt(3)
    s_bitcmp0_b32 s57, 5
    s_cbranch_scc1 L_sf_23
    s_waitcnt vmcnt(2)
    s_bitcmp0_b32 s58, 5
    s_cbranch_scc1 L_sf_23
    s_waitcnt vmcnt(1)
L_sf_23:
    buffer_load_dwordx4 v[60:63], v1, s[48:51], s97 offen offset:1024 nt
    s_waitcnt vmcnt(3)
    s_bitcmp0_b32 s57, 6
    s_cbranch_scc1 L_sf_24
    s_waitcnt vmcnt(2)
    s_bitcmp0_b32 s58, 6
    s_cbranch_scc1 L_sf_24
    s_waitcnt vmcnt(1)
L_sf_24:
    buffer_load_dwordx4 v[64:67], v1, s[48:51], s97 offen offset:2048 nt
    s_waitcnt vmcnt(3)
    s_bitcmp0_b32 s57, 7
    s_cbranch_scc1 L_sf_25
    s_waitcnt vmcnt(2)
    s_bitcmp0_b32 s58, 7
    s_cbranch_scc1 L_sf_25
    s_waitcnt vmcnt(1)
L_sf_25:
    buffer_load_dwordx4 v[68:71], v1, s[48:51], s97 offen offset:3072 nt
    s_add_u32 s97, s97, 32768
    v_add_u32 v1, 4096, v1
    v_and_b32 v1, 0x7fff, v1
    s_waitcnt vmcnt(3)
    s_bitcmp0_b32 s57, 8
    s_cbranch_scc1 L_sf_26
    s_waitcnt vmcnt(2)
    s_bitcmp0_b32 s58, 8
    s_cbranch_scc1 L_sf_26
    s_waitcnt vmcnt(1)
L_sf_26:
    buffer_load_dwordx4 v[72:75], v1, s[48:51], s97 offen offset:0 nt
    s_waitcnt vmcnt(3)
    s_bitcmp0_b32 s57, 9
    s_cbranch_scc1 L_sf_27
    s_waitcnt vmcnt(2)
    s_bitcmp0_b32 s58, 9
    s_cbranch_scc1 L_sf_27
    s_waitcnt vmcnt(1)
L_sf_27:
    buffer_load_dwordx4 v[76:79], v1, s[48:51], s97 offen offset:1024 nt
    s_waitcnt vmcnt(3)
    s_bitcmp0_b32 s57, 10
    s_cbranch_scc1 L_sf_28
    s_waitcnt vmcnt(2)
    s_bitcmp0_b32 s58, 10
    s_cbranch_scc1 L_sf_28
    s_waitcnt vmcnt(1)
L_sf_28:
    buffer_load_dwordx4 v[80:83], v1, s[48:51], s97 offen offset:2048 nt
    s_waitcnt vmcnt(3)
    s_bitcmp0_b32 s57, 11
    s_cbranch_scc1 L_sf_29
    s_waitcnt vmcnt(2)
    s_bitcmp0_b32 s58, 11
    s_cbranch_scc1 L_sf_29
    s_waitcnt vmcnt(1)
L_sf_29:
    buffer_load_dwordx4 v[84:87], v1, s[48:51], s97 offen offset:3072 nt
    s_add_u32 s97, s97, 32768
    v_add_u32 v1, 4096, v1
    v_and_b32 v1, 0x7fff, v1
    s_waitcnt vmcnt(3)
    s_bitcmp0_b32 s57, 12
    s_cbranch_scc1 L_sf_30
    s_waitcnt vmcnt(2)
    s_bitcmp0_b32 s58, 12
    s_cbranch_scc1 L_sf_30
    s_waitcnt vmcnt(1)
L_sf_30:
    buffer_load_dwordx4 v[88:91], v1, s[48:51], s97 offen offset:0 nt
    s_waitcnt vmcnt(3)
    s_bitcmp0_b32 s57, 13
    s_cbranch_scc1 L_sf_31
    s_waitcnt vmcnt(2)
    s_bitcmp0_b32 s58, 13
    s_cbranch_scc1 L_sf_31
    s_waitcnt vmcnt(1)
L_sf_31:
    buffer_load_dwordx4 v[92:95], v1, s[48:51], s97 offen offset:1024 nt
    s_waitcnt vmcnt(3)
    s_bitcmp0_b32 s57, 14
    s_cbranch_scc1 L_sf_32
    s_waitcnt vmcnt(2)
    s_bitcmp0_b32 s58, 14
    s_cbranch_scc1 L_sf_32
    s_waitcnt vmcnt(1)
L_sf_32:
    buffer_load_dwordx4 v[96:99], v1, s[48:51], s97 offen offset:2048 nt
    s_waitcnt vmcnt(3)
    s_bitcmp0_b32 s57, 15
    s_cbranch_scc1 L_sf_33
    s_waitcnt vmcnt(2)
    s_bitcmp0_b32 s58, 15
    s_cbranch_scc1 L_sf_33
    s_waitcnt vmcnt(1)
L_sf_33:
    buffer_load_dwordx4 v[100:103], v1, s[48:51], s97 offen offset:3072 nt
    s_add_u32 s97, s97, 32768
    v_add_u32 v1, 4096, v1
    v_and_b32 v1, 0x7fff, v1
    s_waitcnt vmcnt(3)
    s_bitcmp0_b32 s57, 16
    s_cbranch_scc1 L_sf_34
    s_waitcnt vmcnt(2)
    s_bitcmp0_b32 s58, 16
    s_cbranch_scc1 L_sf_34
    s_waitcnt vmcnt(1)
L_sf_34:
    buffer_load_dwordx4 v[104:107], v1, s[48:51], s97 offen offset:0 nt
    s_waitcnt vmcnt(3)
    s_bitcmp0_b32 s57, 17
    s_cbranch_scc1 L_sf_35
    s_waitcnt vmcnt(2)
    s_bitcmp0_b32 s58, 17
    s_cbranch_scc1 L_sf_35
    s_waitcnt vmcnt(1)
L_sf_35:
    buffer_load_dwordx4 v[108:111], v1, s[48:51], s97 offen offset:1024 nt
    s_waitcnt vmcnt(3)
    s_bitcmp0_b32 s57, 18
    s_cbranch_scc1 L_sf_36
    s_waitcnt vmcnt(2)
    s_bitcmp0_b32 s58, 18
    s_cbranch_scc1 L_sf_36
    s_waitcnt vmcnt(1)
L_sf_36:
    buffer_load_dwordx4 v[112:115], v1, s[48:51], s97 offen offset:2048 nt
    s_waitcnt vmcnt(3)
    s_bitcmp0_b32 s57, 19
    s_cbranch_scc1 L_sf_37
    s_waitcnt vmcnt(2)
    s_bitcmp0_b32 s58, 19
    s_cbranch_scc1 L_sf_37
    s_waitcnt vmcnt(1)
L_sf_37:
    buffer_load_dwordx4 v[116:119], v1, s[48:51], s97 offen offset:3072 nt
    s_add_u32 s97, s97, 32768
    v_add_u32 v1, 4096, v1
    v_and_b32 v1, 0x7fff, v1
    s_waitcnt vmcnt(3)
    s_bitcmp0_b32 s57, 20
    s_cbranch_scc1 L_sf_38
    s_waitcnt vmcnt(2)
    s_bitcmp0_b32 s58, 20
    s_cbranch_scc1 L_sf_38
    s_waitcnt vmcnt(1)
L_sf_38:
    buffer_load_dwordx4 v[120:123], v1, s[48:51], s97 offen offset:0 nt
    s_waitcnt vmcnt(3)
    s_bitcmp0_b32 s57, 21
    s_cbranch_scc1 L_sf_39
    s_waitcnt vmcnt(2)
    s_bitcmp0_b32 s58, 21
    s_cbranch_scc1 L_sf_39
    s_waitcnt vmcnt(1)
L_sf_39:
    buffer_load_dwordx4 v[124:127], v1, s[48:51], s97 offen offset:1024 nt
    s_cmp_eq_u32 s12, -1
    s_cbranch_scc1 L_k_nopf
    s_waitcnt vmcnt(3)
    s_bitcmp0_b32 s57, 22
    s_cbranch_scc1 L_sf_40
    s_waitcnt vmcnt(2)
    s_bitcmp0_b32 s58, 22
    s_cbranch_scc1 L_sf_40
    s_waitcnt vmcnt(1)
L_sf_40:
    buffer_load_dwordx4 v[128:131], v1, s[48:51], s97 offen offset:2048 nt
    s_waitcnt vmcnt(3)
    s_bitcmp0_b32 s57, 23
    s_cbranch_scc1 L_sf_41
    s_waitcnt vmcnt(2)
    s_bitcmp0_b32 s58, 23
    s_cbranch_scc1 L_sf_41
    s_waitcnt vmcnt(1)
L_sf_41:
    buffer_load_dwordx4 v[132:135], v1, s[48:51], s97 offen offset:3072 nt
    s_add_u32 s97, s97, 32768
    v_add_u32 v1, 4096, v1
    v_and_b32 v1, 0x7fff, v1
    s_waitcnt vmcnt(3)
    s_bitcmp0_b32 s57, 24
    s_cbranch_scc1 L_sf_42
    s_waitcnt vmcnt(2)
    s_bitcmp0_b32 s58, 24
    s_cbranch_scc1 L_sf_42
    s_waitcnt vmcnt(1)
L_sf_42:
    buffer_load_dwordx4 v[136:139], v1, s[48:51], s97 offen offset:0 nt
    s_waitcnt vmcnt(3)
    s_bitcmp0_b32 s57, 25
    s_cbranch_scc1 L_sf_43
    s_waitcnt vmcnt(2)
    s_bitcmp0_b32 s58, 25
    s_cbranch_scc1 L_sf_43
    s_waitcnt vmcnt(1)
L_sf_43:
    buffer_load_dwordx4 v[140:143], v1, s[48:51], s97 offen offset:1024 nt
    s_waitcnt vmcnt(3)
    s_bitcmp0_b32 s57, 26
    s_cbranch_scc1 L_sf_44
    s_waitcnt vmcnt(2)
    s_bitcmp0_b32 s58, 26
    s_cbranch_scc1 L_sf_44
    s_waitcnt vmcnt(1)
L_sf_44:
    buffer_load_dwordx4 v[144:147], v1, s[48:51], s97 offen offset:2048 nt
    s_waitcnt vmcnt(3)
    s_bitcmp0_b32 s57, 27
    s_cbranch_scc1 L_sf_45
    s_waitcnt vmcnt(2)
    s_bitcmp0_b32 s58, 27
    s_cbranch_scc1 L_sf_45
    s_waitcnt vmcnt(1)
L_sf_45:
    buffer_load_dwordx4 v[148:151], v1, s[48:51], s97 offen offset:3072 nt
    s_add_u32 s97, s97, 32768
    v_add_u32 v1, 4096, v1
    v_and_b32 v1, 0x7fff, v1
    s_waitcnt vmcnt(3)
    s_bitcmp0_b32 s57, 28
    s_cbranch_scc1 L_sf_46
    s_waitcnt vmcnt(2)
    s_bitcmp0_b32 s58, 28
    s_cbranch_scc1 L_sf_46
    s_waitcnt vmcnt(1)
L_sf_46:
    buffer_load_dwordx4 v[152:155], v1, s[48:51], s97 offen offset:0 nt
    s_waitcnt vmcnt(3)
    s_bitcmp0_b32 s57, 29
    s_cbranch_scc1 L_sf_47
    s_waitcnt vmcnt(2)
    s_bitcmp0_b32 s58, 29
    s_cbranch_scc1 L_sf_47
    s_waitcnt vmcnt(1)
L_sf_47:
    buffer_load_dwordx4 v[156:159], v1, s[48:51], s97 offen offset:1024 nt
    s_waitcnt vmcnt(3)
    s_bitcmp0_b32 s57, 30
    s_cbranch_scc1 L_sf_48
    s_waitcnt vmcnt(2)
    s_bitcmp0_b32 s58, 30
    s_cbranch_scc1 L_sf_48
    s_waitcnt vmcnt(1)
L_sf_48:
    buffer_load_dwordx4 v[160:163], v1, s[48:51], s97 offen offset:2048 nt
    v_min_u32 v39, 15, v0
    v_and_b32 v38, 1, v39
    v_mul_u32_u24 v38, 126, v38
    v_lshl_add_u32 v39, v39, 1, v38
    buffer_load_dword v37, v39, s[44:47], 0 offen sc1
    s_waitcnt vmcnt(4)
    s_bitcmp0_b32 s57, 31
    s_cbranch_scc1 L_sf_49
    s_waitcnt vmcnt(3)
    s_bitcmp0_b32 s58, 31
    s_cbranch_scc1 L_sf_49
    s_waitcnt vmcnt(2)
L_sf_49:
    buffer_load_dwordx4 v[164:167], v1, s[48:51], s97 offen offset:3072 nt
    s_mov_b32 s97, 0
    v_add_u32 v1, 4096, v1
    v_and_b32 v1, 0x7fff, v1
    s_waitcnt vmcnt(4)
    s_bitcmp0_b32 s14, 0
    s_cbranch_scc1 L_sf_50
    s_waitcnt vmcnt(3)
    s_bitcmp0_b32 s15, 0
    s_cbranch_scc1 L_sf_50
    s_waitcnt vmcnt(2)
L_sf_50:
    s_add_u32 m0, s12, 0
    s_nop 0
    buffer_load_dwordx4 v1, s[52:55], s97 offen offset:0 nt lds
    s_waitcnt vmcnt(4)
    s_bitcmp0_b32 s14, 1
    s_cbranch_scc1 L_sf_51
    s_waitcnt vmcnt(3)
    s_bitcmp0_b32 s15, 1
    s_cbranch_scc1 L_sf_51
    s_waitcnt vmcnt(1)
L_sf_51:
    buffer_load_dwordx4 v1, s[52:55], s97 offen offset:1024 nt lds
    s_waitcnt vmcnt(4)
    s_bitcmp0_b32 s14, 2
    s_cbranch_scc1 L_sf_52
    s_waitcnt vmcnt(2)
    s_bitcmp0_b32 s15, 2
    s_cbranch_scc1 L_sf_52
    s_waitcnt vmcnt(1)
L_sf_52:
    buffer_load_dwordx4 v1, s[52:55], s97 offen offset:2048 nt lds
    s_waitcnt vmcnt(3)
    s_bitcmp0_b32 s14, 3
    s_cbranch_scc1 L_sf_53
    s_waitcnt vmcnt(2)
    s_bitcmp0_b32 s15, 3
    s_cbranch_scc1 L_sf_53
    s_waitcnt vmcnt(1)
L_sf_53:
    buffer_load_dwordx4 v1, s[52:55], s97 offen offset:3072 nt lds
    s_add_u32 s97, s97, 32768
    v_add_u32 v1, 4096, v1
    v_and_b32 v1, 0x7fff, v1
    v_cmp_eq_u32 vcc, 0, v37
    s_nop 0
    s_or_b32 s96, vcc_lo, vcc_hi
    buffer_load_dwordx4 v[4:7], v2, s[40:43], s98 offen sc1
    s_waitcnt vmcnt(4)
    s_bitcmp0_b32 s14, 4
    s_cbranch_scc1 L_sf_54
    s_waitcnt vmcnt(3)
    s_bitcmp0_b32 s15, 4
    s_cbranch_scc1 L_sf_54
    s_waitcnt vmcnt(2)
L_sf_54:
    s_add_u32 m0, s12, 4096
    s_nop 0
    buffer_load_dwordx4 v1, s[52:55], s97 offen offset:0 nt lds
    s_waitcnt vmcnt(4)
    s_bitcmp0_b32 s14, 5
    s_cbranch_scc1 L_sf_55
    s_waitcnt vmcnt(3)
    s_bitcmp0_b32 s15, 5
    s_cbranch_scc1 L_sf_55
    s_waitcnt vmcnt(2)
L_sf_55:
    buffer_load_dwordx4 v1, s[52:55], s97 offen offset:1024 nt lds
    s_waitcnt vmcnt(4)
    s_bitcmp0_b32 s14, 6
    s_cbranch_scc1 L_sf_56
    s_waitcnt vmcnt(3)
    s_bitcmp0_b32 s15, 6
    s_cbranch_scc1 L_sf_56
    s_waitcnt vmcnt(1)
L_sf_56:
    buffer_load_dwordx4 v1, s[52:55], s97 offen offset:2048 nt lds
    s_waitcnt vmcnt(4)
    s_bitcmp0_b32 s14, 7
    s_cbranch_scc1 L_sf_57
    s_waitcnt vmcnt(2)
    s_bitcmp0_b32 s15, 7
    s_cbranch_scc1 L_sf_57
    s_waitcnt vmcnt(1)
L_sf_57:
    buffer_load_dwordx4 v1, s[52:55], s97 offen offset:3072 nt lds
    s_add_u32 s97, s97, 32768
    v_add_u32 v1, 4096, v1
    v_and_b32 v1, 0x7fff, v1
L_k_join:
    s_waitcnt vmcnt(4)
    v_max3_u32 v38, v4, v5, v6
    v_max_u32 v38, v38, v7
    v_cmp_eq_u32 vcc, -1, v38
    s_cmp_lg_u32 s96, 0
    s_cbranch_scc1 L_qslow
    s_cbranch_vccnz L_qslow2
L_qok:
    v_dot2_f32_bf16 v8, v72, v4, 0
    v_dot2_f32_bf16 v9, v76, v4, 0
    v_dot2_f32_bf16 v10, v80, v4, 0
    v_dot2_f32_bf16 v11, v84, v4, 0
    v_dot2_f32_bf16 v24, v88, v4, 0
    v_dot2_f32_bf16 v25, v92, v4, 0
    v_dot2_f32_bf16 v26, v96, v4, 0
    v_dot2_f32_bf16 v27, v100, v4, 0
    v_dot2_f32_bf16 v8, v73, v5, v8
    v_dot2_f32_bf16 v9, v77, v5, v9
    v_dot2_f32_bf16 v10, v81, v5, v10
    v_dot2_f32_bf16 v11, v85, v5, v11
    v_dot2_f32_bf16 v24, v89, v5, v24
    v_dot2_f32_bf16 v25, v93, v5, v25
    v_dot2_f32_bf16 v26, v97, v5, v26
    v_dot2_f32_bf16 v27, v101, v5, v27
    v_dot2_f32_bf16 v8, v74, v6, v8
    v_dot2_f32_bf16 v9, v78, v6, v9
    v_dot2_f32_bf16 v10, v82, v6, v10
    v_dot2_f32_bf16 v11, v86, v6, v11
    v_dot2_f32_bf16 v24, v90, v6, v24
    v_dot2_f32_bf16 v25, v94, v6, v25
    v_dot2_f32_bf16 v26, v98, v6, v26
    v_dot2_f32_bf16 v27, v102, v6, v27
    v_dot2_f32_bf16 v8, v75, v7, v8
    v_dot2_f32_bf16 v9, v79, v7, v9
    v_dot2_f32_bf16 v10, v83, v7, v10
    v_dot2_f32_bf16 v11, v87, v7, v11
    v_dot2_f32_bf16 v24, v91, v7, v24
    v_dot2_f32_bf16 v25, v95, v7, v25
    v_dot2_f32_bf16 v26, v99, v7, v26
    v_dot2_f32_bf16 v27, v103, v7, v27
    v_add_f32_dpp v8, v8, v8 row_ror:8 row_mask:0xf bank_mask:0x3
    v_add_f32_dpp v10, v10, v10 row_ror:8 row_mask:0xf bank_mask:0x3
    v_add_f32_dpp v24, v24, v24 row_ror:8 row_mask:0xf bank_mask:0x3
    v_add_f32_dpp v26, v26, v26 row_ror:8 row_mask:0xf bank_mask:0x3
    v_add_f32_dpp v8, v9, v9 row_ror:8 row_mask:0xf bank_mask:0xc
    v_add_f32_dpp v10, v11, v11 row_ror:8 row_mask:0xf bank_mask:0xc
    v_add_f32_dpp v24, v25, v25 row_ror:8 row_mask:0xf bank_mask:0xc
    v_add_f32_dpp v26, v27, v27 row_ror:8 row_mask:0xf bank_mask:0xc
    v_add_f32_dpp v14, v8, v8 row_half_mirror row_mask:0xf bank_mask:0x5
    v_add_f32_dpp v15, v24, v24 row_half_mirror row_mask:0xf bank_mask:0x5
    v_add_f32_dpp v14, v10, v10 row_half_mirror row_mask:0xf bank_mask:0xa
    v_add_f32_dpp v15, v26, v26 row_half_mirror row_mask:0xf bank_mask:0xa
    s_nop 0
    v_add_f32_dpp v14, v14, v14 quad_perm:[1,0,3,2] row_mask:0xf bank_mask:0xf
    v_add_f32_dpp v15, v15, v15 quad_perm:[1,0,3,2] row_mask:0xf bank_mask:0xf
    s_nop 0
    v_add_f32_dpp v14, v14, v14 quad_perm:[2,3,0,1] row_mask:0xf bank_mask:0xf
    v_add_f32_dpp v15, v15, v15 quad_perm:[2,3,0,1] row_mask:0xf bank_mask:0xf
    s_waitcnt vmcnt(3)
    s_bitcmp0_b32 s14, 8
    s_cbranch_scc1 L_sf_68
    s_waitcnt vmcnt(2)
    s_bitcmp0_b32 s15, 8
    s_cbranch_scc1 L_sf_68
    s_waitcnt vmcnt(1)
L_sf_68:
    buffer_load_dwordx4 v[72:75], v1, s[52:55], s97 offen offset:0 nt
    v_dot2_f32_bf16 v8, v40, v4, 0
    v_dot2_f32_bf16 v9, v44, v4, 0
    v_dot2_f32_bf16 v10, v48, v4, 0
    v_dot2_f32_bf16 v11, v52, v4, 0
    v_dot2_f32_bf16 v24, v56, v4, 0
    v_dot2_f32_bf16 v25, v60, v4, 0
    v_dot2_f32_bf16 v26, v64, v4, 0
    v_dot2_f32_bf16 v27, v68, v4, 0
    v_dot2_f32_bf16 v28, v104, v4, 0
    v_dot2_f32_bf16 v29, v108, v4, 0
    v_dot2_f32_bf16 v30, v112, v4, 0
    v_dot2_f32_bf16 v31, v116, v4, 0
    v_dot2_f32_bf16 v8, v41, v5, v8
    v_dot2_f32_bf16 v9, v45, v5, v9
    v_dot2_f32_bf16 v10, v49, v5, v10
    v_dot2_f32_bf16 v11, v53, v5, v11
    v_dot2_f32_bf16 v24, v57, v5, v24
    v_dot2_f32_bf16 v25, v61, v5, v25
    v_dot2_f32_bf16 v26, v65, v5, v26
    v_dot2_f32_bf16 v27, v69, v5, v27
    v_dot2_f32_bf16 v28, v105, v5, v28
    v_dot2_f32_bf16 v29, v109, v5, v29
    v_dot2_f32_bf16 v30, v113, v5, v30
    v_dot2_f32_bf16 v31, v117, v5, v31
    v_dot2_f32_bf16 v8, v42, v6, v8
    v_dot2_f32_bf16 v9, v46, v6, v9
    v_dot2_f32_bf16 v10, v50, v6, v10
    v_dot2_f32_bf16 v11, v54, v6, v11
    v_dot2_f32_bf16 v24, v58, v6, v24
    v_dot2_f32_bf16 v25, v62, v6, v25
    v_dot2_f32_bf16 v26, v66, v6, v26
    v_dot2_f32_bf16 v27, v70, v6, v27
    v_dot2_f32_bf16 v28, v106, v6, v28
    v_dot2_f32_bf16 v29, v110, v6, v29
    v_dot2_f32_bf16 v30, v114, v6, v30
    v_dot2_f32_bf16 v31, v118, v6, v31
    v_dot2_f32_bf16 v8, v43, v7, v8
    v_dot2_f32_bf16 v9, v47, v7, v9
    v_dot2_f32_bf16 v10, v51, v7, v10
    v_dot2_f32_bf16 v11, v55, v7, v11
    v_dot2_f32_bf16 v24, v59, v7, v24
    v_dot2_f32_bf16 v25, v63, v7, v25
    v_dot2_f32_bf16 v26, v67, v7, v26
    v_dot2_f32_bf16 v27, v71, v7, v27
    v_dot2_f32_bf16 v28, v107, v7, v28
    v_dot2_f32_bf16 v29, v111, v7, v29
    v_dot2_f32_bf16 v30, v115, v7, v30
    v_dot2_f32_bf16 v31, v119, v7, v31
    v_add_f32_dpp v8, v8, v8 row_ror:8 row_mask:0xf bank_mask:0x3
    v_add_f32_dpp v10, v10, v10 row_ror:8 row_mask:0xf bank_mask:0x3
    v_add_f32_dpp v24, v24, v24 row_ror:8 row_mask:0xf bank_mask:0x3
    v_add_f32_dpp v26, v26, v26 row_ror:8 row_mask:0xf bank_mask:0x3
    v_add_f32_dpp v28, v28, v28 row_ror:8 row_mask:0xf bank_mask:0x3
    v_add_f32_dpp v30, v30, v30 row_ror:8 row_mask:0xf bank_mask:0x3
    v_add_f32_dpp v8, v9, v9 row_ror:8 row_mask:0xf bank_mask:0xc
    v_add_f32_dpp v10, v11, v11 row_ror:8 row_mask:0xf bank_mask:0xc
    v_add_f32_dpp v24, v25, v25 row_ror:8 row_mask:0xf bank_mask:0xc
    v_add_f32_dpp v26, v27, v27 row_ror:8 row_mask:0xf bank_mask:0xc
    v_add_f32_dpp v28, v29, v29 row_ror:8 row_mask:0xf bank_mask:0xc
    v_add_f32_dpp v30, v31, v31 row_ror:8 row_mask:0xf bank_mask:0xc
    v_add_f32_dpp v12, v8, v8 row_half_mirror row_mask:0xf bank_mask:0x5
    v_add_f32_dpp v13, v24, v24 row_half_mirror row_mask:0xf bank_mask:0x5
    v_add_f32_dpp v16, v28, v28 row_half_mirror row_mask:0xf bank_mask:0x5
    v_add_f32_dpp v12, v10, v10 row_half_mirror row_mask:0xf bank_mask:0xa
    v_add_f32_dpp v13, v26, v26 row_half_mirror row_mask:0xf bank_mask:0xa
    v_add_f32_dpp v16, v30, v30 row_half_mirror row_mask:0xf bank_mask:0xa
    v_add_f32_dpp v12, v12, v12 quad_perm:[1,0,3,2] row_mask:0xf bank_mask:0xf
    v_add_f32_dpp v13, v13, v13 quad_perm:[1,0,3,2] row_mask:0xf bank_mask:0xf
    v_add_f32_dpp v16, v16, v16 quad_perm:[1,0,3,2] row_mask:0xf bank_mask:0xf
    v_add_f32_dpp v12, v12, v12 quad_perm:[2,3,0,1] row_mask:0xf bank_mask:0xf
    v_add_f32_dpp v13, v13, v13 quad_perm:[2,3,0,1] row_mask:0xf bank_mask:0xf
    v_add_f32_dpp v16, v16, v16 quad_perm:[2,3,0,1] row_mask:0xf bank_mask:0xf
    s_waitcnt vmcnt(3)
    s_bitcmp0_b32 s14, 9
    s_cbranch_scc1 L_sf_69
    s_waitcnt vmcnt(2)
    s_bitcmp0_b32 s15, 9
    s_cbranch_scc1 L_sf_69
    s_waitcnt vmcnt(1)
L_sf_69:
    buffer_load_dwordx4 v[76:79], v1, s[52:55], s97 offen offset:1024 nt
    v_dot2_f32_bf16 v8, v120, v4, 0
    v_dot2_f32_bf16 v9, v124, v4, 0
    v_dot2_f32_bf16 v10, v128, v4, 0
    v_dot2_f32_bf16 v11, v132, v4, 0
    v_dot2_f32_bf16 v24, v136, v4, 0
    v_dot2_f32_bf16 v25, v140, v4, 0
    v_dot2_f32_bf16 v26, v144, v4, 0
    v_dot2_f32_bf16 v27, v148, v4, 0
    v_dot2_f32_bf16 v8, v121, v5, v8
    v_dot2_f32_bf16 v9, v125, v5, v9
    v_dot2_f32_bf16 v10, v129, v5, v10
    v_dot2_f32_bf16 v11, v133, v5, v11
    v_dot2_f32_bf16 v24, v137, v5, v24
    v_dot2_f32_bf16 v25, v141, v5, v25
    v_dot2_f32_bf16 v26, v145, v5, v26
    v_dot2_f32_bf16 v27, v149, v5, v27
    v_dot2_f32_bf16 v8, v122, v6, v8
    v_dot2_f32_bf16 v9, v126, v6, v9
    v_dot2_f32_bf16 v10, v130, v6, v10
    v_dot2_f32_bf16 v11, v134, v6, v11
    v_dot2_f32_bf16 v24, v138, v6, v24
    v_dot2_f32_bf16 v25, v142, v6, v25
    v_dot2_f32_bf16 v26, v146, v6, v26
    v_dot2_f32_bf16 v27, v150, v6, v27
    v_dot2_f32_bf16 v8, v123, v7, v8
    v_dot2_f32_bf16 v9, v127, v7, v9
    v_dot2_f32_bf16 v10, v131, v7, v10
    v_dot2_f32_bf16 v11, v135, v7, v11
    v_dot2_f32_bf16 v24, v139, v7, v24
    v_dot2_f32_bf16 v25, v143, v7, v25
    v_dot2_f32_bf16 v26, v147, v7, v26
    v_dot2_f32_bf16 v27, v151, v7, v27
    v_add_f32_dpp v8, v8, v8 row_ror:8 row_mask:0xf bank_mask:0x3
    v_add_f32_dpp v10, v10, v10 row_ror:8 row_mask:0xf bank_mask:0x3
    v_add_f32_dpp v24, v24, v24 row_ror:8 row_mask:0xf bank_mask:0x3
    v_add_f32_dpp v26, v26, v26 row_ror:8 row_mask:0xf bank_mask:0x3
    v_add_f32_dpp v8, v9, v9 row_ror:8 row_mask:0xf bank_mask:0xc
    v_add_f32_dpp v10, v11, v11 row_ror:8 row_mask:0xf bank_mask:0xc
    v_add_f32_dpp v24, v25, v25 row_ror:8 row_mask:0xf bank_mask:0xc
    v_add_f32_dpp v26, v27, v27 row_ror:8 row_mask:0xf bank_mask:0xc
    v_add_f32_dpp v17, v8, v8 row_half_mirror row_mask:0xf bank_mask:0x5
    v_add_f32_dpp v18, v24, v24 row_half_mirror row_mask:0xf bank_mask:0x5
    v_add_f32_dpp v17, v10, v10 row_half_mirror row_mask:0xf bank_mask:0xa
    v_add_f32_dpp v18, v26, v26 row_half_mirror row_mask:0xf bank_mask:0xa
    s_nop 0
    v_add_f32_dpp v17, v17, v17 quad_perm:[1,0,3,2] row_mask:0xf bank_mask:0xf
    v_add_f32_dpp v18, v18, v18 quad_perm:[1,0,3,2] row_mask:0xf bank_mask:0xf
    s_nop 0
    v_add_f32_dpp v17, v17, v17 quad_perm:[2,3,0,1] row_mask:0xf bank_mask:0xf
    v_add_f32_dpp v18, v18, v18 quad_perm:[2,3,0,1] row_mask:0xf bank_mask:0xf
    s_waitcnt vmcnt(3)
    s_bitcmp0_b32 s14, 10
    s_cbranch_scc1 L_sf_70
    s_waitcnt vmcnt(2)
    s_bitcmp0_b32 s15, 10
    s_cbranch_scc1 L_sf_70
    s_waitcnt vmcnt(1)
L_sf_70:
    buffer_load_dwordx4 v[80:83], v1, s[52:55], s97 offen offset:2048 nt
    s_waitcnt vmcnt(3)
    s_bitcmp0_b32 s14, 11
    s_cbranch_scc1 L_sf_71
    s_waitcnt vmcnt(2)
    s_bitcmp0_b32 s15, 11
    s_cbranch_scc1 L_sf_71
    s_waitcnt vmcnt(1)
L_sf_71:
    buffer_load_dwordx4 v[84:87], v1, s[52:55], s97 offen offset:3072 nt
    s_add_u32 s97, s97, 32768
    v_add_u32 v1, 4096, v1
    v_and_b32 v1, 0x7fff, v1
    s_cmp_eq_u32 s12, -1
    s_cbranch_scc1 L_nopfrd
    v_lshl_add_u32 v38, v0, 4, s12
    ds_read_b128 v[40:43], v38 offset:0
    ds_read_b128 v[44:47], v38 offset:1024
    ds_read_b128 v[48:51], v38 offset:2048
    ds_read_b128 v[52:55], v38 offset:3072
    ds_read_b128 v[56:59], v38 offset:4096
    ds_read_b128 v[60:63], v38 offset:5120
    ds_read_b128 v[64:67], v38 offset:6144
    ds_read_b128 v[68:71], v38 offset:7168
L_nopfrd:
    v_dot2_f32_bf16 v8, v152, v4, 0
    v_dot2_f32_bf16 v9, v156, v4, 0
    v_dot2_f32_bf16 v10, v160, v4, 0
    v_dot2_f32_bf16 v11, v164, v4, 0
    v_dot2_f32_bf16 v8, v153, v5, v8
    v_dot2_f32_bf16 v9, v157, v5, v9
    v_dot2_f32_bf16 v10, v161, v5, v10
    v_dot2_f32_bf16 v11, v165, v5, v11
    v_dot2_f32_bf16 v8, v154, v6, v8
    v_dot2_f32_bf16 v9, v158, v6, v9
    v_dot2_f32_bf16 v10, v162, v6, v10
    v_dot2_f32_bf16 v11, v166, v6, v11
    v_dot2_f32_bf16 v8, v155, v7, v8
    v_dot2_f32_bf16 v9, v159, v7, v9
    v_dot2_f32_bf16 v10, v163, v7, v10
    v_dot2_f32_bf16 v11, v167, v7, v11
    v_add_f32_dpp v8, v8, v8 row_ror:8 row_mask:0xf bank_mask:0x3
    s_nop 0
    v_add_f32_dpp v10, v10, v10 row_ror:8 row_mask:0xf bank_mask:0x3
    v_add_f32_dpp v8, v9, v9 row_ror:8 row_mask:0xf bank_mask:0xc
    v_add_f32_dpp v10, v11, v11 row_ror:8 row_mask:0xf bank_mask:0xc
    s_nop 0
    v_add_f32_dpp v19, v8, v8 row_half_mirror row_mask:0xf bank_mask:0x5
    v_add_f32_dpp v19, v10, v10 row_half_mirror row_mask:0xf bank_mask:0xa
    s_nop 1
    v_add_f32_dpp v19, v19, v19 quad_perm:[1,0,3,2] row_mask:0xf bank_mask:0xf
    s_nop 1
    v_add_f32_dpp v19, v19, v19 quad_perm:[2,3,0,1] row_mask:0xf bank_mask:0xf
    v_max3_f32 v3, v12, v13, v14
    v_max3_f32 v8, v15, v16, v17
    v_max3_f32 v3, v3, v18, v19
    v_max_f32 v3, v3, v8
    s_nop 1
    v_max_f32_dpp v3, v3, v3 row_ror:4 row_mask:0xf bank_mask:0xf
    s_nop 1
    v_max_f32_dpp v3, v3, v3 row_ror:8 row_mask:0xf bank_mask:0xf
    v_mov_b32 v8, v3
    s_nop 1
    v_permlane16_swap_b32 v3, v8
    v_max_f32 v3, v3, v8
    v_mov_b32 v8, v3
    s_nop 1
    v_permlane32_swap_b32 v3, v8
    v_max_f32 v3, v3, v8
    s_mov_b32 s96, 0x3e0293ee
    v_mul_f32 v8, s96, v3
    v_fma_f32 v12, v12, s96, -v8
    v_fma_f32 v13, v13, s96, -v8
    v_fma_f32 v14, v14, s96, -v8
    v_fma_f32 v15, v15, s96, -v8
    v_fma_f32 v16, v16, s96, -v8
    v_fma_f32 v17, v17, s96, -v8
    v_fma_f32 v18, v18, s96, -v8
    v_fma_f32 v19, v19, s96, -v8
    v_exp_f32 v12, v12
    v_exp_f32 v13, v13
    v_exp_f32 v14, v14
    v_exp_f32 v15, v15
    v_exp_f32 v16, v16
    v_exp_f32 v17, v17
    v_exp_f32 v18, v18
    v_exp_f32 v19, v19
    v_add_f32 v9, v12, v13
    v_add_f32 v10, v14, v15
    v_add_f32 v11, v16, v17
    v_add_f32 v3, v18, v19
    v_add_f32 v9, v9, v10
    v_add_f32 v3, v3, v11
    v_add_f32 v9, v9, v3
    v_cvt_pk_bf16_f32 v12, v12, v12
    v_cvt_pk_bf16_f32 v13, v13, v13
    v_cvt_pk_bf16_f32 v14, v14, v14
    v_cvt_pk_bf16_f32 v15, v15, v15
    v_cvt_pk_bf16_f32 v16, v16, v16
    v_cvt_pk_bf16_f32 v17, v17, v17
    v_cvt_pk_bf16_f32 v18, v18, v18
    v_cvt_pk_bf16_f32 v19, v19, v19
    v_add_f32_dpp v9, v9, v9 row_ror:4 row_mask:0xf bank_mask:0xf
    s_nop 1
    v_add_f32_dpp v9, v9, v9 row_ror:8 row_mask:0xf bank_mask:0xf
    v_mov_b32 v10, v9
    s_nop 1
    v_permlane16_swap_b32 v9, v10
    v_add_f32 v9, v9, v10
    v_mov_b32 v10, v9
    s_nop 1
    v_permlane32_swap_b32 v9, v10
    v_add_f32 v9, v9, v10
    s_mov_b64 exec, 1
    s_cmp_lg_u32 s13, 0
    s_cbranch_scc1 L_mljob
    s_lshl_b32 s96, s3, 3
    s_add_u32 s96, s96, 161920
    v_mov_b32 v10, s96
    v_mov_b32 v11, 162068
    v_mov_b32 v3, 1
    ds_write_b64 v10, v[8:9]
    ds_add_u32 v11, v3
L_mldone:
    s_mov_b64 exec, -1
    v_lshrrev_b32 v2, 1, v2
    v_and_b32_dpp v24, v14, v20 row_newbcast:0 row_mask:0xf bank_mask:0xf
    v_and_b32_dpp v25, v14, v21 row_newbcast:0 row_mask:0xf bank_mask:0xf
    v_and_b32_dpp v26, v14, v22 row_newbcast:0 row_mask:0xf bank_mask:0xf
    v_and_b32_dpp v27, v14, v23 row_newbcast:0 row_mask:0xf bank_mask:0xf
    s_waitcnt vmcnt(3)
    s_bitcmp0_b32 s14, 12
    s_cbranch_scc1 L_sf_72
    s_waitcnt vmcnt(2)
    s_bitcmp0_b32 s15, 12
    s_cbranch_scc1 L_sf_72
    s_waitcnt vmcnt(1)
L_sf_72:
    buffer_load_dwordx4 v[88:91], v1, s[52:55], s97 offen offset:0 nt
    v_mfma_f32_16x16x32_bf16 v[32:35], v[24:27], v[72:75], v[32:35]
    s_cmp_eq_u32 s12, -1
    s_cbranch_scc1 L_nopfpv8
    s_waitcnt lgkmcnt(0)
    v_and_b32_dpp v24, v12, v20 row_newbcast:0 row_mask:0xf bank_mask:0xf
    v_and_b32_dpp v25, v12, v21 row_newbcast:0 row_mask:0xf bank_mask:0xf
    v_and_b32_dpp v26, v12, v22 row_newbcast:0 row_mask:0xf bank_mask:0xf
    v_and_b32_dpp v27, v12, v23 row_newbcast:0 row_mask:0xf bank_mask:0xf
    s_nop 1
    v_mfma_f32_16x16x32_bf16 v[32:35], v[24:27], v[40:43], v[32:35]
    v_and_b32_dpp v28, v12, v20 row_newbcast:8 row_mask:0xf bank_mask:0xf
    v_and_b32_dpp v29, v12, v21 row_newbcast:8 row_mask:0xf bank_mask:0xf
    v_and_b32_dpp v30, v12, v22 row_newbcast:8 row_mask:0xf bank_mask:0xf
    v_and_b32_dpp v31, v12, v23 row_newbcast:8 row_mask:0xf bank_mask:0xf
    s_nop 1
    v_mfma_f32_16x16x32_bf16 v[32:35], v[28:31], v[44:47], v[32:35]
    v_and_b32_dpp v24, v12, v20 row_newbcast:4 row_mask:0xf bank_mask:0xf
    v_and_b32_dpp v25, v12, v21 row_newbcast:4 row_mask:0xf bank_mask:0xf
    v_and_b32_dpp v26, v12, v22 row_newbcast:4 row_mask:0xf bank_mask:0xf
    v_and_b32_dpp v27, v12, v23 row_newbcast:4 row_mask:0xf bank_mask:0xf
    s_nop 1
    v_mfma_f32_16x16x32_bf16 v[32:35], v[24:27], v[48:51], v[32:35]
    v_and_b32_dpp v28, v12, v20 row_newbcast:12 row_mask:0xf bank_mask:0xf
    v_and_b32_dpp v29, v12, v21 row_newbcast:12 row_mask:0xf bank_mask:0xf
    v_and_b32_dpp v30, v12, v22 row_newbcast:12 row_mask:0xf bank_mask:0xf
    v_and_b32_dpp v31, v12, v23 row_newbcast:12 row_mask:0xf bank_mask:0xf
    s_nop 1
    v_mfma_f32_16x16x32_bf16 v[32:35], v[28:31], v[52:55], v[32:35]
L_nopfpv8:
    v_and_b32_dpp v28, v14, v20 row_newbcast:8 row_mask:0xf bank_mask:0xf
    v_and_b32_dpp v29, v14, v21 row_newbcast:8 row_mask:0xf bank_mask:0xf
    v_and_b32_dpp v30, v14, v22 row_newbcast:8 row_mask:0xf bank_mask:0xf
    v_and_b32_dpp v31, v14, v23 row_newbcast:8 row_mask:0xf bank_mask:0xf
    s_waitcnt vmcnt(3)
    s_bitcmp0_b32 s14, 13
    s_cbranch_scc1 L_sf_73
    s_waitcnt vmcnt(2)
    s_bitcmp0_b32 s15, 13
    s_cbranch_scc1 L_sf_73
    s_waitcnt vmcnt(1)
L_sf_73:
    buffer_load_dwordx4 v[92:95], v1, s[52:55], s97 offen offset:1024 nt
    v_mfma_f32_16x16x32_bf16 v[32:35], v[28:31], v[76:79], v[32:35]
    s_cmp_eq_u32 s12, -1
    s_cbranch_scc1 L_nopfpv9
    s_waitcnt lgkmcnt(0)
    v_and_b32_dpp v24, v13, v20 row_newbcast:0 row_mask:0xf bank_mask:0xf
    v_and_b32_dpp v25, v13, v21 row_newbcast:0 row_mask:0xf bank_mask:0xf
    v_and_b32_dpp v26, v13, v22 row_newbcast:0 row_mask:0xf bank_mask:0xf
    v_and_b32_dpp v27, v13, v23 row_newbcast:0 row_mask:0xf bank_mask:0xf
    s_nop 1
    v_mfma_f32_16x16x32_bf16 v[32:35], v[24:27], v[56:59], v[32:35]
    v_and_b32_dpp v28, v13, v20 row_newbcast:8 row_mask:0xf bank_mask:0xf
    v_and_b32_dpp v29, v13, v21 row_newbcast:8 row_mask:0xf bank_mask:0xf
    v_and_b32_dpp v30, v13, v22 row_newbcast:8 row_mask:0xf bank_mask:0xf
    v_and_b32_dpp v31, v13, v23 row_newbcast:8 row_mask:0xf bank_mask:0xf
    s_nop 1
    v_mfma_f32_16x16x32_bf16 v[32:35], v[28:31], v[60:63], v[32:35]
    v_and_b32_dpp v24, v13, v20 row_newbcast:4 row_mask:0xf bank_mask:0xf
    v_and_b32_dpp v25, v13, v21 row_newbcast:4 row_mask:0xf bank_mask:0xf
    v_and_b32_dpp v26, v13, v22 row_newbcast:4 row_mask:0xf bank_mask:0xf
    v_and_b32_dpp v27, v13, v23 row_newbcast:4 row_mask:0xf bank_mask:0xf
    s_nop 1
    v_mfma_f32_16x16x32_bf16 v[32:35], v[24:27], v[64:67], v[32:35]
    v_and_b32_dpp v28, v13, v20 row_newbcast:12 row_mask:0xf bank_mask:0xf
    v_and_b32_dpp v29, v13, v21 row_newbcast:12 row_mask:0xf bank_mask:0xf
    v_and_b32_dpp v30, v13, v22 row_newbcast:12 row_mask:0xf bank_mask:0xf
    v_and_b32_dpp v31, v13, v23 row_newbcast:12 row_mask:0xf bank_mask:0xf
    s_nop 1
    v_mfma_f32_16x16x32_bf16 v[32:35], v[28:31], v[68:71], v[32:35]
L_nopfpv9:
    v_and_b32_dpp v24, v14, v20 row_newbcast:4 row_mask:0xf bank_mask:0xf
    v_and_b32_dpp v25, v14, v21 row_newbcast:4 row_mask:0xf bank_mask:0xf
    v_and_b32_dpp v26, v14, v22 row_newbcast:4 row_mask:0xf bank_mask:0xf
    v_and_b32_dpp v27, v14, v23 row_newbcast:4 row_mask:0xf bank_mask:0xf
    s_waitcnt vmcnt(3)
    s_bitcmp0_b32 s14, 14
    s_cbranch_scc1 L_sf_74
    s_waitcnt vmcnt(2)
    s_bitcmp0_b32 s15, 14
    s_cbranch_scc1 L_sf_74
    s_waitcnt vmcnt(1)
L_sf_74:
    buffer_load_dwordx4 v[96:99], v1, s[52:55], s97 offen offset:2048 nt
    v_mfma_f32_16x16x32_bf16 v[32:35], v[24:27], v[80:83], v[32:35]
    v_and_b32_dpp v28, v14, v20 row_newbcast:12 row_mask:0xf bank_mask:0xf
    v_and_b32_dpp v29, v14, v21 row_newbcast:12 row_mask:0xf bank_mask:0xf
    v_and_b32_dpp v30, v14, v22 row_newbcast:12 row_mask:0xf bank_mask:0xf
    v_and_b32_dpp v31, v14, v23 row_newbcast:12 row_mask:0xf bank_mask:0xf
    s_waitcnt vmcnt(3)
    s_bitcmp0_b32 s14, 15
    s_cbranch_scc1 L_sf_75
    s_waitcnt vmcnt(2)
    s_bitcmp0_b32 s15, 15
    s_cbranch_scc1 L_sf_75
    s_waitcnt vmcnt(1)
L_sf_75:
    buffer_load_dwordx4 v[100:103], v1, s[52:55], s97 offen offset:3072 nt
    s_add_u32 s97, s97, 32768
    v_add_u32 v1, 4096, v1
    v_and_b32 v1, 0x7fff, v1
    v_mfma_f32_16x16x32_bf16 v[32:35], v[28:31], v[84:87], v[32:35]
    v_and_b32_dpp v24, v15, v20 row_newbcast:0 row_mask:0xf bank_mask:0xf
    v_and_b32_dpp v25, v15, v21 row_newbcast:0 row_mask:0xf bank_mask:0xf
    v_and_b32_dpp v26, v15, v22 row_newbcast:0 row_mask:0xf bank_mask:0xf
    v_and_b32_dpp v27, v15, v23 row_newbcast:0 row_mask:0xf bank_mask:0xf
    s_waitcnt vmcnt(3)
    s_bitcmp0_b32 s14, 16
    s_cbranch_scc1 L_sf_76
    s_waitcnt vmcnt(2)
    s_bitcmp0_b32 s15, 16
    s_cbranch_scc1 L_sf_76
    s_waitcnt vmcnt(1)
L_sf_76:
    buffer_load_dwordx4 v[104:107], v1, s[52:55], s97 offen offset:0 nt
    v_mfma_f32_16x16x32_bf16 v[32:35], v[24:27], v[88:91], v[32:35]
    v_and_b32_dpp v28, v15, v20 row_newbcast:8 row_mask:0xf bank_mask:0xf
    v_and_b32_dpp v29, v15, v21 row_newbcast:8 row_mask:0xf bank_mask:0xf
    v_and_b32_dpp v30, v15, v22 row_newbcast:8 row_mask:0xf bank_mask:0xf
    v_and_b32_dpp v31, v15, v23 row_newbcast:8 row_mask:0xf bank_mask:0xf
    s_waitcnt vmcnt(3)
    s_bitcmp0_b32 s14, 17
    s_cbranch_scc1 L_sf_77
    s_waitcnt vmcnt(2)
    s_bitcmp0_b32 s15, 17
    s_cbranch_scc1 L_sf_77
    s_waitcnt vmcnt(1)
L_sf_77:
    buffer_load_dwordx4 v[108:111], v1, s[52:55], s97 offen offset:1024 nt
    v_mfma_f32_16x16x32_bf16 v[32:35], v[28:31], v[92:95], v[32:35]
    v_and_b32_dpp v24, v15, v20 row_newbcast:4 row_mask:0xf bank_mask:0xf
    v_and_b32_dpp v25, v15, v21 row_newbcast:4 row_mask:0xf bank_mask:0xf
    v_and_b32_dpp v26, v15, v22 row_newbcast:4 row_mask:0xf bank_mask:0xf
    v_and_b32_dpp v27, v15, v23 row_newbcast:4 row_mask:0xf bank_mask:0xf
    s_waitcnt vmcnt(3)
    s_bitcmp0_b32 s14, 18
    s_cbranch_scc1 L_sf_78
    s_waitcnt vmcnt(2)
    s_bitcmp0_b32 s15, 18
    s_cbranch_scc1 L_sf_78
    s_waitcnt vmcnt(1)
L_sf_78:
    buffer_load_dwordx4 v[112:115], v1, s[52:55], s97 offen offset:2048 nt
    v_mfma_f32_16x16x32_bf16 v[32:35], v[24:27], v[96:99], v[32:35]
    v_and_b32_dpp v28, v15, v20 row_newbcast:12 row_mask:0xf bank_mask:0xf
    v_and_b32_dpp v29, v15, v21 row_newbcast:12 row_mask:0xf bank_mask:0xf
    v_and_b32_dpp v30, v15, v22 row_newbcast:12 row_mask:0xf bank_mask:0xf
    v_and_b32_dpp v31, v15, v23 row_newbcast:12 row_mask:0xf bank_mask:0xf
    s_waitcnt vmcnt(3)
    s_bitcmp0_b32 s14, 19
    s_cbranch_scc1 L_sf_79
    s_waitcnt vmcnt(2)
    s_bitcmp0_b32 s15, 19
    s_cbranch_scc1 L_sf_79
    s_waitcnt vmcnt(1)
L_sf_79:
    buffer_load_dwordx4 v[116:119], v1, s[52:55], s97 offen offset:3072 nt
    s_add_u32 s97, s97, 32768
    v_add_u32 v1, 4096, v1
    v_and_b32 v1, 0x7fff, v1
    v_mfma_f32_16x16x32_bf16 v[32:35], v[28:31], v[100:103], v[32:35]
    v_and_b32_dpp v24, v16, v20 row_newbcast:0 row_mask:0xf bank_mask:0xf
    v_and_b32_dpp v25, v16, v21 row_newbcast:0 row_mask:0xf bank_mask:0xf
    v_and_b32_dpp v26, v16, v22 row_newbcast:0 row_mask:0xf bank_mask:0xf
    v_and_b32_dpp v27, v16, v23 row_newbcast:0 row_mask:0xf bank_mask:0xf
    s_waitcnt vmcnt(3)
    s_bitcmp0_b32 s14, 20
    s_cbranch_scc1 L_sf_80
    s_waitcnt vmcnt(2)
    s_bitcmp0_b32 s15, 20
    s_cbranch_scc1 L_sf_80
    s_waitcnt vmcnt(1)
L_sf_80:
    buffer_load_dwordx4 v[120:123], v1, s[52:55], s97 offen offset:0 nt
    v_mfma_f32_16x16x32_bf16 v[32:35], v[24:27], v[104:107], v[32:35]
    v_and_b32_dpp v28, v16, v20 row_newbcast:8 row_mask:0xf bank_mask:0xf
    v_and_b32_dpp v29, v16, v21 row_newbcast:8 row_mask:0xf bank_mask:0xf
    v_and_b32_dpp v30, v16, v22 row_newbcast:8 row_mask:0xf bank_mask:0xf
    v_and_b32_dpp v31, v16, v23 row_newbcast:8 row_mask:0xf bank_mask:0xf
    s_waitcnt vmcnt(3)
    s_bitcmp0_b32 s14, 21
    s_cbranch_scc1 L_sf_81
    s_waitcnt vmcnt(2)
    s_bitcmp0_b32 s15, 21
    s_cbranch_scc1 L_sf_81
    s_waitcnt vmcnt(1)
L_sf_81:
    buffer_load_dwordx4 v[124:127], v1, s[52:55], s97 offen offset:1024 nt
    v_mfma_f32_16x16x32_bf16 v[32:35], v[28:31], v[108:111], v[32:35]
    v_and_b32_dpp v24, v16, v20 row_newbcast:4 row_mask:0xf bank_mask:0xf
    v_and_b32_dpp v25, v16, v21 row_newbcast:4 row_mask:0xf bank_mask:0xf
    v_and_b32_dpp v26, v16, v22 row_newbcast:4 row_mask:0xf bank_mask:0xf
    v_and_b32_dpp v27, v16, v23 row_newbcast:4 row_mask:0xf bank_mask:0xf
    s_waitcnt vmcnt(3)
    s_bitcmp0_b32 s14, 22
    s_cbranch_scc1 L_sf_82
    s_waitcnt vmcnt(2)
    s_bitcmp0_b32 s15, 22
    s_cbranch_scc1 L_sf_82
    s_waitcnt vmcnt(1)
L_sf_82:
    buffer_load_dwordx4 v[128:131], v1, s[52:55], s97 offen offset:2048 nt
    v_mfma_f32_16x16x32_bf16 v[32:35], v[24:27], v[112:115], v[32:35]
    v_and_b32_dpp v28, v16, v20 row_newbcast:12 row_mask:0xf bank_mask:0xf
    v_and_b32_dpp v29, v16, v21 row_newbcast:12 row_mask:0xf bank_mask:0xf
    v_and_b32_dpp v30, v16, v22 row_newbcast:12 row_mask:0xf bank_mask:0xf
    v_and_b32_dpp v31, v16, v23 row_newbcast:12 row_mask:0xf bank_mask:0xf
    s_waitcnt vmcnt(3)
    s_bitcmp0_b32 s14, 23
    s_cbranch_scc1 L_sf_83
    s_waitcnt vmcnt(2)
    s_bitcmp0_b32 s15, 23
    s_cbranch_scc1 L_sf_83
    s_waitcnt vmcnt(1)
L_sf_83:
    buffer_load_dwordx4 v[132:135], v1, s[52:55], s97 offen offset:3072 nt
    s_add_u32 s97, s97, 32768
    v_add_u32 v1, 4096, v1
    v_and_b32 v1, 0x7fff, v1
    v_mfma_f32_16x16x32_bf16 v[32:35], v[28:31], v[116:119], v[32:35]
    v_and_b32_dpp v24, v17, v20 row_newbcast:0 row_mask:0xf bank_mask:0xf
    v_and_b32_dpp v25, v17, v21 row_newbcast:0 row_mask:0xf bank_mask:0xf
    v_and_b32_dpp v26, v17, v22 row_newbcast:0 row_mask:0xf bank_mask:0xf
    v_and_b32_dpp v27, v17, v23 row_newbcast:0 row_mask:0xf bank_mask:0xf
    s_waitcnt vmcnt(3)
    s_bitcmp0_b32 s14, 24
    s_cbranch_scc1 L_sf_84
    s_waitcnt vmcnt(2)
    s_bitcmp0_b32 s15, 24
    s_cbranch_scc1 L_sf_84
    s_waitcnt vmcnt(1)
L_sf_84:
    buffer_load_dwordx4 v[136:139], v1, s[52:55], s97 offen offset:0 nt
    v_mfma_f32_16x16x32_bf16 v[32:35], v[24:27], v[120:123], v[32:35]
    s_or_b32 s96, s59, 0
    s_cbranch_scc0 L_nofrag_85
    v_mov_b32 v104, 162060
L_lw_86:
    ds_read_b32 v105, v104
    s_waitcnt lgkmcnt(0)
    v_cmp_gt_u32 vcc, 4, v105
    s_cbranch_vccz L_lw_86e
    s_sleep 2
    s_sub_u32 s60, s60, 1
    s_cbranch_scc0 L_lw_86
    s_mov_b32 s60, 0
L_lw_86e:
    s_cmp_eq_u32 s59, 0
    s_cbranch_scc1 L_nofrag_85
    v_bfe_u32 v104, v0, 2, 1
    v_bfe_u32 v110, v0, 4, 1
    v_lshl_add_u32 v104, v110, 2, v104
    v_and_b32 v110, 8, v0
    v_add_u32 v104, v104, v110
    v_lshrrev_b32 v110, 5, v0
    v_lshl_add_u32 v104, v110, 4, v104
    v_bfe_u32 v111, v0, 0, 1
    v_mul_u32_u24 v111, 0xaaaa, v111
    v_add_u32 v111, 0x4444, v111
    v_mov_b32 v112, 0
    v_mov_b32 v113, 0
    v_mov_b32 v114, 0
    v_mov_b32 v115, 0
    v_mov_b32 v116, 0
    v_mov_b32 v117, 0
    v_mov_b32 v118, 0
    v_mov_b32 v119, 0
    v_lshlrev_b32 v104, 7, v104
    v_and_b32 v110, 3, v0
    v_lshl_add_u32 v104, v110, 3, v104
    v_lshrrev_b32 v109, 4, v0
    v_and_b32 v110, 1, v0
    s_lshr_b32 s63, s3, 1
    s_and_b32 s62, s3, 1
    s_lshl_b32 s96, s63, 14
    s_lshl_b32 s100, s62, 6
    s_add_u32 s100, s100, 81920
    s_add_u32 s96, s96, s100
    v_add_u32 v104, s96, v104
    ds_read_b64_tr_b16 v[72:73], v104 offset:0
    ds_read_b64_tr_b16 v[74:75], v104 offset:256
    ds_read_b64_tr_b16 v[76:77], v104 offset:4096
    ds_read_b64_tr_b16 v[78:79], v104 offset:4352
    ds_read_b64_tr_b16 v[80:81], v104 offset:32
    ds_read_b64_tr_b16 v[82:83], v104 offset:288
    ds_read_b64_tr_b16 v[84:85], v104 offset:4128
    ds_read_b64_tr_b16 v[86:87], v104 offset:4384
    ds_read_b64_tr_b16 v[88:89], v104 offset:8192
    ds_read_b64_tr_b16 v[90:91], v104 offset:8448
    ds_read_b64_tr_b16 v[92:93], v104 offset:12288
    ds_read_b64_tr_b16 v[94:95], v104 offset:12544
    ds_read_b64_tr_b16 v[96:97], v104 offset:8224
    ds_read_b64_tr_b16 v[98:99], v104 offset:8480
    ds_read_b64_tr_b16 v[100:101], v104 offset:12320
    ds_read_b64_tr_b16 v[102:103], v104 offset:12576
    v_bfe_u32 v105, v0, 1, 3
    v_lshlrev_b32 v105, 8, v105
    v_lshl_add_u32 v105, v109, 5, v105
    v_lshl_add_u32 v105, v110, 4, v105
    v_lshrrev_b32 v106, 3, v0
    v_lshlrev_b32 v106, 7, v106
    v_and_b32 v110, 7, v0
    v_lshl_add_u32 v107, v110, 3, v106
    v_add_u32 v107, s100, v107
    v_lshlrev_b32 v106, 8, v109
    v_and_b32 v110, 15, v0
    v_lshl_add_u32 v106, v110, 2, v106
    v_add_u32 v106, s96, v106
    v_lshlrev_b32 v108, 2, v0
    s_lshl_b32 s96, s62, 2
    s_add_u32 s96, s96, 162088
    v_mov_b32 v109, s96
    s_lshl_b32 s100, s63, 11
    s_lshl_b32 s96, s34, 13
    s_add_u32 s100, s100, s96
    s_add_u32 s100, s100, 106496
    s_mul_i32 s101, s34, 5120
    s_lshl_b32 s96, s35, 9
    s_add_u32 s101, s101, s96
    s_lshl_b32 s96, s62, 8
    s_add_u32 s101, s101, s96
    s_sub_u32 s101, s101, 11264
    s_and_b32 s96, s101, 0xffffe000
    s_add_u32 s101, s101, s96
    s_add_u32 s101, s101, 212992
    v_add_u32 v110, 8192, v108
L_nofrag_85:
    v_and_b32_dpp v28, v17, v20 row_newbcast:8 row_mask:0xf bank_mask:0xf
    v_and_b32_dpp v29, v17, v21 row_newbcast:8 row_mask:0xf bank_mask:0xf
    v_and_b32_dpp v30, v17, v22 row_newbcast:8 row_mask:0xf bank_mask:0xf
    v_and_b32_dpp v31, v17, v23 row_newbcast:8 row_mask:0xf bank_mask:0xf
    s_waitcnt vmcnt(3)
    s_bitcmp0_b32 s14, 25
    s_cbranch_scc1 L_sf_87
    s_waitcnt vmcnt(2)
    s_bitcmp0_b32 s15, 25
    s_cbranch_scc1 L_sf_87
    s_waitcnt vmcnt(1)
L_sf_87:
    buffer_load_dwordx4 v[140:143], v1, s[52:55], s97 offen offset:1024 nt
    v_mfma_f32_16x16x32_bf16 v[32:35], v[28:31], v[124:127], v[32:35]
    v_and_b32_dpp v24, v17, v20 row_newbcast:4 row_mask:0xf bank_mask:0xf
    v_and_b32_dpp v25, v17, v21 row_newbcast:4 row_mask:0xf bank_mask:0xf
    v_and_b32_dpp v26, v17, v22 row_newbcast:4 row_mask:0xf bank_mask:0xf
    v_and_b32_dpp v27, v17, v23 row_newbcast:4 row_mask:0xf bank_mask:0xf
    s_waitcnt vmcnt(3)
    s_bitcmp0_b32 s14, 26
    s_cbranch_scc1 L_sf_88
    s_waitcnt vmcnt(2)
    s_bitcmp0_b32 s15, 26
    s_cbranch_scc1 L_sf_88
    s_waitcnt vmcnt(1)
L_sf_88:
    buffer_load_dwordx4 v[144:147], v1, s[52:55], s97 offen offset:2048 nt
    v_mfma_f32_16x16x32_bf16 v[32:35], v[24:27], v[128:131], v[32:35]
    v_and_b32_dpp v28, v17, v20 row_newbcast:12 row_mask:0xf bank_mask:0xf
    v_and_b32_dpp v29, v17, v21 row_newbcast:12 row_mask:0xf bank_mask:0xf
    v_and_b32_dpp v30, v17, v22 row_newbcast:12 row_mask:0xf bank_mask:0xf
    v_and_b32_dpp v31, v17, v23 row_newbcast:12 row_mask:0xf bank_mask:0xf
    s_waitcnt vmcnt(3)
    s_bitcmp0_b32 s14, 27
    s_cbranch_scc1 L_sf_89
    s_waitcnt vmcnt(2)
    s_bitcmp0_b32 s15, 27
    s_cbranch_scc1 L_sf_89
    s_waitcnt vmcnt(1)
L_sf_89:
    buffer_load_dwordx4 v[148:151], v1, s[52:55], s97 offen offset:3072 nt
    s_add_u32 s97, s97, 32768
    v_add_u32 v1, 4096, v1
    v_and_b32 v1, 0x7fff, v1
    v_mfma_f32_16x16x32_bf16 v[32:35], v[28:31], v[132:135], v[32:35]
    v_and_b32_dpp v24, v18, v20 row_newbcast:0 row_mask:0xf bank_mask:0xf
    v_and_b32_dpp v25, v18, v21 row_newbcast:0 row_mask:0xf bank_mask:0xf
    v_and_b32_dpp v26, v18, v22 row_newbcast:0 row_mask:0xf bank_mask:0xf
    v_and_b32_dpp v27, v18, v23 row_newbcast:0 row_mask:0xf bank_mask:0xf
    s_waitcnt vmcnt(3)
    s_bitcmp0_b32 s14, 28
    s_cbranch_scc1 L_sf_90
    s_waitcnt vmcnt(2)
    s_bitcmp0_b32 s15, 28
    s_cbranch_scc1 L_sf_90
    s_waitcnt vmcnt(1)
L_sf_90:
    buffer_load_dwordx4 v[152:155], v1, s[52:55], s97 offen offset:0 nt
    v_mfma_f32_16x16x32_bf16 v[32:35], v[24:27], v[136:139], v[32:35]
    v_mov_b32 v10, 162076
    v_mov_b32 v11, 1
    s_mov_b64 exec, 1
    ds_add_u32 v10, v11
    s_mov_b64 exec, -1
    v_and_b32_dpp v28, v18, v20 row_newbcast:8 row_mask:0xf bank_mask:0xf
    v_and_b32_dpp v29, v18, v21 row_newbcast:8 row_mask:0xf bank_mask:0xf
    v_and_b32_dpp v30, v18, v22 row_newbcast:8 row_mask:0xf bank_mask:0xf
    v_and_b32_dpp v31, v18, v23 row_newbcast:8 row_mask:0xf bank_mask:0xf
    s_waitcnt vmcnt(3)
    s_bitcmp0_b32 s14, 29
    s_cbranch_scc1 L_sf_91
    s_waitcnt vmcnt(2)
    s_bitcmp0_b32 s15, 29
    s_cbranch_scc1 L_sf_91
    s_waitcnt vmcnt(1)
L_sf_91:
    buffer_load_dwordx4 v[156:159], v1, s[52:55], s97 offen offset:1024 nt
    v_mfma_f32_16x16x32_bf16 v[32:35], v[28:31], v[140:143], v[32:35]
    v_and_b32_dpp v24, v18, v20 row_newbcast:4 row_mask:0xf bank_mask:0xf
    v_and_b32_dpp v25, v18, v21 row_newbcast:4 row_mask:0xf bank_mask:0xf
    v_and_b32_dpp v26, v18, v22 row_newbcast:4 row_mask:0xf bank_mask:0xf
    v_and_b32_dpp v27, v18, v23 row_newbcast:4 row_mask:0xf bank_mask:0xf
    s_waitcnt vmcnt(3)
    s_bitcmp0_b32 s14, 30
    s_cbranch_scc1 L_sf_92
    s_waitcnt vmcnt(2)
    s_bitcmp0_b32 s15, 30
    s_cbranch_scc1 L_sf_92
    s_waitcnt vmcnt(1)
L_sf_92:
    buffer_load_dwordx4 v[160:163], v1, s[52:55], s97 offen offset:2048 nt
    v_mfma_f32_16x16x32_bf16 v[32:35], v[24:27], v[144:147], v[32:35]
    v_lshrrev_b32 v9, 4, v0
    v_lshl_add_u32 v8, v9, 2, v2
    s_lshl_b32 s96, s3, 9
    s_add_u32 s96, s96, 157824
    v_lshl_add_u32 v8, v8, 2, s96
    v_lshlrev_b32 v9, 3, v0
    v_add_u32 v9, 157824, v9
    v_mov_b32 v10, 162048
    v_mov_b32 v11, 1
    s_lshl_b32 s96, s38, 5
    s_add_u32 s96, s96, 161984
    v_mov_b32 v3, s96
    s_sub_u32 s62, 8, s39
    s_lshl_b32 s98, s34, 5
    s_add_u32 s98, s98, s35
    s_lshl_b32 s98, s98, 8
    s_add_u32 s98, s98, 106496
    v_lshlrev_b32 v39, 2, v0
    v_and_b32_dpp v28, v18, v20 row_newbcast:12 row_mask:0xf bank_mask:0xf
    v_and_b32_dpp v29, v18, v21 row_newbcast:12 row_mask:0xf bank_mask:0xf
    v_and_b32_dpp v30, v18, v22 row_newbcast:12 row_mask:0xf bank_mask:0xf
    v_and_b32_dpp v31, v18, v23 row_newbcast:12 row_mask:0xf bank_mask:0xf
    s_waitcnt vmcnt(3)
    s_bitcmp0_b32 s14, 31
    s_cbranch_scc1 L_sf_93
    s_waitcnt vmcnt(2)
    s_bitcmp0_b32 s15, 31
    s_cbranch_scc1 L_sf_93
    s_waitcnt vmcnt(1)
L_sf_93:
    buffer_load_dwordx4 v[164:167], v1, s[52:55], s97 offen offset:3072 nt
    s_mov_b32 s97, 0
    v_add_u32 v1, 4096, v1
    v_and_b32 v1, 0x7fff, v1
    v_mfma_f32_16x16x32_bf16 v[32:35], v[28:31], v[148:151], v[32:35]
    s_cmp_eq_u32 s12, -1
    s_cbranch_scc1 L_v_nopf
    v_and_b32_dpp v40, v19, v20 row_newbcast:0 row_mask:0xf bank_mask:0xf
    v_and_b32_dpp v41, v19, v21 row_newbcast:0 row_mask:0xf bank_mask:0xf
    v_and_b32_dpp v42, v19, v22 row_newbcast:0 row_mask:0xf bank_mask:0xf
    v_and_b32_dpp v43, v19, v23 row_newbcast:0 row_mask:0xf bank_mask:0xf
    v_and_b32_dpp v44, v19, v20 row_newbcast:8 row_mask:0xf bank_mask:0xf
    v_and_b32_dpp v45, v19, v21 row_newbcast:8 row_mask:0xf bank_mask:0xf
    v_and_b32_dpp v46, v19, v22 row_newbcast:8 row_mask:0xf bank_mask:0xf
    v_and_b32_dpp v47, v19, v23 row_newbcast:8 row_mask:0xf bank_mask:0xf
    v_and_b32_dpp v48, v19, v20 row_newbcast:4 row_mask:0xf bank_mask:0xf
    v_and_b32_dpp v49, v19, v21 row_newbcast:4 row_mask:0xf bank_mask:0xf
    v_and_b32_dpp v50, v19, v22 row_newbcast:4 row_mask:0xf bank_mask:0xf
    v_and_b32_dpp v51, v19, v23 row_newbcast:4 row_mask:0xf bank_mask:0xf
    v_and_b32_dpp v52, v19, v20 row_newbcast:12 row_mask:0xf bank_mask:0xf
    v_and_b32_dpp v53, v19, v21 row_newbcast:12 row_mask:0xf bank_mask:0xf
    v_and_b32_dpp v54, v19, v22 row_newbcast:12 row_mask:0xf bank_mask:0xf
    v_and_b32_dpp v55, v19, v23 row_newbcast:12 row_mask:0xf bank_mask:0xf
    s_waitcnt vmcnt(3)
    v_mfma_f32_16x16x32_bf16 v[32:35], v[40:43], v[152:155], v[32:35]
    s_waitcnt vmcnt(2)
    v_mfma_f32_16x16x32_bf16 v[32:35], v[44:47], v[156:159], v[32:35]
    s_waitcnt vmcnt(1)
    v_mfma_f32_16x16x32_bf16 v[32:35], v[48:51], v[160:163], v[32:35]
    s_waitcnt vmcnt(0)
    v_mfma_f32_16x16x32_bf16 v[32:35], v[52:55], v[164:167], v[32:35]
L_v_join:
    s_cmp_lg_u32 s13, 0
    s_cbranch_scc1 L_jobend
L_t0:
    s_mov_b32 exec_hi, 0
    s_nop 4
    ds_write_b128 v8, v[32:35]
L_t0b:
    s_mov_b64 exec, 1
    ds_add_rtn_u32 v37, v10, v11
    s_mov_b64 exec, -1
    ds_read_b32 v38, v10 offset:24
    ds_read_b128 v[24:27], v3
    ds_read_b128 v[28:31], v3 offset:16
    ds_read_b64 v[144:145], v9 offset:0
    ds_read_b64 v[146:147], v9 offset:512
    ds_read_b64 v[148:149], v9 offset:1024
    ds_read_b64 v[150:151], v9 offset:1536
    ds_read_b64 v[152:153], v9 offset:2048
    ds_read_b64 v[154:155], v9 offset:2560
    ds_read_b64 v[156:157], v9 offset:3072
    ds_read_b64 v[158:159], v9 offset:3584
    s_waitcnt lgkmcnt(10)
    v_readfirstlane_b32 s96, v37
    v_readfirstlane_b32 s61, v38
    s_cmp_lg_u32 s96, s62
    s_cbranch_scc1 L_nopub
    s_waitcnt lgkmcnt(6)
    v_pk_mul_f32 v[144:145], v[144:145], v[24:25] op_sel:[0,0] op_sel_hi:[1,0]
    v_pk_mul_f32 v[146:147], v[146:147], v[24:25] op_sel:[0,1] op_sel_hi:[1,1]
    s_waitcnt lgkmcnt(4)
    v_pk_fma_f32 v[144:145], v[148:149], v[26:27], v[144:145] op_sel:[0,0,0] op_sel_hi:[1,0,1]
    v_pk_fma_f32 v[146:147], v[150:151], v[26:27], v[146:147] op_sel:[0,1,0] op_sel_hi:[1,1,1]
    s_waitcnt lgkmcnt(2)
    v_pk_fma_f32 v[144:145], v[152:153], v[28:29], v[144:145] op_sel:[0,0,0] op_sel_hi:[1,0,1]
    v_pk_fma_f32 v[146:147], v[154:155], v[28:29], v[146:147] op_sel:[0,1,0] op_sel_hi:[1,1,1]
    s_waitcnt lgkmcnt(0)
    v_pk_fma_f32 v[144:145], v[156:157], v[30:31], v[144:145] op_sel:[0,0,0] op_sel_hi:[1,0,1]
    v_pk_fma_f32 v[146:147], v[158:159], v[30:31], v[146:147] op_sel:[0,1,0] op_sel_hi:[1,1,1]
    s_cmp_eq_u32 s61, 1
    v_pk_add_f32 v[144:145], v[144:145], v[146:147]
    v_cvt_pk_bf16_f32 v32, v144, v145
    s_cbranch_scc0 L_oslow
    buffer_store_dword v32, v39, s[40:43], s98 offen
L_odone:
L_nopub:
    s_cmp_eq_u32 s59, 0
    s_cbranch_scc1 L_not1
L_poll_102:
    buffer_load_dwordx4 v[16:19], v105, s[40:43], s100 offen sc1
    buffer_load_dwordx4 v[20:23], v105, s[40:43], s100 offen offset:128 sc1
    s_sub_u32 s60, s60, 1
    s_cbranch_scc1 L_poll_102t
    s_waitcnt vmcnt(0)
    v_max3_u32 v38, v16, v17, v18
    v_max3_u32 v38, v38, v19, v20
    v_max3_u32 v38, v38, v21, v22
    v_max_u32 v38, v38, v23
    v_cmp_eq_u32 vcc, -1, v38
    s_cbranch_vccnz L_poll_102
L_poll_102e:
    v_smfmac_f32_16x16x64_bf16 v[112:115], v[16:19], v[72:79], v111
    v_smfmac_f32_16x16x64_bf16 v[116:119], v[16:19], v[80:87], v111
    v_smfmac_f32_16x16x64_bf16 v[112:115], v[20:23], v[88:95], v111
    v_smfmac_f32_16x16x64_bf16 v[116:119], v[20:23], v[96:103], v111
    s_nop 6
    v_pk_add_f32 v[112:113], v[112:113], v[114:115]
    v_pk_add_f32 v[116:117], v[116:117], v[118:119]
    v_add_f32 v12, v112, v113
    v_add_f32 v13, v116, v117
    ds_write2_b32 v106, v12, v13 offset0:0 offset1:32
    s_mov_b64 exec, 1
    ds_add_rtn_u32 v37, v109, v11
    s_mov_b64 exec, -1
    ds_read_b64 v[72:73], v107 offset:0
    ds_read_b64 v[74:75], v107 offset:16384
    ds_read_b64 v[76:77], v107 offset:32768
    ds_read_b64 v[78:79], v107 offset:49152
    s_cmp_eq_u32 s34, 2
    s_cselect_b32 s97, s61, 0
    s_waitcnt lgkmcnt(4)
    v_readfirstlane_b32 s96, v37
    s_waitcnt lgkmcnt(2)
    v_pk_add_f32 v[72:73], v[72:73], v[74:75]
    s_cmp_lg_u32 s96, 3
    s_cbranch_scc1 L_not1
    s_cmp_eq_u32 s97, 1
    s_waitcnt lgkmcnt(0)
    v_pk_add_f32 v[76:77], v[76:77], v[78:79]
    v_pk_add_f32 v[72:73], v[72:73], v[76:77]
    v_cvt_pk_bf16_f32 v12, v72, v73
    s_cbranch_scc1 L_pfast
    buffer_store_dword v12, v108, s[40:43], s101 offen sc1
    buffer_store_dword v12, v110, s[40:43], s101 offen sc1
L_pdone:
L_not1:
    s_waitcnt lgkmcnt(0)
    s_cmp_eq_u32 s39, 1
    s_cbranch_scc1 L_s_role
    s_cmp_eq_u32 s34, 2
    s_cselect_b32 s62, s59, 0
    s_cmp_eq_u32 s62, 1
    s_cbranch_scc1 L_refetch
L_norf:
    s_endpgm
L_k_nopf:
    s_waitcnt vmcnt(3)
    s_bitcmp0_b32 s57, 22
    s_cbranch_scc1 L_sf_58
    s_waitcnt vmcnt(2)
    s_bitcmp0_b32 s58, 22
    s_cbranch_scc1 L_sf_58
    s_waitcnt vmcnt(1)
L_sf_58:
    buffer_load_dwordx4 v[128:131], v1, s[48:51], s97 offen offset:2048 nt
    v_min_u32 v39, 15, v0
    v_and_b32 v38, 1, v39
    v_mul_u32_u24 v38, 126, v38
    v_lshl_add_u32 v39, v39, 1, v38
    buffer_load_dword v37, v39, s[44:47], 0 offen sc1
    s_waitcnt vmcnt(4)
    s_bitcmp0_b32 s57, 23
    s_cbranch_scc1 L_sf_59
    s_waitcnt vmcnt(3)
    s_bitcmp0_b32 s58, 23
    s_cbranch_scc1 L_sf_59
    s_waitcnt vmcnt(2)
L_sf_59:
    buffer_load_dwordx4 v[132:135], v1, s[48:51], s97 offen offset:3072 nt
    s_add_u32 s97, s97, 32768
    v_add_u32 v1, 4096, v1
    v_and_b32 v1, 0x7fff, v1
    s_waitcnt vmcnt(4)
    s_bitcmp0_b32 s57, 24
    s_cbranch_scc1 L_sf_60
    s_waitcnt vmcnt(3)
    s_bitcmp0_b32 s58, 24
    s_cbranch_scc1 L_sf_60
    s_waitcnt vmcnt(2)
L_sf_60:
    buffer_load_dwordx4 v[136:139], v1, s[48:51], s97 offen offset:0 nt
    s_waitcnt vmcnt(4)
    s_bitcmp0_b32 s57, 25
    s_cbranch_scc1 L_sf_61
    s_waitcnt vmcnt(3)
    s_bitcmp0_b32 s58, 25
    s_cbranch_scc1 L_sf_61
    s_waitcnt vmcnt(1)
L_sf_61:
    buffer_load_dwordx4 v[140:143], v1, s[48:51], s97 offen offset:1024 nt
    s_waitcnt vmcnt(4)
    s_bitcmp0_b32 s57, 26
    s_cbranch_scc1 L_sf_62
    s_waitcnt vmcnt(2)
    s_bitcmp0_b32 s58, 26
    s_cbranch_scc1 L_sf_62
    s_waitcnt vmcnt(1)
L_sf_62:
    buffer_load_dwordx4 v[144:147], v1, s[48:51], s97 offen offset:2048 nt
    s_waitcnt vmcnt(3)
    s_bitcmp0_b32 s57, 27
    s_cbranch_scc1 L_sf_63
    s_waitcnt vmcnt(2)
    s_bitcmp0_b32 s58, 27
    s_cbranch_scc1 L_sf_63
    s_waitcnt vmcnt(1)
L_sf_63:
    buffer_load_dwordx4 v[148:151], v1, s[48:51], s97 offen offset:3072 nt
    s_add_u32 s97, s97, 32768
    v_add_u32 v1, 4096, v1
    v_and_b32 v1, 0x7fff, v1
    v_cmp_eq_u32 vcc, 0, v37
    s_nop 0
    s_or_b32 s96, vcc_lo, vcc_hi
    buffer_load_dwordx4 v[4:7], v2, s[40:43], s98 offen sc1
    s_waitcnt vmcnt(4)
    s_bitcmp0_b32 s57, 28
    s_cbranch_scc1 L_sf_64
    s_waitcnt vmcnt(3)
    s_bitcmp0_b32 s58, 28
    s_cbranch_scc1 L_sf_64
    s_waitcnt vmcnt(2)
L_sf_64:
    buffer_load_dwordx4 v[152:155], v1, s[48:51], s97 offen offset:0 nt
    s_waitcnt vmcnt(4)
    s_bitcmp0_b32 s57, 29
    s_cbranch_scc1 L_sf_65
    s_waitcnt vmcnt(3)
    s_bitcmp0_b32 s58, 29
    s_cbranch_scc1 L_sf_65
    s_waitcnt vmcnt(2)
L_sf_65:
    buffer_load_dwordx4 v[156:159], v1, s[48:51], s97 offen offset:1024 nt
    s_waitcnt vmcnt(4)
    s_bitcmp0_b32 s57, 30
    s_cbranch_scc1 L_sf_66
    s_waitcnt vmcnt(3)
    s_bitcmp0_b32 s58, 30
    s_cbranch_scc1 L_sf_66
    s_waitcnt vmcnt(1)
L_sf_66:
    buffer_load_dwordx4 v[160:163], v1, s[48:51], s97 offen offset:2048 nt
    s_waitcnt vmcnt(4)
    s_bitcmp0_b32 s57, 31
    s_cbranch_scc1 L_sf_67
    s_waitcnt vmcnt(2)
    s_bitcmp0_b32 s58, 31
    s_cbranch_scc1 L_sf_67
    s_waitcnt vmcnt(1)
L_sf_67:
    buffer_load_dwordx4 v[164:167], v1, s[48:51], s97 offen offset:3072 nt
    s_mov_b32 s97, 0
    v_add_u32 v1, 4096, v1
    v_and_b32 v1, 0x7fff, v1
    v_add_u32 v1, 8192, v1
    v_and_b32 v1, 0x7fff, v1
    s_mov_b32 s97, 65536
    s_branch L_k_join
L_v_nopf:
    v_and_b32_dpp v24, v19, v20 row_newbcast:0 row_mask:0xf bank_mask:0xf
    v_and_b32_dpp v25, v19, v21 row_newbcast:0 row_mask:0xf bank_mask:0xf
    v_and_b32_dpp v26, v19, v22 row_newbcast:0 row_mask:0xf bank_mask:0xf
    v_and_b32_dpp v27, v19, v23 row_newbcast:0 row_mask:0xf bank_mask:0xf
    s_waitcnt vmcnt(3)
    s_bitcmp0_b32 s14, 0
    s_cbranch_scc1 L_sf_94
    s_waitcnt vmcnt(2)
    s_bitcmp0_b32 s15, 0
    s_cbranch_scc1 L_sf_94
    s_waitcnt vmcnt(1)
L_sf_94:
    buffer_load_dwordx4 v[40:43], v1, s[52:55], s97 offen offset:0 nt
    v_mfma_f32_16x16x32_bf16 v[32:35], v[24:27], v[152:155], v[32:35]
    v_and_b32_dpp v28, v19, v20 row_newbcast:8 row_mask:0xf bank_mask:0xf
    v_and_b32_dpp v29, v19, v21 row_newbcast:8 row_mask:0xf bank_mask:0xf
    v_and_b32_dpp v30, v19, v22 row_newbcast:8 row_mask:0xf bank_mask:0xf
    v_and_b32_dpp v31, v19, v23 row_newbcast:8 row_mask:0xf bank_mask:0xf
    s_waitcnt vmcnt(3)
    s_bitcmp0_b32 s14, 1
    s_cbranch_scc1 L_sf_95
    s_waitcnt vmcnt(2)
    s_bitcmp0_b32 s15, 1
    s_cbranch_scc1 L_sf_95
    s_waitcnt vmcnt(1)
L_sf_95:
    buffer_load_dwordx4 v[44:47], v1, s[52:55], s97 offen offset:1024 nt
    v_mfma_f32_16x16x32_bf16 v[32:35], v[28:31], v[156:159], v[32:35]
    v_and_b32_dpp v24, v19, v20 row_newbcast:4 row_mask:0xf bank_mask:0xf
    v_and_b32_dpp v25, v19, v21 row_newbcast:4 row_mask:0xf bank_mask:0xf
    v_and_b32_dpp v26, v19, v22 row_newbcast:4 row_mask:0xf bank_mask:0xf
    v_and_b32_dpp v27, v19, v23 row_newbcast:4 row_mask:0xf bank_mask:0xf
    s_waitcnt vmcnt(3)
    s_bitcmp0_b32 s14, 2
    s_cbranch_scc1 L_sf_96
    s_waitcnt vmcnt(2)
    s_bitcmp0_b32 s15, 2
    s_cbranch_scc1 L_sf_96
    s_waitcnt vmcnt(1)
L_sf_96:
    buffer_load_dwordx4 v[48:51], v1, s[52:55], s97 offen offset:2048 nt
    v_mfma_f32_16x16x32_bf16 v[32:35], v[24:27], v[160:163], v[32:35]
    v_and_b32_dpp v28, v19, v20 row_newbcast:12 row_mask:0xf bank_mask:0xf
    v_and_b32_dpp v29, v19, v21 row_newbcast:12 row_mask:0xf bank_mask:0xf
    v_and_b32_dpp v30, v19, v22 row_newbcast:12 row_mask:0xf bank_mask:0xf
    v_and_b32_dpp v31, v19, v23 row_newbcast:12 row_mask:0xf bank_mask:0xf
    s_waitcnt vmcnt(3)
    s_bitcmp0_b32 s14, 3
    s_cbranch_scc1 L_sf_97
    s_waitcnt vmcnt(2)
    s_bitcmp0_b32 s15, 3
    s_cbranch_scc1 L_sf_97
    s_waitcnt vmcnt(1)
L_sf_97:
    buffer_load_dwordx4 v[52:55], v1, s[52:55], s97 offen offset:3072 nt
    s_add_u32 s97, s97, 32768
    v_add_u32 v1, 4096, v1
    v_and_b32 v1, 0x7fff, v1
    v_mfma_f32_16x16x32_bf16 v[32:35], v[28:31], v[164:167], v[32:35]
    v_and_b32_dpp v24, v12, v20 row_newbcast:0 row_mask:0xf bank_mask:0xf
    v_and_b32_dpp v25, v12, v21 row_newbcast:0 row_mask:0xf bank_mask:0xf
    v_and_b32_dpp v26, v12, v22 row_newbcast:0 row_mask:0xf bank_mask:0xf
    v_and_b32_dpp v27, v12, v23 row_newbcast:0 row_mask:0xf bank_mask:0xf
    s_waitcnt vmcnt(3)
    s_bitcmp0_b32 s14, 4
    s_cbranch_scc1 L_sf_98
    s_waitcnt vmcnt(2)
    s_bitcmp0_b32 s15, 4
    s_cbranch_scc1 L_sf_98
    s_waitcnt vmcnt(1)
L_sf_98:
    buffer_load_dwordx4 v[56:59], v1, s[52:55], s97 offen offset:0 nt
    v_mfma_f32_16x16x32_bf16 v[32:35], v[24:27], v[40:43], v[32:35]
    v_and_b32_dpp v28, v12, v20 row_newbcast:8 row_mask:0xf bank_mask:0xf
    v_and_b32_dpp v29, v12, v21 row_newbcast:8 row_mask:0xf bank_mask:0xf
    v_and_b32_dpp v30, v12, v22 row_newbcast:8 row_mask:0xf bank_mask:0xf
    v_and_b32_dpp v31, v12, v23 row_newbcast:8 row_mask:0xf bank_mask:0xf
    s_waitcnt vmcnt(3)
    s_bitcmp0_b32 s14, 5
    s_cbranch_scc1 L_sf_99
    s_waitcnt vmcnt(2)
    s_bitcmp0_b32 s15, 5
    s_cbranch_scc1 L_sf_99
    s_waitcnt vmcnt(1)
L_sf_99:
    buffer_load_dwordx4 v[60:63], v1, s[52:55], s97 offen offset:1024 nt
    v_mfma_f32_16x16x32_bf16 v[32:35], v[28:31], v[44:47], v[32:35]
    v_and_b32_dpp v24, v12, v20 row_newbcast:4 row_mask:0xf bank_mask:0xf
    v_and_b32_dpp v25, v12, v21 row_newbcast:4 row_mask:0xf bank_mask:0xf
    v_and_b32_dpp v26, v12, v22 row_newbcast:4 row_mask:0xf bank_mask:0xf
    v_and_b32_dpp v27, v12, v23 row_newbcast:4 row_mask:0xf bank_mask:0xf
    s_waitcnt vmcnt(3)
    s_bitcmp0_b32 s14, 6
    s_cbranch_scc1 L_sf_100
    s_waitcnt vmcnt(2)
    s_bitcmp0_b32 s15, 6
    s_cbranch_scc1 L_sf_100
    s_waitcnt vmcnt(1)
L_sf_100:
    buffer_load_dwordx4 v[64:67], v1, s[52:55], s97 offen offset:2048 nt
    v_mfma_f32_16x16x32_bf16 v[32:35], v[24:27], v[48:51], v[32:35]
    v_and_b32_dpp v28, v12, v20 row_newbcast:12 row_mask:0xf bank_mask:0xf
    v_and_b32_dpp v29, v12, v21 row_newbcast:12 row_mask:0xf bank_mask:0xf
    v_and_b32_dpp v30, v12, v22 row_newbcast:12 row_mask:0xf bank_mask:0xf
    v_and_b32_dpp v31, v12, v23 row_newbcast:12 row_mask:0xf bank_mask:0xf
    s_waitcnt vmcnt(3)
    s_bitcmp0_b32 s14, 7
    s_cbranch_scc1 L_sf_101
    s_waitcnt vmcnt(2)
    s_bitcmp0_b32 s15, 7
    s_cbranch_scc1 L_sf_101
    s_waitcnt vmcnt(1)
L_sf_101:
    buffer_load_dwordx4 v[68:71], v1, s[52:55], s97 offen offset:3072 nt
    s_add_u32 s97, s97, 32768
    v_add_u32 v1, 4096, v1
    v_and_b32 v1, 0x7fff, v1
    v_mfma_f32_16x16x32_bf16 v[32:35], v[28:31], v[52:55], v[32:35]
    v_and_b32_dpp v24, v13, v20 row_newbcast:0 row_mask:0xf bank_mask:0xf
    v_and_b32_dpp v25, v13, v21 row_newbcast:0 row_mask:0xf bank_mask:0xf
    v_and_b32_dpp v26, v13, v22 row_newbcast:0 row_mask:0xf bank_mask:0xf
    v_and_b32_dpp v27, v13, v23 row_newbcast:0 row_mask:0xf bank_mask:0xf
    s_waitcnt vmcnt(3)
    s_nop 0
    v_mfma_f32_16x16x32_bf16 v[32:35], v[24:27], v[56:59], v[32:35]
    v_and_b32_dpp v28, v13, v20 row_newbcast:8 row_mask:0xf bank_mask:0xf
    v_and_b32_dpp v29, v13, v21 row_newbcast:8 row_mask:0xf bank_mask:0xf
    v_and_b32_dpp v30, v13, v22 row_newbcast:8 row_mask:0xf bank_mask:0xf
    v_and_b32_dpp v31, v13, v23 row_newbcast:8 row_mask:0xf bank_mask:0xf
    s_waitcnt vmcnt(2)
    s_nop 0
    v_mfma_f32_16x16x32_bf16 v[32:35], v[28:31], v[60:63], v[32:35]
    v_and_b32_dpp v24, v13, v20 row_newbcast:4 row_mask:0xf bank_mask:0xf
    v_and_b32_dpp v25, v13, v21 row_newbcast:4 row_mask:0xf bank_mask:0xf
    v_and_b32_dpp v26, v13, v22 row_newbcast:4 row_mask:0xf bank_mask:0xf
    v_and_b32_dpp v27, v13, v23 row_newbcast:4 row_mask:0xf bank_mask:0xf
    s_waitcnt vmcnt(1)
    s_nop 0
    v_mfma_f32_16x16x32_bf16 v[32:35], v[24:27], v[64:67], v[32:35]
    v_and_b32_dpp v28, v13, v20 row_newbcast:12 row_mask:0xf bank_mask:0xf
    v_and_b32_dpp v29, v13, v21 row_newbcast:12 row_mask:0xf bank_mask:0xf
    v_and_b32_dpp v30, v13, v22 row_newbcast:12 row_mask:0xf bank_mask:0xf
    v_and_b32_dpp v31, v13, v23 row_newbcast:12 row_mask:0xf bank_mask:0xf
    s_waitcnt vmcnt(0)
    s_nop 0
    v_mfma_f32_16x16x32_bf16 v[32:35], v[28:31], v[68:71], v[32:35]
    s_branch L_v_join
L_oslow:
    buffer_store_dword v32, v39, s[40:43], s98 offen sc1
    s_branch L_odone
L_refetch:
    s_lshr_b32 s62, s3, 2
    s_mul_i32 s62, s62, 5
    s_add_u32 s62, s62, s35
    s_sub_u32 s62, s62, 27
    s_cmp_ge_u32 s62, 7
    s_cbranch_scc1 L_norf
    s_add_u32 s62, s62, 3
    s_and_b32 s62, s62, 7
    s_mul_i32 s62, s62, 5120
    v_mov_b32 v8, 162048
L_lw_103:
    ds_read_b32 v9, v8
    s_waitcnt lgkmcnt(0)
    v_cmp_gt_u32 vcc, 9, v9
    s_cbranch_vccz L_lw_103e
    s_sleep 2
    s_sub_u32 s60, s60, 1
    s_cbranch_scc0 L_lw_103
    s_mov_b32 s60, 0
L_lw_103e:
    ds_read_b32 v9, v8 offset:36
    v_lshlrev_b32 v5, 4, v0
    v_add_u32 v5, 212992, v5
    s_add_u32 s4, s62, 0
    s_and_b32 s63, s4, 0xffffe000
    s_add_u32 s4, s4, s63
    s_add_u32 s5, s62, 1024
    s_and_b32 s63, s5, 0xffffe000
    s_add_u32 s5, s5, s63
    s_add_u32 s6, s62, 2048
    s_and_b32 s63, s6, 0xffffe000
    s_add_u32 s6, s6, s63
    s_add_u32 s7, s62, 3072
    s_and_b32 s63, s7, 0xffffe000
    s_add_u32 s7, s7, s63
    s_add_u32 s8, s62, 4096
    s_and_b32 s63, s8, 0xffffe000
    s_add_u32 s8, s8, s63
    s_waitcnt lgkmcnt(0)
    v_add_u32 v5, v5, v9
L_poll_104:
    buffer_load_dwordx4 v[12:15], v5, s[40:43], s4 offen sc1
    buffer_load_dwordx4 v[16:19], v5, s[40:43], s5 offen sc1
    buffer_load_dwordx4 v[20:23], v5, s[40:43], s6 offen sc1
    buffer_load_dwordx4 v[24:27], v5, s[40:43], s7 offen sc1
    buffer_load_dwordx4 v[28:31], v5, s[40:43], s8 offen sc1
    s_sub_u32 s60, s60, 1
    s_cbranch_scc1 L_poll_104t
    s_waitcnt vmcnt(0)
    v_max3_u32 v3, v12, v16, v20
    v_max3_u32 v3, v3, v24, v28
    v_cmp_eq_u32 vcc, -1, v3
    s_cbranch_vccnz L_poll_104
L_poll_104e:
    s_branch L_norf
L_qslow:
L_wy_105:
    buffer_load_dword v37, v39, s[44:47], 0 offen sc1
    s_waitcnt vmcnt(0)
    v_cmp_ne_u32 vcc, -1, v37
    s_cbranch_vccz L_wy_105e
    s_sleep 4
    s_sub_u32 s60, s60, 1
    s_cbranch_scc0 L_wy_105
    s_mov_b32 s60, 0
L_wy_105e:
L_qslow2:
    s_branch L_poll_106
L_poll_106s:
    s_sleep 2
L_poll_106:
    buffer_load_dwordx4 v[4:7], v2, s[40:43], s98 offen sc1
    s_sub_u32 s60, s60, 1
    s_cbranch_scc1 L_poll_106t
    s_waitcnt vmcnt(0)
    v_max3_u32 v38, v4, v5, v6
    v_max_u32 v38, v38, v7
    v_cmp_eq_u32 vcc, -1, v38
    s_cbranch_vccnz L_poll_106s
L_poll_106e:
    s_branch L_qok
L_mljob:
    s_lshl4_add_u32 s96, s35, s3
    s_lshl_b32 s96, s96, 3
    s_add_u32 s96, s96, 81920
    buffer_store_dwordx2 v[8:9], v36, s[40:43], s96 offen sc1
    s_branch L_mldone
L_service:
    v_mov_b32 v72, 0
    v_mov_b32 v73, 0
    v_mov_b32 v74, 0
    v_mov_b32 v75, 0
    v_mov_b32 v76, 0
    s_mov_b32 s59, 0
    v_mov_b32 v5, 0
    v_mov_b32 v105, 0
    v_mov_b32 v108, 0
    v_mov_b32 v110, 0
    v_mov_b32 v160, 0
    v_mov_b32 v163, 0
    v_mov_b32 v8, 162068
L_lw_107:
    ds_read_b32 v9, v8
    s_waitcnt lgkmcnt(0)
    v_cmp_gt_u32 vcc, 8, v9
    s_cbranch_vccz L_lw_107e
    s_sleep 8
    s_sub_u32 s60, s60, 1
    s_cbranch_scc0 L_lw_107
    s_mov_b32 s60, 0
L_lw_107e:
    v_and_b32 v2, 15, v0
    v_lshlrev_b32 v2, 3, v2
    v_add_u32 v3, 161920, v2
    ds_read_b64 v[8:9], v3
    v_mov_b32 v11, 162096
    ds_read_b32 v11, v11
    s_getreg_b32 s58, hwreg(HW_REG_XCC_ID, 0, 4)
    s_lshl_b32 s98, s34, 5
    s_add_u32 s98, s98, s35
    s_lshl_b32 s62, s98, 7
    s_add_u32 s62, s62, 73728
    s_and_b32 s99, s62, 0xffffff00
    s_lshl_b32 s98, s98, 8
    s_add_u32 s98, s98, 106496
    v_lshlrev_b32 v39, 2, v0
    v_and_b32 v21, 64, v2
    v_add_u32 v21, v21, v2
    v_cmp_eq_u32 vcc, 8, v0
    s_bfm_b64 exec, 8, 0
    s_bitset1_b32 exec_lo, 8
    s_waitcnt lgkmcnt(0)
    v_lshl_add_u32 v10, v11, 8, s58
    v_cndmask_b32 v8, v8, v10, vcc
    buffer_store_dwordx2 v[8:9], v2, s[40:43], s62 offen sc1
    s_mov_b64 exec, -1
    v_mov_b32 v12, 162076
L_lw_108:
    ds_read_b32 v13, v12
    s_waitcnt lgkmcnt(0)
    v_cmp_gt_u32 vcc, 4, v13
    s_cbranch_vccz L_lw_108e
    s_sleep 4
    s_sub_u32 s60, s60, 1
    s_cbranch_scc0 L_lw_108
    s_mov_b32 s60, 0
L_lw_108e:
    v_and_b32 v11, 31, v0
    v_lshlrev_b32 v11, 7, v11
    s_lshl_b32 s63, s34, 12
    s_add_u32 s63, s63, 73792
    buffer_load_dword v12, v39, s[40:43], s98 offen sc1
    s_branch L_poll_109
L_poll_109s:
    s_sleep 16
L_poll_109:
    buffer_load_dwordx2 v[8:9], v21, s[40:43], s99 offen sc1
    buffer_load_dword v10, v11, s[40:43], s63 offen sc1
    s_sub_u32 s60, s60, 1
    s_cbranch_scc1 L_poll_109t
    s_waitcnt vmcnt(0)
    v_max3_u32 v38, v8, v9, v10
    v_cmp_eq_u32 vcc, -1, v38
    s_cbranch_vccnz L_poll_109s
L_poll_109e:
    v_mov_b32 v37, v8
    s_nop 1
    v_max_f32_dpp v37, v37, v37 quad_perm:[1,0,3,2] row_mask:0xf bank_mask:0xf
    s_nop 1
    v_max_f32_dpp v37, v37, v37 quad_perm:[2,3,0,1] row_mask:0xf bank_mask:0xf
    s_nop 1
    v_max_f32_dpp v37, v37, v37 row_ror:4 row_mask:0xf bank_mask:0xf
    s_nop 1
    v_max_f32_dpp v37, v37, v37 row_ror:8 row_mask:0xf bank_mask:0xf
    v_sub_f32 v8, v8, v37
    v_exp_f32 v8, v8
    s_nop 0
    v_mul_f32 v9, v8, v9
    s_nop 1
    v_add_f32_dpp v9, v9, v9 quad_perm:[1,0,3,2] row_mask:0xf bank_mask:0xf
    s_nop 1
    v_add_f32_dpp v9, v9, v9 quad_perm:[2,3,0,1] row_mask:0xf bank_mask:0xf
    s_nop 1
    v_add_f32_dpp v9, v9, v9 row_ror:4 row_mask:0xf bank_mask:0xf
    s_nop 1
    v_add_f32_dpp v9, v9, v9 row_ror:8 row_mask:0xf bank_mask:0xf
    v_ashrrev_i32 v12, 8, v10
    s_nop 1
    v_add_u32_dpp v12, v12, v12 quad_perm:[1,0,3,2] row_mask:0xf bank_mask:0xf
    s_nop 1
    v_add_u32_dpp v12, v12, v12 quad_perm:[2,3,0,1] row_mask:0xf bank_mask:0xf
    s_nop 1
    v_add_u32_dpp v12, v12, v12 row_ror:4 row_mask:0xf bank_mask:0xf
    s_nop 1
    v_add_u32_dpp v12, v12, v12 row_ror:8 row_mask:0xf bank_mask:0xf
    v_mov_b32 v13, v12
    s_nop 1
    v_permlane16_swap_b32 v12, v13
    v_add_u32 v12, v12, v13
    v_mov_b32 v13, v12
    s_nop 1
    v_permlane32_swap_b32 v12, v13
    v_add_u32 v12, v12, v13
    v_ashrrev_i32 v12, 31, v12
    v_and_b32 v12, 8192, v12
    v_mov_b32 v13, 162084
    ds_write_b32 v13, v12
    v_and_b32 v10, 0xff, v10
    s_getreg_b32 s62, hwreg(HW_REG_XCC_ID, 0, 4)
    v_cmp_ne_u32 vcc, s62, v10
    s_nop 0
    s_cmp_eq_u64 vcc, 0
    s_cselect_b32 s61, 1, 0
    v_rcp_f32 v9, v9
    v_lshrrev_b32 v3, 1, v2
    v_add_u32 v3, 161984, v3
    v_mul_f32 v8, v8, v9
    v_mov_b32 v10, 162072
    v_mov_b32 v11, s61
    ds_write_b32 v3, v8
    ds_write_b32 v10, v11
    s_mov_b32 s3, 1
    v_lshrrev_b32 v9, 4, v0
    v_lshl_add_u32 v8, v9, 2, v2
    s_lshl_b32 s96, s3, 9
    s_add_u32 s96, s96, 157824
    v_lshl_add_u32 v8, v8, 2, s96
    v_lshlrev_b32 v9, 3, v0
    v_add_u32 v9, 157824, v9
    v_mov_b32 v10, 162048
    v_mov_b32 v11, 1
    s_lshl_b32 s96, s38, 5
    s_add_u32 s96, s96, 161984
    v_mov_b32 v3, s96
    s_sub_u32 s62, 8, s39
    s_lshl_b32 s98, s34, 5
    s_add_u32 s98, s98, s35
    s_lshl_b32 s98, s98, 8
    s_add_u32 s98, s98, 106496
    v_lshlrev_b32 v39, 2, v0
    s_branch L_t0b
L_jobend:
    v_lshlrev_b32 v9, 4, v0
    s_mov_b32 exec_hi, 0
    s_nop 3
    buffer_store_dwordx4 v[32:35], v9, s[40:43], s13 offen sc1
    s_endpgm
L_proxy:
    v_mov_b32 v72, 0
    v_mov_b32 v73, 0
    v_mov_b32 v74, 0
    v_mov_b32 v75, 0
    v_mov_b32 v76, 0
    v_mov_b32 v5, 0
    v_mov_b32 v105, 0
    v_mov_b32 v108, 0
    v_mov_b32 v110, 0
    v_mov_b32 v160, 0
    v_mov_b32 v163, 0
    s_barrier
    s_waitcnt lgkmcnt(0)
    s_barrier
    s_mov_b32 s40, s32
    s_mov_b32 s41, s33
    s_mov_b32 s42, 589824
    s_mov_b32 s43, 0x20000
    s_mov_b32 s44, s30
    s_mov_b32 s45, s31
    s_mov_b32 s46, 256
    s_mov_b32 s47, 0x20000
    s_sub_u32 s97, 7, s3
    s_mul_i32 s97, s97, 27
    s_cmp_eq_u32 s3, 5
    s_cselect_b32 s97, 32, s97
    s_add_u32 s97, s97, s35
    s_lshl_b32 s97, s97, 9
    s_add_u32 s97, s97, 172032
    v_and_b32 v2, 15, v0
    v_lshlrev_b32 v2, 3, v2
    v_and_b32 v20, 31, v0
    v_lshlrev_b32 v20, 4, v20
    s_cmp_lg_u32 s3, 7
    s_cbranch_scc1 L_px6
    s_sub_u32 s96, 6, s59
    s_mul_i32 s62, s35, 5120
    s_add_u32 s62, s62, 327680
    v_lshl_add_u32 v22, v0, 4, s62
    v_add_u32 v23, 4096, v22
    v_mov_b32 v24, -1
    v_mov_b32 v25, -1
    v_mov_b32 v26, -1
    v_mov_b32 v27, -1
    v_mov_b32 v8, 162068
L_lw_110:
    ds_read_b32 v9, v8
    s_waitcnt lgkmcnt(0)
    v_cmp_gt_u32 vcc, s96, v9
    s_cbranch_vccz L_lw_110e
    s_sleep 8
    s_sub_u32 s60, s60, 1
    s_cbranch_scc0 L_lw_110
    s_mov_b32 s60, 0
L_lw_110e:
    v_and_b32 v2, 15, v0
    v_lshlrev_b32 v2, 3, v2
    v_add_u32 v3, 161920, v2
    ds_read_b64 v[8:9], v3
    v_mov_b32 v11, 162096
    ds_read_b32 v11, v11
    s_getreg_b32 s58, hwreg(HW_REG_XCC_ID, 0, 4)
    s_lshl_b32 s98, s34, 5
    s_add_u32 s98, s98, s35
    s_lshl_b32 s62, s98, 7
    s_add_u32 s62, s62, 73728
    s_and_b32 s99, s62, 0xffffff00
    s_lshl_b32 s98, s98, 8
    s_add_u32 s98, s98, 106496
    v_lshlrev_b32 v39, 2, v0
    v_and_b32 v21, 64, v2
    v_add_u32 v21, v21, v2
    v_cmp_eq_u32 vcc, 8, v0
    s_bfm_b64 exec, s96, 0
    s_bitset1_b32 exec_lo, 8
    s_waitcnt lgkmcnt(0)
    v_lshl_add_u32 v10, v11, 8, s58
    v_cndmask_b32 v8, v8, v10, vcc
    buffer_store_dwordx2 v[8:9], v2, s[40:43], s62 offen sc1
    s_mov_b64 exec, -1
    buffer_load_dwordx4 v[120:123], v22, s[40:43], 0 offen offset:0 sc1
    buffer_load_dwordx4 v[124:127], v22, s[40:43], 0 offen offset:1024 sc1
    buffer_load_dwordx4 v[128:131], v22, s[40:43], 0 offen offset:2048 sc1
    buffer_load_dwordx4 v[132:135], v22, s[40:43], 0 offen offset:3072 sc1
    buffer_load_dwordx4 v[136:139], v23, s[40:43], 0 offen offset:0 sc1
    s_mov_b32 s100, 4
    s_lshl_b32 s63, s100, 8
    v_and_b32 v8, 15, v0
    v_lshl_add_u32 v8, v8, 4, s63
    v_lshrrev_b32 v9, 4, v0
    v_mul_u32_u24 v5, 1280, v9
    v_add_u32 v5, v5, v8
    v_mul_u32_u24 v4, 1296, v9
    v_add_u32 v4, v4, v8
    v_add_u32 v4, 82944, v4
    v_lshlrev_b32 v6, 1, v5
    v_add_u32 v6, 99328, v6
    s_lshl_b32 s62, s100, 9
    s_add_u32 s62, s62, 88128
    v_lshl_add_u32 v7, v0, 3, s62
    s_mov_b32 s48, s4
    s_mov_b32 s49, s5
    s_mov_b32 s50, 5120
    s_mov_b32 s51, 0x20000
    buffer_load_dwordx4 v[8:11], v5, s[48:51], 0 offen
    s_mov_b32 s62, 20480
    s_mov_b32 s63, 30720
    s_branch L_poll_111
L_poll_111s:
    s_sleep 32
L_poll_111:
    buffer_load_dwordx4 v[12:15], v5, s[40:43], s62 offen sc1
    buffer_load_dwordx4 v[16:19], v5, s[40:43], s63 offen sc1
    s_sub_u32 s60, s60, 1
    s_cbranch_scc1 L_poll_111t
    s_waitcnt vmcnt(0)
    v_max3_u32 v38, v12, v13, v14
    v_max3_u32 v38, v38, v15, v16
    v_max3_u32 v38, v38, v17, v18
    v_max_u32 v38, v38, v19
    v_cmp_eq_u32 vcc, -1, v38
    s_cbranch_vccnz L_poll_111s
L_poll_111e:
    v_lshlrev_b32 v40, 16, v8
    v_and_b32 v41, 0xffff0000, v8
    v_lshlrev_b32 v42, 16, v9
    v_and_b32 v43, 0xffff0000, v9
    v_lshlrev_b32 v44, 16, v10
    v_and_b32 v45, 0xffff0000, v10
    v_lshlrev_b32 v46, 16, v11
    v_and_b32 v47, 0xffff0000, v11
    v_lshlrev_b32 v48, 16, v12
    v_and_b32 v49, 0xffff0000, v12
    v_lshlrev_b32 v50, 16, v13
    v_and_b32 v51, 0xffff0000, v13
    v_lshlrev_b32 v52, 16, v14
    v_and_b32 v53, 0xffff0000, v14
    v_lshlrev_b32 v54, 16, v15
    v_and_b32 v55, 0xffff0000, v15
    v_lshlrev_b32 v56, 16, v16
    v_and_b32 v57, 0xffff0000, v16
    v_lshlrev_b32 v58, 16, v17
    v_and_b32 v59, 0xffff0000, v17
    v_lshlrev_b32 v60, 16, v18
    v_and_b32 v61, 0xffff0000, v18
    v_lshlrev_b32 v62, 16, v19
    v_and_b32 v63, 0xffff0000, v19
    v_mov_b32 v64, 0
    v_mov_b32 v65, 0
    v_mov_b32 v66, 0
    v_mov_b32 v67, 0
    v_mov_b32 v68, 0
    v_mov_b32 v69, 0
    v_mov_b32 v70, 0
    v_mov_b32 v71, 0
    v_bfe_u32 v5, v0, 2, 2
    v_lshlrev_b32 v5, 8, v5
    v_lshrrev_b32 v8, 4, v0
    v_lshl_add_u32 v5, v8, 6, v5
    v_and_b32 v8, 3, v0
    v_lshl_add_u32 v5, v8, 4, v5
    s_lshl_b32 s56, s100, 10
    s_or_b32 s96, s59, 0
    s_cbranch_scc0 L_nofrag_112
    v_mov_b32 v104, 162060
L_lw_113:
    ds_read_b32 v105, v104
    s_waitcnt lgkmcnt(0)
    v_cmp_gt_u32 vcc, 4, v105
    s_cbranch_vccz L_lw_113e
    s_sleep 2
    s_sub_u32 s60, s60, 1
    s_cbranch_scc0 L_lw_113
    s_mov_b32 s60, 0
L_lw_113e:
    s_cmp_eq_u32 s59, 0
    s_cbranch_scc1 L_nofrag_112
    v_bfe_u32 v104, v0, 2, 1
    v_bfe_u32 v110, v0, 4, 1
    v_lshl_add_u32 v104, v110, 2, v104
    v_and_b32 v110, 8, v0
    v_add_u32 v104, v104, v110
    v_lshrrev_b32 v110, 5, v0
    v_lshl_add_u32 v104, v110, 4, v104
    v_bfe_u32 v111, v0, 0, 1
    v_mul_u32_u24 v111, 0xaaaa, v111
    v_add_u32 v111, 0x4444, v111
    v_mov_b32 v112, 0
    v_mov_b32 v113, 0
    v_mov_b32 v114, 0
    v_mov_b32 v115, 0
    v_mov_b32 v116, 0
    v_mov_b32 v117, 0
    v_mov_b32 v118, 0
    v_mov_b32 v119, 0
    v_lshlrev_b32 v104, 7, v104
    v_and_b32 v110, 3, v0
    v_lshl_add_u32 v104, v110, 3, v104
    v_lshrrev_b32 v109, 4, v0
    v_and_b32 v110, 1, v0
    s_lshr_b32 s63, s3, 1
    s_and_b32 s62, s3, 1
    s_lshl_b32 s96, s63, 14
    s_lshl_b32 s100, s62, 6
    s_add_u32 s100, s100, 81920
    s_add_u32 s96, s96, s100
    v_add_u32 v104, s96, v104
    ds_read_b64_tr_b16 v[72:73], v104 offset:0
    ds_read_b64_tr_b16 v[74:75], v104 offset:256
    ds_read_b64_tr_b16 v[76:77], v104 offset:4096
    ds_read_b64_tr_b16 v[78:79], v104 offset:4352
    ds_read_b64_tr_b16 v[80:81], v104 offset:32
    ds_read_b64_tr_b16 v[82:83], v104 offset:288
    ds_read_b64_tr_b16 v[84:85], v104 offset:4128
    ds_read_b64_tr_b16 v[86:87], v104 offset:4384
    ds_read_b64_tr_b16 v[88:89], v104 offset:8192
    ds_read_b64_tr_b16 v[90:91], v104 offset:8448
    ds_read_b64_tr_b16 v[92:93], v104 offset:12288
    ds_read_b64_tr_b16 v[94:95], v104 offset:12544
    ds_read_b64_tr_b16 v[96:97], v104 offset:8224
    ds_read_b64_tr_b16 v[98:99], v104 offset:8480
    ds_read_b64_tr_b16 v[100:101], v104 offset:12320
    ds_read_b64_tr_b16 v[102:103], v104 offset:12576
    v_bfe_u32 v105, v0, 1, 3
    v_lshlrev_b32 v105, 8, v105
    v_lshl_add_u32 v105, v109, 5, v105
    v_lshl_add_u32 v105, v110, 4, v105
    v_lshrrev_b32 v106, 3, v0
    v_lshlrev_b32 v106, 7, v106
    v_and_b32 v110, 7, v0
    v_lshl_add_u32 v107, v110, 3, v106
    v_add_u32 v107, s100, v107
    v_lshlrev_b32 v106, 8, v109
    v_and_b32 v110, 15, v0
    v_lshl_add_u32 v106, v110, 2, v106
    v_add_u32 v106, s96, v106
    v_lshlrev_b32 v108, 2, v0
    s_lshl_b32 s96, s62, 2
    s_add_u32 s96, s96, 162088
    v_mov_b32 v109, s96
    s_lshl_b32 s100, s63, 11
    s_lshl_b32 s96, s34, 13
    s_add_u32 s100, s100, s96
    s_add_u32 s100, s100, 106496
    s_mul_i32 s101, s34, 5120
    s_lshl_b32 s96, s35, 9
    s_add_u32 s101, s101, s96
    s_lshl_b32 s96, s62, 8
    s_add_u32 s101, s101, s96
    s_sub_u32 s101, s101, 11264
    s_and_b32 s96, s101, 0xffffe000
    s_add_u32 s101, s101, s96
    s_add_u32 s101, s101, 212992
    v_add_u32 v110, 8192, v108
L_nofrag_112:
    s_cmp_ge_u32 s35, 20
    s_cbranch_scc1 L_nofin_114
    s_lshl1_add_u32 s62, s35, s3
    s_sub_u32 s62, s62, 6
    s_lshl_b32 s57, s62, 7
    s_mul_i32 s63, s62, 0x199a
    s_lshr_b32 s63, s63, 16
    s_mul_i32 s63, s63, 1280
    s_sub_u32 s63, s57, s63
    v_lshrrev_b32 v72, 3, v0
    v_mul_u32_u24 v72, 5120, v72
    v_and_b32 v8, 7, v0
    v_lshl_add_u32 v72, v8, 4, v72
    s_add_u32 s62, s57, 327680
    v_add_u32 v72, s62, v72
    v_add_u32 v73, 40960, v72
    v_add_u32 v74, 81920, v72
    v_add_u32 v75, 122880, v72
    v_bfe_u32 v9, v0, 4, 1
    v_lshlrev_b32 v76, 4, v8
    v_lshl_add_u32 v76, v9, 3, v76
    s_lshl_b32 s62, s57, 1
    s_add_u32 s62, s62, 99328
    v_lshl_add_u32 v77, v76, 1, s62
    s_mov_b32 s48, s22
    s_mov_b32 s49, s23
    s_mov_b32 s50, 1280
    s_mov_b32 s51, 0x20000
    buffer_load_dwordx2 v[86:87], v76, s[48:51], s63 offen
    s_add_u32 s62, s57, 35840
    s_branch L_poll_115
L_poll_115s:
    s_sleep 32
L_poll_115:
    buffer_load_dwordx2 v[8:9], v76, s[40:43], s62 offen sc1
    s_sub_u32 s60, s60, 1
    s_cbranch_scc1 L_poll_115t
    s_waitcnt vmcnt(0)
    v_max_u32 v38, v8, v9
    v_cmp_eq_u32 vcc, -1, v38
    s_cbranch_vccnz L_poll_115s
L_poll_115e:
    v_lshlrev_b32 v78, 16, v86
    v_and_b32 v79, 0xffff0000, v86
    v_lshlrev_b32 v82, 16, v8
    v_and_b32 v83, 0xffff0000, v8
    v_lshlrev_b32 v80, 16, v87
    v_and_b32 v81, 0xffff0000, v87
    v_lshlrev_b32 v84, 16, v9
    v_and_b32 v85, 0xffff0000, v9
    v_bfe_u32 v8, v0, 1, 3
    v_and_b32 v9, 1, v0
    v_lshlrev_b32 v9, 4, v9
    v_mov_b32 v10, 0x3f80
    v_lshlrev_b32 v9, v9, v10
    v_cmp_eq_u32 vcc, 0, v8
    v_mov_b32 v100, 0
    s_nop 0
    v_cndmask_b32 v104, 0, v9, vcc
    v_cmp_eq_u32 vcc, 1, v8
    v_mov_b32 v101, 0
    s_nop 0
    v_cndmask_b32 v105, 0, v9, vcc
    v_cmp_eq_u32 vcc, 2, v8
    v_mov_b32 v102, 0
    s_nop 0
    v_cndmask_b32 v106, 0, v9, vcc
    v_cmp_eq_u32 vcc, 3, v8
    v_mov_b32 v103, 0
    s_nop 0
    v_cndmask_b32 v107, 0, v9, vcc
L_nofin_114:
    v_mov_b32 v12, 162076
L_lw_116:
    ds_read_b32 v13, v12
    s_waitcnt lgkmcnt(0)
    v_cmp_gt_u32 vcc, 4, v13
    s_cbranch_vccz L_lw_116e
    s_sleep 4
    s_sub_u32 s60, s60, 1
    s_cbranch_scc0 L_lw_116
    s_mov_b32 s60, 0
L_lw_116e:
    v_and_b32 v11, 31, v0
    v_lshlrev_b32 v11, 7, v11
    s_lshl_b32 s63, s34, 12
    s_add_u32 s63, s63, 73792
    buffer_load_dword v12, v39, s[40:43], s98 offen sc1
    s_branch L_poll_117
L_poll_117s:
    s_sleep 2
L_poll_117:
    buffer_load_dwordx2 v[8:9], v21, s[40:43], s99 offen sc1
    buffer_load_dword v10, v11, s[40:43], s63 offen sc1
    s_sub_u32 s60, s60, 1
    s_cbranch_scc1 L_poll_117t
    s_waitcnt vmcnt(0)
    v_max3_u32 v38, v8, v9, v10
    v_cmp_eq_u32 vcc, -1, v38
    s_cbranch_vccnz L_poll_117s
L_poll_117e:
    v_mov_b32 v37, v8
    s_nop 1
    v_max_f32_dpp v37, v37, v37 quad_perm:[1,0,3,2] row_mask:0xf bank_mask:0xf
    s_nop 1
    v_max_f32_dpp v37, v37, v37 quad_perm:[2,3,0,1] row_mask:0xf bank_mask:0xf
    s_nop 1
    v_max_f32_dpp v37, v37, v37 row_ror:4 row_mask:0xf bank_mask:0xf
    s_nop 1
    v_max_f32_dpp v37, v37, v37 row_ror:8 row_mask:0xf bank_mask:0xf
    v_sub_f32 v8, v8, v37
    v_exp_f32 v8, v8
    s_nop 0
    v_mul_f32 v9, v8, v9
    s_nop 1
    v_add_f32_dpp v9, v9, v9 quad_perm:[1,0,3,2] row_mask:0xf bank_mask:0xf
    s_nop 1
    v_add_f32_dpp v9, v9, v9 quad_perm:[2,3,0,1] row_mask:0xf bank_mask:0xf
    s_nop 1
    v_add_f32_dpp v9, v9, v9 row_ror:4 row_mask:0xf bank_mask:0xf
    s_nop 1
    v_add_f32_dpp v9, v9, v9 row_ror:8 row_mask:0xf bank_mask:0xf
    v_ashrrev_i32 v12, 8, v10
    s_nop 1
    v_add_u32_dpp v12, v12, v12 quad_perm:[1,0,3,2] row_mask:0xf bank_mask:0xf
    s_nop 1
    v_add_u32_dpp v12, v12, v12 quad_perm:[2,3,0,1] row_mask:0xf bank_mask:0xf
    s_nop 1
    v_add_u32_dpp v12, v12, v12 row_ror:4 row_mask:0xf bank_mask:0xf
    s_nop 1
    v_add_u32_dpp v12, v12, v12 row_ror:8 row_mask:0xf bank_mask:0xf
    v_mov_b32 v13, v12
    s_nop 1
    v_permlane16_swap_b32 v12, v13
    v_add_u32 v12, v12, v13
    v_mov_b32 v13, v12
    s_nop 1
    v_permlane32_swap_b32 v12, v13
    v_add_u32 v12, v12, v13
    v_ashrrev_i32 v12, 31, v12
    v_and_b32 v12, 8192, v12
    v_mov_b32 v13, 162084
    ds_write_b32 v13, v12
    v_and_b32 v10, 0xff, v10
    s_getreg_b32 s62, hwreg(HW_REG_XCC_ID, 0, 4)
    v_cmp_ne_u32 vcc, s62, v10
    s_nop 0
    s_cmp_eq_u64 vcc, 0
    s_cselect_b32 s61, 1, 0
    v_rcp_f32 v9, v9
    v_lshrrev_b32 v3, 1, v2
    v_add_u32 v3, 161984, v3
    v_mul_f32 v8, v8, v9
    v_mov_b32 v10, 162072
    v_mov_b32 v11, s61
    ds_write_b32 v3, v8
    ds_write_b32 v10, v11
    s_cmp_eq_u32 s61, 1
    s_cbranch_scc0 L_ycs
    buffer_store_dwordx4 v[24:27], v22, s[40:43], 0 offen offset:0
    buffer_store_dwordx4 v[24:27], v22, s[40:43], 0 offen offset:1024
    buffer_store_dwordx4 v[24:27], v22, s[40:43], 0 offen offset:2048
    buffer_store_dwordx4 v[24:27], v22, s[40:43], 0 offen offset:3072
    buffer_store_dwordx4 v[24:27], v23, s[40:43], 0 offen offset:0
L_ycd:
    s_branch L_poll_118
L_poll_118s:
    s_sleep 2
L_poll_118:
    buffer_load_dwordx4 v[32:35], v20, s[40:43], s97 offen sc1
    s_sub_u32 s60, s60, 1
    s_cbranch_scc1 L_poll_118t
    s_waitcnt vmcnt(0)
    v_max3_u32 v38, v32, v33, v34
    v_max_u32 v38, v38, v35
    v_cmp_eq_u32 vcc, -1, v38
    s_cbranch_vccnz L_poll_118s
L_poll_118e:
    s_branch L_pxj
L_px6:
    s_or_b32 s96, s59, s39
    s_cbranch_scc0 L_nofrag_119
    v_mov_b32 v104, 162060
L_lw_120:
    ds_read_b32 v105, v104
    s_waitcnt lgkmcnt(0)
    v_cmp_gt_u32 vcc, 4, v105
    s_cbranch_vccz L_lw_120e
    s_sleep 2
    s_sub_u32 s60, s60, 1
    s_cbranch_scc0 L_lw_120
    s_mov_b32 s60, 0
L_lw_120e:
    s_cmp_eq_u32 s59, 0
    s_cbranch_scc1 L_nofrag_119
    v_bfe_u32 v104, v0, 2, 1
    v_bfe_u32 v110, v0, 4, 1
    v_lshl_add_u32 v104, v110, 2, v104
    v_and_b32 v110, 8, v0
    v_add_u32 v104, v104, v110
    v_lshrrev_b32 v110, 5, v0
    v_lshl_add_u32 v104, v110, 4, v104
    v_bfe_u32 v111, v0, 0, 1
    v_mul_u32_u24 v111, 0xaaaa, v111
    v_add_u32 v111, 0x4444, v111
    v_mov_b32 v112, 0
    v_mov_b32 v113, 0
    v_mov_b32 v114, 0
    v_mov_b32 v115, 0
    v_mov_b32 v116, 0
    v_mov_b32 v117, 0
    v_mov_b32 v118, 0
    v_mov_b32 v119, 0
    v_lshlrev_b32 v104, 7, v104
    v_and_b32 v110, 3, v0
    v_lshl_add_u32 v104, v110, 3, v104
    v_lshrrev_b32 v109, 4, v0
    v_and_b32 v110, 1, v0
    s_lshr_b32 s63, s3, 1
    s_and_b32 s62, s3, 1
    s_lshl_b32 s96, s63, 14
    s_lshl_b32 s100, s62, 6
    s_add_u32 s100, s100, 81920
    s_add_u32 s96, s96, s100
    v_add_u32 v104, s96, v104
    ds_read_b64_tr_b16 v[72:73], v104 offset:0
    ds_read_b64_tr_b16 v[74:75], v104 offset:256
    ds_read_b64_tr_b16 v[76:77], v104 offset:4096
    ds_read_b64_tr_b16 v[78:79], v104 offset:4352
    ds_read_b64_tr_b16 v[80:81], v104 offset:32
    ds_read_b64_tr_b16 v[82:83], v104 offset:288
    ds_read_b64_tr_b16 v[84:85], v104 offset:4128
    ds_read_b64_tr_b16 v[86:87], v104 offset:4384
    ds_read_b64_tr_b16 v[88:89], v104 offset:8192
    ds_read_b64_tr_b16 v[90:91], v104 offset:8448
    ds_read_b64_tr_b16 v[92:93], v104 offset:12288
    ds_read_b64_tr_b16 v[94:95], v104 offset:12544
    ds_read_b64_tr_b16 v[96:97], v104 offset:8224
    ds_read_b64_tr_b16 v[98:99], v104 offset:8480
    ds_read_b64_tr_b16 v[100:101], v104 offset:12320
    ds_read_b64_tr_b16 v[102:103], v104 offset:12576
    v_bfe_u32 v105, v0, 1, 3
    v_lshlrev_b32 v105, 8, v105
    v_lshl_add_u32 v105, v109, 5, v105
    v_lshl_add_u32 v105, v110, 4, v105
    v_lshrrev_b32 v106, 3, v0
    v_lshlrev_b32 v106, 7, v106
    v_and_b32 v110, 7, v0
    v_lshl_add_u32 v107, v110, 3, v106
    v_add_u32 v107, s100, v107
    v_lshlrev_b32 v106, 8, v109
    v_and_b32 v110, 15, v0
    v_lshl_add_u32 v106, v110, 2, v106
    v_add_u32 v106, s96, v106
    v_lshlrev_b32 v108, 2, v0
    s_lshl_b32 s96, s62, 2
    s_add_u32 s96, s96, 162088
    v_mov_b32 v109, s96
    s_lshl_b32 s100, s63, 11
    s_lshl_b32 s96, s34, 13
    s_add_u32 s100, s100, s96
    s_add_u32 s100, s100, 106496
    s_mul_i32 s101, s34, 5120
    s_lshl_b32 s96, s35, 9
    s_add_u32 s101, s101, s96
    s_lshl_b32 s96, s62, 8
    s_add_u32 s101, s101, s96
    s_sub_u32 s101, s101, 11264
    s_and_b32 s96, s101, 0xffffe000
    s_add_u32 s101, s101, s96
    s_add_u32 s101, s101, 212992
    v_add_u32 v110, 8192, v108
L_nofrag_119:
    s_mov_b32 s62, 3
    s_lshl1_add_u32 s96, s35, s3
    s_and_b32 s63, s96, 7
    s_lshl_b32 s63, s63, 14
    s_lshl_b32 s96, s96, 7
    s_add_u32 s96, s96, s63
    s_add_u32 s96, s96, 475136
    s_add_u32 s98, s32, s96
    s_addc_u32 s99, s33, 0
    s_load_dword s4, s[98:99], 0 glc
    s_load_dword s5, s[98:99], 8192 glc
    s_mov_b32 s63, 0
    s_waitcnt lgkmcnt(0)
L_np:
    s_not_b32 s4, s4
    s_mov_b32 s6, s4
    s_mov_b32 s7, 0
    s_load_dword s4, s[98:99], 0 glc
L_npc0:
    s_add_u32 s7, s7, 1
    s_cmp_eq_u32 s4, s6
    s_cselect_b32 s8, s7, 1000
    s_cmp_lt_u32 s8, 60
    s_cbranch_scc1 L_npc0
    s_waitcnt lgkmcnt(0)
    s_sub_u32 s63, s63, s7
    s_not_b32 s5, s5
    s_mov_b32 s6, s5
    s_mov_b32 s7, 0
    s_load_dword s5, s[98:99], 8192 glc
L_npc1:
    s_add_u32 s7, s7, 1
    s_cmp_eq_u32 s5, s6
    s_cselect_b32 s8, s7, 1000
    s_cmp_lt_u32 s8, 60
    s_cbranch_scc1 L_npc1
    s_waitcnt lgkmcnt(0)
    s_add_u32 s63, s63, s7
    s_sub_u32 s62, s62, 1
    s_cmp_lg_u32 s62, 0
    s_cbranch_scc1 L_np
    v_mov_b32 v8, 162096
    v_mov_b32 v9, s63
    s_mov_b64 exec, 1
    ds_add_u32 v8, v9
    s_mov_b64 exec, -1
    v_mov_b32 v8, 162068
L_lw_121:
    ds_read_b32 v9, v8
    s_waitcnt lgkmcnt(0)
    v_cmp_gt_u32 vcc, 1, v9
    s_cbranch_vccz L_lw_121e
    s_sleep 32
    s_sub_u32 s60, s60, 1
    s_cbranch_scc0 L_lw_121
    s_mov_b32 s60, 0
L_lw_121e:
    s_cmp_ge_u32 s35, 20
    s_cbranch_scc1 L_nofin_122
    s_lshl1_add_u32 s62, s35, s3
    s_sub_u32 s62, s62, 6
    s_lshl_b32 s57, s62, 7
    s_mul_i32 s63, s62, 0x199a
    s_lshr_b32 s63, s63, 16
    s_mul_i32 s63, s63, 1280
    s_sub_u32 s63, s57, s63
    v_lshrrev_b32 v72, 3, v0
    v_mul_u32_u24 v72, 5120, v72
    v_and_b32 v8, 7, v0
    v_lshl_add_u32 v72, v8, 4, v72
    s_add_u32 s62, s57, 327680
    v_add_u32 v72, s62, v72
    v_add_u32 v73, 40960, v72
    v_add_u32 v74, 81920, v72
    v_add_u32 v75, 122880, v72
    v_bfe_u32 v9, v0, 4, 1
    v_lshlrev_b32 v76, 4, v8
    v_lshl_add_u32 v76, v9, 3, v76
    s_lshl_b32 s62, s57, 1
    s_add_u32 s62, s62, 99328
    v_lshl_add_u32 v77, v76, 1, s62
    s_mov_b32 s48, s22
    s_mov_b32 s49, s23
    s_mov_b32 s50, 1280
    s_mov_b32 s51, 0x20000
    buffer_load_dwordx2 v[86:87], v76, s[48:51], s63 offen
    s_add_u32 s62, s57, 35840
    s_branch L_poll_123
L_poll_123s:
    s_sleep 32
L_poll_123:
    buffer_load_dwordx2 v[8:9], v76, s[40:43], s62 offen sc1
    s_sub_u32 s60, s60, 1
    s_cbranch_scc1 L_poll_123t
    s_waitcnt vmcnt(0)
    v_max_u32 v38, v8, v9
    v_cmp_eq_u32 vcc, -1, v38
    s_cbranch_vccnz L_poll_123s
L_poll_123e:
    v_lshlrev_b32 v78, 16, v86
    v_and_b32 v79, 0xffff0000, v86
    v_lshlrev_b32 v82, 16, v8
    v_and_b32 v83, 0xffff0000, v8
    v_lshlrev_b32 v80, 16, v87
    v_and_b32 v81, 0xffff0000, v87
    v_lshlrev_b32 v84, 16, v9
    v_and_b32 v85, 0xffff0000, v9
    v_bfe_u32 v8, v0, 1, 3
    v_and_b32 v9, 1, v0
    v_lshlrev_b32 v9, 4, v9
    v_mov_b32 v10, 0x3f80
    v_lshlrev_b32 v9, v9, v10
    v_cmp_eq_u32 vcc, 0, v8
    v_mov_b32 v100, 0
    s_nop 0
    v_cndmask_b32 v104, 0, v9, vcc
    v_cmp_eq_u32 vcc, 1, v8
    v_mov_b32 v101, 0
    s_nop 0
    v_cndmask_b32 v105, 0, v9, vcc
    v_cmp_eq_u32 vcc, 2, v8
    v_mov_b32 v102, 0
    s_nop 0
    v_cndmask_b32 v106, 0, v9, vcc
    v_cmp_eq_u32 vcc, 3, v8
    v_mov_b32 v103, 0
    s_nop 0
    v_cndmask_b32 v107, 0, v9, vcc
L_nofin_122:
    v_mov_b32 v8, 162076
L_lw_124:
    ds_read_b32 v9, v8
    s_waitcnt lgkmcnt(0)
    v_cmp_gt_u32 vcc, 4, v9
    s_cbranch_vccz L_lw_124e
    s_sleep 16
    s_sub_u32 s60, s60, 1
    s_cbranch_scc0 L_lw_124
    s_mov_b32 s60, 0
L_lw_124e:
    s_branch L_poll_125
L_poll_125s:
    s_sleep 2
L_poll_125:
    buffer_load_dwordx4 v[32:35], v20, s[40:43], s97 offen sc1
    s_sub_u32 s60, s60, 1
    s_cbranch_scc1 L_poll_125t
    s_waitcnt vmcnt(0)
    v_max3_u32 v38, v32, v33, v34
    v_max_u32 v38, v38, v35
    v_cmp_eq_u32 vcc, -1, v38
    s_cbranch_vccnz L_poll_125s
L_poll_125e:
L_pxj:
    s_cmp_ge_u32 s35, 20
    s_cbranch_scc1 L_pxk
    s_mov_b64 exec, -1
L_pxk:
    v_mov_b32 v8, 162048
L_lw_126:
    ds_read_b32 v9, v8
    s_waitcnt lgkmcnt(0)
    v_cmp_gt_u32 vcc, 3, v9
    s_cbranch_vccz L_lw_126e
    s_sleep 2
    s_sub_u32 s60, s60, 1
    s_cbranch_scc0 L_lw_126
    s_mov_b32 s60, 0
L_lw_126e:
    v_lshrrev_b32 v9, 4, v0
    v_lshl_add_u32 v8, v9, 2, v2
    s_lshl_b32 s96, s3, 9
    s_add_u32 s96, s96, 157824
    v_lshl_add_u32 v8, v8, 2, s96
    v_lshlrev_b32 v9, 3, v0
    v_add_u32 v9, 157824, v9
    v_mov_b32 v10, 162048
    v_mov_b32 v11, 1
    s_lshl_b32 s96, s38, 5
    s_add_u32 s96, s96, 161984
    v_mov_b32 v3, s96
    s_sub_u32 s62, 8, s39
    s_lshl_b32 s98, s34, 5
    s_add_u32 s98, s98, s35
    s_lshl_b32 s98, s98, 8
    s_add_u32 s98, s98, 106496
    v_lshlrev_b32 v39, 2, v0
    s_branch L_t0
L_s_role:
    s_cmp_eq_u32 s3, 7
    s_cbranch_scc1 L_t2gate
    s_cmp_gt_u32 s3, 3
    s_cbranch_scc1 L_fin_prep
    s_mov_b32 s48, s18
    s_mov_b32 s49, s19
    s_mov_b32 s50, 3456
    s_mov_b32 s51, 0x20000
    v_lshrrev_b32 v3, 4, v0
    v_and_b32 v4, 15, v0
    v_lshlrev_b32 v4, 1, v4
    s_lshl_b32 s62, s35, 7
    s_lshl_b32 s63, s3, 5
    s_add_u32 s62, s62, s63
    buffer_load_ushort v82, v4, s[48:51], s62 offen
    v_mov_b32 v72, 162064
L_lw_127:
    ds_read_b32 v73, v72
    s_waitcnt lgkmcnt(0)
    v_cmp_gt_u32 vcc, 4, v73
    s_cbranch_vccz L_lw_127e
    s_sleep 2
    s_sub_u32 s60, s60, 1
    s_cbranch_scc0 L_lw_127
    s_mov_b32 s60, 0
L_lw_127e:
    v_bfe_u32 v72, v0, 2, 1
    v_bfe_u32 v73, v0, 4, 1
    v_lshl_add_u32 v72, v73, 2, v72
    v_and_b32 v73, 8, v0
    v_add_u32 v72, v72, v73
    v_lshrrev_b32 v73, 5, v0
    v_lshl_add_u32 v72, v73, 4, v72
    v_lshlrev_b32 v72, 7, v72
    v_and_b32 v73, 3, v0
    v_lshl_add_u32 v72, v73, 3, v72
    v_and_b32 v73, 8, v0
    v_lshl_add_u32 v72, v73, 3, v72
    v_xor_b32 v72, s63, v72
    v_xor_b32 v73, 32, v72
    v_add_u32 v74, 40960, v72
    v_add_u32 v75, 40960, v73
    v_bfe_u32 v1, v0, 2, 2
    v_bfe_u32 v2, v0, 1, 1
    v_and_b32 v6, 1, v0
    v_lshlrev_b32 v7, 5, v3
    v_lshl_add_u32 v7, v6, 4, v7
    v_lshl_add_u32 v5, v2, 2, v1
    v_mul_u32_u24 v5, 1296, v5
    v_add_u32 v5, v5, v7
    v_add_u32 v5, 147456, v5
    v_bfe_u32 v87, v0, 0, 1
    v_mul_u32_u24 v87, 0xaaaa, v87
    v_add_u32 v87, 0x4444, v87
    ds_read_b64_tr_b16 v[88:89], v72 offset:0
    ds_read_b64_tr_b16 v[90:91], v73 offset:256
    ds_read_b64_tr_b16 v[92:93], v72 offset:4096
    ds_read_b64_tr_b16 v[94:95], v73 offset:4352
    ds_read_b64_tr_b16 v[96:97], v72 offset:8192
    ds_read_b64_tr_b16 v[98:99], v73 offset:8448
    ds_read_b64_tr_b16 v[100:101], v72 offset:12288
    ds_read_b64_tr_b16 v[102:103], v73 offset:12544
    ds_read_b64_tr_b16 v[104:105], v72 offset:16384
    ds_read_b64_tr_b16 v[106:107], v73 offset:16640
    ds_read_b64_tr_b16 v[108:109], v72 offset:20480
    ds_read_b64_tr_b16 v[110:111], v73 offset:20736
    ds_read_b64_tr_b16 v[112:113], v72 offset:24576
    ds_read_b64_tr_b16 v[114:115], v73 offset:24832
    ds_read_b64_tr_b16 v[116:117], v72 offset:28672
    ds_read_b64_tr_b16 v[118:119], v73 offset:28928
    ds_read_b64_tr_b16 v[120:121], v72 offset:32768
    ds_read_b64_tr_b16 v[122:123], v73 offset:33024
    ds_read_b64_tr_b16 v[124:125], v72 offset:36864
    ds_read_b64_tr_b16 v[126:127], v73 offset:37120
    ds_read_b64_tr_b16 v[128:129], v74 offset:0
    ds_read_b64_tr_b16 v[130:131], v75 offset:256
    ds_read_b64_tr_b16 v[132:133], v74 offset:4096
    ds_read_b64_tr_b16 v[134:135], v75 offset:4352
    ds_read_b64_tr_b16 v[136:137], v74 offset:8192
    ds_read_b64_tr_b16 v[138:139], v75 offset:8448
    ds_read_b64_tr_b16 v[140:141], v74 offset:12288
    ds_read_b64_tr_b16 v[142:143], v75 offset:12544
    ds_read_b64_tr_b16 v[144:145], v74 offset:16384
    ds_read_b64_tr_b16 v[146:147], v75 offset:16640
    ds_read_b64_tr_b16 v[148:149], v74 offset:20480
    ds_read_b64_tr_b16 v[150:151], v75 offset:20736
    ds_read_b64_tr_b16 v[152:153], v74 offset:24576
    ds_read_b64_tr_b16 v[154:155], v75 offset:24832
    ds_read_b64_tr_b16 v[156:157], v74 offset:28672
    ds_read_b64_tr_b16 v[158:159], v75 offset:28928
    ds_read_b64_tr_b16 v[160:161], v74 offset:32768
    ds_read_b64_tr_b16 v[162:163], v75 offset:33024
    ds_read_b64_tr_b16 v[164:165], v74 offset:36864
    ds_read_b64_tr_b16 v[166:167], v75 offset:37120
    ds_read_b128 v[8:11], v5 offset:0
    ds_read_b128 v[12:15], v5 offset:128
    ds_read_b128 v[16:19], v5 offset:256
    ds_read_b128 v[20:23], v5 offset:384
    ds_read_b128 v[24:27], v5 offset:512
    ds_read_b128 v[28:31], v5 offset:640
    ds_read_b128 v[32:35], v5 offset:768
    ds_read_b128 v[36:39], v5 offset:896
    ds_read_b128 v[40:43], v5 offset:1024
    ds_read_b128 v[44:47], v5 offset:1152
    v_mov_b32 v48, 0
    v_mov_b32 v49, 0
    v_mov_b32 v50, 0
    v_mov_b32 v51, 0
    v_mov_b32 v52, 0
    v_mov_b32 v53, 0
    v_mov_b32 v54, 0
    v_mov_b32 v55, 0
    v_mov_b32 v56, 0
    v_mov_b32 v57, 0
    v_mov_b32 v58, 0
    v_mov_b32 v59, 0
    s_waitcnt lgkmcnt(9)
    v_smfmac_f32_16x16x64_bf16 v[48:51], v[8:11], v[88:95], v87
    s_waitcnt lgkmcnt(8)
    v_smfmac_f32_16x16x64_bf16 v[48:51], v[12:15], v[96:103], v87
    s_waitcnt lgkmcnt(7)
    v_smfmac_f32_16x16x64_bf16 v[48:51], v[16:19], v[104:111], v87
    s_waitcnt lgkmcnt(6)
    v_smfmac_f32_16x16x64_bf16 v[48:51], v[20:23], v[112:119], v87
    s_waitcnt lgkmcnt(5)
    v_smfmac_f32_16x16x64_bf16 v[48:51], v[24:27], v[120:127], v87
    s_waitcnt lgkmcnt(4)
    v_smfmac_f32_16x16x64_bf16 v[48:51], v[28:31], v[128:135], v87
    s_waitcnt lgkmcnt(3)
    v_smfmac_f32_16x16x64_bf16 v[48:51], v[32:35], v[136:143], v87
    s_waitcnt lgkmcnt(2)
    v_smfmac_f32_16x16x64_bf16 v[48:51], v[36:39], v[144:151], v87
    s_waitcnt lgkmcnt(1)
    v_smfmac_f32_16x16x64_bf16 v[48:51], v[40:43], v[152:159], v87
    s_waitcnt lgkmcnt(0)
    v_smfmac_f32_16x16x64_bf16 v[48:51], v[44:47], v[160:167], v87
    v_mul_u32_u24 v79, 1296, v1
    v_lshl_add_u32 v79, v2, 7, v79
    v_add_u32 v79, v79, v7
    v_add_u32 v79, 82944, v79
    v_mul_u32_u24 v80, 144, v3
    v_add3_u32 v80, v80, v4, s63
    v_add_u32 v80, 90688, v80
    v_lshlrev_b32 v81, 3, v0
    v_add_u32 v81, 88128, v81
    v_add_f32 v84, v48, v49
    v_add_f32 v85, v50, v51
    s_mov_b32 s62, 0xbacccccd
    s_mov_b32 s63, 0xbdd2d3e8
    v_mov_b32 v86, 0xc0135761
    s_waitcnt vmcnt(0)
    v_lshlrev_b32 v82, 16, v82
    v_add_f32 v85, v85, v82
    s_branch L_ffn1
L_fin_prep:
    s_cmp_lg_u32 s3, 6
    s_cbranch_scc1 L_end
    s_cmp_ge_u32 s35, 20
    s_cbranch_scc1 L_end
    s_barrier
L_fin:
    s_mov_b32 s52, s28
    s_mov_b32 s53, s29
    s_mov_b32 s54, 5120
    s_mov_b32 s55, 0x20000
    s_mov_b64 s[4:5], -1
    s_mov_b64 s[6:7], -1
    s_mov_b64 s[8:9], -1
    s_mov_b64 s[10:11], 0xffffff
    s_barrier
    ds_read_b128 v[108:111], v77
    s_waitcnt lgkmcnt(0)
    v_pk_fma_f32 v[108:109], v[78:79], v[82:83], v[108:109]
    v_pk_fma_f32 v[110:111], v[80:81], v[84:85], v[110:111]
    s_barrier
L_yg:
    s_mov_b64 exec, s[4:5]
    buffer_load_dwordx4 v[88:91], v72, s[40:43], 0 offen sc1
    s_mov_b64 exec, s[6:7]
    buffer_load_dwordx4 v[92:95], v73, s[40:43], 0 offen sc1
    s_mov_b64 exec, s[8:9]
    buffer_load_dwordx4 v[96:99], v74, s[40:43], 0 offen sc1
    s_mov_b64 exec, s[10:11]
    buffer_load_dwordx4 v[100:103], v75, s[40:43], 0 offen sc1
    s_mov_b64 exec, -1
    s_sub_u32 s60, s60, 1
    s_cbranch_scc1 L_ygt
    s_waitcnt vmcnt(3)
    v_max3_u32 v3, v88, v89, v90
    v_max_u32 v3, v3, v91
    v_cmp_eq_u32 s[4:5], -1, v3
    v_mfma_f32_16x16x32_bf16 v[112:115], v[104:107], v[88:91], 0
    s_waitcnt vmcnt(2)
    v_max3_u32 v3, v92, v93, v94
    v_max_u32 v3, v3, v95
    v_cmp_eq_u32 s[6:7], -1, v3
    v_mfma_f32_16x16x32_bf16 v[112:115], v[104:107], v[92:95], v[112:115]
    s_waitcnt vmcnt(1)
    v_max3_u32 v3, v96, v97, v98
    v_max_u32 v3, v3, v99
    v_cmp_eq_u32 s[8:9], -1, v3
    v_mfma_f32_16x16x32_bf16 v[112:115], v[104:107], v[96:99], v[112:115]
    s_waitcnt vmcnt(0)
    v_max3_u32 v3, v100, v101, v102
    v_max_u32 v3, v3, v103
    v_cmp_eq_u32 s[10:11], -1, v3
    v_mfma_f32_16x16x32_bf16 v[112:115], v[104:107], v[100:103], v[112:115]
    s_or_b64 s[16:17], s[4:5], s[6:7]
    s_or_b64 s[16:17], s[16:17], s[8:9]
    s_or_b64 s[16:17], s[16:17], s[10:11]
    s_cbranch_scc1 L_yg
L_ygd:
    s_nop 3
    v_add_f32_dpp v112, v112, v112 row_ror:8 row_mask:0xf bank_mask:0xf
    v_add_f32_dpp v113, v113, v113 row_ror:8 row_mask:0xf bank_mask:0xf
    v_add_f32_dpp v114, v114, v114 row_ror:8 row_mask:0xf bank_mask:0xf
    v_add_f32_dpp v115, v115, v115 row_ror:8 row_mask:0xf bank_mask:0xf
    v_pk_fma_f32 v[112:113], v[112:113], v[82:83], v[108:109]
    v_pk_fma_f32 v[114:115], v[114:115], v[84:85], v[110:111]
    v_cvt_pk_bf16_f32 v112, v112, v113
    v_cvt_pk_bf16_f32 v113, v114, v115
    s_mov_b64 exec, 0x00ff00ff
    buffer_store_dwordx2 v[112:113], v76, s[52:55], s57 offen
    s_endpgm
L_t2gate:
    v_mov_b32 v8, 162048
L_lw_128:
    ds_read_b32 v9, v8
    s_waitcnt lgkmcnt(0)
    v_cmp_gt_u32 vcc, 8, v9
    s_cbranch_vccz L_lw_128e
    s_sleep 2
    s_sub_u32 s60, s60, 1
    s_cbranch_scc0 L_lw_128
    s_mov_b32 s60, 0
L_lw_128e:
    ds_read_b32 v9, v8 offset:24
    ds_read_b32 v10, v8 offset:36
    v_add_u32 v5, 212992, v5
    s_waitcnt lgkmcnt(0)
    v_readfirstlane_b32 s61, v9
    v_add_u32 v5, v5, v10
    s_mov_b32 s58, 0x3f80
    s_mov_b32 s59, 0x3f800000
    s_mov_b32 s63, 0xff
L_prb:
    s_bcnt1_i32_b32 s62, s63
    s_mov_b32 s97, s63
    s_ff1_i32_b32 s12, s97
    s_bitset0_b32 s97, s12
    s_mul_i32 s4, s12, 5120
    s_add_u32 s4, s4, s56
    s_and_b32 s96, s4, 0xffffe000
    s_add_u32 s4, s4, s96
    s_cmp_eq_u32 s62, 1
    s_cbranch_scc1 L_pi1
    s_ff1_i32_b32 s13, s97
    s_bitset0_b32 s97, s13
    s_mul_i32 s5, s13, 5120
    s_add_u32 s5, s5, s56
    s_and_b32 s96, s5, 0xffffe000
    s_add_u32 s5, s5, s96
    s_cmp_eq_u32 s62, 2
    s_cbranch_scc1 L_pi2
    s_ff1_i32_b32 s14, s97
    s_bitset0_b32 s97, s14
    s_mul_i32 s6, s14, 5120
    s_add_u32 s6, s6, s56
    s_and_b32 s96, s6, 0xffffe000
    s_add_u32 s6, s6, s96
    s_cmp_eq_u32 s62, 3
    s_cbranch_scc1 L_pi3
    s_ff1_i32_b32 s15, s97
    s_bitset0_b32 s97, s15
    s_mul_i32 s7, s15, 5120
    s_add_u32 s7, s7, s56
    s_and_b32 s96, s7, 0xffffe000
    s_add_u32 s7, s7, s96
    s_cmp_eq_u32 s62, 4
    s_cbranch_scc1 L_pi4
    s_ff1_i32_b32 s16, s97
    s_bitset0_b32 s97, s16
    s_mul_i32 s8, s16, 5120
    s_add_u32 s8, s8, s56
    s_and_b32 s96, s8, 0xffffe000
    s_add_u32 s8, s8, s96
    s_cmp_eq_u32 s62, 5
    s_cbranch_scc1 L_pi5
    s_ff1_i32_b32 s17, s97
    s_bitset0_b32 s97, s17
    s_mul_i32 s9, s17, 5120
    s_add_u32 s9, s9, s56
    s_and_b32 s96, s9, 0xffffe000
    s_add_u32 s9, s9, s96
    s_cmp_eq_u32 s62, 6
    s_cbranch_scc1 L_pi6
    s_ff1_i32_b32 s18, s97
    s_bitset0_b32 s97, s18
    s_mul_i32 s10, s18, 5120
    s_add_u32 s10, s10, s56
    s_and_b32 s96, s10, 0xffffe000
    s_add_u32 s10, s10, s96
    s_cmp_eq_u32 s62, 7
    s_cbranch_scc1 L_pi7
    s_ff1_i32_b32 s19, s97
    s_bitset0_b32 s97, s19
    s_mul_i32 s11, s19, 5120
    s_add_u32 s11, s11, s56
    s_and_b32 s96, s11, 0xffffe000
    s_add_u32 s11, s11, s96
L_pi8:
    buffer_load_dwordx4 v[36:39], v5, s[40:43], s11 offen sc1
L_pi7:
    buffer_load_dwordx4 v[32:35], v5, s[40:43], s10 offen sc1
L_pi6:
    buffer_load_dwordx4 v[28:31], v5, s[40:43], s9 offen sc1
L_pi5:
    buffer_load_dwordx4 v[24:27], v5, s[40:43], s8 offen sc1
L_pi4:
    buffer_load_dwordx4 v[20:23], v5, s[40:43], s7 offen sc1
L_pi3:
    buffer_load_dwordx4 v[16:19], v5, s[40:43], s6 offen sc1
L_pi2:
    buffer_load_dwordx4 v[12:15], v5, s[40:43], s5 offen sc1
    buffer_load_dwordx4 v[8:11], v5, s[40:43], s4 offen sc1
    s_sub_u32 s60, s60, 1
    s_cbranch_scc1 L_pto
    s_waitcnt vmcnt(0)
    v_max3_u32 v3, v8, v9, v10
    v_max_u32 v3, v3, v11
    v_cmp_eq_u32 vcc, -1, v3
    s_cbranch_vccz L_pgot0
    v_max3_u32 v3, v12, v13, v14
    v_max_u32 v3, v3, v15
    v_cmp_eq_u32 vcc, -1, v3
    s_cbranch_vccz L_pgot1
    s_cmp_eq_u32 s62, 2
    s_cbranch_scc1 L_pi2
    v_max3_u32 v3, v16, v17, v18
    v_max_u32 v3, v3, v19
    v_cmp_eq_u32 vcc, -1, v3
    s_cbranch_vccz L_pgot2
    s_cmp_eq_u32 s62, 3
    s_cbranch_scc1 L_pi3
    v_max3_u32 v3, v20, v21, v22
    v_max_u32 v3, v3, v23
    v_cmp_eq_u32 vcc, -1, v3
    s_cbranch_vccz L_pgot3
    s_cmp_eq_u32 s62, 4
    s_cbranch_scc1 L_pi4
    v_max3_u32 v3, v24, v25, v26
    v_max_u32 v3, v3, v27
    v_cmp_eq_u32 vcc, -1, v3
    s_cbranch_vccz L_pgot4
    s_cmp_eq_u32 s62, 5
    s_cbranch_scc1 L_pi5
    v_max3_u32 v3, v28, v29, v30
    v_max_u32 v3, v3, v31
    v_cmp_eq_u32 vcc, -1, v3
    s_cbranch_vccz L_pgot5
    s_cmp_eq_u32 s62, 6
    s_cbranch_scc1 L_pi6
    v_max3_u32 v3, v32, v33, v34
    v_max_u32 v3, v3, v35
    v_cmp_eq_u32 vcc, -1, v3
    s_cbranch_vccz L_pgot6
    s_cmp_eq_u32 s62, 7
    s_cbranch_scc1 L_pi7
    v_max3_u32 v3, v36, v37, v38
    v_max_u32 v3, v3, v39
    v_cmp_eq_u32 vcc, -1, v3
    s_cbranch_vccz L_pgot7
    s_branch L_pi8
L_pgot0:
    v_dot2c_f32_bf16 v64, s58, v8
    v_dot2c_f32_bf16 v65, s59, v8
    v_dot2c_f32_bf16 v66, s58, v9
    v_dot2c_f32_bf16 v67, s59, v9
    v_dot2c_f32_bf16 v68, s58, v10
    v_dot2c_f32_bf16 v69, s59, v10
    v_dot2c_f32_bf16 v70, s58, v11
    v_dot2c_f32_bf16 v71, s59, v11
    s_bitset0_b32 s63, s12
    s_cmp_eq_u32 s63, 0
    s_cbranch_scc1 L_pgd
L_pn0:
    s_cmp_eq_u32 s62, 1
    s_cbranch_scc1 L_prb
    v_max3_u32 v3, v12, v13, v14
    v_max_u32 v3, v3, v15
    v_cmp_eq_u32 vcc, -1, v3
    s_cbranch_vccnz L_pn1
L_pgot1:
    v_dot2c_f32_bf16 v64, s58, v12
    v_dot2c_f32_bf16 v65, s59, v12
    v_dot2c_f32_bf16 v66, s58, v13
    v_dot2c_f32_bf16 v67, s59, v13
    v_dot2c_f32_bf16 v68, s58, v14
    v_dot2c_f32_bf16 v69, s59, v14
    v_dot2c_f32_bf16 v70, s58, v15
    v_dot2c_f32_bf16 v71, s59, v15
    s_bitset0_b32 s63, s13
    s_cmp_eq_u32 s63, 0
    s_cbranch_scc1 L_pgd
L_pn1:
    s_cmp_eq_u32 s62, 2
    s_cbranch_scc1 L_prb
    v_max3_u32 v3, v16, v17, v18
    v_max_u32 v3, v3, v19
    v_cmp_eq_u32 vcc, -1, v3
    s_cbranch_vccnz L_pn2
L_pgot2:
    v_dot2c_f32_bf16 v64, s58, v16
    v_dot2c_f32_bf16 v65, s59, v16
    v_dot2c_f32_bf16 v66, s58, v17
    v_dot2c_f32_bf16 v67, s59, v17
    v_dot2c_f32_bf16 v68, s58, v18
    v_dot2c_f32_bf16 v69, s59, v18
    v_dot2c_f32_bf16 v70, s58, v19
    v_dot2c_f32_bf16 v71, s59, v19
    s_bitset0_b32 s63, s14
    s_cmp_eq_u32 s63, 0
    s_cbranch_scc1 L_pgd
L_pn2:
    s_cmp_eq_u32 s62, 3
    s_cbranch_scc1 L_prb
    v_max3_u32 v3, v20, v21, v22
    v_max_u32 v3, v3, v23
    v_cmp_eq_u32 vcc, -1, v3
    s_cbranch_vccnz L_pn3
L_pgot3:
    v_dot2c_f32_bf16 v64, s58, v20
    v_dot2c_f32_bf16 v65, s59, v20
    v_dot2c_f32_bf16 v66, s58, v21
    v_dot2c_f32_bf16 v67, s59, v21
    v_dot2c_f32_bf16 v68, s58, v22
    v_dot2c_f32_bf16 v69, s59, v22
    v_dot2c_f32_bf16 v70, s58, v23
    v_dot2c_f32_bf16 v71, s59, v23
    s_bitset0_b32 s63, s15
    s_cmp_eq_u32 s63, 0
    s_cbranch_scc1 L_pgd
L_pn3:
    s_cmp_eq_u32 s62, 4
    s_cbranch_scc1 L_prb
    v_max3_u32 v3, v24, v25, v26
    v_max_u32 v3, v3, v27
    v_cmp_eq_u32 vcc, -1, v3
    s_cbranch_vccnz L_pn4
L_pgot4:
    v_dot2c_f32_bf16 v64, s58, v24
    v_dot2c_f32_bf16 v65, s59, v24
    v_dot2c_f32_bf16 v66, s58, v25
    v_dot2c_f32_bf16 v67, s59, v25
    v_dot2c_f32_bf16 v68, s58, v26
    v_dot2c_f32_bf16 v69, s59, v26
    v_dot2c_f32_bf16 v70, s58, v27
    v_dot2c_f32_bf16 v71, s59, v27
    s_bitset0_b32 s63, s16
    s_cmp_eq_u32 s63, 0
    s_cbranch_scc1 L_pgd
L_pn4:
    s_cmp_eq_u32 s62, 5
    s_cbranch_scc1 L_prb
    v_max3_u32 v3, v28, v29, v30
    v_max_u32 v3, v3, v31
    v_cmp_eq_u32 vcc, -1, v3
    s_cbranch_vccnz L_pn5
L_pgot5:
    v_dot2c_f32_bf16 v64, s58, v28
    v_dot2c_f32_bf16 v65, s59, v28
    v_dot2c_f32_bf16 v66, s58, v29
    v_dot2c_f32_bf16 v67, s59, v29
    v_dot2c_f32_bf16 v68, s58, v30
    v_dot2c_f32_bf16 v69, s59, v30
    v_dot2c_f32_bf16 v70, s58, v31
    v_dot2c_f32_bf16 v71, s59, v31
    s_bitset0_b32 s63, s17
    s_cmp_eq_u32 s63, 0
    s_cbranch_scc1 L_pgd
L_pn5:
    s_cmp_eq_u32 s62, 6
    s_cbranch_scc1 L_prb
    v_max3_u32 v3, v32, v33, v34
    v_max_u32 v3, v3, v35
    v_cmp_eq_u32 vcc, -1, v3
    s_cbranch_vccnz L_pn6
L_pgot6:
    v_dot2c_f32_bf16 v64, s58, v32
    v_dot2c_f32_bf16 v65, s59, v32
    v_dot2c_f32_bf16 v66, s58, v33
    v_dot2c_f32_bf16 v67, s59, v33
    v_dot2c_f32_bf16 v68, s58, v34
    v_dot2c_f32_bf16 v69, s59, v34
    v_dot2c_f32_bf16 v70, s58, v35
    v_dot2c_f32_bf16 v71, s59, v35
    s_bitset0_b32 s63, s18
    s_cmp_eq_u32 s63, 0
    s_cbranch_scc1 L_pgd
L_pn6:
    s_cmp_eq_u32 s62, 7
    s_cbranch_scc1 L_prb
    v_max3_u32 v3, v36, v37, v38
    v_max_u32 v3, v3, v39
    v_cmp_eq_u32 vcc, -1, v3
    s_cbranch_vccnz L_pn7
L_pgot7:
    v_dot2c_f32_bf16 v64, s58, v36
    v_dot2c_f32_bf16 v65, s59, v36
    v_dot2c_f32_bf16 v66, s58, v37
    v_dot2c_f32_bf16 v67, s59, v37
    v_dot2c_f32_bf16 v68, s58, v38
    v_dot2c_f32_bf16 v69, s59, v38
    v_dot2c_f32_bf16 v70, s58, v39
    v_dot2c_f32_bf16 v71, s59, v39
    s_bitset0_b32 s63, s19
    s_cmp_eq_u32 s63, 0
    s_cbranch_scc1 L_pgd
L_pn7:
    s_branch L_prb
L_pi1:
L_poll_129:
    buffer_load_dwordx4 v[8:11], v5, s[40:43], s4 offen sc1
    s_sub_u32 s60, s60, 1
    s_cbranch_scc1 L_poll_129t
    s_waitcnt vmcnt(0)
    v_max3_u32 v3, v8, v9, v10
    v_max_u32 v3, v3, v11
    v_cmp_eq_u32 vcc, -1, v3
    s_cbranch_vccnz L_poll_129
L_poll_129e:
    v_dot2c_f32_bf16 v64, s58, v8
    v_dot2c_f32_bf16 v65, s59, v8
    v_dot2c_f32_bf16 v66, s58, v9
    v_dot2c_f32_bf16 v67, s59, v9
    v_dot2c_f32_bf16 v68, s58, v10
    v_dot2c_f32_bf16 v69, s59, v10
    v_dot2c_f32_bf16 v70, s58, v11
    v_dot2c_f32_bf16 v71, s59, v11
L_pgd:
    v_pk_fma_f32 v[64:65], v[64:65], v[48:49], v[40:41]
    v_pk_fma_f32 v[66:67], v[66:67], v[50:51], v[42:43]
    v_pk_fma_f32 v[68:69], v[68:69], v[52:53], v[44:45]
    v_pk_fma_f32 v[70:71], v[70:71], v[54:55], v[46:47]
    v_pk_mul_f32 v[56:57], v[64:65], v[56:57]
    v_pk_mul_f32 v[58:59], v[66:67], v[58:59]
    v_pk_mul_f32 v[60:61], v[68:69], v[60:61]
    v_pk_mul_f32 v[62:63], v[70:71], v[62:63]
    v_cvt_pk_bf16_f32 v8, v56, v57
    v_cvt_pk_bf16_f32 v9, v58, v59
    v_cvt_pk_bf16_f32 v10, v60, v61
    v_cvt_pk_bf16_f32 v11, v62, v63
    ds_write_b128 v4, v[8:11]
    v_pk_add_f32 v[40:41], v[64:65], v[66:67]
    v_pk_add_f32 v[42:43], v[68:69], v[70:71]
    v_pk_mul_f32 v[44:45], v[64:65], v[64:65]
    v_pk_mul_f32 v[46:47], v[66:67], v[66:67]
    v_pk_add_f32 v[40:41], v[40:41], v[42:43]
    v_pk_fma_f32 v[44:45], v[68:69], v[68:69], v[44:45]
    v_pk_fma_f32 v[46:47], v[70:71], v[70:71], v[46:47]
    v_add_f32 v40, v40, v41
    v_pk_add_f32 v[44:45], v[44:45], v[46:47]
    v_add_f32 v41, v44, v45
    ds_write_b64 v7, v[40:41]
    s_waitcnt lgkmcnt(0)
    s_barrier
    v_mov_b32 v16, 0
    v_mov_b32 v17, 0
    v_mov_b32 v18, 0
    v_mov_b32 v19, 0
    v_mov_b32 v20, 0
    v_mov_b32 v21, 0
    v_mov_b32 v22, 0
    v_mov_b32 v23, 0
    v_mov_b32 v24, 0
    v_mov_b32 v25, 0
    v_mov_b32 v26, 0
    v_mov_b32 v27, 0
    v_mov_b32 v28, 0
    v_mov_b32 v29, 0
    v_mov_b32 v30, 0
    v_mov_b32 v31, 0
    v_mov_b32 v32, 0
    v_mov_b32 v33, 0
    v_mov_b32 v34, 0
    v_mov_b32 v35, 0
    ds_write_b128 v6, v[64:67]
    ds_write_b128 v6, v[68:71] offset:16
    s_waitcnt lgkmcnt(0)
    s_cmp_lg_u32 s3, 7
    s_cbranch_scc1 L_ffn2
    s_cmp_lt_u32 s35, 20
    s_cbranch_scc1 L_fin
    s_endpgm
L_ffn1:
    s_barrier
L_ffn1b:
    ds_read_b128 v[8:11], v79
    ds_read_b64 v[30:31], v81 offset:0
    ds_read_b64 v[32:33], v81 offset:512
    ds_read_b64 v[34:35], v81 offset:1024
    ds_read_b64 v[36:37], v81 offset:1536
    ds_read_b64 v[38:39], v81 offset:2048
    ds_read_b128 v[12:15], v79 offset:256
    ds_read_b128 v[16:19], v79 offset:512
    ds_read_b128 v[20:23], v79 offset:768
    ds_read_b128 v[24:27], v79 offset:1024
    s_waitcnt lgkmcnt(9)
    v_smfmac_f32_16x16x64_bf16 v[52:55], v[8:11], v[88:95], v87
    v_smfmac_f32_16x16x64_bf16 v[56:59], v[8:11], v[96:103], v87
    s_waitcnt lgkmcnt(3)
    v_smfmac_f32_16x16x64_bf16 v[52:55], v[12:15], v[104:111], v87
    v_pk_add_f32 v[30:31], v[30:31], v[32:33]
    v_pk_add_f32 v[34:35], v[34:35], v[36:37]
    v_smfmac_f32_16x16x64_bf16 v[56:59], v[12:15], v[112:119], v87
    v_pk_add_f32 v[30:31], v[30:31], v[38:39]
    v_pk_add_f32 v[30:31], v[30:31], v[34:35]
    s_waitcnt lgkmcnt(2)
    v_smfmac_f32_16x16x64_bf16 v[52:55], v[16:19], v[120:127], v87
    v_add_f32_dpp v30, v30, v30 quad_perm:[1,0,3,2] row_mask:0xf bank_mask:0xf
    v_add_f32_dpp v31, v31, v31 quad_perm:[1,0,3,2] row_mask:0xf bank_mask:0xf
    v_smfmac_f32_16x16x64_bf16 v[56:59], v[16:19], v[128:135], v87
    v_add_f32_dpp v30, v30, v30 quad_perm:[2,3,0,1] row_mask:0xf bank_mask:0xf
    v_add_f32_dpp v31, v31, v31 quad_perm:[2,3,0,1] row_mask:0xf bank_mask:0xf
    s_waitcnt lgkmcnt(1)
    v_smfmac_f32_16x16x64_bf16 v[52:55], v[20:23], v[136:143], v87
    v_add_f32_dpp v30, v30, v30 row_ror:4 row_mask:0xf bank_mask:0xf
    v_add_f32_dpp v31, v31, v31 row_ror:4 row_mask:0xf bank_mask:0xf
    v_smfmac_f32_16x16x64_bf16 v[56:59], v[20:23], v[144:151], v87
    v_add_f32_dpp v30, v30, v30 row_ror:8 row_mask:0xf bank_mask:0xf
    v_add_f32_dpp v31, v31, v31 row_ror:8 row_mask:0xf bank_mask:0xf
    s_waitcnt lgkmcnt(0)
    v_smfmac_f32_16x16x64_bf16 v[52:55], v[24:27], v[152:159], v87
    v_mul_f32 v48, s62, v30
    v_mul_f32 v49, s62, v31
    v_smfmac_f32_16x16x64_bf16 v[56:59], v[24:27], v[160:167], v87
    v_mul_f32 v7, v84, v48
    v_fma_f32 v49, -v48, v48, -v49
    v_max_f32 v49, 0, v49
    v_add_f32 v49, 0x3727c5ac, v49
    v_rsq_f32 v49, v49
    v_add_f32 v4, v52, v53
    v_add_f32 v4, v4, v7
    s_nop 0
    v_add_f32 v5, v58, v59
    v_add_f32 v4, v4, v5
    v_fma_f32 v4, v4, v49, v85
    v_mul_f32 v5, v4, v4
    v_fma_f32 v5, v5, s63, v86
    v_mul_f32 v5, v5, v4
    v_exp_f32 v5, v5
    s_nop 0
    v_add_f32 v5, 1.0, v5
    v_rcp_f32 v5, v5
    s_nop 0
    v_mul_f32 v4, v4, v5
    v_cvt_pk_bf16_f32 v4, v4, v4
    ds_write_b16 v80, v4
    s_waitcnt lgkmcnt(0)
    s_barrier
    s_endpgm
L_cut:
L_h_t1:
    s_sub_u32 s63, s56, 154
    s_cmp_lt_u32 s63, 16
    s_cbranch_scc0 L_h_noclr
    s_lshl2_add_u32 s62, s63, s3
    s_mul_i32 s62, s62, 4608
    v_mov_b32 v4, -1
    v_mov_b32 v5, -1
    v_mov_b32 v6, -1
    v_mov_b32 v7, -1
    v_lshlrev_b32 v8, 4, v0
    buffer_store_dwordx4 v[4:7], v8, s[40:43], s62 offen offset:0 sc1
    buffer_store_dwordx4 v[4:7], v8, s[40:43], s62 offen offset:1024 sc1
    buffer_store_dwordx4 v[4:7], v8, s[40:43], s62 offen offset:2048 sc1
    buffer_store_dwordx4 v[4:7], v8, s[40:43], s62 offen offset:3072 sc1
    s_add_u32 s62, s62, 4096
    s_bfm_b64 exec, 32, 0
    buffer_store_dwordx4 v[4:7], v8, s[40:43], s62 offen offset:0 sc1
    s_mov_b64 exec, 1
    v_mov_b32 v9, 162100
    v_mov_b32 v10, 1
    s_and_b32 s62, s63, 1
    s_mul_i32 s62, s62, 126
    s_lshl1_add_u32 s63, s63, s62
    s_waitcnt vmcnt(0)
    ds_add_rtn_u32 v10, v9, v10
    s_waitcnt lgkmcnt(0)
    v_readfirstlane_b32 s62, v10
    s_nop 0
    s_cmp_lg_u32 s62, 3
    s_cbranch_scc1 L_h_clrd
    buffer_store_dword v4, v36, s[44:47], s63 offen sc1
L_h_clrd:
    s_mov_b64 exec, -1
L_h_noclr:
    v_lshrrev_b32 v1, 3, v0
    v_mul_u32_u24 v1, 1280, v1
    v_and_b32 v2, 7, v0
    v_lshl_add_u32 v1, v2, 4, v1
    s_lshl2_add_u32 s63, s34, s3
    s_mul_i32 s63, s63, 163840
    s_lshl_b32 s62, s35, 7
    s_add_u32 s63, s63, s62
    s_sub_u32 s63, s63, 2816
    s_lshl_b32 s62, s3, 14
    s_add_u32 s62, s62, 81920
    s_mov_b32 m0, s62
    s_mov_b32 s48, s12
    s_mov_b32 s49, s13
    s_mov_b32 s50, 5242880
    s_mov_b32 s51, 0x20000
    s_add_u32 s100, s39, 1
    s_mov_b32 s62, 8
L_dma_5:
    buffer_load_dwordx4 v1, s[48:51], s63 offen nt lds
    s_add_u32 m0, m0, 1024
    s_add_u32 s63, s63, 10240
    s_cmp_eq_u32 s100, 0
    s_cbranch_scc1 L_dma_5n0
    s_waitcnt vmcnt(7)
    s_cmp_eq_u32 s100, 2
    s_cbranch_scc1 L_dma_5n0
    s_waitcnt vmcnt(5)
L_dma_5n0:
    buffer_load_dwordx4 v1, s[48:51], s63 offen nt lds
    s_add_u32 m0, m0, 1024
    s_add_u32 s63, s63, 10240
    s_cmp_eq_u32 s100, 0
    s_cbranch_scc1 L_dma_5n1
    s_waitcnt vmcnt(7)
    s_cmp_eq_u32 s100, 2
    s_cbranch_scc1 L_dma_5n1
    s_waitcnt vmcnt(5)
L_dma_5n1:
    s_sub_u32 s62, s62, 1
    s_cmp_lg_u32 s62, 0
    s_cbranch_scc1 L_dma_5
    s_cmp_eq_u32 s39, 1
    s_cbranch_scc1 L_h_role
    s_barrier
    s_waitcnt vmcnt(0)
    v_mov_b32 v4, 162060
    v_mov_b32 v5, 1
    s_mov_b64 exec, 1
    ds_add_u32 v4, v5
    s_mov_b64 exec, -1
    s_cmp_eq_u32 s3, 0
    s_cbranch_scc1 L_service
    s_endpgm
L_h_role:
    v_mov_b32 v72, 0
    v_mov_b32 v73, 0
    v_mov_b32 v74, 0
    v_mov_b32 v75, 0
    v_mov_b32 v76, 0
    v_lshrrev_b32 v3, 4, v0
    v_and_b32 v2, 3, v0
    v_bfe_u32 v1, v0, 2, 2
    v_mul_u32_u24 v160, 1280, v3
    v_and_b32 v4, 15, v0
    v_lshl_add_u32 v163, v4, 2, v160
    v_lshl_add_u32 v160, v4, 3, v160
    s_mul_i32 s57, s35, 5120
    s_mul_i32 s62, s3, 320
    s_add_u32 s57, s57, s62
    s_add_u32 s57, s57, 327680
    s_mov_b32 s48, s20
    s_mov_b32 s49, s21
    s_mov_b32 s50, 2211840
    s_mov_b32 s51, 0x20000
    s_and_b32 s96, s3, 1
    s_lshl_b32 s97, s96, 6
    s_xor_b32 s96, s96, 1
    s_lshl_b32 s96, s96, 8
    v_add_u32 v160, s97, v160
    v_add_u32 v163, s96, v163
    v_lshrrev_b32 v8, 5, v0
    v_lshlrev_b32 v8, 2, v8
    v_bfe_u32 v9, v0, 4, 1
    v_add_u32 v8, v8, v9
    v_mul_u32_u24 v8, 5120, v8
    v_lshl_add_u32 v9, v4, 2, v8
    v_lshl_add_u32 v8, v4, 3, v8
    v_add_u32 v9, s96, v9
    v_add_u32 v8, s97, v8
    s_mul_i32 s63, s35, 81920
    s_add_u32 s63, s63, s62
    buffer_load_dwordx2 v[16:17], v8, s[48:51], s63 offen offset:0 nt
    buffer_load_dwordx2 v[48:49], v8, s[48:51], s63 offen offset:128 nt
    buffer_load_dword v80, v9, s[48:51], s63 offen offset:0 nt
    buffer_load_dwordx2 v[18:19], v8, s[48:51], s63 offen offset:1280 nt
    buffer_load_dwordx2 v[50:51], v8, s[48:51], s63 offen offset:1408 nt
    buffer_load_dword v81, v9, s[48:51], s63 offen offset:1280 nt
    buffer_load_dwordx2 v[24:25], v8, s[48:51], s63 offen offset:2560 nt
    buffer_load_dwordx2 v[56:57], v8, s[48:51], s63 offen offset:2688 nt
    buffer_load_dword v84, v9, s[48:51], s63 offen offset:2560 nt
    buffer_load_dwordx2 v[26:27], v8, s[48:51], s63 offen offset:3840 nt
    buffer_load_dwordx2 v[58:59], v8, s[48:51], s63 offen offset:3968 nt
    buffer_load_dword v85, v9, s[48:51], s63 offen offset:3840 nt
    s_add_u32 s63, s63, 10240
    buffer_load_dwordx2 v[20:21], v8, s[48:51], s63 offen offset:0 nt
    buffer_load_dwordx2 v[52:53], v8, s[48:51], s63 offen offset:128 nt
    buffer_load_dword v82, v9, s[48:51], s63 offen offset:0 nt
    buffer_load_dwordx2 v[22:23], v8, s[48:51], s63 offen offset:1280 nt
    s_waitcnt vmcnt(15)
    buffer_load_dwordx2 v[54:55], v8, s[48:51], s63 offen offset:1408 nt
    s_waitcnt vmcnt(15)
    buffer_load_dword v83, v9, s[48:51], s63 offen offset:1280 nt
    s_waitcnt vmcnt(15)
    buffer_load_dwordx2 v[28:29], v8, s[48:51], s63 offen offset:2560 nt
    s_waitcnt vmcnt(15)
    buffer_load_dwordx2 v[60:61], v8, s[48:51], s63 offen offset:2688 nt
    s_waitcnt vmcnt(15)
    buffer_load_dword v86, v9, s[48:51], s63 offen offset:2560 nt
    s_waitcnt vmcnt(15)
    buffer_load_dwordx2 v[30:31], v8, s[48:51], s63 offen offset:3840 nt
    s_waitcnt vmcnt(15)
    buffer_load_dwordx2 v[62:63], v8, s[48:51], s63 offen offset:3968 nt
    s_waitcnt vmcnt(15)
    buffer_load_dword v87, v9, s[48:51], s63 offen offset:3840 nt
    s_add_u32 s63, s63, 30720
    s_waitcnt vmcnt(15)
    buffer_load_dwordx2 v[32:33], v8, s[48:51], s63 offen offset:0 nt
    s_waitcnt vmcnt(15)
    buffer_load_dwordx2 v[64:65], v8, s[48:51], s63 offen offset:128 nt
    s_waitcnt vmcnt(15)
    buffer_load_dword v88, v9, s[48:51], s63 offen offset:0 nt
    s_waitcnt vmcnt(15)
    buffer_load_dwordx2 v[34:35], v8, s[48:51], s63 offen offset:1280 nt
    s_waitcnt vmcnt(15)
    buffer_load_dwordx2 v[66:67], v8, s[48:51], s63 offen offset:1408 nt
    s_waitcnt vmcnt(15)
    buffer_load_dword v89, v9, s[48:51], s63 offen offset:1280 nt
    s_waitcnt vmcnt(15)
    buffer_load_dwordx2 v[40:41], v8, s[48:51], s63 offen offset:2560 nt
    s_waitcnt vmcnt(15)
    buffer_load_dwordx2 v[72:73], v8, s[48:51], s63 offen offset:2688 nt
    s_waitcnt vmcnt(15)
    buffer_load_dword v92, v9, s[48:51], s63 offen offset:2560 nt
    s_waitcnt vmcnt(15)
    buffer_load_dwordx2 v[42:43], v8, s[48:51], s63 offen offset:3840 nt
    s_waitcnt vmcnt(15)
    buffer_load_dwordx2 v[74:75], v8, s[48:51], s63 offen offset:3968 nt
    s_waitcnt vmcnt(15)
    buffer_load_dword v93, v9, s[48:51], s63 offen offset:3840 nt
    s_add_u32 s63, s63, 10240
    s_waitcnt vmcnt(15)
    buffer_load_dwordx2 v[36:37], v8, s[48:51], s63 offen offset:0 nt
    s_waitcnt vmcnt(15)
    buffer_load_dwordx2 v[68:69], v8, s[48:51], s63 offen offset:128 nt
    s_waitcnt vmcnt(15)
    buffer_load_dword v90, v9, s[48:51], s63 offen offset:0 nt
    s_waitcnt vmcnt(15)
    buffer_load_dwordx2 v[38:39], v8, s[48:51], s63 offen offset:1280 nt
    s_waitcnt vmcnt(15)
    buffer_load_dwordx2 v[70:71], v8, s[48:51], s63 offen offset:1408 nt
    s_waitcnt vmcnt(15)
    buffer_load_dword v91, v9, s[48:51], s63 offen offset:1280 nt
    s_waitcnt vmcnt(15)
    buffer_load_dwordx2 v[44:45], v8, s[48:51], s63 offen offset:2560 nt
    s_waitcnt vmcnt(15)
    buffer_load_dwordx2 v[76:77], v8, s[48:51], s63 offen offset:2688 nt
    s_waitcnt vmcnt(15)
    buffer_load_dword v94, v9, s[48:51], s63 offen offset:2560 nt
    s_waitcnt vmcnt(15)
    buffer_load_dwordx2 v[46:47], v8, s[48:51], s63 offen offset:3840 nt
    s_waitcnt vmcnt(15)
    buffer_load_dwordx2 v[78:79], v8, s[48:51], s63 offen offset:3968 nt
    s_waitcnt vmcnt(15)
    buffer_load_dword v95, v9, s[48:51], s63 offen offset:3840 nt
    s_barrier
    s_mov_b32 s48, s16
    s_mov_b32 s49, s17
    s_mov_b32 s50, 2211840
    s_mov_b32 s51, 0x20000
    s_lshl_b32 s98, s35, 7
    s_mov_b32 s99, 3456
    v_lshrrev_b32 v12, 3, v0
    v_mul_lo_u32 v10, v12, s99
    v_and_b32 v12, 2, v12
    v_xor_b32 v12, v12, v0
    v_and_b32 v12, 7, v12
    v_lshl_add_u32 v10, v12, 4, v10
    v_add_u32 v10, s98, v10
    v_xor_b32 v11, 64, v10
    s_mul_i32 s63, s3, 552960
    s_mov_b32 m0, s101
    s_waitcnt lgkmcnt(0)
    s_cmp_ge_u32 s35, 22
    s_cselect_b32 s100, 2, 1
    s_mov_b32 s62, 10
L_dma_6:
    buffer_load_dwordx4 v10, s[48:51], s63 offen nt lds
    s_add_u32 m0, m0, 1024
    s_add_u32 s63, s63, 27648
    s_cmp_eq_u32 s100, 0
    s_cbranch_scc1 L_dma_6n0
    s_waitcnt vmcnt(7)
    s_cmp_eq_u32 s100, 2
    s_cbranch_scc1 L_dma_6n0
    s_waitcnt vmcnt(7)
L_dma_6n0:
    buffer_load_dwordx4 v11, s[48:51], s63 offen nt lds
    s_add_u32 m0, m0, 1024
    s_add_u32 s63, s63, 27648
    s_cmp_eq_u32 s100, 0
    s_cbranch_scc1 L_dma_6n1
    s_waitcnt vmcnt(7)
    s_cmp_eq_u32 s100, 2
    s_cbranch_scc1 L_dma_6n1
    s_waitcnt vmcnt(7)
L_dma_6n1:
    s_sub_u32 s62, s62, 1
    s_cmp_lg_u32 s62, 0
    s_cbranch_scc1 L_dma_6
    s_waitcnt vmcnt(20)
    v_mov_b32 v4, 162060
    v_mov_b32 v5, 1
    s_mov_b64 exec, 1
    ds_add_u32 v4, v5
    s_mov_b64 exec, -1
    s_mov_b32 s62, 0x05040100
    s_mov_b32 s63, 0x07060302
    v_perm_b32 v144, v81, v80, s62
    v_perm_b32 v152, v81, v80, s63
    v_perm_b32 v145, v83, v82, s62
    v_perm_b32 v153, v83, v82, s63
    v_perm_b32 v146, v85, v84, s62
    v_perm_b32 v154, v85, v84, s63
    v_perm_b32 v147, v87, v86, s62
    v_perm_b32 v155, v87, v86, s63
    v_perm_b32 v148, v89, v88, s62
    v_perm_b32 v156, v89, v88, s63
    v_perm_b32 v149, v91, v90, s62
    v_perm_b32 v157, v91, v90, s63
    v_perm_b32 v150, v93, v92, s62
    v_perm_b32 v158, v93, v92, s63
    v_perm_b32 v151, v95, v94, s62
    v_perm_b32 v159, v95, v94, s63
    v_perm_b32 v80, v18, v16, s62
    v_perm_b32 v88, v18, v16, s63
    v_perm_b32 v96, v19, v17, s62
    v_perm_b32 v104, v19, v17, s63
    v_perm_b32 v81, v22, v20, s62
    v_perm_b32 v89, v22, v20, s63
    v_perm_b32 v97, v23, v21, s62
    v_perm_b32 v105, v23, v21, s63
    v_perm_b32 v82, v26, v24, s62
    v_perm_b32 v90, v26, v24, s63
    v_perm_b32 v98, v27, v25, s62
    v_perm_b32 v106, v27, v25, s63
    v_perm_b32 v83, v30, v28, s62
    v_perm_b32 v91, v30, v28, s63
    v_perm_b32 v99, v31, v29, s62
    v_perm_b32 v107, v31, v29, s63
    v_perm_b32 v84, v34, v32, s62
    v_perm_b32 v92, v34, v32, s63
    v_perm_b32 v100, v35, v33, s62
    v_perm_b32 v108, v35, v33, s63
    v_perm_b32 v85, v38, v36, s62
    v_perm_b32 v93, v38, v36, s63
    v_perm_b32 v101, v39, v37, s62
    v_perm_b32 v109, v39, v37, s63
    v_perm_b32 v86, v42, v40, s62
    v_perm_b32 v94, v42, v40, s63
    v_perm_b32 v102, v43, v41, s62
    v_perm_b32 v110, v43, v41, s63
    v_perm_b32 v87, v46, v44, s62
    v_perm_b32 v95, v46, v44, s63
    v_perm_b32 v103, v47, v45, s62
    v_perm_b32 v111, v47, v45, s63
    v_perm_b32 v112, v50, v48, s62
    v_perm_b32 v120, v50, v48, s63
    v_perm_b32 v128, v51, v49, s62
    v_perm_b32 v136, v51, v49, s63
    v_perm_b32 v113, v54, v52, s62
    v_perm_b32 v121, v54, v52, s63
    v_perm_b32 v129, v55, v53, s62
    v_perm_b32 v137, v55, v53, s63
    v_perm_b32 v114, v58, v56, s62
    v_perm_b32 v122, v58, v56, s63
    v_perm_b32 v130, v59, v57, s62
    v_perm_b32 v138, v59, v57, s63
    v_perm_b32 v115, v62, v60, s62
    v_perm_b32 v123, v62, v60, s63
    v_perm_b32 v131, v63, v61, s62
    v_perm_b32 v139, v63, v61, s63
    v_perm_b32 v116, v66, v64, s62
    v_perm_b32 v124, v66, v64, s63
    v_perm_b32 v132, v67, v65, s62
    v_perm_b32 v140, v67, v65, s63
    v_perm_b32 v117, v70, v68, s62
    v_perm_b32 v125, v70, v68, s63
    v_perm_b32 v133, v71, v69, s62
    v_perm_b32 v141, v71, v69, s63
    v_perm_b32 v118, v74, v72, s62
    v_perm_b32 v126, v74, v72, s63
    v_perm_b32 v134, v75, v73, s62
    v_perm_b32 v142, v75, v73, s63
    v_perm_b32 v119, v78, v76, s62
    v_perm_b32 v127, v78, v76, s63
    v_perm_b32 v135, v79, v77, s62
    v_perm_b32 v143, v79, v77, s63
    v_mov_b32 v8, 162068
L_lw_7:
    ds_read_b32 v9, v8
    s_waitcnt lgkmcnt(0)
    v_cmp_gt_u32 vcc, 1, v9
    s_cbranch_vccz L_lw_7e
    s_sleep 8
    s_sub_u32 s60, s60, 1
    s_cbranch_scc0 L_lw_7
    s_mov_b32 s60, 0
L_lw_7e:
    s_cmp_lg_u32 s3, 3
    s_cbranch_scc1 L_h_nomo
    v_and_b32 v4, 15, v0
    v_lshlrev_b32 v4, 4, v4
    v_mul_u32_u24 v5, 1280, v3
    v_add_u32 v5, v5, v4
    v_mul_u32_u24 v6, 1296, v3
    v_add_u32 v6, v6, v4
    v_add_u32 v6, 147456, v6
    s_mov_b32 s62, 30720
    s_mov_b32 s63, 25600
    s_branch L_poll_8
L_poll_8s:
    s_sleep 8
L_poll_8:
    buffer_load_dwordx4 v[40:43], v5, s[40:43], s62 offen offset:0 sc1
    buffer_load_dwordx4 v[44:47], v5, s[40:43], s62 offen offset:256 sc1
    buffer_load_dwordx4 v[48:51], v5, s[40:43], s62 offen offset:512 sc1
    buffer_load_dwordx4 v[52:55], v5, s[40:43], s62 offen offset:768 sc1
    buffer_load_dwordx4 v[56:59], v5, s[40:43], s62 offen offset:1024 sc1
    buffer_load_dwordx4 v[60:63], v5, s[40:43], s63 offen offset:0 sc1
    buffer_load_dwordx4 v[64:67], v5, s[40:43], s63 offen offset:256 sc1
    buffer_load_dwordx4 v[68:71], v5, s[40:43], s63 offen offset:512 sc1
    buffer_load_dwordx4 v[72:75], v5, s[40:43], s63 offen offset:768 sc1
    buffer_load_dwordx4 v[76:79], v5, s[40:43], s63 offen offset:1024 sc1
    s_sub_u32 s60, s60, 1
    s_cbranch_scc1 L_poll_8t
    s_waitcnt vmcnt(0)
    v_max3_u32 v7, v40, v41, v42
    v_max3_u32 v7, v7, v43, v44
    v_max3_u32 v7, v7, v45, v46
    v_max3_u32 v7, v7, v47, v48
    v_max3_u32 v7, v7, v49, v50
    v_max3_u32 v7, v7, v51, v52
    v_max3_u32 v7, v7, v53, v54
    v_max3_u32 v7, v7, v55, v56
    v_max3_u32 v7, v7, v57, v58
    v_max3_u32 v7, v7, v59, v60
    v_max3_u32 v7, v7, v61, v62
    v_max3_u32 v7, v7, v63, v64
    v_max3_u32 v7, v7, v65, v66
    v_max3_u32 v7, v7, v67, v68
    v_max3_u32 v7, v7, v69, v70
    v_max3_u32 v7, v7, v71, v72
    v_max3_u32 v7, v7, v73, v74
    v_max3_u32 v7, v7, v75, v76
    v_max3_u32 v7, v7, v77, v78
    v_max_u32 v7, v7, v79
    v_cmp_eq_u32 vcc, -1, v7
    s_cbranch_vccnz L_poll_8s
L_poll_8e:
    ds_write_b128 v6, v[40:43] offset:0
    ds_write_b128 v6, v[44:47] offset:256
    ds_write_b128 v6, v[48:51] offset:512
    ds_write_b128 v6, v[52:55] offset:768
    ds_write_b128 v6, v[56:59] offset:1024
    ds_write_b128 v6, v[60:63] offset:5184
    ds_write_b128 v6, v[64:67] offset:5440
    ds_write_b128 v6, v[68:71] offset:5696
    ds_write_b128 v6, v[72:75] offset:5952
    ds_write_b128 v6, v[76:79] offset:6208
L_h_nomo:
    v_mul_u32_u24 v4, 144, v1
    v_lshl_add_u32 v4, v3, 5, v4
    v_bfe_u32 v5, v0, 1, 1
    v_lshl_add_u32 v4, v5, 4, v4
    v_add_u32 v4, 90688, v4
    v_mov_b32 v5, 162112
    v_and_b32 v6, 1, v0
    v_cmp_eq_u32 vcc, 0, v6
    s_nop 1
    v_cndmask_b32 v161, v5, v4, vcc
    v_cndmask_b32 v162, v4, v5, vcc
    v_bfe_u32 v164, v0, 1, 1
    v_mul_u32_u24 v164, 0xaaaa, v164
    v_add_u32 v164, 0x4444, v164
    s_mov_b32 s100, s3
    s_lshl_b32 s63, s100, 8
    v_and_b32 v8, 15, v0
    v_lshl_add_u32 v8, v8, 4, s63
    v_lshrrev_b32 v9, 4, v0
    v_mul_u32_u24 v5, 1280, v9
    v_add_u32 v5, v5, v8
    v_mul_u32_u24 v4, 1296, v9
    v_add_u32 v4, v4, v8
    v_add_u32 v4, 82944, v4
    v_lshlrev_b32 v6, 1, v5
    v_add_u32 v6, 99328, v6
    s_lshl_b32 s62, s100, 9
    s_add_u32 s62, s62, 88128
    v_lshl_add_u32 v7, v0, 3, s62
    s_mov_b32 s48, s4
    s_mov_b32 s49, s5
    s_mov_b32 s50, 5120
    s_mov_b32 s51, 0x20000
    buffer_load_dwordx4 v[8:11], v5, s[48:51], 0 offen
    s_mov_b32 s62, 20480
    s_mov_b32 s63, 30720
    s_branch L_poll_9
L_poll_9s:
    s_sleep 8
L_poll_9:
    buffer_load_dwordx4 v[12:15], v5, s[40:43], s62 offen sc1
    buffer_load_dwordx4 v[16:19], v5, s[40:43], s63 offen sc1
    s_sub_u32 s60, s60, 1
    s_cbranch_scc1 L_poll_9t
    s_waitcnt vmcnt(0)
    v_max3_u32 v38, v12, v13, v14
    v_max3_u32 v38, v38, v15, v16
    v_max3_u32 v38, v38, v17, v18
    v_max_u32 v38, v38, v19
    v_cmp_eq_u32 vcc, -1, v38
    s_cbranch_vccnz L_poll_9s
L_poll_9e:
    v_lshlrev_b32 v40, 16, v8
    v_and_b32 v41, 0xffff0000, v8
    v_lshlrev_b32 v42, 16, v9
    v_and_b32 v43, 0xffff0000, v9
    v_lshlrev_b32 v44, 16, v10
    v_and_b32 v45, 0xffff0000, v10
    v_lshlrev_b32 v46, 16, v11
    v_and_b32 v47, 0xffff0000, v11
    v_lshlrev_b32 v48, 16, v12
    v_and_b32 v49, 0xffff0000, v12
    v_lshlrev_b32 v50, 16, v13
    v_and_b32 v51, 0xffff0000, v13
    v_lshlrev_b32 v52, 16, v14
    v_and_b32 v53, 0xffff0000, v14
    v_lshlrev_b32 v54, 16, v15
    v_and_b32 v55, 0xffff0000, v15
    v_lshlrev_b32 v56, 16, v16
    v_and_b32 v57, 0xffff0000, v16
    v_lshlrev_b32 v58, 16, v17
    v_and_b32 v59, 0xffff0000, v17
    v_lshlrev_b32 v60, 16, v18
    v_and_b32 v61, 0xffff0000, v18
    v_lshlrev_b32 v62, 16, v19
    v_and_b32 v63, 0xffff0000, v19
    v_mov_b32 v64, 0
    v_mov_b32 v65, 0
    v_mov_b32 v66, 0
    v_mov_b32 v67, 0
    v_mov_b32 v68, 0
    v_mov_b32 v69, 0
    v_mov_b32 v70, 0
    v_mov_b32 v71, 0
    v_bfe_u32 v5, v0, 2, 2
    v_lshlrev_b32 v5, 8, v5
    v_lshrrev_b32 v8, 4, v0
    v_lshl_add_u32 v5, v8, 6, v5
    v_and_b32 v8, 3, v0
    v_lshl_add_u32 v5, v8, 4, v5
    s_lshl_b32 s56, s100, 10
    s_waitcnt vmcnt(0) lgkmcnt(0)
    v_mov_b32 v8, 162064
    v_mov_b32 v9, 1
    s_mov_b64 exec, 1
    ds_add_u32 v8, v9
    s_mov_b64 exec, -1
    s_branch L_t2gate
L_ffn2:
    s_barrier
L_ffn2b:
    ds_read_b128 v[8:11], v161
    ds_read_b128 v[12:15], v162
    s_cmp_eq_u32 s61, 1
    s_cbranch_scc0 L_f2slow
    s_waitcnt lgkmcnt(1)
    v_smfmac_f32_16x16x64_bf16 v[16:19], v[8:11], v[80:87], v164
    v_smfmac_f32_16x16x64_bf16 v[20:23], v[8:11], v[96:103], v164
    s_waitcnt lgkmcnt(0)
    v_smfmac_f32_16x16x64_bf16 v[16:19], v[12:15], v[88:95], v164
    v_smfmac_f32_16x16x64_bf16 v[20:23], v[12:15], v[104:111], v164
    v_smfmac_f32_16x16x64_bf16 v[24:27], v[8:11], v[112:119], v164
    v_smfmac_f32_16x16x64_bf16 v[28:31], v[8:11], v[128:135], v164
    v_smfmac_f32_16x16x64_bf16 v[24:27], v[12:15], v[120:127], v164
    v_smfmac_f32_16x16x64_bf16 v[28:31], v[12:15], v[136:143], v164
    v_smfmac_f32_16x16x64_bf16 v[32:35], v[8:11], v[144:151], v164
    v_smfmac_f32_16x16x64_bf16 v[32:35], v[12:15], v[152:159], v164
    s_nop 0
    v_pk_add_f32 v[16:17], v[16:17], v[18:19]
    v_cvt_pk_bf16_f32 v40, v16, v17
    v_pk_add_f32 v[20:21], v[20:21], v[22:23]
    v_cvt_pk_bf16_f32 v41, v20, v21
    buffer_store_dwordx2 v[40:41], v160, s[40:43], s57 offen
    v_pk_add_f32 v[24:25], v[24:25], v[26:27]
    v_cvt_pk_bf16_f32 v42, v24, v25
    v_pk_add_f32 v[28:29], v[28:29], v[30:31]
    v_cvt_pk_bf16_f32 v43, v28, v29
    buffer_store_dwordx2 v[42:43], v160, s[40:43], s57 offen offset:128
    v_pk_add_f32 v[32:33], v[32:33], v[34:35]
    v_cvt_pk_bf16_f32 v44, v32, v33
    buffer_store_dword v44, v163, s[40:43], s57 offen
L_f2done:
    s_barrier
    s_endpgm
L_f2slow:
    s_waitcnt lgkmcnt(1)
    v_smfmac_f32_16x16x64_bf16 v[16:19], v[8:11], v[80:87], v164
    v_smfmac_f32_16x16x64_bf16 v[20:23], v[8:11], v[96:103], v164
    s_waitcnt lgkmcnt(0)
    v_smfmac_f32_16x16x64_bf16 v[16:19], v[12:15], v[88:95], v164
    v_smfmac_f32_16x16x64_bf16 v[20:23], v[12:15], v[104:111], v164
    v_smfmac_f32_16x16x64_bf16 v[24:27], v[8:11], v[112:119], v164
    v_smfmac_f32_16x16x64_bf16 v[28:31], v[8:11], v[128:135], v164
    v_smfmac_f32_16x16x64_bf16 v[24:27], v[12:15], v[120:127], v164
    v_smfmac_f32_16x16x64_bf16 v[28:31], v[12:15], v[136:143], v164
    v_smfmac_f32_16x16x64_bf16 v[32:35], v[8:11], v[144:151], v164
    v_smfmac_f32_16x16x64_bf16 v[32:35], v[12:15], v[152:159], v164
    s_nop 0
    v_pk_add_f32 v[16:17], v[16:17], v[18:19]
    v_cvt_pk_bf16_f32 v40, v16, v17
    v_pk_add_f32 v[20:21], v[20:21], v[22:23]
    v_cvt_pk_bf16_f32 v41, v20, v21
    buffer_store_dwordx2 v[40:41], v160, s[40:43], s57 offen sc1
    v_pk_add_f32 v[24:25], v[24:25], v[26:27]
    v_cvt_pk_bf16_f32 v42, v24, v25
    v_pk_add_f32 v[28:29], v[28:29], v[30:31]
    v_cvt_pk_bf16_f32 v43, v28, v29
    buffer_store_dwordx2 v[42:43], v160, s[40:43], s57 offen offset:128 sc1
    v_pk_add_f32 v[32:33], v[32:33], v[34:35]
    v_cvt_pk_bf16_f32 v44, v32, v33
    buffer_store_dword v44, v163, s[40:43], s57 offen sc1
    s_branch L_f2done
L_poll_3t:
    s_mov_b32 s60, 0
    s_waitcnt vmcnt(0)
    s_branch L_poll_3e
L_poll_8t:
    s_mov_b32 s60, 0
    s_waitcnt vmcnt(0)
    s_branch L_poll_8e
L_poll_9t:
    s_mov_b32 s60, 0
    s_waitcnt vmcnt(0)
    s_branch L_poll_9e
L_poll_102t:
    s_mov_b32 s60, 0
    s_waitcnt vmcnt(0)
    s_branch L_poll_102e
L_pfast:
    buffer_store_dword v12, v108, s[40:43], s101 offen
    buffer_store_dword v12, v110, s[40:43], s101 offen
    s_branch L_pdone
L_poll_104t:
    s_mov_b32 s60, 0
    s_waitcnt vmcnt(0)
    s_branch L_poll_104e
L_poll_106t:
    s_mov_b32 s60, 0
    s_waitcnt vmcnt(0)
    s_branch L_poll_106e
L_poll_109t:
    s_mov_b32 s60, 0
    s_waitcnt vmcnt(0)
    s_branch L_poll_109e
L_poll_111t:
    s_mov_b32 s60, 0
    s_waitcnt vmcnt(0)
    s_branch L_poll_111e
L_poll_115t:
    s_mov_b32 s60, 0
    s_waitcnt vmcnt(0)
    s_branch L_poll_115e
L_poll_117t:
    s_mov_b32 s60, 0
    s_waitcnt vmcnt(0)
    s_branch L_poll_117e
L_ycs:
    buffer_store_dwordx4 v[24:27], v22, s[40:43], 0 offen offset:0 sc1
    buffer_store_dwordx4 v[24:27], v22, s[40:43], 0 offen offset:1024 sc1
    buffer_store_dwordx4 v[24:27], v22, s[40:43], 0 offen offset:2048 sc1
    buffer_store_dwordx4 v[24:27], v22, s[40:43], 0 offen offset:3072 sc1
    buffer_store_dwordx4 v[24:27], v23, s[40:43], 0 offen offset:0 sc1
    s_branch L_ycd
L_poll_118t:
    s_mov_b32 s60, 0
    s_waitcnt vmcnt(0)
    s_branch L_poll_118e
L_poll_123t:
    s_mov_b32 s60, 0
    s_waitcnt vmcnt(0)
    s_branch L_poll_123e
L_poll_125t:
    s_mov_b32 s60, 0
    s_waitcnt vmcnt(0)
    s_branch L_poll_125e
L_ygt:
    s_waitcnt vmcnt(0)
    v_mfma_f32_16x16x32_bf16 v[112:115], v[104:107], v[88:91], 0
    v_mfma_f32_16x16x32_bf16 v[112:115], v[104:107], v[92:95], v[112:115]
    v_mfma_f32_16x16x32_bf16 v[112:115], v[104:107], v[96:99], v[112:115]
    v_mfma_f32_16x16x32_bf16 v[112:115], v[104:107], v[100:103], v[112:115]
    s_nop 7
    s_branch L_ygd
L_pto:
    s_mov_b32 s60, 0
    s_waitcnt vmcnt(0)
    s_branch L_pgot0
L_poll_129t:
    s_mov_b32 s60, 0
    s_waitcnt vmcnt(0)
    s_branch L_poll_129e
L_end:
    s_endpgm
L_codeend:
.section .rodata,"a"
.p2align 6
.amdhsa_kernel adaLN_cond__sliding_block_cached__dense_activation_gelu__decode_kernel
  .amdhsa_next_free_vgpr 168
  .amdhsa_next_free_sgpr 102
  .amdhsa_accum_offset 168
  .amdhsa_group_segment_fixed_size 0
  .amdhsa_kernarg_size 120
  .amdhsa_user_sgpr_count 2
  .amdhsa_user_sgpr_kernarg_segment_ptr 1
  .amdhsa_system_sgpr_workgroup_id_x 1
.end_amdhsa_kernel
```

```asm
; @launch grid=(256,1,1) block=(768,1,1) lds=162176
.amdgcn_target "amdgcn-amd-amdhsa--gfx950"
.text
.globl adaLN_cond__sliding_block_cached__dense_activation_gelu__decode_kernel
.p2align 8
.type adaLN_cond__sliding_block_cached__dense_activation_gelu__decode_kernel,@function
adaLN_cond__sliding_block_cached__dense_activation_gelu__decode_kernel:
    s_load_dwordx16 s[4:19], s[0:1], 0
    s_load_dwordx8 s[20:27], s[0:1], 64
    s_load_dwordx4 s[28:31], s[0:1], 96
    s_load_dwordx2 s[32:33], s[0:1], 112
    s_cmp_ge_u32 s2, 256
    s_cbranch_scc1 L_end
    v_lshrrev_b32 v1, 6, v0
    v_mul_u32_u24 v2, 36, v0
    v_readfirstlane_b32 s3, v1
    v_and_b32 v0, 63, v0
    s_and_b32 s34, s2, 7
    s_lshr_b32 s35, s2, 3
    s_cmp_lg_u32 s35, 21
    s_cbranch_scc1 L_nopf
    s_getpc_b64 s[48:49]
L_pc:
    v_min_u32 v2, L_codeend-L_pc-4, v2
    v_mov_b32 v3, s49
    v_add_co_u32 v2, vcc, s48, v2
    s_nop 1
    v_addc_co_u32 v3, vcc, 0, v3, vcc
    global_load_dword v152, v[2:3], off
L_nopf:
    s_lshr_b32 s36, s35, 3
    s_lshl2_add_u32 s36, s34, s36
    s_bfe_u32 s37, s35, 0x20001
    s_and_b32 s38, s35, 1
    s_cmp_lt_u32 s35, 27
    s_cselect_b32 s39, 1, 0
    s_cmp_eq_u32 s34, 2
    s_cselect_b32 s39, s39, 0
    s_sub_u32 s62, s34, 3
    s_and_b32 s62, s62, 7
    s_mul_i32 s56, s35, 7
    s_add_u32 s56, s56, s62
    s_cmp_eq_u32 s62, 7
    s_cselect_b32 s56, 255, s56
    s_mov_b32 s60, 1000000
    s_mov_b32 s61, 0
    v_mov_b32 v36, 0
    s_cmp_lt_u32 s3, 4
    s_cbranch_scc1 L_helpers
    s_sub_u32 s3, s3, 4
    s_cmp_ge_u32 s35, 22
    s_cselect_b32 s59, 1, 0
    s_add_u32 s62, s3, s59
    s_cmp_ge_u32 s62, 6
    s_cselect_b32 s62, s39, 0
    s_cmp_eq_u32 s62, 1
    s_cbranch_scc1 L_proxy
    s_cmp_eq_u32 s59, 1
    s_cselect_b32 s100, 0, 81920
    s_lshl_b32 s62, s3, 13
    s_add_u32 s100, s100, s62
    s_and_b32 s62, s39, s59
    s_cselect_b32 s100, -1, s100
    s_mov_b32 s101, 0
L_stream:
    s_lshl_b32 s62, s37, 5
    s_add_u32 s62, s62, s36
    s_lshl_b32 s63, s62, 21
    s_lshl_b32 s96, s38, 18
    s_add_u32 s63, s63, s96
    s_add_u32 s63, s63, 1572864
    v_lshlrev_b32 v1, 4, v0
    s_lshl_b32 s96, s3, 12
    v_add_u32 v1, s96, v1
    s_mov_b32 s97, 0
    s_mov_b32 s50, 262144
    s_mov_b32 s51, 0x20000
    s_waitcnt lgkmcnt(0)
    s_add_u32 s48, s6, s63
    s_addc_u32 s49, s7, 0
    s_cmp_lt_u32 s56, 40
    s_cbranch_scc0 L_nob0
    s_barrier
L_nob0:
    buffer_load_dwordx4 v[40:43], v1, s[48:51], s97 offen offset:0 nt
    buffer_load_dwordx4 v[44:47], v1, s[48:51], s97 offen offset:1024 nt
    s_cmp_lt_u32 s56, 40
    s_cbranch_scc1 L_stream2
    s_barrier
    s_branch L_stream2
L_helpers:
    s_cmp_lg_u32 s3, 0
    s_cbranch_scc1 L_noinit
    v_lshlrev_b32 v1, 2, v0
    v_add_u32 v1, 161920, v1
    ds_write_b32 v1, v36
L_noinit:
    s_waitcnt lgkmcnt(0)
    s_mov_b32 s40, s32
    s_mov_b32 s41, s33
    s_mov_b32 s42, 589824
    s_mov_b32 s43, 0x20000
    s_mov_b32 s44, s30
    s_mov_b32 s45, s31
    s_mov_b32 s46, 256
    s_mov_b32 s47, 0x20000
    s_lshl2_add_u32 s62, s35, s3
    s_cmp_eq_u32 s62, 87
    s_cbranch_scc1 L_touch
L_notp:
    s_mul_i32 s101, s3, 20480
    s_mov_b32 s96, s56
    s_cmp_lt_u32 s56, 40
    s_cbranch_scc0 L_nothalf
    s_cmp_lt_u32 s3, 2
    s_cbranch_scc1 L_unit
    s_add_u32 s62, s56, 20
    s_cmp_eq_u32 s3, 2
    s_cbranch_scc1 L_job
    s_barrier
    s_branch L_service
L_nothalf:
    s_cmp_lt_u32 s56, 144
    s_cbranch_scc1 L_unit
    s_sub_u32 s62, s56, 144
    s_cmp_lt_u32 s62, 10
    s_cbranch_scc0 L_nojob
    s_cmp_lt_u32 s3, 2
    s_cbranch_scc0 L_nojob
    s_mul_i32 s63, s3, 10
    s_add_u32 s62, s62, s63
L_job:
    s_cmp_lt_u32 s62, 59
    s_cbranch_scc0 L_end
    s_mov_b32 s100, s101
    s_lshl_b32 s101, s62, 9
    s_add_u32 s101, s101, 172032
    s_cmp_lt_u32 s62, 27
    s_cselect_b32 s63, 0, 27
    s_cselect_b32 s3, 7, 6
    s_cmp_lt_u32 s62, 54
    s_cselect_b32 s63, s63, 32
    s_cselect_b32 s3, s3, 5
    s_sub_u32 s35, s62, s63
    s_mov_b32 s34, 2
    s_lshr_b32 s36, s35, 3
    s_add_u32 s36, s36, 8
    s_bfe_u32 s37, s35, 0x20001
    s_and_b32 s38, s35, 1
    s_mov_b32 s59, 0
    s_branch L_stream
L_nojob:
    s_barrier
    s_cmp_ge_u32 s35, 22
    s_cbranch_scc1 L_h_t1
    s_cmp_eq_u32 s39, 1
    s_cbranch_scc1 L_h_role
    s_cmp_lt_u32 s96, 144
    s_cbranch_scc1 L_unit
    s_cmp_eq_u32 s3, 3
    s_cbranch_scc1 L_service
    s_endpgm
L_unit:
    v_lshrrev_b32 v3, 4, v0
    v_and_b32 v4, 3, v0
    v_bfe_u32 v7, v0, 2, 2
    s_mov_b32 s14, s3
    s_mov_b32 s15, 3
    s_sub_u32 s62, s96, 40
    s_cmp_lt_u32 s62, 64
    s_cbranch_scc1 L_u_q
    s_mov_b32 s100, 1
    s_sub_u32 s96, s96, 84
    s_cmp_lt_u32 s56, 40
    s_cbranch_scc0 L_u_full
    s_mov_b32 s100, 0
    s_lshr_b32 s96, s56, 1
    s_and_b32 s62, s56, 1
    s_lshl1_add_u32 s14, s62, s14
    s_mov_b32 s15, 1
L_u_full:
    s_mov_b32 s97, 0
    s_mov_b32 s99, 7680
    s_mov_b32 s48, s26
    s_mov_b32 s49, s27
    s_mov_b32 s50, 4915200
    s_mov_b32 s51, 0x20000
    s_mov_b32 s52, s24
    s_mov_b32 s53, s25
    s_mov_b32 s54, 5120
    s_mov_b32 s55, 0x20000
    v_and_b32 v6, 15, v0
    v_lshlrev_b32 v6, 4, v6
    v_mul_u32_u24 v5, 1280, v3
    v_add_u32 v5, v5, v6
    s_mul_i32 s62, s14, 320
    buffer_load_dwordx4 v[8:11], v5, s[52:55], s62 offen
    s_mov_b32 exec_lo, 0x000f000f
    s_mov_b32 exec_hi, 0x000f000f
    buffer_load_dwordx4 v[12:15], v5, s[52:55], s62 offen offset:256
    s_mov_b64 exec, -1
    s_lshl_b32 s98, s96, 7
    s_mul_i32 s13, s96, 0x199a
    s_lshr_b32 s13, s13, 16
    s_cmp_lg_u32 s13, 1
    s_cbranch_scc1 L_u_go
    s_mov_b32 s52, s4
    s_mov_b32 s53, s5
    s_mov_b32 s54, 5120
    s_mov_b32 s55, 0x20000
    v_mul_u32_u24 v5, 1280, v4
    v_lshlrev_b32 v64, 5, v7
    v_lshl_add_u32 v64, v3, 3, v64
    v_add_u32 v64, v64, v5
    v_lshrrev_b32 v6, 2, v0
    v_lshl_add_u32 v6, v6, 4, v5
    s_sub_u32 s62, s98, 1280
    buffer_load_dwordx4 v[16:19], v6, s[52:55], 0 offen offset:0
    buffer_load_dwordx4 v[20:23], v6, s[52:55], 0 offen offset:256
    buffer_load_dwordx4 v[24:27], v6, s[52:55], 0 offen offset:512
    buffer_load_dwordx4 v[28:31], v6, s[52:55], 0 offen offset:768
    buffer_load_dwordx4 v[32:35], v6, s[52:55], 0 offen offset:1024
    buffer_load_dwordx2 v[66:67], v64, s[52:55], s62 offen
    s_branch L_u_go
L_u_q:
    s_mov_b32 s97, 1
    s_mov_b32 s99, 8192
    s_mov_b32 s100, 2
    s_lshl_b32 s98, s62, 7
    s_mov_b32 s48, s10
    s_mov_b32 s49, s11
    s_mov_b32 s50, 5242880
    s_mov_b32 s51, 0x20000
L_u_go:
    v_lshrrev_b32 v6, 3, v0
    v_mul_lo_u32 v1, v6, s99
    v_and_b32 v6, 2, v6
    v_xor_b32 v6, v6, v0
    v_and_b32 v6, 7, v6
    v_lshl_add_u32 v1, v6, 4, v1
    v_add_u32 v1, s98, v1
    v_xor_b32 v2, 64, v1
    s_mul_i32 s63, s99, s14
    s_mul_i32 s63, s63, 160
    s_lshl_b32 s59, s99, 3
    s_mov_b32 m0, s101
    s_mov_b32 s62, 10
L_dma_1:
    buffer_load_dwordx4 v1, s[48:51], s63 offen nt lds
    s_add_u32 m0, m0, 1024
    s_add_u32 s63, s63, s59
    s_cmp_eq_u32 s100, 0
    s_cbranch_scc1 L_dma_1n0
    s_waitcnt vmcnt(5)
    s_cmp_eq_u32 s100, 2
    s_cbranch_scc1 L_dma_1n0
    s_waitcnt vmcnt(5)
L_dma_1n0:
    buffer_load_dwordx4 v2, s[48:51], s63 offen nt lds
    s_add_u32 m0, m0, 1024
    s_add_u32 s63, s63, s59
    s_cmp_eq_u32 s100, 0
    s_cbranch_scc1 L_dma_1n1
    s_waitcnt vmcnt(5)
    s_cmp_eq_u32 s100, 2
    s_cbranch_scc1 L_dma_1n1
    s_waitcnt vmcnt(5)
L_dma_1n1:
    s_sub_u32 s62, s62, 1
    s_cmp_lg_u32 s62, 0
    s_cbranch_scc1 L_dma_1
    v_min_u32 v65, 15, v0
    v_and_b32 v6, 1, v65
    v_mul_u32_u24 v6, 126, v6
    v_lshl_add_u32 v65, v65, 1, v6
    v_mov_b32 v68, 0
    s_cmp_lt_u32 s56, 40
    s_cbranch_scc1 L_u_nofl
    buffer_load_dword v68, v65, s[44:47], 0 offen sc1
L_u_nofl:
    s_cmp_lt_u32 s56, 144
    s_cbranch_scc0 L_u_nob
    s_barrier
L_u_nob:
    v_lshrrev_b32 v60, 4, v0
    v_lshlrev_b32 v60, 10, v60
    v_bfe_u32 v6, v0, 2, 2
    v_lshl_add_u32 v60, v6, 7, v60
    v_and_b32 v6, 3, v0
    v_lshl_add_u32 v60, v6, 3, v60
    v_bfe_u32 v6, v0, 3, 2
    v_lshl_add_u32 v60, v6, 5, v60
    v_xor_b32 v61, 32, v60
    v_xor_b32 v62, 64, v60
    v_xor_b32 v63, 0x60, v60
    v_add_u32 v60, s101, v60
    v_add_u32 v61, s101, v61
    v_add_u32 v62, s101, v62
    v_add_u32 v63, s101, v63
    v_mov_b32 v56, 1.0
    v_mov_b32 v57, 1.0
    v_mov_b32 v58, 1.0
    v_mov_b32 v59, 1.0
    s_mov_b32 s58, 0
    v_lshl_add_u32 v69, v7, 2, v3
    v_lshl_add_u32 v69, v4, 4, v69
    v_and_b32 v64, 15, v0
    v_lshlrev_b32 v64, 3, v64
    s_cmp_eq_u32 s97, 1
    s_cbranch_scc1 L_u_q2
    v_mul_u32_u24 v6, 1280, v3
    v_add_u32 v64, v64, v6
    s_mul_i32 s63, s13, 3840
    s_add_u32 s57, s98, s63
    s_add_u32 s57, s57, 10240
    s_cmp_lt_u32 s56, 40
    s_cbranch_scc0 L_u_nat
    v_lshrrev_b32 v69, 1, v3
    v_lshlrev_b32 v69, 3, v69
    v_lshl_add_u32 v69, v7, 4, v69
    v_lshl_add_u32 v69, v4, 1, v69
    v_and_b32 v6, 1, v3
    v_add_u32 v69, v69, v6
    s_lshr_b32 s62, s56, 1
    s_lshl_b32 s57, s62, 11
    s_cmp_ge_u32 s62, 10
    s_cselect_b32 s62, -19968, 0
    s_add_u32 s57, s57, s62
    s_and_b32 s62, s56, 1
    s_lshl_b32 s62, s62, 8
    s_add_u32 s57, s57, s62
    v_lshrrev_b32 v64, 5, v0
    v_lshlrev_b32 v64, 10, v64
    v_and_b32 v6, 31, v0
    v_lshl_add_u32 v64, v6, 3, v64
L_u_nat:
    s_cmp_eq_u32 s13, 4
    s_cselect_b32 s58, 1.0, 0
    s_cmp_eq_u32 s13, 1
    s_cselect_b32 s58, 1.0, s58
    s_cselect_b32 s56, 1, 0
    s_cmp_eq_u32 s14, 0
    s_cselect_b32 s58, s58, 0
    s_waitcnt vmcnt(20)
    s_mov_b32 s62, 0xbfb8aa3b
    v_lshlrev_b32 v40, 16, v8
    v_and_b32 v41, 0xffff0000, v8
    v_lshlrev_b32 v42, 16, v9
    v_and_b32 v43, 0xffff0000, v9
    v_lshlrev_b32 v44, 16, v10
    v_and_b32 v45, 0xffff0000, v10
    v_lshlrev_b32 v46, 16, v11
    v_and_b32 v47, 0xffff0000, v11
    v_mul_f32 v48, s62, v40
    v_mul_f32 v49, s62, v41
    v_mul_f32 v50, s62, v42
    v_mul_f32 v51, s62, v43
    v_mul_f32 v52, s62, v44
    v_mul_f32 v53, s62, v45
    v_mul_f32 v54, s62, v46
    v_mul_f32 v55, s62, v47
    v_exp_f32 v48, v48
    v_exp_f32 v49, v49
    v_exp_f32 v50, v50
    v_exp_f32 v51, v51
    v_exp_f32 v52, v52
    v_exp_f32 v53, v53
    v_exp_f32 v54, v54
    v_exp_f32 v55, v55
    v_add_f32 v48, 1.0, v48
    v_add_f32 v49, 1.0, v49
    v_add_f32 v50, 1.0, v50
    v_add_f32 v51, 1.0, v51
    v_add_f32 v52, 1.0, v52
    v_add_f32 v53, 1.0, v53
    v_add_f32 v54, 1.0, v54
    v_add_f32 v55, 1.0, v55
    v_rcp_f32 v48, v48
    v_rcp_f32 v49, v49
    v_rcp_f32 v50, v50
    v_rcp_f32 v51, v51
    v_rcp_f32 v52, v52
    v_rcp_f32 v53, v53
    v_rcp_f32 v54, v54
    v_rcp_f32 v55, v55
    v_mul_f32 v40, v40, v48
    v_mul_f32 v41, v41, v49
    v_mul_f32 v42, v42, v50
    v_mul_f32 v43, v43, v51
    v_mul_f32 v44, v44, v52
    v_mul_f32 v45, v45, v53
    v_mul_f32 v46, v46, v54
    v_mul_f32 v47, v47, v55
    v_cvt_pk_bf16_f32 v8, v40, v41
    v_cvt_pk_bf16_f32 v9, v42, v43
    v_cvt_pk_bf16_f32 v10, v44, v45
    v_cvt_pk_bf16_f32 v11, v46, v47
    v_lshlrev_b32 v40, 16, v12
    v_and_b32 v41, 0xffff0000, v12
    v_lshlrev_b32 v42, 16, v13
    v_and_b32 v43, 0xffff0000, v13
    v_lshlrev_b32 v44, 16, v14
    v_and_b32 v45, 0xffff0000, v14
    v_lshlrev_b32 v46, 16, v15
    v_and_b32 v47, 0xffff0000, v15
    v_mul_f32 v48, s62, v40
    v_mul_f32 v49, s62, v41
    v_mul_f32 v50, s62, v42
    v_mul_f32 v51, s62, v43
    v_mul_f32 v52, s62, v44
    v_mul_f32 v53, s62, v45
    v_mul_f32 v54, s62, v46
    v_mul_f32 v55, s62, v47
    v_exp_f32 v48, v48
    v_exp_f32 v49, v49
    v_exp_f32 v50, v50
    v_exp_f32 v51, v51
    v_exp_f32 v52, v52
    v_exp_f32 v53, v53
    v_exp_f32 v54, v54
    v_exp_f32 v55, v55
    v_add_f32 v48, 1.0, v48
    v_add_f32 v49, 1.0, v49
    v_add_f32 v50, 1.0, v50
    v_add_f32 v51, 1.0, v51
    v_add_f32 v52, 1.0, v52
    v_add_f32 v53, 1.0, v53
    v_add_f32 v54, 1.0, v54
    v_add_f32 v55, 1.0, v55
    v_rcp_f32 v48, v48
    v_rcp_f32 v49, v49
    v_rcp_f32 v50, v50
    v_rcp_f32 v51, v51
    v_rcp_f32 v52, v52
    v_rcp_f32 v53, v53
    v_rcp_f32 v54, v54
    v_rcp_f32 v55, v55
    v_mul_f32 v40, v40, v48
    v_mul_f32 v41, v41, v49
    v_mul_f32 v42, v42, v50
    v_mul_f32 v43, v43, v51
    v_mul_f32 v44, v44, v52
    v_mul_f32 v45, v45, v53
    v_mul_f32 v46, v46, v54
    v_mul_f32 v47, v47, v55
    v_cvt_pk_bf16_f32 v12, v40, v41
    v_cvt_pk_bf16_f32 v13, v42, v43
    v_cvt_pk_bf16_f32 v14, v44, v45
    v_cvt_pk_bf16_f32 v15, v46, v47
    s_mul_i32 s62, s3, 1344
    s_add_u32 s62, s62, 151552
    v_mul_u32_u24 v5, 336, v3
    v_and_b32 v6, 15, v0
    v_lshl_add_u32 v5, v6, 4, v5
    v_add_u32 v5, s62, v5
    ds_write_b128 v5, v[8:11]
    s_mov_b32 exec_lo, 0x000f000f
    s_mov_b32 exec_hi, 0x000f000f
    ds_write_b128 v5, v[12:15] offset:256
    s_mov_b64 exec, -1
    v_mul_u32_u24 v5, 336, v4
    v_lshl_add_u32 v5, v3, 4, v5
    v_add_u32 v5, s62, v5
    s_mov_b32 s59, 0x3e800000
    s_cmp_eq_u32 s56, 0
    s_cbranch_scc1 L_u_nost
    v_mov_b32 v40, 0
    v_mov_b32 v41, 0
    s_mov_b32 s62, 0x3f803f80
    v_dot2c_f32_bf16 v40, s62, v16
    v_dot2c_f32_bf16 v41, v16, v16
    v_dot2c_f32_bf16 v40, s62, v17
    v_dot2c_f32_bf16 v41, v17, v17
    v_dot2c_f32_bf16 v40, s62, v18
    v_dot2c_f32_bf16 v41, v18, v18
    v_dot2c_f32_bf16 v40, s62, v19
    v_dot2c_f32_bf16 v41, v19, v19
    v_dot2c_f32_bf16 v40, s62, v20
    v_dot2c_f32_bf16 v41, v20, v20
    v_dot2c_f32_bf16 v40, s62, v21
    v_dot2c_f32_bf16 v41, v21, v21
    v_dot2c_f32_bf16 v40, s62, v22
    v_dot2c_f32_bf16 v41, v22, v22
    v_dot2c_f32_bf16 v40, s62, v23
    v_dot2c_f32_bf16 v41, v23, v23
    v_dot2c_f32_bf16 v40, s62, v24
    v_dot2c_f32_bf16 v41, v24, v24
    v_dot2c_f32_bf16 v40, s62, v25
    v_dot2c_f32_bf16 v41, v25, v25
    v_dot2c_f32_bf16 v40, s62, v26
    v_dot2c_f32_bf16 v41, v26, v26
    v_dot2c_f32_bf16 v40, s62, v27
    v_dot2c_f32_bf16 v41, v27, v27
    v_dot2c_f32_bf16 v40, s62, v28
    v_dot2c_f32_bf16 v41, v28, v28
    v_dot2c_f32_bf16 v40, s62, v29
    v_dot2c_f32_bf16 v41, v29, v29
    v_dot2c_f32_bf16 v40, s62, v30
    v_dot2c_f32_bf16 v41, v30, v30
    v_dot2c_f32_bf16 v40, s62, v31
    v_dot2c_f32_bf16 v41, v31, v31
    v_dot2c_f32_bf16 v40, s62, v32
    v_dot2c_f32_bf16 v41, v32, v32
    v_dot2c_f32_bf16 v40, s62, v33
    v_dot2c_f32_bf16 v41, v33, v33
    v_dot2c_f32_bf16 v40, s62, v34
    v_dot2c_f32_bf16 v41, v34, v34
    v_dot2c_f32_bf16 v40, s62, v35
    v_dot2c_f32_bf16 v41, v35, v35
    s_nop 1
    v_add_f32_dpp v40, v40, v40 row_ror:4 row_mask:0xf bank_mask:0xf
    v_add_f32_dpp v41, v41, v41 row_ror:4 row_mask:0xf bank_mask:0xf
    s_nop 0
    v_add_f32_dpp v40, v40, v40 row_ror:8 row_mask:0xf bank_mask:0xf
    v_add_f32_dpp v41, v41, v41 row_ror:8 row_mask:0xf bank_mask:0xf
    v_mov_b32 v42, v40
    v_mov_b32 v43, v41
    s_nop 0
    v_permlane16_swap_b32 v40, v42
    v_permlane16_swap_b32 v41, v43
    v_add_f32 v40, v40, v42
    v_add_f32 v41, v41, v43
    v_mov_b32 v42, v40
    v_mov_b32 v43, v41
    s_nop 0
    v_permlane32_swap_b32 v40, v42
    v_permlane32_swap_b32 v41, v43
    v_add_f32 v40, v40, v42
    v_add_f32 v41, v41, v43
    s_mov_b32 s62, 0x3acccccd
    v_mul_f32 v40, s62, v40
    v_mul_f32 v41, s62, v41
    v_fma_f32 v41, -v40, v40, v41
    v_max_f32 v41, 0, v41
    v_add_f32 v41, 0x3727c5ac, v41
    v_rsq_f32 v41, v41
    v_lshlrev_b32 v56, 16, v66
    v_and_b32 v57, 0xffff0000, v66
    v_lshlrev_b32 v58, 16, v67
    v_and_b32 v59, 0xffff0000, v67
    v_sub_f32 v56, v56, v40
    v_sub_f32 v57, v57, v40
    v_sub_f32 v58, v58, v40
    v_sub_f32 v59, v59, v40
    v_mul_f32 v56, v56, v41
    v_mul_f32 v57, v57, v41
    v_mul_f32 v58, v58, v41
    v_mul_f32 v59, v59, v41
L_u_nost:
    ds_read_b128 v[8:11], v5 offset:0
    ds_read_b128 v[12:15], v5 offset:64
    ds_read_b128 v[16:19], v5 offset:128
    ds_read_b128 v[20:23], v5 offset:192
    ds_read_b128 v[24:27], v5 offset:256
    s_branch L_u_frag
L_u_q2:
    v_lshl_add_u32 v64, v3, 13, v64
    s_add_u32 s57, s98, 40960
    v_lshlrev_b32 v5, 8, v7
    v_lshl_add_u32 v5, v3, 6, v5
    v_lshl_add_u32 v5, v4, 4, v5
    s_mul_i32 s63, s3, 5120
    s_add_u32 s63, s63, 0
    s_add_u32 s12, s63, 4096
    s_mov_b32 s59, 1.0
L_u_frag:
    s_waitcnt vmcnt(0)
    v_cmp_ne_u32 vcc, -1, v68
    s_cbranch_vccz L_u_yok
    s_cmp_eq_u32 s97, 1
    s_cbranch_scc1 L_u_ywait
    buffer_load_dword v68, v65, s[44:47], 0 offen sc1
    s_branch L_u_yok
L_u_ywait:
L_wy_2:
    buffer_load_dword v68, v65, s[44:47], 0 offen sc1
    s_waitcnt vmcnt(0)
    v_cmp_ne_u32 vcc, -1, v68
    s_cbranch_vccz L_wy_2e
    s_sleep 4
    s_sub_u32 s60, s60, 1
    s_cbranch_scc0 L_wy_2
    s_mov_b32 s60, 0
L_wy_2e:
L_u_yok:
    ds_read_b64_tr_b16 v[80:81], v60 offset:0
    ds_read_b64_tr_b16 v[82:83], v60 offset:512
    ds_read_b64_tr_b16 v[84:85], v61 offset:0
    ds_read_b64_tr_b16 v[86:87], v61 offset:512
    ds_read_b64_tr_b16 v[88:89], v62 offset:0
    ds_read_b64_tr_b16 v[90:91], v62 offset:512
    ds_read_b64_tr_b16 v[92:93], v63 offset:0
    ds_read_b64_tr_b16 v[94:95], v63 offset:512
    ds_read_b64_tr_b16 v[96:97], v60 offset:4096
    ds_read_b64_tr_b16 v[98:99], v60 offset:4608
    ds_read_b64_tr_b16 v[100:101], v61 offset:4096
    ds_read_b64_tr_b16 v[102:103], v61 offset:4608
    ds_read_b64_tr_b16 v[104:105], v62 offset:4096
    ds_read_b64_tr_b16 v[106:107], v62 offset:4608
    ds_read_b64_tr_b16 v[108:109], v63 offset:4096
    ds_read_b64_tr_b16 v[110:111], v63 offset:4608
    ds_read_b64_tr_b16 v[112:113], v60 offset:8192
    ds_read_b64_tr_b16 v[114:115], v60 offset:8704
    ds_read_b64_tr_b16 v[116:117], v61 offset:8192
    ds_read_b64_tr_b16 v[118:119], v61 offset:8704
    ds_read_b64_tr_b16 v[120:121], v62 offset:8192
    ds_read_b64_tr_b16 v[122:123], v62 offset:8704
    ds_read_b64_tr_b16 v[124:125], v63 offset:8192
    ds_read_b64_tr_b16 v[126:127], v63 offset:8704
    ds_read_b64_tr_b16 v[128:129], v60 offset:12288
    ds_read_b64_tr_b16 v[130:131], v60 offset:12800
    ds_read_b64_tr_b16 v[132:133], v61 offset:12288
    ds_read_b64_tr_b16 v[134:135], v61 offset:12800
    ds_read_b64_tr_b16 v[136:137], v62 offset:12288
    ds_read_b64_tr_b16 v[138:139], v62 offset:12800
    ds_read_b64_tr_b16 v[140:141], v63 offset:12288
    ds_read_b64_tr_b16 v[142:143], v63 offset:12800
    ds_read_b64_tr_b16 v[144:145], v60 offset:16384
    ds_read_b64_tr_b16 v[146:147], v60 offset:16896
    ds_read_b64_tr_b16 v[148:149], v61 offset:16384
    ds_read_b64_tr_b16 v[150:151], v61 offset:16896
    ds_read_b64_tr_b16 v[152:153], v62 offset:16384
    ds_read_b64_tr_b16 v[154:155], v62 offset:16896
    ds_read_b64_tr_b16 v[156:157], v63 offset:16384
    ds_read_b64_tr_b16 v[158:159], v63 offset:16896
    s_cmp_eq_u32 s97, 0
    s_cbranch_scc1 L_u_mm
    s_branch L_poll_3
L_poll_3s:
    s_sleep 8
L_poll_3:
    buffer_load_dwordx4 v[8:11], v5, s[40:43], s63 offen offset:0 sc1
    buffer_load_dwordx4 v[12:15], v5, s[40:43], s63 offen offset:1024 sc1
    buffer_load_dwordx4 v[16:19], v5, s[40:43], s63 offen offset:2048 sc1
    buffer_load_dwordx4 v[20:23], v5, s[40:43], s63 offen offset:3072 sc1
    buffer_load_dwordx4 v[24:27], v5, s[40:43], s12 offen offset:0 sc1
    s_sub_u32 s60, s60, 1
    s_cbranch_scc1 L_poll_3t
    s_waitcnt vmcnt(0)
    v_max3_u32 v37, v8, v9, v10
    v_max3_u32 v37, v37, v11, v12
    v_max3_u32 v37, v37, v13, v14
    v_max3_u32 v37, v37, v15, v16
    v_max3_u32 v37, v37, v17, v18
    v_max3_u32 v37, v37, v19, v20
    v_max3_u32 v37, v37, v21, v22
    v_max3_u32 v37, v37, v23, v24
    v_max3_u32 v37, v37, v25, v26
    v_max_u32 v37, v37, v27
    v_cmp_eq_u32 vcc, -1, v37
    s_cbranch_vccnz L_poll_3s
L_poll_3e:
L_u_got:
L_u_mm:
    s_waitcnt lgkmcnt(0)
    v_mfma_f32_16x16x32_bf16 v[40:43], v[80:83], v[8:11], 0
    v_mfma_f32_16x16x32_bf16 v[44:47], v[84:87], v[8:11], 0
    v_mfma_f32_16x16x32_bf16 v[48:51], v[88:91], v[8:11], 0
    v_mfma_f32_16x16x32_bf16 v[52:55], v[92:95], v[8:11], 0
    v_mfma_f32_16x16x32_bf16 v[40:43], v[96:99], v[12:15], v[40:43]
    v_mfma_f32_16x16x32_bf16 v[44:47], v[100:103], v[12:15], v[44:47]
    v_mfma_f32_16x16x32_bf16 v[48:51], v[104:107], v[12:15], v[48:51]
    v_mfma_f32_16x16x32_bf16 v[52:55], v[108:111], v[12:15], v[52:55]
    v_mfma_f32_16x16x32_bf16 v[40:43], v[112:115], v[16:19], v[40:43]
    v_mfma_f32_16x16x32_bf16 v[44:47], v[116:119], v[16:19], v[44:47]
    v_mfma_f32_16x16x32_bf16 v[48:51], v[120:123], v[16:19], v[48:51]
    v_mfma_f32_16x16x32_bf16 v[52:55], v[124:127], v[16:19], v[52:55]
    v_mfma_f32_16x16x32_bf16 v[40:43], v[128:131], v[20:23], v[40:43]
    v_mfma_f32_16x16x32_bf16 v[44:47], v[132:135], v[20:23], v[44:47]
    v_mfma_f32_16x16x32_bf16 v[48:51], v[136:139], v[20:23], v[48:51]
    v_mfma_f32_16x16x32_bf16 v[52:55], v[140:143], v[20:23], v[52:55]
    v_mfma_f32_16x16x32_bf16 v[40:43], v[144:147], v[24:27], v[40:43]
    v_mfma_f32_16x16x32_bf16 v[44:47], v[148:151], v[24:27], v[44:47]
    v_mfma_f32_16x16x32_bf16 v[48:51], v[152:155], v[24:27], v[48:51]
    v_mfma_f32_16x16x32_bf16 v[52:55], v[156:159], v[24:27], v[52:55]
    v_lshlrev_b32 v5, 4, v0
    v_add_u32 v5, 147456, v5
    s_lshl_b32 s62, s3, 10
    s_add_u32 s62, s62, 147456
    v_lshl_add_u32 v6, v69, 4, s62
    v_mov_b32 v24, s58
    v_mov_b32 v32, 162056
    v_mov_b32 v33, 1
    v_add_f32_dpp v40, v40, v40 row_ror:8 row_mask:0xf bank_mask:0xf
    v_add_f32_dpp v41, v41, v41 row_ror:8 row_mask:0xf bank_mask:0xf
    v_add_f32_dpp v42, v42, v42 row_ror:8 row_mask:0xf bank_mask:0xf
    v_add_f32_dpp v43, v43, v43 row_ror:8 row_mask:0xf bank_mask:0xf
    v_add_f32_dpp v44, v44, v44 row_ror:8 row_mask:0xf bank_mask:0xf
    v_add_f32_dpp v45, v45, v45 row_ror:8 row_mask:0xf bank_mask:0xf
    v_add_f32_dpp v46, v46, v46 row_ror:8 row_mask:0xf bank_mask:0xf
    v_add_f32_dpp v47, v47, v47 row_ror:8 row_mask:0xf bank_mask:0xf
    v_add_f32_dpp v48, v48, v48 row_ror:8 row_mask:0xf bank_mask:0xf
    v_add_f32_dpp v49, v49, v49 row_ror:8 row_mask:0xf bank_mask:0xf
    v_add_f32_dpp v50, v50, v50 row_ror:8 row_mask:0xf bank_mask:0xf
    v_add_f32_dpp v51, v51, v51 row_ror:8 row_mask:0xf bank_mask:0xf
    v_add_f32_dpp v52, v52, v52 row_ror:8 row_mask:0xf bank_mask:0xf
    v_add_f32_dpp v53, v53, v53 row_ror:8 row_mask:0xf bank_mask:0xf
    v_add_f32_dpp v54, v54, v54 row_ror:8 row_mask:0xf bank_mask:0xf
    v_add_f32_dpp v55, v55, v55 row_ror:8 row_mask:0xf bank_mask:0xf
    v_add_f32_dpp v28, v40, v40 row_ror:4 row_mask:0xf bank_mask:0x1
    v_add_f32_dpp v29, v41, v41 row_ror:4 row_mask:0xf bank_mask:0x1
    v_add_f32_dpp v30, v42, v42 row_ror:4 row_mask:0xf bank_mask:0x1
    v_add_f32_dpp v31, v43, v43 row_ror:4 row_mask:0xf bank_mask:0x1
    v_add_f32_dpp v28, v44, v44 row_ror:4 row_mask:0xf bank_mask:0x2
    v_add_f32_dpp v29, v45, v45 row_ror:4 row_mask:0xf bank_mask:0x2
    v_add_f32_dpp v30, v46, v46 row_ror:4 row_mask:0xf bank_mask:0x2
    v_add_f32_dpp v31, v47, v47 row_ror:4 row_mask:0xf bank_mask:0x2
    v_add_f32_dpp v28, v48, v48 row_ror:4 row_mask:0xf bank_mask:0x4
    v_add_f32_dpp v29, v49, v49 row_ror:4 row_mask:0xf bank_mask:0x4
    v_add_f32_dpp v30, v50, v50 row_ror:4 row_mask:0xf bank_mask:0x4
    v_add_f32_dpp v31, v51, v51 row_ror:4 row_mask:0xf bank_mask:0x4
    v_add_f32_dpp v28, v52, v52 row_ror:4 row_mask:0xf bank_mask:0x8
    v_add_f32_dpp v29, v53, v53 row_ror:4 row_mask:0xf bank_mask:0x8
    v_add_f32_dpp v30, v54, v54 row_ror:4 row_mask:0xf bank_mask:0x8
    v_add_f32_dpp v31, v55, v55 row_ror:4 row_mask:0xf bank_mask:0x8
    v_fma_f32 v28, v28, s59, v24
    v_fma_f32 v29, v29, s59, v24
    v_fma_f32 v30, v30, s59, v24
    v_fma_f32 v31, v31, s59, v24
    v_mul_f32 v28, v28, v56
    v_mul_f32 v29, v29, v57
    v_mul_f32 v30, v30, v58
    v_mul_f32 v31, v31, v59
    ds_write_b128 v6, v[28:31]
    s_mov_b64 exec, 1
    ds_add_rtn_u32 v34, v32, v33
    s_mov_b64 exec, -1
    ds_read_b128 v[8:11], v5
    ds_read_b128 v[12:15], v5 offset:1024
    ds_read_b128 v[16:19], v5 offset:2048
    ds_read_b128 v[20:23], v5 offset:3072
    s_waitcnt lgkmcnt(0)
    v_readfirstlane_b32 s62, v34
    s_nop 0
    s_cmp_eq_u32 s62, s15
    s_cbranch_scc1 L_u_last
    s_cmp_eq_u32 s62, 1
    s_cbranch_scc1 L_service
    s_endpgm
L_u_last:
    v_add_f32 v8, v8, v12
    v_add_f32 v9, v9, v13
    v_add_f32 v10, v10, v14
    v_add_f32 v11, v11, v15
    s_cmp_eq_u32 s15, 1
    s_cbranch_scc1 L_u_two
    v_add_f32 v16, v16, v20
    v_add_f32 v17, v17, v21
    v_add_f32 v18, v18, v22
    v_add_f32 v19, v19, v23
    v_add_f32 v8, v8, v16
    v_add_f32 v9, v9, v17
    v_add_f32 v10, v10, v18
    v_add_f32 v11, v11, v19
L_u_two:
    v_cvt_pk_bf16_f32 v8, v8, v9
    v_cvt_pk_bf16_f32 v9, v10, v11
    s_waitcnt vmcnt(0)
    v_cmp_ne_u32 vcc, -1, v68
    s_cbranch_vccz L_u_st
L_wy_4:
    buffer_load_dword v68, v65, s[44:47], 0 offen sc1
    s_waitcnt vmcnt(0)
    v_cmp_ne_u32 vcc, -1, v68
    s_cbranch_vccz L_wy_4e
    s_sleep 4
    s_sub_u32 s60, s60, 1
    s_cbranch_scc0 L_wy_4
    s_mov_b32 s60, 0
L_wy_4e:
L_u_st:
    buffer_store_dwordx2 v[8:9], v64, s[40:43], s57 offen sc1
    s_endpgm
L_touch:
    s_load_dword s0, s[32:33], 0
    s_load_dword s0, s[30:31], 0
    s_cmp_eq_u32 s39, 1
    s_cbranch_scc1 L_tpr
    s_mov_b32 s62, 16777216
    s_load_dword s0, s[8:9], s62
    s_mov_b32 s62, 83886080
    s_load_dword s0, s[8:9], s62
    s_mov_b32 s62, 150994944
    s_load_dword s0, s[8:9], s62
    s_mov_b32 s62, 218103808
    s_load_dword s0, s[8:9], s62
    s_branch L_tpv
L_tpr:
    s_load_dword s0, s[20:21], 0
    s_mov_b32 s62, 2211836
    s_load_dword s0, s[20:21], s62
    s_load_dword s0, s[16:17], 0
    s_mov_b32 s62, 2211836
    s_load_dword s0, s[16:17], s62
    s_load_dword s0, s[18:19], 0
    s_load_dword s0, s[22:23], 0
    s_load_dword s0, s[28:29], 0
    s_load_dword s0, s[4:5], 0
L_tpv:
    s_lshl_b32 s62, s34, 23
    s_load_dword s0, s[8:9], s62
    s_add_u32 s62, s62, 67108864
    s_load_dword s0, s[8:9], s62
    s_add_u32 s62, s62, 67108864
    s_load_dword s0, s[8:9], s62
    s_add_u32 s62, s62, 67108864
    s_load_dword s0, s[8:9], s62
    s_add_u32 s62, s62, 67108864
    s_branch L_notp
L_stream2:
    s_mov_b32 s12, s100
    s_mov_b32 s13, s101
    s_or_b32 s96, s59, s39
    s_cbranch_scc0 L_noua
    s_barrier
L_noua:
    s_mov_b32 s40, s32
    s_mov_b32 s41, s33
    s_mov_b32 s42, 589824
    s_mov_b32 s43, 0x20000
    s_mov_b32 s44, s30
    s_mov_b32 s45, s31
    s_mov_b32 s46, 256
    s_mov_b32 s47, 0x20000
    s_bitcmp1_b32 s3, 0
    s_mov_b32 s57, 0xffffffff
    s_mov_b32 s58, 0x0
    s_mov_b32 s14, 0xffffff
    s_mov_b32 s15, 0x0
L_pm_10:
    s_sub_u32 s96, s56, 104
    s_cmp_lt_u32 s96, 66
    s_cbranch_scc0 L_pm_11
    s_bitcmp1_b32 s3, 0
    s_mov_b32 s57, 0xff00000f
    s_mov_b32 s58, 0x0
    s_mov_b32 s14, 0xffffff
    s_mov_b32 s15, 0x0
L_pm_11:
    s_sub_u32 s96, s56, 144
    s_cmp_lt_u32 s96, 10
    s_cbranch_scc0 L_pm_12
    s_bitcmp1_b32 s3, 0
    s_mov_b32 s57, 0xffffffff
    s_mov_b32 s58, 0xfff
    s_mov_b32 s14, 0xffffff
    s_mov_b32 s15, 0x0
L_pm_12:
    s_cmp_lt_u32 s56, 104
    s_cbranch_scc0 L_pm_13
    s_bitcmp1_b32 s3, 0
    s_mov_b32 s57, 0xf
    s_mov_b32 s58, 0x0
    s_mov_b32 s14, 0xffffff
    s_mov_b32 s15, 0x0
L_pm_13:
    s_sub_u32 s96, s56, 43
    s_and_b32 s96, s96, 0xffffffc7
    s_cmp_eq_u32 s96, 0
    s_cbranch_scc0 L_pm_14
    s_bitcmp1_b32 s3, 0
    s_mov_b32 s57, 0x0
    s_mov_b32 s58, 0x0
    s_mov_b32 s14, 0x0
    s_mov_b32 s15, 0x0
L_pm_14:
    s_cmp_lt_u32 s56, 40
    s_cbranch_scc0 L_pm_15
    s_bitcmp1_b32 s3, 0
    s_mov_b32 s57, 0xffffffff
    s_mov_b32 s58, 0xf
    s_mov_b32 s14, 0xffffff
    s_mov_b32 s15, 0x0
L_pm_15:
    s_cmp_eq_u32 s56, 255
    s_cbranch_scc0 L_pm_16
    s_bitcmp1_b32 s3, 0
    s_mov_b32 s57, 0xffffffff
    s_mov_b32 s58, 0x0
    s_mov_b32 s14, 0x0
    s_mov_b32 s15, 0x0
L_pm_16:
    s_cmp_eq_u32 s39, 1
    s_cbranch_scc0 L_pm_17
    s_bitcmp1_b32 s3, 0
    s_mov_b32 s57, 0x0
    s_mov_b32 s58, 0x0
    s_mov_b32 s14, 0x0
    s_mov_b32 s15, 0x0
L_pm_17:
    s_cmp_lg_u32 s13, 0
    s_cbranch_scc0 L_pm_18
    s_bitcmp1_b32 s3, 0
    s_mov_b32 s57, 0xffffffff
    s_mov_b32 s58, 0x0
    s_mov_b32 s14, 0x0
    s_mov_b32 s15, 0x0
L_pm_18:
    s_and_b32 s96, s39, s59
    s_cbranch_scc0 L_pm_19
    s_bitcmp1_b32 s3, 0
    s_mov_b32 s57, 0x0
    s_mov_b32 s58, 0x0
    s_mov_b32 s14, 0x0
    s_mov_b32 s15, 0x0
L_pm_19:
    s_add_u32 s52, s8, s63
    s_addc_u32 s53, s9, 0
    s_mov_b32 s54, 262144
    s_mov_b32 s55, 0x20000
    v_and_b32 v2, 15, v0
    v_lshrrev_b32 v3, 1, v2
    v_and_b32 v37, 1, v2
    v_lshlrev_b32 v37, 4, v37
    v_mov_b32 v38, 0xffff
    v_lshlrev_b32 v37, v37, v38
    v_cmp_eq_u32 vcc, 0, v3
    v_mov_b32 v32, 0
    s_nop 0
    v_cndmask_b32 v20, 0, v37, vcc
    v_cmp_eq_u32 vcc, 1, v3
    v_mov_b32 v33, 0
    s_nop 0
    v_cndmask_b32 v21, 0, v37, vcc
    v_cmp_eq_u32 vcc, 2, v3
    v_mov_b32 v34, 0
    s_nop 0
    v_cndmask_b32 v22, 0, v37, vcc
    v_cmp_eq_u32 vcc, 3, v3
    v_mov_b32 v35, 0
    s_nop 0
    v_cndmask_b32 v23, 0, v37, vcc
    v_lshlrev_b32 v2, 4, v2
    s_lshl_b32 s98, s62, 8
    s_add_u32 s98, s98, 40960
    s_bitcmp0_b32 s57, 2
    s_cbranch_scc1 L_sf_20
    s_bitcmp0_b32 s58, 2
    s_cbranch_scc1 L_sf_20
    s_waitcnt vmcnt(1)
L_sf_20:
    buffer_load_dwordx4 v[48:51], v1, s[48:51], s97 offen offset:2048 nt
    s_bitcmp0_b32 s57, 3
    s_cbranch_scc1 L_sf_21
    s_waitcnt vmcnt(2)
    s_bitcmp0_b32 s58, 3
    s_cbranch_scc1 L_sf_21
    s_waitcnt vmcnt(1)
L_sf_21:
    buffer_load_dwordx4 v[52:55], v1, s[48:51], s97 offen offset:3072 nt
    s_add_u32 s97, s97, 32768
    v_add_u32 v1, 4096, v1
    v_and_b32 v1, 0x7fff, v1
    s_waitcnt vmcnt(3)
    s_bitcmp0_b32 s57, 4
    s_cbranch_scc1 L_sf_22
    s_waitcnt vmcnt(2)
    s_bitcmp0_b32 s58, 4
    s_cbranch_scc1 L_sf_22
    s_waitcnt vmcnt(1)
L_sf_22:
    buffer_load_dwordx4 v[56:59], v1, s[48:51], s97 offen offset:0 nt
    s_waitcnt vmcnt(3)
    s_bitcmp0_b32 s57, 5
    s_cbranch_scc1 L_sf_23
    s_waitcnt vmcnt(2)
    s_bitcmp0_b32 s58, 5
    s_cbranch_scc1 L_sf_23
    s_waitcnt vmcnt(1)
L_sf_23:
    buffer_load_dwordx4 v[60:63], v1, s[48:51], s97 offen offset:1024 nt
    s_waitcnt vmcnt(3)
    s_bitcmp0_b32 s57, 6
    s_cbranch_scc1 L_sf_24
    s_waitcnt vmcnt(2)
    s_bitcmp0_b32 s58, 6
    s_cbranch_scc1 L_sf_24
    s_waitcnt vmcnt(1)
L_sf_24:
    buffer_load_dwordx4 v[64:67], v1, s[48:51], s97 offen offset:2048 nt
    s_waitcnt vmcnt(3)
    s_bitcmp0_b32 s57, 7
    s_cbranch_scc1 L_sf_25
    s_waitcnt vmcnt(2)
    s_bitcmp0_b32 s58, 7
    s_cbranch_scc1 L_sf_25
    s_waitcnt vmcnt(1)
L_sf_25:
    buffer_load_dwordx4 v[68:71], v1, s[48:51], s97 offen offset:3072 nt
    s_add_u32 s97, s97, 32768
    v_add_u32 v1, 4096, v1
    v_and_b32 v1, 0x7fff, v1
    s_waitcnt vmcnt(3)
    s_bitcmp0_b32 s57, 8
    s_cbranch_scc1 L_sf_26
    s_waitcnt vmcnt(2)
    s_bitcmp0_b32 s58, 8
    s_cbranch_scc1 L_sf_26
    s_waitcnt vmcnt(1)
L_sf_26:
    buffer_load_dwordx4 v[72:75], v1, s[48:51], s97 offen offset:0 nt
    s_waitcnt vmcnt(3)
    s_bitcmp0_b32 s57, 9
    s_cbranch_scc1 L_sf_27
    s_waitcnt vmcnt(2)
    s_bitcmp0_b32 s58, 9
    s_cbranch_scc1 L_sf_27
    s_waitcnt vmcnt(1)
L_sf_27:
    buffer_load_dwordx4 v[76:79], v1, s[48:51], s97 offen offset:1024 nt
    s_waitcnt vmcnt(3)
    s_bitcmp0_b32 s57, 10
    s_cbranch_scc1 L_sf_28
    s_waitcnt vmcnt(2)
    s_bitcmp0_b32 s58, 10
    s_cbranch_scc1 L_sf_28
    s_waitcnt vmcnt(1)
L_sf_28:
    buffer_load_dwordx4 v[80:83], v1, s[48:51], s97 offen offset:2048 nt
    s_waitcnt vmcnt(3)
    s_bitcmp0_b32 s57, 11
    s_cbranch_scc1 L_sf_29
    s_waitcnt vmcnt(2)
    s_bitcmp0_b32 s58, 11
    s_cbranch_scc1 L_sf_29
    s_waitcnt vmcnt(1)
L_sf_29:
    buffer_load_dwordx4 v[84:87], v1, s[48:51], s97 offen offset:3072 nt
    s_add_u32 s97, s97, 32768
    v_add_u32 v1, 4096, v1
    v_and_b32 v1, 0x7fff, v1
    s_waitcnt vmcnt(3)
    s_bitcmp0_b32 s57, 12
    s_cbranch_scc1 L_sf_30
    s_waitcnt vmcnt(2)
    s_bitcmp0_b32 s58, 12
    s_cbranch_scc1 L_sf_30
    s_waitcnt vmcnt(1)
L_sf_30:
    buffer_load_dwordx4 v[88:91], v1, s[48:51], s97 offen offset:0 nt
    s_waitcnt vmcnt(3)
    s_bitcmp0_b32 s57, 13
    s_cbranch_scc1 L_sf_31
    s_waitcnt vmcnt(2)
    s_bitcmp0_b32 s58, 13
    s_cbranch_scc1 L_sf_31
    s_waitcnt vmcnt(1)
L_sf_31:
    buffer_load_dwordx4 v[92:95], v1, s[48:51], s97 offen offset:1024 nt
    s_waitcnt vmcnt(3)
    s_bitcmp0_b32 s57, 14
    s_cbranch_scc1 L_sf_32
    s_waitcnt vmcnt(2)
    s_bitcmp0_b32 s58, 14
    s_cbranch_scc1 L_sf_32
    s_waitcnt vmcnt(1)
L_sf_32:
    buffer_load_dwordx4 v[96:99], v1, s[48:51], s97 offen offset:2048 nt
    s_waitcnt vmcnt(3)
    s_bitcmp0_b32 s57, 15
    s_cbranch_scc1 L_sf_33
    s_waitcnt vmcnt(2)
    s_bitcmp0_b32 s58, 15
    s_cbranch_scc1 L_sf_33
    s_waitcnt vmcnt(1)
L_sf_33:
    buffer_load_dwordx4 v[100:103], v1, s[48:51], s97 offen offset:3072 nt
    s_add_u32 s97, s97, 32768
    v_add_u32 v1, 4096, v1
    v_and_b32 v1, 0x7fff, v1
    s_waitcnt vmcnt(3)
    s_bitcmp0_b32 s57, 16
    s_cbranch_scc1 L_sf_34
    s_waitcnt vmcnt(2)
    s_bitcmp0_b32 s58, 16
    s_cbranch_scc1 L_sf_34
    s_waitcnt vmcnt(1)
L_sf_34:
    buffer_load_dwordx4 v[104:107], v1, s[48:51], s97 offen offset:0 nt
    s_waitcnt vmcnt(3)
    s_bitcmp0_b32 s57, 17
    s_cbranch_scc1 L_sf_35
    s_waitcnt vmcnt(2)
    s_bitcmp0_b32 s58, 17
    s_cbranch_scc1 L_sf_35
    s_waitcnt vmcnt(1)
L_sf_35:
    buffer_load_dwordx4 v[108:111], v1, s[48:51], s97 offen offset:1024 nt
    s_waitcnt vmcnt(3)
    s_bitcmp0_b32 s57, 18
    s_cbranch_scc1 L_sf_36
    s_waitcnt vmcnt(2)
    s_bitcmp0_b32 s58, 18
    s_cbranch_scc1 L_sf_36
    s_waitcnt vmcnt(1)
L_sf_36:
    buffer_load_dwordx4 v[112:115], v1, s[48:51], s97 offen offset:2048 nt
    s_waitcnt vmcnt(3)
    s_bitcmp0_b32 s57, 19
    s_cbranch_scc1 L_sf_37
    s_waitcnt vmcnt(2)
    s_bitcmp0_b32 s58, 19
    s_cbranch_scc1 L_sf_37
    s_waitcnt vmcnt(1)
L_sf_37:
    buffer_load_dwordx4 v[116:119], v1, s[48:51], s97 offen offset:3072 nt
    s_add_u32 s97, s97, 32768
    v_add_u32 v1, 4096, v1
    v_and_b32 v1, 0x7fff, v1
    s_waitcnt vmcnt(3)
    s_bitcmp0_b32 s57, 20
    s_cbranch_scc1 L_sf_38
    s_waitcnt vmcnt(2)
    s_bitcmp0_b32 s58, 20
    s_cbranch_scc1 L_sf_38
    s_waitcnt vmcnt(1)
L_sf_38:
    buffer_load_dwordx4 v[120:123], v1, s[48:51], s97 offen offset:0 nt
    s_waitcnt vmcnt(3)
    s_bitcmp0_b32 s57, 21
    s_cbranch_scc1 L_sf_39
    s_waitcnt vmcnt(2)
    s_bitcmp0_b32 s58, 21
    s_cbranch_scc1 L_sf_39
    s_waitcnt vmcnt(1)
L_sf_39:
    buffer_load_dwordx4 v[124:127], v1, s[48:51], s97 offen offset:1024 nt
    s_cmp_eq_u32 s12, -1
    s_cbranch_scc1 L_k_nopf
    s_waitcnt vmcnt(3)
    s_bitcmp0_b32 s57, 22
    s_cbranch_scc1 L_sf_40
    s_waitcnt vmcnt(2)
    s_bitcmp0_b32 s58, 22
    s_cbranch_scc1 L_sf_40
    s_waitcnt vmcnt(1)
L_sf_40:
    buffer_load_dwordx4 v[128:131], v1, s[48:51], s97 offen offset:2048 nt
    s_waitcnt vmcnt(3)
    s_bitcmp0_b32 s57, 23
    s_cbranch_scc1 L_sf_41
    s_waitcnt vmcnt(2)
    s_bitcmp0_b32 s58, 23
    s_cbranch_scc1 L_sf_41
    s_waitcnt vmcnt(1)
L_sf_41:
    buffer_load_dwordx4 v[132:135], v1, s[48:51], s97 offen offset:3072 nt
    s_add_u32 s97, s97, 32768
    v_add_u32 v1, 4096, v1
    v_and_b32 v1, 0x7fff, v1
    s_waitcnt vmcnt(3)
    s_bitcmp0_b32 s57, 24
    s_cbranch_scc1 L_sf_42
    s_waitcnt vmcnt(2)
    s_bitcmp0_b32 s58, 24
    s_cbranch_scc1 L_sf_42
    s_waitcnt vmcnt(1)
L_sf_42:
    buffer_load_dwordx4 v[136:139], v1, s[48:51], s97 offen offset:0 nt
    s_waitcnt vmcnt(3)
    s_bitcmp0_b32 s57, 25
    s_cbranch_scc1 L_sf_43
    s_waitcnt vmcnt(2)
    s_bitcmp0_b32 s58, 25
    s_cbranch_scc1 L_sf_43
    s_waitcnt vmcnt(1)
L_sf_43:
    buffer_load_dwordx4 v[140:143], v1, s[48:51], s97 offen offset:1024 nt
    s_waitcnt vmcnt(3)
    s_bitcmp0_b32 s57, 26
    s_cbranch_scc1 L_sf_44
    s_waitcnt vmcnt(2)
    s_bitcmp0_b32 s58, 26
    s_cbranch_scc1 L_sf_44
    s_waitcnt vmcnt(1)
L_sf_44:
    buffer_load_dwordx4 v[144:147], v1, s[48:51], s97 offen offset:2048 nt
    s_waitcnt vmcnt(3)
    s_bitcmp0_b32 s57, 27
    s_cbranch_scc1 L_sf_45
    s_waitcnt vmcnt(2)
    s_bitcmp0_b32 s58, 27
    s_cbranch_scc1 L_sf_45
    s_waitcnt vmcnt(1)
L_sf_45:
    buffer_load_dwordx4 v[148:151], v1, s[48:51], s97 offen offset:3072 nt
    s_add_u32 s97, s97, 32768
    v_add_u32 v1, 4096, v1
    v_and_b32 v1, 0x7fff, v1
    s_waitcnt vmcnt(3)
    s_bitcmp0_b32 s57, 28
    s_cbranch_scc1 L_sf_46
    s_waitcnt vmcnt(2)
    s_bitcmp0_b32 s58, 28
    s_cbranch_scc1 L_sf_46
    s_waitcnt vmcnt(1)
L_sf_46:
    buffer_load_dwordx4 v[152:155], v1, s[48:51], s97 offen offset:0 nt
    s_waitcnt vmcnt(3)
    s_bitcmp0_b32 s57, 29
    s_cbranch_scc1 L_sf_47
    s_waitcnt vmcnt(2)
    s_bitcmp0_b32 s58, 29
    s_cbranch_scc1 L_sf_47
    s_waitcnt vmcnt(1)
L_sf_47:
    buffer_load_dwordx4 v[156:159], v1, s[48:51], s97 offen offset:1024 nt
    s_waitcnt vmcnt(3)
    s_bitcmp0_b32 s57, 30
    s_cbranch_scc1 L_sf_48
    s_waitcnt vmcnt(2)
    s_bitcmp0_b32 s58, 30
    s_cbranch_scc1 L_sf_48
    s_waitcnt vmcnt(1)
L_sf_48:
    buffer_load_dwordx4 v[160:163], v1, s[48:51], s97 offen offset:2048 nt
    v_min_u32 v39, 15, v0
    v_and_b32 v38, 1, v39
    v_mul_u32_u24 v38, 126, v38
    v_lshl_add_u32 v39, v39, 1, v38
    buffer_load_dword v37, v39, s[44:47], 0 offen sc1
    s_waitcnt vmcnt(4)
    s_bitcmp0_b32 s57, 31
    s_cbranch_scc1 L_sf_49
    s_waitcnt vmcnt(3)
    s_bitcmp0_b32 s58, 31
    s_cbranch_scc1 L_sf_49
    s_waitcnt vmcnt(2)
L_sf_49:
    buffer_load_dwordx4 v[164:167], v1, s[48:51], s97 offen offset:3072 nt
    s_mov_b32 s97, 0
    v_add_u32 v1, 4096, v1
    v_and_b32 v1, 0x7fff, v1
    s_waitcnt vmcnt(4)
    s_bitcmp0_b32 s14, 0
    s_cbranch_scc1 L_sf_50
    s_waitcnt vmcnt(3)
    s_bitcmp0_b32 s15, 0
    s_cbranch_scc1 L_sf_50
    s_waitcnt vmcnt(2)
L_sf_50:
    s_add_u32 m0, s12, 0
    s_nop 0
    buffer_load_dwordx4 v1, s[52:55], s97 offen offset:0 nt lds
    s_waitcnt vmcnt(4)
    s_bitcmp0_b32 s14, 1
    s_cbranch_scc1 L_sf_51
    s_waitcnt vmcnt(3)
    s_bitcmp0_b32 s15, 1
    s_cbranch_scc1 L_sf_51
    s_waitcnt vmcnt(1)
L_sf_51:
    buffer_load_dwordx4 v1, s[52:55], s97 offen offset:1024 nt lds
    s_waitcnt vmcnt(4)
    s_bitcmp0_b32 s14, 2
    s_cbranch_scc1 L_sf_52
    s_waitcnt vmcnt(2)
    s_bitcmp0_b32 s15, 2
    s_cbranch_scc1 L_sf_52
    s_waitcnt vmcnt(1)
L_sf_52:
    buffer_load_dwordx4 v1, s[52:55], s97 offen offset:2048 nt lds
    s_waitcnt vmcnt(3)
    s_bitcmp0_b32 s14, 3
    s_cbranch_scc1 L_sf_53
    s_waitcnt vmcnt(2)
    s_bitcmp0_b32 s15, 3
    s_cbranch_scc1 L_sf_53
    s_waitcnt vmcnt(1)
L_sf_53:
    buffer_load_dwordx4 v1, s[52:55], s97 offen offset:3072 nt lds
    s_add_u32 s97, s97, 32768
    v_add_u32 v1, 4096, v1
    v_and_b32 v1, 0x7fff, v1
    v_cmp_eq_u32 vcc, 0, v37
    s_nop 0
    s_or_b32 s96, vcc_lo, vcc_hi
    buffer_load_dwordx4 v[4:7], v2, s[40:43], s98 offen sc1
    s_waitcnt vmcnt(4)
    s_bitcmp0_b32 s14, 4
    s_cbranch_scc1 L_sf_54
    s_waitcnt vmcnt(3)
    s_bitcmp0_b32 s15, 4
    s_cbranch_scc1 L_sf_54
    s_waitcnt vmcnt(2)
L_sf_54:
    s_add_u32 m0, s12, 4096
    s_nop 0
    buffer_load_dwordx4 v1, s[52:55], s97 offen offset:0 nt lds
    s_waitcnt vmcnt(4)
    s_bitcmp0_b32 s14, 5
    s_cbranch_scc1 L_sf_55
    s_waitcnt vmcnt(3)
    s_bitcmp0_b32 s15, 5
    s_cbranch_scc1 L_sf_55
    s_waitcnt vmcnt(2)
L_sf_55:
    buffer_load_dwordx4 v1, s[52:55], s97 offen offset:1024 nt lds
    s_waitcnt vmcnt(4)
    s_bitcmp0_b32 s14, 6
    s_cbranch_scc1 L_sf_56
    s_waitcnt vmcnt(3)
    s_bitcmp0_b32 s15, 6
    s_cbranch_scc1 L_sf_56
    s_waitcnt vmcnt(1)
L_sf_56:
    buffer_load_dwordx4 v1, s[52:55], s97 offen offset:2048 nt lds
    s_waitcnt vmcnt(4)
    s_bitcmp0_b32 s14, 7
    s_cbranch_scc1 L_sf_57
    s_waitcnt vmcnt(2)
    s_bitcmp0_b32 s15, 7
    s_cbranch_scc1 L_sf_57
    s_waitcnt vmcnt(1)
L_sf_57:
    buffer_load_dwordx4 v1, s[52:55], s97 offen offset:3072 nt lds
    s_add_u32 s97, s97, 32768
    v_add_u32 v1, 4096, v1
    v_and_b32 v1, 0x7fff, v1
L_k_join:
    s_waitcnt vmcnt(4)
    v_max3_u32 v38, v4, v5, v6
    v_max_u32 v38, v38, v7
    v_cmp_eq_u32 vcc, -1, v38
    s_cmp_lg_u32 s96, 0
    s_cbranch_scc1 L_qslow
    s_cbranch_vccnz L_qslow2
L_qok:
    v_dot2_f32_bf16 v8, v72, v4, 0
    v_dot2_f32_bf16 v9, v76, v4, 0
    v_dot2_f32_bf16 v10, v80, v4, 0
    v_dot2_f32_bf16 v11, v84, v4, 0
    v_dot2_f32_bf16 v24, v88, v4, 0
    v_dot2_f32_bf16 v25, v92, v4, 0
    v_dot2_f32_bf16 v26, v96, v4, 0
    v_dot2_f32_bf16 v27, v100, v4, 0
    v_dot2_f32_bf16 v8, v73, v5, v8
    v_dot2_f32_bf16 v9, v77, v5, v9
    v_dot2_f32_bf16 v10, v81, v5, v10
    v_dot2_f32_bf16 v11, v85, v5, v11
    v_dot2_f32_bf16 v24, v89, v5, v24
    v_dot2_f32_bf16 v25, v93, v5, v25
    v_dot2_f32_bf16 v26, v97, v5, v26
    v_dot2_f32_bf16 v27, v101, v5, v27
    v_dot2_f32_bf16 v8, v74, v6, v8
    v_dot2_f32_bf16 v9, v78, v6, v9
    v_dot2_f32_bf16 v10, v82, v6, v10
    v_dot2_f32_bf16 v11, v86, v6, v11
    v_dot2_f32_bf16 v24, v90, v6, v24
    v_dot2_f32_bf16 v25, v94, v6, v25
    v_dot2_f32_bf16 v26, v98, v6, v26
    v_dot2_f32_bf16 v27, v102, v6, v27
    v_dot2_f32_bf16 v8, v75, v7, v8
    v_dot2_f32_bf16 v9, v79, v7, v9
    v_dot2_f32_bf16 v10, v83, v7, v10
    v_dot2_f32_bf16 v11, v87, v7, v11
    v_dot2_f32_bf16 v24, v91, v7, v24
    v_dot2_f32_bf16 v25, v95, v7, v25
    v_dot2_f32_bf16 v26, v99, v7, v26
    v_dot2_f32_bf16 v27, v103, v7, v27
    v_add_f32_dpp v8, v8, v8 row_ror:8 row_mask:0xf bank_mask:0x3
    v_add_f32_dpp v10, v10, v10 row_ror:8 row_mask:0xf bank_mask:0x3
    v_add_f32_dpp v24, v24, v24 row_ror:8 row_mask:0xf bank_mask:0x3
    v_add_f32_dpp v26, v26, v26 row_ror:8 row_mask:0xf bank_mask:0x3
    v_add_f32_dpp v8, v9, v9 row_ror:8 row_mask:0xf bank_mask:0xc
    v_add_f32_dpp v10, v11, v11 row_ror:8 row_mask:0xf bank_mask:0xc
    v_add_f32_dpp v24, v25, v25 row_ror:8 row_mask:0xf bank_mask:0xc
    v_add_f32_dpp v26, v27, v27 row_ror:8 row_mask:0xf bank_mask:0xc
    v_add_f32_dpp v14, v8, v8 row_half_mirror row_mask:0xf bank_mask:0x5
    v_add_f32_dpp v15, v24, v24 row_half_mirror row_mask:0xf bank_mask:0x5
    v_add_f32_dpp v14, v10, v10 row_half_mirror row_mask:0xf bank_mask:0xa
    v_add_f32_dpp v15, v26, v26 row_half_mirror row_mask:0xf bank_mask:0xa
    s_nop 0
    v_add_f32_dpp v14, v14, v14 quad_perm:[1,0,3,2] row_mask:0xf bank_mask:0xf
    v_add_f32_dpp v15, v15, v15 quad_perm:[1,0,3,2] row_mask:0xf bank_mask:0xf
    s_nop 0
    v_add_f32_dpp v14, v14, v14 quad_perm:[2,3,0,1] row_mask:0xf bank_mask:0xf
    v_add_f32_dpp v15, v15, v15 quad_perm:[2,3,0,1] row_mask:0xf bank_mask:0xf
    s_waitcnt vmcnt(3)
    s_bitcmp0_b32 s14, 8
    s_cbranch_scc1 L_sf_68
    s_waitcnt vmcnt(2)
    s_bitcmp0_b32 s15, 8
    s_cbranch_scc1 L_sf_68
    s_waitcnt vmcnt(1)
L_sf_68:
    buffer_load_dwordx4 v[72:75], v1, s[52:55], s97 offen offset:0 nt
    v_dot2_f32_bf16 v8, v40, v4, 0
    v_dot2_f32_bf16 v9, v44, v4, 0
    v_dot2_f32_bf16 v10, v48, v4, 0
    v_dot2_f32_bf16 v11, v52, v4, 0
    v_dot2_f32_bf16 v24, v56, v4, 0
    v_dot2_f32_bf16 v25, v60, v4, 0
    v_dot2_f32_bf16 v26, v64, v4, 0
    v_dot2_f32_bf16 v27, v68, v4, 0
    v_dot2_f32_bf16 v28, v104, v4, 0
    v_dot2_f32_bf16 v29, v108, v4, 0
    v_dot2_f32_bf16 v30, v112, v4, 0
    v_dot2_f32_bf16 v31, v116, v4, 0
    v_dot2_f32_bf16 v8, v41, v5, v8
    v_dot2_f32_bf16 v9, v45, v5, v9
    v_dot2_f32_bf16 v10, v49, v5, v10
    v_dot2_f32_bf16 v11, v53, v5, v11
    v_dot2_f32_bf16 v24, v57, v5, v24
    v_dot2_f32_bf16 v25, v61, v5, v25
    v_dot2_f32_bf16 v26, v65, v5, v26
    v_dot2_f32_bf16 v27, v69, v5, v27
    v_dot2_f32_bf16 v28, v105, v5, v28
    v_dot2_f32_bf16 v29, v109, v5, v29
    v_dot2_f32_bf16 v30, v113, v5, v30
    v_dot2_f32_bf16 v31, v117, v5, v31
    v_dot2_f32_bf16 v8, v42, v6, v8
    v_dot2_f32_bf16 v9, v46, v6, v9
    v_dot2_f32_bf16 v10, v50, v6, v10
    v_dot2_f32_bf16 v11, v54, v6, v11
    v_dot2_f32_bf16 v24, v58, v6, v24
    v_dot2_f32_bf16 v25, v62, v6, v25
    v_dot2_f32_bf16 v26, v66, v6, v26
    v_dot2_f32_bf16 v27, v70, v6, v27
    v_dot2_f32_bf16 v28, v106, v6, v28
    v_dot2_f32_bf16 v29, v110, v6, v29
    v_dot2_f32_bf16 v30, v114, v6, v30
    v_dot2_f32_bf16 v31, v118, v6, v31
    v_dot2_f32_bf16 v8, v43, v7, v8
    v_dot2_f32_bf16 v9, v47, v7, v9
    v_dot2_f32_bf16 v10, v51, v7, v10
    v_dot2_f32_bf16 v11, v55, v7, v11
    v_dot2_f32_bf16 v24, v59, v7, v24
    v_dot2_f32_bf16 v25, v63, v7, v25
    v_dot2_f32_bf16 v26, v67, v7, v26
    v_dot2_f32_bf16 v27, v71, v7, v27
    v_dot2_f32_bf16 v28, v107, v7, v28
    v_dot2_f32_bf16 v29, v111, v7, v29
    v_dot2_f32_bf16 v30, v115, v7, v30
    v_dot2_f32_bf16 v31, v119, v7, v31
    v_add_f32_dpp v8, v8, v8 row_ror:8 row_mask:0xf bank_mask:0x3
    v_add_f32_dpp v10, v10, v10 row_ror:8 row_mask:0xf bank_mask:0x3
    v_add_f32_dpp v24, v24, v24 row_ror:8 row_mask:0xf bank_mask:0x3
    v_add_f32_dpp v26, v26, v26 row_ror:8 row_mask:0xf bank_mask:0x3
    v_add_f32_dpp v28, v28, v28 row_ror:8 row_mask:0xf bank_mask:0x3
    v_add_f32_dpp v30, v30, v30 row_ror:8 row_mask:0xf bank_mask:0x3
    v_add_f32_dpp v8, v9, v9 row_ror:8 row_mask:0xf bank_mask:0xc
    v_add_f32_dpp v10, v11, v11 row_ror:8 row_mask:0xf bank_mask:0xc
    v_add_f32_dpp v24, v25, v25 row_ror:8 row_mask:0xf bank_mask:0xc
    v_add_f32_dpp v26, v27, v27 row_ror:8 row_mask:0xf bank_mask:0xc
    v_add_f32_dpp v28, v29, v29 row_ror:8 row_mask:0xf bank_mask:0xc
    v_add_f32_dpp v30, v31, v31 row_ror:8 row_mask:0xf bank_mask:0xc
    v_add_f32_dpp v12, v8, v8 row_half_mirror row_mask:0xf bank_mask:0x5
    v_add_f32_dpp v13, v24, v24 row_half_mirror row_mask:0xf bank_mask:0x5
    v_add_f32_dpp v16, v28, v28 row_half_mirror row_mask:0xf bank_mask:0x5
    v_add_f32_dpp v12, v10, v10 row_half_mirror row_mask:0xf bank_mask:0xa
    v_add_f32_dpp v13, v26, v26 row_half_mirror row_mask:0xf bank_mask:0xa
    v_add_f32_dpp v16, v30, v30 row_half_mirror row_mask:0xf bank_mask:0xa
    v_add_f32_dpp v12, v12, v12 quad_perm:[1,0,3,2] row_mask:0xf bank_mask:0xf
    v_add_f32_dpp v13, v13, v13 quad_perm:[1,0,3,2] row_mask:0xf bank_mask:0xf
    v_add_f32_dpp v16, v16, v16 quad_perm:[1,0,3,2] row_mask:0xf bank_mask:0xf
    v_add_f32_dpp v12, v12, v12 quad_perm:[2,3,0,1] row_mask:0xf bank_mask:0xf
    v_add_f32_dpp v13, v13, v13 quad_perm:[2,3,0,1] row_mask:0xf bank_mask:0xf
    v_add_f32_dpp v16, v16, v16 quad_perm:[2,3,0,1] row_mask:0xf bank_mask:0xf
    s_waitcnt vmcnt(3)
    s_bitcmp0_b32 s14, 9
    s_cbranch_scc1 L_sf_69
    s_waitcnt vmcnt(2)
    s_bitcmp0_b32 s15, 9
    s_cbranch_scc1 L_sf_69
    s_waitcnt vmcnt(1)
L_sf_69:
    buffer_load_dwordx4 v[76:79], v1, s[52:55], s97 offen offset:1024 nt
    v_dot2_f32_bf16 v8, v120, v4, 0
    v_dot2_f32_bf16 v9, v124, v4, 0
    v_dot2_f32_bf16 v10, v128, v4, 0
    v_dot2_f32_bf16 v11, v132, v4, 0
    v_dot2_f32_bf16 v24, v136, v4, 0
    v_dot2_f32_bf16 v25, v140, v4, 0
    v_dot2_f32_bf16 v26, v144, v4, 0
    v_dot2_f32_bf16 v27, v148, v4, 0
    v_dot2_f32_bf16 v8, v121, v5, v8
    v_dot2_f32_bf16 v9, v125, v5, v9
    v_dot2_f32_bf16 v10, v129, v5, v10
    v_dot2_f32_bf16 v11, v133, v5, v11
    v_dot2_f32_bf16 v24, v137, v5, v24
    v_dot2_f32_bf16 v25, v141, v5, v25
    v_dot2_f32_bf16 v26, v145, v5, v26
    v_dot2_f32_bf16 v27, v149, v5, v27
    v_dot2_f32_bf16 v8, v122, v6, v8
    v_dot2_f32_bf16 v9, v126, v6, v9
    v_dot2_f32_bf16 v10, v130, v6, v10
    v_dot2_f32_bf16 v11, v134, v6, v11
    v_dot2_f32_bf16 v24, v138, v6, v24
    v_dot2_f32_bf16 v25, v142, v6, v25
    v_dot2_f32_bf16 v26, v146, v6, v26
    v_dot2_f32_bf16 v27, v150, v6, v27
    v_dot2_f32_bf16 v8, v123, v7, v8
    v_dot2_f32_bf16 v9, v127, v7, v9
    v_dot2_f32_bf16 v10, v131, v7, v10
    v_dot2_f32_bf16 v11, v135, v7, v11
    v_dot2_f32_bf16 v24, v139, v7, v24
    v_dot2_f32_bf16 v25, v143, v7, v25
    v_dot2_f32_bf16 v26, v147, v7, v26
    v_dot2_f32_bf16 v27, v151, v7, v27
    v_add_f32_dpp v8, v8, v8 row_ror:8 row_mask:0xf bank_mask:0x3
    v_add_f32_dpp v10, v10, v10 row_ror:8 row_mask:0xf bank_mask:0x3
    v_add_f32_dpp v24, v24, v24 row_ror:8 row_mask:0xf bank_mask:0x3
    v_add_f32_dpp v26, v26, v26 row_ror:8 row_mask:0xf bank_mask:0x3
    v_add_f32_dpp v8, v9, v9 row_ror:8 row_mask:0xf bank_mask:0xc
    v_add_f32_dpp v10, v11, v11 row_ror:8 row_mask:0xf bank_mask:0xc
    v_add_f32_dpp v24, v25, v25 row_ror:8 row_mask:0xf bank_mask:0xc
    v_add_f32_dpp v26, v27, v27 row_ror:8 row_mask:0xf bank_mask:0xc
    v_add_f32_dpp v17, v8, v8 row_half_mirror row_mask:0xf bank_mask:0x5
    v_add_f32_dpp v18, v24, v24 row_half_mirror row_mask:0xf bank_mask:0x5
    v_add_f32_dpp v17, v10, v10 row_half_mirror row_mask:0xf bank_mask:0xa
    v_add_f32_dpp v18, v26, v26 row_half_mirror row_mask:0xf bank_mask:0xa
    s_nop 0
    v_add_f32_dpp v17, v17, v17 quad_perm:[1,0,3,2] row_mask:0xf bank_mask:0xf
    v_add_f32_dpp v18, v18, v18 quad_perm:[1,0,3,2] row_mask:0xf bank_mask:0xf
    s_nop 0
    v_add_f32_dpp v17, v17, v17 quad_perm:[2,3,0,1] row_mask:0xf bank_mask:0xf
    v_add_f32_dpp v18, v18, v18 quad_perm:[2,3,0,1] row_mask:0xf bank_mask:0xf
    s_waitcnt vmcnt(3)
    s_bitcmp0_b32 s14, 10
    s_cbranch_scc1 L_sf_70
    s_waitcnt vmcnt(2)
    s_bitcmp0_b32 s15, 10
    s_cbranch_scc1 L_sf_70
    s_waitcnt vmcnt(1)
L_sf_70:
    buffer_load_dwordx4 v[80:83], v1, s[52:55], s97 offen offset:2048 nt
    s_waitcnt vmcnt(3)
    s_bitcmp0_b32 s14, 11
    s_cbranch_scc1 L_sf_71
    s_waitcnt vmcnt(2)
    s_bitcmp0_b32 s15, 11
    s_cbranch_scc1 L_sf_71
    s_waitcnt vmcnt(1)
L_sf_71:
    buffer_load_dwordx4 v[84:87], v1, s[52:55], s97 offen offset:3072 nt
    s_add_u32 s97, s97, 32768
    v_add_u32 v1, 4096, v1
    v_and_b32 v1, 0x7fff, v1
    s_cmp_eq_u32 s12, -1
    s_cbranch_scc1 L_nopfrd
    v_lshl_add_u32 v38, v0, 4, s12
    ds_read_b128 v[40:43], v38 offset:0
    ds_read_b128 v[44:47], v38 offset:1024
    ds_read_b128 v[48:51], v38 offset:2048
    ds_read_b128 v[52:55], v38 offset:3072
    ds_read_b128 v[56:59], v38 offset:4096
    ds_read_b128 v[60:63], v38 offset:5120
    ds_read_b128 v[64:67], v38 offset:6144
    ds_read_b128 v[68:71], v38 offset:7168
L_nopfrd:
    v_dot2_f32_bf16 v8, v152, v4, 0
    v_dot2_f32_bf16 v9, v156, v4, 0
    v_dot2_f32_bf16 v10, v160, v4, 0
    v_dot2_f32_bf16 v11, v164, v4, 0
    v_dot2_f32_bf16 v8, v153, v5, v8
    v_dot2_f32_bf16 v9, v157, v5, v9
    v_dot2_f32_bf16 v10, v161, v5, v10
    v_dot2_f32_bf16 v11, v165, v5, v11
    v_dot2_f32_bf16 v8, v154, v6, v8
    v_dot2_f32_bf16 v9, v158, v6, v9
    v_dot2_f32_bf16 v10, v162, v6, v10
    v_dot2_f32_bf16 v11, v166, v6, v11
    v_dot2_f32_bf16 v8, v155, v7, v8
    v_dot2_f32_bf16 v9, v159, v7, v9
    v_dot2_f32_bf16 v10, v163, v7, v10
    v_dot2_f32_bf16 v11, v167, v7, v11
    v_add_f32_dpp v8, v8, v8 row_ror:8 row_mask:0xf bank_mask:0x3
    s_nop 0
    v_add_f32_dpp v10, v10, v10 row_ror:8 row_mask:0xf bank_mask:0x3
    v_add_f32_dpp v8, v9, v9 row_ror:8 row_mask:0xf bank_mask:0xc
    v_add_f32_dpp v10, v11, v11 row_ror:8 row_mask:0xf bank_mask:0xc
    s_nop 0
    v_add_f32_dpp v19, v8, v8 row_half_mirror row_mask:0xf bank_mask:0x5
    v_add_f32_dpp v19, v10, v10 row_half_mirror row_mask:0xf bank_mask:0xa
    s_nop 1
    v_add_f32_dpp v19, v19, v19 quad_perm:[1,0,3,2] row_mask:0xf bank_mask:0xf
    s_nop 1
    v_add_f32_dpp v19, v19, v19 quad_perm:[2,3,0,1] row_mask:0xf bank_mask:0xf
    v_max3_f32 v3, v12, v13, v14
    v_max3_f32 v8, v15, v16, v17
    v_max3_f32 v3, v3, v18, v19
    v_max_f32 v3, v3, v8
    s_nop 1
    v_max_f32_dpp v3, v3, v3 row_ror:4 row_mask:0xf bank_mask:0xf
    s_nop 1
    v_max_f32_dpp v3, v3, v3 row_ror:8 row_mask:0xf bank_mask:0xf
    v_mov_b32 v8, v3
    s_nop 1
    v_permlane16_swap_b32 v3, v8
    v_max_f32 v3, v3, v8
    v_mov_b32 v8, v3
    s_nop 1
    v_permlane32_swap_b32 v3, v8
    v_max_f32 v3, v3, v8
    s_mov_b32 s96, 0x3e0293ee
    v_mul_f32 v8, s96, v3
    v_fma_f32 v12, v12, s96, -v8
    v_fma_f32 v13, v13, s96, -v8
    v_fma_f32 v14, v14, s96, -v8
    v_fma_f32 v15, v15, s96, -v8
    v_fma_f32 v16, v16, s96, -v8
    v_fma_f32 v17, v17, s96, -v8
    v_fma_f32 v18, v18, s96, -v8
    v_fma_f32 v19, v19, s96, -v8
    v_exp_f32 v12, v12
    v_exp_f32 v13, v13
    v_exp_f32 v14, v14
    v_exp_f32 v15, v15
    v_exp_f32 v16, v16
    v_exp_f32 v17, v17
    v_exp_f32 v18, v18
    v_exp_f32 v19, v19
    v_add_f32 v9, v12, v13
    v_add_f32 v10, v14, v15
    v_add_f32 v11, v16, v17
    v_add_f32 v3, v18, v19
    v_add_f32 v9, v9, v10
    v_add_f32 v3, v3, v11
    v_add_f32 v9, v9, v3
    v_cvt_pk_bf16_f32 v12, v12, v12
    v_cvt_pk_bf16_f32 v13, v13, v13
    v_cvt_pk_bf16_f32 v14, v14, v14
    v_cvt_pk_bf16_f32 v15, v15, v15
    v_cvt_pk_bf16_f32 v16, v16, v16
    v_cvt_pk_bf16_f32 v17, v17, v17
    v_cvt_pk_bf16_f32 v18, v18, v18
    v_cvt_pk_bf16_f32 v19, v19, v19
    v_add_f32_dpp v9, v9, v9 row_ror:4 row_mask:0xf bank_mask:0xf
    s_nop 1
    v_add_f32_dpp v9, v9, v9 row_ror:8 row_mask:0xf bank_mask:0xf
    v_mov_b32 v10, v9
    s_nop 1
    v_permlane16_swap_b32 v9, v10
    v_add_f32 v9, v9, v10
    v_mov_b32 v10, v9
    s_nop 1
    v_permlane32_swap_b32 v9, v10
    v_add_f32 v9, v9, v10
    s_mov_b64 exec, 1
    s_cmp_lg_u32 s13, 0
    s_cbranch_scc1 L_mljob
    s_lshl_b32 s96, s3, 3
    s_add_u32 s96, s96, 161920
    v_mov_b32 v10, s96
    v_mov_b32 v11, 162068
    v_mov_b32 v3, 1
    ds_write_b64 v10, v[8:9]
    ds_add_u32 v11, v3
L_mldone:
    s_mov_b64 exec, -1
    v_lshrrev_b32 v2, 1, v2
    v_and_b32_dpp v24, v14, v20 row_newbcast:0 row_mask:0xf bank_mask:0xf
    v_and_b32_dpp v25, v14, v21 row_newbcast:0 row_mask:0xf bank_mask:0xf
    v_and_b32_dpp v26, v14, v22 row_newbcast:0 row_mask:0xf bank_mask:0xf
    v_and_b32_dpp v27, v14, v23 row_newbcast:0 row_mask:0xf bank_mask:0xf
    s_waitcnt vmcnt(3)
    s_bitcmp0_b32 s14, 12
    s_cbranch_scc1 L_sf_72
    s_waitcnt vmcnt(2)
    s_bitcmp0_b32 s15, 12
    s_cbranch_scc1 L_sf_72
    s_waitcnt vmcnt(1)
L_sf_72:
    buffer_load_dwordx4 v[88:91], v1, s[52:55], s97 offen offset:0 nt
    v_mfma_f32_16x16x32_bf16 v[32:35], v[24:27], v[72:75], v[32:35]
    s_cmp_eq_u32 s12, -1
    s_cbranch_scc1 L_nopfpv8
    s_waitcnt lgkmcnt(0)
    v_and_b32_dpp v24, v12, v20 row_newbcast:0 row_mask:0xf bank_mask:0xf
    v_and_b32_dpp v25, v12, v21 row_newbcast:0 row_mask:0xf bank_mask:0xf
    v_and_b32_dpp v26, v12, v22 row_newbcast:0 row_mask:0xf bank_mask:0xf
    v_and_b32_dpp v27, v12, v23 row_newbcast:0 row_mask:0xf bank_mask:0xf
    s_nop 1
    v_mfma_f32_16x16x32_bf16 v[32:35], v[24:27], v[40:43], v[32:35]
    v_and_b32_dpp v28, v12, v20 row_newbcast:8 row_mask:0xf bank_mask:0xf
    v_and_b32_dpp v29, v12, v21 row_newbcast:8 row_mask:0xf bank_mask:0xf
    v_and_b32_dpp v30, v12, v22 row_newbcast:8 row_mask:0xf bank_mask:0xf
    v_and_b32_dpp v31, v12, v23 row_newbcast:8 row_mask:0xf bank_mask:0xf
    s_nop 1
    v_mfma_f32_16x16x32_bf16 v[32:35], v[28:31], v[44:47], v[32:35]
    v_and_b32_dpp v24, v12, v20 row_newbcast:4 row_mask:0xf bank_mask:0xf
    v_and_b32_dpp v25, v12, v21 row_newbcast:4 row_mask:0xf bank_mask:0xf
    v_and_b32_dpp v26, v12, v22 row_newbcast:4 row_mask:0xf bank_mask:0xf
    v_and_b32_dpp v27, v12, v23 row_newbcast:4 row_mask:0xf bank_mask:0xf
    s_nop 1
    v_mfma_f32_16x16x32_bf16 v[32:35], v[24:27], v[48:51], v[32:35]
    v_and_b32_dpp v28, v12, v20 row_newbcast:12 row_mask:0xf bank_mask:0xf
    v_and_b32_dpp v29, v12, v21 row_newbcast:12 row_mask:0xf bank_mask:0xf
    v_and_b32_dpp v30, v12, v22 row_newbcast:12 row_mask:0xf bank_mask:0xf
    v_and_b32_dpp v31, v12, v23 row_newbcast:12 row_mask:0xf bank_mask:0xf
    s_nop 1
    v_mfma_f32_16x16x32_bf16 v[32:35], v[28:31], v[52:55], v[32:35]
L_nopfpv8:
    v_and_b32_dpp v28, v14, v20 row_newbcast:8 row_mask:0xf bank_mask:0xf
    v_and_b32_dpp v29, v14, v21 row_newbcast:8 row_mask:0xf bank_mask:0xf
    v_and_b32_dpp v30, v14, v22 row_newbcast:8 row_mask:0xf bank_mask:0xf
    v_and_b32_dpp v31, v14, v23 row_newbcast:8 row_mask:0xf bank_mask:0xf
    s_waitcnt vmcnt(3)
    s_bitcmp0_b32 s14, 13
    s_cbranch_scc1 L_sf_73
    s_waitcnt vmcnt(2)
    s_bitcmp0_b32 s15, 13
    s_cbranch_scc1 L_sf_73
    s_waitcnt vmcnt(1)
L_sf_73:
    buffer_load_dwordx4 v[92:95], v1, s[52:55], s97 offen offset:1024 nt
    v_mfma_f32_16x16x32_bf16 v[32:35], v[28:31], v[76:79], v[32:35]
    s_cmp_eq_u32 s12, -1
    s_cbranch_scc1 L_nopfpv9
    s_waitcnt lgkmcnt(0)
    v_and_b32_dpp v24, v13, v20 row_newbcast:0 row_mask:0xf bank_mask:0xf
    v_and_b32_dpp v25, v13, v21 row_newbcast:0 row_mask:0xf bank_mask:0xf
    v_and_b32_dpp v26, v13, v22 row_newbcast:0 row_mask:0xf bank_mask:0xf
    v_and_b32_dpp v27, v13, v23 row_newbcast:0 row_mask:0xf bank_mask:0xf
    s_nop 1
    v_mfma_f32_16x16x32_bf16 v[32:35], v[24:27], v[56:59], v[32:35]
    v_and_b32_dpp v28, v13, v20 row_newbcast:8 row_mask:0xf bank_mask:0xf
    v_and_b32_dpp v29, v13, v21 row_newbcast:8 row_mask:0xf bank_mask:0xf
    v_and_b32_dpp v30, v13, v22 row_newbcast:8 row_mask:0xf bank_mask:0xf
    v_and_b32_dpp v31, v13, v23 row_newbcast:8 row_mask:0xf bank_mask:0xf
    s_nop 1
    v_mfma_f32_16x16x32_bf16 v[32:35], v[28:31], v[60:63], v[32:35]
    v_and_b32_dpp v24, v13, v20 row_newbcast:4 row_mask:0xf bank_mask:0xf
    v_and_b32_dpp v25, v13, v21 row_newbcast:4 row_mask:0xf bank_mask:0xf
    v_and_b32_dpp v26, v13, v22 row_newbcast:4 row_mask:0xf bank_mask:0xf
    v_and_b32_dpp v27, v13, v23 row_newbcast:4 row_mask:0xf bank_mask:0xf
    s_nop 1
    v_mfma_f32_16x16x32_bf16 v[32:35], v[24:27], v[64:67], v[32:35]
    v_and_b32_dpp v28, v13, v20 row_newbcast:12 row_mask:0xf bank_mask:0xf
    v_and_b32_dpp v29, v13, v21 row_newbcast:12 row_mask:0xf bank_mask:0xf
    v_and_b32_dpp v30, v13, v22 row_newbcast:12 row_mask:0xf bank_mask:0xf
    v_and_b32_dpp v31, v13, v23 row_newbcast:12 row_mask:0xf bank_mask:0xf
    s_nop 1
    v_mfma_f32_16x16x32_bf16 v[32:35], v[28:31], v[68:71], v[32:35]
L_nopfpv9:
    v_and_b32_dpp v24, v14, v20 row_newbcast:4 row_mask:0xf bank_mask:0xf
    v_and_b32_dpp v25, v14, v21 row_newbcast:4 row_mask:0xf bank_mask:0xf
    v_and_b32_dpp v26, v14, v22 row_newbcast:4 row_mask:0xf bank_mask:0xf
    v_and_b32_dpp v27, v14, v23 row_newbcast:4 row_mask:0xf bank_mask:0xf
    s_waitcnt vmcnt(3)
    s_bitcmp0_b32 s14, 14
    s_cbranch_scc1 L_sf_74
    s_waitcnt vmcnt(2)
    s_bitcmp0_b32 s15, 14
    s_cbranch_scc1 L_sf_74
    s_waitcnt vmcnt(1)
L_sf_74:
    buffer_load_dwordx4 v[96:99], v1, s[52:55], s97 offen offset:2048 nt
    v_mfma_f32_16x16x32_bf16 v[32:35], v[24:27], v[80:83], v[32:35]
    v_and_b32_dpp v28, v14, v20 row_newbcast:12 row_mask:0xf bank_mask:0xf
    v_and_b32_dpp v29, v14, v21 row_newbcast:12 row_mask:0xf bank_mask:0xf
    v_and_b32_dpp v30, v14, v22 row_newbcast:12 row_mask:0xf bank_mask:0xf
    v_and_b32_dpp v31, v14, v23 row_newbcast:12 row_mask:0xf bank_mask:0xf
    s_waitcnt vmcnt(3)
    s_bitcmp0_b32 s14, 15
    s_cbranch_scc1 L_sf_75
    s_waitcnt vmcnt(2)
    s_bitcmp0_b32 s15, 15
    s_cbranch_scc1 L_sf_75
    s_waitcnt vmcnt(1)
L_sf_75:
    buffer_load_dwordx4 v[100:103], v1, s[52:55], s97 offen offset:3072 nt
    s_add_u32 s97, s97, 32768
    v_add_u32 v1, 4096, v1
    v_and_b32 v1, 0x7fff, v1
    v_mfma_f32_16x16x32_bf16 v[32:35], v[28:31], v[84:87], v[32:35]
    v_and_b32_dpp v24, v15, v20 row_newbcast:0 row_mask:0xf bank_mask:0xf
    v_and_b32_dpp v25, v15, v21 row_newbcast:0 row_mask:0xf bank_mask:0xf
    v_and_b32_dpp v26, v15, v22 row_newbcast:0 row_mask:0xf bank_mask:0xf
    v_and_b32_dpp v27, v15, v23 row_newbcast:0 row_mask:0xf bank_mask:0xf
    s_waitcnt vmcnt(3)
    s_bitcmp0_b32 s14, 16
    s_cbranch_scc1 L_sf_76
    s_waitcnt vmcnt(2)
    s_bitcmp0_b32 s15, 16
    s_cbranch_scc1 L_sf_76
    s_waitcnt vmcnt(1)
L_sf_76:
    buffer_load_dwordx4 v[104:107], v1, s[52:55], s97 offen offset:0 nt
    v_mfma_f32_16x16x32_bf16 v[32:35], v[24:27], v[88:91], v[32:35]
    v_and_b32_dpp v28, v15, v20 row_newbcast:8 row_mask:0xf bank_mask:0xf
    v_and_b32_dpp v29, v15, v21 row_newbcast:8 row_mask:0xf bank_mask:0xf
    v_and_b32_dpp v30, v15, v22 row_newbcast:8 row_mask:0xf bank_mask:0xf
    v_and_b32_dpp v31, v15, v23 row_newbcast:8 row_mask:0xf bank_mask:0xf
    s_waitcnt vmcnt(3)
    s_bitcmp0_b32 s14, 17
    s_cbranch_scc1 L_sf_77
    s_waitcnt vmcnt(2)
    s_bitcmp0_b32 s15, 17
    s_cbranch_scc1 L_sf_77
    s_waitcnt vmcnt(1)
L_sf_77:
    buffer_load_dwordx4 v[108:111], v1, s[52:55], s97 offen offset:1024 nt
    v_mfma_f32_16x16x32_bf16 v[32:35], v[28:31], v[92:95], v[32:35]
    v_and_b32_dpp v24, v15, v20 row_newbcast:4 row_mask:0xf bank_mask:0xf
    v_and_b32_dpp v25, v15, v21 row_newbcast:4 row_mask:0xf bank_mask:0xf
    v_and_b32_dpp v26, v15, v22 row_newbcast:4 row_mask:0xf bank_mask:0xf
    v_and_b32_dpp v27, v15, v23 row_newbcast:4 row_mask:0xf bank_mask:0xf
    s_waitcnt vmcnt(3)
    s_bitcmp0_b32 s14, 18
    s_cbranch_scc1 L_sf_78
    s_waitcnt vmcnt(2)
    s_bitcmp0_b32 s15, 18
    s_cbranch_scc1 L_sf_78
    s_waitcnt vmcnt(1)
L_sf_78:
    buffer_load_dwordx4 v[112:115], v1, s[52:55], s97 offen offset:2048 nt
    v_mfma_f32_16x16x32_bf16 v[32:35], v[24:27], v[96:99], v[32:35]
    v_and_b32_dpp v28, v15, v20 row_newbcast:12 row_mask:0xf bank_mask:0xf
    v_and_b32_dpp v29, v15, v21 row_newbcast:12 row_mask:0xf bank_mask:0xf
    v_and_b32_dpp v30, v15, v22 row_newbcast:12 row_mask:0xf bank_mask:0xf
    v_and_b32_dpp v31, v15, v23 row_newbcast:12 row_mask:0xf bank_mask:0xf
    s_waitcnt vmcnt(3)
    s_bitcmp0_b32 s14, 19
    s_cbranch_scc1 L_sf_79
    s_waitcnt vmcnt(2)
    s_bitcmp0_b32 s15, 19
    s_cbranch_scc1 L_sf_79
    s_waitcnt vmcnt(1)
L_sf_79:
    buffer_load_dwordx4 v[116:119], v1, s[52:55], s97 offen offset:3072 nt
    s_add_u32 s97, s97, 32768
    v_add_u32 v1, 4096, v1
    v_and_b32 v1, 0x7fff, v1
    v_mfma_f32_16x16x32_bf16 v[32:35], v[28:31], v[100:103], v[32:35]
    v_and_b32_dpp v24, v16, v20 row_newbcast:0 row_mask:0xf bank_mask:0xf
    v_and_b32_dpp v25, v16, v21 row_newbcast:0 row_mask:0xf bank_mask:0xf
    v_and_b32_dpp v26, v16, v22 row_newbcast:0 row_mask:0xf bank_mask:0xf
    v_and_b32_dpp v27, v16, v23 row_newbcast:0 row_mask:0xf bank_mask:0xf
    s_waitcnt vmcnt(3)
    s_bitcmp0_b32 s14, 20
    s_cbranch_scc1 L_sf_80
    s_waitcnt vmcnt(2)
    s_bitcmp0_b32 s15, 20
    s_cbranch_scc1 L_sf_80
    s_waitcnt vmcnt(1)
L_sf_80:
    buffer_load_dwordx4 v[120:123], v1, s[52:55], s97 offen offset:0 nt
    v_mfma_f32_16x16x32_bf16 v[32:35], v[24:27], v[104:107], v[32:35]
    v_and_b32_dpp v28, v16, v20 row_newbcast:8 row_mask:0xf bank_mask:0xf
    v_and_b32_dpp v29, v16, v21 row_newbcast:8 row_mask:0xf bank_mask:0xf
    v_and_b32_dpp v30, v16, v22 row_newbcast:8 row_mask:0xf bank_mask:0xf
    v_and_b32_dpp v31, v16, v23 row_newbcast:8 row_mask:0xf bank_mask:0xf
    s_waitcnt vmcnt(3)
    s_bitcmp0_b32 s14, 21
    s_cbranch_scc1 L_sf_81
    s_waitcnt vmcnt(2)
    s_bitcmp0_b32 s15, 21
    s_cbranch_scc1 L_sf_81
    s_waitcnt vmcnt(1)
L_sf_81:
    buffer_load_dwordx4 v[124:127], v1, s[52:55], s97 offen offset:1024 nt
    v_mfma_f32_16x16x32_bf16 v[32:35], v[28:31], v[108:111], v[32:35]
    v_and_b32_dpp v24, v16, v20 row_newbcast:4 row_mask:0xf bank_mask:0xf
    v_and_b32_dpp v25, v16, v21 row_newbcast:4 row_mask:0xf bank_mask:0xf
    v_and_b32_dpp v26, v16, v22 row_newbcast:4 row_mask:0xf bank_mask:0xf
    v_and_b32_dpp v27, v16, v23 row_newbcast:4 row_mask:0xf bank_mask:0xf
    s_waitcnt vmcnt(3)
    s_bitcmp0_b32 s14, 22
    s_cbranch_scc1 L_sf_82
    s_waitcnt vmcnt(2)
    s_bitcmp0_b32 s15, 22
    s_cbranch_scc1 L_sf_82
    s_waitcnt vmcnt(1)
L_sf_82:
    buffer_load_dwordx4 v[128:131], v1, s[52:55], s97 offen offset:2048 nt
    v_mfma_f32_16x16x32_bf16 v[32:35], v[24:27], v[112:115], v[32:35]
    v_and_b32_dpp v28, v16, v20 row_newbcast:12 row_mask:0xf bank_mask:0xf
    v_and_b32_dpp v29, v16, v21 row_newbcast:12 row_mask:0xf bank_mask:0xf
    v_and_b32_dpp v30, v16, v22 row_newbcast:12 row_mask:0xf bank_mask:0xf
    v_and_b32_dpp v31, v16, v23 row_newbcast:12 row_mask:0xf bank_mask:0xf
    s_waitcnt vmcnt(3)
    s_bitcmp0_b32 s14, 23
    s_cbranch_scc1 L_sf_83
    s_waitcnt vmcnt(2)
    s_bitcmp0_b32 s15, 23
    s_cbranch_scc1 L_sf_83
    s_waitcnt vmcnt(1)
L_sf_83:
    buffer_load_dwordx4 v[132:135], v1, s[52:55], s97 offen offset:3072 nt
    s_add_u32 s97, s97, 32768
    v_add_u32 v1, 4096, v1
    v_and_b32 v1, 0x7fff, v1
    v_mfma_f32_16x16x32_bf16 v[32:35], v[28:31], v[116:119], v[32:35]
    v_and_b32_dpp v24, v17, v20 row_newbcast:0 row_mask:0xf bank_mask:0xf
    v_and_b32_dpp v25, v17, v21 row_newbcast:0 row_mask:0xf bank_mask:0xf
    v_and_b32_dpp v26, v17, v22 row_newbcast:0 row_mask:0xf bank_mask:0xf
    v_and_b32_dpp v27, v17, v23 row_newbcast:0 row_mask:0xf bank_mask:0xf
    s_waitcnt vmcnt(3)
    s_bitcmp0_b32 s14, 24
    s_cbranch_scc1 L_sf_84
    s_waitcnt vmcnt(2)
    s_bitcmp0_b32 s15, 24
    s_cbranch_scc1 L_sf_84
    s_waitcnt vmcnt(1)
L_sf_84:
    buffer_load_dwordx4 v[136:139], v1, s[52:55], s97 offen offset:0 nt
    v_mfma_f32_16x16x32_bf16 v[32:35], v[24:27], v[120:123], v[32:35]
    s_or_b32 s96, s59, 0
    s_cbranch_scc0 L_nofrag_85
    v_mov_b32 v104, 162060
L_lw_86:
    ds_read_b32 v105, v104
    s_waitcnt lgkmcnt(0)
    v_cmp_gt_u32 vcc, 4, v105
    s_cbranch_vccz L_lw_86e
    s_sleep 2
    s_sub_u32 s60, s60, 1
    s_cbranch_scc0 L_lw_86
    s_mov_b32 s60, 0
L_lw_86e:
    s_cmp_eq_u32 s59, 0
    s_cbranch_scc1 L_nofrag_85
    v_bfe_u32 v104, v0, 2, 1
    v_bfe_u32 v110, v0, 4, 1
    v_lshl_add_u32 v104, v110, 2, v104
    v_and_b32 v110, 8, v0
    v_add_u32 v104, v104, v110
    v_lshrrev_b32 v110, 5, v0
    v_lshl_add_u32 v104, v110, 4, v104
    v_bfe_u32 v111, v0, 0, 1
    v_mul_u32_u24 v111, 0xaaaa, v111
    v_add_u32 v111, 0x4444, v111
    v_mov_b32 v112, 0
    v_mov_b32 v113, 0
    v_mov_b32 v114, 0
    v_mov_b32 v115, 0
    v_mov_b32 v116, 0
    v_mov_b32 v117, 0
    v_mov_b32 v118, 0
    v_mov_b32 v119, 0
    v_lshlrev_b32 v104, 7, v104
    v_and_b32 v110, 3, v0
    v_lshl_add_u32 v104, v110, 3, v104
    v_lshrrev_b32 v109, 4, v0
    v_and_b32 v110, 1, v0
    s_lshr_b32 s63, s3, 1
    s_and_b32 s62, s3, 1
    s_lshl_b32 s96, s63, 14
    s_lshl_b32 s100, s62, 6
    s_add_u32 s100, s100, 81920
    s_add_u32 s96, s96, s100
    v_add_u32 v104, s96, v104
    ds_read_b64_tr_b16 v[72:73], v104 offset:0
    ds_read_b64_tr_b16 v[74:75], v104 offset:256
    ds_read_b64_tr_b16 v[76:77], v104 offset:4096
    ds_read_b64_tr_b16 v[78:79], v104 offset:4352
    ds_read_b64_tr_b16 v[80:81], v104 offset:32
    ds_read_b64_tr_b16 v[82:83], v104 offset:288
    ds_read_b64_tr_b16 v[84:85], v104 offset:4128
    ds_read_b64_tr_b16 v[86:87], v104 offset:4384
    ds_read_b64_tr_b16 v[88:89], v104 offset:8192
    ds_read_b64_tr_b16 v[90:91], v104 offset:8448
    ds_read_b64_tr_b16 v[92:93], v104 offset:12288
    ds_read_b64_tr_b16 v[94:95], v104 offset:12544
    ds_read_b64_tr_b16 v[96:97], v104 offset:8224
    ds_read_b64_tr_b16 v[98:99], v104 offset:8480
    ds_read_b64_tr_b16 v[100:101], v104 offset:12320
    ds_read_b64_tr_b16 v[102:103], v104 offset:12576
    v_bfe_u32 v105, v0, 1, 3
    v_lshlrev_b32 v105, 8, v105
    v_lshl_add_u32 v105, v109, 5, v105
    v_lshl_add_u32 v105, v110, 4, v105
    v_lshrrev_b32 v106, 3, v0
    v_lshlrev_b32 v106, 7, v106
    v_and_b32 v110, 7, v0
    v_lshl_add_u32 v107, v110, 3, v106
    v_add_u32 v107, s100, v107
    v_lshlrev_b32 v106, 8, v109
    v_and_b32 v110, 15, v0
    v_lshl_add_u32 v106, v110, 2, v106
    v_add_u32 v106, s96, v106
    v_lshlrev_b32 v108, 2, v0
    s_lshl_b32 s96, s62, 2
    s_add_u32 s96, s96, 162088
    v_mov_b32 v109, s96
    s_lshl_b32 s100, s63, 11
    s_lshl_b32 s96, s34, 13
    s_add_u32 s100, s100, s96
    s_add_u32 s100, s100, 106496
    s_mul_i32 s101, s34, 5120
    s_lshl_b32 s96, s35, 9
    s_add_u32 s101, s101, s96
    s_lshl_b32 s96, s62, 8
    s_add_u32 s101, s101, s96
    s_sub_u32 s101, s101, 11264
    s_and_b32 s96, s101, 0xffffe000
    s_add_u32 s101, s101, s96
    s_add_u32 s101, s101, 212992
    v_add_u32 v110, 8192, v108
L_nofrag_85:
    v_and_b32_dpp v28, v17, v20 row_newbcast:8 row_mask:0xf bank_mask:0xf
    v_and_b32_dpp v29, v17, v21 row_newbcast:8 row_mask:0xf bank_mask:0xf
    v_and_b32_dpp v30, v17, v22 row_newbcast:8 row_mask:0xf bank_mask:0xf
    v_and_b32_dpp v31, v17, v23 row_newbcast:8 row_mask:0xf bank_mask:0xf
    s_waitcnt vmcnt(3)
    s_bitcmp0_b32 s14, 25
    s_cbranch_scc1 L_sf_87
    s_waitcnt vmcnt(2)
    s_bitcmp0_b32 s15, 25
    s_cbranch_scc1 L_sf_87
    s_waitcnt vmcnt(1)
L_sf_87:
    buffer_load_dwordx4 v[140:143], v1, s[52:55], s97 offen offset:1024 nt
    v_mfma_f32_16x16x32_bf16 v[32:35], v[28:31], v[124:127], v[32:35]
    v_and_b32_dpp v24, v17, v20 row_newbcast:4 row_mask:0xf bank_mask:0xf
    v_and_b32_dpp v25, v17, v21 row_newbcast:4 row_mask:0xf bank_mask:0xf
    v_and_b32_dpp v26, v17, v22 row_newbcast:4 row_mask:0xf bank_mask:0xf
    v_and_b32_dpp v27, v17, v23 row_newbcast:4 row_mask:0xf bank_mask:0xf
    s_waitcnt vmcnt(3)
    s_bitcmp0_b32 s14, 26
    s_cbranch_scc1 L_sf_88
    s_waitcnt vmcnt(2)
    s_bitcmp0_b32 s15, 26
    s_cbranch_scc1 L_sf_88
    s_waitcnt vmcnt(1)
L_sf_88:
    buffer_load_dwordx4 v[144:147], v1, s[52:55], s97 offen offset:2048 nt
    v_mfma_f32_16x16x32_bf16 v[32:35], v[24:27], v[128:131], v[32:35]
    v_and_b32_dpp v28, v17, v20 row_newbcast:12 row_mask:0xf bank_mask:0xf
    v_and_b32_dpp v29, v17, v21 row_newbcast:12 row_mask:0xf bank_mask:0xf
    v_and_b32_dpp v30, v17, v22 row_newbcast:12 row_mask:0xf bank_mask:0xf
    v_and_b32_dpp v31, v17, v23 row_newbcast:12 row_mask:0xf bank_mask:0xf
    s_waitcnt vmcnt(3)
    s_bitcmp0_b32 s14, 27
    s_cbranch_scc1 L_sf_89
    s_waitcnt vmcnt(2)
    s_bitcmp0_b32 s15, 27
    s_cbranch_scc1 L_sf_89
    s_waitcnt vmcnt(1)
L_sf_89:
    buffer_load_dwordx4 v[148:151], v1, s[52:55], s97 offen offset:3072 nt
    s_add_u32 s97, s97, 32768
    v_add_u32 v1, 4096, v1
    v_and_b32 v1, 0x7fff, v1
    v_mfma_f32_16x16x32_bf16 v[32:35], v[28:31], v[132:135], v[32:35]
    v_and_b32_dpp v24, v18, v20 row_newbcast:0 row_mask:0xf bank_mask:0xf
    v_and_b32_dpp v25, v18, v21 row_newbcast:0 row_mask:0xf bank_mask:0xf
    v_and_b32_dpp v26, v18, v22 row_newbcast:0 row_mask:0xf bank_mask:0xf
    v_and_b32_dpp v27, v18, v23 row_newbcast:0 row_mask:0xf bank_mask:0xf
    s_waitcnt vmcnt(3)
    s_bitcmp0_b32 s14, 28
    s_cbranch_scc1 L_sf_90
    s_waitcnt vmcnt(2)
    s_bitcmp0_b32 s15, 28
    s_cbranch_scc1 L_sf_90
    s_waitcnt vmcnt(1)
L_sf_90:
    buffer_load_dwordx4 v[152:155], v1, s[52:55], s97 offen offset:0 nt
    v_mfma_f32_16x16x32_bf16 v[32:35], v[24:27], v[136:139], v[32:35]
    v_mov_b32 v10, 162076
    v_mov_b32 v11, 1
    s_mov_b64 exec, 1
    ds_add_u32 v10, v11
    s_mov_b64 exec, -1
    v_and_b32_dpp v28, v18, v20 row_newbcast:8 row_mask:0xf bank_mask:0xf
    v_and_b32_dpp v29, v18, v21 row_newbcast:8 row_mask:0xf bank_mask:0xf
    v_and_b32_dpp v30, v18, v22 row_newbcast:8 row_mask:0xf bank_mask:0xf
    v_and_b32_dpp v31, v18, v23 row_newbcast:8 row_mask:0xf bank_mask:0xf
    s_waitcnt vmcnt(3)
    s_bitcmp0_b32 s14, 29
    s_cbranch_scc1 L_sf_91
    s_waitcnt vmcnt(2)
    s_bitcmp0_b32 s15, 29
    s_cbranch_scc1 L_sf_91
    s_waitcnt vmcnt(1)
L_sf_91:
    buffer_load_dwordx4 v[156:159], v1, s[52:55], s97 offen offset:1024 nt
    v_mfma_f32_16x16x32_bf16 v[32:35], v[28:31], v[140:143], v[32:35]
    v_and_b32_dpp v24, v18, v20 row_newbcast:4 row_mask:0xf bank_mask:0xf
    v_and_b32_dpp v25, v18, v21 row_newbcast:4 row_mask:0xf bank_mask:0xf
    v_and_b32_dpp v26, v18, v22 row_newbcast:4 row_mask:0xf bank_mask:0xf
    v_and_b32_dpp v27, v18, v23 row_newbcast:4 row_mask:0xf bank_mask:0xf
    s_waitcnt vmcnt(3)
    s_bitcmp0_b32 s14, 30
    s_cbranch_scc1 L_sf_92
    s_waitcnt vmcnt(2)
    s_bitcmp0_b32 s15, 30
    s_cbranch_scc1 L_sf_92
    s_waitcnt vmcnt(1)
L_sf_92:
    buffer_load_dwordx4 v[160:163], v1, s[52:55], s97 offen offset:2048 nt
    v_mfma_f32_16x16x32_bf16 v[32:35], v[24:27], v[144:147], v[32:35]
    v_lshrrev_b32 v9, 4, v0
    v_lshl_add_u32 v8, v9, 2, v2
    s_lshl_b32 s96, s3, 9
    s_add_u32 s96, s96, 157824
    v_lshl_add_u32 v8, v8, 2, s96
    v_lshlrev_b32 v9, 3, v0
    v_add_u32 v9, 157824, v9
    v_mov_b32 v10, 162048
    v_mov_b32 v11, 1
    s_lshl_b32 s96, s38, 5
    s_add_u32 s96, s96, 161984
    v_mov_b32 v3, s96
    s_sub_u32 s62, 8, s39
    s_lshl_b32 s98, s34, 5
    s_add_u32 s98, s98, s35
    s_lshl_b32 s98, s98, 8
    s_add_u32 s98, s98, 106496
    v_lshlrev_b32 v39, 2, v0
    v_and_b32_dpp v28, v18, v20 row_newbcast:12 row_mask:0xf bank_mask:0xf
    v_and_b32_dpp v29, v18, v21 row_newbcast:12 row_mask:0xf bank_mask:0xf
    v_and_b32_dpp v30, v18, v22 row_newbcast:12 row_mask:0xf bank_mask:0xf
    v_and_b32_dpp v31, v18, v23 row_newbcast:12 row_mask:0xf bank_mask:0xf
    s_waitcnt vmcnt(3)
    s_bitcmp0_b32 s14, 31
    s_cbranch_scc1 L_sf_93
    s_waitcnt vmcnt(2)
    s_bitcmp0_b32 s15, 31
    s_cbranch_scc1 L_sf_93
    s_waitcnt vmcnt(1)
L_sf_93:
    buffer_load_dwordx4 v[164:167], v1, s[52:55], s97 offen offset:3072 nt
    s_mov_b32 s97, 0
    v_add_u32 v1, 4096, v1
    v_and_b32 v1, 0x7fff, v1
    v_mfma_f32_16x16x32_bf16 v[32:35], v[28:31], v[148:151], v[32:35]
    s_cmp_eq_u32 s12, -1
    s_cbranch_scc1 L_v_nopf
    v_and_b32_dpp v40, v19, v20 row_newbcast:0 row_mask:0xf bank_mask:0xf
    v_and_b32_dpp v41, v19, v21 row_newbcast:0 row_mask:0xf bank_mask:0xf
    v_and_b32_dpp v42, v19, v22 row_newbcast:0 row_mask:0xf bank_mask:0xf
    v_and_b32_dpp v43, v19, v23 row_newbcast:0 row_mask:0xf bank_mask:0xf
    v_and_b32_dpp v44, v19, v20 row_newbcast:8 row_mask:0xf bank_mask:0xf
    v_and_b32_dpp v45, v19, v21 row_newbcast:8 row_mask:0xf bank_mask:0xf
    v_and_b32_dpp v46, v19, v22 row_newbcast:8 row_mask:0xf bank_mask:0xf
    v_and_b32_dpp v47, v19, v23 row_newbcast:8 row_mask:0xf bank_mask:0xf
    v_and_b32_dpp v48, v19, v20 row_newbcast:4 row_mask:0xf bank_mask:0xf
    v_and_b32_dpp v49, v19, v21 row_newbcast:4 row_mask:0xf bank_mask:0xf
    v_and_b32_dpp v50, v19, v22 row_newbcast:4 row_mask:0xf bank_mask:0xf
    v_and_b32_dpp v51, v19, v23 row_newbcast:4 row_mask:0xf bank_mask:0xf
    v_and_b32_dpp v52, v19, v20 row_newbcast:12 row_mask:0xf bank_mask:0xf
    v_and_b32_dpp v53, v19, v21 row_newbcast:12 row_mask:0xf bank_mask:0xf
    v_and_b32_dpp v54, v19, v22 row_newbcast:12 row_mask:0xf bank_mask:0xf
    v_and_b32_dpp v55, v19, v23 row_newbcast:12 row_mask:0xf bank_mask:0xf
    s_waitcnt vmcnt(3)
    v_mfma_f32_16x16x32_bf16 v[32:35], v[40:43], v[152:155], v[32:35]
    s_waitcnt vmcnt(2)
    v_mfma_f32_16x16x32_bf16 v[32:35], v[44:47], v[156:159], v[32:35]
    s_waitcnt vmcnt(1)
    v_mfma_f32_16x16x32_bf16 v[32:35], v[48:51], v[160:163], v[32:35]
    s_waitcnt vmcnt(0)
    v_mfma_f32_16x16x32_bf16 v[32:35], v[52:55], v[164:167], v[32:35]
L_v_join:
    s_cmp_lg_u32 s13, 0
    s_cbranch_scc1 L_jobend
L_t0:
    s_mov_b32 exec_hi, 0
    s_nop 4
    ds_write_b128 v8, v[32:35]
L_t0b:
    s_mov_b64 exec, 1
    ds_add_rtn_u32 v37, v10, v11
    s_mov_b64 exec, -1
    ds_read_b32 v38, v10 offset:24
    ds_read_b128 v[24:27], v3
    ds_read_b128 v[28:31], v3 offset:16
    ds_read_b64 v[144:145], v9 offset:0
    ds_read_b64 v[146:147], v9 offset:512
    ds_read_b64 v[148:149], v9 offset:1024
    ds_read_b64 v[150:151], v9 offset:1536
    ds_read_b64 v[152:153], v9 offset:2048
    ds_read_b64 v[154:155], v9 offset:2560
    ds_read_b64 v[156:157], v9 offset:3072
    ds_read_b64 v[158:159], v9 offset:3584
    s_waitcnt lgkmcnt(10)
    v_readfirstlane_b32 s96, v37
    v_readfirstlane_b32 s61, v38
    s_cmp_lg_u32 s96, s62
    s_cbranch_scc1 L_nopub
    s_waitcnt lgkmcnt(6)
    v_pk_mul_f32 v[144:145], v[144:145], v[24:25] op_sel:[0,0] op_sel_hi:[1,0]
    v_pk_mul_f32 v[146:147], v[146:147], v[24:25] op_sel:[0,1] op_sel_hi:[1,1]
    s_waitcnt lgkmcnt(4)
    v_pk_fma_f32 v[144:145], v[148:149], v[26:27], v[144:145] op_sel:[0,0,0] op_sel_hi:[1,0,1]
    v_pk_fma_f32 v[146:147], v[150:151], v[26:27], v[146:147] op_sel:[0,1,0] op_sel_hi:[1,1,1]
    s_waitcnt lgkmcnt(2)
    v_pk_fma_f32 v[144:145], v[152:153], v[28:29], v[144:145] op_sel:[0,0,0] op_sel_hi:[1,0,1]
    v_pk_fma_f32 v[146:147], v[154:155], v[28:29], v[146:147] op_sel:[0,1,0] op_sel_hi:[1,1,1]
    s_waitcnt lgkmcnt(0)
    v_pk_fma_f32 v[144:145], v[156:157], v[30:31], v[144:145] op_sel:[0,0,0] op_sel_hi:[1,0,1]
    v_pk_fma_f32 v[146:147], v[158:159], v[30:31], v[146:147] op_sel:[0,1,0] op_sel_hi:[1,1,1]
    s_cmp_eq_u32 s61, 1
    v_pk_add_f32 v[144:145], v[144:145], v[146:147]
    v_cvt_pk_bf16_f32 v32, v144, v145
    s_cbranch_scc0 L_oslow
    buffer_store_dword v32, v39, s[40:43], s98 offen
L_odone:
L_nopub:
    s_cmp_eq_u32 s59, 0
    s_cbranch_scc1 L_not1
L_poll_102:
    buffer_load_dwordx4 v[16:19], v105, s[40:43], s100 offen sc1
    buffer_load_dwordx4 v[20:23], v105, s[40:43], s100 offen offset:128 sc1
    s_sub_u32 s60, s60, 1
    s_cbranch_scc1 L_poll_102t
    s_waitcnt vmcnt(0)
    v_max3_u32 v38, v16, v17, v18
    v_max3_u32 v38, v38, v19, v20
    v_max3_u32 v38, v38, v21, v22
    v_max_u32 v38, v38, v23
    v_cmp_eq_u32 vcc, -1, v38
    s_cbranch_vccnz L_poll_102
L_poll_102e:
    v_smfmac_f32_16x16x64_bf16 v[112:115], v[16:19], v[72:79], v111
    v_smfmac_f32_16x16x64_bf16 v[116:119], v[16:19], v[80:87], v111
    v_smfmac_f32_16x16x64_bf16 v[112:115], v[20:23], v[88:95], v111
    v_smfmac_f32_16x16x64_bf16 v[116:119], v[20:23], v[96:103], v111
    s_nop 6
    v_pk_add_f32 v[112:113], v[112:113], v[114:115]
    v_pk_add_f32 v[116:117], v[116:117], v[118:119]
    v_add_f32 v12, v112, v113
    v_add_f32 v13, v116, v117
    ds_write2_b32 v106, v12, v13 offset0:0 offset1:32
    s_mov_b64 exec, 1
    ds_add_rtn_u32 v37, v109, v11
    s_mov_b64 exec, -1
    ds_read_b64 v[72:73], v107 offset:0
    ds_read_b64 v[74:75], v107 offset:16384
    ds_read_b64 v[76:77], v107 offset:32768
    ds_read_b64 v[78:79], v107 offset:49152
    s_cmp_eq_u32 s34, 2
    s_cselect_b32 s97, s61, 0
    s_waitcnt lgkmcnt(4)
    v_readfirstlane_b32 s96, v37
    s_waitcnt lgkmcnt(2)
    v_pk_add_f32 v[72:73], v[72:73], v[74:75]
    s_cmp_lg_u32 s96, 3
    s_cbranch_scc1 L_not1
    s_cmp_eq_u32 s97, 1
    s_waitcnt lgkmcnt(0)
    v_pk_add_f32 v[76:77], v[76:77], v[78:79]
    v_pk_add_f32 v[72:73], v[72:73], v[76:77]
    v_cvt_pk_bf16_f32 v12, v72, v73
    s_cbranch_scc1 L_pfast
    buffer_store_dword v12, v108, s[40:43], s101 offen sc1
    buffer_store_dword v12, v110, s[40:43], s101 offen sc1
L_pdone:
L_not1:
    s_waitcnt lgkmcnt(0)
    s_cmp_eq_u32 s39, 1
    s_cbranch_scc1 L_s_role
    s_cmp_eq_u32 s34, 2
    s_cselect_b32 s62, s59, 0
    s_cmp_eq_u32 s62, 1
    s_cbranch_scc1 L_refetch
L_norf:
    s_endpgm
L_k_nopf:
    s_waitcnt vmcnt(3)
    s_bitcmp0_b32 s57, 22
    s_cbranch_scc1 L_sf_58
    s_waitcnt vmcnt(2)
    s_bitcmp0_b32 s58, 22
    s_cbranch_scc1 L_sf_58
    s_waitcnt vmcnt(1)
L_sf_58:
    buffer_load_dwordx4 v[128:131], v1, s[48:51], s97 offen offset:2048 nt
    v_min_u32 v39, 15, v0
    v_and_b32 v38, 1, v39
    v_mul_u32_u24 v38, 126, v38
    v_lshl_add_u32 v39, v39, 1, v38
    buffer_load_dword v37, v39, s[44:47], 0 offen sc1
    s_waitcnt vmcnt(4)
    s_bitcmp0_b32 s57, 23
    s_cbranch_scc1 L_sf_59
    s_waitcnt vmcnt(3)
    s_bitcmp0_b32 s58, 23
    s_cbranch_scc1 L_sf_59
    s_waitcnt vmcnt(2)
L_sf_59:
    buffer_load_dwordx4 v[132:135], v1, s[48:51], s97 offen offset:3072 nt
    s_add_u32 s97, s97, 32768
    v_add_u32 v1, 4096, v1
    v_and_b32 v1, 0x7fff, v1
    s_waitcnt vmcnt(4)
    s_bitcmp0_b32 s57, 24
    s_cbranch_scc1 L_sf_60
    s_waitcnt vmcnt(3)
    s_bitcmp0_b32 s58, 24
    s_cbranch_scc1 L_sf_60
    s_waitcnt vmcnt(2)
L_sf_60:
    buffer_load_dwordx4 v[136:139], v1, s[48:51], s97 offen offset:0 nt
    s_waitcnt vmcnt(4)
    s_bitcmp0_b32 s57, 25
    s_cbranch_scc1 L_sf_61
    s_waitcnt vmcnt(3)
    s_bitcmp0_b32 s58, 25
    s_cbranch_scc1 L_sf_61
    s_waitcnt vmcnt(1)
L_sf_61:
    buffer_load_dwordx4 v[140:143], v1, s[48:51], s97 offen offset:1024 nt
    s_waitcnt vmcnt(4)
    s_bitcmp0_b32 s57, 26
    s_cbranch_scc1 L_sf_62
    s_waitcnt vmcnt(2)
    s_bitcmp0_b32 s58, 26
    s_cbranch_scc1 L_sf_62
    s_waitcnt vmcnt(1)
L_sf_62:
    buffer_load_dwordx4 v[144:147], v1, s[48:51], s97 offen offset:2048 nt
    s_waitcnt vmcnt(3)
    s_bitcmp0_b32 s57, 27
    s_cbranch_scc1 L_sf_63
    s_waitcnt vmcnt(2)
    s_bitcmp0_b32 s58, 27
    s_cbranch_scc1 L_sf_63
    s_waitcnt vmcnt(1)
L_sf_63:
    buffer_load_dwordx4 v[148:151], v1, s[48:51], s97 offen offset:3072 nt
    s_add_u32 s97, s97, 32768
    v_add_u32 v1, 4096, v1
    v_and_b32 v1, 0x7fff, v1
    v_cmp_eq_u32 vcc, 0, v37
    s_nop 0
    s_or_b32 s96, vcc_lo, vcc_hi
    buffer_load_dwordx4 v[4:7], v2, s[40:43], s98 offen sc1
    s_waitcnt vmcnt(4)
    s_bitcmp0_b32 s57, 28
    s_cbranch_scc1 L_sf_64
    s_waitcnt vmcnt(3)
    s_bitcmp0_b32 s58, 28
    s_cbranch_scc1 L_sf_64
    s_waitcnt vmcnt(2)
L_sf_64:
    buffer_load_dwordx4 v[152:155], v1, s[48:51], s97 offen offset:0 nt
    s_waitcnt vmcnt(4)
    s_bitcmp0_b32 s57, 29
    s_cbranch_scc1 L_sf_65
    s_waitcnt vmcnt(3)
    s_bitcmp0_b32 s58, 29
    s_cbranch_scc1 L_sf_65
    s_waitcnt vmcnt(2)
L_sf_65:
    buffer_load_dwordx4 v[156:159], v1, s[48:51], s97 offen offset:1024 nt
    s_waitcnt vmcnt(4)
    s_bitcmp0_b32 s57, 30
    s_cbranch_scc1 L_sf_66
    s_waitcnt vmcnt(3)
    s_bitcmp0_b32 s58, 30
    s_cbranch_scc1 L_sf_66
    s_waitcnt vmcnt(1)
L_sf_66:
    buffer_load_dwordx4 v[160:163], v1, s[48:51], s97 offen offset:2048 nt
    s_waitcnt vmcnt(4)
    s_bitcmp0_b32 s57, 31
    s_cbranch_scc1 L_sf_67
    s_waitcnt vmcnt(2)
    s_bitcmp0_b32 s58, 31
    s_cbranch_scc1 L_sf_67
    s_waitcnt vmcnt(1)
L_sf_67:
    buffer_load_dwordx4 v[164:167], v1, s[48:51], s97 offen offset:3072 nt
    s_mov_b32 s97, 0
    v_add_u32 v1, 4096, v1
    v_and_b32 v1, 0x7fff, v1
    v_add_u32 v1, 8192, v1
    v_and_b32 v1, 0x7fff, v1
    s_mov_b32 s97, 65536
    s_branch L_k_join
L_v_nopf:
    v_and_b32_dpp v24, v19, v20 row_newbcast:0 row_mask:0xf bank_mask:0xf
    v_and_b32_dpp v25, v19, v21 row_newbcast:0 row_mask:0xf bank_mask:0xf
    v_and_b32_dpp v26, v19, v22 row_newbcast:0 row_mask:0xf bank_mask:0xf
    v_and_b32_dpp v27, v19, v23 row_newbcast:0 row_mask:0xf bank_mask:0xf
    s_waitcnt vmcnt(3)
    s_bitcmp0_b32 s14, 0
    s_cbranch_scc1 L_sf_94
    s_waitcnt vmcnt(2)
    s_bitcmp0_b32 s15, 0
    s_cbranch_scc1 L_sf_94
    s_waitcnt vmcnt(1)
L_sf_94:
    buffer_load_dwordx4 v[40:43], v1, s[52:55], s97 offen offset:0 nt
    v_mfma_f32_16x16x32_bf16 v[32:35], v[24:27], v[152:155], v[32:35]
    v_and_b32_dpp v28, v19, v20 row_newbcast:8 row_mask:0xf bank_mask:0xf
    v_and_b32_dpp v29, v19, v21 row_newbcast:8 row_mask:0xf bank_mask:0xf
    v_and_b32_dpp v30, v19, v22 row_newbcast:8 row_mask:0xf bank_mask:0xf
    v_and_b32_dpp v31, v19, v23 row_newbcast:8 row_mask:0xf bank_mask:0xf
    s_waitcnt vmcnt(3)
    s_bitcmp0_b32 s14, 1
    s_cbranch_scc1 L_sf_95
    s_waitcnt vmcnt(2)
    s_bitcmp0_b32 s15, 1
    s_cbranch_scc1 L_sf_95
    s_waitcnt vmcnt(1)
L_sf_95:
    buffer_load_dwordx4 v[44:47], v1, s[52:55], s97 offen offset:1024 nt
    v_mfma_f32_16x16x32_bf16 v[32:35], v[28:31], v[156:159], v[32:35]
    v_and_b32_dpp v24, v19, v20 row_newbcast:4 row_mask:0xf bank_mask:0xf
    v_and_b32_dpp v25, v19, v21 row_newbcast:4 row_mask:0xf bank_mask:0xf
    v_and_b32_dpp v26, v19, v22 row_newbcast:4 row_mask:0xf bank_mask:0xf
    v_and_b32_dpp v27, v19, v23 row_newbcast:4 row_mask:0xf bank_mask:0xf
    s_waitcnt vmcnt(3)
    s_bitcmp0_b32 s14, 2
    s_cbranch_scc1 L_sf_96
    s_waitcnt vmcnt(2)
    s_bitcmp0_b32 s15, 2
    s_cbranch_scc1 L_sf_96
    s_waitcnt vmcnt(1)
L_sf_96:
    buffer_load_dwordx4 v[48:51], v1, s[52:55], s97 offen offset:2048 nt
    v_mfma_f32_16x16x32_bf16 v[32:35], v[24:27], v[160:163], v[32:35]
    v_and_b32_dpp v28, v19, v20 row_newbcast:12 row_mask:0xf bank_mask:0xf
    v_and_b32_dpp v29, v19, v21 row_newbcast:12 row_mask:0xf bank_mask:0xf
    v_and_b32_dpp v30, v19, v22 row_newbcast:12 row_mask:0xf bank_mask:0xf
    v_and_b32_dpp v31, v19, v23 row_newbcast:12 row_mask:0xf bank_mask:0xf
    s_waitcnt vmcnt(3)
    s_bitcmp0_b32 s14, 3
    s_cbranch_scc1 L_sf_97
    s_waitcnt vmcnt(2)
    s_bitcmp0_b32 s15, 3
    s_cbranch_scc1 L_sf_97
    s_waitcnt vmcnt(1)
L_sf_97:
    buffer_load_dwordx4 v[52:55], v1, s[52:55], s97 offen offset:3072 nt
    s_add_u32 s97, s97, 32768
    v_add_u32 v1, 4096, v1
    v_and_b32 v1, 0x7fff, v1
    v_mfma_f32_16x16x32_bf16 v[32:35], v[28:31], v[164:167], v[32:35]
    v_and_b32_dpp v24, v12, v20 row_newbcast:0 row_mask:0xf bank_mask:0xf
    v_and_b32_dpp v25, v12, v21 row_newbcast:0 row_mask:0xf bank_mask:0xf
    v_and_b32_dpp v26, v12, v22 row_newbcast:0 row_mask:0xf bank_mask:0xf
    v_and_b32_dpp v27, v12, v23 row_newbcast:0 row_mask:0xf bank_mask:0xf
    s_waitcnt vmcnt(3)
    s_bitcmp0_b32 s14, 4
    s_cbranch_scc1 L_sf_98
    s_waitcnt vmcnt(2)
    s_bitcmp0_b32 s15, 4
    s_cbranch_scc1 L_sf_98
    s_waitcnt vmcnt(1)
L_sf_98:
    buffer_load_dwordx4 v[56:59], v1, s[52:55], s97 offen offset:0 nt
    v_mfma_f32_16x16x32_bf16 v[32:35], v[24:27], v[40:43], v[32:35]
    v_and_b32_dpp v28, v12, v20 row_newbcast:8 row_mask:0xf bank_mask:0xf
    v_and_b32_dpp v29, v12, v21 row_newbcast:8 row_mask:0xf bank_mask:0xf
    v_and_b32_dpp v30, v12, v22 row_newbcast:8 row_mask:0xf bank_mask:0xf
    v_and_b32_dpp v31, v12, v23 row_newbcast:8 row_mask:0xf bank_mask:0xf
    s_waitcnt vmcnt(3)
    s_bitcmp0_b32 s14, 5
    s_cbranch_scc1 L_sf_99
    s_waitcnt vmcnt(2)
    s_bitcmp0_b32 s15, 5
    s_cbranch_scc1 L_sf_99
    s_waitcnt vmcnt(1)
L_sf_99:
    buffer_load_dwordx4 v[60:63], v1, s[52:55], s97 offen offset:1024 nt
    v_mfma_f32_16x16x32_bf16 v[32:35], v[28:31], v[44:47], v[32:35]
    v_and_b32_dpp v24, v12, v20 row_newbcast:4 row_mask:0xf bank_mask:0xf
    v_and_b32_dpp v25, v12, v21 row_newbcast:4 row_mask:0xf bank_mask:0xf
    v_and_b32_dpp v26, v12, v22 row_newbcast:4 row_mask:0xf bank_mask:0xf
    v_and_b32_dpp v27, v12, v23 row_newbcast:4 row_mask:0xf bank_mask:0xf
    s_waitcnt vmcnt(3)
    s_bitcmp0_b32 s14, 6
    s_cbranch_scc1 L_sf_100
    s_waitcnt vmcnt(2)
    s_bitcmp0_b32 s15, 6
    s_cbranch_scc1 L_sf_100
    s_waitcnt vmcnt(1)
L_sf_100:
    buffer_load_dwordx4 v[64:67], v1, s[52:55], s97 offen offset:2048 nt
    v_mfma_f32_16x16x32_bf16 v[32:35], v[24:27], v[48:51], v[32:35]
    v_and_b32_dpp v28, v12, v20 row_newbcast:12 row_mask:0xf bank_mask:0xf
    v_and_b32_dpp v29, v12, v21 row_newbcast:12 row_mask:0xf bank_mask:0xf
    v_and_b32_dpp v30, v12, v22 row_newbcast:12 row_mask:0xf bank_mask:0xf
    v_and_b32_dpp v31, v12, v23 row_newbcast:12 row_mask:0xf bank_mask:0xf
    s_waitcnt vmcnt(3)
    s_bitcmp0_b32 s14, 7
    s_cbranch_scc1 L_sf_101
    s_waitcnt vmcnt(2)
    s_bitcmp0_b32 s15, 7
    s_cbranch_scc1 L_sf_101
    s_waitcnt vmcnt(1)
L_sf_101:
    buffer_load_dwordx4 v[68:71], v1, s[52:55], s97 offen offset:3072 nt
    s_add_u32 s97, s97, 32768
    v_add_u32 v1, 4096, v1
    v_and_b32 v1, 0x7fff, v1
    v_mfma_f32_16x16x32_bf16 v[32:35], v[28:31], v[52:55], v[32:35]
    v_and_b32_dpp v24, v13, v20 row_newbcast:0 row_mask:0xf bank_mask:0xf
    v_and_b32_dpp v25, v13, v21 row_newbcast:0 row_mask:0xf bank_mask:0xf
    v_and_b32_dpp v26, v13, v22 row_newbcast:0 row_mask:0xf bank_mask:0xf
    v_and_b32_dpp v27, v13, v23 row_newbcast:0 row_mask:0xf bank_mask:0xf
    s_waitcnt vmcnt(3)
    s_nop 0
    v_mfma_f32_16x16x32_bf16 v[32:35], v[24:27], v[56:59], v[32:35]
    v_and_b32_dpp v28, v13, v20 row_newbcast:8 row_mask:0xf bank_mask:0xf
    v_and_b32_dpp v29, v13, v21 row_newbcast:8 row_mask:0xf bank_mask:0xf
    v_and_b32_dpp v30, v13, v22 row_newbcast:8 row_mask:0xf bank_mask:0xf
    v_and_b32_dpp v31, v13, v23 row_newbcast:8 row_mask:0xf bank_mask:0xf
    s_waitcnt vmcnt(2)
    s_nop 0
    v_mfma_f32_16x16x32_bf16 v[32:35], v[28:31], v[60:63], v[32:35]
    v_and_b32_dpp v24, v13, v20 row_newbcast:4 row_mask:0xf bank_mask:0xf
    v_and_b32_dpp v25, v13, v21 row_newbcast:4 row_mask:0xf bank_mask:0xf
    v_and_b32_dpp v26, v13, v22 row_newbcast:4 row_mask:0xf bank_mask:0xf
    v_and_b32_dpp v27, v13, v23 row_newbcast:4 row_mask:0xf bank_mask:0xf
    s_waitcnt vmcnt(1)
    s_nop 0
    v_mfma_f32_16x16x32_bf16 v[32:35], v[24:27], v[64:67], v[32:35]
    v_and_b32_dpp v28, v13, v20 row_newbcast:12 row_mask:0xf bank_mask:0xf
    v_and_b32_dpp v29, v13, v21 row_newbcast:12 row_mask:0xf bank_mask:0xf
    v_and_b32_dpp v30, v13, v22 row_newbcast:12 row_mask:0xf bank_mask:0xf
    v_and_b32_dpp v31, v13, v23 row_newbcast:12 row_mask:0xf bank_mask:0xf
    s_waitcnt vmcnt(0)
    s_nop 0
    v_mfma_f32_16x16x32_bf16 v[32:35], v[28:31], v[68:71], v[32:35]
    s_branch L_v_join
L_oslow:
    buffer_store_dword v32, v39, s[40:43], s98 offen sc1
    s_branch L_odone
L_refetch:
    s_lshr_b32 s62, s3, 2
    s_mul_i32 s62, s62, 5
    s_add_u32 s62, s62, s35
    s_sub_u32 s62, s62, 27
    s_cmp_ge_u32 s62, 7
    s_cbranch_scc1 L_norf
    s_add_u32 s62, s62, 3
    s_and_b32 s62, s62, 7
    s_mul_i32 s62, s62, 5120
    v_mov_b32 v8, 162048
L_lw_103:
    ds_read_b32 v9, v8
    s_waitcnt lgkmcnt(0)
    v_cmp_gt_u32 vcc, 9, v9
    s_cbranch_vccz L_lw_103e
    s_sleep 2
    s_sub_u32 s60, s60, 1
    s_cbranch_scc0 L_lw_103
    s_mov_b32 s60, 0
L_lw_103e:
    ds_read_b32 v9, v8 offset:36
    v_lshlrev_b32 v5, 4, v0
    v_add_u32 v5, 212992, v5
    s_add_u32 s4, s62, 0
    s_and_b32 s63, s4, 0xffffe000
    s_add_u32 s4, s4, s63
    s_add_u32 s5, s62, 1024
    s_and_b32 s63, s5, 0xffffe000
    s_add_u32 s5, s5, s63
    s_add_u32 s6, s62, 2048
    s_and_b32 s63, s6, 0xffffe000
    s_add_u32 s6, s6, s63
    s_add_u32 s7, s62, 3072
    s_and_b32 s63, s7, 0xffffe000
    s_add_u32 s7, s7, s63
    s_add_u32 s8, s62, 4096
    s_and_b32 s63, s8, 0xffffe000
    s_add_u32 s8, s8, s63
    s_waitcnt lgkmcnt(0)
    v_add_u32 v5, v5, v9
L_poll_104:
    buffer_load_dwordx4 v[12:15], v5, s[40:43], s4 offen sc1
    buffer_load_dwordx4 v[16:19], v5, s[40:43], s5 offen sc1
    buffer_load_dwordx4 v[20:23], v5, s[40:43], s6 offen sc1
    buffer_load_dwordx4 v[24:27], v5, s[40:43], s7 offen sc1
    buffer_load_dwordx4 v[28:31], v5, s[40:43], s8 offen sc1
    s_sub_u32 s60, s60, 1
    s_cbranch_scc1 L_poll_104t
    s_waitcnt vmcnt(0)
    v_max3_u32 v3, v12, v16, v20
    v_max3_u32 v3, v3, v24, v28
    v_cmp_eq_u32 vcc, -1, v3
    s_cbranch_vccnz L_poll_104
L_poll_104e:
    s_branch L_norf
L_qslow:
L_wy_105:
    buffer_load_dword v37, v39, s[44:47], 0 offen sc1
    s_waitcnt vmcnt(0)
    v_cmp_ne_u32 vcc, -1, v37
    s_cbranch_vccz L_wy_105e
    s_sleep 4
    s_sub_u32 s60, s60, 1
    s_cbranch_scc0 L_wy_105
    s_mov_b32 s60, 0
L_wy_105e:
L_qslow2:
    s_branch L_poll_106
L_poll_106s:
    s_sleep 2
L_poll_106:
    buffer_load_dwordx4 v[4:7], v2, s[40:43], s98 offen sc1
    s_sub_u32 s60, s60, 1
    s_cbranch_scc1 L_poll_106t
    s_waitcnt vmcnt(0)
    v_max3_u32 v38, v4, v5, v6
    v_max_u32 v38, v38, v7
    v_cmp_eq_u32 vcc, -1, v38
    s_cbranch_vccnz L_poll_106s
L_poll_106e:
    s_branch L_qok
L_mljob:
    s_lshl4_add_u32 s96, s35, s3
    s_lshl_b32 s96, s96, 3
    s_add_u32 s96, s96, 81920
    buffer_store_dwordx2 v[8:9], v36, s[40:43], s96 offen sc1
    s_branch L_mldone
L_service:
    v_mov_b32 v72, 0
    v_mov_b32 v73, 0
    v_mov_b32 v74, 0
    v_mov_b32 v75, 0
    v_mov_b32 v76, 0
    s_mov_b32 s59, 0
    v_mov_b32 v5, 0
    v_mov_b32 v105, 0
    v_mov_b32 v108, 0
    v_mov_b32 v110, 0
    v_mov_b32 v160, 0
    v_mov_b32 v163, 0
    v_mov_b32 v8, 162068
L_lw_107:
    ds_read_b32 v9, v8
    s_waitcnt lgkmcnt(0)
    v_cmp_gt_u32 vcc, 8, v9
    s_cbranch_vccz L_lw_107e
    s_sleep 8
    s_sub_u32 s60, s60, 1
    s_cbranch_scc0 L_lw_107
    s_mov_b32 s60, 0
L_lw_107e:
    v_and_b32 v2, 15, v0
    v_lshlrev_b32 v2, 3, v2
    v_add_u32 v3, 161920, v2
    ds_read_b64 v[8:9], v3
    v_mov_b32 v11, 162096
    ds_read_b32 v11, v11
    s_getreg_b32 s58, hwreg(HW_REG_XCC_ID, 0, 4)
    s_lshl_b32 s98, s34, 5
    s_add_u32 s98, s98, s35
    s_lshl_b32 s62, s98, 7
    s_add_u32 s62, s62, 73728
    s_and_b32 s99, s62, 0xffffff00
    s_lshl_b32 s98, s98, 8
    s_add_u32 s98, s98, 106496
    v_lshlrev_b32 v39, 2, v0
    v_and_b32 v21, 64, v2
    v_add_u32 v21, v21, v2
    v_cmp_eq_u32 vcc, 8, v0
    s_bfm_b64 exec, 8, 0
    s_bitset1_b32 exec_lo, 8
    s_waitcnt lgkmcnt(0)
    v_lshl_add_u32 v10, v11, 8, s58
    v_cndmask_b32 v8, v8, v10, vcc
    buffer_store_dwordx2 v[8:9], v2, s[40:43], s62 offen sc1
    s_mov_b64 exec, -1
    v_mov_b32 v12, 162076
L_lw_108:
    ds_read_b32 v13, v12
    s_waitcnt lgkmcnt(0)
    v_cmp_gt_u32 vcc, 4, v13
    s_cbranch_vccz L_lw_108e
    s_sleep 4
    s_sub_u32 s60, s60, 1
    s_cbranch_scc0 L_lw_108
    s_mov_b32 s60, 0
L_lw_108e:
    v_and_b32 v11, 31, v0
    v_lshlrev_b32 v11, 7, v11
    s_lshl_b32 s63, s34, 12
    s_add_u32 s63, s63, 73792
    buffer_load_dword v12, v39, s[40:43], s98 offen sc1
    s_branch L_poll_109
L_poll_109s:
    s_sleep 16
L_poll_109:
    buffer_load_dwordx2 v[8:9], v21, s[40:43], s99 offen sc1
    buffer_load_dword v10, v11, s[40:43], s63 offen sc1
    s_sub_u32 s60, s60, 1
    s_cbranch_scc1 L_poll_109t
    s_waitcnt vmcnt(0)
    v_max3_u32 v38, v8, v9, v10
    v_cmp_eq_u32 vcc, -1, v38
    s_cbranch_vccnz L_poll_109s
L_poll_109e:
    v_mov_b32 v37, v8
    s_nop 1
    v_max_f32_dpp v37, v37, v37 quad_perm:[1,0,3,2] row_mask:0xf bank_mask:0xf
    s_nop 1
    v_max_f32_dpp v37, v37, v37 quad_perm:[2,3,0,1] row_mask:0xf bank_mask:0xf
    s_nop 1
    v_max_f32_dpp v37, v37, v37 row_ror:4 row_mask:0xf bank_mask:0xf
    s_nop 1
    v_max_f32_dpp v37, v37, v37 row_ror:8 row_mask:0xf bank_mask:0xf
    v_sub_f32 v8, v8, v37
    v_exp_f32 v8, v8
    s_nop 0
    v_mul_f32 v9, v8, v9
    s_nop 1
    v_add_f32_dpp v9, v9, v9 quad_perm:[1,0,3,2] row_mask:0xf bank_mask:0xf
    s_nop 1
    v_add_f32_dpp v9, v9, v9 quad_perm:[2,3,0,1] row_mask:0xf bank_mask:0xf
    s_nop 1
    v_add_f32_dpp v9, v9, v9 row_ror:4 row_mask:0xf bank_mask:0xf
    s_nop 1
    v_add_f32_dpp v9, v9, v9 row_ror:8 row_mask:0xf bank_mask:0xf
    v_ashrrev_i32 v12, 8, v10
    s_nop 1
    v_add_u32_dpp v12, v12, v12 quad_perm:[1,0,3,2] row_mask:0xf bank_mask:0xf
    s_nop 1
    v_add_u32_dpp v12, v12, v12 quad_perm:[2,3,0,1] row_mask:0xf bank_mask:0xf
    s_nop 1
    v_add_u32_dpp v12, v12, v12 row_ror:4 row_mask:0xf bank_mask:0xf
    s_nop 1
    v_add_u32_dpp v12, v12, v12 row_ror:8 row_mask:0xf bank_mask:0xf
    v_mov_b32 v13, v12
    s_nop 1
    v_permlane16_swap_b32 v12, v13
    v_add_u32 v12, v12, v13
    v_mov_b32 v13, v12
    s_nop 1
    v_permlane32_swap_b32 v12, v13
    v_add_u32 v12, v12, v13
    v_ashrrev_i32 v12, 31, v12
    v_and_b32 v12, 8192, v12
    v_mov_b32 v13, 162084
    ds_write_b32 v13, v12
    v_and_b32 v10, 0xff, v10
    s_getreg_b32 s62, hwreg(HW_REG_XCC_ID, 0, 4)
    v_cmp_ne_u32 vcc, s62, v10
    s_nop 0
    s_cmp_eq_u64 vcc, 0
    s_cselect_b32 s61, 1, 0
    v_rcp_f32 v9, v9
    v_lshrrev_b32 v3, 1, v2
    v_add_u32 v3, 161984, v3
    v_mul_f32 v8, v8, v9
    v_mov_b32 v10, 162072
    v_mov_b32 v11, s61
    ds_write_b32 v3, v8
    ds_write_b32 v10, v11
    s_mov_b32 s3, 1
    v_lshrrev_b32 v9, 4, v0
    v_lshl_add_u32 v8, v9, 2, v2
    s_lshl_b32 s96, s3, 9
    s_add_u32 s96, s96, 157824
    v_lshl_add_u32 v8, v8, 2, s96
    v_lshlrev_b32 v9, 3, v0
    v_add_u32 v9, 157824, v9
    v_mov_b32 v10, 162048
    v_mov_b32 v11, 1
    s_lshl_b32 s96, s38, 5
    s_add_u32 s96, s96, 161984
    v_mov_b32 v3, s96
    s_sub_u32 s62, 8, s39
    s_lshl_b32 s98, s34, 5
    s_add_u32 s98, s98, s35
    s_lshl_b32 s98, s98, 8
    s_add_u32 s98, s98, 106496
    v_lshlrev_b32 v39, 2, v0
    s_branch L_t0b
L_jobend:
    v_lshlrev_b32 v9, 4, v0
    s_mov_b32 exec_hi, 0
    s_nop 3
    buffer_store_dwordx4 v[32:35], v9, s[40:43], s13 offen sc1
    s_endpgm
L_proxy:
    v_mov_b32 v72, 0
    v_mov_b32 v73, 0
    v_mov_b32 v74, 0
    v_mov_b32 v75, 0
    v_mov_b32 v76, 0
    v_mov_b32 v5, 0
    v_mov_b32 v105, 0
    v_mov_b32 v108, 0
    v_mov_b32 v110, 0
    v_mov_b32 v160, 0
    v_mov_b32 v163, 0
    s_barrier
    s_waitcnt lgkmcnt(0)
    s_barrier
    s_mov_b32 s40, s32
    s_mov_b32 s41, s33
    s_mov_b32 s42, 589824
    s_mov_b32 s43, 0x20000
    s_mov_b32 s44, s30
    s_mov_b32 s45, s31
    s_mov_b32 s46, 256
    s_mov_b32 s47, 0x20000
    s_sub_u32 s97, 7, s3
    s_mul_i32 s97, s97, 27
    s_cmp_eq_u32 s3, 5
    s_cselect_b32 s97, 32, s97
    s_add_u32 s97, s97, s35
    s_lshl_b32 s97, s97, 9
    s_add_u32 s97, s97, 172032
    v_and_b32 v2, 15, v0
    v_lshlrev_b32 v2, 3, v2
    v_and_b32 v20, 31, v0
    v_lshlrev_b32 v20, 4, v20
    s_cmp_lg_u32 s3, 7
    s_cbranch_scc1 L_px6
    s_sub_u32 s96, 6, s59
    s_mul_i32 s62, s35, 5120
    s_add_u32 s62, s62, 327680
    v_lshl_add_u32 v22, v0, 4, s62
    v_add_u32 v23, 4096, v22
    v_mov_b32 v24, -1
    v_mov_b32 v25, -1
    v_mov_b32 v26, -1
    v_mov_b32 v27, -1
    v_mov_b32 v8, 162068
L_lw_110:
    ds_read_b32 v9, v8
    s_waitcnt lgkmcnt(0)
    v_cmp_gt_u32 vcc, s96, v9
    s_cbranch_vccz L_lw_110e
    s_sleep 8
    s_sub_u32 s60, s60, 1
    s_cbranch_scc0 L_lw_110
    s_mov_b32 s60, 0
L_lw_110e:
    v_and_b32 v2, 15, v0
    v_lshlrev_b32 v2, 3, v2
    v_add_u32 v3, 161920, v2
    ds_read_b64 v[8:9], v3
    v_mov_b32 v11, 162096
    ds_read_b32 v11, v11
    s_getreg_b32 s58, hwreg(HW_REG_XCC_ID, 0, 4)
    s_lshl_b32 s98, s34, 5
    s_add_u32 s98, s98, s35
    s_lshl_b32 s62, s98, 7
    s_add_u32 s62, s62, 73728
    s_and_b32 s99, s62, 0xffffff00
    s_lshl_b32 s98, s98, 8
    s_add_u32 s98, s98, 106496
    v_lshlrev_b32 v39, 2, v0
    v_and_b32 v21, 64, v2
    v_add_u32 v21, v21, v2
    v_cmp_eq_u32 vcc, 8, v0
    s_bfm_b64 exec, s96, 0
    s_bitset1_b32 exec_lo, 8
    s_waitcnt lgkmcnt(0)
    v_lshl_add_u32 v10, v11, 8, s58
    v_cndmask_b32 v8, v8, v10, vcc
    buffer_store_dwordx2 v[8:9], v2, s[40:43], s62 offen sc1
    s_mov_b64 exec, -1
    buffer_load_dwordx4 v[120:123], v22, s[40:43], 0 offen offset:0 sc1
    buffer_load_dwordx4 v[124:127], v22, s[40:43], 0 offen offset:1024 sc1
    buffer_load_dwordx4 v[128:131], v22, s[40:43], 0 offen offset:2048 sc1
    buffer_load_dwordx4 v[132:135], v22, s[40:43], 0 offen offset:3072 sc1
    buffer_load_dwordx4 v[136:139], v23, s[40:43], 0 offen offset:0 sc1
    s_mov_b32 s100, 4
    s_lshl_b32 s63, s100, 8
    v_and_b32 v8, 15, v0
    v_lshl_add_u32 v8, v8, 4, s63
    v_lshrrev_b32 v9, 4, v0
    v_mul_u32_u24 v5, 1280, v9
    v_add_u32 v5, v5, v8
    v_mul_u32_u24 v4, 1296, v9
    v_add_u32 v4, v4, v8
    v_add_u32 v4, 82944, v4
    v_lshlrev_b32 v6, 1, v5
    v_add_u32 v6, 99328, v6
    s_lshl_b32 s62, s100, 9
    s_add_u32 s62, s62, 88128
    v_lshl_add_u32 v7, v0, 3, s62
    s_mov_b32 s48, s4
    s_mov_b32 s49, s5
    s_mov_b32 s50, 5120
    s_mov_b32 s51, 0x20000
    buffer_load_dwordx4 v[8:11], v5, s[48:51], 0 offen
    s_mov_b32 s62, 20480
    s_mov_b32 s63, 30720
    s_branch L_poll_111
L_poll_111s:
    s_sleep 32
L_poll_111:
    buffer_load_dwordx4 v[12:15], v5, s[40:43], s62 offen sc1
    buffer_load_dwordx4 v[16:19], v5, s[40:43], s63 offen sc1
    s_sub_u32 s60, s60, 1
    s_cbranch_scc1 L_poll_111t
    s_waitcnt vmcnt(0)
    v_max3_u32 v38, v12, v13, v14
    v_max3_u32 v38, v38, v15, v16
    v_max3_u32 v38, v38, v17, v18
    v_max_u32 v38, v38, v19
    v_cmp_eq_u32 vcc, -1, v38
    s_cbranch_vccnz L_poll_111s
L_poll_111e:
    v_lshlrev_b32 v40, 16, v8
    v_and_b32 v41, 0xffff0000, v8
    v_lshlrev_b32 v42, 16, v9
    v_and_b32 v43, 0xffff0000, v9
    v_lshlrev_b32 v44, 16, v10
    v_and_b32 v45, 0xffff0000, v10
    v_lshlrev_b32 v46, 16, v11
    v_and_b32 v47, 0xffff0000, v11
    v_lshlrev_b32 v48, 16, v12
    v_and_b32 v49, 0xffff0000, v12
    v_lshlrev_b32 v50, 16, v13
    v_and_b32 v51, 0xffff0000, v13
    v_lshlrev_b32 v52, 16, v14
    v_and_b32 v53, 0xffff0000, v14
    v_lshlrev_b32 v54, 16, v15
    v_and_b32 v55, 0xffff0000, v15
    v_lshlrev_b32 v56, 16, v16
    v_and_b32 v57, 0xffff0000, v16
    v_lshlrev_b32 v58, 16, v17
    v_and_b32 v59, 0xffff0000, v17
    v_lshlrev_b32 v60, 16, v18
    v_and_b32 v61, 0xffff0000, v18
    v_lshlrev_b32 v62, 16, v19
    v_and_b32 v63, 0xffff0000, v19
    v_mov_b32 v64, 0
    v_mov_b32 v65, 0
    v_mov_b32 v66, 0
    v_mov_b32 v67, 0
    v_mov_b32 v68, 0
    v_mov_b32 v69, 0
    v_mov_b32 v70, 0
    v_mov_b32 v71, 0
    v_bfe_u32 v5, v0, 2, 2
    v_lshlrev_b32 v5, 8, v5
    v_lshrrev_b32 v8, 4, v0
    v_lshl_add_u32 v5, v8, 6, v5
    v_and_b32 v8, 3, v0
    v_lshl_add_u32 v5, v8, 4, v5
    s_lshl_b32 s56, s100, 10
    s_or_b32 s96, s59, 0
    s_cbranch_scc0 L_nofrag_112
    v_mov_b32 v104, 162060
L_lw_113:
    ds_read_b32 v105, v104
    s_waitcnt lgkmcnt(0)
    v_cmp_gt_u32 vcc, 4, v105
    s_cbranch_vccz L_lw_113e
    s_sleep 2
    s_sub_u32 s60, s60, 1
    s_cbranch_scc0 L_lw_113
    s_mov_b32 s60, 0
L_lw_113e:
    s_cmp_eq_u32 s59, 0
    s_cbranch_scc1 L_nofrag_112
    v_bfe_u32 v104, v0, 2, 1
    v_bfe_u32 v110, v0, 4, 1
    v_lshl_add_u32 v104, v110, 2, v104
    v_and_b32 v110, 8, v0
    v_add_u32 v104, v104, v110
    v_lshrrev_b32 v110, 5, v0
    v_lshl_add_u32 v104, v110, 4, v104
    v_bfe_u32 v111, v0, 0, 1
    v_mul_u32_u24 v111, 0xaaaa, v111
    v_add_u32 v111, 0x4444, v111
    v_mov_b32 v112, 0
    v_mov_b32 v113, 0
    v_mov_b32 v114, 0
    v_mov_b32 v115, 0
    v_mov_b32 v116, 0
    v_mov_b32 v117, 0
    v_mov_b32 v118, 0
    v_mov_b32 v119, 0
    v_lshlrev_b32 v104, 7, v104
    v_and_b32 v110, 3, v0
    v_lshl_add_u32 v104, v110, 3, v104
    v_lshrrev_b32 v109, 4, v0
    v_and_b32 v110, 1, v0
    s_lshr_b32 s63, s3, 1
    s_and_b32 s62, s3, 1
    s_lshl_b32 s96, s63, 14
    s_lshl_b32 s100, s62, 6
    s_add_u32 s100, s100, 81920
    s_add_u32 s96, s96, s100
    v_add_u32 v104, s96, v104
    ds_read_b64_tr_b16 v[72:73], v104 offset:0
    ds_read_b64_tr_b16 v[74:75], v104 offset:256
    ds_read_b64_tr_b16 v[76:77], v104 offset:4096
    ds_read_b64_tr_b16 v[78:79], v104 offset:4352
    ds_read_b64_tr_b16 v[80:81], v104 offset:32
    ds_read_b64_tr_b16 v[82:83], v104 offset:288
    ds_read_b64_tr_b16 v[84:85], v104 offset:4128
    ds_read_b64_tr_b16 v[86:87], v104 offset:4384
    ds_read_b64_tr_b16 v[88:89], v104 offset:8192
    ds_read_b64_tr_b16 v[90:91], v104 offset:8448
    ds_read_b64_tr_b16 v[92:93], v104 offset:12288
    ds_read_b64_tr_b16 v[94:95], v104 offset:12544
    ds_read_b64_tr_b16 v[96:97], v104 offset:8224
    ds_read_b64_tr_b16 v[98:99], v104 offset:8480
    ds_read_b64_tr_b16 v[100:101], v104 offset:12320
    ds_read_b64_tr_b16 v[102:103], v104 offset:12576
    v_bfe_u32 v105, v0, 1, 3
    v_lshlrev_b32 v105, 8, v105
    v_lshl_add_u32 v105, v109, 5, v105
    v_lshl_add_u32 v105, v110, 4, v105
    v_lshrrev_b32 v106, 3, v0
    v_lshlrev_b32 v106, 7, v106
    v_and_b32 v110, 7, v0
    v_lshl_add_u32 v107, v110, 3, v106
    v_add_u32 v107, s100, v107
    v_lshlrev_b32 v106, 8, v109
    v_and_b32 v110, 15, v0
    v_lshl_add_u32 v106, v110, 2, v106
    v_add_u32 v106, s96, v106
    v_lshlrev_b32 v108, 2, v0
    s_lshl_b32 s96, s62, 2
    s_add_u32 s96, s96, 162088
    v_mov_b32 v109, s96
    s_lshl_b32 s100, s63, 11
    s_lshl_b32 s96, s34, 13
    s_add_u32 s100, s100, s96
    s_add_u32 s100, s100, 106496
    s_mul_i32 s101, s34, 5120
    s_lshl_b32 s96, s35, 9
    s_add_u32 s101, s101, s96
    s_lshl_b32 s96, s62, 8
    s_add_u32 s101, s101, s96
    s_sub_u32 s101, s101, 11264
    s_and_b32 s96, s101, 0xffffe000
    s_add_u32 s101, s101, s96
    s_add_u32 s101, s101, 212992
    v_add_u32 v110, 8192, v108
L_nofrag_112:
    s_cmp_ge_u32 s35, 20
    s_cbranch_scc1 L_nofin_114
    s_lshl1_add_u32 s62, s35, s3
    s_sub_u32 s62, s62, 6
    s_lshl_b32 s57, s62, 7
    s_mul_i32 s63, s62, 0x199a
    s_lshr_b32 s63, s63, 16
    s_mul_i32 s63, s63, 1280
    s_sub_u32 s63, s57, s63
    v_lshrrev_b32 v72, 3, v0
    v_mul_u32_u24 v72, 5120, v72
    v_and_b32 v8, 7, v0
    v_lshl_add_u32 v72, v8, 4, v72
    s_add_u32 s62, s57, 327680
    v_add_u32 v72, s62, v72
    v_add_u32 v73, 40960, v72
    v_add_u32 v74, 81920, v72
    v_add_u32 v75, 122880, v72
    v_bfe_u32 v9, v0, 4, 1
    v_lshlrev_b32 v76, 4, v8
    v_lshl_add_u32 v76, v9, 3, v76
    s_lshl_b32 s62, s57, 1
    s_add_u32 s62, s62, 99328
    v_lshl_add_u32 v77, v76, 1, s62
    s_mov_b32 s48, s22
    s_mov_b32 s49, s23
    s_mov_b32 s50, 1280
    s_mov_b32 s51, 0x20000
    buffer_load_dwordx2 v[86:87], v76, s[48:51], s63 offen
    s_add_u32 s62, s57, 35840
    s_branch L_poll_115
L_poll_115s:
    s_sleep 32
L_poll_115:
    buffer_load_dwordx2 v[8:9], v76, s[40:43], s62 offen sc1
    s_sub_u32 s60, s60, 1
    s_cbranch_scc1 L_poll_115t
    s_waitcnt vmcnt(0)
    v_max_u32 v38, v8, v9
    v_cmp_eq_u32 vcc, -1, v38
    s_cbranch_vccnz L_poll_115s
L_poll_115e:
    v_lshlrev_b32 v78, 16, v86
    v_and_b32 v79, 0xffff0000, v86
    v_lshlrev_b32 v82, 16, v8
    v_and_b32 v83, 0xffff0000, v8
    v_lshlrev_b32 v80, 16, v87
    v_and_b32 v81, 0xffff0000, v87
    v_lshlrev_b32 v84, 16, v9
    v_and_b32 v85, 0xffff0000, v9
    v_bfe_u32 v8, v0, 1, 3
    v_and_b32 v9, 1, v0
    v_lshlrev_b32 v9, 4, v9
    v_mov_b32 v10, 0x3f80
    v_lshlrev_b32 v9, v9, v10
    v_cmp_eq_u32 vcc, 0, v8
    v_mov_b32 v100, 0
    s_nop 0
    v_cndmask_b32 v104, 0, v9, vcc
    v_cmp_eq_u32 vcc, 1, v8
    v_mov_b32 v101, 0
    s_nop 0
    v_cndmask_b32 v105, 0, v9, vcc
    v_cmp_eq_u32 vcc, 2, v8
    v_mov_b32 v102, 0
    s_nop 0
    v_cndmask_b32 v106, 0, v9, vcc
    v_cmp_eq_u32 vcc, 3, v8
    v_mov_b32 v103, 0
    s_nop 0
    v_cndmask_b32 v107, 0, v9, vcc
L_nofin_114:
    v_mov_b32 v12, 162076
L_lw_116:
    ds_read_b32 v13, v12
    s_waitcnt lgkmcnt(0)
    v_cmp_gt_u32 vcc, 4, v13
    s_cbranch_vccz L_lw_116e
    s_sleep 4
    s_sub_u32 s60, s60, 1
    s_cbranch_scc0 L_lw_116
    s_mov_b32 s60, 0
L_lw_116e:
    v_and_b32 v11, 31, v0
    v_lshlrev_b32 v11, 7, v11
    s_lshl_b32 s63, s34, 12
    s_add_u32 s63, s63, 73792
    buffer_load_dword v12, v39, s[40:43], s98 offen sc1
    s_branch L_poll_117
L_poll_117s:
    s_sleep 2
L_poll_117:
    buffer_load_dwordx2 v[8:9], v21, s[40:43], s99 offen sc1
    buffer_load_dword v10, v11, s[40:43], s63 offen sc1
    s_sub_u32 s60, s60, 1
    s_cbranch_scc1 L_poll_117t
    s_waitcnt vmcnt(0)
    v_max3_u32 v38, v8, v9, v10
    v_cmp_eq_u32 vcc, -1, v38
    s_cbranch_vccnz L_poll_117s
L_poll_117e:
    v_mov_b32 v37, v8
    s_nop 1
    v_max_f32_dpp v37, v37, v37 quad_perm:[1,0,3,2] row_mask:0xf bank_mask:0xf
    s_nop 1
    v_max_f32_dpp v37, v37, v37 quad_perm:[2,3,0,1] row_mask:0xf bank_mask:0xf
    s_nop 1
    v_max_f32_dpp v37, v37, v37 row_ror:4 row_mask:0xf bank_mask:0xf
    s_nop 1
    v_max_f32_dpp v37, v37, v37 row_ror:8 row_mask:0xf bank_mask:0xf
    v_sub_f32 v8, v8, v37
    v_exp_f32 v8, v8
    s_nop 0
    v_mul_f32 v9, v8, v9
    s_nop 1
    v_add_f32_dpp v9, v9, v9 quad_perm:[1,0,3,2] row_mask:0xf bank_mask:0xf
    s_nop 1
    v_add_f32_dpp v9, v9, v9 quad_perm:[2,3,0,1] row_mask:0xf bank_mask:0xf
    s_nop 1
    v_add_f32_dpp v9, v9, v9 row_ror:4 row_mask:0xf bank_mask:0xf
    s_nop 1
    v_add_f32_dpp v9, v9, v9 row_ror:8 row_mask:0xf bank_mask:0xf
    v_ashrrev_i32 v12, 8, v10
    s_nop 1
    v_add_u32_dpp v12, v12, v12 quad_perm:[1,0,3,2] row_mask:0xf bank_mask:0xf
    s_nop 1
    v_add_u32_dpp v12, v12, v12 quad_perm:[2,3,0,1] row_mask:0xf bank_mask:0xf
    s_nop 1
    v_add_u32_dpp v12, v12, v12 row_ror:4 row_mask:0xf bank_mask:0xf
    s_nop 1
    v_add_u32_dpp v12, v12, v12 row_ror:8 row_mask:0xf bank_mask:0xf
    v_mov_b32 v13, v12
    s_nop 1
    v_permlane16_swap_b32 v12, v13
    v_add_u32 v12, v12, v13
    v_mov_b32 v13, v12
    s_nop 1
    v_permlane32_swap_b32 v12, v13
    v_add_u32 v12, v12, v13
    v_ashrrev_i32 v12, 31, v12
    v_and_b32 v12, 8192, v12
    v_mov_b32 v13, 162084
    ds_write_b32 v13, v12
    v_and_b32 v10, 0xff, v10
    s_getreg_b32 s62, hwreg(HW_REG_XCC_ID, 0, 4)
    v_cmp_ne_u32 vcc, s62, v10
    s_nop 0
    s_cmp_eq_u64 vcc, 0
    s_cselect_b32 s61, 1, 0
    v_rcp_f32 v9, v9
    v_lshrrev_b32 v3, 1, v2
    v_add_u32 v3, 161984, v3
    v_mul_f32 v8, v8, v9
    v_mov_b32 v10, 162072
    v_mov_b32 v11, s61
    ds_write_b32 v3, v8
    ds_write_b32 v10, v11
    s_cmp_eq_u32 s61, 1
    s_cbranch_scc0 L_ycs
    buffer_store_dwordx4 v[24:27], v22, s[40:43], 0 offen offset:0
    buffer_store_dwordx4 v[24:27], v22, s[40:43], 0 offen offset:1024
    buffer_store_dwordx4 v[24:27], v22, s[40:43], 0 offen offset:2048
    buffer_store_dwordx4 v[24:27], v22, s[40:43], 0 offen offset:3072
    buffer_store_dwordx4 v[24:27], v23, s[40:43], 0 offen offset:0
L_ycd:
    s_branch L_poll_118
L_poll_118s:
    s_sleep 2
L_poll_118:
    buffer_load_dwordx4 v[32:35], v20, s[40:43], s97 offen sc1
    s_sub_u32 s60, s60, 1
    s_cbranch_scc1 L_poll_118t
    s_waitcnt vmcnt(0)
    v_max3_u32 v38, v32, v33, v34
    v_max_u32 v38, v38, v35
    v_cmp_eq_u32 vcc, -1, v38
    s_cbranch_vccnz L_poll_118s
L_poll_118e:
    s_branch L_pxj
L_px6:
    s_mov_b32 s62, 3
    s_lshl1_add_u32 s96, s35, s3
    s_and_b32 s63, s96, 7
    s_lshl_b32 s63, s63, 14
    s_lshl_b32 s96, s96, 7
    s_add_u32 s96, s96, s63
    s_add_u32 s96, s96, 475136
    s_add_u32 s98, s32, s96
    s_addc_u32 s99, s33, 0
    s_load_dword s4, s[98:99], 0 glc
    s_load_dword s5, s[98:99], 8192 glc
    s_mov_b32 s63, 0
    s_waitcnt lgkmcnt(0)
L_np:
    s_not_b32 s4, s4
    s_mov_b32 s6, s4
    s_mov_b32 s7, 0
    s_load_dword s4, s[98:99], 0 glc
L_npc0:
    s_add_u32 s7, s7, 1
    s_cmp_eq_u32 s4, s6
    s_cselect_b32 s8, s7, 1000
    s_cmp_lt_u32 s8, 60
    s_cbranch_scc1 L_npc0
    s_waitcnt lgkmcnt(0)
    s_sub_u32 s63, s63, s7
    s_not_b32 s5, s5
    s_mov_b32 s6, s5
    s_mov_b32 s7, 0
    s_load_dword s5, s[98:99], 8192 glc
L_npc1:
    s_add_u32 s7, s7, 1
    s_cmp_eq_u32 s5, s6
    s_cselect_b32 s8, s7, 1000
    s_cmp_lt_u32 s8, 60
    s_cbranch_scc1 L_npc1
    s_waitcnt lgkmcnt(0)
    s_add_u32 s63, s63, s7
    s_sub_u32 s62, s62, 1
    s_cmp_lg_u32 s62, 0
    s_cbranch_scc1 L_np
    v_mov_b32 v8, 162096
    v_mov_b32 v9, s63
    s_mov_b64 exec, 1
    ds_add_u32 v8, v9
    s_mov_b64 exec, -1
    s_or_b32 s96, s59, 0
    s_cbranch_scc0 L_nofrag_119
    v_mov_b32 v104, 162060
L_lw_120:
    ds_read_b32 v105, v104
    s_waitcnt lgkmcnt(0)
    v_cmp_gt_u32 vcc, 4, v105
    s_cbranch_vccz L_lw_120e
    s_sleep 2
    s_sub_u32 s60, s60, 1
    s_cbranch_scc0 L_lw_120
    s_mov_b32 s60, 0
L_lw_120e:
    s_cmp_eq_u32 s59, 0
    s_cbranch_scc1 L_nofrag_119
    v_bfe_u32 v104, v0, 2, 1
    v_bfe_u32 v110, v0, 4, 1
    v_lshl_add_u32 v104, v110, 2, v104
    v_and_b32 v110, 8, v0
    v_add_u32 v104, v104, v110
    v_lshrrev_b32 v110, 5, v0
    v_lshl_add_u32 v104, v110, 4, v104
    v_bfe_u32 v111, v0, 0, 1
    v_mul_u32_u24 v111, 0xaaaa, v111
    v_add_u32 v111, 0x4444, v111
    v_mov_b32 v112, 0
    v_mov_b32 v113, 0
    v_mov_b32 v114, 0
    v_mov_b32 v115, 0
    v_mov_b32 v116, 0
    v_mov_b32 v117, 0
    v_mov_b32 v118, 0
    v_mov_b32 v119, 0
    v_lshlrev_b32 v104, 7, v104
    v_and_b32 v110, 3, v0
    v_lshl_add_u32 v104, v110, 3, v104
    v_lshrrev_b32 v109, 4, v0
    v_and_b32 v110, 1, v0
    s_lshr_b32 s63, s3, 1
    s_and_b32 s62, s3, 1
    s_lshl_b32 s96, s63, 14
    s_lshl_b32 s100, s62, 6
    s_add_u32 s100, s100, 81920
    s_add_u32 s96, s96, s100
    v_add_u32 v104, s96, v104
    ds_read_b64_tr_b16 v[72:73], v104 offset:0
    ds_read_b64_tr_b16 v[74:75], v104 offset:256
    ds_read_b64_tr_b16 v[76:77], v104 offset:4096
    ds_read_b64_tr_b16 v[78:79], v104 offset:4352
    ds_read_b64_tr_b16 v[80:81], v104 offset:32
    ds_read_b64_tr_b16 v[82:83], v104 offset:288
    ds_read_b64_tr_b16 v[84:85], v104 offset:4128
    ds_read_b64_tr_b16 v[86:87], v104 offset:4384
    ds_read_b64_tr_b16 v[88:89], v104 offset:8192
    ds_read_b64_tr_b16 v[90:91], v104 offset:8448
    ds_read_b64_tr_b16 v[92:93], v104 offset:12288
    ds_read_b64_tr_b16 v[94:95], v104 offset:12544
    ds_read_b64_tr_b16 v[96:97], v104 offset:8224
    ds_read_b64_tr_b16 v[98:99], v104 offset:8480
    ds_read_b64_tr_b16 v[100:101], v104 offset:12320
    ds_read_b64_tr_b16 v[102:103], v104 offset:12576
    v_bfe_u32 v105, v0, 1, 3
    v_lshlrev_b32 v105, 8, v105
    v_lshl_add_u32 v105, v109, 5, v105
    v_lshl_add_u32 v105, v110, 4, v105
    v_lshrrev_b32 v106, 3, v0
    v_lshlrev_b32 v106, 7, v106
    v_and_b32 v110, 7, v0
    v_lshl_add_u32 v107, v110, 3, v106
    v_add_u32 v107, s100, v107
    v_lshlrev_b32 v106, 8, v109
    v_and_b32 v110, 15, v0
    v_lshl_add_u32 v106, v110, 2, v106
    v_add_u32 v106, s96, v106
    v_lshlrev_b32 v108, 2, v0
    s_lshl_b32 s96, s62, 2
    s_add_u32 s96, s96, 162088
    v_mov_b32 v109, s96
    s_lshl_b32 s100, s63, 11
    s_lshl_b32 s96, s34, 13
    s_add_u32 s100, s100, s96
    s_add_u32 s100, s100, 106496
    s_mul_i32 s101, s34, 5120
    s_lshl_b32 s96, s35, 9
    s_add_u32 s101, s101, s96
    s_lshl_b32 s96, s62, 8
    s_add_u32 s101, s101, s96
    s_sub_u32 s101, s101, 11264
    s_and_b32 s96, s101, 0xffffe000
    s_add_u32 s101, s101, s96
    s_add_u32 s101, s101, 212992
    v_add_u32 v110, 8192, v108
L_nofrag_119:
    v_mov_b32 v8, 162068
L_lw_121:
    ds_read_b32 v9, v8
    s_waitcnt lgkmcnt(0)
    v_cmp_gt_u32 vcc, 1, v9
    s_cbranch_vccz L_lw_121e
    s_sleep 32
    s_sub_u32 s60, s60, 1
    s_cbranch_scc0 L_lw_121
    s_mov_b32 s60, 0
L_lw_121e:
    s_cmp_ge_u32 s35, 20
    s_cbranch_scc1 L_nofin_122
    s_lshl1_add_u32 s62, s35, s3
    s_sub_u32 s62, s62, 6
    s_lshl_b32 s57, s62, 7
    s_mul_i32 s63, s62, 0x199a
    s_lshr_b32 s63, s63, 16
    s_mul_i32 s63, s63, 1280
    s_sub_u32 s63, s57, s63
    v_lshrrev_b32 v72, 3, v0
    v_mul_u32_u24 v72, 5120, v72
    v_and_b32 v8, 7, v0
    v_lshl_add_u32 v72, v8, 4, v72
    s_add_u32 s62, s57, 327680
    v_add_u32 v72, s62, v72
    v_add_u32 v73, 40960, v72
    v_add_u32 v74, 81920, v72
    v_add_u32 v75, 122880, v72
    v_bfe_u32 v9, v0, 4, 1
    v_lshlrev_b32 v76, 4, v8
    v_lshl_add_u32 v76, v9, 3, v76
    s_lshl_b32 s62, s57, 1
    s_add_u32 s62, s62, 99328
    v_lshl_add_u32 v77, v76, 1, s62
    s_mov_b32 s48, s22
    s_mov_b32 s49, s23
    s_mov_b32 s50, 1280
    s_mov_b32 s51, 0x20000
    buffer_load_dwordx2 v[86:87], v76, s[48:51], s63 offen
    s_add_u32 s62, s57, 35840
    s_branch L_poll_123
L_poll_123s:
    s_sleep 32
L_poll_123:
    buffer_load_dwordx2 v[8:9], v76, s[40:43], s62 offen sc1
    s_sub_u32 s60, s60, 1
    s_cbranch_scc1 L_poll_123t
    s_waitcnt vmcnt(0)
    v_max_u32 v38, v8, v9
    v_cmp_eq_u32 vcc, -1, v38
    s_cbranch_vccnz L_poll_123s
L_poll_123e:
    v_lshlrev_b32 v78, 16, v86
    v_and_b32 v79, 0xffff0000, v86
    v_lshlrev_b32 v82, 16, v8
    v_and_b32 v83, 0xffff0000, v8
    v_lshlrev_b32 v80, 16, v87
    v_and_b32 v81, 0xffff0000, v87
    v_lshlrev_b32 v84, 16, v9
    v_and_b32 v85, 0xffff0000, v9
    v_bfe_u32 v8, v0, 1, 3
    v_and_b32 v9, 1, v0
    v_lshlrev_b32 v9, 4, v9
    v_mov_b32 v10, 0x3f80
    v_lshlrev_b32 v9, v9, v10
    v_cmp_eq_u32 vcc, 0, v8
    v_mov_b32 v100, 0
    s_nop 0
    v_cndmask_b32 v104, 0, v9, vcc
    v_cmp_eq_u32 vcc, 1, v8
    v_mov_b32 v101, 0
    s_nop 0
    v_cndmask_b32 v105, 0, v9, vcc
    v_cmp_eq_u32 vcc, 2, v8
    v_mov_b32 v102, 0
    s_nop 0
    v_cndmask_b32 v106, 0, v9, vcc
    v_cmp_eq_u32 vcc, 3, v8
    v_mov_b32 v103, 0
    s_nop 0
    v_cndmask_b32 v107, 0, v9, vcc
L_nofin_122:
    v_mov_b32 v8, 162076
L_lw_124:
    ds_read_b32 v9, v8
    s_waitcnt lgkmcnt(0)
    v_cmp_gt_u32 vcc, 4, v9
    s_cbranch_vccz L_lw_124e
    s_sleep 16
    s_sub_u32 s60, s60, 1
    s_cbranch_scc0 L_lw_124
    s_mov_b32 s60, 0
L_lw_124e:
    s_branch L_poll_125
L_poll_125s:
    s_sleep 2
L_poll_125:
    buffer_load_dwordx4 v[32:35], v20, s[40:43], s97 offen sc1
    s_sub_u32 s60, s60, 1
    s_cbranch_scc1 L_poll_125t
    s_waitcnt vmcnt(0)
    v_max3_u32 v38, v32, v33, v34
    v_max_u32 v38, v38, v35
    v_cmp_eq_u32 vcc, -1, v38
    s_cbranch_vccnz L_poll_125s
L_poll_125e:
L_pxj:
    s_cmp_ge_u32 s35, 20
    s_cbranch_scc1 L_pxk
    s_mov_b64 exec, -1
L_pxk:
    v_mov_b32 v8, 162048
L_lw_126:
    ds_read_b32 v9, v8
    s_waitcnt lgkmcnt(0)
    v_cmp_gt_u32 vcc, 3, v9
    s_cbranch_vccz L_lw_126e
    s_sleep 2
    s_sub_u32 s60, s60, 1
    s_cbranch_scc0 L_lw_126
    s_mov_b32 s60, 0
L_lw_126e:
    v_lshrrev_b32 v9, 4, v0
    v_lshl_add_u32 v8, v9, 2, v2
    s_lshl_b32 s96, s3, 9
    s_add_u32 s96, s96, 157824
    v_lshl_add_u32 v8, v8, 2, s96
    v_lshlrev_b32 v9, 3, v0
    v_add_u32 v9, 157824, v9
    v_mov_b32 v10, 162048
    v_mov_b32 v11, 1
    s_lshl_b32 s96, s38, 5
    s_add_u32 s96, s96, 161984
    v_mov_b32 v3, s96
    s_sub_u32 s62, 8, s39
    s_lshl_b32 s98, s34, 5
    s_add_u32 s98, s98, s35
    s_lshl_b32 s98, s98, 8
    s_add_u32 s98, s98, 106496
    v_lshlrev_b32 v39, 2, v0
    s_branch L_t0
L_s_role:
    s_cmp_eq_u32 s3, 7
    s_cbranch_scc1 L_t2gate
    s_cmp_gt_u32 s3, 3
    s_cbranch_scc1 L_fin_prep
    s_mov_b32 s48, s18
    s_mov_b32 s49, s19
    s_mov_b32 s50, 3456
    s_mov_b32 s51, 0x20000
    v_lshrrev_b32 v3, 4, v0
    v_and_b32 v4, 15, v0
    v_lshlrev_b32 v4, 1, v4
    s_lshl_b32 s62, s35, 7
    s_lshl_b32 s63, s3, 5
    s_add_u32 s62, s62, s63
    buffer_load_ushort v82, v4, s[48:51], s62 offen
    v_mov_b32 v72, 162064
L_lw_127:
    ds_read_b32 v73, v72
    s_waitcnt lgkmcnt(0)
    v_cmp_gt_u32 vcc, 4, v73
    s_cbranch_vccz L_lw_127e
    s_sleep 2
    s_sub_u32 s60, s60, 1
    s_cbranch_scc0 L_lw_127
    s_mov_b32 s60, 0
L_lw_127e:
    v_bfe_u32 v72, v0, 2, 1
    v_bfe_u32 v73, v0, 4, 1
    v_lshl_add_u32 v72, v73, 2, v72
    v_and_b32 v73, 8, v0
    v_add_u32 v72, v72, v73
    v_lshrrev_b32 v73, 5, v0
    v_lshl_add_u32 v72, v73, 4, v72
    v_lshlrev_b32 v72, 7, v72
    v_and_b32 v73, 3, v0
    v_lshl_add_u32 v72, v73, 3, v72
    v_and_b32 v73, 8, v0
    v_lshl_add_u32 v72, v73, 3, v72
    v_xor_b32 v72, s63, v72
    v_xor_b32 v73, 32, v72
    v_add_u32 v74, 40960, v72
    v_add_u32 v75, 40960, v73
    v_bfe_u32 v1, v0, 2, 2
    v_bfe_u32 v2, v0, 1, 1
    v_and_b32 v6, 1, v0
    v_lshlrev_b32 v7, 5, v3
    v_lshl_add_u32 v7, v6, 4, v7
    v_lshl_add_u32 v5, v2, 2, v1
    v_mul_u32_u24 v5, 1296, v5
    v_add_u32 v5, v5, v7
    v_add_u32 v5, 147456, v5
    v_bfe_u32 v87, v0, 0, 1
    v_mul_u32_u24 v87, 0xaaaa, v87
    v_add_u32 v87, 0x4444, v87
    ds_read_b64_tr_b16 v[88:89], v72 offset:0
    ds_read_b64_tr_b16 v[90:91], v73 offset:256
    ds_read_b64_tr_b16 v[92:93], v72 offset:4096
    ds_read_b64_tr_b16 v[94:95], v73 offset:4352
    ds_read_b64_tr_b16 v[96:97], v72 offset:8192
    ds_read_b64_tr_b16 v[98:99], v73 offset:8448
    ds_read_b64_tr_b16 v[100:101], v72 offset:12288
    ds_read_b64_tr_b16 v[102:103], v73 offset:12544
    ds_read_b64_tr_b16 v[104:105], v72 offset:16384
    ds_read_b64_tr_b16 v[106:107], v73 offset:16640
    ds_read_b64_tr_b16 v[108:109], v72 offset:20480
    ds_read_b64_tr_b16 v[110:111], v73 offset:20736
    ds_read_b64_tr_b16 v[112:113], v72 offset:24576
    ds_read_b64_tr_b16 v[114:115], v73 offset:24832
    ds_read_b64_tr_b16 v[116:117], v72 offset:28672
    ds_read_b64_tr_b16 v[118:119], v73 offset:28928
    ds_read_b64_tr_b16 v[120:121], v72 offset:32768
    ds_read_b64_tr_b16 v[122:123], v73 offset:33024
    ds_read_b64_tr_b16 v[124:125], v72 offset:36864
    ds_read_b64_tr_b16 v[126:127], v73 offset:37120
    ds_read_b64_tr_b16 v[128:129], v74 offset:0
    ds_read_b64_tr_b16 v[130:131], v75 offset:256
    ds_read_b64_tr_b16 v[132:133], v74 offset:4096
    ds_read_b64_tr_b16 v[134:135], v75 offset:4352
    ds_read_b64_tr_b16 v[136:137], v74 offset:8192
    ds_read_b64_tr_b16 v[138:139], v75 offset:8448
    ds_read_b64_tr_b16 v[140:141], v74 offset:12288
    ds_read_b64_tr_b16 v[142:143], v75 offset:12544
    ds_read_b64_tr_b16 v[144:145], v74 offset:16384
    ds_read_b64_tr_b16 v[146:147], v75 offset:16640
    ds_read_b64_tr_b16 v[148:149], v74 offset:20480
    ds_read_b64_tr_b16 v[150:151], v75 offset:20736
    ds_read_b64_tr_b16 v[152:153], v74 offset:24576
    ds_read_b64_tr_b16 v[154:155], v75 offset:24832
    ds_read_b64_tr_b16 v[156:157], v74 offset:28672
    ds_read_b64_tr_b16 v[158:159], v75 offset:28928
    ds_read_b64_tr_b16 v[160:161], v74 offset:32768
    ds_read_b64_tr_b16 v[162:163], v75 offset:33024
    ds_read_b64_tr_b16 v[164:165], v74 offset:36864
    ds_read_b64_tr_b16 v[166:167], v75 offset:37120
    ds_read_b128 v[8:11], v5 offset:0
    ds_read_b128 v[12:15], v5 offset:128
    ds_read_b128 v[16:19], v5 offset:256
    ds_read_b128 v[20:23], v5 offset:384
    ds_read_b128 v[24:27], v5 offset:512
    ds_read_b128 v[28:31], v5 offset:640
    ds_read_b128 v[32:35], v5 offset:768
    ds_read_b128 v[36:39], v5 offset:896
    ds_read_b128 v[40:43], v5 offset:1024
    ds_read_b128 v[44:47], v5 offset:1152
    v_mov_b32 v48, 0
    v_mov_b32 v49, 0
    v_mov_b32 v50, 0
    v_mov_b32 v51, 0
    v_mov_b32 v52, 0
    v_mov_b32 v53, 0
    v_mov_b32 v54, 0
    v_mov_b32 v55, 0
    v_mov_b32 v56, 0
    v_mov_b32 v57, 0
    v_mov_b32 v58, 0
    v_mov_b32 v59, 0
    s_waitcnt lgkmcnt(9)
    v_smfmac_f32_16x16x64_bf16 v[48:51], v[8:11], v[88:95], v87
    s_waitcnt lgkmcnt(8)
    v_smfmac_f32_16x16x64_bf16 v[48:51], v[12:15], v[96:103], v87
    s_waitcnt lgkmcnt(7)
    v_smfmac_f32_16x16x64_bf16 v[48:51], v[16:19], v[104:111], v87
    s_waitcnt lgkmcnt(6)
    v_smfmac_f32_16x16x64_bf16 v[48:51], v[20:23], v[112:119], v87
    s_waitcnt lgkmcnt(5)
    v_smfmac_f32_16x16x64_bf16 v[48:51], v[24:27], v[120:127], v87
    s_waitcnt lgkmcnt(4)
    v_smfmac_f32_16x16x64_bf16 v[48:51], v[28:31], v[128:135], v87
    s_waitcnt lgkmcnt(3)
    v_smfmac_f32_16x16x64_bf16 v[48:51], v[32:35], v[136:143], v87
    s_waitcnt lgkmcnt(2)
    v_smfmac_f32_16x16x64_bf16 v[48:51], v[36:39], v[144:151], v87
    s_waitcnt lgkmcnt(1)
    v_smfmac_f32_16x16x64_bf16 v[48:51], v[40:43], v[152:159], v87
    s_waitcnt lgkmcnt(0)
    v_smfmac_f32_16x16x64_bf16 v[48:51], v[44:47], v[160:167], v87
    v_mul_u32_u24 v79, 1296, v1
    v_lshl_add_u32 v79, v2, 7, v79
    v_add_u32 v79, v79, v7
    v_add_u32 v79, 82944, v79
    v_mul_u32_u24 v80, 144, v3
    v_add3_u32 v80, v80, v4, s63
    v_add_u32 v80, 90688, v80
    v_lshlrev_b32 v81, 3, v0
    v_add_u32 v81, 88128, v81
    v_add_f32 v84, v48, v49
    v_add_f32 v85, v50, v51
    s_mov_b32 s62, 0xbacccccd
    s_mov_b32 s63, 0xbdd2d3e8
    v_mov_b32 v86, 0xc0135761
    s_waitcnt vmcnt(0)
    v_lshlrev_b32 v82, 16, v82
    v_add_f32 v85, v85, v82
    s_branch L_ffn1
L_fin_prep:
    s_cmp_lg_u32 s3, 6
    s_cbranch_scc1 L_end
    s_cmp_ge_u32 s35, 20
    s_cbranch_scc1 L_end
    s_barrier
L_fin:
    s_mov_b32 s52, s28
    s_mov_b32 s53, s29
    s_mov_b32 s54, 5120
    s_mov_b32 s55, 0x20000
    s_mov_b64 s[4:5], -1
    s_mov_b64 s[6:7], -1
    s_mov_b64 s[8:9], -1
    s_mov_b64 s[10:11], 0xffffff
    s_barrier
    ds_read_b128 v[108:111], v77
    s_waitcnt lgkmcnt(0)
    v_pk_fma_f32 v[108:109], v[78:79], v[82:83], v[108:109]
    v_pk_fma_f32 v[110:111], v[80:81], v[84:85], v[110:111]
    s_barrier
L_yg:
    s_mov_b64 exec, s[4:5]
    buffer_load_dwordx4 v[88:91], v72, s[40:43], 0 offen sc1
    s_mov_b64 exec, s[6:7]
    buffer_load_dwordx4 v[92:95], v73, s[40:43], 0 offen sc1
    s_mov_b64 exec, s[8:9]
    buffer_load_dwordx4 v[96:99], v74, s[40:43], 0 offen sc1
    s_mov_b64 exec, s[10:11]
    buffer_load_dwordx4 v[100:103], v75, s[40:43], 0 offen sc1
    s_mov_b64 exec, -1
    s_sub_u32 s60, s60, 1
    s_cbranch_scc1 L_ygt
    s_waitcnt vmcnt(3)
    v_max3_u32 v3, v88, v89, v90
    v_max_u32 v3, v3, v91
    v_cmp_eq_u32 s[4:5], -1, v3
    v_mfma_f32_16x16x32_bf16 v[112:115], v[104:107], v[88:91], 0
    s_waitcnt vmcnt(2)
    v_max3_u32 v3, v92, v93, v94
    v_max_u32 v3, v3, v95
    v_cmp_eq_u32 s[6:7], -1, v3
    v_mfma_f32_16x16x32_bf16 v[112:115], v[104:107], v[92:95], v[112:115]
    s_waitcnt vmcnt(1)
    v_max3_u32 v3, v96, v97, v98
    v_max_u32 v3, v3, v99
    v_cmp_eq_u32 s[8:9], -1, v3
    v_mfma_f32_16x16x32_bf16 v[112:115], v[104:107], v[96:99], v[112:115]
    s_waitcnt vmcnt(0)
    v_max3_u32 v3, v100, v101, v102
    v_max_u32 v3, v3, v103
    v_cmp_eq_u32 s[10:11], -1, v3
    v_mfma_f32_16x16x32_bf16 v[112:115], v[104:107], v[100:103], v[112:115]
    s_or_b64 s[16:17], s[4:5], s[6:7]
    s_or_b64 s[16:17], s[16:17], s[8:9]
    s_or_b64 s[16:17], s[16:17], s[10:11]
    s_cbranch_scc1 L_yg
L_ygd:
    s_nop 3
    v_add_f32_dpp v112, v112, v112 row_ror:8 row_mask:0xf bank_mask:0xf
    v_add_f32_dpp v113, v113, v113 row_ror:8 row_mask:0xf bank_mask:0xf
    v_add_f32_dpp v114, v114, v114 row_ror:8 row_mask:0xf bank_mask:0xf
    v_add_f32_dpp v115, v115, v115 row_ror:8 row_mask:0xf bank_mask:0xf
    v_pk_fma_f32 v[112:113], v[112:113], v[82:83], v[108:109]
    v_pk_fma_f32 v[114:115], v[114:115], v[84:85], v[110:111]
    v_cvt_pk_bf16_f32 v112, v112, v113
    v_cvt_pk_bf16_f32 v113, v114, v115
    s_mov_b64 exec, 0x00ff00ff
    buffer_store_dwordx2 v[112:113], v76, s[52:55], s57 offen
    s_endpgm
L_t2gate:
    v_mov_b32 v8, 162048
L_lw_128:
    ds_read_b32 v9, v8
    s_waitcnt lgkmcnt(0)
    v_cmp_gt_u32 vcc, 8, v9
    s_cbranch_vccz L_lw_128e
    s_sleep 2
    s_sub_u32 s60, s60, 1
    s_cbranch_scc0 L_lw_128
    s_mov_b32 s60, 0
L_lw_128e:
    ds_read_b32 v9, v8 offset:24
    ds_read_b32 v10, v8 offset:36
    v_add_u32 v5, 212992, v5
    s_waitcnt lgkmcnt(0)
    v_readfirstlane_b32 s61, v9
    v_add_u32 v5, v5, v10
    s_mov_b32 s58, 0x3f80
    s_mov_b32 s59, 0x3f800000
    s_mov_b32 s63, 0xff
L_prb:
    s_bcnt1_i32_b32 s62, s63
    s_mov_b32 s97, s63
    s_ff1_i32_b32 s12, s97
    s_bitset0_b32 s97, s12
    s_mul_i32 s4, s12, 5120
    s_add_u32 s4, s4, s56
    s_and_b32 s96, s4, 0xffffe000
    s_add_u32 s4, s4, s96
    s_cmp_eq_u32 s62, 1
    s_cbranch_scc1 L_pi1
    s_ff1_i32_b32 s13, s97
    s_bitset0_b32 s97, s13
    s_mul_i32 s5, s13, 5120
    s_add_u32 s5, s5, s56
    s_and_b32 s96, s5, 0xffffe000
    s_add_u32 s5, s5, s96
    s_cmp_eq_u32 s62, 2
    s_cbranch_scc1 L_pi2
    s_ff1_i32_b32 s14, s97
    s_bitset0_b32 s97, s14
    s_mul_i32 s6, s14, 5120
    s_add_u32 s6, s6, s56
    s_and_b32 s96, s6, 0xffffe000
    s_add_u32 s6, s6, s96
    s_cmp_eq_u32 s62, 3
    s_cbranch_scc1 L_pi3
    s_ff1_i32_b32 s15, s97
    s_bitset0_b32 s97, s15
    s_mul_i32 s7, s15, 5120
    s_add_u32 s7, s7, s56
    s_and_b32 s96, s7, 0xffffe000
    s_add_u32 s7, s7, s96
    s_cmp_eq_u32 s62, 4
    s_cbranch_scc1 L_pi4
    s_ff1_i32_b32 s16, s97
    s_bitset0_b32 s97, s16
    s_mul_i32 s8, s16, 5120
    s_add_u32 s8, s8, s56
    s_and_b32 s96, s8, 0xffffe000
    s_add_u32 s8, s8, s96
    s_cmp_eq_u32 s62, 5
    s_cbranch_scc1 L_pi5
    s_ff1_i32_b32 s17, s97
    s_bitset0_b32 s97, s17
    s_mul_i32 s9, s17, 5120
    s_add_u32 s9, s9, s56
    s_and_b32 s96, s9, 0xffffe000
    s_add_u32 s9, s9, s96
    s_cmp_eq_u32 s62, 6
    s_cbranch_scc1 L_pi6
    s_ff1_i32_b32 s18, s97
    s_bitset0_b32 s97, s18
    s_mul_i32 s10, s18, 5120
    s_add_u32 s10, s10, s56
    s_and_b32 s96, s10, 0xffffe000
    s_add_u32 s10, s10, s96
    s_cmp_eq_u32 s62, 7
    s_cbranch_scc1 L_pi7
    s_ff1_i32_b32 s19, s97
    s_bitset0_b32 s97, s19
    s_mul_i32 s11, s19, 5120
    s_add_u32 s11, s11, s56
    s_and_b32 s96, s11, 0xffffe000
    s_add_u32 s11, s11, s96
L_pi8:
    buffer_load_dwordx4 v[36:39], v5, s[40:43], s11 offen sc1
L_pi7:
    buffer_load_dwordx4 v[32:35], v5, s[40:43], s10 offen sc1
L_pi6:
    buffer_load_dwordx4 v[28:31], v5, s[40:43], s9 offen sc1
L_pi5:
    buffer_load_dwordx4 v[24:27], v5, s[40:43], s8 offen sc1
L_pi4:
    buffer_load_dwordx4 v[20:23], v5, s[40:43], s7 offen sc1
L_pi3:
    buffer_load_dwordx4 v[16:19], v5, s[40:43], s6 offen sc1
L_pi2:
    buffer_load_dwordx4 v[12:15], v5, s[40:43], s5 offen sc1
    buffer_load_dwordx4 v[8:11], v5, s[40:43], s4 offen sc1
    s_sub_u32 s60, s60, 1
    s_cbranch_scc1 L_pto
    s_waitcnt vmcnt(0)
    v_max3_u32 v3, v8, v9, v10
    v_max_u32 v3, v3, v11
    v_cmp_eq_u32 vcc, -1, v3
    s_cbranch_vccz L_pgot0
    v_max3_u32 v3, v12, v13, v14
    v_max_u32 v3, v3, v15
    v_cmp_eq_u32 vcc, -1, v3
    s_cbranch_vccz L_pgot1
    s_cmp_eq_u32 s62, 2
    s_cbranch_scc1 L_pi2
    v_max3_u32 v3, v16, v17, v18
    v_max_u32 v3, v3, v19
    v_cmp_eq_u32 vcc, -1, v3
    s_cbranch_vccz L_pgot2
    s_cmp_eq_u32 s62, 3
    s_cbranch_scc1 L_pi3
    v_max3_u32 v3, v20, v21, v22
    v_max_u32 v3, v3, v23
    v_cmp_eq_u32 vcc, -1, v3
    s_cbranch_vccz L_pgot3
    s_cmp_eq_u32 s62, 4
    s_cbranch_scc1 L_pi4
    v_max3_u32 v3, v24, v25, v26
    v_max_u32 v3, v3, v27
    v_cmp_eq_u32 vcc, -1, v3
    s_cbranch_vccz L_pgot4
    s_cmp_eq_u32 s62, 5
    s_cbranch_scc1 L_pi5
    v_max3_u32 v3, v28, v29, v30
    v_max_u32 v3, v3, v31
    v_cmp_eq_u32 vcc, -1, v3
    s_cbranch_vccz L_pgot5
    s_cmp_eq_u32 s62, 6
    s_cbranch_scc1 L_pi6
    v_max3_u32 v3, v32, v33, v34
    v_max_u32 v3, v3, v35
    v_cmp_eq_u32 vcc, -1, v3
    s_cbranch_vccz L_pgot6
    s_cmp_eq_u32 s62, 7
    s_cbranch_scc1 L_pi7
    v_max3_u32 v3, v36, v37, v38
    v_max_u32 v3, v3, v39
    v_cmp_eq_u32 vcc, -1, v3
    s_cbranch_vccz L_pgot7
    s_branch L_pi8
L_pgot0:
    v_dot2c_f32_bf16 v64, s58, v8
    v_dot2c_f32_bf16 v65, s59, v8
    v_dot2c_f32_bf16 v66, s58, v9
    v_dot2c_f32_bf16 v67, s59, v9
    v_dot2c_f32_bf16 v68, s58, v10
    v_dot2c_f32_bf16 v69, s59, v10
    v_dot2c_f32_bf16 v70, s58, v11
    v_dot2c_f32_bf16 v71, s59, v11
    s_bitset0_b32 s63, s12
    s_cmp_eq_u32 s63, 0
    s_cbranch_scc1 L_pgd
L_pn0:
    s_cmp_eq_u32 s62, 1
    s_cbranch_scc1 L_prb
    v_max3_u32 v3, v12, v13, v14
    v_max_u32 v3, v3, v15
    v_cmp_eq_u32 vcc, -1, v3
    s_cbranch_vccnz L_pn1
L_pgot1:
    v_dot2c_f32_bf16 v64, s58, v12
    v_dot2c_f32_bf16 v65, s59, v12
    v_dot2c_f32_bf16 v66, s58, v13
    v_dot2c_f32_bf16 v67, s59, v13
    v_dot2c_f32_bf16 v68, s58, v14
    v_dot2c_f32_bf16 v69, s59, v14
    v_dot2c_f32_bf16 v70, s58, v15
    v_dot2c_f32_bf16 v71, s59, v15
    s_bitset0_b32 s63, s13
    s_cmp_eq_u32 s63, 0
    s_cbranch_scc1 L_pgd
L_pn1:
    s_cmp_eq_u32 s62, 2
    s_cbranch_scc1 L_prb
    v_max3_u32 v3, v16, v17, v18
    v_max_u32 v3, v3, v19
    v_cmp_eq_u32 vcc, -1, v3
    s_cbranch_vccnz L_pn2
L_pgot2:
    v_dot2c_f32_bf16 v64, s58, v16
    v_dot2c_f32_bf16 v65, s59, v16
    v_dot2c_f32_bf16 v66, s58, v17
    v_dot2c_f32_bf16 v67, s59, v17
    v_dot2c_f32_bf16 v68, s58, v18
    v_dot2c_f32_bf16 v69, s59, v18
    v_dot2c_f32_bf16 v70, s58, v19
    v_dot2c_f32_bf16 v71, s59, v19
    s_bitset0_b32 s63, s14
    s_cmp_eq_u32 s63, 0
    s_cbranch_scc1 L_pgd
L_pn2:
    s_cmp_eq_u32 s62, 3
    s_cbranch_scc1 L_prb
    v_max3_u32 v3, v20, v21, v22
    v_max_u32 v3, v3, v23
    v_cmp_eq_u32 vcc, -1, v3
    s_cbranch_vccnz L_pn3
L_pgot3:
    v_dot2c_f32_bf16 v64, s58, v20
    v_dot2c_f32_bf16 v65, s59, v20
    v_dot2c_f32_bf16 v66, s58, v21
    v_dot2c_f32_bf16 v67, s59, v21
    v_dot2c_f32_bf16 v68, s58, v22
    v_dot2c_f32_bf16 v69, s59, v22
    v_dot2c_f32_bf16 v70, s58, v23
    v_dot2c_f32_bf16 v71, s59, v23
    s_bitset0_b32 s63, s15
    s_cmp_eq_u32 s63, 0
    s_cbranch_scc1 L_pgd
L_pn3:
    s_cmp_eq_u32 s62, 4
    s_cbranch_scc1 L_prb
    v_max3_u32 v3, v24, v25, v26
    v_max_u32 v3, v3, v27
    v_cmp_eq_u32 vcc, -1, v3
    s_cbranch_vccnz L_pn4
L_pgot4:
    v_dot2c_f32_bf16 v64, s58, v24
    v_dot2c_f32_bf16 v65, s59, v24
    v_dot2c_f32_bf16 v66, s58, v25
    v_dot2c_f32_bf16 v67, s59, v25
    v_dot2c_f32_bf16 v68, s58, v26
    v_dot2c_f32_bf16 v69, s59, v26
    v_dot2c_f32_bf16 v70, s58, v27
    v_dot2c_f32_bf16 v71, s59, v27
    s_bitset0_b32 s63, s16
    s_cmp_eq_u32 s63, 0
    s_cbranch_scc1 L_pgd
L_pn4:
    s_cmp_eq_u32 s62, 5
    s_cbranch_scc1 L_prb
    v_max3_u32 v3, v28, v29, v30
    v_max_u32 v3, v3, v31
    v_cmp_eq_u32 vcc, -1, v3
    s_cbranch_vccnz L_pn5
L_pgot5:
    v_dot2c_f32_bf16 v64, s58, v28
    v_dot2c_f32_bf16 v65, s59, v28
    v_dot2c_f32_bf16 v66, s58, v29
    v_dot2c_f32_bf16 v67, s59, v29
    v_dot2c_f32_bf16 v68, s58, v30
    v_dot2c_f32_bf16 v69, s59, v30
    v_dot2c_f32_bf16 v70, s58, v31
    v_dot2c_f32_bf16 v71, s59, v31
    s_bitset0_b32 s63, s17
    s_cmp_eq_u32 s63, 0
    s_cbranch_scc1 L_pgd
L_pn5:
    s_cmp_eq_u32 s62, 6
    s_cbranch_scc1 L_prb
    v_max3_u32 v3, v32, v33, v34
    v_max_u32 v3, v3, v35
    v_cmp_eq_u32 vcc, -1, v3
    s_cbranch_vccnz L_pn6
L_pgot6:
    v_dot2c_f32_bf16 v64, s58, v32
    v_dot2c_f32_bf16 v65, s59, v32
    v_dot2c_f32_bf16 v66, s58, v33
    v_dot2c_f32_bf16 v67, s59, v33
    v_dot2c_f32_bf16 v68, s58, v34
    v_dot2c_f32_bf16 v69, s59, v34
    v_dot2c_f32_bf16 v70, s58, v35
    v_dot2c_f32_bf16 v71, s59, v35
    s_bitset0_b32 s63, s18
    s_cmp_eq_u32 s63, 0
    s_cbranch_scc1 L_pgd
L_pn6:
    s_cmp_eq_u32 s62, 7
    s_cbranch_scc1 L_prb
    v_max3_u32 v3, v36, v37, v38
    v_max_u32 v3, v3, v39
    v_cmp_eq_u32 vcc, -1, v3
    s_cbranch_vccnz L_pn7
L_pgot7:
    v_dot2c_f32_bf16 v64, s58, v36
    v_dot2c_f32_bf16 v65, s59, v36
    v_dot2c_f32_bf16 v66, s58, v37
    v_dot2c_f32_bf16 v67, s59, v37
    v_dot2c_f32_bf16 v68, s58, v38
    v_dot2c_f32_bf16 v69, s59, v38
    v_dot2c_f32_bf16 v70, s58, v39
    v_dot2c_f32_bf16 v71, s59, v39
    s_bitset0_b32 s63, s19
    s_cmp_eq_u32 s63, 0
    s_cbranch_scc1 L_pgd
L_pn7:
    s_branch L_prb
L_pi1:
L_poll_129:
    buffer_load_dwordx4 v[8:11], v5, s[40:43], s4 offen sc1
    s_sub_u32 s60, s60, 1
    s_cbranch_scc1 L_poll_129t
    s_waitcnt vmcnt(0)
    v_max3_u32 v3, v8, v9, v10
    v_max_u32 v3, v3, v11
    v_cmp_eq_u32 vcc, -1, v3
    s_cbranch_vccnz L_poll_129
L_poll_129e:
    v_dot2c_f32_bf16 v64, s58, v8
    v_dot2c_f32_bf16 v65, s59, v8
    v_dot2c_f32_bf16 v66, s58, v9
    v_dot2c_f32_bf16 v67, s59, v9
    v_dot2c_f32_bf16 v68, s58, v10
    v_dot2c_f32_bf16 v69, s59, v10
    v_dot2c_f32_bf16 v70, s58, v11
    v_dot2c_f32_bf16 v71, s59, v11
L_pgd:
    v_pk_fma_f32 v[64:65], v[64:65], v[48:49], v[40:41]
    v_pk_fma_f32 v[66:67], v[66:67], v[50:51], v[42:43]
    v_pk_fma_f32 v[68:69], v[68:69], v[52:53], v[44:45]
    v_pk_fma_f32 v[70:71], v[70:71], v[54:55], v[46:47]
    v_pk_mul_f32 v[56:57], v[64:65], v[56:57]
    v_pk_mul_f32 v[58:59], v[66:67], v[58:59]
    v_pk_mul_f32 v[60:61], v[68:69], v[60:61]
    v_pk_mul_f32 v[62:63], v[70:71], v[62:63]
    v_cvt_pk_bf16_f32 v8, v56, v57
    v_cvt_pk_bf16_f32 v9, v58, v59
    v_cvt_pk_bf16_f32 v10, v60, v61
    v_cvt_pk_bf16_f32 v11, v62, v63
    ds_write_b128 v4, v[8:11]
    v_pk_add_f32 v[40:41], v[64:65], v[66:67]
    v_pk_add_f32 v[42:43], v[68:69], v[70:71]
    v_pk_mul_f32 v[44:45], v[64:65], v[64:65]
    v_pk_mul_f32 v[46:47], v[66:67], v[66:67]
    v_pk_add_f32 v[40:41], v[40:41], v[42:43]
    v_pk_fma_f32 v[44:45], v[68:69], v[68:69], v[44:45]
    v_pk_fma_f32 v[46:47], v[70:71], v[70:71], v[46:47]
    v_add_f32 v40, v40, v41
    v_pk_add_f32 v[44:45], v[44:45], v[46:47]
    v_add_f32 v41, v44, v45
    ds_write_b64 v7, v[40:41]
    s_waitcnt lgkmcnt(0)
    s_barrier
    v_mov_b32 v16, 0
    v_mov_b32 v17, 0
    v_mov_b32 v18, 0
    v_mov_b32 v19, 0
    v_mov_b32 v20, 0
    v_mov_b32 v21, 0
    v_mov_b32 v22, 0
    v_mov_b32 v23, 0
    v_mov_b32 v24, 0
    v_mov_b32 v25, 0
    v_mov_b32 v26, 0
    v_mov_b32 v27, 0
    v_mov_b32 v28, 0
    v_mov_b32 v29, 0
    v_mov_b32 v30, 0
    v_mov_b32 v31, 0
    v_mov_b32 v32, 0
    v_mov_b32 v33, 0
    v_mov_b32 v34, 0
    v_mov_b32 v35, 0
    ds_write_b128 v6, v[64:67]
    ds_write_b128 v6, v[68:71] offset:16
    s_waitcnt lgkmcnt(0)
    s_cmp_lg_u32 s3, 7
    s_cbranch_scc1 L_ffn2
    s_cmp_lt_u32 s35, 20
    s_cbranch_scc1 L_fin
    s_endpgm
L_ffn1:
    s_barrier
L_ffn1b:
    ds_read_b128 v[8:11], v79
    ds_read_b64 v[30:31], v81 offset:0
    ds_read_b64 v[32:33], v81 offset:512
    ds_read_b64 v[34:35], v81 offset:1024
    ds_read_b64 v[36:37], v81 offset:1536
    ds_read_b64 v[38:39], v81 offset:2048
    ds_read_b128 v[12:15], v79 offset:256
    ds_read_b128 v[16:19], v79 offset:512
    ds_read_b128 v[20:23], v79 offset:768
    ds_read_b128 v[24:27], v79 offset:1024
    s_waitcnt lgkmcnt(9)
    v_smfmac_f32_16x16x64_bf16 v[52:55], v[8:11], v[88:95], v87
    v_smfmac_f32_16x16x64_bf16 v[56:59], v[8:11], v[96:103], v87
    s_waitcnt lgkmcnt(3)
    v_smfmac_f32_16x16x64_bf16 v[52:55], v[12:15], v[104:111], v87
    v_pk_add_f32 v[30:31], v[30:31], v[32:33]
    v_pk_add_f32 v[34:35], v[34:35], v[36:37]
    v_smfmac_f32_16x16x64_bf16 v[56:59], v[12:15], v[112:119], v87
    v_pk_add_f32 v[30:31], v[30:31], v[38:39]
    v_pk_add_f32 v[30:31], v[30:31], v[34:35]
    s_waitcnt lgkmcnt(2)
    v_smfmac_f32_16x16x64_bf16 v[52:55], v[16:19], v[120:127], v87
    v_add_f32_dpp v30, v30, v30 quad_perm:[1,0,3,2] row_mask:0xf bank_mask:0xf
    v_add_f32_dpp v31, v31, v31 quad_perm:[1,0,3,2] row_mask:0xf bank_mask:0xf
    v_smfmac_f32_16x16x64_bf16 v[56:59], v[16:19], v[128:135], v87
    v_add_f32_dpp v30, v30, v30 quad_perm:[2,3,0,1] row_mask:0xf bank_mask:0xf
    v_add_f32_dpp v31, v31, v31 quad_perm:[2,3,0,1] row_mask:0xf bank_mask:0xf
    s_waitcnt lgkmcnt(1)
    v_smfmac_f32_16x16x64_bf16 v[52:55], v[20:23], v[136:143], v87
    v_add_f32_dpp v30, v30, v30 row_ror:4 row_mask:0xf bank_mask:0xf
    v_add_f32_dpp v31, v31, v31 row_ror:4 row_mask:0xf bank_mask:0xf
    v_smfmac_f32_16x16x64_bf16 v[56:59], v[20:23], v[144:151], v87
    v_add_f32_dpp v30, v30, v30 row_ror:8 row_mask:0xf bank_mask:0xf
    v_add_f32_dpp v31, v31, v31 row_ror:8 row_mask:0xf bank_mask:0xf
    s_waitcnt lgkmcnt(0)
    v_smfmac_f32_16x16x64_bf16 v[52:55], v[24:27], v[152:159], v87
    v_mul_f32 v48, s62, v30
    v_mul_f32 v49, s62, v31
    v_smfmac_f32_16x16x64_bf16 v[56:59], v[24:27], v[160:167], v87
    v_mul_f32 v7, v84, v48
    v_fma_f32 v49, -v48, v48, -v49
    v_max_f32 v49, 0, v49
    v_add_f32 v49, 0x3727c5ac, v49
    v_rsq_f32 v49, v49
    v_add_f32 v4, v52, v53
    v_add_f32 v4, v4, v7
    s_nop 0
    v_add_f32 v5, v58, v59
    v_add_f32 v4, v4, v5
    v_fma_f32 v4, v4, v49, v85
    v_mul_f32 v5, v4, v4
    v_fma_f32 v5, v5, s63, v86
    v_mul_f32 v5, v5, v4
    v_exp_f32 v5, v5
    s_nop 0
    v_add_f32 v5, 1.0, v5
    v_rcp_f32 v5, v5
    s_nop 0
    v_mul_f32 v4, v4, v5
    v_cvt_pk_bf16_f32 v4, v4, v4
    ds_write_b16 v80, v4
    s_waitcnt lgkmcnt(0)
    s_barrier
    s_endpgm
L_cut:
L_h_t1:
    s_sub_u32 s63, s56, 154
    s_cmp_lt_u32 s63, 16
    s_cbranch_scc0 L_h_noclr
    s_lshl2_add_u32 s62, s63, s3
    s_mul_i32 s62, s62, 4608
    v_mov_b32 v4, -1
    v_mov_b32 v5, -1
    v_mov_b32 v6, -1
    v_mov_b32 v7, -1
    v_lshlrev_b32 v8, 4, v0
    buffer_store_dwordx4 v[4:7], v8, s[40:43], s62 offen offset:0 sc1
    buffer_store_dwordx4 v[4:7], v8, s[40:43], s62 offen offset:1024 sc1
    buffer_store_dwordx4 v[4:7], v8, s[40:43], s62 offen offset:2048 sc1
    buffer_store_dwordx4 v[4:7], v8, s[40:43], s62 offen offset:3072 sc1
    s_add_u32 s62, s62, 4096
    s_bfm_b64 exec, 32, 0
    buffer_store_dwordx4 v[4:7], v8, s[40:43], s62 offen offset:0 sc1
    s_mov_b64 exec, 1
    v_mov_b32 v9, 162100
    v_mov_b32 v10, 1
    s_and_b32 s62, s63, 1
    s_mul_i32 s62, s62, 126
    s_lshl1_add_u32 s63, s63, s62
    s_waitcnt vmcnt(0)
    ds_add_rtn_u32 v10, v9, v10
    s_waitcnt lgkmcnt(0)
    v_readfirstlane_b32 s62, v10
    s_nop 0
    s_cmp_lg_u32 s62, 3
    s_cbranch_scc1 L_h_clrd
    buffer_store_dword v4, v36, s[44:47], s63 offen sc1
L_h_clrd:
    s_mov_b64 exec, -1
L_h_noclr:
    v_lshrrev_b32 v1, 3, v0
    v_mul_u32_u24 v1, 1280, v1
    v_and_b32 v2, 7, v0
    v_lshl_add_u32 v1, v2, 4, v1
    s_lshl2_add_u32 s63, s34, s3
    s_mul_i32 s63, s63, 163840
    s_lshl_b32 s62, s35, 7
    s_add_u32 s63, s63, s62
    s_sub_u32 s63, s63, 2816
    s_lshl_b32 s62, s3, 14
    s_add_u32 s62, s62, 81920
    s_mov_b32 m0, s62
    s_mov_b32 s48, s12
    s_mov_b32 s49, s13
    s_mov_b32 s50, 5242880
    s_mov_b32 s51, 0x20000
    s_add_u32 s100, s39, 1
    s_mov_b32 s62, 8
L_dma_5:
    buffer_load_dwordx4 v1, s[48:51], s63 offen nt lds
    s_add_u32 m0, m0, 1024
    s_add_u32 s63, s63, 10240
    s_cmp_eq_u32 s100, 0
    s_cbranch_scc1 L_dma_5n0
    s_waitcnt vmcnt(7)
    s_cmp_eq_u32 s100, 2
    s_cbranch_scc1 L_dma_5n0
    s_waitcnt vmcnt(5)
L_dma_5n0:
    buffer_load_dwordx4 v1, s[48:51], s63 offen nt lds
    s_add_u32 m0, m0, 1024
    s_add_u32 s63, s63, 10240
    s_cmp_eq_u32 s100, 0
    s_cbranch_scc1 L_dma_5n1
    s_waitcnt vmcnt(7)
    s_cmp_eq_u32 s100, 2
    s_cbranch_scc1 L_dma_5n1
    s_waitcnt vmcnt(5)
L_dma_5n1:
    s_sub_u32 s62, s62, 1
    s_cmp_lg_u32 s62, 0
    s_cbranch_scc1 L_dma_5
    s_cmp_eq_u32 s39, 1
    s_cbranch_scc1 L_h_role
    s_barrier
    s_waitcnt vmcnt(0)
    v_mov_b32 v4, 162060
    v_mov_b32 v5, 1
    s_mov_b64 exec, 1
    ds_add_u32 v4, v5
    s_mov_b64 exec, -1
    s_cmp_eq_u32 s3, 0
    s_cbranch_scc1 L_service
    s_endpgm
L_h_role:
    v_mov_b32 v72, 0
    v_mov_b32 v73, 0
    v_mov_b32 v74, 0
    v_mov_b32 v75, 0
    v_mov_b32 v76, 0
    v_lshrrev_b32 v3, 4, v0
    v_and_b32 v2, 3, v0
    v_bfe_u32 v1, v0, 2, 2
    v_mul_u32_u24 v160, 1280, v3
    v_and_b32 v4, 15, v0
    v_lshl_add_u32 v163, v4, 2, v160
    v_lshl_add_u32 v160, v4, 3, v160
    s_mul_i32 s57, s35, 5120
    s_mul_i32 s62, s3, 320
    s_add_u32 s57, s57, s62
    s_add_u32 s57, s57, 327680
    s_mov_b32 s48, s20
    s_mov_b32 s49, s21
    s_mov_b32 s50, 2211840
    s_mov_b32 s51, 0x20000
    s_and_b32 s96, s3, 1
    s_lshl_b32 s97, s96, 6
    s_xor_b32 s96, s96, 1
    s_lshl_b32 s96, s96, 8
    v_add_u32 v160, s97, v160
    v_add_u32 v163, s96, v163
    v_lshrrev_b32 v8, 5, v0
    v_lshlrev_b32 v8, 2, v8
    v_bfe_u32 v9, v0, 4, 1
    v_add_u32 v8, v8, v9
    v_mul_u32_u24 v8, 5120, v8
    v_lshl_add_u32 v9, v4, 2, v8
    v_lshl_add_u32 v8, v4, 3, v8
    v_add_u32 v9, s96, v9
    v_add_u32 v8, s97, v8
    s_mul_i32 s63, s35, 81920
    s_add_u32 s63, s63, s62
    buffer_load_dwordx2 v[16:17], v8, s[48:51], s63 offen offset:0 nt
    buffer_load_dwordx2 v[48:49], v8, s[48:51], s63 offen offset:128 nt
    buffer_load_dword v80, v9, s[48:51], s63 offen offset:0 nt
    buffer_load_dwordx2 v[18:19], v8, s[48:51], s63 offen offset:1280 nt
    buffer_load_dwordx2 v[50:51], v8, s[48:51], s63 offen offset:1408 nt
    buffer_load_dword v81, v9, s[48:51], s63 offen offset:1280 nt
    buffer_load_dwordx2 v[24:25], v8, s[48:51], s63 offen offset:2560 nt
    buffer_load_dwordx2 v[56:57], v8, s[48:51], s63 offen offset:2688 nt
    buffer_load_dword v84, v9, s[48:51], s63 offen offset:2560 nt
    buffer_load_dwordx2 v[26:27], v8, s[48:51], s63 offen offset:3840 nt
    buffer_load_dwordx2 v[58:59], v8, s[48:51], s63 offen offset:3968 nt
    buffer_load_dword v85, v9, s[48:51], s63 offen offset:3840 nt
    s_add_u32 s63, s63, 10240
    buffer_load_dwordx2 v[20:21], v8, s[48:51], s63 offen offset:0 nt
    buffer_load_dwordx2 v[52:53], v8, s[48:51], s63 offen offset:128 nt
    buffer_load_dword v82, v9, s[48:51], s63 offen offset:0 nt
    buffer_load_dwordx2 v[22:23], v8, s[48:51], s63 offen offset:1280 nt
    s_waitcnt vmcnt(15)
    buffer_load_dwordx2 v[54:55], v8, s[48:51], s63 offen offset:1408 nt
    s_waitcnt vmcnt(15)
    buffer_load_dword v83, v9, s[48:51], s63 offen offset:1280 nt
    s_waitcnt vmcnt(15)
    buffer_load_dwordx2 v[28:29], v8, s[48:51], s63 offen offset:2560 nt
    s_waitcnt vmcnt(15)
    buffer_load_dwordx2 v[60:61], v8, s[48:51], s63 offen offset:2688 nt
    s_waitcnt vmcnt(15)
    buffer_load_dword v86, v9, s[48:51], s63 offen offset:2560 nt
    s_waitcnt vmcnt(15)
    buffer_load_dwordx2 v[30:31], v8, s[48:51], s63 offen offset:3840 nt
    s_waitcnt vmcnt(15)
    buffer_load_dwordx2 v[62:63], v8, s[48:51], s63 offen offset:3968 nt
    s_waitcnt vmcnt(15)
    buffer_load_dword v87, v9, s[48:51], s63 offen offset:3840 nt
    s_add_u32 s63, s63, 30720
    s_waitcnt vmcnt(15)
    buffer_load_dwordx2 v[32:33], v8, s[48:51], s63 offen offset:0 nt
    s_waitcnt vmcnt(15)
    buffer_load_dwordx2 v[64:65], v8, s[48:51], s63 offen offset:128 nt
    s_waitcnt vmcnt(15)
    buffer_load_dword v88, v9, s[48:51], s63 offen offset:0 nt
    s_waitcnt vmcnt(15)
    buffer_load_dwordx2 v[34:35], v8, s[48:51], s63 offen offset:1280 nt
    s_waitcnt vmcnt(15)
    buffer_load_dwordx2 v[66:67], v8, s[48:51], s63 offen offset:1408 nt
    s_waitcnt vmcnt(15)
    buffer_load_dword v89, v9, s[48:51], s63 offen offset:1280 nt
    s_waitcnt vmcnt(15)
    buffer_load_dwordx2 v[40:41], v8, s[48:51], s63 offen offset:2560 nt
    s_waitcnt vmcnt(15)
    buffer_load_dwordx2 v[72:73], v8, s[48:51], s63 offen offset:2688 nt
    s_waitcnt vmcnt(15)
    buffer_load_dword v92, v9, s[48:51], s63 offen offset:2560 nt
    s_waitcnt vmcnt(15)
    buffer_load_dwordx2 v[42:43], v8, s[48:51], s63 offen offset:3840 nt
    s_waitcnt vmcnt(15)
    buffer_load_dwordx2 v[74:75], v8, s[48:51], s63 offen offset:3968 nt
    s_waitcnt vmcnt(15)
    buffer_load_dword v93, v9, s[48:51], s63 offen offset:3840 nt
    s_add_u32 s63, s63, 10240
    s_waitcnt vmcnt(15)
    buffer_load_dwordx2 v[36:37], v8, s[48:51], s63 offen offset:0 nt
    s_waitcnt vmcnt(15)
    buffer_load_dwordx2 v[68:69], v8, s[48:51], s63 offen offset:128 nt
    s_waitcnt vmcnt(15)
    buffer_load_dword v90, v9, s[48:51], s63 offen offset:0 nt
    s_waitcnt vmcnt(15)
    buffer_load_dwordx2 v[38:39], v8, s[48:51], s63 offen offset:1280 nt
    s_waitcnt vmcnt(15)
    buffer_load_dwordx2 v[70:71], v8, s[48:51], s63 offen offset:1408 nt
    s_waitcnt vmcnt(15)
    buffer_load_dword v91, v9, s[48:51], s63 offen offset:1280 nt
    s_waitcnt vmcnt(15)
    buffer_load_dwordx2 v[44:45], v8, s[48:51], s63 offen offset:2560 nt
    s_waitcnt vmcnt(15)
    buffer_load_dwordx2 v[76:77], v8, s[48:51], s63 offen offset:2688 nt
    s_waitcnt vmcnt(15)
    buffer_load_dword v94, v9, s[48:51], s63 offen offset:2560 nt
    s_waitcnt vmcnt(15)
    buffer_load_dwordx2 v[46:47], v8, s[48:51], s63 offen offset:3840 nt
    s_waitcnt vmcnt(15)
    buffer_load_dwordx2 v[78:79], v8, s[48:51], s63 offen offset:3968 nt
    s_waitcnt vmcnt(15)
    buffer_load_dword v95, v9, s[48:51], s63 offen offset:3840 nt
    s_barrier
    s_mov_b32 s48, s16
    s_mov_b32 s49, s17
    s_mov_b32 s50, 2211840
    s_mov_b32 s51, 0x20000
    s_lshl_b32 s98, s35, 7
    s_mov_b32 s99, 3456
    v_lshrrev_b32 v12, 3, v0
    v_mul_lo_u32 v10, v12, s99
    v_and_b32 v12, 2, v12
    v_xor_b32 v12, v12, v0
    v_and_b32 v12, 7, v12
    v_lshl_add_u32 v10, v12, 4, v10
    v_add_u32 v10, s98, v10
    v_xor_b32 v11, 64, v10
    s_mul_i32 s63, s3, 552960
    s_mov_b32 m0, s101
    s_waitcnt lgkmcnt(0)
    s_cmp_ge_u32 s35, 22
    s_cselect_b32 s100, 2, 1
    s_mov_b32 s62, 10
L_dma_6:
    buffer_load_dwordx4 v10, s[48:51], s63 offen nt lds
    s_add_u32 m0, m0, 1024
    s_add_u32 s63, s63, 27648
    s_cmp_eq_u32 s100, 0
    s_cbranch_scc1 L_dma_6n0
    s_waitcnt vmcnt(7)
    s_cmp_eq_u32 s100, 2
    s_cbranch_scc1 L_dma_6n0
    s_waitcnt vmcnt(7)
L_dma_6n0:
    buffer_load_dwordx4 v11, s[48:51], s63 offen nt lds
    s_add_u32 m0, m0, 1024
    s_add_u32 s63, s63, 27648
    s_cmp_eq_u32 s100, 0
    s_cbranch_scc1 L_dma_6n1
    s_waitcnt vmcnt(7)
    s_cmp_eq_u32 s100, 2
    s_cbranch_scc1 L_dma_6n1
    s_waitcnt vmcnt(7)
L_dma_6n1:
    s_sub_u32 s62, s62, 1
    s_cmp_lg_u32 s62, 0
    s_cbranch_scc1 L_dma_6
    s_waitcnt vmcnt(20)
    v_mov_b32 v4, 162060
    v_mov_b32 v5, 1
    s_mov_b64 exec, 1
    ds_add_u32 v4, v5
    s_mov_b64 exec, -1
    s_mov_b32 s62, 0x05040100
    s_mov_b32 s63, 0x07060302
    v_perm_b32 v144, v81, v80, s62
    v_perm_b32 v152, v81, v80, s63
    v_perm_b32 v145, v83, v82, s62
    v_perm_b32 v153, v83, v82, s63
    v_perm_b32 v146, v85, v84, s62
    v_perm_b32 v154, v85, v84, s63
    v_perm_b32 v147, v87, v86, s62
    v_perm_b32 v155, v87, v86, s63
    v_perm_b32 v148, v89, v88, s62
    v_perm_b32 v156, v89, v88, s63
    v_perm_b32 v149, v91, v90, s62
    v_perm_b32 v157, v91, v90, s63
    v_perm_b32 v150, v93, v92, s62
    v_perm_b32 v158, v93, v92, s63
    v_perm_b32 v151, v95, v94, s62
    v_perm_b32 v159, v95, v94, s63
    v_perm_b32 v80, v18, v16, s62
    v_perm_b32 v88, v18, v16, s63
    v_perm_b32 v96, v19, v17, s62
    v_perm_b32 v104, v19, v17, s63
    v_perm_b32 v81, v22, v20, s62
    v_perm_b32 v89, v22, v20, s63
    v_perm_b32 v97, v23, v21, s62
    v_perm_b32 v105, v23, v21, s63
    v_perm_b32 v82, v26, v24, s62
    v_perm_b32 v90, v26, v24, s63
    v_perm_b32 v98, v27, v25, s62
    v_perm_b32 v106, v27, v25, s63
    v_perm_b32 v83, v30, v28, s62
    v_perm_b32 v91, v30, v28, s63
    v_perm_b32 v99, v31, v29, s62
    v_perm_b32 v107, v31, v29, s63
    v_perm_b32 v84, v34, v32, s62
    v_perm_b32 v92, v34, v32, s63
    v_perm_b32 v100, v35, v33, s62
    v_perm_b32 v108, v35, v33, s63
    v_perm_b32 v85, v38, v36, s62
    v_perm_b32 v93, v38, v36, s63
    v_perm_b32 v101, v39, v37, s62
    v_perm_b32 v109, v39, v37, s63
    v_perm_b32 v86, v42, v40, s62
    v_perm_b32 v94, v42, v40, s63
    v_perm_b32 v102, v43, v41, s62
    v_perm_b32 v110, v43, v41, s63
    v_perm_b32 v87, v46, v44, s62
    v_perm_b32 v95, v46, v44, s63
    v_perm_b32 v103, v47, v45, s62
    v_perm_b32 v111, v47, v45, s63
    v_perm_b32 v112, v50, v48, s62
    v_perm_b32 v120, v50, v48, s63
    v_perm_b32 v128, v51, v49, s62
    v_perm_b32 v136, v51, v49, s63
    v_perm_b32 v113, v54, v52, s62
    v_perm_b32 v121, v54, v52, s63
    v_perm_b32 v129, v55, v53, s62
    v_perm_b32 v137, v55, v53, s63
    v_perm_b32 v114, v58, v56, s62
    v_perm_b32 v122, v58, v56, s63
    v_perm_b32 v130, v59, v57, s62
    v_perm_b32 v138, v59, v57, s63
    v_perm_b32 v115, v62, v60, s62
    v_perm_b32 v123, v62, v60, s63
    v_perm_b32 v131, v63, v61, s62
    v_perm_b32 v139, v63, v61, s63
    v_perm_b32 v116, v66, v64, s62
    v_perm_b32 v124, v66, v64, s63
    v_perm_b32 v132, v67, v65, s62
    v_perm_b32 v140, v67, v65, s63
    v_perm_b32 v117, v70, v68, s62
    v_perm_b32 v125, v70, v68, s63
    v_perm_b32 v133, v71, v69, s62
    v_perm_b32 v141, v71, v69, s63
    v_perm_b32 v118, v74, v72, s62
    v_perm_b32 v126, v74, v72, s63
    v_perm_b32 v134, v75, v73, s62
    v_perm_b32 v142, v75, v73, s63
    v_perm_b32 v119, v78, v76, s62
    v_perm_b32 v127, v78, v76, s63
    v_perm_b32 v135, v79, v77, s62
    v_perm_b32 v143, v79, v77, s63
    v_mov_b32 v8, 162068
L_lw_7:
    ds_read_b32 v9, v8
    s_waitcnt lgkmcnt(0)
    v_cmp_gt_u32 vcc, 1, v9
    s_cbranch_vccz L_lw_7e
    s_sleep 8
    s_sub_u32 s60, s60, 1
    s_cbranch_scc0 L_lw_7
    s_mov_b32 s60, 0
L_lw_7e:
    s_cmp_lg_u32 s3, 3
    s_cbranch_scc1 L_h_nomo
    v_and_b32 v4, 15, v0
    v_lshlrev_b32 v4, 4, v4
    v_mul_u32_u24 v5, 1280, v3
    v_add_u32 v5, v5, v4
    v_mul_u32_u24 v6, 1296, v3
    v_add_u32 v6, v6, v4
    v_add_u32 v6, 147456, v6
    s_mov_b32 s62, 30720
    s_mov_b32 s63, 25600
    s_branch L_poll_8
L_poll_8s:
    s_sleep 8
L_poll_8:
    buffer_load_dwordx4 v[40:43], v5, s[40:43], s62 offen offset:0 sc1
    buffer_load_dwordx4 v[44:47], v5, s[40:43], s62 offen offset:256 sc1
    buffer_load_dwordx4 v[48:51], v5, s[40:43], s62 offen offset:512 sc1
    buffer_load_dwordx4 v[52:55], v5, s[40:43], s62 offen offset:768 sc1
    buffer_load_dwordx4 v[56:59], v5, s[40:43], s62 offen offset:1024 sc1
    buffer_load_dwordx4 v[60:63], v5, s[40:43], s63 offen offset:0 sc1
    buffer_load_dwordx4 v[64:67], v5, s[40:43], s63 offen offset:256 sc1
    buffer_load_dwordx4 v[68:71], v5, s[40:43], s63 offen offset:512 sc1
    buffer_load_dwordx4 v[72:75], v5, s[40:43], s63 offen offset:768 sc1
    buffer_load_dwordx4 v[76:79], v5, s[40:43], s63 offen offset:1024 sc1
    s_sub_u32 s60, s60, 1
    s_cbranch_scc1 L_poll_8t
    s_waitcnt vmcnt(0)
    v_max3_u32 v7, v40, v41, v42
    v_max3_u32 v7, v7, v43, v44
    v_max3_u32 v7, v7, v45, v46
    v_max3_u32 v7, v7, v47, v48
    v_max3_u32 v7, v7, v49, v50
    v_max3_u32 v7, v7, v51, v52
    v_max3_u32 v7, v7, v53, v54
    v_max3_u32 v7, v7, v55, v56
    v_max3_u32 v7, v7, v57, v58
    v_max3_u32 v7, v7, v59, v60
    v_max3_u32 v7, v7, v61, v62
    v_max3_u32 v7, v7, v63, v64
    v_max3_u32 v7, v7, v65, v66
    v_max3_u32 v7, v7, v67, v68
    v_max3_u32 v7, v7, v69, v70
    v_max3_u32 v7, v7, v71, v72
    v_max3_u32 v7, v7, v73, v74
    v_max3_u32 v7, v7, v75, v76
    v_max3_u32 v7, v7, v77, v78
    v_max_u32 v7, v7, v79
    v_cmp_eq_u32 vcc, -1, v7
    s_cbranch_vccnz L_poll_8s
L_poll_8e:
    ds_write_b128 v6, v[40:43] offset:0
    ds_write_b128 v6, v[44:47] offset:256
    ds_write_b128 v6, v[48:51] offset:512
    ds_write_b128 v6, v[52:55] offset:768
    ds_write_b128 v6, v[56:59] offset:1024
    ds_write_b128 v6, v[60:63] offset:5184
    ds_write_b128 v6, v[64:67] offset:5440
    ds_write_b128 v6, v[68:71] offset:5696
    ds_write_b128 v6, v[72:75] offset:5952
    ds_write_b128 v6, v[76:79] offset:6208
L_h_nomo:
    v_mul_u32_u24 v4, 144, v1
    v_lshl_add_u32 v4, v3, 5, v4
    v_bfe_u32 v5, v0, 1, 1
    v_lshl_add_u32 v4, v5, 4, v4
    v_add_u32 v4, 90688, v4
    v_mov_b32 v5, 162112
    v_and_b32 v6, 1, v0
    v_cmp_eq_u32 vcc, 0, v6
    s_nop 1
    v_cndmask_b32 v161, v5, v4, vcc
    v_cndmask_b32 v162, v4, v5, vcc
    v_bfe_u32 v164, v0, 1, 1
    v_mul_u32_u24 v164, 0xaaaa, v164
    v_add_u32 v164, 0x4444, v164
    s_mov_b32 s100, s3
    s_lshl_b32 s63, s100, 8
    v_and_b32 v8, 15, v0
    v_lshl_add_u32 v8, v8, 4, s63
    v_lshrrev_b32 v9, 4, v0
    v_mul_u32_u24 v5, 1280, v9
    v_add_u32 v5, v5, v8
    v_mul_u32_u24 v4, 1296, v9
    v_add_u32 v4, v4, v8
    v_add_u32 v4, 82944, v4
    v_lshlrev_b32 v6, 1, v5
    v_add_u32 v6, 99328, v6
    s_lshl_b32 s62, s100, 9
    s_add_u32 s62, s62, 88128
    v_lshl_add_u32 v7, v0, 3, s62
    s_mov_b32 s48, s4
    s_mov_b32 s49, s5
    s_mov_b32 s50, 5120
    s_mov_b32 s51, 0x20000
    buffer_load_dwordx4 v[8:11], v5, s[48:51], 0 offen
    s_mov_b32 s62, 20480
    s_mov_b32 s63, 30720
    s_branch L_poll_9
L_poll_9s:
    s_sleep 8
L_poll_9:
    buffer_load_dwordx4 v[12:15], v5, s[40:43], s62 offen sc1
    buffer_load_dwordx4 v[16:19], v5, s[40:43], s63 offen sc1
    s_sub_u32 s60, s60, 1
    s_cbranch_scc1 L_poll_9t
    s_waitcnt vmcnt(0)
    v_max3_u32 v38, v12, v13, v14
    v_max3_u32 v38, v38, v15, v16
    v_max3_u32 v38, v38, v17, v18
    v_max_u32 v38, v38, v19
    v_cmp_eq_u32 vcc, -1, v38
    s_cbranch_vccnz L_poll_9s
L_poll_9e:
    v_lshlrev_b32 v40, 16, v8
    v_and_b32 v41, 0xffff0000, v8
    v_lshlrev_b32 v42, 16, v9
    v_and_b32 v43, 0xffff0000, v9
    v_lshlrev_b32 v44, 16, v10
    v_and_b32 v45, 0xffff0000, v10
    v_lshlrev_b32 v46, 16, v11
    v_and_b32 v47, 0xffff0000, v11
    v_lshlrev_b32 v48, 16, v12
    v_and_b32 v49, 0xffff0000, v12
    v_lshlrev_b32 v50, 16, v13
    v_and_b32 v51, 0xffff0000, v13
    v_lshlrev_b32 v52, 16, v14
    v_and_b32 v53, 0xffff0000, v14
    v_lshlrev_b32 v54, 16, v15
    v_and_b32 v55, 0xffff0000, v15
    v_lshlrev_b32 v56, 16, v16
    v_and_b32 v57, 0xffff0000, v16
    v_lshlrev_b32 v58, 16, v17
    v_and_b32 v59, 0xffff0000, v17
    v_lshlrev_b32 v60, 16, v18
    v_and_b32 v61, 0xffff0000, v18
    v_lshlrev_b32 v62, 16, v19
    v_and_b32 v63, 0xffff0000, v19
    v_mov_b32 v64, 0
    v_mov_b32 v65, 0
    v_mov_b32 v66, 0
    v_mov_b32 v67, 0
    v_mov_b32 v68, 0
    v_mov_b32 v69, 0
    v_mov_b32 v70, 0
    v_mov_b32 v71, 0
    v_bfe_u32 v5, v0, 2, 2
    v_lshlrev_b32 v5, 8, v5
    v_lshrrev_b32 v8, 4, v0
    v_lshl_add_u32 v5, v8, 6, v5
    v_and_b32 v8, 3, v0
    v_lshl_add_u32 v5, v8, 4, v5
    s_lshl_b32 s56, s100, 10
    s_waitcnt vmcnt(0) lgkmcnt(0)
    v_mov_b32 v8, 162064
    v_mov_b32 v9, 1
    s_mov_b64 exec, 1
    ds_add_u32 v8, v9
    s_mov_b64 exec, -1
    s_branch L_t2gate
L_ffn2:
    s_barrier
L_ffn2b:
    ds_read_b128 v[8:11], v161
    ds_read_b128 v[12:15], v162
    s_cmp_eq_u32 s61, 1
    s_cbranch_scc0 L_f2slow
    s_waitcnt lgkmcnt(1)
    v_smfmac_f32_16x16x64_bf16 v[16:19], v[8:11], v[80:87], v164
    v_smfmac_f32_16x16x64_bf16 v[20:23], v[8:11], v[96:103], v164
    s_waitcnt lgkmcnt(0)
    v_smfmac_f32_16x16x64_bf16 v[16:19], v[12:15], v[88:95], v164
    v_smfmac_f32_16x16x64_bf16 v[20:23], v[12:15], v[104:111], v164
    v_smfmac_f32_16x16x64_bf16 v[24:27], v[8:11], v[112:119], v164
    v_smfmac_f32_16x16x64_bf16 v[28:31], v[8:11], v[128:135], v164
    v_smfmac_f32_16x16x64_bf16 v[24:27], v[12:15], v[120:127], v164
    v_smfmac_f32_16x16x64_bf16 v[28:31], v[12:15], v[136:143], v164
    v_smfmac_f32_16x16x64_bf16 v[32:35], v[8:11], v[144:151], v164
    v_smfmac_f32_16x16x64_bf16 v[32:35], v[12:15], v[152:159], v164
    s_nop 0
    v_pk_add_f32 v[16:17], v[16:17], v[18:19]
    v_cvt_pk_bf16_f32 v40, v16, v17
    v_pk_add_f32 v[20:21], v[20:21], v[22:23]
    v_cvt_pk_bf16_f32 v41, v20, v21
    buffer_store_dwordx2 v[40:41], v160, s[40:43], s57 offen
    v_pk_add_f32 v[24:25], v[24:25], v[26:27]
    v_cvt_pk_bf16_f32 v42, v24, v25
    v_pk_add_f32 v[28:29], v[28:29], v[30:31]
    v_cvt_pk_bf16_f32 v43, v28, v29
    buffer_store_dwordx2 v[42:43], v160, s[40:43], s57 offen offset:128
    v_pk_add_f32 v[32:33], v[32:33], v[34:35]
    v_cvt_pk_bf16_f32 v44, v32, v33
    buffer_store_dword v44, v163, s[40:43], s57 offen
L_f2done:
    s_barrier
    s_endpgm
L_f2slow:
    s_waitcnt lgkmcnt(1)
    v_smfmac_f32_16x16x64_bf16 v[16:19], v[8:11], v[80:87], v164
    v_smfmac_f32_16x16x64_bf16 v[20:23], v[8:11], v[96:103], v164
    s_waitcnt lgkmcnt(0)
    v_smfmac_f32_16x16x64_bf16 v[16:19], v[12:15], v[88:95], v164
    v_smfmac_f32_16x16x64_bf16 v[20:23], v[12:15], v[104:111], v164
    v_smfmac_f32_16x16x64_bf16 v[24:27], v[8:11], v[112:119], v164
    v_smfmac_f32_16x16x64_bf16 v[28:31], v[8:11], v[128:135], v164
    v_smfmac_f32_16x16x64_bf16 v[24:27], v[12:15], v[120:127], v164
    v_smfmac_f32_16x16x64_bf16 v[28:31], v[12:15], v[136:143], v164
    v_smfmac_f32_16x16x64_bf16 v[32:35], v[8:11], v[144:151], v164
    v_smfmac_f32_16x16x64_bf16 v[32:35], v[12:15], v[152:159], v164
    s_nop 0
    v_pk_add_f32 v[16:17], v[16:17], v[18:19]
    v_cvt_pk_bf16_f32 v40, v16, v17
    v_pk_add_f32 v[20:21], v[20:21], v[22:23]
    v_cvt_pk_bf16_f32 v41, v20, v21
    buffer_store_dwordx2 v[40:41], v160, s[40:43], s57 offen sc1
    v_pk_add_f32 v[24:25], v[24:25], v[26:27]
    v_cvt_pk_bf16_f32 v42, v24, v25
    v_pk_add_f32 v[28:29], v[28:29], v[30:31]
    v_cvt_pk_bf16_f32 v43, v28, v29
    buffer_store_dwordx2 v[42:43], v160, s[40:43], s57 offen offset:128 sc1
    v_pk_add_f32 v[32:33], v[32:33], v[34:35]
    v_cvt_pk_bf16_f32 v44, v32, v33
    buffer_store_dword v44, v163, s[40:43], s57 offen sc1
    s_branch L_f2done
L_poll_3t:
    s_mov_b32 s60, 0
    s_waitcnt vmcnt(0)
    s_branch L_poll_3e
L_poll_8t:
    s_mov_b32 s60, 0
    s_waitcnt vmcnt(0)
    s_branch L_poll_8e
L_poll_9t:
    s_mov_b32 s60, 0
    s_waitcnt vmcnt(0)
    s_branch L_poll_9e
L_poll_102t:
    s_mov_b32 s60, 0
    s_waitcnt vmcnt(0)
    s_branch L_poll_102e
L_pfast:
    buffer_store_dword v12, v108, s[40:43], s101 offen
    buffer_store_dword v12, v110, s[40:43], s101 offen
    s_branch L_pdone
L_poll_104t:
    s_mov_b32 s60, 0
    s_waitcnt vmcnt(0)
    s_branch L_poll_104e
L_poll_106t:
    s_mov_b32 s60, 0
    s_waitcnt vmcnt(0)
    s_branch L_poll_106e
L_poll_109t:
    s_mov_b32 s60, 0
    s_waitcnt vmcnt(0)
    s_branch L_poll_109e
L_poll_111t:
    s_mov_b32 s60, 0
    s_waitcnt vmcnt(0)
    s_branch L_poll_111e
L_poll_115t:
    s_mov_b32 s60, 0
    s_waitcnt vmcnt(0)
    s_branch L_poll_115e
L_poll_117t:
    s_mov_b32 s60, 0
    s_waitcnt vmcnt(0)
    s_branch L_poll_117e
L_ycs:
    buffer_store_dwordx4 v[24:27], v22, s[40:43], 0 offen offset:0 sc1
    buffer_store_dwordx4 v[24:27], v22, s[40:43], 0 offen offset:1024 sc1
    buffer_store_dwordx4 v[24:27], v22, s[40:43], 0 offen offset:2048 sc1
    buffer_store_dwordx4 v[24:27], v22, s[40:43], 0 offen offset:3072 sc1
    buffer_store_dwordx4 v[24:27], v23, s[40:43], 0 offen offset:0 sc1
    s_branch L_ycd
L_poll_118t:
    s_mov_b32 s60, 0
    s_waitcnt vmcnt(0)
    s_branch L_poll_118e
L_poll_123t:
    s_mov_b32 s60, 0
    s_waitcnt vmcnt(0)
    s_branch L_poll_123e
L_poll_125t:
    s_mov_b32 s60, 0
    s_waitcnt vmcnt(0)
    s_branch L_poll_125e
L_ygt:
    s_waitcnt vmcnt(0)
    v_mfma_f32_16x16x32_bf16 v[112:115], v[104:107], v[88:91], 0
    v_mfma_f32_16x16x32_bf16 v[112:115], v[104:107], v[92:95], v[112:115]
    v_mfma_f32_16x16x32_bf16 v[112:115], v[104:107], v[96:99], v[112:115]
    v_mfma_f32_16x16x32_bf16 v[112:115], v[104:107], v[100:103], v[112:115]
    s_nop 7
    s_branch L_ygd
L_pto:
    s_mov_b32 s60, 0
    s_waitcnt vmcnt(0)
    s_branch L_pgot0
L_poll_129t:
    s_mov_b32 s60, 0
    s_waitcnt vmcnt(0)
    s_branch L_poll_129e
L_end:
    s_endpgm
L_codeend:
.section .rodata,"a"
.p2align 6
.amdhsa_kernel adaLN_cond__sliding_block_cached__dense_activation_gelu__decode_kernel
  .amdhsa_next_free_vgpr 168
  .amdhsa_next_free_sgpr 102
  .amdhsa_accum_offset 168
  .amdhsa_group_segment_fixed_size 0
  .amdhsa_kernarg_size 120
  .amdhsa_user_sgpr_count 2
  .amdhsa_user_sgpr_kernarg_segment_ptr 1
  .amdhsa_system_sgpr_workgroup_id_x 1
.end_amdhsa_kernel
```
